```python
import torch

def _softmax(x, axis=-1):
    return torch.softmax(x, dim=axis)
def _gelu(x):
    return torch.nn.functional.gelu(x, approximate="tanh")
def _silu(x):
    return torch.nn.functional.silu(x)
def _sigmoid(x):
    return torch.sigmoid(x)
def _layernorm(x, axis=-1, eps=1e-5):
    m = x.mean(dim=axis, keepdim=True)
    v = x.var(dim=axis, keepdim=True, unbiased=False)
    return (x - m) / torch.sqrt(v + eps)
def _scatter_add(tgt, idx, src, axis=0):
    return tgt.clone().index_add_(axis, idx, src)
def _segment_sum(src, seg, n):
    out = torch.zeros((n,) + src.shape[1:], dtype=src.dtype)
    return out.index_add_(0, seg, src)
def _pad(x, pw):
    flat = tuple(v for pair in reversed(pw) for v in pair)
    return torch.nn.functional.pad(x, flat)

kernel_name = 'interleave_layers__softmax_full_mha__moe_arch_mod__prompt'

def setup_inputs():

    _w = (lambda a: (lambda t: t.to(torch.bfloat16) if t.is_floating_point() else t)(torch.as_tensor(a)))
    def _A_setup():
        B, S, D = 1, 2048, 1024
        return {
            "x": _w((lambda *s: torch.randn(*s, dtype=torch.bfloat16) * 0.05)(B, S, D)),
            "wqkv": _w((lambda *s: torch.randn(*s, dtype=torch.bfloat16) * 0.05)(D, 3 * D)),
            "wo": _w((lambda *s: torch.randn(*s, dtype=torch.bfloat16) * 0.05)(D, D)),
        }
    _A_in = _A_setup()

    def _B_setup():
        B, S, D, F, C = 1, 2048, 1024, 3584, 1
        return {
            "x": _w((lambda *s: torch.randn(*s, dtype=torch.bfloat16) * 0.05)(B, S, D)),
            "w_r": _w((lambda *s: torch.randn(*s, dtype=torch.bfloat16) * 0.05)(D)),
            "w_gate": _w((lambda *s: torch.randn(*s, dtype=torch.bfloat16) * 0.05)(D, F)),
            "w_up": _w((lambda *s: torch.randn(*s, dtype=torch.bfloat16) * 0.05)(D, F)),
            "w_down": _w((lambda *s: torch.randn(*s, dtype=torch.bfloat16) * 0.05)(F, D)),
        }
    _B_in = _B_setup()

    return {
        "A_x": _A_in["x"],
        "A_wqkv": _A_in["wqkv"],
        "A_wo": _A_in["wo"],
        "B_x": _B_in["x"],
        "B_w_r": _B_in["w_r"],
        "B_w_gate": _B_in["w_gate"],
        "B_w_up": _B_in["w_up"],
        "B_w_down": _B_in["w_down"],
    }

def reference(A_x, A_wqkv, A_wo, B_x, B_w_r, B_w_gate, B_w_up, B_w_down):
    def _A_ref(x, wqkv, wo):
        B, S, D = x.shape
        H = 32; Dh = D // H
        qkv = (lambda x, *d: x.permute(*d))((x @ wqkv).reshape(B, S, 3, H, Dh), 2, 0, 3, 1, 4)
        q, k, v = qkv[0], qkv[1], qkv[2]
        scale = Dh ** -0.5
        scores = torch.einsum("bhqd,bhkd->bhqk", q, k) * scale
        p = _softmax(scores, axis=-1)
        o = torch.einsum("bhqk,bhkd->bhqd", p, v)
        return (lambda x, *d: x.permute(*d))(o, 0, 2, 1, 3).reshape(B, S, D) @ wo

    def _B_ref(x, w_r, w_gate, w_up, w_down):
        B, S, D = x.shape
        C = 1
        r = x @ w_r
        idx = torch.argsort(-r, axis=-1)[:, :C]
        idx_e = (lambda x, n, axis: torch.repeat_interleave(x, n, dim=axis))(idx.reshape(B, C, 1), D, axis=2)
        x_sel = (lambda x, i, axis: torch.take_along_dim(x, i, dim=axis))(x, idx_e, axis=1)
        g = _silu(x_sel @ w_gate)
        u = x_sel @ w_up
        y = (g * u) @ w_down
        r_sel = _sigmoid((lambda x, i, axis: torch.take_along_dim(x, i, dim=axis))(r, idx, axis=1))
        y = y * r_sel.reshape(B, C, 1)
        b_off = (torch.arange(B) * S).reshape(B, 1)
        flat_idx = (idx + b_off).reshape(B * C)
        zero = (x * 0.0).reshape(B * S, D)
        upd = _scatter_add(zero, flat_idx, y.reshape(B * C, D), axis=0)
        return x + upd.reshape(B, S, D)

    x = A_x
    x = x + _A_ref(_layernorm(x, axis=-1), A_wqkv, A_wo)
    x = x + _B_ref(_layernorm(x, axis=-1), B_w_r, B_w_gate, B_w_up, B_w_down)
    x = x + _A_ref(_layernorm(x, axis=-1), A_wqkv, A_wo)
    x = x + _B_ref(_layernorm(x, axis=-1), B_w_r, B_w_gate, B_w_up, B_w_down)
    return x
```

```asm
; @launch kernel=fz_kernel grid=(256,1,1) block=(512,1,1) lds=163840
.amdgcn_target "amdgcn-amd-amdhsa--gfx950"
.text
.globl fz_kernel
.p2align 8
.type fz_kernel,@function
fz_kernel:
  s_cmp_ge_u32 s2, 256
  s_cbranch_scc1 .fz_kernel_end
  s_load_dwordx16 s[40:55], s[0:1], 0
  s_load_dwordx4 s[56:59], s[0:1], 64
  s_load_dwordx2 s[60:61], s[0:1], 80
  v_lshrrev_b32 v1, 6, v0
  v_and_b32 v2, 63, v0
  v_readfirstlane_b32 s16, v1
  s_and_b32 s21, s2, 7
  s_lshr_b32 s22, s2, 3
  s_and_b32 s23, s21, 3
  s_lshl_b32 s23, s23, 2
  s_and_b32 s24, s22, 3
  s_add_u32 s18, s23, s24
  s_lshr_b32 s24, s21, 2
  s_lshl_b32 s24, s24, 3
  s_lshr_b32 s25, s22, 2
  s_add_u32 s17, s24, s25
  s_lshl_b32 s19, s18, 4
  s_add_u32 s19, s19, s17
  s_lshl_b32 s19, s19, 7
  s_add_u32 s19, s19, 0x1800000
  v_lshlrev_b32 v3, 4, v2
  v_mov_b32 v4, 0
  v_mov_b32 v5, 1
  s_waitcnt lgkmcnt(0)
  s_mov_b32 s4, s60
  s_mov_b32 s5, s61
  s_mov_b32 s6, 0x2c00000
  s_mov_b32 s7, 0x00020000
  s_mov_b32 s62, 0
  s_mov_b32 s63, 0x400000
  s_mov_b32 s64, 0xc00000
  s_mov_b32 s65, 0x1000000
  s_mov_b32 s66, 0x1c00000
  s_mov_b32 s67, 0
  s_mov_b32 s71, 159744
  v_mov_b32 v6, 159808
  s_cmp_ge_u32 s16, 4
  s_cbranch_scc1 .fz_kernel_q_prod1
  v_lshlrev_b32 v20, 2, v0
  v_add_u32 v20, 159744, v20
  s_cmp_ge_u32 s16, 2
  s_cbranch_scc1 .fz_kernel_q_nz
  ds_write_b32 v20, v4
.fz_kernel_q_nz:
  s_lshr_b32 s26, s16, 1
  s_lshl_b32 s28, s26, 13
  v_and_b32 v20, 15, v2
  v_lshrrev_b32 v21, 4, v2
  v_bfe_u32 v22, v2, 1, 3
  v_xor_b32 v22, v22, v21
  v_lshlrev_b32 v20, 7, v20
  v_lshl_add_u32 v20, v22, 4, v20
  v_add_u32 v8, s28, v20
  v_xor_b32 v9, 64, v8
.fz_kernel_q_cs:
  s_and_b32 s27, s16, 1
  s_lshl_b32 s28, s27, 1
  v_lshrrev_b32 v14, 4, v2
  v_bfe_u32 v15, v2, 2, 2
  v_lshl_add_u32 v16, v14, 3, v15
  v_lshlrev_b32 v16, 7, v16
  v_and_b32 v14, 1, v14
  v_lshrrev_b32 v15, 1, v15
  v_lshl_add_u32 v14, v14, 1, v15
  v_xor_b32 v14, s28, v14
  v_lshl_add_u32 v16, v14, 5, v16
  v_and_b32 v14, 3, v2
  v_lshl_add_u32 v16, v14, 3, v16
  v_add_u32 v12, 65536, v16
  v_xor_b32 v13, 32, v12
  v_mov_b32 v10, v12
  v_mov_b32 v11, v13
  s_mov_b32 s29, 16
  s_mov_b32 s30, 0
  v_mov_b32 v128, 0
  v_mov_b32 v129, 0
  v_mov_b32 v130, 0
  v_mov_b32 v131, 0
  v_mov_b32 v132, 0
  v_mov_b32 v133, 0
  v_mov_b32 v134, 0
  v_mov_b32 v135, 0
  v_mov_b32 v136, 0
  v_mov_b32 v137, 0
  v_mov_b32 v138, 0
  v_mov_b32 v139, 0
  v_mov_b32 v140, 0
  v_mov_b32 v141, 0
  v_mov_b32 v142, 0
  v_mov_b32 v143, 0
  v_mov_b32 v144, 0
  v_mov_b32 v145, 0
  v_mov_b32 v146, 0
  v_mov_b32 v147, 0
  v_mov_b32 v148, 0
  v_mov_b32 v149, 0
  v_mov_b32 v150, 0
  v_mov_b32 v151, 0
  v_mov_b32 v152, 0
  v_mov_b32 v153, 0
  v_mov_b32 v154, 0
  v_mov_b32 v155, 0
  v_mov_b32 v156, 0
  v_mov_b32 v157, 0
  v_mov_b32 v158, 0
  v_mov_b32 v159, 0
  v_mov_b32 v160, 0
  v_mov_b32 v161, 0
  v_mov_b32 v162, 0
  v_mov_b32 v163, 0
  v_mov_b32 v164, 0
  v_mov_b32 v165, 0
  v_mov_b32 v166, 0
  v_mov_b32 v167, 0
  v_mov_b32 v168, 0
  v_mov_b32 v169, 0
  v_mov_b32 v170, 0
  v_mov_b32 v171, 0
  v_mov_b32 v172, 0
  v_mov_b32 v173, 0
  v_mov_b32 v174, 0
  v_mov_b32 v175, 0
  v_mov_b32 v176, 0
  v_mov_b32 v177, 0
  v_mov_b32 v178, 0
  v_mov_b32 v179, 0
  v_mov_b32 v180, 0
  v_mov_b32 v181, 0
  v_mov_b32 v182, 0
  v_mov_b32 v183, 0
  v_mov_b32 v184, 0
  v_mov_b32 v185, 0
  v_mov_b32 v186, 0
  v_mov_b32 v187, 0
  v_mov_b32 v188, 0
  v_mov_b32 v189, 0
  v_mov_b32 v190, 0
  v_mov_b32 v191, 0
  v_mov_b32 v192, 0
  v_mov_b32 v193, 0
  v_mov_b32 v194, 0
  v_mov_b32 v195, 0
  v_mov_b32 v196, 0
  v_mov_b32 v197, 0
  v_mov_b32 v198, 0
  v_mov_b32 v199, 0
  v_mov_b32 v200, 0
  v_mov_b32 v201, 0
  v_mov_b32 v202, 0
  v_mov_b32 v203, 0
  v_mov_b32 v204, 0
  v_mov_b32 v205, 0
  v_mov_b32 v206, 0
  v_mov_b32 v207, 0
  v_mov_b32 v208, 0
  v_mov_b32 v209, 0
  v_mov_b32 v210, 0
  v_mov_b32 v211, 0
  v_mov_b32 v212, 0
  v_mov_b32 v213, 0
  v_mov_b32 v214, 0
  v_mov_b32 v215, 0
  v_mov_b32 v216, 0
  v_mov_b32 v217, 0
  v_mov_b32 v218, 0
  v_mov_b32 v219, 0
  v_mov_b32 v220, 0
  v_mov_b32 v221, 0
  v_mov_b32 v222, 0
  v_mov_b32 v223, 0
  s_waitcnt vmcnt(0) lgkmcnt(0)
  s_barrier
  s_barrier
  ds_read_b64_tr_b16 v[56:57], v10 offset:4096
  ds_read_b64_tr_b16 v[58:59], v10 offset:4608
  ds_read_b128 v[32:35], v8 offset:0
  ds_read_b128 v[36:39], v8 offset:2048
  ds_read_b128 v[40:43], v8 offset:4096
  ds_read_b128 v[44:47], v8 offset:6144
  ds_read_b64_tr_b16 v[60:61], v11 offset:4096
  ds_read_b64_tr_b16 v[62:63], v11 offset:4608
  ds_read_b64_tr_b16 v[64:65], v10 offset:8192
  ds_read_b64_tr_b16 v[66:67], v10 offset:8704
  ds_read_b64_tr_b16 v[68:69], v11 offset:8192
  ds_read_b64_tr_b16 v[70:71], v11 offset:8704
  ds_read_b64_tr_b16 v[48:49], v10 offset:0
  ds_read_b64_tr_b16 v[50:51], v10 offset:512
  ds_read_b64_tr_b16 v[52:53], v11 offset:0
  ds_read_b64_tr_b16 v[54:55], v11 offset:512
  s_add_u32 s30, s30, 12288
  s_cmp_eq_u32 s30, 86016
  s_cselect_b32 s30, 0, s30
  v_add_u32 v8, 0x4000, v8
  v_add_u32 v10, s30, v12
  v_add_u32 v11, s30, v13
  v_and_b32 v8, 0xffff, v8
  s_waitcnt lgkmcnt(0)
  s_branch .fz_kernel_q_l0
  .p2align 6
.fz_kernel_q_loop:
  s_barrier
  v_mfma_f32_16x16x32_bf16 v[160:163], v[96:99], v[72:75], v[160:163]
  ds_read_b64_tr_b16 v[56:57], v10 offset:4096
  v_mfma_f32_16x16x32_bf16 v[164:167], v[96:99], v[76:79], v[164:167]
  ds_read_b64_tr_b16 v[58:59], v10 offset:4608
  v_mfma_f32_16x16x32_bf16 v[168:171], v[96:99], v[80:83], v[168:171]
  ds_read_b128 v[32:35], v8 offset:0
  v_mfma_f32_16x16x32_bf16 v[172:175], v[96:99], v[84:87], v[172:175]
  ds_read_b128 v[36:39], v8 offset:2048
  v_mfma_f32_16x16x32_bf16 v[176:179], v[100:103], v[72:75], v[176:179]
  ds_read_b128 v[40:43], v8 offset:4096
  v_mfma_f32_16x16x32_bf16 v[180:183], v[100:103], v[76:79], v[180:183]
  ds_read_b128 v[44:47], v8 offset:6144
  v_mfma_f32_16x16x32_bf16 v[184:187], v[100:103], v[80:83], v[184:187]
  ds_read_b64_tr_b16 v[60:61], v11 offset:4096
  v_mfma_f32_16x16x32_bf16 v[188:191], v[100:103], v[84:87], v[188:191]
  ds_read_b64_tr_b16 v[62:63], v11 offset:4608
  v_mfma_f32_16x16x32_bf16 v[192:195], v[72:75], v[104:107], v[192:195]
  ds_read_b64_tr_b16 v[64:65], v10 offset:8192
  v_mfma_f32_16x16x32_bf16 v[196:199], v[76:79], v[104:107], v[196:199]
  ds_read_b64_tr_b16 v[66:67], v10 offset:8704
  v_mfma_f32_16x16x32_bf16 v[200:203], v[80:83], v[104:107], v[200:203]
  ds_read_b64_tr_b16 v[68:69], v11 offset:8192
  v_mfma_f32_16x16x32_bf16 v[204:207], v[84:87], v[104:107], v[204:207]
  ds_read_b64_tr_b16 v[70:71], v11 offset:8704
  v_mfma_f32_16x16x32_bf16 v[208:211], v[72:75], v[108:111], v[208:211]
  ds_read_b64_tr_b16 v[48:49], v10 offset:0
  v_mfma_f32_16x16x32_bf16 v[212:215], v[76:79], v[108:111], v[212:215]
  ds_read_b64_tr_b16 v[50:51], v10 offset:512
  v_mfma_f32_16x16x32_bf16 v[216:219], v[80:83], v[108:111], v[216:219]
  ds_read_b64_tr_b16 v[52:53], v11 offset:0
  v_mfma_f32_16x16x32_bf16 v[220:223], v[84:87], v[108:111], v[220:223]
  ds_read_b64_tr_b16 v[54:55], v11 offset:512
  v_mfma_f32_16x16x32_bf16 v[128:131], v[88:91], v[72:75], v[128:131]
  s_add_u32 s30, s30, 12288
  s_cmp_eq_u32 s30, 86016
  s_cselect_b32 s30, 0, s30
  v_add_u32 v8, 0x4000, v8
  v_mfma_f32_16x16x32_bf16 v[132:135], v[88:91], v[76:79], v[132:135]
  v_add_u32 v10, s30, v12
  v_mfma_f32_16x16x32_bf16 v[136:139], v[88:91], v[80:83], v[136:139]
  v_add_u32 v11, s30, v13
  v_mfma_f32_16x16x32_bf16 v[140:143], v[88:91], v[84:87], v[140:143]
  v_and_b32 v8, 0xffff, v8
  v_mfma_f32_16x16x32_bf16 v[144:147], v[92:95], v[72:75], v[144:147]
  v_mfma_f32_16x16x32_bf16 v[148:151], v[92:95], v[76:79], v[148:151]
  v_mfma_f32_16x16x32_bf16 v[152:155], v[92:95], v[80:83], v[152:155]
  v_mfma_f32_16x16x32_bf16 v[156:159], v[92:95], v[84:87], v[156:159]
  s_waitcnt lgkmcnt(0)
.fz_kernel_q_l0:
  s_barrier
  v_mfma_f32_16x16x32_bf16 v[160:163], v[56:59], v[32:35], v[160:163]
  ds_read_b64_tr_b16 v[96:97], v10 offset:4096
  v_mfma_f32_16x16x32_bf16 v[164:167], v[56:59], v[36:39], v[164:167]
  ds_read_b64_tr_b16 v[98:99], v10 offset:4608
  v_mfma_f32_16x16x32_bf16 v[168:171], v[56:59], v[40:43], v[168:171]
  ds_read_b128 v[72:75], v9 offset:0
  v_mfma_f32_16x16x32_bf16 v[172:175], v[56:59], v[44:47], v[172:175]
  ds_read_b128 v[76:79], v9 offset:2048
  v_mfma_f32_16x16x32_bf16 v[176:179], v[60:63], v[32:35], v[176:179]
  ds_read_b128 v[80:83], v9 offset:4096
  v_mfma_f32_16x16x32_bf16 v[180:183], v[60:63], v[36:39], v[180:183]
  ds_read_b128 v[84:87], v9 offset:6144
  v_mfma_f32_16x16x32_bf16 v[184:187], v[60:63], v[40:43], v[184:187]
  ds_read_b64_tr_b16 v[100:101], v11 offset:4096
  v_mfma_f32_16x16x32_bf16 v[188:191], v[60:63], v[44:47], v[188:191]
  ds_read_b64_tr_b16 v[102:103], v11 offset:4608
  v_mfma_f32_16x16x32_bf16 v[192:195], v[32:35], v[64:67], v[192:195]
  ds_read_b64_tr_b16 v[104:105], v10 offset:8192
  v_mfma_f32_16x16x32_bf16 v[196:199], v[36:39], v[64:67], v[196:199]
  ds_read_b64_tr_b16 v[106:107], v10 offset:8704
  v_mfma_f32_16x16x32_bf16 v[200:203], v[40:43], v[64:67], v[200:203]
  ds_read_b64_tr_b16 v[108:109], v11 offset:8192
  v_mfma_f32_16x16x32_bf16 v[204:207], v[44:47], v[64:67], v[204:207]
  ds_read_b64_tr_b16 v[110:111], v11 offset:8704
  v_mfma_f32_16x16x32_bf16 v[208:211], v[32:35], v[68:71], v[208:211]
  ds_read_b64_tr_b16 v[88:89], v10 offset:0
  v_mfma_f32_16x16x32_bf16 v[212:215], v[36:39], v[68:71], v[212:215]
  ds_read_b64_tr_b16 v[90:91], v10 offset:512
  v_mfma_f32_16x16x32_bf16 v[216:219], v[40:43], v[68:71], v[216:219]
  ds_read_b64_tr_b16 v[92:93], v11 offset:0
  v_mfma_f32_16x16x32_bf16 v[220:223], v[44:47], v[68:71], v[220:223]
  ds_read_b64_tr_b16 v[94:95], v11 offset:512
  v_mfma_f32_16x16x32_bf16 v[128:131], v[48:51], v[32:35], v[128:131]
  s_add_u32 s30, s30, 12288
  s_cmp_eq_u32 s30, 86016
  s_cselect_b32 s30, 0, s30
  v_add_u32 v9, 0x4000, v9
  v_mfma_f32_16x16x32_bf16 v[132:135], v[48:51], v[36:39], v[132:135]
  v_add_u32 v10, s30, v12
  v_mfma_f32_16x16x32_bf16 v[136:139], v[48:51], v[40:43], v[136:139]
  v_add_u32 v11, s30, v13
  v_mfma_f32_16x16x32_bf16 v[140:143], v[48:51], v[44:47], v[140:143]
  v_and_b32 v9, 0xffff, v9
  v_mfma_f32_16x16x32_bf16 v[144:147], v[52:55], v[32:35], v[144:147]
  s_sub_u32 s29, s29, 1
  s_cmp_lg_u32 s29, 0
  v_mfma_f32_16x16x32_bf16 v[148:151], v[52:55], v[36:39], v[148:151]
  v_mfma_f32_16x16x32_bf16 v[152:155], v[52:55], v[40:43], v[152:155]
  v_mfma_f32_16x16x32_bf16 v[156:159], v[52:55], v[44:47], v[156:159]
  s_waitcnt lgkmcnt(0)
  s_cbranch_scc1 .fz_kernel_q_loop
  s_barrier
  v_mfma_f32_16x16x32_bf16 v[160:163], v[96:99], v[72:75], v[160:163]
  s_lshl_b32 s31, s26, 8
  s_add_u32 s31, s31, 155648
  v_and_b32 v14, 15, v2
  v_and_b32 v15, 48, v2
  v_mfma_f32_16x16x32_bf16 v[164:167], v[96:99], v[76:79], v[164:167]
  s_lshl_b32 s33, s27, 7
  s_add_u32 s33, s33, 155648
  v_lshlrev_b32 v14, 2, v14
  v_mov_b32 v1, 159952
  v_mfma_f32_16x16x32_bf16 v[168:171], v[96:99], v[80:83], v[168:171]
  v_add_u32 v29, s33, v14
  v_add_u32 v14, s31, v14
  v_mfma_f32_16x16x32_bf16 v[172:175], v[96:99], v[84:87], v[172:175]
  v_add_u32 v28, s33, v15
  v_add_u32 v15, s31, v15
  v_mfma_f32_16x16x32_bf16 v[176:179], v[100:103], v[72:75], v[176:179]
  ds_read_b32 v1, v1
  v_add_u32 v64, 4608, v14
  v_mfma_f32_16x16x32_bf16 v[180:183], v[100:103], v[76:79], v[180:183]
  ds_read_b128 v[120:123], v28 offset:5888
  v_mfma_f32_16x16x32_bf16 v[184:187], v[100:103], v[80:83], v[184:187]
  ds_read_b128 v[124:127], v28 offset:5952
  v_mfma_f32_16x16x32_bf16 v[188:191], v[100:103], v[84:87], v[188:191]
  ds_read2_b32 v[16:17], v64 offset0:0 offset1:128
  v_mfma_f32_16x16x32_bf16 v[192:195], v[72:75], v[104:107], v[192:195]
  ds_read2_b32 v[18:19], v64 offset0:16 offset1:144
  v_mfma_f32_16x16x32_bf16 v[196:199], v[76:79], v[104:107], v[196:199]
  ds_read2_b32 v[20:21], v64 offset0:32 offset1:160
  v_mfma_f32_16x16x32_bf16 v[200:203], v[80:83], v[104:107], v[200:203]
  ds_read2_b32 v[22:23], v64 offset0:48 offset1:176
  v_mfma_f32_16x16x32_bf16 v[204:207], v[84:87], v[104:107], v[204:207]
  ds_read_b32 v24, v29 offset:6144
  v_mfma_f32_16x16x32_bf16 v[208:211], v[72:75], v[108:111], v[208:211]
  ds_read_b32 v26, v29 offset:6208
  v_mfma_f32_16x16x32_bf16 v[212:215], v[76:79], v[108:111], v[212:215]
  ds_read_b128 v[32:35], v15 offset:4608
  ds_read_b128 v[48:51], v15 offset:5120
  v_mfma_f32_16x16x32_bf16 v[216:219], v[80:83], v[108:111], v[216:219]
  ds_read_b128 v[36:39], v15 offset:4672
  ds_read_b128 v[52:55], v15 offset:5184
  v_mfma_f32_16x16x32_bf16 v[220:223], v[84:87], v[108:111], v[220:223]
  ds_read_b128 v[40:43], v15 offset:4736
  ds_read_b128 v[56:59], v15 offset:5248
  v_mfma_f32_16x16x32_bf16 v[128:131], v[88:91], v[72:75], v[128:131]
  ds_read_b128 v[44:47], v15 offset:4800
  ds_read_b128 v[60:63], v15 offset:5312
  v_mfma_f32_16x16x32_bf16 v[132:135], v[88:91], v[76:79], v[132:135]
  ds_read_b128 v[112:115], v28 offset:5632
  ds_read_b128 v[116:119], v28 offset:5696
  v_mfma_f32_16x16x32_bf16 v[136:139], v[88:91], v[80:83], v[136:139]
  s_lshl_b32 s34, s18, 1
  s_add_u32 s34, s34, s27
  s_lshl_b32 s34, s34, 4
  s_add_u32 s34, s34, s17
  v_lshrrev_b32 v30, 3, v2
  v_and_b32 v31, 7, v2
  v_mfma_f32_16x16x32_bf16 v[140:143], v[88:91], v[84:87], v[140:143]
  s_lshl_b32 s34, s34, 1
  s_add_u32 s34, s34, s26
  s_lshl_b32 s36, s34, 13
  s_add_u32 s36, s36, s63
  v_lshlrev_b32 v31, 4, v31
  v_lshl_add_u32 v30, v30, 8, v31
  v_mfma_f32_16x16x32_bf16 v[144:147], v[92:95], v[72:75], v[144:147]
  s_add_u32 s37, s36, 4096
  s_lshl_b32 s34, s27, 1
  s_add_u32 s34, s34, s26
  s_lshl_b32 s35, s34, 13
  v_lshrrev_b32 v224, 4, v2
  v_and_b32 v31, 0xf0, v3
  v_mfma_f32_16x16x32_bf16 v[148:151], v[92:95], v[76:79], v[148:151]
  s_add_u32 s35, s35, 122880
  s_lshl_b32 s34, s34, 12
  s_add_u32 s34, s34, 106496
  v_lshl_add_u32 v31, v224, 9, v31
  v_add_u32 v224, s35, v30
  v_mfma_f32_16x16x32_bf16 v[152:155], v[92:95], v[80:83], v[152:155]
  v_add_u32 v225, s35, v31
  v_add_u32 v226, s34, v31
  v_mfma_f32_16x16x32_bf16 v[156:159], v[92:95], v[84:87], v[156:159]
  s_waitcnt lgkmcnt(12)
  v_cmp_ne_u32 vcc, 0, v1
  s_cbranch_vccnz .fz_kernel_q_patch
.fz_kernel_q_pback:
  v_pk_mul_f32 v[64:65], v[120:121], v[16:17] op_sel:[0,1] op_sel_hi:[1,1]
  v_pk_fma_f32 v[160:161], v[160:161], v[16:17], v[64:65] op_sel_hi:[1,0,1]
  v_pk_mul_f32 v[66:67], v[122:123], v[16:17] op_sel:[0,1] op_sel_hi:[1,1]
  v_pk_fma_f32 v[162:163], v[162:163], v[16:17], v[66:67] op_sel_hi:[1,0,1]
  v_pk_mul_f32 v[68:69], v[124:125], v[16:17] op_sel:[0,1] op_sel_hi:[1,1]
  v_pk_fma_f32 v[176:177], v[176:177], v[16:17], v[68:69] op_sel_hi:[1,0,1]
  v_pk_mul_f32 v[70:71], v[126:127], v[16:17] op_sel:[0,1] op_sel_hi:[1,1]
  v_pk_fma_f32 v[178:179], v[178:179], v[16:17], v[70:71] op_sel_hi:[1,0,1]
  v_cvt_pk_bf16_f32 v160, v160, v161
  v_cvt_pk_bf16_f32 v161, v162, v163
  v_cvt_pk_bf16_f32 v162, v176, v177
  v_cvt_pk_bf16_f32 v163, v178, v179
  buffer_store_dwordx4 v[160:163], v30, s[4:7], s36 offen offset:0 sc1
  ds_write_b128 v224, v[160:163] offset:0
  v_pk_mul_f32 v[64:65], v[120:121], v[18:19] op_sel:[0,1] op_sel_hi:[1,1]
  v_pk_fma_f32 v[164:165], v[164:165], v[18:19], v[64:65] op_sel_hi:[1,0,1]
  v_pk_mul_f32 v[66:67], v[122:123], v[18:19] op_sel:[0,1] op_sel_hi:[1,1]
  v_pk_fma_f32 v[166:167], v[166:167], v[18:19], v[66:67] op_sel_hi:[1,0,1]
  v_pk_mul_f32 v[68:69], v[124:125], v[18:19] op_sel:[0,1] op_sel_hi:[1,1]
  v_pk_fma_f32 v[180:181], v[180:181], v[18:19], v[68:69] op_sel_hi:[1,0,1]
  v_pk_mul_f32 v[70:71], v[126:127], v[18:19] op_sel:[0,1] op_sel_hi:[1,1]
  v_pk_fma_f32 v[182:183], v[182:183], v[18:19], v[70:71] op_sel_hi:[1,0,1]
  v_cvt_pk_bf16_f32 v164, v164, v165
  v_cvt_pk_bf16_f32 v165, v166, v167
  v_cvt_pk_bf16_f32 v166, v180, v181
  v_cvt_pk_bf16_f32 v167, v182, v183
  buffer_store_dwordx4 v[164:167], v30, s[4:7], s36 offen offset:128 sc1
  ds_write_b128 v224, v[164:167] offset:128
  v_pk_mul_f32 v[64:65], v[120:121], v[20:21] op_sel:[0,1] op_sel_hi:[1,1]
  v_pk_fma_f32 v[168:169], v[168:169], v[20:21], v[64:65] op_sel_hi:[1,0,1]
  v_pk_mul_f32 v[66:67], v[122:123], v[20:21] op_sel:[0,1] op_sel_hi:[1,1]
  v_pk_fma_f32 v[170:171], v[170:171], v[20:21], v[66:67] op_sel_hi:[1,0,1]
  v_pk_mul_f32 v[68:69], v[124:125], v[20:21] op_sel:[0,1] op_sel_hi:[1,1]
  v_pk_fma_f32 v[184:185], v[184:185], v[20:21], v[68:69] op_sel_hi:[1,0,1]
  v_pk_mul_f32 v[70:71], v[126:127], v[20:21] op_sel:[0,1] op_sel_hi:[1,1]
  v_pk_fma_f32 v[186:187], v[186:187], v[20:21], v[70:71] op_sel_hi:[1,0,1]
  v_cvt_pk_bf16_f32 v168, v168, v169
  v_cvt_pk_bf16_f32 v169, v170, v171
  v_cvt_pk_bf16_f32 v170, v184, v185
  v_cvt_pk_bf16_f32 v171, v186, v187
  buffer_store_dwordx4 v[168:171], v30, s[4:7], s37 offen offset:0 sc1
  ds_write_b128 v224, v[168:171] offset:4096
  v_pk_mul_f32 v[64:65], v[120:121], v[22:23] op_sel:[0,1] op_sel_hi:[1,1]
  v_pk_fma_f32 v[172:173], v[172:173], v[22:23], v[64:65] op_sel_hi:[1,0,1]
  v_pk_mul_f32 v[66:67], v[122:123], v[22:23] op_sel:[0,1] op_sel_hi:[1,1]
  v_pk_fma_f32 v[174:175], v[174:175], v[22:23], v[66:67] op_sel_hi:[1,0,1]
  v_pk_mul_f32 v[68:69], v[124:125], v[22:23] op_sel:[0,1] op_sel_hi:[1,1]
  v_pk_fma_f32 v[188:189], v[188:189], v[22:23], v[68:69] op_sel_hi:[1,0,1]
  v_pk_mul_f32 v[70:71], v[126:127], v[22:23] op_sel:[0,1] op_sel_hi:[1,1]
  v_pk_fma_f32 v[190:191], v[190:191], v[22:23], v[70:71] op_sel_hi:[1,0,1]
  v_cvt_pk_bf16_f32 v172, v172, v173
  v_cvt_pk_bf16_f32 v173, v174, v175
  v_cvt_pk_bf16_f32 v174, v188, v189
  v_cvt_pk_bf16_f32 v175, v190, v191
  buffer_store_dwordx4 v[172:175], v30, s[4:7], s37 offen offset:128 sc1
  ds_write_b128 v224, v[172:175] offset:4224
  s_waitcnt lgkmcnt(4)
  v_pk_mul_f32 v[64:65], v[48:49], v[24:25] op_sel_hi:[1,0]
  v_pk_fma_f32 v[192:193], v[192:193], v[32:33], v[64:65]
  v_pk_mul_f32 v[66:67], v[50:51], v[24:25] op_sel_hi:[1,0]
  v_pk_fma_f32 v[194:195], v[194:195], v[34:35], v[66:67]
  v_pk_mul_f32 v[68:69], v[52:53], v[24:25] op_sel_hi:[1,0]
  v_pk_fma_f32 v[196:197], v[196:197], v[36:37], v[68:69]
  v_pk_mul_f32 v[70:71], v[54:55], v[24:25] op_sel_hi:[1,0]
  v_pk_fma_f32 v[198:199], v[198:199], v[38:39], v[70:71]
  v_cvt_pk_bf16_f32 v192, v192, v193
  v_cvt_pk_bf16_f32 v193, v194, v195
  v_cvt_pk_bf16_f32 v194, v196, v197
  v_cvt_pk_bf16_f32 v195, v198, v199
  buffer_store_dwordx4 v[192:195], v31, s[4:7], s36 offen offset:2048 sc1
  ds_write_b128 v225, v[192:195] offset:2048
  v_pk_mul_f32 v[64:65], v[48:49], v[26:27] op_sel_hi:[1,0]
  v_pk_fma_f32 v[208:209], v[208:209], v[32:33], v[64:65]
  v_pk_mul_f32 v[66:67], v[50:51], v[26:27] op_sel_hi:[1,0]
  v_pk_fma_f32 v[210:211], v[210:211], v[34:35], v[66:67]
  v_pk_mul_f32 v[68:69], v[52:53], v[26:27] op_sel_hi:[1,0]
  v_pk_fma_f32 v[212:213], v[212:213], v[36:37], v[68:69]
  v_pk_mul_f32 v[70:71], v[54:55], v[26:27] op_sel_hi:[1,0]
  v_pk_fma_f32 v[214:215], v[214:215], v[38:39], v[70:71]
  v_cvt_pk_bf16_f32 v208, v208, v209
  v_cvt_pk_bf16_f32 v209, v210, v211
  v_cvt_pk_bf16_f32 v210, v212, v213
  v_cvt_pk_bf16_f32 v211, v214, v215
  buffer_store_dwordx4 v[208:211], v31, s[4:7], s36 offen offset:2304 sc1
  ds_write_b128 v225, v[208:211] offset:2304
  v_pk_mul_f32 v[64:65], v[56:57], v[24:25] op_sel_hi:[1,0]
  v_pk_fma_f32 v[200:201], v[200:201], v[40:41], v[64:65]
  v_pk_mul_f32 v[66:67], v[58:59], v[24:25] op_sel_hi:[1,0]
  v_pk_fma_f32 v[202:203], v[202:203], v[42:43], v[66:67]
  v_pk_mul_f32 v[68:69], v[60:61], v[24:25] op_sel_hi:[1,0]
  v_pk_fma_f32 v[204:205], v[204:205], v[44:45], v[68:69]
  v_pk_mul_f32 v[70:71], v[62:63], v[24:25] op_sel_hi:[1,0]
  v_pk_fma_f32 v[206:207], v[206:207], v[46:47], v[70:71]
  v_cvt_pk_bf16_f32 v200, v200, v201
  v_cvt_pk_bf16_f32 v201, v202, v203
  v_cvt_pk_bf16_f32 v202, v204, v205
  v_cvt_pk_bf16_f32 v203, v206, v207
  buffer_store_dwordx4 v[200:203], v31, s[4:7], s37 offen offset:2048 sc1
  ds_write_b128 v225, v[200:203] offset:6144
  v_pk_mul_f32 v[64:65], v[56:57], v[26:27] op_sel_hi:[1,0]
  v_pk_fma_f32 v[216:217], v[216:217], v[40:41], v[64:65]
  v_pk_mul_f32 v[66:67], v[58:59], v[26:27] op_sel_hi:[1,0]
  v_pk_fma_f32 v[218:219], v[218:219], v[42:43], v[66:67]
  v_pk_mul_f32 v[68:69], v[60:61], v[26:27] op_sel_hi:[1,0]
  v_pk_fma_f32 v[220:221], v[220:221], v[44:45], v[68:69]
  v_pk_mul_f32 v[70:71], v[62:63], v[26:27] op_sel_hi:[1,0]
  v_pk_fma_f32 v[222:223], v[222:223], v[46:47], v[70:71]
  v_cvt_pk_bf16_f32 v216, v216, v217
  v_cvt_pk_bf16_f32 v217, v218, v219
  v_cvt_pk_bf16_f32 v218, v220, v221
  v_cvt_pk_bf16_f32 v219, v222, v223
  buffer_store_dwordx4 v[216:219], v31, s[4:7], s37 offen offset:2304 sc1
  ds_write_b128 v225, v[216:219] offset:6400
  v_mul_f32 v16, 0.25503486164919736, v16
  v_mul_f32 v17, 0.25503486164919736, v17
  v_mul_f32 v18, 0.25503486164919736, v18
  v_mul_f32 v19, 0.25503486164919736, v19
  v_mul_f32 v20, 0.25503486164919736, v20
  v_mul_f32 v21, 0.25503486164919736, v21
  v_mul_f32 v22, 0.25503486164919736, v22
  v_mul_f32 v23, 0.25503486164919736, v23
  v_pk_mul_f32 v[64:65], v[112:113], v[16:17] op_sel:[0,1] op_sel_hi:[1,1]
  v_pk_fma_f32 v[128:129], v[128:129], v[16:17], v[64:65] op_sel_hi:[1,0,1]
  v_pk_mul_f32 v[66:67], v[114:115], v[16:17] op_sel:[0,1] op_sel_hi:[1,1]
  v_pk_fma_f32 v[130:131], v[130:131], v[16:17], v[66:67] op_sel_hi:[1,0,1]
  v_pk_mul_f32 v[68:69], v[116:117], v[16:17] op_sel:[0,1] op_sel_hi:[1,1]
  v_pk_fma_f32 v[144:145], v[144:145], v[16:17], v[68:69] op_sel_hi:[1,0,1]
  v_pk_mul_f32 v[70:71], v[118:119], v[16:17] op_sel:[0,1] op_sel_hi:[1,1]
  v_pk_fma_f32 v[146:147], v[146:147], v[16:17], v[70:71] op_sel_hi:[1,0,1]
  v_cvt_pk_bf16_f32 v128, v128, v129
  v_cvt_pk_bf16_f32 v129, v130, v131
  v_cvt_pk_bf16_f32 v130, v144, v145
  v_cvt_pk_bf16_f32 v131, v146, v147
  ds_write_b128 v226, v[128:131] offset:0
  v_pk_mul_f32 v[64:65], v[112:113], v[18:19] op_sel:[0,1] op_sel_hi:[1,1]
  v_pk_fma_f32 v[132:133], v[132:133], v[18:19], v[64:65] op_sel_hi:[1,0,1]
  v_pk_mul_f32 v[66:67], v[114:115], v[18:19] op_sel:[0,1] op_sel_hi:[1,1]
  v_pk_fma_f32 v[134:135], v[134:135], v[18:19], v[66:67] op_sel_hi:[1,0,1]
  v_pk_mul_f32 v[68:69], v[116:117], v[18:19] op_sel:[0,1] op_sel_hi:[1,1]
  v_pk_fma_f32 v[148:149], v[148:149], v[18:19], v[68:69] op_sel_hi:[1,0,1]
  v_pk_mul_f32 v[70:71], v[118:119], v[18:19] op_sel:[0,1] op_sel_hi:[1,1]
  v_pk_fma_f32 v[150:151], v[150:151], v[18:19], v[70:71] op_sel_hi:[1,0,1]
  v_cvt_pk_bf16_f32 v132, v132, v133
  v_cvt_pk_bf16_f32 v133, v134, v135
  v_cvt_pk_bf16_f32 v134, v148, v149
  v_cvt_pk_bf16_f32 v135, v150, v151
  ds_write_b128 v226, v[132:135] offset:256
  v_pk_mul_f32 v[64:65], v[112:113], v[20:21] op_sel:[0,1] op_sel_hi:[1,1]
  v_pk_fma_f32 v[136:137], v[136:137], v[20:21], v[64:65] op_sel_hi:[1,0,1]
  v_pk_mul_f32 v[66:67], v[114:115], v[20:21] op_sel:[0,1] op_sel_hi:[1,1]
  v_pk_fma_f32 v[138:139], v[138:139], v[20:21], v[66:67] op_sel_hi:[1,0,1]
  v_pk_mul_f32 v[68:69], v[116:117], v[20:21] op_sel:[0,1] op_sel_hi:[1,1]
  v_pk_fma_f32 v[152:153], v[152:153], v[20:21], v[68:69] op_sel_hi:[1,0,1]
  v_pk_mul_f32 v[70:71], v[118:119], v[20:21] op_sel:[0,1] op_sel_hi:[1,1]
  v_pk_fma_f32 v[154:155], v[154:155], v[20:21], v[70:71] op_sel_hi:[1,0,1]
  v_cvt_pk_bf16_f32 v136, v136, v137
  v_cvt_pk_bf16_f32 v137, v138, v139
  v_cvt_pk_bf16_f32 v138, v152, v153
  v_cvt_pk_bf16_f32 v139, v154, v155
  ds_write_b128 v226, v[136:139] offset:2048
  v_pk_mul_f32 v[64:65], v[112:113], v[22:23] op_sel:[0,1] op_sel_hi:[1,1]
  v_pk_fma_f32 v[140:141], v[140:141], v[22:23], v[64:65] op_sel_hi:[1,0,1]
  v_pk_mul_f32 v[66:67], v[114:115], v[22:23] op_sel:[0,1] op_sel_hi:[1,1]
  v_pk_fma_f32 v[142:143], v[142:143], v[22:23], v[66:67] op_sel_hi:[1,0,1]
  v_pk_mul_f32 v[68:69], v[116:117], v[22:23] op_sel:[0,1] op_sel_hi:[1,1]
  v_pk_fma_f32 v[156:157], v[156:157], v[22:23], v[68:69] op_sel_hi:[1,0,1]
  v_pk_mul_f32 v[70:71], v[118:119], v[22:23] op_sel:[0,1] op_sel_hi:[1,1]
  v_pk_fma_f32 v[158:159], v[158:159], v[22:23], v[70:71] op_sel_hi:[1,0,1]
  v_cvt_pk_bf16_f32 v140, v140, v141
  v_cvt_pk_bf16_f32 v141, v142, v143
  v_cvt_pk_bf16_f32 v142, v156, v157
  v_cvt_pk_bf16_f32 v143, v158, v159
  ds_write_b128 v226, v[140:143] offset:2304
  s_lshl_b32 s31, s62, 2
  s_add_u32 s31, s31, 159936
  v_mov_b32 v8, s31
  s_waitcnt lgkmcnt(0)
  s_barrier
  s_mov_b64 exec, 1
  s_waitcnt vmcnt(0)
  ds_add_rtn_u32 v9, v8, v5
  s_waitcnt lgkmcnt(0)
  v_readfirstlane_b32 s31, v9
  s_mov_b64 exec, -1
  s_cmp_lg_u32 s31, 3
  s_cbranch_scc1 .fz_kernel_att
  v_lshlrev_b32 v7, 7, v2
  s_lshl_b32 s31, s18, 11
  s_lshl_b32 s33, 1, s17
  s_add_u32 s31, s31, s67
  s_add_u32 s31, s31, 0x1800000
  v_mov_b32 v8, s33
  s_mov_b64 exec, 0xffff
  buffer_atomic_or v8, v7, s[4:7], s31 offen sc1
  s_mov_b64 exec, -1
  s_branch .fz_kernel_att
.fz_kernel_q_prod1:
  s_cmp_ge_u32 s16, 6
  s_cbranch_scc1 .fz_kernel_q_help1
  s_mov_b32 s8, s40
  s_mov_b32 s9, s41
  s_mov_b32 s10, 0x400000
  s_mov_b32 s11, 0x00020000
  v_lshrrev_b32 v20, 3, v2
  v_and_b32 v21, 7, v2
  v_lshrrev_b32 v22, 4, v2
  v_xor_b32 v23, v21, v22
  v_lshlrev_b32 v23, 4, v23
  v_lshl_add_u32 v24, v20, 11, v23
  v_xor_b32 v25, 64, v24
  s_lshl_b32 s35, s17, 2
  s_and_b32 s31, s16, 1
  s_add_u32 s35, s35, s31
  s_lshl_b32 s35, s35, 16
  s_and_b32 s29, s18, 12
  s_lshr_b32 s33, s17, 3
  s_lshl1_add_u32 s29, s33, s29
  s_lshl2_add_u32 s29, s17, s29
  s_and_b32 s29, s29, 15
  s_mov_b32 s22, 128
  s_mov_b32 s23, 131072
  s_mov_b32 s36, -1
  v_add_u32 v40, 0, v24
  v_add_u32 v41, 15360, v25
  v_add_u32 v42, 30720, v24
  v_add_u32 v43, 46080, v25
.fz_kernel_q_pc:
  s_mov_b32 s12, s42
  s_mov_b32 s13, s43
  s_mov_b32 s14, 0x600000
  s_mov_b32 s15, 0x00020000
  v_lshrrev_b32 v28, 3, v2
  v_and_b32 v29, 7, v2
  v_bfe_u32 v30, v2, 4, 1
  v_lshlrev_b32 v30, 1, v30
  v_xor_b32 v31, v29, v30
  v_lshlrev_b32 v31, 4, v31
  v_mul_u32_u24 v28, 6144, v28
  v_add_u32 v28, v28, v31
  v_xor_b32 v29, 64, v28
  s_lshl_b32 s32, s18, 7
  s_add_u32 s39, s32, 6291456
  s_mul_i32 s33, s29, 393216
  s_add_u32 s33, s33, s32
  s_lshl_b32 s29, s29, 1
  s_mul_i32 s25, s31, 6144
  s_add_u32 s25, s25, 65536
  s_mov_b32 s30, s25
  s_add_u32 s26, s25, 86016
  s_lshl_b32 s21, s31, 12
  s_mov_b32 s27, 0x400004
  s_mov_b32 s28, 0xc0000f
  s_cmp_eq_u32 s31, 0
  s_mov_b32 s24, 100352
  s_cselect_b32 s24, 0, s24
  v_add_u32 v32, s24, v28
  s_mov_b32 s24, 148480
  s_cselect_b32 s24, 48128, s24
  v_add_u32 v33, s24, v29
  s_mov_b32 s24, 2048
  s_cselect_b32 s24, 96256, s24
  v_add_u32 v34, s24, v28
  s_mov_b32 s24, 50176
  s_cselect_b32 s24, 144384, s24
  v_add_u32 v35, s24, v29
  s_mov_b32 s24, 102400
  s_cselect_b32 s24, 2048, s24
  v_add_u32 v36, s24, v28
  s_mov_b32 s24, 150528
  s_cselect_b32 s24, 50176, s24
  v_add_u32 v37, s24, v29
  s_cmp_eq_u32 s62, 0
  s_cbranch_scc1 .fz_kernel_q_st1
  s_mov_b32 s34, 32
  s_waitcnt vmcnt(0)
  s_barrier
  s_call_b64 s[0:1], .fz_kernel_q_iw
  s_call_b64 s[0:1], .fz_kernel_q_iw
  s_call_b64 s[0:1], .fz_kernel_q_iw
  s_waitcnt vmcnt(6)
  s_barrier
  s_call_b64 s[0:1], .fz_kernel_q_iw
  s_call_b64 s[0:1], .fz_kernel_q_iw
  s_call_b64 s[0:1], .fz_kernel_q_iw
  s_call_b64 s[0:1], .fz_kernel_q_ix
  s_call_b64 s[0:1], .fz_kernel_q_ix
  s_call_b64 s[0:1], .fz_kernel_q_ix
  s_call_b64 s[0:1], .fz_kernel_q_ix
  s_waitcnt vmcnt(8)
  s_barrier
  s_waitcnt vmcnt(8)
  s_barrier
  s_call_b64 s[0:1], .fz_kernel_q_ix
  s_call_b64 s[0:1], .fz_kernel_q_ix
  s_waitcnt vmcnt(8)
  s_barrier
  s_call_b64 s[0:1], .fz_kernel_q_ix
  s_call_b64 s[0:1], .fz_kernel_q_iu
  s_waitcnt vmcnt(22)
  s_barrier
  s_call_b64 s[0:1], .fz_kernel_q_iu
  s_waitcnt vmcnt(20)
  s_barrier
  s_call_b64 s[0:1], .fz_kernel_q_iu
  s_branch .fz_kernel_q_s3
.fz_kernel_q_st1:
  s_mov_b32 s34, 32
  s_call_b64 s[0:1], .fz_kernel_q_ix
  s_call_b64 s[0:1], .fz_kernel_q_iu
  s_waitcnt vmcnt(14)
  s_barrier
  s_call_b64 s[0:1], .fz_kernel_q_iu
  s_call_b64 s[0:1], .fz_kernel_q_iu
  s_call_b64 s[0:1], .fz_kernel_q_iu
  s_waitcnt vmcnt(30)
  s_barrier
  s_branch .fz_kernel_q_s2
  .p2align 6
.fz_kernel_q_iu:
  s_mov_b32 m0, s30
  s_add_u32 s30, s30, 12288
  buffer_load_dwordx4 v32, s[12:15], s33 offen offset:0 lds
  s_bfe_u32 s24, s29, 0x40001
  buffer_load_dwordx4 v33, s[12:15], s33 offen offset:1024 lds
  s_mul_i32 s20, s24, s22
  buffer_load_dwordx4 v34, s[12:15], s33 offen offset:2048 lds
  s_bitcmp1_b32 s29, 0
  s_cselect_b32 s31, s23, 0
  buffer_load_dwordx4 v35, s[12:15], s33 offen offset:3072 lds
  s_add_u32 m0, m0, 4096
  s_add_u32 s20, s20, s35
  buffer_load_dwordx4 v36, s[12:15], s33 offen offset:0 lds
  s_add_u32 s20, s20, s31
  buffer_load_dwordx4 v37, s[12:15], s33 offen offset:1024 lds
  s_bitcmp1_b32 s36, s24
  s_cbranch_scc0 .fz_kernel_xok2w
.fz_kernel_xok2:
  s_mov_b32 m0, s21
  s_add_u32 s21, s21, 8192
  buffer_load_dwordx4 v40, s[8:11], s20 offen offset:0 lds
  s_add_u32 s33, s33, 196608
  s_cmp_eq_u32 s33, s39
  s_cselect_b32 s33, s32, s33
  buffer_load_dwordx4 v41, s[8:11], s20 offen offset:1024 lds
  s_cmp_eq_u32 s30, s26
  s_cselect_b32 s30, s25, s30
  buffer_load_dwordx4 v42, s[8:11], s20 offen offset:2048 lds
  s_sub_u32 s34, s34, 1
  s_cmp_eq_u32 s34, 0
  s_cselect_b32 s27, -1, s27
  s_cselect_b32 s28, -1, s28
  buffer_load_dwordx4 v43, s[8:11], s20 offen offset:3072 lds
  s_and_b32 s21, s21, 0xffff
  s_add_u32 s29, s29, 1
  s_setpc_b64 s[0:1]
.fz_kernel_q_s4:
  s_waitcnt vmcnt(40)
  s_barrier
  s_getreg_b32 s31, hwreg(HW_REG_IB_STS)
  s_and_b32 s31, s31, 0xc0000f
  s_cmp_le_i32 s31, s27
  s_cbranch_scc0 .fz_kernel_q_s3
  s_call_b64 s[0:1], .fz_kernel_q_iu
  s_branch .fz_kernel_q_s4
.fz_kernel_q_s3:
  s_waitcnt vmcnt(30)
  s_barrier
  s_getreg_b32 s31, hwreg(HW_REG_IB_STS)
  s_and_b32 s31, s31, 0xc0000f
  s_cmp_le_i32 s31, s27
  s_cbranch_scc0 .fz_kernel_q_s2
  s_call_b64 s[0:1], .fz_kernel_q_iu
  s_branch .fz_kernel_q_s3
.fz_kernel_q_s2:
  s_waitcnt vmcnt(20)
  s_barrier
  s_getreg_b32 s31, hwreg(HW_REG_IB_STS)
  s_and_b32 s31, s31, 0xc0000f
  s_cmp_le_i32 s31, s28
  s_cbranch_scc0 .fz_kernel_q_s1
  s_call_b64 s[0:1], .fz_kernel_q_iu
  s_branch .fz_kernel_q_s2
.fz_kernel_q_s1:
  s_waitcnt vmcnt(10)
  s_barrier
  s_getreg_b32 s31, hwreg(HW_REG_IB_STS)
  s_and_b32 s31, s31, 0xc0000f
  s_cmp_le_i32 s31, s28
  s_cbranch_scc0 .fz_kernel_q_s0
  s_call_b64 s[0:1], .fz_kernel_q_iu
  s_branch .fz_kernel_q_s1
.fz_kernel_q_s0:
  s_waitcnt vmcnt(0)
  s_barrier
  s_getreg_b32 s31, hwreg(HW_REG_IB_STS)
  s_and_b32 s31, s31, 0xc0000f
  s_cmp_le_i32 s31, s28
  s_cbranch_scc0 .fz_kernel_q_se
  s_call_b64 s[0:1], .fz_kernel_q_iu
  s_branch .fz_kernel_q_s0
.fz_kernel_q_se:
  s_barrier
  s_cmp_eq_u32 s16, 5
  s_cbranch_scc1 .fz_kernel_q_pe
  s_add_u32 s37, s19, s67
  s_mov_b64 exec, 1
  buffer_load_dword v7, v4, s[4:7], s37 offen sc1
  s_waitcnt vmcnt(0)
  ds_or_b32 v6, v7
  s_mov_b64 exec, -1
  s_waitcnt lgkmcnt(0)
.fz_kernel_q_pe:
  s_barrier
  s_branch .fz_kernel_att
.fz_kernel_q_help1:
  s_mov_b32 s3, 32
  s_cmp_eq_u32 s16, 7
  s_cbranch_scc1 .fz_kernel_q_h7
  s_mov_b32 s12, s58
  s_mov_b32 s13, s59
  s_mov_b32 s14, 0x100
  s_mov_b32 s15, 0x00020000
  s_and_b32 s31, s18, 3
  s_lshl_b32 s30, s31, 14
  v_and_b32 v20, 15, v2
  v_lshrrev_b32 v21, 4, v2
  v_bfe_u32 v22, v2, 1, 3
  v_xor_b32 v22, v22, v21
  v_lshlrev_b32 v21, 7, v20
  v_lshl_add_u32 v21, v22, 4, v21
  v_add_u32 v21, s30, v21
  v_xor_b32 v22, 64, v21
  v_lshlrev_b32 v20, 3, v20
  s_lshl_b32 s30, s17, 4
  s_add_u32 s30, s30, s18
  s_lshl_b32 s30, s30, 10
  s_add_u32 s30, s30, 0x1880000
  s_mov_b32 s34, 0x00f0000f
  s_mov_b32 s35, 0xf0000f00
  v_mov_b32 v24, 0x3f803f80
  v_mov_b32 v25, v24
  v_mov_b32 v26, v24
  v_mov_b32 v27, v24
  s_lshl_b32 s31, s31, 1
  s_sub_u32 s31, 31, s31
  s_barrier
.fz_kernel_xs3:
  s_barrier
  s_sub_u32 s3, s3, 1
  s_cmp_lg_u32 s3, s31
  s_cbranch_scc1 .fz_kernel_xs3
  ds_read_b128 v[64:67], v21 offset:0
  ds_read_b128 v[72:75], v21 offset:2048
  ds_read_b128 v[80:83], v21 offset:4096
  ds_read_b128 v[88:91], v21 offset:6144
  ds_read_b128 v[96:99], v21 offset:8192
  ds_read_b128 v[104:107], v21 offset:10240
  ds_read_b128 v[112:115], v21 offset:12288
  ds_read_b128 v[120:123], v21 offset:14336
  ds_read_b128 v[68:71], v22 offset:0
  ds_read_b128 v[76:79], v22 offset:2048
  ds_read_b128 v[84:87], v22 offset:4096
  ds_read_b128 v[92:95], v22 offset:6144
  ds_read_b128 v[100:103], v22 offset:8192
  ds_read_b128 v[108:111], v22 offset:10240
  ds_read_b128 v[116:119], v22 offset:12288
  ds_read_b128 v[124:127], v22 offset:14336
  s_waitcnt lgkmcnt(0)
  s_cmp_eq_u32 s3, 0
  s_cbranch_scc1 .fz_kernel_hb4
  s_barrier
  s_sub_u32 s3, s3, 1
.fz_kernel_hb4:
  s_setprio 2
  v_mfma_f32_16x16x32_bf16 v[128:131], v[24:27], v[64:67], 0
  v_mfma_f32_16x16x32_bf16 v[160:163], v[64:67], v[64:67], 0
  v_mfma_f32_16x16x32_bf16 v[132:135], v[24:27], v[72:75], 0
  v_mfma_f32_16x16x32_bf16 v[164:167], v[72:75], v[72:75], 0
  v_mfma_f32_16x16x32_bf16 v[136:139], v[24:27], v[80:83], 0
  v_mfma_f32_16x16x32_bf16 v[168:171], v[80:83], v[80:83], 0
  v_mfma_f32_16x16x32_bf16 v[140:143], v[24:27], v[88:91], 0
  v_mfma_f32_16x16x32_bf16 v[172:175], v[88:91], v[88:91], 0
  v_mfma_f32_16x16x32_bf16 v[144:147], v[24:27], v[96:99], 0
  v_mfma_f32_16x16x32_bf16 v[176:179], v[96:99], v[96:99], 0
  v_mfma_f32_16x16x32_bf16 v[148:151], v[24:27], v[104:107], 0
  v_mfma_f32_16x16x32_bf16 v[180:183], v[104:107], v[104:107], 0
  v_mfma_f32_16x16x32_bf16 v[152:155], v[24:27], v[112:115], 0
  v_mfma_f32_16x16x32_bf16 v[184:187], v[112:115], v[112:115], 0
  v_mfma_f32_16x16x32_bf16 v[156:159], v[24:27], v[120:123], 0
  v_mfma_f32_16x16x32_bf16 v[188:191], v[120:123], v[120:123], 0
  v_mfma_f32_16x16x32_bf16 v[128:131], v[24:27], v[68:71], v[128:131]
  v_mfma_f32_16x16x32_bf16 v[160:163], v[68:71], v[68:71], v[160:163]
  v_mfma_f32_16x16x32_bf16 v[132:135], v[24:27], v[76:79], v[132:135]
  v_mfma_f32_16x16x32_bf16 v[164:167], v[76:79], v[76:79], v[164:167]
  v_mfma_f32_16x16x32_bf16 v[136:139], v[24:27], v[84:87], v[136:139]
  v_mfma_f32_16x16x32_bf16 v[168:171], v[84:87], v[84:87], v[168:171]
  v_mfma_f32_16x16x32_bf16 v[140:143], v[24:27], v[92:95], v[140:143]
  v_mfma_f32_16x16x32_bf16 v[172:175], v[92:95], v[92:95], v[172:175]
  v_mfma_f32_16x16x32_bf16 v[144:147], v[24:27], v[100:103], v[144:147]
  v_mfma_f32_16x16x32_bf16 v[176:179], v[100:103], v[100:103], v[176:179]
  v_mfma_f32_16x16x32_bf16 v[148:151], v[24:27], v[108:111], v[148:151]
  v_mfma_f32_16x16x32_bf16 v[180:183], v[108:111], v[108:111], v[180:183]
  v_mfma_f32_16x16x32_bf16 v[152:155], v[24:27], v[116:119], v[152:155]
  v_mfma_f32_16x16x32_bf16 v[184:187], v[116:119], v[116:119], v[184:187]
  v_mfma_f32_16x16x32_bf16 v[156:159], v[24:27], v[124:127], v[156:159]
  v_mfma_f32_16x16x32_bf16 v[188:191], v[124:127], v[124:127], v[188:191]
  s_setprio 0
  s_cmp_eq_u32 s3, 0
  s_cbranch_scc1 .fz_kernel_hb5
  s_barrier
  s_sub_u32 s3, s3, 1
.fz_kernel_hb5:
  s_mov_b32 exec_lo, 0x11111111
  s_mov_b32 exec_hi, 0x11111111
  v_mov_b32 v129, v160
  v_mov_b32 v133, v164
  v_mov_b32 v137, v168
  v_mov_b32 v141, v172
  v_mov_b32 v145, v176
  v_mov_b32 v149, v180
  v_mov_b32 v153, v184
  v_mov_b32 v157, v188
  s_mov_b32 exec_lo, 0x22222222
  s_mov_b32 exec_hi, 0x22222222
  v_mov_b32 v129, v161
  v_mov_b32 v133, v165
  v_mov_b32 v137, v169
  v_mov_b32 v141, v173
  v_mov_b32 v145, v177
  v_mov_b32 v149, v181
  v_mov_b32 v153, v185
  v_mov_b32 v157, v189
  s_mov_b32 exec_lo, 0x44444444
  s_mov_b32 exec_hi, 0x44444444
  v_mov_b32 v129, v162
  v_mov_b32 v133, v166
  v_mov_b32 v137, v170
  v_mov_b32 v141, v174
  v_mov_b32 v145, v178
  v_mov_b32 v149, v182
  v_mov_b32 v153, v186
  v_mov_b32 v157, v190
  s_mov_b32 exec_lo, 0x88888888
  s_mov_b32 exec_hi, 0x88888888
  v_mov_b32 v129, v163
  v_mov_b32 v133, v167
  v_mov_b32 v137, v171
  v_mov_b32 v141, v175
  v_mov_b32 v145, v179
  v_mov_b32 v149, v183
  v_mov_b32 v153, v187
  v_mov_b32 v157, v191
  s_cmp_eq_u32 s3, 0
  s_cbranch_scc1 .fz_kernel_hb6
  s_barrier
  s_sub_u32 s3, s3, 1
.fz_kernel_hb6:
  s_mov_b64 exec, s[34:35]
  buffer_store_dwordx2 v[128:129], v20, s[4:7], s30 offen offset:0 sc1
  buffer_store_dwordx2 v[132:133], v20, s[4:7], s30 offen offset:128 sc1
  buffer_store_dwordx2 v[136:137], v20, s[4:7], s30 offen offset:256 sc1
  buffer_store_dwordx2 v[140:141], v20, s[4:7], s30 offen offset:384 sc1
  buffer_store_dwordx2 v[144:145], v20, s[4:7], s30 offen offset:512 sc1
  buffer_store_dwordx2 v[148:149], v20, s[4:7], s30 offen offset:640 sc1
  buffer_store_dwordx2 v[152:153], v20, s[4:7], s30 offen offset:768 sc1
  buffer_store_dwordx2 v[156:157], v20, s[4:7], s30 offen offset:896 sc1
  buffer_load_dword v9, v4, s[12:15], 0 offen sc1
  s_mov_b64 exec, 1
  s_mov_b32 s38, 0
.fz_kernel_pw7:
  s_mov_b32 s46, 0
  s_call_b64 s[0:1], .fz_kernel_hw
  s_waitcnt vmcnt(0)
  v_readfirstlane_b32 s31, v9
  s_cmp_eq_u32 s31, 32
  s_cbranch_scc1 .fz_kernel_pw7d
  s_cmp_eq_u32 s3, 0
  s_cbranch_scc1 .fz_kernel_hb8
  s_barrier
  s_sub_u32 s3, s3, 1
.fz_kernel_hb8:
  s_cmp_eq_u32 s3, 0
  s_cbranch_scc1 .fz_kernel_hb9
  s_barrier
  s_sub_u32 s3, s3, 1
.fz_kernel_hb9:
  buffer_load_dword v9, v4, s[12:15], 0 offen sc1
  s_add_u32 s38, s38, 1
  s_cmp_lt_u32 s38, 131072
  s_cbranch_scc1 .fz_kernel_pw7
  s_waitcnt vmcnt(0)
.fz_kernel_pw7d:
  s_mov_b64 exec, -1
  v_lshlrev_b32 v7, 11, v2
  s_lshl_b32 s31, s17, 7
  s_lshl_b32 s33, 1, s18
  s_add_u32 s31, s31, s67
  s_add_u32 s31, s31, 0x1800018
  v_mov_b32 v8, s33
  s_mov_b64 exec, 0xffff
  buffer_atomic_or v8, v7, s[4:7], s31 offen sc1
  s_mov_b64 exec, -1
  s_mov_b32 s20, s48
  s_mov_b32 s21, s49
  s_mov_b32 s22, 0x800
  s_mov_b32 s23, 0x00020000
  v_lshlrev_b32 v20, 5, v2
  buffer_load_dwordx4 v[24:27], v20, s[20:23], 0 offen
  buffer_load_dwordx4 v[28:31], v20, s[20:23], 0 offen offset:16
  v_mov_b32 v20, 0
  s_mov_b32 s46, 0
  s_call_b64 s[0:1], .fz_kernel_hw
  s_waitcnt vmcnt(0)
  v_lshlrev_b32 v21, 16, v24
  v_and_b32 v22, 0xffff0000, v24
  v_add_f32 v20, v20, v21
  v_add_f32 v20, v20, v22
  v_lshlrev_b32 v21, 16, v25
  v_and_b32 v22, 0xffff0000, v25
  v_add_f32 v20, v20, v21
  v_add_f32 v20, v20, v22
  v_lshlrev_b32 v21, 16, v26
  v_and_b32 v22, 0xffff0000, v26
  v_add_f32 v20, v20, v21
  v_add_f32 v20, v20, v22
  v_lshlrev_b32 v21, 16, v27
  v_and_b32 v22, 0xffff0000, v27
  v_add_f32 v20, v20, v21
  v_add_f32 v20, v20, v22
  v_lshlrev_b32 v21, 16, v28
  v_and_b32 v22, 0xffff0000, v28
  v_add_f32 v20, v20, v21
  v_add_f32 v20, v20, v22
  v_lshlrev_b32 v21, 16, v29
  v_and_b32 v22, 0xffff0000, v29
  v_add_f32 v20, v20, v21
  v_add_f32 v20, v20, v22
  v_lshlrev_b32 v21, 16, v30
  v_and_b32 v22, 0xffff0000, v30
  v_add_f32 v20, v20, v21
  v_add_f32 v20, v20, v22
  v_lshlrev_b32 v21, 16, v31
  v_and_b32 v22, 0xffff0000, v31
  v_add_f32 v20, v20, v21
  v_add_f32 v20, v20, v22
  s_nop 1
  v_add_f32 v20, v20, v20 quad_perm:[1,0,3,2] row_mask:0xf bank_mask:0xf
  s_nop 1
  v_add_f32 v20, v20, v20 quad_perm:[2,3,0,1] row_mask:0xf bank_mask:0xf
  s_nop 1
  v_add_f32 v20, v20, v20 row_half_mirror row_mask:0xf bank_mask:0xf
  s_nop 1
  v_add_f32 v20, v20, v20 row_mirror row_mask:0xf bank_mask:0xf
  s_nop 0
  v_readlane_b32 s20, v20, 16
  v_readlane_b32 s21, v20, 32
  v_readlane_b32 s22, v20, 48
  v_add_f32 v20, s20, v20
  v_add_f32 v20, s21, v20
  v_add_f32 v20, s22, v20
  v_mul_f32 v20, 0x3a800000, v20
  s_nop 0
  v_readfirstlane_b32 s76, v20
  s_add_u32 s37, s19, 24
  v_mov_b32 v9, 0
  s_mov_b64 exec, 1
  s_mov_b32 s38, 0
.fz_kernel_pw10:
  s_mov_b32 s46, 0
  s_call_b64 s[0:1], .fz_kernel_hw
  s_waitcnt vmcnt(0)
  v_readfirstlane_b32 s31, v9
  s_cmp_eq_u32 s31, 65535
  s_cbranch_scc1 .fz_kernel_pw10d
  s_cmp_eq_u32 s3, 0
  s_cbranch_scc1 .fz_kernel_hb11
  s_barrier
  s_sub_u32 s3, s3, 1
.fz_kernel_hb11:
  s_cmp_eq_u32 s3, 0
  s_cbranch_scc1 .fz_kernel_hb12
  s_barrier
  s_sub_u32 s3, s3, 1
.fz_kernel_hb12:
  buffer_load_dword v9, v4, s[4:7], s37 offen sc1
  s_add_u32 s38, s38, 1
  s_cmp_lt_u32 s38, 131072
  s_cbranch_scc1 .fz_kernel_pw10
  s_waitcnt vmcnt(0)
.fz_kernel_pw10d:
  s_mov_b64 exec, -1
  s_lshl_b32 s30, s17, 14
  s_add_u32 s30, s30, 0x1880000
  buffer_load_dwordx4 v[64:67], v3, s[4:7], s30 offen offset:0
  buffer_load_dwordx4 v[68:71], v3, s[4:7], s30 offen offset:1024
  buffer_load_dwordx4 v[72:75], v3, s[4:7], s30 offen offset:2048
  buffer_load_dwordx4 v[76:79], v3, s[4:7], s30 offen offset:3072
  s_add_u32 s30, s30, 4096
  buffer_load_dwordx4 v[80:83], v3, s[4:7], s30 offen offset:0
  buffer_load_dwordx4 v[84:87], v3, s[4:7], s30 offen offset:1024
  buffer_load_dwordx4 v[88:91], v3, s[4:7], s30 offen offset:2048
  buffer_load_dwordx4 v[92:95], v3, s[4:7], s30 offen offset:3072
  s_add_u32 s30, s30, 4096
  buffer_load_dwordx4 v[96:99], v3, s[4:7], s30 offen offset:0
  buffer_load_dwordx4 v[100:103], v3, s[4:7], s30 offen offset:1024
  buffer_load_dwordx4 v[104:107], v3, s[4:7], s30 offen offset:2048
  buffer_load_dwordx4 v[108:111], v3, s[4:7], s30 offen offset:3072
  s_add_u32 s30, s30, 4096
  buffer_load_dwordx4 v[112:115], v3, s[4:7], s30 offen offset:0
  buffer_load_dwordx4 v[116:119], v3, s[4:7], s30 offen offset:1024
  buffer_load_dwordx4 v[120:123], v3, s[4:7], s30 offen offset:2048
  buffer_load_dwordx4 v[124:127], v3, s[4:7], s30 offen offset:3072
  s_add_u32 s30, s30, 4096
  s_mov_b32 s46, 0
  s_call_b64 s[0:1], .fz_kernel_hw
  s_waitcnt vmcnt(0)
  v_add_f32 v64, v64, v68
  v_add_f32 v65, v65, v69
  v_add_f32 v66, v66, v70
  v_add_f32 v67, v67, v71
  v_add_f32 v64, v64, v72
  v_add_f32 v65, v65, v73
  v_add_f32 v66, v66, v74
  v_add_f32 v67, v67, v75
  v_add_f32 v64, v64, v76
  v_add_f32 v65, v65, v77
  v_add_f32 v66, v66, v78
  v_add_f32 v67, v67, v79
  s_cmp_eq_u32 s3, 0
  s_cbranch_scc1 .fz_kernel_hb13
  s_barrier
  s_sub_u32 s3, s3, 1
.fz_kernel_hb13:
  v_add_f32 v64, v64, v80
  v_add_f32 v65, v65, v81
  v_add_f32 v66, v66, v82
  v_add_f32 v67, v67, v83
  v_add_f32 v64, v64, v84
  v_add_f32 v65, v65, v85
  v_add_f32 v66, v66, v86
  v_add_f32 v67, v67, v87
  v_add_f32 v64, v64, v88
  v_add_f32 v65, v65, v89
  v_add_f32 v66, v66, v90
  v_add_f32 v67, v67, v91
  v_add_f32 v64, v64, v92
  v_add_f32 v65, v65, v93
  v_add_f32 v66, v66, v94
  v_add_f32 v67, v67, v95
  v_add_f32 v64, v64, v96
  v_add_f32 v65, v65, v97
  v_add_f32 v66, v66, v98
  v_add_f32 v67, v67, v99
  v_add_f32 v64, v64, v100
  v_add_f32 v65, v65, v101
  v_add_f32 v66, v66, v102
  v_add_f32 v67, v67, v103
  v_add_f32 v64, v64, v104
  v_add_f32 v65, v65, v105
  v_add_f32 v66, v66, v106
  v_add_f32 v67, v67, v107
  s_cmp_eq_u32 s3, 0
  s_cbranch_scc1 .fz_kernel_hb14
  s_barrier
  s_sub_u32 s3, s3, 1
.fz_kernel_hb14:
  v_add_f32 v64, v64, v108
  v_add_f32 v65, v65, v109
  v_add_f32 v66, v66, v110
  v_add_f32 v67, v67, v111
  v_add_f32 v64, v64, v112
  v_add_f32 v65, v65, v113
  v_add_f32 v66, v66, v114
  v_add_f32 v67, v67, v115
  v_add_f32 v64, v64, v116
  v_add_f32 v65, v65, v117
  v_add_f32 v66, v66, v118
  v_add_f32 v67, v67, v119
  v_add_f32 v64, v64, v120
  v_add_f32 v65, v65, v121
  v_add_f32 v66, v66, v122
  v_add_f32 v67, v67, v123
  v_add_f32 v64, v64, v124
  v_add_f32 v65, v65, v125
  v_add_f32 v66, v66, v126
  v_add_f32 v67, v67, v127
  s_cmp_eq_u32 s3, 0
  s_cbranch_scc1 .fz_kernel_hb15
  s_barrier
  s_sub_u32 s3, s3, 1
.fz_kernel_hb15:
  v_mov_b32 v26, 0.0009765625
  v_mul_f32 v20, v26, v64
  v_mul_f32 v27, v20, v20
  v_fma_f32 v22, v65, v26, -v27
  v_max_f32 v22, 0, v22
  v_add_f32 v22, 1e-05, v22
  v_rsq_f32 v22, v22
  s_nop 0
  v_mul_f32 v20, v20, v22
  v_sub_f32 v20, 0, v20
  v_mul_f32 v21, v26, v66
  v_mul_f32 v27, v21, v21
  v_fma_f32 v23, v67, v26, -v27
  v_max_f32 v23, 0, v23
  v_add_f32 v23, 1e-05, v23
  v_rsq_f32 v23, v23
  s_nop 0
  v_mul_f32 v21, v21, v23
  v_sub_f32 v21, 0, v21
  v_lshlrev_b32 v24, 3, v2
  v_add_u32 v24, 155648, v24
  ds_write_b64 v24, v[22:23] offset:4608
  ds_write_b64 v24, v[20:21] offset:5120
  v_mov_b32 v20, 1.0
  v_mov_b32 v21, 1.0
  v_mov_b32 v22, 0
  v_mov_b32 v23, 0
  ds_write_b64 v24, v[20:21] offset:6400
  ds_write_b64 v24, v[22:23] offset:6912
  v_mov_b32 v24, 159952
  v_mov_b32 v25, s76
  ds_write_b32 v24, v25 offset:8
  s_waitcnt lgkmcnt(0)
.fz_kernel_q_hw2:
  s_add_u32 s3, s3, 2
.fz_kernel_q_he:
  s_cmp_eq_u32 s3, 0
  s_cbranch_scc1 .fz_kernel_att
  s_barrier
  s_sub_u32 s3, s3, 1
  s_branch .fz_kernel_q_he
.fz_kernel_q_h7:
  s_mov_b32 s8, s58
  s_mov_b32 s9, s59
  s_mov_b32 s10, 0x100
  s_mov_b32 s11, 0x00020000
  v_mov_b32 v12, 0
  v_mov_b32 v13, 0
  v_mov_b32 v14, 0
  v_mov_b32 v15, 0
  s_cmp_ge_u32 s2, 32
  s_cbranch_scc1 .fz_kernel_q_nzero
  s_lshl_b32 s36, s2, 10
  s_add_u32 s36, s36, 0x1800000
  buffer_store_dwordx4 v[12:15], v3, s[4:7], s36 offen sc1
.fz_kernel_q_nzero:
  v_and_b32 v21, 7, v2
  v_and_b32 v20, 16, v2
  v_lshlrev_b32 v20, 1, v20
  v_xor_b32 v20, v20, v3
  s_bfe_u32 s33, s17, 0x10002
  s_lshl_b32 s33, s33, 1
  s_mul_i32 s31, s33, 12288
  s_add_u32 s31, s31, 65536
  v_add_u32 v16, s31, v20
  v_xor_b32 v17, 64, v16
  s_add_u32 s31, s31, 12288
  s_cmp_eq_u32 s33, 6
  s_cselect_b32 s31, 65536, s31
  v_add_u32 v18, s31, v20
  v_xor_b32 v19, 64, v18
  s_sub_u32 s33, 31, s33
  v_lshlrev_b32 v21, 5, v21
  v_and_b32 v22, 16, v2
  v_add_u32 v21, v22, v21
  s_lshl_b32 s30, s18, 4
  s_add_u32 s30, s30, s17
  s_mul_i32 s30, s30, 768
  s_add_u32 s30, s30, 0x18c0000
  v_and_b32 v22, 1, v2
  v_lshlrev_b32 v22, 4, v22
  v_mov_b32 v23, 0x3f80
  v_lshlrev_b32 v22, v22, v23
  v_mov_b32 v24, 0
  v_mov_b32 v25, 0
  v_mov_b32 v26, 0
  v_mov_b32 v27, 0
  s_mov_b32 exec_lo, 0x30003
  s_mov_b32 exec_hi, 0x30003
  v_mov_b32 v24, v22
  s_mov_b32 exec_lo, 0xc000c
  s_mov_b32 exec_hi, 0xc000c
  v_mov_b32 v25, v22
  s_mov_b32 exec_lo, 0x300030
  s_mov_b32 exec_hi, 0x300030
  v_mov_b32 v26, v22
  s_mov_b32 exec_lo, 0xc000c0
  s_mov_b32 exec_hi, 0xc000c0
  v_mov_b32 v27, v22
  s_mov_b64 exec, -1
  s_barrier
  s_cmp_ge_u32 s2, 32
  s_cbranch_scc1 .fz_kernel_nz2
  s_mov_b64 exec, 1
  s_waitcnt vmcnt(0)
  buffer_atomic_add v5, v4, s[8:11], 0 offen sc1
  s_mov_b64 exec, -1
.fz_kernel_nz2:
  s_barrier
  s_sub_u32 s3, s3, 1
  s_cmp_lg_u32 s3, s33
  s_cbranch_scc1 .fz_kernel_nz2
  ds_read_b128 v[64:67], v16 offset:0
  ds_read_b128 v[68:71], v16 offset:4096
  ds_read_b128 v[72:75], v16 offset:8192
  ds_read_b128 v[76:79], v17 offset:1024
  ds_read_b128 v[80:83], v17 offset:5120
  ds_read_b128 v[84:87], v17 offset:9216
  ds_read_b128 v[88:91], v16 offset:2048
  ds_read_b128 v[92:95], v16 offset:6144
  ds_read_b128 v[96:99], v16 offset:10240
  ds_read_b128 v[100:103], v17 offset:3072
  ds_read_b128 v[104:107], v17 offset:7168
  ds_read_b128 v[108:111], v17 offset:11264
  s_waitcnt lgkmcnt(0)
  s_cmp_eq_u32 s3, 0
  s_cbranch_scc1 .fz_kernel_hb16
  s_barrier
  s_sub_u32 s3, s3, 1
.fz_kernel_hb16:
  ds_read_b128 v[112:115], v18 offset:0
  ds_read_b128 v[116:119], v18 offset:4096
  ds_read_b128 v[120:123], v18 offset:8192
  ds_read_b128 v[124:127], v19 offset:1024
  ds_read_b128 v[128:131], v19 offset:5120
  ds_read_b128 v[132:135], v19 offset:9216
  ds_read_b128 v[136:139], v18 offset:2048
  ds_read_b128 v[140:143], v18 offset:6144
  ds_read_b128 v[144:147], v18 offset:10240
  ds_read_b128 v[148:151], v19 offset:3072
  ds_read_b128 v[152:155], v19 offset:7168
  ds_read_b128 v[156:159], v19 offset:11264
  s_waitcnt lgkmcnt(0)
  s_cmp_eq_u32 s3, 0
  s_cbranch_scc1 .fz_kernel_hb17
  s_barrier
  s_sub_u32 s3, s3, 1
.fz_kernel_hb17:
  s_setprio 2
  v_mfma_f32_16x16x32_bf16 v[160:163], v[24:27], v[64:67], 0
  v_mfma_f32_16x16x32_bf16 v[164:167], v[24:27], v[68:71], 0
  v_mfma_f32_16x16x32_bf16 v[168:171], v[24:27], v[72:75], 0
  v_mfma_f32_16x16x32_bf16 v[160:163], v[24:27], v[76:79], v[160:163]
  v_mfma_f32_16x16x32_bf16 v[164:167], v[24:27], v[80:83], v[164:167]
  v_mfma_f32_16x16x32_bf16 v[168:171], v[24:27], v[84:87], v[168:171]
  v_mfma_f32_16x16x32_bf16 v[160:163], v[24:27], v[88:91], v[160:163]
  v_mfma_f32_16x16x32_bf16 v[164:167], v[24:27], v[92:95], v[164:167]
  v_mfma_f32_16x16x32_bf16 v[168:171], v[24:27], v[96:99], v[168:171]
  v_mfma_f32_16x16x32_bf16 v[160:163], v[24:27], v[100:103], v[160:163]
  v_mfma_f32_16x16x32_bf16 v[164:167], v[24:27], v[104:107], v[164:167]
  v_mfma_f32_16x16x32_bf16 v[168:171], v[24:27], v[108:111], v[168:171]
  v_mfma_f32_16x16x32_bf16 v[160:163], v[24:27], v[112:115], v[160:163]
  v_mfma_f32_16x16x32_bf16 v[164:167], v[24:27], v[116:119], v[164:167]
  v_mfma_f32_16x16x32_bf16 v[168:171], v[24:27], v[120:123], v[168:171]
  v_mfma_f32_16x16x32_bf16 v[160:163], v[24:27], v[124:127], v[160:163]
  v_mfma_f32_16x16x32_bf16 v[164:167], v[24:27], v[128:131], v[164:167]
  v_mfma_f32_16x16x32_bf16 v[168:171], v[24:27], v[132:135], v[168:171]
  v_mfma_f32_16x16x32_bf16 v[160:163], v[24:27], v[136:139], v[160:163]
  v_mfma_f32_16x16x32_bf16 v[164:167], v[24:27], v[140:143], v[164:167]
  v_mfma_f32_16x16x32_bf16 v[168:171], v[24:27], v[144:147], v[168:171]
  v_mfma_f32_16x16x32_bf16 v[160:163], v[24:27], v[148:151], v[160:163]
  v_mfma_f32_16x16x32_bf16 v[164:167], v[24:27], v[152:155], v[164:167]
  v_mfma_f32_16x16x32_bf16 v[168:171], v[24:27], v[156:159], v[168:171]
  s_setprio 0
  s_nop 4
  v_add_f32 v160, v160, v160 row_ror:8 row_mask:0xf bank_mask:0xf
  v_add_f32 v161, v161, v161 row_ror:8 row_mask:0xf bank_mask:0xf
  v_add_f32 v162, v162, v162 row_ror:8 row_mask:0xf bank_mask:0xf
  v_add_f32 v163, v163, v163 row_ror:8 row_mask:0xf bank_mask:0xf
  v_add_f32 v164, v164, v164 row_ror:8 row_mask:0xf bank_mask:0xf
  v_add_f32 v165, v165, v165 row_ror:8 row_mask:0xf bank_mask:0xf
  v_add_f32 v166, v166, v166 row_ror:8 row_mask:0xf bank_mask:0xf
  v_add_f32 v167, v167, v167 row_ror:8 row_mask:0xf bank_mask:0xf
  v_add_f32 v168, v168, v168 row_ror:8 row_mask:0xf bank_mask:0xf
  v_add_f32 v169, v169, v169 row_ror:8 row_mask:0xf bank_mask:0xf
  v_add_f32 v170, v170, v170 row_ror:8 row_mask:0xf bank_mask:0xf
  v_add_f32 v171, v171, v171 row_ror:8 row_mask:0xf bank_mask:0xf
  s_mov_b64 exec, 0x00ff00ff
  buffer_store_dwordx4 v[160:163], v21, s[4:7], s30 offen offset:0 sc1
  buffer_store_dwordx4 v[164:167], v21, s[4:7], s30 offen offset:256 sc1
  buffer_store_dwordx4 v[168:171], v21, s[4:7], s30 offen offset:512 sc1
  buffer_load_dword v9, v4, s[8:11], 0 offen sc1
  s_mov_b64 exec, 1
  s_mov_b32 s38, 0
.fz_kernel_pw18:
  s_mov_b32 s46, 0
  s_call_b64 s[0:1], .fz_kernel_hw
  s_waitcnt vmcnt(0)
  v_readfirstlane_b32 s31, v9
  s_cmp_eq_u32 s31, 32
  s_cbranch_scc1 .fz_kernel_pw18d
  s_cmp_eq_u32 s3, 0
  s_cbranch_scc1 .fz_kernel_hb19
  s_barrier
  s_sub_u32 s3, s3, 1
.fz_kernel_hb19:
  s_cmp_eq_u32 s3, 0
  s_cbranch_scc1 .fz_kernel_hb20
  s_barrier
  s_sub_u32 s3, s3, 1
.fz_kernel_hb20:
  buffer_load_dword v9, v4, s[8:11], 0 offen sc1
  s_add_u32 s38, s38, 1
  s_cmp_lt_u32 s38, 131072
  s_cbranch_scc1 .fz_kernel_pw18
  s_waitcnt vmcnt(0)
.fz_kernel_pw18d:
  s_mov_b64 exec, -1
  v_lshlrev_b32 v7, 7, v2
  s_lshl_b32 s31, s18, 11
  s_lshl_b32 s33, 1, s17
  s_add_u32 s31, s31, s67
  s_add_u32 s31, s31, 0x180001c
  v_mov_b32 v8, s33
  s_mov_b64 exec, 0xffff
  buffer_atomic_or v8, v7, s[4:7], s31 offen sc1
  s_mov_b64 exec, -1
  s_cmp_ge_u32 s2, 196
  s_cbranch_scc1 .fz_kernel_lz21
  s_lshl_b32 s36, s2, 12
  s_add_u32 s36, s36, 0x1c00000
  s_sub_u32 s31, s2, 66
  s_min_u32 s31, s31, s2
  s_sub_u32 s31, s31, 4
  s_cmp_lt_u32 s31, 6
  s_cbranch_scc1 .fz_kernel_lz21a
  buffer_store_dwordx4 v[12:15], v3, s[4:7], s36 offen sc1
  buffer_store_dwordx4 v[12:15], v3, s[4:7], s36 offen offset:1024 sc1
  buffer_store_dwordx4 v[12:15], v3, s[4:7], s36 offen offset:2048 sc1
  buffer_store_dwordx4 v[12:15], v3, s[4:7], s36 offen offset:3072 sc1
.fz_kernel_lz21:
  s_add_u32 s37, s19, 28
  v_mov_b32 v9, 0
  s_mov_b64 exec, 1
  s_mov_b32 s38, 0
.fz_kernel_pw22:
  s_mov_b32 s46, 0
  s_call_b64 s[0:1], .fz_kernel_hw
  s_waitcnt vmcnt(0)
  v_readfirstlane_b32 s31, v9
  s_cmp_eq_u32 s31, 65535
  s_cbranch_scc1 .fz_kernel_pw22d
  s_cmp_eq_u32 s3, 0
  s_cbranch_scc1 .fz_kernel_hb23
  s_barrier
  s_sub_u32 s3, s3, 1
.fz_kernel_hb23:
  s_cmp_eq_u32 s3, 0
  s_cbranch_scc1 .fz_kernel_hb24
  s_barrier
  s_sub_u32 s3, s3, 1
.fz_kernel_hb24:
  buffer_load_dword v9, v4, s[4:7], s37 offen sc1
  s_add_u32 s38, s38, 1
  s_cmp_lt_u32 s38, 131072
  s_cbranch_scc1 .fz_kernel_pw22
  s_waitcnt vmcnt(0)
.fz_kernel_pw22d:
  s_mov_b64 exec, -1
  s_mul_i32 s30, s18, 12288
  s_add_u32 s30, s30, 0x18c0000
  buffer_load_dwordx4 v[64:67], v3, s[4:7], s30 offen offset:0
  buffer_load_dwordx4 v[68:71], v3, s[4:7], s30 offen offset:768
  buffer_load_dwordx4 v[72:75], v3, s[4:7], s30 offen offset:1536
  buffer_load_dwordx4 v[76:79], v3, s[4:7], s30 offen offset:2304
  s_add_u32 s30, s30, 3072
  buffer_load_dwordx4 v[80:83], v3, s[4:7], s30 offen offset:0
  buffer_load_dwordx4 v[84:87], v3, s[4:7], s30 offen offset:768
  buffer_load_dwordx4 v[88:91], v3, s[4:7], s30 offen offset:1536
  buffer_load_dwordx4 v[92:95], v3, s[4:7], s30 offen offset:2304
  s_add_u32 s30, s30, 3072
  buffer_load_dwordx4 v[96:99], v3, s[4:7], s30 offen offset:0
  buffer_load_dwordx4 v[100:103], v3, s[4:7], s30 offen offset:768
  buffer_load_dwordx4 v[104:107], v3, s[4:7], s30 offen offset:1536
  buffer_load_dwordx4 v[108:111], v3, s[4:7], s30 offen offset:2304
  s_add_u32 s30, s30, 3072
  buffer_load_dwordx4 v[112:115], v3, s[4:7], s30 offen offset:0
  buffer_load_dwordx4 v[116:119], v3, s[4:7], s30 offen offset:768
  buffer_load_dwordx4 v[120:123], v3, s[4:7], s30 offen offset:1536
  buffer_load_dwordx4 v[124:127], v3, s[4:7], s30 offen offset:2304
  s_add_u32 s30, s30, 3072
  s_mov_b32 s46, 0
  s_call_b64 s[0:1], .fz_kernel_hw
  s_waitcnt vmcnt(0)
  v_add_f32 v64, v64, v68
  v_add_f32 v65, v65, v69
  v_add_f32 v66, v66, v70
  v_add_f32 v67, v67, v71
  v_add_f32 v64, v64, v72
  v_add_f32 v65, v65, v73
  v_add_f32 v66, v66, v74
  v_add_f32 v67, v67, v75
  v_add_f32 v64, v64, v76
  v_add_f32 v65, v65, v77
  v_add_f32 v66, v66, v78
  v_add_f32 v67, v67, v79
  s_cmp_eq_u32 s3, 0
  s_cbranch_scc1 .fz_kernel_hb25
  s_barrier
  s_sub_u32 s3, s3, 1
.fz_kernel_hb25:
  v_add_f32 v64, v64, v80
  v_add_f32 v65, v65, v81
  v_add_f32 v66, v66, v82
  v_add_f32 v67, v67, v83
  v_add_f32 v64, v64, v84
  v_add_f32 v65, v65, v85
  v_add_f32 v66, v66, v86
  v_add_f32 v67, v67, v87
  v_add_f32 v64, v64, v88
  v_add_f32 v65, v65, v89
  v_add_f32 v66, v66, v90
  v_add_f32 v67, v67, v91
  v_add_f32 v64, v64, v92
  v_add_f32 v65, v65, v93
  v_add_f32 v66, v66, v94
  v_add_f32 v67, v67, v95
  v_add_f32 v64, v64, v96
  v_add_f32 v65, v65, v97
  v_add_f32 v66, v66, v98
  v_add_f32 v67, v67, v99
  v_add_f32 v64, v64, v100
  v_add_f32 v65, v65, v101
  v_add_f32 v66, v66, v102
  v_add_f32 v67, v67, v103
  v_add_f32 v64, v64, v104
  v_add_f32 v65, v65, v105
  v_add_f32 v66, v66, v106
  v_add_f32 v67, v67, v107
  s_cmp_eq_u32 s3, 0
  s_cbranch_scc1 .fz_kernel_hb26
  s_barrier
  s_sub_u32 s3, s3, 1
.fz_kernel_hb26:
  v_add_f32 v64, v64, v108
  v_add_f32 v65, v65, v109
  v_add_f32 v66, v66, v110
  v_add_f32 v67, v67, v111
  v_add_f32 v64, v64, v112
  v_add_f32 v65, v65, v113
  v_add_f32 v66, v66, v114
  v_add_f32 v67, v67, v115
  v_add_f32 v64, v64, v116
  v_add_f32 v65, v65, v117
  v_add_f32 v66, v66, v118
  v_add_f32 v67, v67, v119
  v_add_f32 v64, v64, v120
  v_add_f32 v65, v65, v121
  v_add_f32 v66, v66, v122
  v_add_f32 v67, v67, v123
  v_add_f32 v64, v64, v124
  v_add_f32 v65, v65, v125
  v_add_f32 v66, v66, v126
  v_add_f32 v67, v67, v127
  s_cmp_eq_u32 s3, 0
  s_cbranch_scc1 .fz_kernel_hb27
  s_barrier
  s_sub_u32 s3, s3, 1
.fz_kernel_hb27:
  v_add_u32 v24, 155648, v3
  s_mov_b32 exec_hi, 0xffff
  ds_write_b128 v24, v[64:67] offset:5632
  s_mov_b64 exec, -1
  s_waitcnt lgkmcnt(0)
  s_branch .fz_kernel_q_hw2
.fz_kernel_att:
  s_setprio 3
  ds_read_b32 v7, v6
  s_and_b32 s39, s16, 1
  s_lshr_b32 s32, s16, 1
  s_lshl2_add_u32 s31, s39, s32
  s_lshl_b32 s31, s31, 12
  s_add_u32 s31, s31, 122880
  v_add_u32 v8, s31, v3
  ds_read_b128 v[184:187], v8 offset:0
  ds_read_b128 v[188:191], v8 offset:1024
  s_add_u32 s31, s32, 0
  s_and_b32 s31, s31, 3
  s_lshl2_add_u32 s31, s39, s31
  s_lshl_b32 s31, s31, 11
  s_add_u32 s31, s31, 106496
  v_add_u32 v9, s31, v3
  ds_read_b128 v[32:35], v9
  ds_read_b128 v[36:39], v9 offset:1024
  ds_read_b128 v[192:195], v8 offset:2048
  ds_read_b128 v[196:199], v8 offset:3072
  s_add_u32 s31, s32, 1
  s_and_b32 s31, s31, 3
  s_lshl2_add_u32 s31, s39, s31
  s_lshl_b32 s31, s31, 11
  s_add_u32 s31, s31, 106496
  v_add_u32 v9, s31, v3
  ds_read_b128 v[40:43], v9
  ds_read_b128 v[44:47], v9 offset:1024
  s_add_u32 s31, s32, 2
  s_and_b32 s31, s31, 3
  s_lshl2_add_u32 s31, s39, s31
  s_lshl_b32 s31, s31, 11
  s_add_u32 s31, s31, 106496
  v_add_u32 v9, s31, v3
  ds_read_b128 v[48:51], v9
  ds_read_b128 v[52:55], v9 offset:1024
  s_add_u32 s31, s32, 3
  s_and_b32 s31, s31, 3
  s_lshl2_add_u32 s31, s39, s31
  s_lshl_b32 s31, s31, 11
  s_add_u32 s31, s31, 106496
  v_add_u32 v9, s31, v3
  ds_read_b128 v[56:59], v9
  ds_read_b128 v[60:63], v9 offset:1024
  s_mov_b32 s24, s44
  s_mov_b32 s25, s45
  s_mov_b32 s26, 0x200000
  s_mov_b32 s27, 0x00020000
  v_lshrrev_b32 v8, 3, v2
  v_and_b32 v9, 7, v2
  v_bfe_u32 v10, v2, 4, 1
  v_lshlrev_b32 v10, 2, v10
  v_xor_b32 v9, v9, v10
  v_lshlrev_b32 v9, 4, v9
  v_lshl_add_u32 v10, v8, 11, v9
  s_lshl_b32 s31, s18, 7
  s_lshl_b32 s71, s16, 10
  s_sub_u32 s28, s71, 16384
  v_add_u32 v13, s31, v10
  s_lshl1_add_u32 s35, s18, s39
  s_lshl_b32 s35, s35, 6
  s_add_u32 s35, s35, s32
  s_lshl_b32 s35, s35, 12
  s_add_u32 s35, s35, s63
  s_add_u32 s37, s19, s67
  s_lshl_b32 s34, 1, s17
  v_mov_b32 v12, 0x3f803f80
  v_mov_b32 v27, 0x4444
  v_mov_b32 v28, v12
  v_mov_b32 v30, 0
  s_mov_b32 exec_lo, 0xaaaaaaaa
  s_mov_b32 exec_hi, 0xaaaaaaaa
  v_mov_b32 v28, 0
  v_mov_b32 v30, v12
  s_mov_b32 exec_lo, 0xcccccccc
  s_mov_b32 exec_hi, 0xcccccccc
  v_mov_b32 v27, 0xeeee
  s_mov_b64 exec, -1
  v_mov_b32 v29, v28
  v_mov_b32 v31, v30
  s_mov_b32 s8, s54
  s_mov_b32 s9, s55
  s_mov_b32 s10, 0x0
  s_mov_b32 s11, 0x00020000
  s_mov_b32 s12, 0
  s_mov_b32 s13, 0
  v_mov_b32 v15, 0
  v_mov_b32 v128, 0
  v_mov_b32 v129, 0
  v_mov_b32 v130, 0
  v_mov_b32 v131, 0
  v_mov_b32 v132, 0
  v_mov_b32 v133, 0
  v_mov_b32 v134, 0
  v_mov_b32 v135, 0
  v_mov_b32 v136, 0
  v_mov_b32 v137, 0
  v_mov_b32 v138, 0
  v_mov_b32 v139, 0
  v_mov_b32 v140, 0
  v_mov_b32 v141, 0
  v_mov_b32 v142, 0
  v_mov_b32 v143, 0
  s_waitcnt lgkmcnt(12)
  v_readfirstlane_b32 s36, v7
  s_andn2_b32 s33, s36, s34
  s_bcnt1_i32_b32 s39, s33
  s_cmp_lt_u32 s39, 3
  s_cbranch_scc1 .fz_kernel_a_p0
  s_andn2_b32 s33, s36, s34
  s_cbranch_scc0 .fz_kernel_pk28c
.fz_kernel_pk28:
  s_ff1_i32_b32 s33, s33
  s_bitset1_b32 s34, s33
  s_lshl_b32 s33, s33, 14
  s_add_u32 s30, s33, s35
  buffer_load_dwordx4 v[200:203], v3, s[4:7], s30 offen offset:0
  buffer_load_dwordx4 v[204:207], v3, s[4:7], s30 offen offset:1024
  buffer_load_dwordx4 v[208:211], v3, s[4:7], s30 offen offset:2048
  buffer_load_dwordx4 v[212:215], v3, s[4:7], s30 offen offset:3072
  buffer_load_dword v248, v3, s[4:7], s30 offen offset:3072
  buffer_load_dword v248, v3, s[4:7], s30 offen offset:3072
  s_andn2_b32 s33, s36, s34
  s_cbranch_scc0 .fz_kernel_pk29c
.fz_kernel_pk29:
  s_ff1_i32_b32 s33, s33
  s_bitset1_b32 s34, s33
  s_lshl_b32 s33, s33, 14
  s_add_u32 s30, s33, s35
  buffer_load_dwordx4 v[216:219], v3, s[4:7], s30 offen offset:0
  buffer_load_dwordx4 v[220:223], v3, s[4:7], s30 offen offset:1024
  buffer_load_dwordx4 v[224:227], v3, s[4:7], s30 offen offset:2048
  buffer_load_dwordx4 v[228:231], v3, s[4:7], s30 offen offset:3072
  buffer_load_dword v248, v3, s[4:7], s30 offen offset:3072
  buffer_load_dword v248, v3, s[4:7], s30 offen offset:3072
  s_andn2_b32 s33, s36, s34
  s_cbranch_scc0 .fz_kernel_pk30c
.fz_kernel_pk30:
  s_ff1_i32_b32 s33, s33
  s_bitset1_b32 s34, s33
  s_lshl_b32 s33, s33, 14
  s_add_u32 s30, s33, s35
  buffer_load_dwordx4 v[232:235], v3, s[4:7], s30 offen offset:0
  buffer_load_dwordx4 v[236:239], v3, s[4:7], s30 offen offset:1024
  buffer_load_dwordx4 v[240:243], v3, s[4:7], s30 offen offset:2048
  buffer_load_dwordx4 v[244:247], v3, s[4:7], s30 offen offset:3072
  buffer_load_dword v248, v3, s[4:7], s30 offen offset:3072
  buffer_load_dword v248, v3, s[4:7], s30 offen offset:3072
.fz_kernel_a_p0:
  s_waitcnt lgkmcnt(8)
  v_mfma_f32_32x32x16_bf16 v[144:159], v[184:187], v[32:35], 0
  v_mfma_f32_32x32x16_bf16 v[144:159], v[188:191], v[36:39], v[144:159]
  s_mov_b64 exec, 1
  s_waitcnt lgkmcnt(0)
  ds_add_u32 v6, v5 offset:0x100
  s_mov_b64 exec, -1
  v_mfma_f32_32x32x16_bf16 v[160:175], v[184:187], v[40:43], 0
  s_nop 6
  v_exp_f32 v144, v144
  v_exp_f32 v145, v145
  v_exp_f32 v146, v146
  v_exp_f32 v147, v147
  v_exp_f32 v148, v148
  v_exp_f32 v149, v149
  v_exp_f32 v150, v150
  v_exp_f32 v151, v151
  v_mfma_f32_32x32x16_bf16 v[160:175], v[188:191], v[44:47], v[160:175]
  v_cvt_pk_bf16_f32 v176, v144, v145
  v_cvt_pk_bf16_f32 v177, v146, v147
  v_cvt_pk_bf16_f32 v178, v148, v149
  v_cvt_pk_bf16_f32 v179, v150, v151
  v_exp_f32 v152, v152
  v_exp_f32 v153, v153
  v_exp_f32 v154, v154
  v_exp_f32 v155, v155
  v_mfma_f32_32x32x16_bf16 v[64:79], v[192:195], v[176:179], 0
  v_exp_f32 v156, v156
  v_exp_f32 v157, v157
  v_exp_f32 v158, v158
  v_exp_f32 v159, v159
  v_cvt_pk_bf16_f32 v180, v152, v153
  v_cvt_pk_bf16_f32 v181, v154, v155
  v_cvt_pk_bf16_f32 v182, v156, v157
  v_cvt_pk_bf16_f32 v183, v158, v159
  v_mfma_f32_32x32x16_bf16 v[144:159], v[184:187], v[48:51], 0
  v_exp_f32 v160, v160
  v_exp_f32 v161, v161
  v_exp_f32 v162, v162
  v_exp_f32 v163, v163
  v_mfma_f32_32x32x16_bf16 v[64:79], v[196:199], v[180:183], v[64:79]
  v_exp_f32 v164, v164
  v_exp_f32 v165, v165
  v_exp_f32 v166, v166
  v_smfmac_f32_16x16x64_bf16 v[128:131], v[28:31], v[176:183], v27
  v_exp_f32 v167, v167
  v_mfma_f32_32x32x16_bf16 v[144:159], v[188:191], v[52:55], v[144:159]
  v_cvt_pk_bf16_f32 v176, v160, v161
  v_cvt_pk_bf16_f32 v177, v162, v163
  v_cvt_pk_bf16_f32 v178, v164, v165
  v_cvt_pk_bf16_f32 v179, v166, v167
  v_exp_f32 v168, v168
  v_exp_f32 v169, v169
  v_exp_f32 v170, v170
  v_exp_f32 v171, v171
  v_mfma_f32_32x32x16_bf16 v[80:95], v[192:195], v[176:179], 0
  v_exp_f32 v172, v172
  v_exp_f32 v173, v173
  v_exp_f32 v174, v174
  v_exp_f32 v175, v175
  v_cvt_pk_bf16_f32 v180, v168, v169
  v_cvt_pk_bf16_f32 v181, v170, v171
  v_cvt_pk_bf16_f32 v182, v172, v173
  v_cvt_pk_bf16_f32 v183, v174, v175
  v_mfma_f32_32x32x16_bf16 v[160:175], v[184:187], v[56:59], 0
  v_exp_f32 v144, v144
  v_exp_f32 v145, v145
  v_exp_f32 v146, v146
  v_exp_f32 v147, v147
  v_mfma_f32_32x32x16_bf16 v[80:95], v[196:199], v[180:183], v[80:95]
  v_exp_f32 v148, v148
  v_exp_f32 v149, v149
  v_exp_f32 v150, v150
  v_smfmac_f32_16x16x64_bf16 v[132:135], v[28:31], v[176:183], v27
  v_exp_f32 v151, v151
  v_mfma_f32_32x32x16_bf16 v[160:175], v[188:191], v[60:63], v[160:175]
  v_cvt_pk_bf16_f32 v176, v144, v145
  v_cvt_pk_bf16_f32 v177, v146, v147
  v_cvt_pk_bf16_f32 v178, v148, v149
  v_cvt_pk_bf16_f32 v179, v150, v151
  v_exp_f32 v152, v152
  v_exp_f32 v153, v153
  v_exp_f32 v154, v154
  v_exp_f32 v155, v155
  v_mfma_f32_32x32x16_bf16 v[96:111], v[192:195], v[176:179], 0
  v_exp_f32 v156, v156
  v_exp_f32 v157, v157
  v_exp_f32 v158, v158
  v_exp_f32 v159, v159
  v_cvt_pk_bf16_f32 v180, v152, v153
  v_cvt_pk_bf16_f32 v181, v154, v155
  v_cvt_pk_bf16_f32 v182, v156, v157
  v_cvt_pk_bf16_f32 v183, v158, v159
  v_exp_f32 v160, v160
  v_exp_f32 v161, v161
  v_exp_f32 v162, v162
  v_exp_f32 v163, v163
  v_mfma_f32_32x32x16_bf16 v[96:111], v[196:199], v[180:183], v[96:111]
  v_exp_f32 v164, v164
  v_exp_f32 v165, v165
  v_exp_f32 v166, v166
  v_smfmac_f32_16x16x64_bf16 v[136:139], v[28:31], v[176:183], v27
  v_exp_f32 v167, v167
  v_cvt_pk_bf16_f32 v176, v160, v161
  v_cvt_pk_bf16_f32 v177, v162, v163
  v_cvt_pk_bf16_f32 v178, v164, v165
  v_cvt_pk_bf16_f32 v179, v166, v167
  v_exp_f32 v168, v168
  v_exp_f32 v169, v169
  v_exp_f32 v170, v170
  v_exp_f32 v171, v171
  v_mfma_f32_32x32x16_bf16 v[112:127], v[192:195], v[176:179], 0
  v_exp_f32 v172, v172
  v_exp_f32 v173, v173
  v_exp_f32 v174, v174
  v_exp_f32 v175, v175
  v_cvt_pk_bf16_f32 v180, v168, v169
  v_cvt_pk_bf16_f32 v181, v170, v171
  v_cvt_pk_bf16_f32 v182, v172, v173
  v_cvt_pk_bf16_f32 v183, v174, v175
  s_cmp_ge_u32 s39, 3
  s_cbranch_scc1 .fz_kernel_a_p1
  s_andn2_b32 s33, s36, s34
  s_cbranch_scc0 .fz_kernel_pk31c
.fz_kernel_pk31:
  s_ff1_i32_b32 s33, s33
  s_bitset1_b32 s34, s33
  s_lshl_b32 s33, s33, 14
  s_add_u32 s30, s33, s35
  buffer_load_dwordx4 v[200:203], v3, s[4:7], s30 offen offset:0
  buffer_load_dwordx4 v[204:207], v3, s[4:7], s30 offen offset:1024
  buffer_load_dwordx4 v[208:211], v3, s[4:7], s30 offen offset:2048
  buffer_load_dwordx4 v[212:215], v3, s[4:7], s30 offen offset:3072
  buffer_load_dword v248, v3, s[4:7], s30 offen offset:3072
  buffer_load_dword v248, v3, s[4:7], s30 offen offset:3072
  s_andn2_b32 s33, s36, s34
  s_cbranch_scc0 .fz_kernel_pk32c
.fz_kernel_pk32:
  s_ff1_i32_b32 s33, s33
  s_bitset1_b32 s34, s33
  s_lshl_b32 s33, s33, 14
  s_add_u32 s30, s33, s35
  buffer_load_dwordx4 v[216:219], v3, s[4:7], s30 offen offset:0
  buffer_load_dwordx4 v[220:223], v3, s[4:7], s30 offen offset:1024
  buffer_load_dwordx4 v[224:227], v3, s[4:7], s30 offen offset:2048
  buffer_load_dwordx4 v[228:231], v3, s[4:7], s30 offen offset:3072
  buffer_load_dword v248, v3, s[4:7], s30 offen offset:3072
  buffer_load_dword v248, v3, s[4:7], s30 offen offset:3072
  s_andn2_b32 s33, s36, s34
  s_cbranch_scc0 .fz_kernel_pk33c
.fz_kernel_pk33:
  s_ff1_i32_b32 s33, s33
  s_bitset1_b32 s34, s33
  s_lshl_b32 s33, s33, 14
  s_add_u32 s30, s33, s35
  buffer_load_dwordx4 v[232:235], v3, s[4:7], s30 offen offset:0
  buffer_load_dwordx4 v[236:239], v3, s[4:7], s30 offen offset:1024
  buffer_load_dwordx4 v[240:243], v3, s[4:7], s30 offen offset:2048
  buffer_load_dwordx4 v[244:247], v3, s[4:7], s30 offen offset:3072
  buffer_load_dword v248, v3, s[4:7], s30 offen offset:3072
  buffer_load_dword v248, v3, s[4:7], s30 offen offset:3072
.fz_kernel_a_p1:
  s_waitcnt vmcnt(16)
  v_mfma_f32_32x32x16_bf16 v[144:159], v[200:203], v[32:35], 0
  v_mfma_f32_32x32x16_bf16 v[144:159], v[204:207], v[36:39], v[144:159]
  s_waitcnt vmcnt(14)
  s_mov_b32 s32, 4
  s_nop 8
  s_branch .fz_kernel_a_b1
  .p2align 3
.fz_kernel_a_loop:
  s_cmp_lg_u32 s32, 1
  s_cbranch_scc1 .fz_kernel_pr34
  s_setprio 1
.fz_kernel_pr34:
  v_mfma_f32_32x32x16_bf16 v[160:175], v[184:187], v[40:43], 0
  v_exp_f32 v144, v144
  v_exp_f32 v145, v145
  v_exp_f32 v146, v146
  v_exp_f32 v147, v147
  v_mfma_f32_32x32x16_bf16 v[112:127], v[244:247], v[180:183], v[112:127]
  v_exp_f32 v148, v148
  v_exp_f32 v149, v149
  v_exp_f32 v150, v150
  v_smfmac_f32_16x16x64_bf16 v[140:143], v[28:31], v[176:183], v27
  v_exp_f32 v151, v151
  v_mfma_f32_32x32x16_bf16 v[160:175], v[188:191], v[44:47], v[160:175]
  v_cvt_pk_bf16_f32 v176, v144, v145
  v_cvt_pk_bf16_f32 v177, v146, v147
  v_cvt_pk_bf16_f32 v178, v148, v149
  v_cvt_pk_bf16_f32 v179, v150, v151
  s_andn2_b32 s33, s36, s34
  s_cbranch_scc0 .fz_kernel_pk35c
.fz_kernel_pk35:
  s_ff1_i32_b32 s33, s33
  s_bitset1_b32 s34, s33
  s_lshl_b32 s33, s33, 14
  s_add_u32 s30, s33, s35
  buffer_load_dwordx4 v[232:235], v3, s[4:7], s30 offen offset:0
  buffer_load_dwordx4 v[236:239], v3, s[4:7], s30 offen offset:1024
  buffer_load_dwordx4 v[240:243], v3, s[4:7], s30 offen offset:2048
  buffer_load_dwordx4 v[244:247], v3, s[4:7], s30 offen offset:3072
  s_max_i32 m0, s28, s71
  s_add_u32 s28, s28, 8192
  s_lshl_b32 s29, m0, 4
  buffer_load_dwordx4 v13, s[24:27], s29 offen lds
  buffer_load_dword v248, v15, s[8:11], s12 offen
  s_add_u32 s12, s12, s13
  v_exp_f32 v152, v152
  v_exp_f32 v153, v153
  v_exp_f32 v154, v154
  v_exp_f32 v155, v155
  v_mfma_f32_32x32x16_bf16 v[64:79], v[192:195], v[176:179], v[64:79]
  v_exp_f32 v156, v156
  v_exp_f32 v157, v157
  v_exp_f32 v158, v158
  v_exp_f32 v159, v159
  v_cvt_pk_bf16_f32 v180, v152, v153
  v_cvt_pk_bf16_f32 v181, v154, v155
  v_cvt_pk_bf16_f32 v182, v156, v157
  v_cvt_pk_bf16_f32 v183, v158, v159
  v_mfma_f32_32x32x16_bf16 v[144:159], v[184:187], v[48:51], 0
  v_exp_f32 v160, v160
  v_exp_f32 v161, v161
  v_exp_f32 v162, v162
  v_exp_f32 v163, v163
  v_mfma_f32_32x32x16_bf16 v[64:79], v[196:199], v[180:183], v[64:79]
  v_exp_f32 v164, v164
  v_exp_f32 v165, v165
  v_exp_f32 v166, v166
  v_smfmac_f32_16x16x64_bf16 v[128:131], v[28:31], v[176:183], v27
  v_exp_f32 v167, v167
  v_mfma_f32_32x32x16_bf16 v[144:159], v[188:191], v[52:55], v[144:159]
  v_cvt_pk_bf16_f32 v176, v160, v161
  v_cvt_pk_bf16_f32 v177, v162, v163
  v_cvt_pk_bf16_f32 v178, v164, v165
  v_cvt_pk_bf16_f32 v179, v166, v167
  v_exp_f32 v168, v168
  v_exp_f32 v169, v169
  v_exp_f32 v170, v170
  v_exp_f32 v171, v171
  v_mfma_f32_32x32x16_bf16 v[80:95], v[192:195], v[176:179], v[80:95]
  v_exp_f32 v172, v172
  v_exp_f32 v173, v173
  v_exp_f32 v174, v174
  v_exp_f32 v175, v175
  v_cvt_pk_bf16_f32 v180, v168, v169
  v_cvt_pk_bf16_f32 v181, v170, v171
  v_cvt_pk_bf16_f32 v182, v172, v173
  v_cvt_pk_bf16_f32 v183, v174, v175
  v_mfma_f32_32x32x16_bf16 v[160:175], v[184:187], v[56:59], 0
  v_exp_f32 v144, v144
  v_exp_f32 v145, v145
  v_exp_f32 v146, v146
  v_exp_f32 v147, v147
  v_mfma_f32_32x32x16_bf16 v[80:95], v[196:199], v[180:183], v[80:95]
  v_exp_f32 v148, v148
  v_exp_f32 v149, v149
  v_exp_f32 v150, v150
  v_smfmac_f32_16x16x64_bf16 v[132:135], v[28:31], v[176:183], v27
  v_exp_f32 v151, v151
  v_mfma_f32_32x32x16_bf16 v[160:175], v[188:191], v[60:63], v[160:175]
  v_cvt_pk_bf16_f32 v176, v144, v145
  v_cvt_pk_bf16_f32 v177, v146, v147
  v_cvt_pk_bf16_f32 v178, v148, v149
  v_cvt_pk_bf16_f32 v179, v150, v151
  v_exp_f32 v152, v152
  v_exp_f32 v153, v153
  v_exp_f32 v154, v154
  v_exp_f32 v155, v155
  v_mfma_f32_32x32x16_bf16 v[96:111], v[192:195], v[176:179], v[96:111]
  v_exp_f32 v156, v156
  v_exp_f32 v157, v157
  v_exp_f32 v158, v158
  v_exp_f32 v159, v159
  v_cvt_pk_bf16_f32 v180, v152, v153
  v_cvt_pk_bf16_f32 v181, v154, v155
  v_cvt_pk_bf16_f32 v182, v156, v157
  v_cvt_pk_bf16_f32 v183, v158, v159
  s_waitcnt vmcnt(14)
  v_mfma_f32_32x32x16_bf16 v[144:159], v[200:203], v[32:35], 0
  v_exp_f32 v160, v160
  v_exp_f32 v161, v161
  v_exp_f32 v162, v162
  v_exp_f32 v163, v163
  v_mfma_f32_32x32x16_bf16 v[96:111], v[196:199], v[180:183], v[96:111]
  v_exp_f32 v164, v164
  v_exp_f32 v165, v165
  v_exp_f32 v166, v166
  v_smfmac_f32_16x16x64_bf16 v[136:139], v[28:31], v[176:183], v27
  v_exp_f32 v167, v167
  v_mfma_f32_32x32x16_bf16 v[144:159], v[204:207], v[36:39], v[144:159]
  v_cvt_pk_bf16_f32 v176, v160, v161
  v_cvt_pk_bf16_f32 v177, v162, v163
  v_cvt_pk_bf16_f32 v178, v164, v165
  v_cvt_pk_bf16_f32 v179, v166, v167
  v_exp_f32 v168, v168
  v_exp_f32 v169, v169
  v_exp_f32 v170, v170
  v_exp_f32 v171, v171
  v_mfma_f32_32x32x16_bf16 v[112:127], v[192:195], v[176:179], v[112:127]
  v_exp_f32 v172, v172
  v_exp_f32 v173, v173
  v_exp_f32 v174, v174
  v_exp_f32 v175, v175
  v_cvt_pk_bf16_f32 v180, v168, v169
  v_cvt_pk_bf16_f32 v181, v170, v171
  v_cvt_pk_bf16_f32 v182, v172, v173
  v_cvt_pk_bf16_f32 v183, v174, v175
.fz_kernel_a_b1:
  v_mfma_f32_32x32x16_bf16 v[160:175], v[200:203], v[40:43], 0
  v_exp_f32 v144, v144
  v_exp_f32 v145, v145
  v_exp_f32 v146, v146
  v_exp_f32 v147, v147
  v_mfma_f32_32x32x16_bf16 v[112:127], v[196:199], v[180:183], v[112:127]
  v_exp_f32 v148, v148
  v_exp_f32 v149, v149
  v_exp_f32 v150, v150
  v_smfmac_f32_16x16x64_bf16 v[140:143], v[28:31], v[176:183], v27
  v_exp_f32 v151, v151
  v_mfma_f32_32x32x16_bf16 v[160:175], v[204:207], v[44:47], v[160:175]
  v_cvt_pk_bf16_f32 v176, v144, v145
  v_cvt_pk_bf16_f32 v177, v146, v147
  v_cvt_pk_bf16_f32 v178, v148, v149
  v_cvt_pk_bf16_f32 v179, v150, v151
  s_andn2_b32 s33, s36, s34
  s_cbranch_scc0 .fz_kernel_pk36c
.fz_kernel_pk36:
  s_ff1_i32_b32 s33, s33
  s_bitset1_b32 s34, s33
  s_lshl_b32 s33, s33, 14
  s_add_u32 s30, s33, s35
  buffer_load_dwordx4 v[184:187], v3, s[4:7], s30 offen offset:0
  buffer_load_dwordx4 v[188:191], v3, s[4:7], s30 offen offset:1024
  buffer_load_dwordx4 v[192:195], v3, s[4:7], s30 offen offset:2048
  buffer_load_dwordx4 v[196:199], v3, s[4:7], s30 offen offset:3072
  s_max_i32 m0, s28, s71
  s_add_u32 s28, s28, 8192
  s_lshl_b32 s29, m0, 4
  buffer_load_dwordx4 v13, s[24:27], s29 offen lds
  buffer_load_dword v248, v15, s[8:11], s12 offen
  s_add_u32 s12, s12, s13
  v_exp_f32 v152, v152
  v_exp_f32 v153, v153
  v_exp_f32 v154, v154
  v_exp_f32 v155, v155
  v_mfma_f32_32x32x16_bf16 v[64:79], v[208:211], v[176:179], v[64:79]
  v_exp_f32 v156, v156
  v_exp_f32 v157, v157
  v_exp_f32 v158, v158
  v_exp_f32 v159, v159
  v_cvt_pk_bf16_f32 v180, v152, v153
  v_cvt_pk_bf16_f32 v181, v154, v155
  v_cvt_pk_bf16_f32 v182, v156, v157
  v_cvt_pk_bf16_f32 v183, v158, v159
  v_mfma_f32_32x32x16_bf16 v[144:159], v[200:203], v[48:51], 0
  v_exp_f32 v160, v160
  v_exp_f32 v161, v161
  v_exp_f32 v162, v162
  v_exp_f32 v163, v163
  v_mfma_f32_32x32x16_bf16 v[64:79], v[212:215], v[180:183], v[64:79]
  v_exp_f32 v164, v164
  v_exp_f32 v165, v165
  v_exp_f32 v166, v166
  v_smfmac_f32_16x16x64_bf16 v[128:131], v[28:31], v[176:183], v27
  v_exp_f32 v167, v167
  v_mfma_f32_32x32x16_bf16 v[144:159], v[204:207], v[52:55], v[144:159]
  v_cvt_pk_bf16_f32 v176, v160, v161
  v_cvt_pk_bf16_f32 v177, v162, v163
  v_cvt_pk_bf16_f32 v178, v164, v165
  v_cvt_pk_bf16_f32 v179, v166, v167
  v_exp_f32 v168, v168
  v_exp_f32 v169, v169
  v_exp_f32 v170, v170
  v_exp_f32 v171, v171
  v_mfma_f32_32x32x16_bf16 v[80:95], v[208:211], v[176:179], v[80:95]
  v_exp_f32 v172, v172
  v_exp_f32 v173, v173
  v_exp_f32 v174, v174
  v_exp_f32 v175, v175
  v_cvt_pk_bf16_f32 v180, v168, v169
  v_cvt_pk_bf16_f32 v181, v170, v171
  v_cvt_pk_bf16_f32 v182, v172, v173
  v_cvt_pk_bf16_f32 v183, v174, v175
  v_mfma_f32_32x32x16_bf16 v[160:175], v[200:203], v[56:59], 0
  v_exp_f32 v144, v144
  v_exp_f32 v145, v145
  v_exp_f32 v146, v146
  v_exp_f32 v147, v147
  v_mfma_f32_32x32x16_bf16 v[80:95], v[212:215], v[180:183], v[80:95]
  v_exp_f32 v148, v148
  v_exp_f32 v149, v149
  v_exp_f32 v150, v150
  v_smfmac_f32_16x16x64_bf16 v[132:135], v[28:31], v[176:183], v27
  v_exp_f32 v151, v151
  v_mfma_f32_32x32x16_bf16 v[160:175], v[204:207], v[60:63], v[160:175]
  v_cvt_pk_bf16_f32 v176, v144, v145
  v_cvt_pk_bf16_f32 v177, v146, v147
  v_cvt_pk_bf16_f32 v178, v148, v149
  v_cvt_pk_bf16_f32 v179, v150, v151
  v_exp_f32 v152, v152
  v_exp_f32 v153, v153
  v_exp_f32 v154, v154
  v_exp_f32 v155, v155
  v_mfma_f32_32x32x16_bf16 v[96:111], v[208:211], v[176:179], v[96:111]
  v_exp_f32 v156, v156
  v_exp_f32 v157, v157
  v_exp_f32 v158, v158
  v_exp_f32 v159, v159
  v_cvt_pk_bf16_f32 v180, v152, v153
  v_cvt_pk_bf16_f32 v181, v154, v155
  v_cvt_pk_bf16_f32 v182, v156, v157
  v_cvt_pk_bf16_f32 v183, v158, v159
  s_waitcnt vmcnt(14)
  v_mfma_f32_32x32x16_bf16 v[144:159], v[216:219], v[32:35], 0
  v_exp_f32 v160, v160
  v_exp_f32 v161, v161
  v_exp_f32 v162, v162
  v_exp_f32 v163, v163
  v_mfma_f32_32x32x16_bf16 v[96:111], v[212:215], v[180:183], v[96:111]
  v_exp_f32 v164, v164
  v_exp_f32 v165, v165
  v_exp_f32 v166, v166
  v_smfmac_f32_16x16x64_bf16 v[136:139], v[28:31], v[176:183], v27
  v_exp_f32 v167, v167
  v_mfma_f32_32x32x16_bf16 v[144:159], v[220:223], v[36:39], v[144:159]
  v_cvt_pk_bf16_f32 v176, v160, v161
  v_cvt_pk_bf16_f32 v177, v162, v163
  v_cvt_pk_bf16_f32 v178, v164, v165
  v_cvt_pk_bf16_f32 v179, v166, v167
  v_exp_f32 v168, v168
  v_exp_f32 v169, v169
  v_exp_f32 v170, v170
  v_exp_f32 v171, v171
  v_mfma_f32_32x32x16_bf16 v[112:127], v[208:211], v[176:179], v[112:127]
  v_exp_f32 v172, v172
  v_exp_f32 v173, v173
  v_exp_f32 v174, v174
  v_exp_f32 v175, v175
  v_cvt_pk_bf16_f32 v180, v168, v169
  v_cvt_pk_bf16_f32 v181, v170, v171
  v_cvt_pk_bf16_f32 v182, v172, v173
  v_cvt_pk_bf16_f32 v183, v174, v175
  v_mfma_f32_32x32x16_bf16 v[160:175], v[216:219], v[40:43], 0
  v_exp_f32 v144, v144
  v_exp_f32 v145, v145
  v_exp_f32 v146, v146
  v_exp_f32 v147, v147
  v_mfma_f32_32x32x16_bf16 v[112:127], v[212:215], v[180:183], v[112:127]
  v_exp_f32 v148, v148
  v_exp_f32 v149, v149
  v_exp_f32 v150, v150
  v_smfmac_f32_16x16x64_bf16 v[140:143], v[28:31], v[176:183], v27
  v_exp_f32 v151, v151
  v_mfma_f32_32x32x16_bf16 v[160:175], v[220:223], v[44:47], v[160:175]
  v_cvt_pk_bf16_f32 v176, v144, v145
  v_cvt_pk_bf16_f32 v177, v146, v147
  v_cvt_pk_bf16_f32 v178, v148, v149
  v_cvt_pk_bf16_f32 v179, v150, v151
  s_andn2_b32 s33, s36, s34
  s_cbranch_scc0 .fz_kernel_pk37c
.fz_kernel_pk37:
  s_ff1_i32_b32 s33, s33
  s_bitset1_b32 s34, s33
  s_lshl_b32 s33, s33, 14
  s_add_u32 s30, s33, s35
  buffer_load_dwordx4 v[200:203], v3, s[4:7], s30 offen offset:0
  buffer_load_dwordx4 v[204:207], v3, s[4:7], s30 offen offset:1024
  buffer_load_dwordx4 v[208:211], v3, s[4:7], s30 offen offset:2048
  buffer_load_dwordx4 v[212:215], v3, s[4:7], s30 offen offset:3072
  s_max_i32 m0, s28, s71
  s_add_u32 s28, s28, 8192
  s_lshl_b32 s29, m0, 4
  buffer_load_dwordx4 v13, s[24:27], s29 offen lds
  buffer_load_dword v248, v15, s[8:11], s12 offen
  s_add_u32 s12, s12, s13
  v_exp_f32 v152, v152
  v_exp_f32 v153, v153
  v_exp_f32 v154, v154
  v_exp_f32 v155, v155
  v_mfma_f32_32x32x16_bf16 v[64:79], v[224:227], v[176:179], v[64:79]
  v_exp_f32 v156, v156
  v_exp_f32 v157, v157
  v_exp_f32 v158, v158
  v_exp_f32 v159, v159
  v_cvt_pk_bf16_f32 v180, v152, v153
  v_cvt_pk_bf16_f32 v181, v154, v155
  v_cvt_pk_bf16_f32 v182, v156, v157
  v_cvt_pk_bf16_f32 v183, v158, v159
  v_mfma_f32_32x32x16_bf16 v[144:159], v[216:219], v[48:51], 0
  v_exp_f32 v160, v160
  v_exp_f32 v161, v161
  v_exp_f32 v162, v162
  v_exp_f32 v163, v163
  v_mfma_f32_32x32x16_bf16 v[64:79], v[228:231], v[180:183], v[64:79]
  v_exp_f32 v164, v164
  v_exp_f32 v165, v165
  v_exp_f32 v166, v166
  v_smfmac_f32_16x16x64_bf16 v[128:131], v[28:31], v[176:183], v27
  v_exp_f32 v167, v167
  v_mfma_f32_32x32x16_bf16 v[144:159], v[220:223], v[52:55], v[144:159]
  v_cvt_pk_bf16_f32 v176, v160, v161
  v_cvt_pk_bf16_f32 v177, v162, v163
  v_cvt_pk_bf16_f32 v178, v164, v165
  v_cvt_pk_bf16_f32 v179, v166, v167
  v_exp_f32 v168, v168
  v_exp_f32 v169, v169
  v_exp_f32 v170, v170
  v_exp_f32 v171, v171
  v_mfma_f32_32x32x16_bf16 v[80:95], v[224:227], v[176:179], v[80:95]
  v_exp_f32 v172, v172
  v_exp_f32 v173, v173
  v_exp_f32 v174, v174
  v_exp_f32 v175, v175
  v_cvt_pk_bf16_f32 v180, v168, v169
  v_cvt_pk_bf16_f32 v181, v170, v171
  v_cvt_pk_bf16_f32 v182, v172, v173
  v_cvt_pk_bf16_f32 v183, v174, v175
  v_mfma_f32_32x32x16_bf16 v[160:175], v[216:219], v[56:59], 0
  v_exp_f32 v144, v144
  v_exp_f32 v145, v145
  v_exp_f32 v146, v146
  v_exp_f32 v147, v147
  v_mfma_f32_32x32x16_bf16 v[80:95], v[228:231], v[180:183], v[80:95]
  v_exp_f32 v148, v148
  v_exp_f32 v149, v149
  v_exp_f32 v150, v150
  v_smfmac_f32_16x16x64_bf16 v[132:135], v[28:31], v[176:183], v27
  v_exp_f32 v151, v151
  v_mfma_f32_32x32x16_bf16 v[160:175], v[220:223], v[60:63], v[160:175]
  v_cvt_pk_bf16_f32 v176, v144, v145
  v_cvt_pk_bf16_f32 v177, v146, v147
  v_cvt_pk_bf16_f32 v178, v148, v149
  v_cvt_pk_bf16_f32 v179, v150, v151
  v_exp_f32 v152, v152
  v_exp_f32 v153, v153
  v_exp_f32 v154, v154
  v_exp_f32 v155, v155
  v_mfma_f32_32x32x16_bf16 v[96:111], v[224:227], v[176:179], v[96:111]
  v_exp_f32 v156, v156
  v_exp_f32 v157, v157
  v_exp_f32 v158, v158
  v_exp_f32 v159, v159
  v_cvt_pk_bf16_f32 v180, v152, v153
  v_cvt_pk_bf16_f32 v181, v154, v155
  v_cvt_pk_bf16_f32 v182, v156, v157
  v_cvt_pk_bf16_f32 v183, v158, v159
  s_waitcnt vmcnt(14)
  v_mfma_f32_32x32x16_bf16 v[144:159], v[232:235], v[32:35], 0
  v_exp_f32 v160, v160
  v_exp_f32 v161, v161
  v_exp_f32 v162, v162
  v_exp_f32 v163, v163
  v_mfma_f32_32x32x16_bf16 v[96:111], v[228:231], v[180:183], v[96:111]
  v_exp_f32 v164, v164
  v_exp_f32 v165, v165
  v_exp_f32 v166, v166
  v_smfmac_f32_16x16x64_bf16 v[136:139], v[28:31], v[176:183], v27
  v_exp_f32 v167, v167
  v_mfma_f32_32x32x16_bf16 v[144:159], v[236:239], v[36:39], v[144:159]
  v_cvt_pk_bf16_f32 v176, v160, v161
  v_cvt_pk_bf16_f32 v177, v162, v163
  v_cvt_pk_bf16_f32 v178, v164, v165
  v_cvt_pk_bf16_f32 v179, v166, v167
  v_exp_f32 v168, v168
  v_exp_f32 v169, v169
  v_exp_f32 v170, v170
  v_exp_f32 v171, v171
  v_mfma_f32_32x32x16_bf16 v[112:127], v[224:227], v[176:179], v[112:127]
  v_exp_f32 v172, v172
  v_exp_f32 v173, v173
  v_exp_f32 v174, v174
  v_exp_f32 v175, v175
  v_cvt_pk_bf16_f32 v180, v168, v169
  v_cvt_pk_bf16_f32 v181, v170, v171
  v_cvt_pk_bf16_f32 v182, v172, v173
  v_cvt_pk_bf16_f32 v183, v174, v175
  s_cmp_lg_u32 s32, 3
  s_cbranch_scc1 .fz_kernel_pr38
  s_setprio 2
.fz_kernel_pr38:
  s_cmp_lg_u32 s32, 1
  s_cbranch_scc1 .fz_kernel_pr39
  s_setprio 0
.fz_kernel_pr39:
  v_mfma_f32_32x32x16_bf16 v[160:175], v[232:235], v[40:43], 0
  v_exp_f32 v144, v144
  v_exp_f32 v145, v145
  v_exp_f32 v146, v146
  v_exp_f32 v147, v147
  v_mfma_f32_32x32x16_bf16 v[112:127], v[228:231], v[180:183], v[112:127]
  v_exp_f32 v148, v148
  v_exp_f32 v149, v149
  v_exp_f32 v150, v150
  v_smfmac_f32_16x16x64_bf16 v[140:143], v[28:31], v[176:183], v27
  v_exp_f32 v151, v151
  v_mfma_f32_32x32x16_bf16 v[160:175], v[236:239], v[44:47], v[160:175]
  v_cvt_pk_bf16_f32 v176, v144, v145
  v_cvt_pk_bf16_f32 v177, v146, v147
  v_cvt_pk_bf16_f32 v178, v148, v149
  v_cvt_pk_bf16_f32 v179, v150, v151
  s_andn2_b32 s33, s36, s34
  s_cbranch_scc0 .fz_kernel_pk40c
.fz_kernel_pk40:
  s_ff1_i32_b32 s33, s33
  s_bitset1_b32 s34, s33
  s_lshl_b32 s33, s33, 14
  s_add_u32 s30, s33, s35
  buffer_load_dwordx4 v[216:219], v3, s[4:7], s30 offen offset:0
  buffer_load_dwordx4 v[220:223], v3, s[4:7], s30 offen offset:1024
  buffer_load_dwordx4 v[224:227], v3, s[4:7], s30 offen offset:2048
  buffer_load_dwordx4 v[228:231], v3, s[4:7], s30 offen offset:3072
  s_max_i32 m0, s28, s71
  s_add_u32 s28, s28, 8192
  s_lshl_b32 s29, m0, 4
  buffer_load_dwordx4 v13, s[24:27], s29 offen lds
  buffer_load_dword v248, v15, s[8:11], s12 offen
  s_add_u32 s12, s12, s13
  v_exp_f32 v152, v152
  v_exp_f32 v153, v153
  v_exp_f32 v154, v154
  v_exp_f32 v155, v155
  v_mfma_f32_32x32x16_bf16 v[64:79], v[240:243], v[176:179], v[64:79]
  v_exp_f32 v156, v156
  v_exp_f32 v157, v157
  v_exp_f32 v158, v158
  v_exp_f32 v159, v159
  v_cvt_pk_bf16_f32 v180, v152, v153
  v_cvt_pk_bf16_f32 v181, v154, v155
  v_cvt_pk_bf16_f32 v182, v156, v157
  v_cvt_pk_bf16_f32 v183, v158, v159
  v_mfma_f32_32x32x16_bf16 v[144:159], v[232:235], v[48:51], 0
  v_exp_f32 v160, v160
  v_exp_f32 v161, v161
  v_exp_f32 v162, v162
  v_exp_f32 v163, v163
  v_mfma_f32_32x32x16_bf16 v[64:79], v[244:247], v[180:183], v[64:79]
  v_exp_f32 v164, v164
  v_exp_f32 v165, v165
  v_exp_f32 v166, v166
  v_smfmac_f32_16x16x64_bf16 v[128:131], v[28:31], v[176:183], v27
  v_exp_f32 v167, v167
  v_mfma_f32_32x32x16_bf16 v[144:159], v[236:239], v[52:55], v[144:159]
  v_cvt_pk_bf16_f32 v176, v160, v161
  v_cvt_pk_bf16_f32 v177, v162, v163
  v_cvt_pk_bf16_f32 v178, v164, v165
  v_cvt_pk_bf16_f32 v179, v166, v167
  v_exp_f32 v168, v168
  v_exp_f32 v169, v169
  v_exp_f32 v170, v170
  v_exp_f32 v171, v171
  v_mfma_f32_32x32x16_bf16 v[80:95], v[240:243], v[176:179], v[80:95]
  v_exp_f32 v172, v172
  v_exp_f32 v173, v173
  v_exp_f32 v174, v174
  v_exp_f32 v175, v175
  v_cvt_pk_bf16_f32 v180, v168, v169
  v_cvt_pk_bf16_f32 v181, v170, v171
  v_cvt_pk_bf16_f32 v182, v172, v173
  v_cvt_pk_bf16_f32 v183, v174, v175
  v_mfma_f32_32x32x16_bf16 v[160:175], v[232:235], v[56:59], 0
  v_exp_f32 v144, v144
  v_exp_f32 v145, v145
  v_exp_f32 v146, v146
  v_exp_f32 v147, v147
  v_mfma_f32_32x32x16_bf16 v[80:95], v[244:247], v[180:183], v[80:95]
  v_exp_f32 v148, v148
  v_exp_f32 v149, v149
  v_exp_f32 v150, v150
  v_smfmac_f32_16x16x64_bf16 v[132:135], v[28:31], v[176:183], v27
  v_exp_f32 v151, v151
  v_mfma_f32_32x32x16_bf16 v[160:175], v[236:239], v[60:63], v[160:175]
  v_cvt_pk_bf16_f32 v176, v144, v145
  v_cvt_pk_bf16_f32 v177, v146, v147
  v_cvt_pk_bf16_f32 v178, v148, v149
  v_cvt_pk_bf16_f32 v179, v150, v151
  v_exp_f32 v152, v152
  v_exp_f32 v153, v153
  v_exp_f32 v154, v154
  v_exp_f32 v155, v155
  v_mfma_f32_32x32x16_bf16 v[96:111], v[240:243], v[176:179], v[96:111]
  v_exp_f32 v156, v156
  v_exp_f32 v157, v157
  v_exp_f32 v158, v158
  v_exp_f32 v159, v159
  v_cvt_pk_bf16_f32 v180, v152, v153
  v_cvt_pk_bf16_f32 v181, v154, v155
  v_cvt_pk_bf16_f32 v182, v156, v157
  v_cvt_pk_bf16_f32 v183, v158, v159
  s_waitcnt vmcnt(14)
  v_mfma_f32_32x32x16_bf16 v[144:159], v[184:187], v[32:35], 0
  v_exp_f32 v160, v160
  v_exp_f32 v161, v161
  v_exp_f32 v162, v162
  v_exp_f32 v163, v163
  v_mfma_f32_32x32x16_bf16 v[96:111], v[244:247], v[180:183], v[96:111]
  v_exp_f32 v164, v164
  v_exp_f32 v165, v165
  v_exp_f32 v166, v166
  v_smfmac_f32_16x16x64_bf16 v[136:139], v[28:31], v[176:183], v27
  v_exp_f32 v167, v167
  v_mfma_f32_32x32x16_bf16 v[144:159], v[188:191], v[36:39], v[144:159]
  v_cvt_pk_bf16_f32 v176, v160, v161
  v_cvt_pk_bf16_f32 v177, v162, v163
  v_cvt_pk_bf16_f32 v178, v164, v165
  v_cvt_pk_bf16_f32 v179, v166, v167
  v_exp_f32 v168, v168
  v_exp_f32 v169, v169
  v_exp_f32 v170, v170
  v_exp_f32 v171, v171
  v_mfma_f32_32x32x16_bf16 v[112:127], v[240:243], v[176:179], v[112:127]
  v_exp_f32 v172, v172
  v_exp_f32 v173, v173
  v_exp_f32 v174, v174
  v_exp_f32 v175, v175
  v_cvt_pk_bf16_f32 v180, v168, v169
  v_cvt_pk_bf16_f32 v181, v170, v171
  v_cvt_pk_bf16_f32 v182, v172, v173
  v_cvt_pk_bf16_f32 v183, v174, v175
  s_sub_u32 s32, s32, 1
  s_cmp_lg_u32 s32, 0
  s_cbranch_scc1 .fz_kernel_a_t3
  ds_read_b32 v7, v6 offset:0x100
  v_mfma_f32_32x32x16_bf16 v[112:127], v[244:247], v[180:183], v[112:127]
  v_smfmac_f32_16x16x64_bf16 v[140:143], v[28:31], v[176:183], v27
  s_and_b32 s39, s16, 1
  s_lshr_b32 s32, s16, 1
  v_and_b32 v8, 16, v2
  v_cmp_ne_u32 s[34:35], 0, v8
  v_and_b32 v11, 31, v2
  v_lshlrev_b32 v11, 2, v11
  v_cvt_pk_bf16_f32 v80, v80, v81
  v_cvt_pk_bf16_f32 v81, v82, v83
  v_cvt_pk_bf16_f32 v82, v84, v85
  v_cvt_pk_bf16_f32 v83, v86, v87
  v_cvt_pk_bf16_f32 v84, v88, v89
  v_cvt_pk_bf16_f32 v85, v90, v91
  v_cvt_pk_bf16_f32 v86, v92, v93
  v_cvt_pk_bf16_f32 v87, v94, v95
  s_waitcnt lgkmcnt(0)
  v_cmp_gt_u32 vcc, 8, v7
  s_cbranch_vccnz .fz_kernel_a_cw
.fz_kernel_a_cb:
  s_add_u32 s31, s32, 1
  s_and_b32 s31, s31, 3
  s_lshl1_add_u32 s31, s31, s39
  s_mul_i32 s31, s31, 3
  s_add_u32 s31, s31, 0
  s_lshl_b32 s33, s31, 11
  s_add_u32 s33, s33, 106496
  v_add_u32 v12, s33, v3
  s_lshl_b32 s33, s31, 7
  s_add_u32 s33, s33, 155648
  v_add_u32 v17, s33, v11
  ds_write_b128 v12, v[80:83] offset:0
  ds_write_b128 v12, v[84:87] offset:1024
  v_add_f32 v132, v132, v134
  v_add_f32 v133, v133, v135
  v_cndmask_b32 v8, v132, v133, s[34:35]
  ds_write_b32 v17, v8
  s_add_u32 s31, s32, 2
  s_and_b32 s31, s31, 3
  s_lshl1_add_u32 s31, s31, s39
  s_mul_i32 s31, s31, 3
  s_add_u32 s31, s31, 1
  s_lshl_b32 s33, s31, 11
  s_add_u32 s33, s33, 106496
  v_add_u32 v12, s33, v3
  s_lshl_b32 s33, s31, 7
  s_add_u32 s33, s33, 155648
  v_add_u32 v17, s33, v11
  v_cvt_pk_bf16_f32 v96, v96, v97
  v_cvt_pk_bf16_f32 v97, v98, v99
  v_cvt_pk_bf16_f32 v98, v100, v101
  v_cvt_pk_bf16_f32 v99, v102, v103
  v_cvt_pk_bf16_f32 v100, v104, v105
  v_cvt_pk_bf16_f32 v101, v106, v107
  v_cvt_pk_bf16_f32 v102, v108, v109
  v_cvt_pk_bf16_f32 v103, v110, v111
  ds_write_b128 v12, v[96:99] offset:0
  ds_write_b128 v12, v[100:103] offset:1024
  v_add_f32 v136, v136, v138
  v_add_f32 v137, v137, v139
  v_cndmask_b32 v8, v136, v137, s[34:35]
  ds_write_b32 v17, v8
  s_add_u32 s31, s32, 3
  s_and_b32 s31, s31, 3
  s_lshl1_add_u32 s31, s31, s39
  s_mul_i32 s31, s31, 3
  s_add_u32 s31, s31, 2
  s_lshl_b32 s33, s31, 11
  s_add_u32 s33, s33, 106496
  v_add_u32 v12, s33, v3
  s_lshl_b32 s33, s31, 7
  s_add_u32 s33, s33, 155648
  v_add_u32 v17, s33, v11
  v_cvt_pk_bf16_f32 v112, v112, v113
  v_cvt_pk_bf16_f32 v113, v114, v115
  v_cvt_pk_bf16_f32 v114, v116, v117
  v_cvt_pk_bf16_f32 v115, v118, v119
  v_cvt_pk_bf16_f32 v116, v120, v121
  v_cvt_pk_bf16_f32 v117, v122, v123
  v_cvt_pk_bf16_f32 v118, v124, v125
  v_cvt_pk_bf16_f32 v119, v126, v127
  ds_write_b128 v12, v[112:115] offset:0
  ds_write_b128 v12, v[116:119] offset:1024
  v_add_f32 v140, v140, v142
  v_add_f32 v141, v141, v143
  v_cndmask_b32 v8, v140, v141, s[34:35]
  ds_write_b32 v17, v8
  v_add_f32 v128, v128, v130
  v_add_f32 v129, v129, v131
  s_mul_i32 s31, s16, 3
  s_lshl_b32 s33, s31, 11
  s_add_u32 s33, s33, 106496
  v_add_u32 v12, s33, v3
  s_lshl_b32 s33, s31, 7
  s_add_u32 s33, s33, 155648
  v_add_u32 v17, s33, v11
  v_cndmask_b32 v9, v128, v129, s[34:35]
  v_and_b32 v8, 1, v2
  v_lshlrev_b32 v8, 4, v8
  v_mov_b32 v18, 0x3f80
  v_lshlrev_b32 v8, v8, v18
  v_mov_b32 v232, 0
  v_mov_b32 v233, 0
  v_mov_b32 v234, 0
  v_mov_b32 v235, 0
  v_mov_b32 v236, 0
  v_mov_b32 v237, 0
  v_mov_b32 v238, 0
  v_mov_b32 v239, 0
  s_mov_b32 exec_lo, 0x3
  s_mov_b32 exec_hi, 0x30
  v_mov_b32 v232, v8
  s_mov_b32 exec_lo, 0xc
  s_mov_b32 exec_hi, 0xc0
  v_mov_b32 v233, v8
  s_mov_b32 exec_lo, 0x300
  s_mov_b32 exec_hi, 0x3000
  v_mov_b32 v234, v8
  s_mov_b32 exec_lo, 0xc00
  s_mov_b32 exec_hi, 0xc000
  v_mov_b32 v235, v8
  s_mov_b32 exec_lo, 0x30000
  s_mov_b32 exec_hi, 0x300000
  v_mov_b32 v236, v8
  s_mov_b32 exec_lo, 0xc0000
  s_mov_b32 exec_hi, 0xc00000
  v_mov_b32 v237, v8
  s_mov_b32 exec_lo, 0x3000000
  s_mov_b32 exec_hi, 0x30000000
  v_mov_b32 v238, v8
  s_mov_b32 exec_lo, 0xc000000
  s_mov_b32 exec_hi, 0xc0000000
  v_mov_b32 v239, v8
  s_mov_b64 exec, -1
  s_waitcnt lgkmcnt(0)
  s_barrier
  ds_read_b128 v[144:147], v12 offset:0
  ds_read_b128 v[148:151], v12 offset:1024
  ds_read_b128 v[152:155], v12 offset:2048
  ds_read_b128 v[156:159], v12 offset:3072
  ds_read_b128 v[160:163], v12 offset:4096
  ds_read_b128 v[164:167], v12 offset:5120
  ds_read_b32 v14, v17 offset:0
  ds_read_b32 v15, v17 offset:128
  ds_read_b32 v16, v17 offset:256
  s_waitcnt lgkmcnt(8)
  v_mfma_f32_32x32x16_bf16 v[64:79], v[232:235], v[144:147], v[64:79]
  s_waitcnt lgkmcnt(7)
  v_mfma_f32_32x32x16_bf16 v[64:79], v[236:239], v[148:151], v[64:79]
  s_waitcnt lgkmcnt(6)
  v_mfma_f32_32x32x16_bf16 v[64:79], v[232:235], v[152:155], v[64:79]
  s_waitcnt lgkmcnt(5)
  v_mfma_f32_32x32x16_bf16 v[64:79], v[236:239], v[156:159], v[64:79]
  s_waitcnt lgkmcnt(4)
  v_mfma_f32_32x32x16_bf16 v[64:79], v[232:235], v[160:163], v[64:79]
  s_waitcnt lgkmcnt(3)
  v_mfma_f32_32x32x16_bf16 v[64:79], v[236:239], v[164:167], v[64:79]
  v_mov_b32 v17, 8.673617379884035e-19
  v_mov_b32 v18, 1.152921504606847e+18
  v_mov_b32 v19, 1.329227995784916e+36
  s_waitcnt lgkmcnt(0)
  v_add_f32 v9, v9, v14
  v_add_f32 v15, v15, v16
  v_add_f32 v9, v9, v15
  s_nop 4
  v_max3_f32 v16, abs(v64), abs(v65), abs(v66)
  v_max3_f32 v11, abs(v67), abs(v68), abs(v69)
  v_max3_f32 v12, abs(v70), abs(v71), abs(v72)
  v_max3_f32 v13, abs(v73), abs(v74), abs(v75)
  v_max3_f32 v14, abs(v76), abs(v77), abs(v78)
  v_max3_f32 v16, v16, v11, abs(v79)
  v_max3_f32 v12, v12, v13, v14
  v_pk_add_f32 v[144:145], v[64:65], v[66:67]
  v_pk_add_f32 v[146:147], v[68:69], v[70:71]
  v_pk_add_f32 v[148:149], v[72:73], v[74:75]
  v_pk_add_f32 v[150:151], v[76:77], v[78:79]
  v_pk_add_f32 v[144:145], v[144:145], v[146:147]
  v_pk_add_f32 v[148:149], v[148:149], v[150:151]
  v_max_f32 v16, v16, v12
  v_pk_add_f32 v[144:145], v[144:145], v[148:149]
  v_cmp_ge_f32 vcc, v9, v17
  v_cmp_le_f32 s[36:37], v9, v18
  v_cmp_le_f32 s[30:31], v16, v19
  v_cmp_o_f32 s[28:29], v144, v145
  s_and_b64 vcc, vcc, s[36:37]
  s_and_b64 s[30:31], s[30:31], s[28:29]
  s_and_b64 vcc, vcc, s[30:31]
  s_cmp_eq_u64 vcc, -1
  s_cbranch_scc0 .fz_kernel_a_slow
.fz_kernel_a_fin:
  v_rcp_f32 v12, v9
  s_lshl_b32 s31, s17, 2
  s_add_u32 s31, s31, s32
  s_lshl_b32 s31, s31, 6
  s_lshl_b32 s33, s18, 2
  s_add_u32 s31, s31, s33
  s_lshl_b32 s33, s39, 1
  s_add_u32 s31, s31, s33
  s_lshl_b32 s31, s31, 10
  s_add_u32 s31, s31, s64
  v_pk_mul_f32 v[64:65], v[64:65], v[12:13] op_sel_hi:[1,0]
  v_pk_mul_f32 v[66:67], v[66:67], v[12:13] op_sel_hi:[1,0]
  v_pk_mul_f32 v[68:69], v[68:69], v[12:13] op_sel_hi:[1,0]
  v_pk_mul_f32 v[70:71], v[70:71], v[12:13] op_sel_hi:[1,0]
  v_cvt_pk_bf16_f32 v144, v64, v65
  v_cvt_pk_bf16_f32 v145, v66, v67
  v_cvt_pk_bf16_f32 v146, v68, v69
  v_cvt_pk_bf16_f32 v147, v70, v71
  buffer_store_dwordx4 v[144:147], v3, s[4:7], s31 offen offset:0 sc1
  v_pk_mul_f32 v[72:73], v[72:73], v[12:13] op_sel_hi:[1,0]
  v_pk_mul_f32 v[74:75], v[74:75], v[12:13] op_sel_hi:[1,0]
  v_pk_mul_f32 v[76:77], v[76:77], v[12:13] op_sel_hi:[1,0]
  v_pk_mul_f32 v[78:79], v[78:79], v[12:13] op_sel_hi:[1,0]
  v_cvt_pk_bf16_f32 v148, v72, v73
  v_cvt_pk_bf16_f32 v149, v74, v75
  v_cvt_pk_bf16_f32 v150, v76, v77
  v_cvt_pk_bf16_f32 v151, v78, v79
  buffer_store_dwordx4 v[148:151], v3, s[4:7], s31 offen offset:1024 sc1
  s_cmp_ge_u32 s16, 6
  s_cbranch_scc1 .fz_kernel_chain
  s_cmp_ge_u32 s16, 4
  s_cbranch_scc1 .fz_kernel_w_ld
  s_mov_b32 s8, s48
  s_mov_b32 s9, s49
  s_mov_b32 s10, 0x800
  s_mov_b32 s11, 0x00020000
  s_mov_b32 s12, s40
  s_mov_b32 s13, s41
  s_mov_b32 s14, 0x400000
  s_mov_b32 s15, 0x00020000
  v_lshrrev_b32 v17, 5, v2
  v_and_b32 v18, 31, v2
  v_lshlrev_b32 v19, 4, v17
  s_lshl_b32 s32, s17, 2
  s_add_u32 s32, s32, s16
  s_lshl_b32 s22, s18, 7
  s_lshl_b32 s39, s17, 4
  s_add_u32 s39, s39, s18
  s_lshl_b32 s39, s39, 2
  s_add_u32 s39, s39, s16
  s_lshl_b32 s39, s39, 12
  v_and_b32 v16, 16, v2
  v_lshlrev_b32 v16, 7, v16
  v_lshl_add_u32 v16, v17, 8, v16
  v_and_b32 v1, 0xf0, v3
  v_add_u32 v16, v16, v1
  s_cmp_lg_u32 s62, 0
  s_cbranch_scc1 .fz_kernel_wx2
  v_lshl_add_u32 v11, v18, 11, v19
  s_lshl_b32 s23, s32, 16
  s_add_u32 s23, s22, s23
  buffer_load_dwordx4 v[240:243], v11, s[12:15], s23 offen offset:0
  buffer_load_dwordx4 v[244:247], v11, s[12:15], s23 offen offset:32
  buffer_load_dwordx4 v[248:251], v11, s[12:15], s23 offen offset:64
  buffer_load_dwordx4 v[252:255], v11, s[12:15], s23 offen offset:96
  s_branch .fz_kernel_wx3
.fz_kernel_wx2:
  s_add_u32 s23, s39, 0x1000000
  buffer_load_dwordx4 v[240:243], v16, s[4:7], s23 offen offset:0
  buffer_load_dwordx4 v[244:247], v16, s[4:7], s23 offen offset:512
  buffer_load_dwordx4 v[248:251], v16, s[4:7], s23 offen offset:1024
  buffer_load_dwordx4 v[252:255], v16, s[4:7], s23 offen offset:1536
.fz_kernel_wx3:
  buffer_load_dwordx4 v[48:51], v19, s[8:11], s22 offen offset:0
  buffer_load_dwordx4 v[52:55], v19, s[8:11], s22 offen offset:32
  buffer_load_dwordx4 v[56:59], v19, s[8:11], s22 offen offset:64
  buffer_load_dwordx4 v[60:63], v19, s[8:11], s22 offen offset:96
  s_add_u32 s39, s39, s65
  s_lshl_b32 s31, s16, 5
  v_add_u32 v45, s31, v18
  v_lshlrev_b32 v11, 2, v45
  v_add_u32 v11, 155648, v11
  v_mov_b32 v44, 159952
  ds_read_b32 v40, v11 offset:6400
  ds_read_b32 v42, v11 offset:6912
  ds_read_b32 v46, v44 offset:8
  ds_read_b32 v44, v44
  v_mov_b32 v47, 0.32768
  v_add_u32 v45, 1, v45
  v_bfe_u32 v11, v2, 2, 2
  v_lshl_add_u32 v12, v17, 2, v11
  v_lshlrev_b32 v12, 7, v12
  v_lshrrev_b32 v13, 1, v11
  v_lshl_add_u32 v12, v13, 6, v12
  v_bfe_u32 v13, v2, 4, 1
  v_lshl_add_u32 v12, v13, 5, v12
  v_and_b32 v13, 1, v2
  v_lshl_add_u32 v12, v13, 4, v12
  v_bfe_u32 v13, v2, 1, 1
  v_lshl_add_u32 v14, v13, 3, v12
  v_xor_b32 v15, 64, v14
  s_lshl_b32 s35, s32, 16
  s_add_u32 s35, s35, s64
  s_mov_b32 s34, 0xe000
  s_lshl_b32 s36, 1, s18
  s_add_u32 s37, s19, s67
  s_add_u32 s37, s37, 4
  v_add_u32 v6, 8, v6
  s_and_b32 s28, s18, 3
  s_lshl_b32 s28, s28, 2
  s_waitcnt vmcnt(8)
  s_barrier
  s_cmp_lg_u32 s16, 3
  s_cbranch_scc1 .fz_kernel_w_nf
  v_lshlrev_b32 v7, 11, v2
  s_lshl_b32 s31, s17, 7
  s_lshl_b32 s33, 1, s18
  s_add_u32 s31, s31, s67
  s_add_u32 s31, s31, 0x1800004
  v_mov_b32 v8, s33
  s_mov_b64 exec, 0xffff
  buffer_atomic_or v8, v7, s[4:7], s31 offen sc1
  s_mov_b64 exec, -1
.fz_kernel_w_nf:
  s_andn2_b32 s33, s36, s34
  s_cbranch_scc0 .fz_kernel_pk41c
.fz_kernel_pk41:
  s_ff1_i32_b32 s33, s33
  s_bitset1_b32 s34, s33
  s_lshl_b32 s20, s33, 13
  s_lshl_b32 s33, s33, 12
  s_add_u32 s30, s33, s35
  buffer_load_dwordx4 v[96:99], v3, s[4:7], s30 offen offset:0
  buffer_load_dwordx4 v[100:103], v3, s[4:7], s30 offen offset:1024
  buffer_load_dwordx4 v[104:107], v3, s[4:7], s30 offen offset:2048
  buffer_load_dwordx4 v[108:111], v3, s[4:7], s30 offen offset:3072
  s_waitcnt vmcnt(8) lgkmcnt(0)
  v_lshlrev_b32 v64, 16, v240
  v_and_b32 v65, 0xffff0000, v240
  v_lshlrev_b32 v66, 16, v241
  v_and_b32 v67, 0xffff0000, v241
  v_lshlrev_b32 v68, 16, v242
  v_and_b32 v69, 0xffff0000, v242
  v_lshlrev_b32 v70, 16, v243
  v_and_b32 v71, 0xffff0000, v243
  v_lshlrev_b32 v72, 16, v244
  v_and_b32 v73, 0xffff0000, v244
  v_lshlrev_b32 v74, 16, v245
  v_and_b32 v75, 0xffff0000, v245
  v_lshlrev_b32 v76, 16, v246
  v_and_b32 v77, 0xffff0000, v246
  v_lshlrev_b32 v78, 16, v247
  v_and_b32 v79, 0xffff0000, v247
  v_lshlrev_b32 v80, 16, v248
  v_and_b32 v81, 0xffff0000, v248
  v_lshlrev_b32 v82, 16, v249
  v_and_b32 v83, 0xffff0000, v249
  v_lshlrev_b32 v84, 16, v250
  v_and_b32 v85, 0xffff0000, v250
  v_lshlrev_b32 v86, 16, v251
  v_and_b32 v87, 0xffff0000, v251
  v_lshlrev_b32 v88, 16, v252
  v_and_b32 v89, 0xffff0000, v252
  v_lshlrev_b32 v90, 16, v253
  v_and_b32 v91, 0xffff0000, v253
  v_lshlrev_b32 v92, 16, v254
  v_and_b32 v93, 0xffff0000, v254
  v_lshlrev_b32 v94, 16, v255
  v_and_b32 v95, 0xffff0000, v255
  v_pk_fma_f32 v[64:65], v[64:65], v[40:41], v[42:43] op_sel_hi:[1,0,0]
  v_pk_fma_f32 v[66:67], v[66:67], v[40:41], v[42:43] op_sel_hi:[1,0,0]
  v_pk_fma_f32 v[68:69], v[68:69], v[40:41], v[42:43] op_sel_hi:[1,0,0]
  v_pk_fma_f32 v[70:71], v[70:71], v[40:41], v[42:43] op_sel_hi:[1,0,0]
  v_pk_fma_f32 v[72:73], v[72:73], v[40:41], v[42:43] op_sel_hi:[1,0,0]
  v_pk_fma_f32 v[74:75], v[74:75], v[40:41], v[42:43] op_sel_hi:[1,0,0]
  v_pk_fma_f32 v[76:77], v[76:77], v[40:41], v[42:43] op_sel_hi:[1,0,0]
  v_pk_fma_f32 v[78:79], v[78:79], v[40:41], v[42:43] op_sel_hi:[1,0,0]
  v_pk_fma_f32 v[80:81], v[80:81], v[40:41], v[42:43] op_sel_hi:[1,0,0]
  v_pk_fma_f32 v[82:83], v[82:83], v[40:41], v[42:43] op_sel_hi:[1,0,0]
  v_pk_fma_f32 v[84:85], v[84:85], v[40:41], v[42:43] op_sel_hi:[1,0,0]
  v_pk_fma_f32 v[86:87], v[86:87], v[40:41], v[42:43] op_sel_hi:[1,0,0]
  v_pk_fma_f32 v[88:89], v[88:89], v[40:41], v[42:43] op_sel_hi:[1,0,0]
  v_pk_fma_f32 v[90:91], v[90:91], v[40:41], v[42:43] op_sel_hi:[1,0,0]
  v_pk_fma_f32 v[92:93], v[92:93], v[40:41], v[42:43] op_sel_hi:[1,0,0]
  v_pk_fma_f32 v[94:95], v[94:95], v[40:41], v[42:43] op_sel_hi:[1,0,0]
  v_cmp_eq_u32 vcc, v44, v45
  s_cbranch_vccnz .fz_kernel_w_pt
.fz_kernel_w_pb:
  s_andn2_b32 s33, s36, s34
  s_cbranch_scc0 .fz_kernel_pk42c
.fz_kernel_pk42:
  s_ff1_i32_b32 s33, s33
  s_bitset1_b32 s34, s33
  s_lshl_b32 s21, s33, 13
  s_lshl_b32 s33, s33, 12
  s_add_u32 s30, s33, s35
  buffer_load_dwordx4 v[112:115], v3, s[4:7], s30 offen offset:0
  buffer_load_dwordx4 v[116:119], v3, s[4:7], s30 offen offset:1024
  buffer_load_dwordx4 v[120:123], v3, s[4:7], s30 offen offset:2048
  buffer_load_dwordx4 v[124:127], v3, s[4:7], s30 offen offset:3072
  s_andn2_b32 s33, s36, s34
  s_cbranch_scc0 .fz_kernel_pk43c
.fz_kernel_pk43:
  s_ff1_i32_b32 s33, s33
  s_bitset1_b32 s34, s33
  s_lshl_b32 s22, s33, 13
  s_lshl_b32 s33, s33, 12
  s_add_u32 s30, s33, s35
  buffer_load_dwordx4 v[128:131], v3, s[4:7], s30 offen offset:0
  buffer_load_dwordx4 v[132:135], v3, s[4:7], s30 offen offset:1024
  buffer_load_dwordx4 v[136:139], v3, s[4:7], s30 offen offset:2048
  buffer_load_dwordx4 v[140:143], v3, s[4:7], s30 offen offset:3072
  v_add_u32 v10, s20, v14
  v_add_u32 v11, s20, v15
  ds_read_b64_tr_b16 v[224:225], v10 offset:0
  ds_read_b64_tr_b16 v[226:227], v10 offset:1024
  ds_read_b64_tr_b16 v[228:229], v11 offset:0
  ds_read_b64_tr_b16 v[230:231], v11 offset:1024
  ds_read_b64_tr_b16 v[232:233], v10 offset:2048
  ds_read_b64_tr_b16 v[234:235], v10 offset:3072
  ds_read_b64_tr_b16 v[236:237], v11 offset:2048
  ds_read_b64_tr_b16 v[238:239], v11 offset:3072
  s_andn2_b32 s33, s36, s34
  s_cbranch_scc0 .fz_kernel_pk44c
.fz_kernel_pk44:
  s_ff1_i32_b32 s33, s33
  s_bitset1_b32 s34, s33
  s_lshl_b32 s23, s33, 13
  s_lshl_b32 s33, s33, 12
  s_add_u32 s30, s33, s35
  s_waitcnt vmcnt(11) lgkmcnt(6)
  v_mfma_f32_32x32x16_bf16 v[64:79], v[224:227], v[96:99], v[64:79]
  v_add_u32 v12, s21, v14
  v_add_u32 v13, s21, v15
  ds_read_b64_tr_b16 v[240:241], v10 offset:4096
  ds_read_b64_tr_b16 v[242:243], v10 offset:5120
  buffer_load_dwordx4 v[144:147], v3, s[4:7], s30 offen offset:0
  s_waitcnt lgkmcnt(6)
  v_mfma_f32_32x32x16_bf16 v[80:95], v[228:231], v[96:99], v[80:95]
  ds_read_b64_tr_b16 v[244:245], v11 offset:4096
  ds_read_b64_tr_b16 v[246:247], v11 offset:5120
  s_waitcnt vmcnt(11) lgkmcnt(6)
  v_mfma_f32_32x32x16_bf16 v[64:79], v[232:235], v[100:103], v[64:79]
  ds_read_b64_tr_b16 v[248:249], v10 offset:6144
  ds_read_b64_tr_b16 v[250:251], v10 offset:7168
  buffer_load_dwordx4 v[148:151], v3, s[4:7], s30 offen offset:1024
  s_waitcnt lgkmcnt(6)
  v_mfma_f32_32x32x16_bf16 v[80:95], v[236:239], v[100:103], v[80:95]
  ds_read_b64_tr_b16 v[252:253], v11 offset:6144
  ds_read_b64_tr_b16 v[254:255], v11 offset:7168
  s_waitcnt vmcnt(11) lgkmcnt(6)
  v_mfma_f32_32x32x16_bf16 v[64:79], v[240:243], v[104:107], v[64:79]
  ds_read_b64_tr_b16 v[224:225], v12 offset:0
  ds_read_b64_tr_b16 v[226:227], v12 offset:1024
  buffer_load_dwordx4 v[152:155], v3, s[4:7], s30 offen offset:2048
  s_waitcnt lgkmcnt(6)
  v_mfma_f32_32x32x16_bf16 v[80:95], v[244:247], v[104:107], v[80:95]
  ds_read_b64_tr_b16 v[228:229], v13 offset:0
  ds_read_b64_tr_b16 v[230:231], v13 offset:1024
  s_waitcnt vmcnt(11) lgkmcnt(6)
  v_mfma_f32_32x32x16_bf16 v[64:79], v[248:251], v[108:111], v[64:79]
  ds_read_b64_tr_b16 v[232:233], v12 offset:2048
  ds_read_b64_tr_b16 v[234:235], v12 offset:3072
  buffer_load_dwordx4 v[156:159], v3, s[4:7], s30 offen offset:3072
  s_waitcnt lgkmcnt(6)
  v_mfma_f32_32x32x16_bf16 v[80:95], v[252:255], v[108:111], v[80:95]
  ds_read_b64_tr_b16 v[236:237], v13 offset:2048
  ds_read_b64_tr_b16 v[238:239], v13 offset:3072
  s_andn2_b32 s33, s36, s34
  s_cbranch_scc0 .fz_kernel_pk45c
.fz_kernel_pk45:
  s_ff1_i32_b32 s33, s33
  s_bitset1_b32 s34, s33
  s_lshl_b32 s24, s33, 13
  s_lshl_b32 s33, s33, 12
  s_add_u32 s30, s33, s35
  s_waitcnt vmcnt(11) lgkmcnt(6)
  v_mfma_f32_32x32x16_bf16 v[64:79], v[224:227], v[112:115], v[64:79]
  v_add_u32 v10, s22, v14
  v_add_u32 v11, s22, v15
  ds_read_b64_tr_b16 v[240:241], v12 offset:4096
  ds_read_b64_tr_b16 v[242:243], v12 offset:5120
  buffer_load_dwordx4 v[160:163], v3, s[4:7], s30 offen offset:0
  s_waitcnt lgkmcnt(6)
  v_mfma_f32_32x32x16_bf16 v[80:95], v[228:231], v[112:115], v[80:95]
  ds_read_b64_tr_b16 v[244:245], v13 offset:4096
  ds_read_b64_tr_b16 v[246:247], v13 offset:5120
  s_waitcnt vmcnt(11) lgkmcnt(6)
  v_mfma_f32_32x32x16_bf16 v[64:79], v[232:235], v[116:119], v[64:79]
  ds_read_b64_tr_b16 v[248:249], v12 offset:6144
  ds_read_b64_tr_b16 v[250:251], v12 offset:7168
  buffer_load_dwordx4 v[164:167], v3, s[4:7], s30 offen offset:1024
  s_waitcnt lgkmcnt(6)
  v_mfma_f32_32x32x16_bf16 v[80:95], v[236:239], v[116:119], v[80:95]
  ds_read_b64_tr_b16 v[252:253], v13 offset:6144
  ds_read_b64_tr_b16 v[254:255], v13 offset:7168
  s_waitcnt vmcnt(11) lgkmcnt(6)
  v_mfma_f32_32x32x16_bf16 v[64:79], v[240:243], v[120:123], v[64:79]
  ds_read_b64_tr_b16 v[224:225], v10 offset:0
  ds_read_b64_tr_b16 v[226:227], v10 offset:1024
  buffer_load_dwordx4 v[168:171], v3, s[4:7], s30 offen offset:2048
  s_waitcnt lgkmcnt(6)
  v_mfma_f32_32x32x16_bf16 v[80:95], v[244:247], v[120:123], v[80:95]
  ds_read_b64_tr_b16 v[228:229], v11 offset:0
  ds_read_b64_tr_b16 v[230:231], v11 offset:1024
  s_waitcnt vmcnt(11) lgkmcnt(6)
  v_mfma_f32_32x32x16_bf16 v[64:79], v[248:251], v[124:127], v[64:79]
  ds_read_b64_tr_b16 v[232:233], v10 offset:2048
  ds_read_b64_tr_b16 v[234:235], v10 offset:3072
  buffer_load_dwordx4 v[172:175], v3, s[4:7], s30 offen offset:3072
  s_waitcnt lgkmcnt(6)
  v_mfma_f32_32x32x16_bf16 v[80:95], v[252:255], v[124:127], v[80:95]
  ds_read_b64_tr_b16 v[236:237], v11 offset:2048
  ds_read_b64_tr_b16 v[238:239], v11 offset:3072
  s_barrier
  s_and_b32 s34, s34, 0x1fff
  s_andn2_b32 s33, s36, s34
  s_cbranch_scc0 .fz_kernel_pk46c
.fz_kernel_pk46:
  s_ff1_i32_b32 s33, s33
  s_bitset1_b32 s34, s33
  s_lshl_b32 s25, s33, 13
  s_lshl_b32 s33, s33, 12
  s_add_u32 s30, s33, s35
  s_waitcnt vmcnt(11) lgkmcnt(6)
  v_mfma_f32_32x32x16_bf16 v[64:79], v[224:227], v[128:131], v[64:79]
  v_add_u32 v12, s23, v14
  v_add_u32 v13, s23, v15
  ds_read_b64_tr_b16 v[240:241], v10 offset:4096
  ds_read_b64_tr_b16 v[242:243], v10 offset:5120
  buffer_load_dwordx4 v[176:179], v3, s[4:7], s30 offen offset:0
  s_waitcnt lgkmcnt(6)
  v_mfma_f32_32x32x16_bf16 v[80:95], v[228:231], v[128:131], v[80:95]
  ds_read_b64_tr_b16 v[244:245], v11 offset:4096
  ds_read_b64_tr_b16 v[246:247], v11 offset:5120
  s_waitcnt vmcnt(11) lgkmcnt(6)
  v_mfma_f32_32x32x16_bf16 v[64:79], v[232:235], v[132:135], v[64:79]
  ds_read_b64_tr_b16 v[248:249], v10 offset:6144
  ds_read_b64_tr_b16 v[250:251], v10 offset:7168
  buffer_load_dwordx4 v[180:183], v3, s[4:7], s30 offen offset:1024
  s_waitcnt lgkmcnt(6)
  v_mfma_f32_32x32x16_bf16 v[80:95], v[236:239], v[132:135], v[80:95]
  ds_read_b64_tr_b16 v[252:253], v11 offset:6144
  ds_read_b64_tr_b16 v[254:255], v11 offset:7168
  s_waitcnt vmcnt(11) lgkmcnt(6)
  v_mfma_f32_32x32x16_bf16 v[64:79], v[240:243], v[136:139], v[64:79]
  ds_read_b64_tr_b16 v[224:225], v12 offset:0
  ds_read_b64_tr_b16 v[226:227], v12 offset:1024
  buffer_load_dwordx4 v[184:187], v3, s[4:7], s30 offen offset:2048
  s_waitcnt lgkmcnt(6)
  v_mfma_f32_32x32x16_bf16 v[80:95], v[244:247], v[136:139], v[80:95]
  ds_read_b64_tr_b16 v[228:229], v13 offset:0
  ds_read_b64_tr_b16 v[230:231], v13 offset:1024
  s_waitcnt vmcnt(11) lgkmcnt(6)
  v_mfma_f32_32x32x16_bf16 v[64:79], v[248:251], v[140:143], v[64:79]
  ds_read_b64_tr_b16 v[232:233], v12 offset:2048
  ds_read_b64_tr_b16 v[234:235], v12 offset:3072
  buffer_load_dwordx4 v[188:191], v3, s[4:7], s30 offen offset:3072
  s_waitcnt lgkmcnt(6)
  v_mfma_f32_32x32x16_bf16 v[80:95], v[252:255], v[140:143], v[80:95]
  ds_read_b64_tr_b16 v[236:237], v13 offset:2048
  ds_read_b64_tr_b16 v[238:239], v13 offset:3072
  s_andn2_b32 s33, s36, s34
  s_cbranch_scc0 .fz_kernel_pk47c
.fz_kernel_pk47:
  s_ff1_i32_b32 s33, s33
  s_bitset1_b32 s34, s33
  s_lshl_b32 s26, s33, 13
  s_lshl_b32 s33, s33, 12
  s_add_u32 s30, s33, s35
  s_waitcnt vmcnt(11) lgkmcnt(6)
  v_mfma_f32_32x32x16_bf16 v[64:79], v[224:227], v[144:147], v[64:79]
  v_add_u32 v10, s24, v14
  v_add_u32 v11, s24, v15
  ds_read_b64_tr_b16 v[240:241], v12 offset:4096
  ds_read_b64_tr_b16 v[242:243], v12 offset:5120
  buffer_load_dwordx4 v[192:195], v3, s[4:7], s30 offen offset:0
  s_waitcnt lgkmcnt(6)
  v_mfma_f32_32x32x16_bf16 v[80:95], v[228:231], v[144:147], v[80:95]
  ds_read_b64_tr_b16 v[244:245], v13 offset:4096
  ds_read_b64_tr_b16 v[246:247], v13 offset:5120
  s_waitcnt vmcnt(11) lgkmcnt(6)
  v_mfma_f32_32x32x16_bf16 v[64:79], v[232:235], v[148:151], v[64:79]
  ds_read_b64_tr_b16 v[248:249], v12 offset:6144
  ds_read_b64_tr_b16 v[250:251], v12 offset:7168
  buffer_load_dwordx4 v[196:199], v3, s[4:7], s30 offen offset:1024
  s_waitcnt lgkmcnt(6)
  v_mfma_f32_32x32x16_bf16 v[80:95], v[236:239], v[148:151], v[80:95]
  ds_read_b64_tr_b16 v[252:253], v13 offset:6144
  ds_read_b64_tr_b16 v[254:255], v13 offset:7168
  s_waitcnt vmcnt(11) lgkmcnt(6)
  v_mfma_f32_32x32x16_bf16 v[64:79], v[240:243], v[152:155], v[64:79]
  ds_read_b64_tr_b16 v[224:225], v10 offset:0
  ds_read_b64_tr_b16 v[226:227], v10 offset:1024
  buffer_load_dwordx4 v[200:203], v3, s[4:7], s30 offen offset:2048
  s_waitcnt lgkmcnt(6)
  v_mfma_f32_32x32x16_bf16 v[80:95], v[244:247], v[152:155], v[80:95]
  ds_read_b64_tr_b16 v[228:229], v11 offset:0
  ds_read_b64_tr_b16 v[230:231], v11 offset:1024
  s_waitcnt vmcnt(11) lgkmcnt(6)
  v_mfma_f32_32x32x16_bf16 v[64:79], v[248:251], v[156:159], v[64:79]
  ds_read_b64_tr_b16 v[232:233], v10 offset:2048
  ds_read_b64_tr_b16 v[234:235], v10 offset:3072
  buffer_load_dwordx4 v[204:207], v3, s[4:7], s30 offen offset:3072
  s_waitcnt lgkmcnt(6)
  v_mfma_f32_32x32x16_bf16 v[80:95], v[252:255], v[156:159], v[80:95]
  ds_read_b64_tr_b16 v[236:237], v11 offset:2048
  ds_read_b64_tr_b16 v[238:239], v11 offset:3072
  s_andn2_b32 s33, s36, s34
  s_cbranch_scc0 .fz_kernel_pk48c
.fz_kernel_pk48:
  s_ff1_i32_b32 s33, s33
  s_bitset1_b32 s34, s33
  s_lshl_b32 s27, s33, 13
  s_lshl_b32 s33, s33, 12
  s_add_u32 s30, s33, s35
  s_waitcnt vmcnt(11) lgkmcnt(6)
  v_mfma_f32_32x32x16_bf16 v[64:79], v[224:227], v[160:163], v[64:79]
  v_add_u32 v12, s25, v14
  v_add_u32 v13, s25, v15
  ds_read_b64_tr_b16 v[240:241], v10 offset:4096
  ds_read_b64_tr_b16 v[242:243], v10 offset:5120
  buffer_load_dwordx4 v[208:211], v3, s[4:7], s30 offen offset:0
  s_waitcnt lgkmcnt(6)
  v_mfma_f32_32x32x16_bf16 v[80:95], v[228:231], v[160:163], v[80:95]
  ds_read_b64_tr_b16 v[244:245], v11 offset:4096
  ds_read_b64_tr_b16 v[246:247], v11 offset:5120
  s_waitcnt vmcnt(11) lgkmcnt(6)
  v_mfma_f32_32x32x16_bf16 v[64:79], v[232:235], v[164:167], v[64:79]
  ds_read_b64_tr_b16 v[248:249], v10 offset:6144
  ds_read_b64_tr_b16 v[250:251], v10 offset:7168
  buffer_load_dwordx4 v[212:215], v3, s[4:7], s30 offen offset:1024
  s_waitcnt lgkmcnt(6)
  v_mfma_f32_32x32x16_bf16 v[80:95], v[236:239], v[164:167], v[80:95]
  ds_read_b64_tr_b16 v[252:253], v11 offset:6144
  ds_read_b64_tr_b16 v[254:255], v11 offset:7168
  s_waitcnt vmcnt(11) lgkmcnt(6)
  v_mfma_f32_32x32x16_bf16 v[64:79], v[240:243], v[168:171], v[64:79]
  ds_read_b64_tr_b16 v[224:225], v12 offset:0
  ds_read_b64_tr_b16 v[226:227], v12 offset:1024
  buffer_load_dwordx4 v[216:219], v3, s[4:7], s30 offen offset:2048
  s_waitcnt lgkmcnt(6)
  v_mfma_f32_32x32x16_bf16 v[80:95], v[244:247], v[168:171], v[80:95]
  ds_read_b64_tr_b16 v[228:229], v13 offset:0
  ds_read_b64_tr_b16 v[230:231], v13 offset:1024
  s_waitcnt vmcnt(11) lgkmcnt(6)
  v_mfma_f32_32x32x16_bf16 v[64:79], v[248:251], v[172:175], v[64:79]
  ds_read_b64_tr_b16 v[232:233], v12 offset:2048
  ds_read_b64_tr_b16 v[234:235], v12 offset:3072
  buffer_load_dwordx4 v[220:223], v3, s[4:7], s30 offen offset:3072
  s_waitcnt lgkmcnt(6)
  v_mfma_f32_32x32x16_bf16 v[80:95], v[252:255], v[172:175], v[80:95]
  ds_read_b64_tr_b16 v[236:237], v13 offset:2048
  ds_read_b64_tr_b16 v[238:239], v13 offset:3072
  s_andn2_b32 s33, s36, s34
  s_cbranch_scc0 .fz_kernel_pk49c
.fz_kernel_pk49:
  s_ff1_i32_b32 s33, s33
  s_bitset1_b32 s34, s33
  s_lshl_b32 s20, s33, 13
  s_lshl_b32 s33, s33, 12
  s_add_u32 s30, s33, s35
  s_waitcnt vmcnt(11) lgkmcnt(6)
  v_mfma_f32_32x32x16_bf16 v[64:79], v[224:227], v[176:179], v[64:79]
  v_add_u32 v10, s26, v14
  v_add_u32 v11, s26, v15
  ds_read_b64_tr_b16 v[240:241], v12 offset:4096
  ds_read_b64_tr_b16 v[242:243], v12 offset:5120
  buffer_load_dwordx4 v[96:99], v3, s[4:7], s30 offen offset:0
  s_waitcnt lgkmcnt(6)
  v_mfma_f32_32x32x16_bf16 v[80:95], v[228:231], v[176:179], v[80:95]
  ds_read_b64_tr_b16 v[244:245], v13 offset:4096
  ds_read_b64_tr_b16 v[246:247], v13 offset:5120
  s_waitcnt vmcnt(11) lgkmcnt(6)
  v_mfma_f32_32x32x16_bf16 v[64:79], v[232:235], v[180:183], v[64:79]
  ds_read_b64_tr_b16 v[248:249], v12 offset:6144
  ds_read_b64_tr_b16 v[250:251], v12 offset:7168
  buffer_load_dwordx4 v[100:103], v3, s[4:7], s30 offen offset:1024
  s_waitcnt lgkmcnt(6)
  v_mfma_f32_32x32x16_bf16 v[80:95], v[236:239], v[180:183], v[80:95]
  ds_read_b64_tr_b16 v[252:253], v13 offset:6144
  ds_read_b64_tr_b16 v[254:255], v13 offset:7168
  s_waitcnt vmcnt(11) lgkmcnt(6)
  v_mfma_f32_32x32x16_bf16 v[64:79], v[240:243], v[184:187], v[64:79]
  ds_read_b64_tr_b16 v[224:225], v10 offset:0
  ds_read_b64_tr_b16 v[226:227], v10 offset:1024
  buffer_load_dwordx4 v[104:107], v3, s[4:7], s30 offen offset:2048
  s_waitcnt lgkmcnt(6)
  v_mfma_f32_32x32x16_bf16 v[80:95], v[244:247], v[184:187], v[80:95]
  ds_read_b64_tr_b16 v[228:229], v11 offset:0
  ds_read_b64_tr_b16 v[230:231], v11 offset:1024
  s_waitcnt vmcnt(11) lgkmcnt(6)
  v_mfma_f32_32x32x16_bf16 v[64:79], v[248:251], v[188:191], v[64:79]
  ds_read_b64_tr_b16 v[232:233], v10 offset:2048
  ds_read_b64_tr_b16 v[234:235], v10 offset:3072
  buffer_load_dwordx4 v[108:111], v3, s[4:7], s30 offen offset:3072
  s_waitcnt lgkmcnt(6)
  v_mfma_f32_32x32x16_bf16 v[80:95], v[252:255], v[188:191], v[80:95]
  ds_read_b64_tr_b16 v[236:237], v11 offset:2048
  ds_read_b64_tr_b16 v[238:239], v11 offset:3072
  s_andn2_b32 s33, s36, s34
  s_cbranch_scc0 .fz_kernel_pk50c
.fz_kernel_pk50:
  s_ff1_i32_b32 s33, s33
  s_bitset1_b32 s34, s33
  s_lshl_b32 s21, s33, 13
  s_lshl_b32 s33, s33, 12
  s_add_u32 s30, s33, s35
  s_waitcnt vmcnt(11) lgkmcnt(6)
  v_mfma_f32_32x32x16_bf16 v[64:79], v[224:227], v[192:195], v[64:79]
  v_add_u32 v12, s27, v14
  v_add_u32 v13, s27, v15
  ds_read_b64_tr_b16 v[240:241], v10 offset:4096
  ds_read_b64_tr_b16 v[242:243], v10 offset:5120
  buffer_load_dwordx4 v[112:115], v3, s[4:7], s30 offen offset:0
  s_waitcnt lgkmcnt(6)
  v_mfma_f32_32x32x16_bf16 v[80:95], v[228:231], v[192:195], v[80:95]
  ds_read_b64_tr_b16 v[244:245], v11 offset:4096
  ds_read_b64_tr_b16 v[246:247], v11 offset:5120
  s_waitcnt vmcnt(11) lgkmcnt(6)
  v_mfma_f32_32x32x16_bf16 v[64:79], v[232:235], v[196:199], v[64:79]
  ds_read_b64_tr_b16 v[248:249], v10 offset:6144
  ds_read_b64_tr_b16 v[250:251], v10 offset:7168
  buffer_load_dwordx4 v[116:119], v3, s[4:7], s30 offen offset:1024
  s_waitcnt lgkmcnt(6)
  v_mfma_f32_32x32x16_bf16 v[80:95], v[236:239], v[196:199], v[80:95]
  ds_read_b64_tr_b16 v[252:253], v11 offset:6144
  ds_read_b64_tr_b16 v[254:255], v11 offset:7168
  s_waitcnt vmcnt(11) lgkmcnt(6)
  v_mfma_f32_32x32x16_bf16 v[64:79], v[240:243], v[200:203], v[64:79]
  ds_read_b64_tr_b16 v[224:225], v12 offset:0
  ds_read_b64_tr_b16 v[226:227], v12 offset:1024
  buffer_load_dwordx4 v[120:123], v3, s[4:7], s30 offen offset:2048
  s_waitcnt lgkmcnt(6)
  v_mfma_f32_32x32x16_bf16 v[80:95], v[244:247], v[200:203], v[80:95]
  ds_read_b64_tr_b16 v[228:229], v13 offset:0
  ds_read_b64_tr_b16 v[230:231], v13 offset:1024
  s_waitcnt vmcnt(11) lgkmcnt(6)
  v_mfma_f32_32x32x16_bf16 v[64:79], v[248:251], v[204:207], v[64:79]
  ds_read_b64_tr_b16 v[232:233], v12 offset:2048
  ds_read_b64_tr_b16 v[234:235], v12 offset:3072
  buffer_load_dwordx4 v[124:127], v3, s[4:7], s30 offen offset:3072
  s_waitcnt lgkmcnt(6)
  v_mfma_f32_32x32x16_bf16 v[80:95], v[252:255], v[204:207], v[80:95]
  ds_read_b64_tr_b16 v[236:237], v13 offset:2048
  ds_read_b64_tr_b16 v[238:239], v13 offset:3072
  s_andn2_b32 s33, s36, s34
  s_cbranch_scc0 .fz_kernel_pk51c
.fz_kernel_pk51:
  s_ff1_i32_b32 s33, s33
  s_bitset1_b32 s34, s33
  s_lshl_b32 s22, s33, 13
  s_lshl_b32 s33, s33, 12
  s_add_u32 s30, s33, s35
  s_waitcnt vmcnt(11) lgkmcnt(6)
  v_mfma_f32_32x32x16_bf16 v[64:79], v[224:227], v[208:211], v[64:79]
  v_add_u32 v10, s20, v14
  v_add_u32 v11, s20, v15
  ds_read_b64_tr_b16 v[240:241], v12 offset:4096
  ds_read_b64_tr_b16 v[242:243], v12 offset:5120
  buffer_load_dwordx4 v[128:131], v3, s[4:7], s30 offen offset:0
  s_waitcnt lgkmcnt(6)
  v_mfma_f32_32x32x16_bf16 v[80:95], v[228:231], v[208:211], v[80:95]
  ds_read_b64_tr_b16 v[244:245], v13 offset:4096
  ds_read_b64_tr_b16 v[246:247], v13 offset:5120
  s_waitcnt vmcnt(11) lgkmcnt(6)
  v_mfma_f32_32x32x16_bf16 v[64:79], v[232:235], v[212:215], v[64:79]
  ds_read_b64_tr_b16 v[248:249], v12 offset:6144
  ds_read_b64_tr_b16 v[250:251], v12 offset:7168
  buffer_load_dwordx4 v[132:135], v3, s[4:7], s30 offen offset:1024
  s_waitcnt lgkmcnt(6)
  v_mfma_f32_32x32x16_bf16 v[80:95], v[236:239], v[212:215], v[80:95]
  ds_read_b64_tr_b16 v[252:253], v13 offset:6144
  ds_read_b64_tr_b16 v[254:255], v13 offset:7168
  s_waitcnt vmcnt(11) lgkmcnt(6)
  v_mfma_f32_32x32x16_bf16 v[64:79], v[240:243], v[216:219], v[64:79]
  ds_read_b64_tr_b16 v[224:225], v10 offset:0
  ds_read_b64_tr_b16 v[226:227], v10 offset:1024
  buffer_load_dwordx4 v[136:139], v3, s[4:7], s30 offen offset:2048
  s_waitcnt lgkmcnt(6)
  v_mfma_f32_32x32x16_bf16 v[80:95], v[244:247], v[216:219], v[80:95]
  ds_read_b64_tr_b16 v[228:229], v11 offset:0
  ds_read_b64_tr_b16 v[230:231], v11 offset:1024
  s_waitcnt vmcnt(11) lgkmcnt(6)
  v_mfma_f32_32x32x16_bf16 v[64:79], v[248:251], v[220:223], v[64:79]
  ds_read_b64_tr_b16 v[232:233], v10 offset:2048
  ds_read_b64_tr_b16 v[234:235], v10 offset:3072
  buffer_load_dwordx4 v[140:143], v3, s[4:7], s30 offen offset:3072
  s_waitcnt lgkmcnt(6)
  v_mfma_f32_32x32x16_bf16 v[80:95], v[252:255], v[220:223], v[80:95]
  ds_read_b64_tr_b16 v[236:237], v11 offset:2048
  ds_read_b64_tr_b16 v[238:239], v11 offset:3072
  s_andn2_b32 s33, s36, s34
  s_cbranch_scc0 .fz_kernel_pk52c
.fz_kernel_pk52:
  s_ff1_i32_b32 s33, s33
  s_bitset1_b32 s34, s33
  s_lshl_b32 s23, s33, 13
  s_lshl_b32 s33, s33, 12
  s_add_u32 s30, s33, s35
  s_waitcnt vmcnt(11) lgkmcnt(6)
  v_mfma_f32_32x32x16_bf16 v[64:79], v[224:227], v[96:99], v[64:79]
  v_add_u32 v12, s21, v14
  v_add_u32 v13, s21, v15
  ds_read_b64_tr_b16 v[240:241], v10 offset:4096
  ds_read_b64_tr_b16 v[242:243], v10 offset:5120
  buffer_load_dwordx4 v[144:147], v3, s[4:7], s30 offen offset:0
  s_waitcnt lgkmcnt(6)
  v_mfma_f32_32x32x16_bf16 v[80:95], v[228:231], v[96:99], v[80:95]
  ds_read_b64_tr_b16 v[244:245], v11 offset:4096
  ds_read_b64_tr_b16 v[246:247], v11 offset:5120
  s_waitcnt vmcnt(11) lgkmcnt(6)
  v_mfma_f32_32x32x16_bf16 v[64:79], v[232:235], v[100:103], v[64:79]
  ds_read_b64_tr_b16 v[248:249], v10 offset:6144
  ds_read_b64_tr_b16 v[250:251], v10 offset:7168
  buffer_load_dwordx4 v[148:151], v3, s[4:7], s30 offen offset:1024
  s_waitcnt lgkmcnt(6)
  v_mfma_f32_32x32x16_bf16 v[80:95], v[236:239], v[100:103], v[80:95]
  ds_read_b64_tr_b16 v[252:253], v11 offset:6144
  ds_read_b64_tr_b16 v[254:255], v11 offset:7168
  s_waitcnt vmcnt(11) lgkmcnt(6)
  v_mfma_f32_32x32x16_bf16 v[64:79], v[240:243], v[104:107], v[64:79]
  ds_read_b64_tr_b16 v[224:225], v12 offset:0
  ds_read_b64_tr_b16 v[226:227], v12 offset:1024
  buffer_load_dwordx4 v[152:155], v3, s[4:7], s30 offen offset:2048
  s_waitcnt lgkmcnt(6)
  v_mfma_f32_32x32x16_bf16 v[80:95], v[244:247], v[104:107], v[80:95]
  ds_read_b64_tr_b16 v[228:229], v13 offset:0
  ds_read_b64_tr_b16 v[230:231], v13 offset:1024
  s_waitcnt vmcnt(11) lgkmcnt(6)
  v_mfma_f32_32x32x16_bf16 v[64:79], v[248:251], v[108:111], v[64:79]
  ds_read_b64_tr_b16 v[232:233], v12 offset:2048
  ds_read_b64_tr_b16 v[234:235], v12 offset:3072
  buffer_load_dwordx4 v[156:159], v3, s[4:7], s30 offen offset:3072
  s_waitcnt lgkmcnt(6)
  v_mfma_f32_32x32x16_bf16 v[80:95], v[252:255], v[108:111], v[80:95]
  ds_read_b64_tr_b16 v[236:237], v13 offset:2048
  ds_read_b64_tr_b16 v[238:239], v13 offset:3072
  s_andn2_b32 s33, s36, s34
  s_cbranch_scc0 .fz_kernel_pk53c
.fz_kernel_pk53:
  s_ff1_i32_b32 s33, s33
  s_bitset1_b32 s34, s33
  s_lshl_b32 s24, s33, 13
  s_lshl_b32 s33, s33, 12
  s_add_u32 s30, s33, s35
  s_waitcnt vmcnt(11) lgkmcnt(6)
  v_mfma_f32_32x32x16_bf16 v[64:79], v[224:227], v[112:115], v[64:79]
  v_add_u32 v10, s22, v14
  v_add_u32 v11, s22, v15
  ds_read_b64_tr_b16 v[240:241], v12 offset:4096
  ds_read_b64_tr_b16 v[242:243], v12 offset:5120
  buffer_load_dwordx4 v[160:163], v3, s[4:7], s30 offen offset:0
  s_waitcnt lgkmcnt(6)
  v_mfma_f32_32x32x16_bf16 v[80:95], v[228:231], v[112:115], v[80:95]
  ds_read_b64_tr_b16 v[244:245], v13 offset:4096
  ds_read_b64_tr_b16 v[246:247], v13 offset:5120
  s_waitcnt vmcnt(11) lgkmcnt(6)
  v_mfma_f32_32x32x16_bf16 v[64:79], v[232:235], v[116:119], v[64:79]
  ds_read_b64_tr_b16 v[248:249], v12 offset:6144
  ds_read_b64_tr_b16 v[250:251], v12 offset:7168
  buffer_load_dwordx4 v[164:167], v3, s[4:7], s30 offen offset:1024
  s_waitcnt lgkmcnt(6)
  v_mfma_f32_32x32x16_bf16 v[80:95], v[236:239], v[116:119], v[80:95]
  ds_read_b64_tr_b16 v[252:253], v13 offset:6144
  ds_read_b64_tr_b16 v[254:255], v13 offset:7168
  s_waitcnt vmcnt(11) lgkmcnt(6)
  v_mfma_f32_32x32x16_bf16 v[64:79], v[240:243], v[120:123], v[64:79]
  ds_read_b64_tr_b16 v[224:225], v10 offset:0
  ds_read_b64_tr_b16 v[226:227], v10 offset:1024
  buffer_load_dwordx4 v[168:171], v3, s[4:7], s30 offen offset:2048
  s_waitcnt lgkmcnt(6)
  v_mfma_f32_32x32x16_bf16 v[80:95], v[244:247], v[120:123], v[80:95]
  ds_read_b64_tr_b16 v[228:229], v11 offset:0
  ds_read_b64_tr_b16 v[230:231], v11 offset:1024
  s_waitcnt vmcnt(11) lgkmcnt(6)
  v_mfma_f32_32x32x16_bf16 v[64:79], v[248:251], v[124:127], v[64:79]
  ds_read_b64_tr_b16 v[232:233], v10 offset:2048
  ds_read_b64_tr_b16 v[234:235], v10 offset:3072
  buffer_load_dwordx4 v[172:175], v3, s[4:7], s30 offen offset:3072
  s_waitcnt lgkmcnt(6)
  v_mfma_f32_32x32x16_bf16 v[80:95], v[252:255], v[124:127], v[80:95]
  ds_read_b64_tr_b16 v[236:237], v11 offset:2048
  ds_read_b64_tr_b16 v[238:239], v11 offset:3072
  s_andn2_b32 s33, s36, s34
  s_cbranch_scc0 .fz_kernel_pk54c
.fz_kernel_pk54:
  s_ff1_i32_b32 s33, s33
  s_bitset1_b32 s34, s33
  s_lshl_b32 s25, s33, 13
  s_lshl_b32 s33, s33, 12
  s_add_u32 s30, s33, s35
  s_waitcnt vmcnt(11) lgkmcnt(6)
  v_mfma_f32_32x32x16_bf16 v[64:79], v[224:227], v[128:131], v[64:79]
  v_add_u32 v12, s23, v14
  v_add_u32 v13, s23, v15
  ds_read_b64_tr_b16 v[240:241], v10 offset:4096
  ds_read_b64_tr_b16 v[242:243], v10 offset:5120
  buffer_load_dwordx4 v[176:179], v3, s[4:7], s30 offen offset:0
  s_waitcnt lgkmcnt(6)
  v_mfma_f32_32x32x16_bf16 v[80:95], v[228:231], v[128:131], v[80:95]
  ds_read_b64_tr_b16 v[244:245], v11 offset:4096
  ds_read_b64_tr_b16 v[246:247], v11 offset:5120
  s_waitcnt vmcnt(11) lgkmcnt(6)
  v_mfma_f32_32x32x16_bf16 v[64:79], v[232:235], v[132:135], v[64:79]
  ds_read_b64_tr_b16 v[248:249], v10 offset:6144
  ds_read_b64_tr_b16 v[250:251], v10 offset:7168
  buffer_load_dwordx4 v[180:183], v3, s[4:7], s30 offen offset:1024
  s_waitcnt lgkmcnt(6)
  v_mfma_f32_32x32x16_bf16 v[80:95], v[236:239], v[132:135], v[80:95]
  ds_read_b64_tr_b16 v[252:253], v11 offset:6144
  ds_read_b64_tr_b16 v[254:255], v11 offset:7168
  s_waitcnt vmcnt(11) lgkmcnt(6)
  v_mfma_f32_32x32x16_bf16 v[64:79], v[240:243], v[136:139], v[64:79]
  ds_read_b64_tr_b16 v[224:225], v12 offset:0
  ds_read_b64_tr_b16 v[226:227], v12 offset:1024
  buffer_load_dwordx4 v[184:187], v3, s[4:7], s30 offen offset:2048
  s_waitcnt lgkmcnt(6)
  v_mfma_f32_32x32x16_bf16 v[80:95], v[244:247], v[136:139], v[80:95]
  ds_read_b64_tr_b16 v[228:229], v13 offset:0
  ds_read_b64_tr_b16 v[230:231], v13 offset:1024
  s_waitcnt vmcnt(11) lgkmcnt(6)
  v_mfma_f32_32x32x16_bf16 v[64:79], v[248:251], v[140:143], v[64:79]
  ds_read_b64_tr_b16 v[232:233], v12 offset:2048
  ds_read_b64_tr_b16 v[234:235], v12 offset:3072
  buffer_load_dwordx4 v[188:191], v3, s[4:7], s30 offen offset:3072
  s_waitcnt lgkmcnt(6)
  v_mfma_f32_32x32x16_bf16 v[80:95], v[252:255], v[140:143], v[80:95]
  ds_read_b64_tr_b16 v[236:237], v13 offset:2048
  ds_read_b64_tr_b16 v[238:239], v13 offset:3072
  s_andn2_b32 s33, s36, s34
  s_cbranch_scc0 .fz_kernel_pk55c
.fz_kernel_pk55:
  s_ff1_i32_b32 s33, s33
  s_bitset1_b32 s34, s33
  s_lshl_b32 s26, s33, 13
  s_lshl_b32 s33, s33, 12
  s_add_u32 s30, s33, s35
  s_waitcnt vmcnt(11) lgkmcnt(6)
  v_mfma_f32_32x32x16_bf16 v[64:79], v[224:227], v[144:147], v[64:79]
  v_add_u32 v10, s24, v14
  v_add_u32 v11, s24, v15
  ds_read_b64_tr_b16 v[240:241], v12 offset:4096
  ds_read_b64_tr_b16 v[242:243], v12 offset:5120
  buffer_load_dwordx4 v[192:195], v3, s[4:7], s30 offen offset:0
  s_waitcnt lgkmcnt(6)
  v_mfma_f32_32x32x16_bf16 v[80:95], v[228:231], v[144:147], v[80:95]
  ds_read_b64_tr_b16 v[244:245], v13 offset:4096
  ds_read_b64_tr_b16 v[246:247], v13 offset:5120
  s_waitcnt vmcnt(11) lgkmcnt(6)
  v_mfma_f32_32x32x16_bf16 v[64:79], v[232:235], v[148:151], v[64:79]
  ds_read_b64_tr_b16 v[248:249], v12 offset:6144
  ds_read_b64_tr_b16 v[250:251], v12 offset:7168
  buffer_load_dwordx4 v[196:199], v3, s[4:7], s30 offen offset:1024
  s_waitcnt lgkmcnt(6)
  v_mfma_f32_32x32x16_bf16 v[80:95], v[236:239], v[148:151], v[80:95]
  ds_read_b64_tr_b16 v[252:253], v13 offset:6144
  ds_read_b64_tr_b16 v[254:255], v13 offset:7168
  s_waitcnt vmcnt(11) lgkmcnt(6)
  v_mfma_f32_32x32x16_bf16 v[64:79], v[240:243], v[152:155], v[64:79]
  ds_read_b64_tr_b16 v[224:225], v10 offset:0
  ds_read_b64_tr_b16 v[226:227], v10 offset:1024
  buffer_load_dwordx4 v[200:203], v3, s[4:7], s30 offen offset:2048
  s_waitcnt lgkmcnt(6)
  v_mfma_f32_32x32x16_bf16 v[80:95], v[244:247], v[152:155], v[80:95]
  ds_read_b64_tr_b16 v[228:229], v11 offset:0
  ds_read_b64_tr_b16 v[230:231], v11 offset:1024
  s_waitcnt vmcnt(11) lgkmcnt(6)
  v_mfma_f32_32x32x16_bf16 v[64:79], v[248:251], v[156:159], v[64:79]
  ds_read_b64_tr_b16 v[232:233], v10 offset:2048
  ds_read_b64_tr_b16 v[234:235], v10 offset:3072
  buffer_load_dwordx4 v[204:207], v3, s[4:7], s30 offen offset:3072
  s_waitcnt lgkmcnt(6)
  v_mfma_f32_32x32x16_bf16 v[80:95], v[252:255], v[156:159], v[80:95]
  ds_read_b64_tr_b16 v[236:237], v11 offset:2048
  ds_read_b64_tr_b16 v[238:239], v11 offset:3072
  s_andn2_b32 s33, s36, s34
  s_cbranch_scc0 .fz_kernel_pk56c
.fz_kernel_pk56:
  s_ff1_i32_b32 s33, s33
  s_bitset1_b32 s34, s33
  s_lshl_b32 s27, s33, 13
  s_lshl_b32 s33, s33, 12
  s_add_u32 s30, s33, s35
  s_waitcnt vmcnt(11) lgkmcnt(6)
  v_mfma_f32_32x32x16_bf16 v[64:79], v[224:227], v[160:163], v[64:79]
  v_add_u32 v12, s25, v14
  v_add_u32 v13, s25, v15
  ds_read_b64_tr_b16 v[240:241], v10 offset:4096
  ds_read_b64_tr_b16 v[242:243], v10 offset:5120
  buffer_load_dwordx4 v[208:211], v3, s[4:7], s30 offen offset:0
  s_waitcnt lgkmcnt(6)
  v_mfma_f32_32x32x16_bf16 v[80:95], v[228:231], v[160:163], v[80:95]
  ds_read_b64_tr_b16 v[244:245], v11 offset:4096
  ds_read_b64_tr_b16 v[246:247], v11 offset:5120
  s_waitcnt vmcnt(11) lgkmcnt(6)
  v_mfma_f32_32x32x16_bf16 v[64:79], v[232:235], v[164:167], v[64:79]
  ds_read_b64_tr_b16 v[248:249], v10 offset:6144
  ds_read_b64_tr_b16 v[250:251], v10 offset:7168
  buffer_load_dwordx4 v[212:215], v3, s[4:7], s30 offen offset:1024
  s_waitcnt lgkmcnt(6)
  v_mfma_f32_32x32x16_bf16 v[80:95], v[236:239], v[164:167], v[80:95]
  ds_read_b64_tr_b16 v[252:253], v11 offset:6144
  ds_read_b64_tr_b16 v[254:255], v11 offset:7168
  s_waitcnt vmcnt(11) lgkmcnt(6)
  v_mfma_f32_32x32x16_bf16 v[64:79], v[240:243], v[168:171], v[64:79]
  ds_read_b64_tr_b16 v[224:225], v12 offset:0
  ds_read_b64_tr_b16 v[226:227], v12 offset:1024
  buffer_load_dwordx4 v[216:219], v3, s[4:7], s30 offen offset:2048
  s_waitcnt lgkmcnt(6)
  v_mfma_f32_32x32x16_bf16 v[80:95], v[244:247], v[168:171], v[80:95]
  ds_read_b64_tr_b16 v[228:229], v13 offset:0
  ds_read_b64_tr_b16 v[230:231], v13 offset:1024
  s_waitcnt vmcnt(11) lgkmcnt(6)
  v_mfma_f32_32x32x16_bf16 v[64:79], v[248:251], v[172:175], v[64:79]
  ds_read_b64_tr_b16 v[232:233], v12 offset:2048
  ds_read_b64_tr_b16 v[234:235], v12 offset:3072
  buffer_load_dwordx4 v[220:223], v3, s[4:7], s30 offen offset:3072
  s_waitcnt lgkmcnt(6)
  v_mfma_f32_32x32x16_bf16 v[80:95], v[252:255], v[172:175], v[80:95]
  ds_read_b64_tr_b16 v[236:237], v13 offset:2048
  ds_read_b64_tr_b16 v[238:239], v13 offset:3072
  s_waitcnt vmcnt(11) lgkmcnt(6)
  v_mfma_f32_32x32x16_bf16 v[64:79], v[224:227], v[176:179], v[64:79]
  v_add_u32 v10, s26, v14
  v_add_u32 v11, s26, v15
  ds_read_b64_tr_b16 v[240:241], v12 offset:4096
  ds_read_b64_tr_b16 v[242:243], v12 offset:5120
  s_waitcnt lgkmcnt(6)
  v_mfma_f32_32x32x16_bf16 v[80:95], v[228:231], v[176:179], v[80:95]
  ds_read_b64_tr_b16 v[244:245], v13 offset:4096
  ds_read_b64_tr_b16 v[246:247], v13 offset:5120
  s_waitcnt vmcnt(10) lgkmcnt(6)
  v_mfma_f32_32x32x16_bf16 v[64:79], v[232:235], v[180:183], v[64:79]
  ds_read_b64_tr_b16 v[248:249], v12 offset:6144
  ds_read_b64_tr_b16 v[250:251], v12 offset:7168
  s_waitcnt lgkmcnt(6)
  v_mfma_f32_32x32x16_bf16 v[80:95], v[236:239], v[180:183], v[80:95]
  ds_read_b64_tr_b16 v[252:253], v13 offset:6144
  ds_read_b64_tr_b16 v[254:255], v13 offset:7168
  s_waitcnt vmcnt(9) lgkmcnt(6)
  v_mfma_f32_32x32x16_bf16 v[64:79], v[240:243], v[184:187], v[64:79]
  ds_read_b64_tr_b16 v[224:225], v10 offset:0
  ds_read_b64_tr_b16 v[226:227], v10 offset:1024
  s_waitcnt lgkmcnt(6)
  v_mfma_f32_32x32x16_bf16 v[80:95], v[244:247], v[184:187], v[80:95]
  ds_read_b64_tr_b16 v[228:229], v11 offset:0
  ds_read_b64_tr_b16 v[230:231], v11 offset:1024
  s_waitcnt vmcnt(8) lgkmcnt(6)
  v_mfma_f32_32x32x16_bf16 v[64:79], v[248:251], v[188:191], v[64:79]
  ds_read_b64_tr_b16 v[232:233], v10 offset:2048
  ds_read_b64_tr_b16 v[234:235], v10 offset:3072
  s_waitcnt lgkmcnt(6)
  v_mfma_f32_32x32x16_bf16 v[80:95], v[252:255], v[188:191], v[80:95]
  ds_read_b64_tr_b16 v[236:237], v11 offset:2048
  ds_read_b64_tr_b16 v[238:239], v11 offset:3072
  s_waitcnt vmcnt(7) lgkmcnt(6)
  v_mfma_f32_32x32x16_bf16 v[64:79], v[224:227], v[192:195], v[64:79]
  v_add_u32 v12, s27, v14
  v_add_u32 v13, s27, v15
  ds_read_b64_tr_b16 v[240:241], v10 offset:4096
  ds_read_b64_tr_b16 v[242:243], v10 offset:5120
  s_waitcnt lgkmcnt(6)
  v_mfma_f32_32x32x16_bf16 v[80:95], v[228:231], v[192:195], v[80:95]
  ds_read_b64_tr_b16 v[244:245], v11 offset:4096
  ds_read_b64_tr_b16 v[246:247], v11 offset:5120
  s_waitcnt vmcnt(6) lgkmcnt(6)
  v_mfma_f32_32x32x16_bf16 v[64:79], v[232:235], v[196:199], v[64:79]
  ds_read_b64_tr_b16 v[248:249], v10 offset:6144
  ds_read_b64_tr_b16 v[250:251], v10 offset:7168
  s_waitcnt lgkmcnt(6)
  v_mfma_f32_32x32x16_bf16 v[80:95], v[236:239], v[196:199], v[80:95]
  ds_read_b64_tr_b16 v[252:253], v11 offset:6144
  ds_read_b64_tr_b16 v[254:255], v11 offset:7168
  s_waitcnt vmcnt(5) lgkmcnt(6)
  v_mfma_f32_32x32x16_bf16 v[64:79], v[240:243], v[200:203], v[64:79]
  ds_read_b64_tr_b16 v[224:225], v12 offset:0
  ds_read_b64_tr_b16 v[226:227], v12 offset:1024
  s_waitcnt lgkmcnt(6)
  v_mfma_f32_32x32x16_bf16 v[80:95], v[244:247], v[200:203], v[80:95]
  ds_read_b64_tr_b16 v[228:229], v13 offset:0
  ds_read_b64_tr_b16 v[230:231], v13 offset:1024
  s_waitcnt vmcnt(4) lgkmcnt(6)
  v_mfma_f32_32x32x16_bf16 v[64:79], v[248:251], v[204:207], v[64:79]
  ds_read_b64_tr_b16 v[232:233], v12 offset:2048
  ds_read_b64_tr_b16 v[234:235], v12 offset:3072
  s_waitcnt lgkmcnt(6)
  v_mfma_f32_32x32x16_bf16 v[80:95], v[252:255], v[204:207], v[80:95]
  ds_read_b64_tr_b16 v[236:237], v13 offset:2048
  ds_read_b64_tr_b16 v[238:239], v13 offset:3072
  s_waitcnt vmcnt(3) lgkmcnt(6)
  v_mfma_f32_32x32x16_bf16 v[64:79], v[224:227], v[208:211], v[64:79]
  ds_read_b64_tr_b16 v[240:241], v12 offset:4096
  ds_read_b64_tr_b16 v[242:243], v12 offset:5120
  s_waitcnt lgkmcnt(6)
  v_mfma_f32_32x32x16_bf16 v[80:95], v[228:231], v[208:211], v[80:95]
  ds_read_b64_tr_b16 v[244:245], v13 offset:4096
  ds_read_b64_tr_b16 v[246:247], v13 offset:5120
  s_waitcnt vmcnt(2) lgkmcnt(6)
  v_mfma_f32_32x32x16_bf16 v[64:79], v[232:235], v[212:215], v[64:79]
  ds_read_b64_tr_b16 v[248:249], v12 offset:6144
  ds_read_b64_tr_b16 v[250:251], v12 offset:7168
  s_waitcnt lgkmcnt(6)
  v_mfma_f32_32x32x16_bf16 v[80:95], v[236:239], v[212:215], v[80:95]
  ds_read_b64_tr_b16 v[252:253], v13 offset:6144
  ds_read_b64_tr_b16 v[254:255], v13 offset:7168
  s_waitcnt vmcnt(1) lgkmcnt(6)
  v_mfma_f32_32x32x16_bf16 v[64:79], v[240:243], v[216:219], v[64:79]
  s_waitcnt lgkmcnt(4)
  v_mfma_f32_32x32x16_bf16 v[80:95], v[244:247], v[216:219], v[80:95]
  s_waitcnt vmcnt(0) lgkmcnt(0)
  s_barrier
  v_mfma_f32_32x32x16_bf16 v[64:79], v[248:251], v[220:223], v[64:79]
  v_mfma_f32_32x32x16_bf16 v[80:95], v[252:255], v[220:223], v[80:95]
  s_mov_b32 s36, 0x3f803f80
  v_mov_b32 v8, 0
  v_mov_b32 v9, 0
  v_mov_b32 v10, 0
  v_mov_b32 v11, 0
  v_mov_b32 v12, 0
  v_mov_b32 v13, 0
  v_lshlrev_b32 v19, 2, v18
  v_lshl_add_u32 v19, v17, 13, v19
  s_lshl_b32 s34, s32, 7
  s_add_u32 s34, s34, s66
  s_add_u32 s34, s34, 16384
  s_add_u32 s37, s34, 16384
  v_cvt_pk_bf16_f32 v20, v64, v65
  v_cvt_pk_bf16_f32 v21, v66, v67
  v_cvt_pk_bf16_f32 v22, v68, v69
  v_cvt_pk_bf16_f32 v23, v70, v71
  buffer_store_dwordx4 v[20:23], v16, s[4:7], s39 offen offset:0 sc1
  v_cvt_pk_bf16_f32 v24, v72, v73
  v_cvt_pk_bf16_f32 v25, v74, v75
  v_cvt_pk_bf16_f32 v26, v76, v77
  v_cvt_pk_bf16_f32 v27, v78, v79
  buffer_store_dwordx4 v[24:27], v16, s[4:7], s39 offen offset:512 sc1
  v_cvt_pk_bf16_f32 v28, v80, v81
  v_cvt_pk_bf16_f32 v29, v82, v83
  v_cvt_pk_bf16_f32 v30, v84, v85
  v_cvt_pk_bf16_f32 v31, v86, v87
  buffer_store_dwordx4 v[28:31], v16, s[4:7], s39 offen offset:1024 sc1
  v_cvt_pk_bf16_f32 v32, v88, v89
  v_cvt_pk_bf16_f32 v33, v90, v91
  v_cvt_pk_bf16_f32 v34, v92, v93
  v_cvt_pk_bf16_f32 v35, v94, v95
  buffer_store_dwordx4 v[32:35], v16, s[4:7], s39 offen offset:1536 sc1
  v_dot2c_f32_bf16 v8, s36, v20
  v_dot2c_f32_bf16 v9, v20, v20
  v_dot2c_f32_bf16 v10, v20, v48
  v_dot2c_f32_bf16 v11, s36, v21
  v_dot2c_f32_bf16 v12, v21, v21
  v_dot2c_f32_bf16 v13, v21, v49
  v_dot2c_f32_bf16 v8, s36, v22
  v_dot2c_f32_bf16 v9, v22, v22
  v_dot2c_f32_bf16 v10, v22, v50
  v_dot2c_f32_bf16 v11, s36, v23
  v_dot2c_f32_bf16 v12, v23, v23
  v_dot2c_f32_bf16 v13, v23, v51
  v_dot2c_f32_bf16 v8, s36, v24
  v_dot2c_f32_bf16 v9, v24, v24
  v_dot2c_f32_bf16 v10, v24, v52
  v_dot2c_f32_bf16 v11, s36, v25
  v_dot2c_f32_bf16 v12, v25, v25
  v_dot2c_f32_bf16 v13, v25, v53
  v_dot2c_f32_bf16 v8, s36, v26
  v_dot2c_f32_bf16 v9, v26, v26
  v_dot2c_f32_bf16 v10, v26, v54
  v_dot2c_f32_bf16 v11, s36, v27
  v_dot2c_f32_bf16 v12, v27, v27
  v_dot2c_f32_bf16 v13, v27, v55
  v_dot2c_f32_bf16 v8, s36, v28
  v_dot2c_f32_bf16 v9, v28, v28
  v_dot2c_f32_bf16 v10, v28, v56
  v_dot2c_f32_bf16 v11, s36, v29
  v_dot2c_f32_bf16 v12, v29, v29
  v_dot2c_f32_bf16 v13, v29, v57
  v_dot2c_f32_bf16 v8, s36, v30
  v_dot2c_f32_bf16 v9, v30, v30
  v_dot2c_f32_bf16 v10, v30, v58
  v_dot2c_f32_bf16 v11, s36, v31
  v_dot2c_f32_bf16 v12, v31, v31
  v_dot2c_f32_bf16 v13, v31, v59
  v_dot2c_f32_bf16 v8, s36, v32
  v_dot2c_f32_bf16 v9, v32, v32
  v_dot2c_f32_bf16 v10, v32, v60
  v_dot2c_f32_bf16 v11, s36, v33
  v_dot2c_f32_bf16 v12, v33, v33
  v_dot2c_f32_bf16 v13, v33, v61
  v_dot2c_f32_bf16 v8, s36, v34
  v_dot2c_f32_bf16 v9, v34, v34
  v_dot2c_f32_bf16 v10, v34, v62
  v_dot2c_f32_bf16 v11, s36, v35
  v_dot2c_f32_bf16 v12, v35, v35
  v_dot2c_f32_bf16 v13, v35, v63
  s_nop 0
  v_add_f32 v36, v8, v11
  v_add_f32 v37, v9, v12
  v_add_f32 v38, v10, v13
  v_fma_f32 v38, -v36, v46, v38
  v_fmac_f32 v47, 0x44800000, v37
  v_mov_b32 v39, v38
  s_nop 0
  v_permlane32_swap_b32 v36, v47
  v_permlane32_swap_b32 v38, v39
  v_add_f32 v36, v36, v47
  v_add_f32 v38, v38, v39
  buffer_atomic_add_f32 v36, v19, s[4:7], s34 offen sc1
  s_mov_b32 exec_hi, 0
  buffer_atomic_add_f32 v38, v19, s[4:7], s37 offen sc1
  s_mov_b64 exec, -1
  s_mov_b32 s72, s66
  s_mov_b32 s73, s65
  s_mov_b32 s74, s67
  s_mov_b32 s75, s62
  s_cmp_lg_u32 s62, 0
  s_cbranch_scc1 .fz_kernel_tail
  s_mov_b32 s62, 1
  s_mov_b32 s63, 0x2000000
  s_mov_b32 s64, 0x2800000
  s_mov_b32 s65, 0x1400000
  s_mov_b32 s66, 0x1c42000
  s_mov_b32 s67, 12
  s_mov_b32 s71, 159776
  v_mov_b32 v6, 159832
  s_branch .fz_kernel_q_cons2
.fz_kernel_tail:
  s_mov_b32 s28, s56
  s_mov_b32 s29, s57
  s_mov_b32 s30, 0x400000
  s_mov_b32 s31, 0x00020000
  v_lshlrev_b32 v37, 2, v45
  v_add_u32 v37, 155644, v37
  v_mov_b32 v36, 159952
  v_lshlrev_b32 v38, 11, v18
  v_lshl_add_u32 v38, v17, 4, v38
  s_lshl_b32 s32, s32, 16
  s_lshl_b32 s33, s18, 7
  s_add_u32 s32, s32, s33
  v_lshlrev_b32 v64, 16, v20
  v_and_b32 v65, 0xffff0000, v20
  v_lshlrev_b32 v66, 16, v21
  v_and_b32 v67, 0xffff0000, v21
  v_lshlrev_b32 v68, 16, v22
  v_and_b32 v69, 0xffff0000, v22
  v_lshlrev_b32 v70, 16, v23
  v_and_b32 v71, 0xffff0000, v23
  v_lshlrev_b32 v72, 16, v24
  v_and_b32 v73, 0xffff0000, v24
  v_lshlrev_b32 v74, 16, v25
  v_and_b32 v75, 0xffff0000, v25
  v_lshlrev_b32 v76, 16, v26
  v_and_b32 v77, 0xffff0000, v26
  v_lshlrev_b32 v78, 16, v27
  v_and_b32 v79, 0xffff0000, v27
  v_lshlrev_b32 v80, 16, v28
  v_and_b32 v81, 0xffff0000, v28
  v_lshlrev_b32 v82, 16, v29
  v_and_b32 v83, 0xffff0000, v29
  v_lshlrev_b32 v84, 16, v30
  v_and_b32 v85, 0xffff0000, v30
  v_lshlrev_b32 v86, 16, v31
  v_and_b32 v87, 0xffff0000, v31
  v_lshlrev_b32 v88, 16, v32
  v_and_b32 v89, 0xffff0000, v32
  v_lshlrev_b32 v90, 16, v33
  v_and_b32 v91, 0xffff0000, v33
  v_lshlrev_b32 v92, 16, v34
  v_and_b32 v93, 0xffff0000, v34
  v_lshlrev_b32 v94, 16, v35
  v_and_b32 v95, 0xffff0000, v35
  s_waitcnt vmcnt(0)
  s_barrier
  s_barrier
  ds_read_b32 v40, v37 offset:6400
  ds_read_b32 v42, v37 offset:6912
  ds_read_b32 v36, v36
  s_waitcnt lgkmcnt(0)
  v_cmp_ne_u32 vcc, v36, v45
  s_mov_b64 exec, vcc
  v_pk_fma_f32 v[64:65], v[64:65], v[40:41], v[42:43] op_sel_hi:[1,0,0]
  v_pk_fma_f32 v[66:67], v[66:67], v[40:41], v[42:43] op_sel_hi:[1,0,0]
  v_pk_fma_f32 v[68:69], v[68:69], v[40:41], v[42:43] op_sel_hi:[1,0,0]
  v_pk_fma_f32 v[70:71], v[70:71], v[40:41], v[42:43] op_sel_hi:[1,0,0]
  v_cvt_pk_bf16_f32 v20, v64, v65
  v_cvt_pk_bf16_f32 v21, v66, v67
  v_cvt_pk_bf16_f32 v22, v68, v69
  v_cvt_pk_bf16_f32 v23, v70, v71
  buffer_store_dwordx4 v[20:23], v38, s[28:31], s32 offen offset:0
  v_pk_fma_f32 v[72:73], v[72:73], v[40:41], v[42:43] op_sel_hi:[1,0,0]
  v_pk_fma_f32 v[74:75], v[74:75], v[40:41], v[42:43] op_sel_hi:[1,0,0]
  v_pk_fma_f32 v[76:77], v[76:77], v[40:41], v[42:43] op_sel_hi:[1,0,0]
  v_pk_fma_f32 v[78:79], v[78:79], v[40:41], v[42:43] op_sel_hi:[1,0,0]
  v_cvt_pk_bf16_f32 v24, v72, v73
  v_cvt_pk_bf16_f32 v25, v74, v75
  v_cvt_pk_bf16_f32 v26, v76, v77
  v_cvt_pk_bf16_f32 v27, v78, v79
  buffer_store_dwordx4 v[24:27], v38, s[28:31], s32 offen offset:32
  v_pk_fma_f32 v[80:81], v[80:81], v[40:41], v[42:43] op_sel_hi:[1,0,0]
  v_pk_fma_f32 v[82:83], v[82:83], v[40:41], v[42:43] op_sel_hi:[1,0,0]
  v_pk_fma_f32 v[84:85], v[84:85], v[40:41], v[42:43] op_sel_hi:[1,0,0]
  v_pk_fma_f32 v[86:87], v[86:87], v[40:41], v[42:43] op_sel_hi:[1,0,0]
  v_cvt_pk_bf16_f32 v28, v80, v81
  v_cvt_pk_bf16_f32 v29, v82, v83
  v_cvt_pk_bf16_f32 v30, v84, v85
  v_cvt_pk_bf16_f32 v31, v86, v87
  buffer_store_dwordx4 v[28:31], v38, s[28:31], s32 offen offset:64
  v_pk_fma_f32 v[88:89], v[88:89], v[40:41], v[42:43] op_sel_hi:[1,0,0]
  v_pk_fma_f32 v[90:91], v[90:91], v[40:41], v[42:43] op_sel_hi:[1,0,0]
  v_pk_fma_f32 v[92:93], v[92:93], v[40:41], v[42:43] op_sel_hi:[1,0,0]
  v_pk_fma_f32 v[94:95], v[94:95], v[40:41], v[42:43] op_sel_hi:[1,0,0]
  v_cvt_pk_bf16_f32 v32, v88, v89
  v_cvt_pk_bf16_f32 v33, v90, v91
  v_cvt_pk_bf16_f32 v34, v92, v93
  v_cvt_pk_bf16_f32 v35, v94, v95
  buffer_store_dwordx4 v[32:35], v38, s[28:31], s32 offen offset:96
  s_mov_b64 exec, -1
  s_branch .fz_kernel_fin
.fz_kernel_chain:
  s_setprio 0
  s_bitcmp1_b32 s18, 0
  s_cselect_b32 s8, s52, s50
  s_cselect_b32 s9, s53, s51
  s_mov_b32 s10, 0x700000
  s_mov_b32 s11, 0x00020000
  s_lshl_b32 s12, s16, 8
  s_and_b32 s12, s12, 511
  s_and_b32 s31, s18, 2
  s_lshl_b32 s31, s31, 8
  s_add_u32 s12, s12, s31
  s_mul_i32 s12, s12, 7168
  s_lshl_b32 s31, s17, 2
  s_lshr_b32 s33, s18, 2
  s_add_u32 s31, s31, s33
  s_lshl_b32 s31, s31, 7
  s_add_u32 s12, s12, s31
  v_lshrrev_b32 v13, 4, v2
  v_mul_u32_u24 v13, 458752, v13
  v_and_b32 v11, 15, v2
  v_lshl_add_u32 v13, v11, 3, v13
  s_mov_b32 s36, 0x05040100
  s_mov_b32 s37, 0x07060302
  s_cmp_ge_u32 s17, 14
  s_cbranch_scc1 .fz_kernel_c_nl
  buffer_load_dwordx2 v[128:129], v13, s[8:11], s12 offen
  s_add_u32 s12, s12, 7168
  buffer_load_dwordx2 v[130:131], v13, s[8:11], s12 offen
  s_add_u32 s12, s12, 7168
  buffer_load_dwordx2 v[132:133], v13, s[8:11], s12 offen
  s_add_u32 s12, s12, 7168
  buffer_load_dwordx2 v[134:135], v13, s[8:11], s12 offen
  s_add_u32 s12, s12, 7168
  buffer_load_dwordx2 v[136:137], v13, s[8:11], s12 offen
  s_add_u32 s12, s12, 7168
  buffer_load_dwordx2 v[138:139], v13, s[8:11], s12 offen
  s_add_u32 s12, s12, 7168
  buffer_load_dwordx2 v[140:141], v13, s[8:11], s12 offen
  s_add_u32 s12, s12, 7168
  buffer_load_dwordx2 v[142:143], v13, s[8:11], s12 offen
  s_add_u32 s12, s12, 7168
  buffer_load_dwordx2 v[144:145], v13, s[8:11], s12 offen
  s_add_u32 s12, s12, 7168
  buffer_load_dwordx2 v[146:147], v13, s[8:11], s12 offen
  s_add_u32 s12, s12, 7168
  buffer_load_dwordx2 v[148:149], v13, s[8:11], s12 offen
  s_add_u32 s12, s12, 7168
  buffer_load_dwordx2 v[150:151], v13, s[8:11], s12 offen
  s_add_u32 s12, s12, 7168
  buffer_load_dwordx2 v[152:153], v13, s[8:11], s12 offen
  s_add_u32 s12, s12, 7168
  buffer_load_dwordx2 v[154:155], v13, s[8:11], s12 offen
  s_add_u32 s12, s12, 7168
  buffer_load_dwordx2 v[156:157], v13, s[8:11], s12 offen
  s_add_u32 s12, s12, 7168
  buffer_load_dwordx2 v[158:159], v13, s[8:11], s12 offen
  s_add_u32 s12, s12, 7168
  s_waitcnt vmcnt(16)
  s_barrier
  buffer_load_dwordx2 v[160:161], v13, s[8:11], s12 offen
  s_add_u32 s12, s12, 7168
  buffer_load_dwordx2 v[162:163], v13, s[8:11], s12 offen
  s_add_u32 s12, s12, 7168
  buffer_load_dwordx2 v[164:165], v13, s[8:11], s12 offen
  s_add_u32 s12, s12, 7168
  buffer_load_dwordx2 v[166:167], v13, s[8:11], s12 offen
  s_add_u32 s12, s12, 7168
  buffer_load_dwordx2 v[168:169], v13, s[8:11], s12 offen
  s_add_u32 s12, s12, 7168
  buffer_load_dwordx2 v[170:171], v13, s[8:11], s12 offen
  s_add_u32 s12, s12, 7168
  buffer_load_dwordx2 v[172:173], v13, s[8:11], s12 offen
  s_add_u32 s12, s12, 7168
  buffer_load_dwordx2 v[174:175], v13, s[8:11], s12 offen
  s_add_u32 s12, s12, 7168
  buffer_load_dwordx2 v[176:177], v13, s[8:11], s12 offen
  s_add_u32 s12, s12, 7168
  buffer_load_dwordx2 v[178:179], v13, s[8:11], s12 offen
  s_add_u32 s12, s12, 7168
  buffer_load_dwordx2 v[180:181], v13, s[8:11], s12 offen
  s_add_u32 s12, s12, 7168
  buffer_load_dwordx2 v[182:183], v13, s[8:11], s12 offen
  s_add_u32 s12, s12, 7168
  buffer_load_dwordx2 v[184:185], v13, s[8:11], s12 offen
  s_add_u32 s12, s12, 7168
  buffer_load_dwordx2 v[186:187], v13, s[8:11], s12 offen
  s_add_u32 s12, s12, 7168
  buffer_load_dwordx2 v[188:189], v13, s[8:11], s12 offen
  s_add_u32 s12, s12, 7168
  buffer_load_dwordx2 v[190:191], v13, s[8:11], s12 offen
  s_add_u32 s12, s12, 7168
  buffer_load_dwordx2 v[192:193], v13, s[8:11], s12 offen
  s_add_u32 s12, s12, 7168
  buffer_load_dwordx2 v[194:195], v13, s[8:11], s12 offen
  s_add_u32 s12, s12, 7168
  buffer_load_dwordx2 v[196:197], v13, s[8:11], s12 offen
  s_add_u32 s12, s12, 7168
  buffer_load_dwordx2 v[198:199], v13, s[8:11], s12 offen
  s_add_u32 s12, s12, 7168
  buffer_load_dwordx2 v[200:201], v13, s[8:11], s12 offen
  s_add_u32 s12, s12, 7168
  buffer_load_dwordx2 v[202:203], v13, s[8:11], s12 offen
  s_add_u32 s12, s12, 7168
  buffer_load_dwordx2 v[204:205], v13, s[8:11], s12 offen
  s_add_u32 s12, s12, 7168
  buffer_load_dwordx2 v[206:207], v13, s[8:11], s12 offen
  s_add_u32 s12, s12, 7168
  buffer_load_dwordx2 v[208:209], v13, s[8:11], s12 offen
  s_add_u32 s12, s12, 7168
  buffer_load_dwordx2 v[210:211], v13, s[8:11], s12 offen
  s_add_u32 s12, s12, 7168
  buffer_load_dwordx2 v[212:213], v13, s[8:11], s12 offen
  s_add_u32 s12, s12, 7168
  buffer_load_dwordx2 v[214:215], v13, s[8:11], s12 offen
  s_add_u32 s12, s12, 7168
  buffer_load_dwordx2 v[216:217], v13, s[8:11], s12 offen
  s_add_u32 s12, s12, 7168
  buffer_load_dwordx2 v[218:219], v13, s[8:11], s12 offen
  s_add_u32 s12, s12, 7168
  buffer_load_dwordx2 v[220:221], v13, s[8:11], s12 offen
  s_add_u32 s12, s12, 7168
  buffer_load_dwordx2 v[222:223], v13, s[8:11], s12 offen
  s_add_u32 s12, s12, 7168
  buffer_load_dwordx2 v[224:225], v13, s[8:11], s12 offen
  s_add_u32 s12, s12, 7168
  buffer_load_dwordx2 v[226:227], v13, s[8:11], s12 offen
  s_add_u32 s12, s12, 7168
  buffer_load_dwordx2 v[228:229], v13, s[8:11], s12 offen
  s_add_u32 s12, s12, 7168
  buffer_load_dwordx2 v[230:231], v13, s[8:11], s12 offen
  s_add_u32 s12, s12, 7168
  buffer_load_dwordx2 v[232:233], v13, s[8:11], s12 offen
  s_add_u32 s12, s12, 7168
  buffer_load_dwordx2 v[234:235], v13, s[8:11], s12 offen
  s_add_u32 s12, s12, 7168
  buffer_load_dwordx2 v[236:237], v13, s[8:11], s12 offen
  s_add_u32 s12, s12, 7168
  buffer_load_dwordx2 v[238:239], v13, s[8:11], s12 offen
  s_add_u32 s12, s12, 7168
  buffer_load_dwordx2 v[240:241], v13, s[8:11], s12 offen
  s_add_u32 s12, s12, 7168
  buffer_load_dwordx2 v[242:243], v13, s[8:11], s12 offen
  s_add_u32 s12, s12, 7168
  buffer_load_dwordx2 v[244:245], v13, s[8:11], s12 offen
  s_add_u32 s12, s12, 7168
  buffer_load_dwordx2 v[246:247], v13, s[8:11], s12 offen
  s_add_u32 s12, s12, 7168
  s_waitcnt vmcnt(58)
  buffer_load_dwordx2 v[248:249], v13, s[8:11], s12 offen
  s_add_u32 s12, s12, 7168
  buffer_load_dwordx2 v[250:251], v13, s[8:11], s12 offen
  s_add_u32 s12, s12, 7168
  buffer_load_dwordx2 v[252:253], v13, s[8:11], s12 offen
  s_add_u32 s12, s12, 7168
  buffer_load_dwordx2 v[254:255], v13, s[8:11], s12 offen
  s_add_u32 s12, s12, 7168
  s_barrier
  v_mov_b32 v48, 0x3f803f80
  v_mov_b32 v49, 0x3f803f80
  v_mov_b32 v50, 0x3f803f80
  v_mov_b32 v51, 0x3f803f80
  s_waitcnt vmcnt(56)
  v_perm_b32 v112, v130, v128, s36
  v_perm_b32 v116, v130, v128, s37
  v_perm_b32 v120, v131, v129, s36
  v_perm_b32 v124, v131, v129, s37
  v_perm_b32 v113, v134, v132, s36
  v_perm_b32 v117, v134, v132, s37
  v_perm_b32 v121, v135, v133, s36
  v_perm_b32 v125, v135, v133, s37
  v_perm_b32 v114, v138, v136, s36
  v_perm_b32 v118, v138, v136, s37
  v_perm_b32 v122, v139, v137, s36
  v_perm_b32 v126, v139, v137, s37
  v_perm_b32 v115, v142, v140, s36
  v_perm_b32 v119, v142, v140, s37
  v_perm_b32 v123, v143, v141, s36
  v_perm_b32 v127, v143, v141, s37
  s_waitcnt vmcnt(48)
  v_perm_b32 v128, v146, v144, s36
  v_perm_b32 v132, v146, v144, s37
  v_perm_b32 v136, v147, v145, s36
  v_perm_b32 v140, v147, v145, s37
  v_perm_b32 v129, v150, v148, s36
  v_perm_b32 v133, v150, v148, s37
  v_perm_b32 v137, v151, v149, s36
  v_perm_b32 v141, v151, v149, s37
  v_perm_b32 v130, v154, v152, s36
  v_perm_b32 v134, v154, v152, s37
  v_perm_b32 v138, v155, v153, s36
  v_perm_b32 v142, v155, v153, s37
  v_perm_b32 v131, v158, v156, s36
  v_perm_b32 v135, v158, v156, s37
  v_perm_b32 v139, v159, v157, s36
  v_perm_b32 v143, v159, v157, s37
  v_mfma_f32_16x16x32_bf16 v[32:35], v[48:51], v[112:115], 0
  v_mfma_f32_16x16x32_bf16 v[36:39], v[48:51], v[116:119], 0
  v_mfma_f32_16x16x32_bf16 v[40:43], v[48:51], v[120:123], 0
  v_mfma_f32_16x16x32_bf16 v[44:47], v[48:51], v[124:127], 0
  s_waitcnt vmcnt(40)
  v_perm_b32 v144, v162, v160, s36
  v_perm_b32 v148, v162, v160, s37
  v_perm_b32 v152, v163, v161, s36
  v_perm_b32 v156, v163, v161, s37
  v_perm_b32 v145, v166, v164, s36
  v_perm_b32 v149, v166, v164, s37
  v_perm_b32 v153, v167, v165, s36
  v_perm_b32 v157, v167, v165, s37
  v_perm_b32 v146, v170, v168, s36
  v_perm_b32 v150, v170, v168, s37
  v_perm_b32 v154, v171, v169, s36
  v_perm_b32 v158, v171, v169, s37
  v_perm_b32 v147, v174, v172, s36
  v_perm_b32 v151, v174, v172, s37
  v_perm_b32 v155, v175, v173, s36
  v_perm_b32 v159, v175, v173, s37
  v_mfma_f32_16x16x32_bf16 v[32:35], v[48:51], v[128:131], v[32:35]
  v_mfma_f32_16x16x32_bf16 v[36:39], v[48:51], v[132:135], v[36:39]
  v_mfma_f32_16x16x32_bf16 v[40:43], v[48:51], v[136:139], v[40:43]
  v_mfma_f32_16x16x32_bf16 v[44:47], v[48:51], v[140:143], v[44:47]
  s_waitcnt vmcnt(32)
  v_perm_b32 v160, v178, v176, s36
  v_perm_b32 v164, v178, v176, s37
  v_perm_b32 v168, v179, v177, s36
  v_perm_b32 v172, v179, v177, s37
  v_perm_b32 v161, v182, v180, s36
  v_perm_b32 v165, v182, v180, s37
  v_perm_b32 v169, v183, v181, s36
  v_perm_b32 v173, v183, v181, s37
  v_perm_b32 v162, v186, v184, s36
  v_perm_b32 v166, v186, v184, s37
  v_perm_b32 v170, v187, v185, s36
  v_perm_b32 v174, v187, v185, s37
  v_perm_b32 v163, v190, v188, s36
  v_perm_b32 v167, v190, v188, s37
  v_perm_b32 v171, v191, v189, s36
  v_perm_b32 v175, v191, v189, s37
  v_mfma_f32_16x16x32_bf16 v[32:35], v[48:51], v[144:147], v[32:35]
  v_mfma_f32_16x16x32_bf16 v[36:39], v[48:51], v[148:151], v[36:39]
  v_mfma_f32_16x16x32_bf16 v[40:43], v[48:51], v[152:155], v[40:43]
  v_mfma_f32_16x16x32_bf16 v[44:47], v[48:51], v[156:159], v[44:47]
  s_waitcnt vmcnt(24)
  v_perm_b32 v176, v194, v192, s36
  v_perm_b32 v180, v194, v192, s37
  v_perm_b32 v184, v195, v193, s36
  v_perm_b32 v188, v195, v193, s37
  v_perm_b32 v177, v198, v196, s36
  v_perm_b32 v181, v198, v196, s37
  v_perm_b32 v185, v199, v197, s36
  v_perm_b32 v189, v199, v197, s37
  v_perm_b32 v178, v202, v200, s36
  v_perm_b32 v182, v202, v200, s37
  v_perm_b32 v186, v203, v201, s36
  v_perm_b32 v190, v203, v201, s37
  v_perm_b32 v179, v206, v204, s36
  v_perm_b32 v183, v206, v204, s37
  v_perm_b32 v187, v207, v205, s36
  v_perm_b32 v191, v207, v205, s37
  v_mfma_f32_16x16x32_bf16 v[32:35], v[48:51], v[160:163], v[32:35]
  v_mfma_f32_16x16x32_bf16 v[36:39], v[48:51], v[164:167], v[36:39]
  v_mfma_f32_16x16x32_bf16 v[40:43], v[48:51], v[168:171], v[40:43]
  v_mfma_f32_16x16x32_bf16 v[44:47], v[48:51], v[172:175], v[44:47]
  s_waitcnt vmcnt(16)
  v_perm_b32 v192, v210, v208, s36
  v_perm_b32 v196, v210, v208, s37
  v_perm_b32 v200, v211, v209, s36
  v_perm_b32 v204, v211, v209, s37
  v_perm_b32 v193, v214, v212, s36
  v_perm_b32 v197, v214, v212, s37
  v_perm_b32 v201, v215, v213, s36
  v_perm_b32 v205, v215, v213, s37
  v_perm_b32 v194, v218, v216, s36
  v_perm_b32 v198, v218, v216, s37
  v_perm_b32 v202, v219, v217, s36
  v_perm_b32 v206, v219, v217, s37
  v_perm_b32 v195, v222, v220, s36
  v_perm_b32 v199, v222, v220, s37
  v_perm_b32 v203, v223, v221, s36
  v_perm_b32 v207, v223, v221, s37
  v_mfma_f32_16x16x32_bf16 v[32:35], v[48:51], v[176:179], v[32:35]
  v_mfma_f32_16x16x32_bf16 v[36:39], v[48:51], v[180:183], v[36:39]
  v_mfma_f32_16x16x32_bf16 v[40:43], v[48:51], v[184:187], v[40:43]
  v_mfma_f32_16x16x32_bf16 v[44:47], v[48:51], v[188:191], v[44:47]
  s_waitcnt vmcnt(8)
  v_perm_b32 v208, v226, v224, s36
  v_perm_b32 v212, v226, v224, s37
  v_perm_b32 v216, v227, v225, s36
  v_perm_b32 v220, v227, v225, s37
  v_perm_b32 v209, v230, v228, s36
  v_perm_b32 v213, v230, v228, s37
  v_perm_b32 v217, v231, v229, s36
  v_perm_b32 v221, v231, v229, s37
  v_perm_b32 v210, v234, v232, s36
  v_perm_b32 v214, v234, v232, s37
  v_perm_b32 v218, v235, v233, s36
  v_perm_b32 v222, v235, v233, s37
  v_perm_b32 v211, v238, v236, s36
  v_perm_b32 v215, v238, v236, s37
  v_perm_b32 v219, v239, v237, s36
  v_perm_b32 v223, v239, v237, s37
  v_mfma_f32_16x16x32_bf16 v[32:35], v[48:51], v[192:195], v[32:35]
  v_mfma_f32_16x16x32_bf16 v[36:39], v[48:51], v[196:199], v[36:39]
  v_mfma_f32_16x16x32_bf16 v[40:43], v[48:51], v[200:203], v[40:43]
  v_mfma_f32_16x16x32_bf16 v[44:47], v[48:51], v[204:207], v[44:47]
  s_waitcnt vmcnt(0)
  v_perm_b32 v224, v242, v240, s36
  v_perm_b32 v228, v242, v240, s37
  v_perm_b32 v232, v243, v241, s36
  v_perm_b32 v236, v243, v241, s37
  v_perm_b32 v225, v246, v244, s36
  v_perm_b32 v229, v246, v244, s37
  v_perm_b32 v233, v247, v245, s36
  v_perm_b32 v237, v247, v245, s37
  v_perm_b32 v226, v250, v248, s36
  v_perm_b32 v230, v250, v248, s37
  v_perm_b32 v234, v251, v249, s36
  v_perm_b32 v238, v251, v249, s37
  v_perm_b32 v227, v254, v252, s36
  v_perm_b32 v231, v254, v252, s37
  v_perm_b32 v235, v255, v253, s36
  v_perm_b32 v239, v255, v253, s37
  v_mfma_f32_16x16x32_bf16 v[32:35], v[48:51], v[208:211], v[32:35]
  v_mfma_f32_16x16x32_bf16 v[36:39], v[48:51], v[212:215], v[36:39]
  v_mfma_f32_16x16x32_bf16 v[40:43], v[48:51], v[216:219], v[40:43]
  v_mfma_f32_16x16x32_bf16 v[44:47], v[48:51], v[220:223], v[44:47]
  v_mfma_f32_16x16x32_bf16 v[32:35], v[48:51], v[224:227], v[32:35]
  v_mfma_f32_16x16x32_bf16 v[36:39], v[48:51], v[228:231], v[36:39]
  v_mfma_f32_16x16x32_bf16 v[40:43], v[48:51], v[232:235], v[40:43]
  v_mfma_f32_16x16x32_bf16 v[44:47], v[48:51], v[236:239], v[44:47]
.fz_kernel_c_np:
  s_mov_b32 s72, s66
  s_mov_b32 s73, s65
  s_mov_b32 s74, s67
  s_mov_b32 s75, s62
  s_cmp_lg_u32 s62, 0
  s_cbranch_scc1 .fz_kernel_c_n2
  s_mov_b32 s62, 1
  s_mov_b32 s63, 0x2000000
  s_mov_b32 s64, 0x2800000
  s_mov_b32 s65, 0x1400000
  s_mov_b32 s66, 0x1c42000
  s_mov_b32 s67, 12
  s_mov_b32 s71, 159776
  v_mov_b32 v6, 159832
.fz_kernel_c_n2:
  s_lshr_b32 s21, s17, 3
  s_add_u32 s70, s18, s21
  s_lshl1_add_u32 s70, s17, s70
  s_and_b32 s70, s70, 15
  s_cmp_eq_u32 s75, 0
  s_cselect_b32 s3, 32, 0
  s_cselect_b32 s70, s70, s18
  s_and_b32 s20, s16, 1
  s_mov_b32 s34, 0x00010001
  s_mov_b32 s35, 0x00010001
  s_mov_b32 s71, 0
  v_lshlrev_b32 v19, 3, v11
  v_lshrrev_b32 v8, 4, v2
  v_bfe_u32 v12, v2, 3, 1
  v_lshl_add_u32 v12, v12, 2, v8
  v_lshlrev_b32 v10, 7, v2
  s_lshl_b32 s25, s20, 1
  v_lshrrev_b32 v14, 4, v2
  v_bfe_u32 v15, v2, 2, 2
  v_lshl_add_u32 v16, v14, 3, v15
  v_lshlrev_b32 v16, 7, v16
  v_and_b32 v14, 1, v14
  v_lshrrev_b32 v15, 1, v15
  v_lshl_add_u32 v14, v14, 1, v15
  v_xor_b32 v14, s25, v14
  v_lshl_add_u32 v16, v14, 5, v16
  v_and_b32 v14, 3, v2
  v_lshl_add_u32 v16, v14, 3, v16
  v_add_u32 v7, 65536, v16
  v_xor_b32 v9, 32, v7
  s_add_u32 s21, s74, 0x1800008
  s_sub_u32 s22, s72, 32768
  v_mov_b32 v14, s21
  v_mov_b32 v15, s22
  v_cmp_gt_u32 vcc, 16, v2
  s_nop 1
  v_cndmask_b32 v14, v15, v14, vcc
  v_lshl_add_u32 v14, v2, 11, v14
  s_lshl_b32 s25, s17, 7
  s_lshl_b32 s22, 1, s18
  v_mov_b32 v15, s22
  v_lshlrev_b32 v16, 3, v2
  s_and_b32 s21, s2, 7
  s_lshl_b32 s21, s21, 11
  s_lshl_b32 s22, s20, 10
  s_add_u32 s21, s21, s22
  s_add_u32 s21, s21, s72
  s_lshl_b32 s22, s20, 12
  s_add_u32 s22, s22, s72
  s_add_u32 s22, s22, 16384
  s_add_u32 s23, s22, 8192
  s_add_u32 s24, s22, 16384
  s_cmp_ge_u32 s17, 14
  s_barrier
  s_cbranch_scc1 .fz_kernel_c_n3
.fz_kernel_c_n3:
  s_cmp_eq_u32 s20, 0
  s_barrier
  s_cbranch_scc1 .fz_kernel_c_nf
  s_mov_b64 exec, 0xffffff
  buffer_atomic_or v15, v14, s[4:7], s25 offen sc1
  s_mov_b64 exec, -1
.fz_kernel_c_nf:
  v_lshlrev_b32 v14, 14, v8
  s_cmp_ge_u32 s17, 14
  s_cbranch_scc1 .fz_kernel_c_n4
.fz_kernel_c_n4:
  v_mul_f32 v28, 0.0009765625, v32
  v_mul_f32 v29, 0.0009765625, v36
  v_mul_f32 v30, 0.0009765625, v40
  v_mul_f32 v31, 0.0009765625, v44
  s_cmp_lg_u32 s75, 0
  s_cbranch_scc1 .fz_kernel_c_nw
  ds_read_b64_tr_b16 v[64:65], v7 offset:0
  ds_read_b64_tr_b16 v[66:67], v7 offset:512
  ds_read_b64_tr_b16 v[68:69], v9 offset:0
  ds_read_b64_tr_b16 v[70:71], v9 offset:512
  ds_read_b64_tr_b16 v[72:73], v7 offset:4096
  ds_read_b64_tr_b16 v[74:75], v7 offset:4608
  ds_read_b64_tr_b16 v[76:77], v9 offset:4096
  ds_read_b64_tr_b16 v[78:79], v9 offset:4608
  ds_read_b64_tr_b16 v[80:81], v7 offset:8192
  ds_read_b64_tr_b16 v[82:83], v7 offset:8704
  ds_read_b64_tr_b16 v[84:85], v9 offset:8192
  ds_read_b64_tr_b16 v[86:87], v9 offset:8704
  s_waitcnt lgkmcnt(0)
  ds_read_b64_tr_b16 v[88:89], v7 offset:12288
  ds_read_b64_tr_b16 v[90:91], v7 offset:12800
  ds_read_b64_tr_b16 v[92:93], v9 offset:12288
  ds_read_b64_tr_b16 v[94:95], v9 offset:12800
  ds_read_b64_tr_b16 v[96:97], v7 offset:16384
  ds_read_b64_tr_b16 v[98:99], v7 offset:16896
  ds_read_b64_tr_b16 v[100:101], v9 offset:16384
  ds_read_b64_tr_b16 v[102:103], v9 offset:16896
  ds_read_b64_tr_b16 v[104:105], v7 offset:20480
  ds_read_b64_tr_b16 v[106:107], v7 offset:20992
  ds_read_b64_tr_b16 v[108:109], v9 offset:20480
  ds_read_b64_tr_b16 v[110:111], v9 offset:20992
  s_waitcnt lgkmcnt(0)
  s_cmp_eq_u32 s3, 0
  s_cbranch_scc1 .fz_kernel_hb57
  s_barrier
  s_sub_u32 s3, s3, 1
.fz_kernel_hb57:
.fz_kernel_c_nw:
  s_mov_b64 exec, 0xff
  s_mov_b32 s38, 0
.fz_kernel_c_gm:
  buffer_load_dword v9, v10, s[4:7], s21 offen sc1
  s_add_u32 s38, s38, 1
  s_mov_b32 s46, 0
  s_call_b64 s[0:1], .fz_kernel_hw
  s_waitcnt vmcnt(0)
  v_cmp_ne_u32 vcc, 0xffff, v9
  s_cbranch_vccz .fz_kernel_c_gmd
  s_cmp_eq_u32 s3, 0
  s_cbranch_scc1 .fz_kernel_hb58
  s_barrier
  s_sub_u32 s3, s3, 1
.fz_kernel_hb58:
  s_cmp_lt_u32 s38, 131072
  s_cbranch_scc1 .fz_kernel_c_gm
.fz_kernel_c_gmd:
  s_mov_b64 exec, -1
  buffer_load_dwordx4 v[32:35], v3, s[4:7], s22 offen offset:0
  buffer_load_dwordx4 v[36:39], v3, s[4:7], s23 offen offset:0
  buffer_load_dwordx4 v[40:43], v3, s[4:7], s24 offen offset:0
  buffer_load_dwordx4 v[44:47], v3, s[4:7], s22 offen offset:1024
  buffer_load_dwordx4 v[48:51], v3, s[4:7], s23 offen offset:1024
  buffer_load_dwordx4 v[52:55], v3, s[4:7], s24 offen offset:1024
  buffer_load_dwordx4 v[56:59], v3, s[4:7], s22 offen offset:2048
  buffer_load_dwordx4 v[60:63], v3, s[4:7], s23 offen offset:2048
  buffer_load_dwordx4 v[240:243], v3, s[4:7], s24 offen offset:2048
  buffer_load_dwordx4 v[244:247], v3, s[4:7], s22 offen offset:3072
  buffer_load_dwordx4 v[248:251], v3, s[4:7], s23 offen offset:3072
  buffer_load_dwordx4 v[252:255], v3, s[4:7], s24 offen offset:3072
  s_lshl_b32 s21, s75, 4
  s_add_u32 s21, s21, 159968
  v_mov_b32 v10, s21
  s_lshl_b32 s22, s20, 3
  v_add_u32 v13, s22, v10
  s_mov_b32 s46, 6
  s_call_b64 s[0:1], .fz_kernel_hw
  s_waitcnt vmcnt(6)
  s_waitcnt vmcnt(10)
  v_fma_f32 v36, -v32, v32, v36
  v_fma_f32 v37, -v33, v33, v37
  v_fma_f32 v38, -v34, v34, v38
  v_fma_f32 v39, -v35, v35, v39
  s_cmp_eq_u32 s3, 0
  s_cbranch_scc1 .fz_kernel_hb64
  s_barrier
  s_sub_u32 s3, s3, 1
.fz_kernel_hb64:
  v_rsq_f32 v36, abs(v36)
  v_rsq_f32 v37, abs(v37)
  v_rsq_f32 v38, abs(v38)
  v_rsq_f32 v39, abs(v39)
  s_waitcnt vmcnt(9)
  v_mul_f32 v40, v40, v36
  v_mul_f32 v41, v41, v37
  v_mul_f32 v42, v42, v38
  v_mul_f32 v43, v43, v39
  v_and_or_b32 v40, v40, -16, 0
  v_and_or_b32 v41, v41, -16, 1
  v_and_or_b32 v42, v42, -16, 2
  v_and_or_b32 v43, v43, -16, 3
  v_max3_f32 v9, v40, v41, v42
  v_max_f32 v9, v9, v43
  s_waitcnt vmcnt(7)
  v_fma_f32 v48, -v44, v44, v48
  v_fma_f32 v49, -v45, v45, v49
  v_fma_f32 v50, -v46, v46, v50
  v_fma_f32 v51, -v47, v47, v51
  v_rsq_f32 v48, abs(v48)
  v_rsq_f32 v49, abs(v49)
  v_rsq_f32 v50, abs(v50)
  v_rsq_f32 v51, abs(v51)
  s_waitcnt vmcnt(6)
  v_mul_f32 v52, v52, v48
  v_mul_f32 v53, v53, v49
  v_mul_f32 v54, v54, v50
  v_mul_f32 v55, v55, v51
  s_cmp_eq_u32 s3, 0
  s_cbranch_scc1 .fz_kernel_hb65
  s_barrier
  s_sub_u32 s3, s3, 1
.fz_kernel_hb65:
  v_and_or_b32 v52, v52, -16, 4
  v_and_or_b32 v53, v53, -16, 5
  v_and_or_b32 v54, v54, -16, 6
  v_and_or_b32 v55, v55, -16, 7
  v_max3_f32 v9, v9, v52, v53
  v_max3_f32 v9, v9, v54, v55
  s_waitcnt vmcnt(4)
  v_fma_f32 v60, -v56, v56, v60
  v_fma_f32 v61, -v57, v57, v61
  v_fma_f32 v62, -v58, v58, v62
  v_fma_f32 v63, -v59, v59, v63
  v_rsq_f32 v60, abs(v60)
  v_rsq_f32 v61, abs(v61)
  v_rsq_f32 v62, abs(v62)
  v_rsq_f32 v63, abs(v63)
  s_waitcnt vmcnt(3)
  v_mul_f32 v240, v240, v60
  v_mul_f32 v241, v241, v61
  v_mul_f32 v242, v242, v62
  v_mul_f32 v243, v243, v63
  v_and_or_b32 v240, v240, -16, 8
  v_and_or_b32 v241, v241, -16, 9
  v_and_or_b32 v242, v242, -16, 10
  v_and_or_b32 v243, v243, -16, 11
  v_max3_f32 v9, v9, v240, v241
  v_max3_f32 v9, v9, v242, v243
  s_waitcnt vmcnt(1)
  v_fma_f32 v248, -v244, v244, v248
  v_fma_f32 v249, -v245, v245, v249
  v_fma_f32 v250, -v246, v246, v250
  v_fma_f32 v251, -v247, v247, v251
  v_rsq_f32 v248, abs(v248)
  s_cmp_eq_u32 s3, 0
  s_cbranch_scc1 .fz_kernel_hb66
  s_barrier
  s_sub_u32 s3, s3, 1
.fz_kernel_hb66:
  v_rsq_f32 v249, abs(v249)
  v_rsq_f32 v250, abs(v250)
  v_rsq_f32 v251, abs(v251)
  s_waitcnt vmcnt(0)
  v_mul_f32 v252, v252, v248
  v_mul_f32 v253, v253, v249
  v_mul_f32 v254, v254, v250
  v_mul_f32 v255, v255, v251
  v_and_or_b32 v252, v252, -16, 12
  v_and_or_b32 v253, v253, -16, 13
  v_and_or_b32 v254, v254, -16, 14
  v_and_or_b32 v255, v255, -16, 15
  v_max3_f32 v9, v9, v252, v253
  v_max3_f32 v9, v9, v254, v255
  s_nop 1
  v_max_f32 v7, v9, v9 row_ror:8 row_mask:0xf bank_mask:0xf
  s_nop 1
  v_max_f32 v7, v7, v7 row_ror:4 row_mask:0xf bank_mask:0xf
  s_nop 1
  v_max_f32 v7, v7, v7 row_ror:2 row_mask:0xf bank_mask:0xf
  s_nop 1
  v_max_f32 v7, v7, v7 row_ror:1 row_mask:0xf bank_mask:0xf
  s_nop 1
  v_max_f32 v7, v7, v7 row_bcast:15 row_mask:0xa bank_mask:0xf
  s_nop 1
  v_max_f32 v7, v7, v7 row_bcast:31 row_mask:0xc bank_mask:0xf
  s_nop 0
  v_readlane_b32 s21, v7, 63
  s_nop 1
  v_cmp_eq_u32 vcc, s21, v9
  s_ff1_i32_b64 s22, vcc
  s_lshl_b32 s22, s22, 2
  s_and_b32 s23, s21, 3
  s_add_u32 s22, s22, s23
  s_and_b32 s23, s21, 12
  s_lshl_b32 s23, s23, 6
  s_add_u32 s22, s22, s23
  s_and_b32 s22, s22, 1023
  s_lshl_b32 s23, s20, 10
  s_add_u32 s22, s22, s23
  s_add_u32 s22, s22, 1
  v_mov_b32 v240, s21
  v_mov_b32 v241, s22
  s_mov_b64 exec, 1
  ds_write_b64 v13, v[240:241]
  s_mov_b32 s38, 0
.fz_kernel_c_am:
  s_cmp_eq_u32 s3, 0
  s_cbranch_scc1 .fz_kernel_hb67
  s_barrier
  s_sub_u32 s3, s3, 1
.fz_kernel_hb67:
  ds_read_b128 v[240:243], v10
  s_add_u32 s38, s38, 1
  s_waitcnt lgkmcnt(0)
  v_min_u32 v9, v241, v243
  v_cmp_eq_u32 vcc, 0, v9
  s_cbranch_vccz .fz_kernel_c_amd
  s_cmp_eq_u32 s3, 0
  s_cbranch_scc1 .fz_kernel_hb59
  s_barrier
  s_sub_u32 s3, s3, 1
.fz_kernel_hb59:
  s_cmp_lt_u32 s38, 524288
  s_cbranch_scc1 .fz_kernel_c_am
.fz_kernel_c_amd:
  v_cmp_gt_f32 vcc, v242, v240
  s_nop 1
  v_cndmask_b32 v241, v241, v243, vcc
  v_cndmask_b32 v240, v240, v242, vcc
  v_readfirstlane_b32 s77, v241
  v_readfirstlane_b32 s27, v240
  s_mov_b64 exec, s[34:35]
  s_sub_u32 s77, s77, 1
  s_and_b32 s77, s77, 2047
  s_lshr_b32 s78, s77, 7
  s_lshl_b32 s78, s78, 18
  s_and_b32 s21, s77, 0x70
  s_lshl_b32 s21, s21, 7
  s_add_u32 s78, s78, s21
  s_and_b32 s21, s77, 15
  s_lshl_b32 s21, s21, 4
  s_add_u32 s78, s78, s21
  s_add_u32 s78, s78, s73
  s_and_b32 s25, s18, 2
  s_add_u32 s25, s25, s20
  s_lshl_b32 s21, s25, 16
  s_add_u32 s21, s21, s78
  buffer_load_dwordx4 v[32:35], v14, s[4:7], s21 offen offset:0
  buffer_load_dwordx4 v[36:39], v14, s[4:7], s21 offen offset:256
  buffer_load_dwordx4 v[40:43], v14, s[4:7], s21 offen offset:512
  buffer_load_dwordx4 v[44:47], v14, s[4:7], s21 offen offset:768
  buffer_load_dwordx4 v[48:51], v14, s[4:7], s21 offen offset:1024
  buffer_load_dwordx4 v[52:55], v14, s[4:7], s21 offen offset:1280
  buffer_load_dwordx4 v[56:59], v14, s[4:7], s21 offen offset:1536
  buffer_load_dwordx4 v[60:63], v14, s[4:7], s21 offen offset:1792
  s_mov_b64 exec, -1
  s_lshl_b32 s21, s77, 2
  s_add_u32 s21, s21, s72
  s_add_u32 s21, s21, 16384
  s_add_u32 s22, s21, 8192
  buffer_load_dword v11, v4, s[4:7], s21 offen
  s_cmp_eq_u32 s3, 0
  s_cbranch_scc1 .fz_kernel_hb68
  s_barrier
  s_sub_u32 s3, s3, 1
.fz_kernel_hb68:
  buffer_load_dword v15, v4, s[4:7], s22 offen
  s_lshr_b32 s21, s77, 7
  s_and_b32 s79, s77, 127
  s_add_u32 s79, s79, 1
  s_cmp_eq_u32 s21, s17
  s_cselect_b32 s79, s79, 0
  s_and_b32 s21, s18, 1
  s_lshl_b32 s21, s21, 2
  s_add_u32 s21, s21, s25
  s_lshl_b32 s21, s21, 9
  s_lshl_b32 s22, s17, 13
  s_add_u32 s21, s21, s22
  s_and_b32 s22, s18, 8
  s_lshl_b32 s22, s22, 9
  s_add_u32 s21, s21, s22
  s_and_b32 s22, s18, 4
  s_lshl_b32 s22, s22, 6
  s_add_u32 s21, s21, s22
  s_add_u32 s21, s21, s72
  s_add_u32 s21, s21, 40960
  s_lshl_b32 s26, s17, 1
  s_add_u32 s26, s26, s20
  v_mov_b32 v1, -1477.3197218702985
  v_mul_f32 v1, s27, v1
  v_exp_f32 v1, v1
  v_lshl_add_u32 v13, v8, 16, v19
  v_add_f32 v1, 1.0, v1
  v_rcp_f32 v1, v1
  v_and_b32 v14, 8, v2
  v_lshlrev_b32 v14, 7, v14
  v_lshl_add_u32 v14, v8, 8, v14
  s_lshl_b32 s23, s70, 14
  s_add_u32 s23, s23, s78
  s_lshl_b32 s24, s17, 9
  s_add_u32 s24, s24, s72
  s_add_u32 s24, s24, 16384
  s_add_u32 s25, s24, 8192
  s_mov_b32 s8, s54
  s_mov_b32 s9, s55
  s_mov_b32 s10, 0x700000
  s_mov_b32 s11, 0x00020000
  s_lshl_b32 s27, s26, 18
  s_lshl_b32 s22, s18, 7
  s_add_u32 s22, s27, s22
  s_mov_b32 s46, 0
  s_call_b64 s[0:1], .fz_kernel_hw
  s_waitcnt vmcnt(0)
  s_cmp_ge_u32 s17, 14
  s_cbranch_scc1 .fz_kernel_c_ng
  s_setprio 2
  v_mfma_f32_16x16x32_bf16 v[240:243], v[32:35], v[112:115], 0
  v_mfma_f32_16x16x32_bf16 v[244:247], v[32:35], v[116:119], 0
  v_mfma_f32_16x16x32_bf16 v[248:251], v[32:35], v[120:123], 0
  v_mfma_f32_16x16x32_bf16 v[252:255], v[32:35], v[124:127], 0
  v_mfma_f32_16x16x32_bf16 v[240:243], v[36:39], v[128:131], v[240:243]
  v_mfma_f32_16x16x32_bf16 v[244:247], v[36:39], v[132:135], v[244:247]
  v_mfma_f32_16x16x32_bf16 v[248:251], v[36:39], v[136:139], v[248:251]
  v_mfma_f32_16x16x32_bf16 v[252:255], v[36:39], v[140:143], v[252:255]
  v_mfma_f32_16x16x32_bf16 v[240:243], v[40:43], v[144:147], v[240:243]
  v_mfma_f32_16x16x32_bf16 v[244:247], v[40:43], v[148:151], v[244:247]
  v_mfma_f32_16x16x32_bf16 v[248:251], v[40:43], v[152:155], v[248:251]
  v_mfma_f32_16x16x32_bf16 v[252:255], v[40:43], v[156:159], v[252:255]
  v_mfma_f32_16x16x32_bf16 v[240:243], v[44:47], v[160:163], v[240:243]
  v_mfma_f32_16x16x32_bf16 v[244:247], v[44:47], v[164:167], v[244:247]
  v_mfma_f32_16x16x32_bf16 v[248:251], v[44:47], v[168:171], v[248:251]
  v_mfma_f32_16x16x32_bf16 v[252:255], v[44:47], v[172:175], v[252:255]
  v_mfma_f32_16x16x32_bf16 v[240:243], v[48:51], v[176:179], v[240:243]
  v_mfma_f32_16x16x32_bf16 v[244:247], v[48:51], v[180:183], v[244:247]
  v_mfma_f32_16x16x32_bf16 v[248:251], v[48:51], v[184:187], v[248:251]
  v_mfma_f32_16x16x32_bf16 v[252:255], v[48:51], v[188:191], v[252:255]
  v_mfma_f32_16x16x32_bf16 v[240:243], v[52:55], v[192:195], v[240:243]
  v_mfma_f32_16x16x32_bf16 v[244:247], v[52:55], v[196:199], v[244:247]
  v_mfma_f32_16x16x32_bf16 v[248:251], v[52:55], v[200:203], v[248:251]
  v_mfma_f32_16x16x32_bf16 v[252:255], v[52:55], v[204:207], v[252:255]
  v_mfma_f32_16x16x32_bf16 v[240:243], v[56:59], v[208:211], v[240:243]
  v_mfma_f32_16x16x32_bf16 v[244:247], v[56:59], v[212:215], v[244:247]
  v_mfma_f32_16x16x32_bf16 v[248:251], v[56:59], v[216:219], v[248:251]
  v_mfma_f32_16x16x32_bf16 v[252:255], v[56:59], v[220:223], v[252:255]
  v_mfma_f32_16x16x32_bf16 v[240:243], v[60:63], v[224:227], v[240:243]
  v_mfma_f32_16x16x32_bf16 v[244:247], v[60:63], v[228:231], v[244:247]
  v_mfma_f32_16x16x32_bf16 v[248:251], v[60:63], v[232:235], v[248:251]
  v_mfma_f32_16x16x32_bf16 v[252:255], v[60:63], v[236:239], v[252:255]
  s_nop 4
  v_fma_f32 v32, -v11, v28, v240
  v_fma_f32 v33, -v11, v29, v244
  v_or_b32 v32, 1, v32
  v_fma_f32 v34, -v11, v30, v248
  v_fma_f32 v35, -v11, v31, v252
  v_or_b32 v34, 1, v34
  s_mov_b64 exec, 0xffff
  buffer_store_dwordx4 v[32:35], v3, s[4:7], s21 offen offset:0 sc1
  s_mov_b64 exec, -1
  s_setprio 0
  s_cmp_eq_u32 s3, 0
  s_cbranch_scc1 .fz_kernel_hb60
  s_barrier
  s_sub_u32 s3, s3, 1
.fz_kernel_hb60:
.fz_kernel_c_ng:
  buffer_load_dwordx2 v[252:253], v16, s[4:7], s24 offen
  buffer_load_dwordx2 v[254:255], v16, s[4:7], s25 offen
  buffer_load_dwordx4 v[248:251], v14, s[4:7], s23 offen
  s_cmp_ge_u32 s17, 14
  s_cbranch_scc1 .fz_kernel_c_g1
  buffer_load_dwordx2 v[128:129], v13, s[8:11], s22 offen offset:0
  buffer_load_dwordx2 v[130:131], v13, s[8:11], s22 offen offset:2048
  s_add_u32 s22, s22, 4096
  buffer_load_dwordx2 v[132:133], v13, s[8:11], s22 offen offset:0
  buffer_load_dwordx2 v[134:135], v13, s[8:11], s22 offen offset:2048
  s_add_u32 s22, s22, 4096
  buffer_load_dwordx2 v[136:137], v13, s[8:11], s22 offen offset:0
  buffer_load_dwordx2 v[138:139], v13, s[8:11], s22 offen offset:2048
  s_add_u32 s22, s22, 4096
  buffer_load_dwordx2 v[140:141], v13, s[8:11], s22 offen offset:0
  buffer_load_dwordx2 v[142:143], v13, s[8:11], s22 offen offset:2048
  s_add_u32 s22, s22, 4096
  buffer_load_dwordx2 v[144:145], v13, s[8:11], s22 offen offset:0
  buffer_load_dwordx2 v[146:147], v13, s[8:11], s22 offen offset:2048
  s_add_u32 s22, s22, 4096
  buffer_load_dwordx2 v[148:149], v13, s[8:11], s22 offen offset:0
  buffer_load_dwordx2 v[150:151], v13, s[8:11], s22 offen offset:2048
  s_add_u32 s22, s22, 4096
  s_cmp_eq_u32 s3, 0
  s_cbranch_scc1 .fz_kernel_hb69
  s_barrier
  s_sub_u32 s3, s3, 1
.fz_kernel_hb69:
  buffer_load_dwordx2 v[152:153], v13, s[8:11], s22 offen offset:0
  buffer_load_dwordx2 v[154:155], v13, s[8:11], s22 offen offset:2048
  s_add_u32 s22, s22, 4096
  buffer_load_dwordx2 v[156:157], v13, s[8:11], s22 offen offset:0
  buffer_load_dwordx2 v[158:159], v13, s[8:11], s22 offen offset:2048
  s_add_u32 s22, s22, 4096
  buffer_load_dwordx2 v[160:161], v13, s[8:11], s22 offen offset:0
  buffer_load_dwordx2 v[162:163], v13, s[8:11], s22 offen offset:2048
  s_add_u32 s22, s22, 4096
  buffer_load_dwordx2 v[164:165], v13, s[8:11], s22 offen offset:0
  buffer_load_dwordx2 v[166:167], v13, s[8:11], s22 offen offset:2048
  s_add_u32 s22, s22, 4096
  buffer_load_dwordx2 v[168:169], v13, s[8:11], s22 offen offset:0
  buffer_load_dwordx2 v[170:171], v13, s[8:11], s22 offen offset:2048
  s_add_u32 s22, s22, 4096
  buffer_load_dwordx2 v[172:173], v13, s[8:11], s22 offen offset:0
  buffer_load_dwordx2 v[174:175], v13, s[8:11], s22 offen offset:2048
  s_add_u32 s22, s22, 4096
  buffer_load_dwordx2 v[176:177], v13, s[8:11], s22 offen offset:0
  buffer_load_dwordx2 v[178:179], v13, s[8:11], s22 offen offset:2048
  s_add_u32 s22, s22, 4096
  buffer_load_dwordx2 v[180:181], v13, s[8:11], s22 offen offset:0
  buffer_load_dwordx2 v[182:183], v13, s[8:11], s22 offen offset:2048
  s_add_u32 s22, s22, 4096
  s_cmp_eq_u32 s3, 0
  s_cbranch_scc1 .fz_kernel_hb70
  s_barrier
  s_sub_u32 s3, s3, 1
.fz_kernel_hb70:
  buffer_load_dwordx2 v[184:185], v13, s[8:11], s22 offen offset:0
  buffer_load_dwordx2 v[186:187], v13, s[8:11], s22 offen offset:2048
  s_add_u32 s22, s22, 4096
  buffer_load_dwordx2 v[188:189], v13, s[8:11], s22 offen offset:0
  buffer_load_dwordx2 v[190:191], v13, s[8:11], s22 offen offset:2048
  s_add_u32 s22, s22, 4096
.fz_kernel_c_g1:
  v_fma_f32 v15, -v11, v11, v15
  v_rsq_f32 v15, abs(v15)
  v_mov_b32 v28, 0.0009765625
  v_mov_b32 v29, 9.5367431640625e-07
  v_mov_b32 v30, 1e-05
  v_mul_f32 v227, v11, v15
  v_mul_f32 v15, 0x44800000, v15
  v_sub_f32 v227, 0, v227
  v_add_f32 v226, 1.0, v15
  v_mul_f32 v225, -1.4426950408889634, v15
  v_mul_f32 v15, v15, v15
  v_mul_f32 v1, v1, v15
  s_cmp_eq_u32 s75, 0
  s_cbranch_scc1 .fz_kernel_c_d0
  s_cmp_ge_u32 s17, 14
  s_cbranch_scc1 .fz_kernel_c_t0
  s_waitcnt vmcnt(32)
  s_branch .fz_kernel_c_t1
.fz_kernel_c_t0:
  s_waitcnt vmcnt(0)
.fz_kernel_c_t1:
  s_call_b64 s[68:69], .fz_kernel_c_coef
  s_cmp_lg_u32 s20, 0
  s_cbranch_scc1 .fz_kernel_c_t2
  v_mov_b32 v9, 159952
  v_mov_b32 v7, s79
  ds_write_b64 v31, v[244:245] offset:6400
  ds_write_b64 v31, v[246:247] offset:6912
  ds_write_b32 v9, v7
  s_waitcnt lgkmcnt(0)
.fz_kernel_c_t2:
  s_barrier
.fz_kernel_c_d0:
  s_cmp_ge_u32 s17, 14
  s_cbranch_scc1 .fz_kernel_c_nd
  s_lshl_b32 s21, s26, 12
  s_add_u32 s21, s21, s72
  s_add_u32 s21, s21, 40960
  s_mul_i32 s27, s18, 28
  s_add_u32 s27, s27, s26
  s_lshl_b32 s27, s27, 8
  s_add_u32 s27, s27, s72
  s_add_u32 s27, s27, 155648
  s_mov_b32 s46, 16
  s_call_b64 s[0:1], .fz_kernel_hw
  s_waitcnt vmcnt(16)
  s_cmp_eq_u32 s3, 0
  s_cbranch_scc1 .fz_kernel_hb71
  s_barrier
  s_sub_u32 s3, s3, 1
.fz_kernel_hb71:
  v_perm_b32 v112, v130, v128, s36
  v_perm_b32 v116, v130, v128, s37
  v_perm_b32 v120, v131, v129, s36
  v_perm_b32 v124, v131, v129, s37
  v_perm_b32 v113, v134, v132, s36
  v_perm_b32 v117, v134, v132, s37
  v_perm_b32 v121, v135, v133, s36
  v_perm_b32 v125, v135, v133, s37
  v_perm_b32 v114, v138, v136, s36
  v_perm_b32 v118, v138, v136, s37
  v_perm_b32 v122, v139, v137, s36
  v_perm_b32 v126, v139, v137, s37
  v_perm_b32 v115, v142, v140, s36
  v_perm_b32 v119, v142, v140, s37
  v_perm_b32 v123, v143, v141, s36
  v_perm_b32 v127, v143, v141, s37
  v_perm_b32 v128, v146, v144, s36
  v_perm_b32 v132, v146, v144, s37
  v_perm_b32 v136, v147, v145, s36
  v_perm_b32 v140, v147, v145, s37
  v_perm_b32 v129, v150, v148, s36
  v_perm_b32 v133, v150, v148, s37
  v_perm_b32 v137, v151, v149, s36
  v_perm_b32 v141, v151, v149, s37
  v_perm_b32 v130, v154, v152, s36
  v_perm_b32 v134, v154, v152, s37
  v_perm_b32 v138, v155, v153, s36
  v_perm_b32 v142, v155, v153, s37
  v_perm_b32 v131, v158, v156, s36
  v_perm_b32 v135, v158, v156, s37
  v_perm_b32 v139, v159, v157, s36
  v_perm_b32 v143, v159, v157, s37
  s_mov_b32 s46, 0
  s_call_b64 s[0:1], .fz_kernel_hw
  s_waitcnt vmcnt(0)
  v_perm_b32 v144, v162, v160, s36
  v_perm_b32 v148, v162, v160, s37
  s_cmp_eq_u32 s3, 0
  s_cbranch_scc1 .fz_kernel_hb72
  s_barrier
  s_sub_u32 s3, s3, 1
.fz_kernel_hb72:
  v_perm_b32 v152, v163, v161, s36
  v_perm_b32 v156, v163, v161, s37
  v_perm_b32 v145, v166, v164, s36
  v_perm_b32 v149, v166, v164, s37
  v_perm_b32 v153, v167, v165, s36
  v_perm_b32 v157, v167, v165, s37
  v_perm_b32 v146, v170, v168, s36
  v_perm_b32 v150, v170, v168, s37
  v_perm_b32 v154, v171, v169, s36
  v_perm_b32 v158, v171, v169, s37
  v_perm_b32 v147, v174, v172, s36
  v_perm_b32 v151, v174, v172, s37
  v_perm_b32 v155, v175, v173, s36
  v_perm_b32 v159, v175, v173, s37
  v_perm_b32 v160, v178, v176, s36
  v_perm_b32 v164, v178, v176, s37
  v_perm_b32 v168, v179, v177, s36
  v_perm_b32 v172, v179, v177, s37
  v_perm_b32 v161, v182, v180, s36
  v_perm_b32 v165, v182, v180, s37
  v_perm_b32 v169, v183, v181, s36
  v_perm_b32 v173, v183, v181, s37
  v_perm_b32 v162, v186, v184, s36
  v_perm_b32 v166, v186, v184, s37
  v_perm_b32 v170, v187, v185, s36
  v_perm_b32 v174, v187, v185, s37
  v_perm_b32 v163, v190, v188, s36
  v_perm_b32 v167, v190, v188, s37
  v_perm_b32 v171, v191, v189, s36
  v_perm_b32 v175, v191, v189, s37
  buffer_load_dwordx2 v[192:193], v16, s[4:7], s21 offen offset:0 sc1
  buffer_load_dwordx2 v[194:195], v16, s[4:7], s21 offen offset:512 sc1
  buffer_load_dwordx2 v[196:197], v16, s[4:7], s21 offen offset:1024 sc1
  s_cmp_eq_u32 s3, 0
  s_cbranch_scc1 .fz_kernel_hb73
  s_barrier
  s_sub_u32 s3, s3, 1
.fz_kernel_hb73:
  buffer_load_dwordx2 v[198:199], v16, s[4:7], s21 offen offset:1536 sc1
  buffer_load_dwordx2 v[200:201], v16, s[4:7], s21 offen offset:2048 sc1
  buffer_load_dwordx2 v[202:203], v16, s[4:7], s21 offen offset:2560 sc1
  buffer_load_dwordx2 v[204:205], v16, s[4:7], s21 offen offset:3072 sc1
  buffer_load_dwordx2 v[206:207], v16, s[4:7], s21 offen offset:3584 sc1
  s_mov_b32 s38, 0
.fz_kernel_c_gu:
  s_mov_b32 s46, 0
  s_call_b64 s[0:1], .fz_kernel_hw
  s_waitcnt vmcnt(0)
  v_min3_u32 v9, v192, v194, v196
  v_min3_u32 v9, v9, v198, v200
  v_min3_u32 v9, v9, v202, v204
  v_min_u32 v9, v9, v206
  v_cmp_eq_u32 vcc, 0, v9
  v_add_f32 v208, v192, v194
  v_add_f32 v209, v193, v195
  v_add_f32 v210, v196, v198
  v_add_f32 v211, v197, v199
  s_cbranch_vccnz .fz_kernel_c_gur
.fz_kernel_c_gud:
  v_add_f32 v192, v208, v210
  v_add_f32 v193, v209, v211
  v_mul_f32 v194, v192, v225
  v_mul_f32 v195, v193, v225
  v_exp_f32 v194, v194
  v_exp_f32 v195, v195
  v_add_f32 v200, v200, v202
  v_add_f32 v201, v201, v203
  v_add_f32 v204, v204, v206
  v_add_f32 v205, v205, v207
  v_add_f32 v194, 1.0, v194
  v_add_f32 v195, 1.0, v195
  s_cmp_eq_u32 s3, 0
  s_cbranch_scc1 .fz_kernel_hb74
  s_barrier
  s_sub_u32 s3, s3, 1
.fz_kernel_hb74:
  v_rcp_f32 v194, v194
  v_rcp_f32 v195, v195
  v_add_f32 v200, v200, v204
  v_add_f32 v201, v201, v205
  v_mul_f32 v192, v192, v200
  v_mul_f32 v193, v193, v201
  v_mul_f32 v192, v192, v194
  v_mul_f32 v193, v193, v195
  v_cvt_pk_bf16_f32 v192, v192, v193
  s_setprio 2
  s_nop 0
  v_mov_b32 v208, v192 row_newbcast:0 row_mask:0xf bank_mask:0xf
  v_mov_b32 v209, v192 row_newbcast:1 row_mask:0xf bank_mask:0xf
  v_mov_b32 v210, v192 row_newbcast:2 row_mask:0xf bank_mask:0xf
  v_mov_b32 v211, v192 row_newbcast:3 row_mask:0xf bank_mask:0xf
  v_mov_b32 v212, v192 row_newbcast:4 row_mask:0xf bank_mask:0xf
  v_mov_b32 v213, v192 row_newbcast:5 row_mask:0xf bank_mask:0xf
  v_mov_b32 v214, v192 row_newbcast:6 row_mask:0xf bank_mask:0xf
  v_mov_b32 v215, v192 row_newbcast:7 row_mask:0xf bank_mask:0xf
  v_mfma_f32_16x16x32_bf16 v[32:35], v[208:211], v[112:115], 0
  v_mfma_f32_16x16x32_bf16 v[36:39], v[208:211], v[116:119], 0
  v_mfma_f32_16x16x32_bf16 v[40:43], v[208:211], v[120:123], 0
  v_mfma_f32_16x16x32_bf16 v[44:47], v[208:211], v[124:127], 0
  v_mov_b32 v216, v192 row_newbcast:8 row_mask:0xf bank_mask:0xf
  v_mov_b32 v217, v192 row_newbcast:9 row_mask:0xf bank_mask:0xf
  v_mov_b32 v218, v192 row_newbcast:10 row_mask:0xf bank_mask:0xf
  v_mov_b32 v219, v192 row_newbcast:11 row_mask:0xf bank_mask:0xf
  v_mfma_f32_16x16x32_bf16 v[32:35], v[212:215], v[128:131], v[32:35]
  v_mfma_f32_16x16x32_bf16 v[36:39], v[212:215], v[132:135], v[36:39]
  v_mfma_f32_16x16x32_bf16 v[40:43], v[212:215], v[136:139], v[40:43]
  v_mfma_f32_16x16x32_bf16 v[44:47], v[212:215], v[140:143], v[44:47]
  v_mov_b32 v220, v192 row_newbcast:12 row_mask:0xf bank_mask:0xf
  v_mov_b32 v221, v192 row_newbcast:13 row_mask:0xf bank_mask:0xf
  v_mov_b32 v222, v192 row_newbcast:14 row_mask:0xf bank_mask:0xf
  v_mov_b32 v223, v192 row_newbcast:15 row_mask:0xf bank_mask:0xf
  v_mfma_f32_16x16x32_bf16 v[32:35], v[216:219], v[144:147], v[32:35]
  v_mfma_f32_16x16x32_bf16 v[36:39], v[216:219], v[148:151], v[36:39]
  v_mfma_f32_16x16x32_bf16 v[40:43], v[216:219], v[152:155], v[40:43]
  v_mfma_f32_16x16x32_bf16 v[44:47], v[216:219], v[156:159], v[44:47]
  v_mfma_f32_16x16x32_bf16 v[32:35], v[220:223], v[160:163], v[32:35]
  v_mfma_f32_16x16x32_bf16 v[36:39], v[220:223], v[164:167], v[36:39]
  v_mfma_f32_16x16x32_bf16 v[40:43], v[220:223], v[168:171], v[40:43]
  v_mfma_f32_16x16x32_bf16 v[44:47], v[220:223], v[172:175], v[44:47]
  s_nop 4
  v_or_b32 v32, 1, v32
  v_mov_b32 v33, v36
  v_or_b32 v34, 1, v40
  v_mov_b32 v35, v44
  s_mov_b64 exec, 0xffff
  buffer_store_dwordx4 v[32:35], v3, s[4:7], s27 offen offset:0 sc1
  s_mov_b64 exec, -1
  s_setprio 0
.fz_kernel_c_nd:
  s_cmp_eq_u32 s75, 0
  s_cbranch_scc1 .fz_kernel_c_m0
  s_lshl_b32 s21, s17, 1
  s_add_u32 s21, s21, s20
  s_cmp_lg_u32 s21, 31
  s_cbranch_scc1 .fz_kernel_fin
  s_branch .fz_kernel_c_pp
.fz_kernel_c_m0:
  s_cmp_eq_u32 s3, 0
  s_cbranch_scc1 .fz_kernel_hb62
  s_barrier
  s_sub_u32 s3, s3, 1
.fz_kernel_hb62:
  s_mov_b32 s46, 1
  s_call_b64 s[0:1], .fz_kernel_hw
  s_waitcnt vmcnt(1)
  s_cmp_lt_u32 s17, 14
  s_cbranch_scc1 .fz_kernel_c_m1
  s_waitcnt vmcnt(0)
.fz_kernel_c_m1:
  s_call_b64 s[68:69], .fz_kernel_c_coef
  s_cmp_lg_u32 s79, 0
  s_cbranch_scc1 .fz_kernel_c_pp
  s_cmp_lg_u32 s20, 0
  s_cbranch_scc1 .fz_kernel_c_m2
  ds_write_b64 v31, v[240:241] offset:4608
  ds_write_b64 v31, v[242:243] offset:5120
  ds_write_b64 v31, v[244:245] offset:6400
  ds_write_b64 v31, v[246:247] offset:6912
  s_waitcnt lgkmcnt(0)
.fz_kernel_c_m2:
  s_add_u32 s3, s3, 2
.fz_kernel_c_pp:
  v_and_b32 v10, 7, v2
  v_lshlrev_b32 v10, 8, v10
  v_lshl_add_u32 v10, v12, 5, v10
  s_mul_i32 s21, s70, 7168
  s_add_u32 s21, s21, s72
  s_add_u32 s21, s21, 155648
  s_add_u32 s22, s21, 4096
  s_mov_b32 s24, 0x0f0f0f0f
  s_mov_b32 s25, 0x0f0f0f0f
  s_lshl_b32 s27, s18, 4
  s_add_u32 s27, s27, s17
  s_lshl_b32 s27, s27, 10
  s_add_u32 s27, s27, 0x1c84000
  v_mov_b32 v216, 1
  v_mov_b32 v217, 1
  s_cmp_eq_u32 s3, 0
  s_cbranch_scc1 .fz_kernel_hb75
  s_barrier
  s_sub_u32 s3, s3, 1
.fz_kernel_hb75:
  v_mov_b32 v218, 1
  v_mov_b32 v219, 1
  v_mov_b32 v220, 1
  v_mov_b32 v221, 1
  v_mov_b32 v222, 1
  v_mov_b32 v223, 1
  buffer_load_dwordx4 v[192:195], v10, s[4:7], s21 offen offset:0 sc1
  buffer_load_dwordx4 v[196:199], v10, s[4:7], s21 offen offset:16 sc1
  buffer_load_dwordx4 v[200:203], v10, s[4:7], s21 offen offset:2048 sc1
  buffer_load_dwordx4 v[204:207], v10, s[4:7], s21 offen offset:2064 sc1
  buffer_load_dwordx4 v[208:211], v10, s[4:7], s22 offen offset:0 sc1
  buffer_load_dwordx4 v[212:215], v10, s[4:7], s22 offen offset:16 sc1
  s_mov_b64 exec, s[24:25]
  buffer_load_dwordx4 v[216:219], v10, s[4:7], s22 offen offset:2048 sc1
  buffer_load_dwordx4 v[220:223], v10, s[4:7], s22 offen offset:2064 sc1
  s_mov_b64 exec, -1
  s_mov_b32 s38, 0
.fz_kernel_c_pu:
  s_mov_b32 s46, 0
  s_call_b64 s[0:1], .fz_kernel_hw
  s_waitcnt vmcnt(0)
  v_min3_u32 v9, v192, v194, v196
  v_min3_u32 v9, v9, v198, v200
  v_min3_u32 v9, v9, v202, v204
  v_min3_u32 v9, v9, v206, v208
  v_min3_u32 v9, v9, v210, v212
  v_min3_u32 v9, v9, v214, v216
  v_min3_u32 v9, v9, v218, v220
  v_min_u32 v9, v9, v222
  v_cmp_eq_u32 vcc, 0, v9
  v_add_f32 v32, v192, v200
  v_add_f32 v33, v193, v201
  s_cmp_eq_u32 s3, 0
  s_cbranch_scc1 .fz_kernel_hb76
  s_barrier
  s_sub_u32 s3, s3, 1
.fz_kernel_hb76:
  v_add_f32 v34, v194, v202
  v_add_f32 v35, v195, v203
  s_cbranch_vccnz .fz_kernel_c_pur
.fz_kernel_c_pud:
  v_add_f32 v36, v196, v204
  v_add_f32 v37, v197, v205
  v_add_f32 v38, v198, v206
  v_add_f32 v39, v199, v207
  v_add_f32 v208, v208, v216
  v_add_f32 v209, v209, v217
  v_add_f32 v210, v210, v218
  v_add_f32 v211, v211, v219
  v_add_f32 v212, v212, v220
  v_add_f32 v213, v213, v221
  v_add_f32 v214, v214, v222
  v_add_f32 v215, v215, v223
  v_add_f32 v192, v32, v208
  v_add_f32 v193, v33, v209
  v_add_f32 v194, v34, v210
  v_add_f32 v195, v35, v211
  v_add_f32 v196, v36, v212
  v_add_f32 v197, v37, v213
  v_add_f32 v198, v38, v214
  v_add_f32 v199, v39, v215
  v_add_f32 v192, v192, v192 quad_perm:[1,0,3,2] row_mask:0xf bank_mask:0xf
  v_add_f32 v193, v193, v193 quad_perm:[1,0,3,2] row_mask:0xf bank_mask:0xf
  v_add_f32 v194, v194, v194 quad_perm:[1,0,3,2] row_mask:0xf bank_mask:0xf
  v_add_f32 v195, v195, v195 quad_perm:[1,0,3,2] row_mask:0xf bank_mask:0xf
  v_add_f32 v196, v196, v196 quad_perm:[1,0,3,2] row_mask:0xf bank_mask:0xf
  v_add_f32 v197, v197, v197 quad_perm:[1,0,3,2] row_mask:0xf bank_mask:0xf
  v_add_f32 v198, v198, v198 quad_perm:[1,0,3,2] row_mask:0xf bank_mask:0xf
  v_add_f32 v199, v199, v199 quad_perm:[1,0,3,2] row_mask:0xf bank_mask:0xf
  v_add_f32 v192, v192, v192 quad_perm:[2,3,0,1] row_mask:0xf bank_mask:0xf
  v_add_f32 v193, v193, v193 quad_perm:[2,3,0,1] row_mask:0xf bank_mask:0xf
  v_add_f32 v194, v194, v194 quad_perm:[2,3,0,1] row_mask:0xf bank_mask:0xf
  v_add_f32 v195, v195, v195 quad_perm:[2,3,0,1] row_mask:0xf bank_mask:0xf
  v_add_f32 v196, v196, v196 quad_perm:[2,3,0,1] row_mask:0xf bank_mask:0xf
  s_cmp_eq_u32 s3, 0
  s_cbranch_scc1 .fz_kernel_hb77
  s_barrier
  s_sub_u32 s3, s3, 1
.fz_kernel_hb77:
  v_add_f32 v197, v197, v197 quad_perm:[2,3,0,1] row_mask:0xf bank_mask:0xf
  v_add_f32 v198, v198, v198 quad_perm:[2,3,0,1] row_mask:0xf bank_mask:0xf
  v_add_f32 v199, v199, v199 quad_perm:[2,3,0,1] row_mask:0xf bank_mask:0xf
  v_add_f32 v192, v192, v192 row_half_mirror row_mask:0xf bank_mask:0xf
  v_add_f32 v193, v193, v193 row_half_mirror row_mask:0xf bank_mask:0xf
  v_add_f32 v194, v194, v194 row_half_mirror row_mask:0xf bank_mask:0xf
  v_add_f32 v195, v195, v195 row_half_mirror row_mask:0xf bank_mask:0xf
  v_add_f32 v196, v196, v196 row_half_mirror row_mask:0xf bank_mask:0xf
  v_add_f32 v197, v197, v197 row_half_mirror row_mask:0xf bank_mask:0xf
  v_add_f32 v198, v198, v198 row_half_mirror row_mask:0xf bank_mask:0xf
  v_add_f32 v199, v199, v199 row_half_mirror row_mask:0xf bank_mask:0xf
  v_mul_f32 v192, v192, v1
  v_mul_f32 v193, v193, v1
  v_mul_f32 v194, v194, v1
  v_mul_f32 v195, v195, v1
  v_mul_f32 v196, v196, v1
  v_mul_f32 v197, v197, v1
  v_mul_f32 v198, v198, v1
  v_mul_f32 v199, v199, v1
  v_cvt_pk_bf16_f32 v228, v192, v193
  v_cvt_pk_bf16_f32 v229, v194, v195
  v_cvt_pk_bf16_f32 v230, v196, v197
  v_cvt_pk_bf16_f32 v231, v198, v199
  s_or_b32 s21, s75, s71
  s_cbranch_scc1 .fz_kernel_c_w7
  s_mul_i32 s21, s20, 384
  s_add_u32 s21, s21, s27
  s_setprio 2
  v_mfma_f32_16x16x32_bf16 v[32:35], v[228:231], v[64:67], 0
  v_mov_b32 v112, v228 row_ror:8 row_mask:0xf bank_mask:0xf
  v_mfma_f32_16x16x32_bf16 v[36:39], v[228:231], v[68:71], 0
  v_mov_b32 v113, v229 row_ror:8 row_mask:0xf bank_mask:0xf
  v_mfma_f32_16x16x32_bf16 v[40:43], v[228:231], v[72:75], 0
  v_mov_b32 v114, v230 row_ror:8 row_mask:0xf bank_mask:0xf
  v_mfma_f32_16x16x32_bf16 v[44:47], v[228:231], v[76:79], 0
  v_mov_b32 v115, v231 row_ror:8 row_mask:0xf bank_mask:0xf
  v_mfma_f32_16x16x32_bf16 v[48:51], v[228:231], v[80:83], 0
  v_mfma_f32_16x16x32_bf16 v[52:55], v[228:231], v[84:87], 0
  v_mfma_f32_16x16x32_bf16 v[32:35], v[112:115], v[88:91], v[32:35]
  v_mfma_f32_16x16x32_bf16 v[36:39], v[112:115], v[92:95], v[36:39]
  v_mfma_f32_16x16x32_bf16 v[40:43], v[112:115], v[96:99], v[40:43]
  v_mfma_f32_16x16x32_bf16 v[44:47], v[112:115], v[100:103], v[44:47]
  v_mfma_f32_16x16x32_bf16 v[48:51], v[112:115], v[104:107], v[48:51]
  v_mfma_f32_16x16x32_bf16 v[52:55], v[112:115], v[108:111], v[52:55]
  s_nop 2
  v_or_b32 v32, 1, v32
  v_mov_b32 v33, v36
  v_or_b32 v34, 1, v40
  v_mov_b32 v35, v44
  s_mov_b64 exec, 0xffff
  buffer_store_dwordx4 v[32:35], v3, s[4:7], s21 offen offset:0 sc1
  v_or_b32 v48, 1, v48
  v_mov_b32 v49, v52
  buffer_store_dwordx2 v[48:49], v16, s[4:7], s21 offen offset:256 sc1
  s_mov_b64 exec, -1
  s_setprio 0
  s_cmp_lg_u32 s20, 0
  s_cbranch_scc1 .fz_kernel_c_w7
  s_cmp_eq_u32 s79, 0
  s_cbranch_scc1 .fz_kernel_c_no2
  s_cmp_eq_u32 s3, 0
  s_cbranch_scc1 .fz_kernel_hb78
  s_barrier
  s_sub_u32 s3, s3, 1
.fz_kernel_hb78:
  v_add_u32 v13, 155648, v3
  s_lshl_b32 s21, s18, 14
  s_add_u32 s21, s21, 0x1c84000
  s_add_u32 s22, s21, 4096
  s_add_u32 s23, s21, 8192
  s_add_u32 s24, s21, 12288
  v_rcp_f32 v192, v226
  v_lshlrev_b32 v194, 1, v2
  v_sub_u32 v194, s79, v194
  v_cmp_eq_u32 s[28:29], 1, v194
  v_cmp_eq_u32 s[30:31], 2, v194
  s_nop 0
  v_cndmask_b32 v196, 0, v192, s[28:29]
  v_cndmask_b32 v197, 0, v192, s[30:31]
  s_bfm_b64 exec, 49, 0
  s_mov_b32 s38, 0
.fz_kernel_c_pd:
  buffer_load_dwordx4 v[120:123], v3, s[4:7], s21 offen offset:0 sc1
  buffer_load_dwordx4 v[124:127], v3, s[4:7], s21 offen offset:1024 sc1
  buffer_load_dwordx4 v[128:131], v3, s[4:7], s21 offen offset:2048 sc1
  buffer_load_dwordx4 v[132:135], v3, s[4:7], s21 offen offset:3072 sc1
  buffer_load_dwordx4 v[136:139], v3, s[4:7], s22 offen offset:0 sc1
  buffer_load_dwordx4 v[140:143], v3, s[4:7], s22 offen offset:1024 sc1
  buffer_load_dwordx4 v[144:147], v3, s[4:7], s22 offen offset:2048 sc1
  buffer_load_dwordx4 v[148:151], v3, s[4:7], s22 offen offset:3072 sc1
  buffer_load_dwordx4 v[152:155], v3, s[4:7], s23 offen offset:0 sc1
  buffer_load_dwordx4 v[156:159], v3, s[4:7], s23 offen offset:1024 sc1
  buffer_load_dwordx4 v[160:163], v3, s[4:7], s23 offen offset:2048 sc1
  s_cmp_eq_u32 s3, 0
  s_cbranch_scc1 .fz_kernel_hb79
  s_barrier
  s_sub_u32 s3, s3, 1
.fz_kernel_hb79:
  buffer_load_dwordx4 v[164:167], v3, s[4:7], s23 offen offset:3072 sc1
  buffer_load_dwordx4 v[168:171], v3, s[4:7], s24 offen offset:0 sc1
  buffer_load_dwordx4 v[172:175], v3, s[4:7], s24 offen offset:1024 sc1
  buffer_load_dwordx4 v[176:179], v3, s[4:7], s24 offen offset:2048 sc1
  buffer_load_dwordx4 v[180:183], v3, s[4:7], s24 offen offset:3072 sc1
  s_add_u32 s38, s38, 1
  s_mov_b32 s46, 0
  s_call_b64 s[0:1], .fz_kernel_hw
  s_waitcnt vmcnt(0)
  v_min3_u32 v9, v120, v122, v124
  v_min3_u32 v9, v9, v126, v128
  v_min3_u32 v9, v9, v130, v132
  v_min3_u32 v9, v9, v134, v136
  v_min3_u32 v9, v9, v138, v140
  v_min3_u32 v9, v9, v142, v144
  v_min3_u32 v9, v9, v146, v148
  v_min3_u32 v9, v9, v150, v152
  v_min3_u32 v9, v9, v154, v156
  v_min3_u32 v9, v9, v158, v160
  v_min3_u32 v9, v9, v162, v164
  v_min3_u32 v9, v9, v166, v168
  v_min3_u32 v9, v9, v170, v172
  v_min3_u32 v9, v9, v174, v176
  v_min3_u32 v9, v9, v178, v180
  v_min_u32 v9, v9, v182
  v_cmp_eq_u32 vcc, 0, v9
  s_cbranch_vccz .fz_kernel_c_pdd
  s_cmp_lt_u32 s38, 131072
  s_cbranch_scc1 .fz_kernel_c_pd
.fz_kernel_c_pdd:
  v_add_f32 v120, v120, v152
  v_add_f32 v121, v121, v153
  v_add_f32 v122, v122, v154
  v_add_f32 v123, v123, v155
  v_add_f32 v124, v124, v156
  s_cmp_eq_u32 s3, 0
  s_cbranch_scc1 .fz_kernel_hb80
  s_barrier
  s_sub_u32 s3, s3, 1
.fz_kernel_hb80:
  v_add_f32 v125, v125, v157
  v_add_f32 v126, v126, v158
  v_add_f32 v127, v127, v159
  v_add_f32 v128, v128, v160
  v_add_f32 v129, v129, v161
  v_add_f32 v130, v130, v162
  v_add_f32 v131, v131, v163
  v_add_f32 v132, v132, v164
  v_add_f32 v133, v133, v165
  v_add_f32 v134, v134, v166
  v_add_f32 v135, v135, v167
  v_add_f32 v136, v136, v168
  v_add_f32 v137, v137, v169
  v_add_f32 v138, v138, v170
  v_add_f32 v139, v139, v171
  v_add_f32 v140, v140, v172
  v_add_f32 v141, v141, v173
  v_add_f32 v142, v142, v174
  v_add_f32 v143, v143, v175
  v_add_f32 v144, v144, v176
  v_add_f32 v145, v145, v177
  v_add_f32 v146, v146, v178
  v_add_f32 v147, v147, v179
  v_add_f32 v148, v148, v180
  v_add_f32 v149, v149, v181
  v_add_f32 v150, v150, v182
  v_add_f32 v151, v151, v183
  v_add_f32 v120, v120, v136
  v_add_f32 v121, v121, v137
  v_add_f32 v122, v122, v138
  v_add_f32 v123, v123, v139
  v_add_f32 v124, v124, v140
  v_add_f32 v125, v125, v141
  v_add_f32 v126, v126, v142
  v_add_f32 v127, v127, v143
  v_add_f32 v128, v128, v144
  s_cmp_eq_u32 s3, 0
  s_cbranch_scc1 .fz_kernel_hb81
  s_barrier
  s_sub_u32 s3, s3, 1
.fz_kernel_hb81:
  v_add_f32 v129, v129, v145
  v_add_f32 v130, v130, v146
  v_add_f32 v131, v131, v147
  v_add_f32 v132, v132, v148
  v_add_f32 v133, v133, v149
  v_add_f32 v134, v134, v150
  v_add_f32 v135, v135, v151
  v_add_f32 v120, v120, v128
  v_add_f32 v121, v121, v129
  v_add_f32 v122, v122, v130
  v_add_f32 v123, v123, v131
  v_add_f32 v124, v124, v132
  v_add_f32 v125, v125, v133
  v_add_f32 v126, v126, v134
  v_add_f32 v127, v127, v135
  v_add_f32 v120, v120, v124
  v_add_f32 v121, v121, v125
  v_add_f32 v122, v122, v126
  v_add_f32 v123, v123, v127
  s_mov_b64 exec, -1
  v_readlane_b32 s21, v120, 48
  v_readlane_b32 s22, v122, 48
  s_nop 0
  v_mul_f32 v192, s21, v28
  v_fma_f32 v193, s22, v28, v30
  v_fma_f32 v193, -v192, v192, v193
  v_rsq_f32 v193, abs(v193)
  v_sub_f32 v192, v227, v192
  v_mul_f32 v194, v193, v226
  v_mul_f32 v195, v193, v192
  v_cndmask_b32 v240, v240, v194, s[28:29]
  v_cndmask_b32 v241, v241, v194, s[30:31]
  v_cndmask_b32 v242, v242, v195, s[28:29]
  v_cndmask_b32 v243, v243, v195, s[30:31]
  v_mov_b32 v9, 159952
  v_mov_b32 v7, s79
  s_cmp_eq_u32 s3, 0
  s_cbranch_scc1 .fz_kernel_hb82
  s_barrier
  s_sub_u32 s3, s3, 1
.fz_kernel_hb82:
  ds_write_b64 v31, v[240:241] offset:4608
  ds_write_b64 v31, v[242:243] offset:5120
  ds_write_b64 v31, v[244:245] offset:6400
  ds_write_b64 v31, v[246:247] offset:6912
  ds_write_b32 v9, v7
  ds_write_b64 v31, v[196:197] offset:512
  s_mov_b32 exec_hi, 0xffff
  ds_write_b128 v13, v[120:123] offset:1536
  s_mov_b64 exec, -1
  s_waitcnt lgkmcnt(0)
  s_add_u32 s3, s3, 2
.fz_kernel_c_no2:
  s_branch .fz_kernel_q_he
.fz_kernel_c_w7:
  v_lshlrev_b32 v192, 16, v228
  v_and_b32 v193, 0xffff0000, v228
  v_lshlrev_b32 v194, 16, v229
  v_and_b32 v195, 0xffff0000, v229
  v_lshlrev_b32 v196, 16, v230
  v_and_b32 v197, 0xffff0000, v230
  v_lshlrev_b32 v198, 16, v231
  v_and_b32 v199, 0xffff0000, v231
  s_cmp_lg_u32 s71, 0
  s_cbranch_scc1 .fz_kernel_c_eu
  v_add_f32 v232, v232, v192
  v_add_f32 v233, v233, v193
  v_add_f32 v234, v234, v194
  v_add_f32 v235, v235, v195
  v_add_f32 v236, v236, v196
  v_add_f32 v237, v237, v197
  v_add_f32 v238, v238, v198
  v_add_f32 v239, v239, v199
  s_cmp_lg_u32 s75, 0
  s_cbranch_scc1 .fz_kernel_c_t3
  v_mul_f32 v200, v232, v232
  s_cmp_eq_u32 s3, 0
  s_cbranch_scc1 .fz_kernel_hb83
  s_barrier
  s_sub_u32 s3, s3, 1
.fz_kernel_hb83:
  v_add_f32 v202, v232, v233
  v_fmac_f32 v200, v233, v233
  v_fmac_f32 v200, v234, v234
  v_add_f32 v202, v202, v234
  v_fmac_f32 v200, v235, v235
  v_add_f32 v202, v202, v235
  v_fmac_f32 v200, v236, v236
  v_add_f32 v202, v202, v236
  v_fmac_f32 v200, v237, v237
  v_add_f32 v202, v202, v237
  v_fmac_f32 v200, v238, v238
  v_add_f32 v202, v202, v238
  v_fmac_f32 v200, v239, v239
  v_add_f32 v202, v202, v239
  v_lshrrev_b32 v9, 5, v2
  v_lshlrev_b32 v9, 3, v9
  v_permlane32_swap_b32 v202, v200
  v_add_f32 v202, v202, v200
  s_nop 1
  v_add_f32 v202, v202, v202 row_ror:8 row_mask:0xf bank_mask:0xf
  s_nop 1
  v_add_f32 v202, v202, v202 row_bcast:15 row_mask:0xa bank_mask:0xf
  v_or_b32 v202, 1, v202
  s_mov_b32 exec_lo, 0x10000
  s_mov_b32 exec_hi, 0x10000
  buffer_store_dword v202, v9, s[4:7], s27 offen offset:768 sc1
  s_mov_b64 exec, -1
  s_cmp_eq_u32 s79, 0
  s_cbranch_scc1 .fz_kernel_q_he
  s_add_u32 s3, s3, 2
  s_mov_b32 s71, 1
  s_mov_b32 s70, s18
  s_branch .fz_kernel_c_pp
.fz_kernel_c_eu:
  v_lshlrev_b32 v9, 5, v12
  v_add_u32 v9, 155648, v9
  s_mov_b32 exec_lo, 0x01010101
  s_mov_b32 exec_hi, 0x01010101
  ds_write_b128 v9, v[192:195] offset:7424
  ds_write_b128 v9, v[196:199] offset:7440
  s_mov_b64 exec, -1
  s_waitcnt lgkmcnt(0)
  s_branch .fz_kernel_q_he
.fz_kernel_c_t3:
  s_mov_b32 s28, s56
  s_mov_b32 s29, s57
  s_mov_b32 s30, 0x400000
  s_mov_b32 s31, 0x00020000
  s_cmp_eq_u32 s3, 0
  s_cbranch_scc1 .fz_kernel_hb84
  s_barrier
  s_sub_u32 s3, s3, 1
.fz_kernel_hb84:
  v_cvt_pk_bf16_f32 v192, v232, v233
  v_cvt_pk_bf16_f32 v193, v234, v235
  v_cvt_pk_bf16_f32 v194, v236, v237
  v_cvt_pk_bf16_f32 v195, v238, v239
  v_lshlrev_b32 v9, 4, v12
  s_lshl_b32 s21, s77, 11
  s_lshl_b32 s22, s18, 7
  s_add_u32 s21, s21, s22
  s_mov_b32 exec_lo, 0x01010101
  s_mov_b32 exec_hi, 0x01010101
  buffer_store_dwordx4 v[192:195], v9, s[28:31], s21 offen
  s_mov_b64 exec, -1
.fz_kernel_fin:
.fz_kernel_end:
  s_endpgm
.fz_kernel_pick:
  s_mov_b32 s33, 1
  s_cmp_eq_u32 s34, 0xffff
  s_cselect_b32 s35, 0x40000000, s35
  s_cbranch_scc1 .fz_kernel_pick_ret
  s_mov_b64 exec, 1
  s_mov_b32 s38, 0
.fz_kernel_pick_l:
  ds_read_b32 v7, v6
  s_waitcnt lgkmcnt(0)
  v_readfirstlane_b32 s36, v7
  s_andn2_b32 s33, s36, s34
  s_cbranch_scc1 .fz_kernel_pick_out
  ds_wrxchg_rtn_b32 v7, v6, v5 offset:4
  s_waitcnt lgkmcnt(0)
  v_readfirstlane_b32 s33, v7
  s_cmp_lg_u32 s33, 0
  s_cbranch_scc1 .fz_kernel_pick_sl
  buffer_load_dword v7, v4, s[4:7], s37 offen sc1
  s_waitcnt vmcnt(0)
  ds_or_b32 v6, v7
  ds_write_b32 v6, v4 offset:4
  v_readfirstlane_b32 s36, v7
  s_andn2_b32 s33, s36, s34
  s_cbranch_scc1 .fz_kernel_pick_out
.fz_kernel_pick_sl:
  s_sleep 1
  s_add_u32 s38, s38, 1
  s_cmp_lt_u32 s38, 131072
  s_cbranch_scc1 .fz_kernel_pick_l
  s_mov_b32 s36, 0xffff
  s_andn2_b32 s33, s36, s34
.fz_kernel_pick_out:
  s_waitcnt lgkmcnt(0)
  s_mov_b64 exec, -1
.fz_kernel_pick_ret:
  s_nop 4
  s_setpc_b64 s[68:69]
.fz_kernel_hw:
  s_mov_b32 s47, 0
.fz_kernel_hwl:
  s_getreg_b32 s100, hwreg(HW_REG_IB_STS)
  s_bfe_u32 s101, s100, 0x20016
  s_and_b32 s100, s100, 15
  s_lshl4_add_u32 s100, s101, s100
  s_cmp_le_u32 s100, s46
  s_cbranch_scc1 .fz_kernel_hwr
  s_sub_u32 s47, s47, 1
  s_cbranch_scc0 .fz_kernel_hwl
  s_cmp_eq_u32 s3, 0
  s_cbranch_scc1 .fz_kernel_hwr
  s_barrier
  s_sub_u32 s3, s3, 1
  s_mov_b32 s47, 4
  s_branch .fz_kernel_hwl
.fz_kernel_hwr:
  s_setpc_b64 s[0:1]
.fz_kernel_q_cons2:
  s_lshr_b32 s26, s16, 1
  s_lshl_b32 s28, s26, 13
  v_add_u32 v8, s28, v3
  v_add_u32 v9, 1024, v8
  s_branch .fz_kernel_q_cs
.fz_kernel_q_patch:
  s_mul_i32 s31, s27, 384
  s_add_u32 s31, s31, 155648
  v_and_b32 v229, 48, v2
  v_lshlrev_b32 v229, 2, v229
  v_add_u32 v229, s31, v229
  v_and_b32 v231, 15, v2
  v_lshlrev_b32 v231, 3, v231
  v_add_u32 v231, s31, v231
  ds_read_b32 v228, v14 offset:512
  ds_read_b32 v230, v14 offset:576
  ds_read_b32 v232, v14 offset:640
  ds_read_b32 v234, v14 offset:704
  ds_read_b128 v[236:239], v229 offset:1536
  ds_read_b128 v[240:243], v229 offset:1552
  ds_read_b128 v[244:247], v229 offset:1568
  ds_read_b128 v[248:251], v229 offset:1584
  s_waitcnt lgkmcnt(0)
  v_fmac_f32 v160, v238, v228
  v_fmac_f32 v161, v242, v228
  v_fmac_f32 v162, v246, v228
  v_fmac_f32 v163, v250, v228
  v_fmac_f32 v164, v238, v230
  v_fmac_f32 v165, v242, v230
  v_fmac_f32 v166, v246, v230
  v_fmac_f32 v167, v250, v230
  v_fmac_f32 v168, v238, v232
  v_fmac_f32 v169, v242, v232
  v_fmac_f32 v170, v246, v232
  v_fmac_f32 v171, v250, v232
  v_fmac_f32 v172, v238, v234
  v_fmac_f32 v173, v242, v234
  v_fmac_f32 v174, v246, v234
  v_fmac_f32 v175, v250, v234
  v_fmac_f32 v176, v239, v228
  v_fmac_f32 v177, v243, v228
  v_fmac_f32 v178, v247, v228
  v_fmac_f32 v179, v251, v228
  v_fmac_f32 v180, v239, v230
  v_fmac_f32 v181, v243, v230
  v_fmac_f32 v182, v247, v230
  v_fmac_f32 v183, v251, v230
  v_fmac_f32 v184, v239, v232
  v_fmac_f32 v185, v243, v232
  v_fmac_f32 v186, v247, v232
  v_fmac_f32 v187, v251, v232
  v_fmac_f32 v188, v239, v234
  v_fmac_f32 v189, v243, v234
  v_fmac_f32 v190, v247, v234
  v_fmac_f32 v191, v251, v234
  v_fmac_f32 v128, v236, v228
  v_fmac_f32 v129, v240, v228
  v_fmac_f32 v130, v244, v228
  v_fmac_f32 v131, v248, v228
  v_fmac_f32 v132, v236, v230
  v_fmac_f32 v133, v240, v230
  v_fmac_f32 v134, v244, v230
  v_fmac_f32 v135, v248, v230
  v_fmac_f32 v136, v236, v232
  v_fmac_f32 v137, v240, v232
  v_fmac_f32 v138, v244, v232
  v_fmac_f32 v139, v248, v232
  v_fmac_f32 v140, v236, v234
  v_fmac_f32 v141, v240, v234
  v_fmac_f32 v142, v244, v234
  v_fmac_f32 v143, v248, v234
  v_fmac_f32 v144, v237, v228
  v_fmac_f32 v145, v241, v228
  v_fmac_f32 v146, v245, v228
  v_fmac_f32 v147, v249, v228
  v_fmac_f32 v148, v237, v230
  v_fmac_f32 v149, v241, v230
  v_fmac_f32 v150, v245, v230
  v_fmac_f32 v151, v249, v230
  v_fmac_f32 v152, v237, v232
  v_fmac_f32 v153, v241, v232
  v_fmac_f32 v154, v245, v232
  v_fmac_f32 v155, v249, v232
  v_fmac_f32 v156, v237, v234
  v_fmac_f32 v157, v241, v234
  v_fmac_f32 v158, v245, v234
  v_fmac_f32 v159, v249, v234
  ds_read_b128 v[236:239], v15 offset:512
  ds_read_b128 v[240:243], v15 offset:576
  ds_read_b128 v[244:247], v15 offset:640
  ds_read_b128 v[248:251], v15 offset:704
  ds_read_b64 v[228:229], v231 offset:1792
  s_waitcnt lgkmcnt(0)
  v_fmac_f32 v192, v236, v228
  v_fmac_f32 v193, v237, v228
  v_fmac_f32 v194, v238, v228
  v_fmac_f32 v195, v239, v228
  v_fmac_f32 v196, v240, v228
  v_fmac_f32 v197, v241, v228
  v_fmac_f32 v198, v242, v228
  v_fmac_f32 v199, v243, v228
  v_fmac_f32 v200, v244, v228
  v_fmac_f32 v201, v245, v228
  v_fmac_f32 v202, v246, v228
  v_fmac_f32 v203, v247, v228
  v_fmac_f32 v204, v248, v228
  v_fmac_f32 v205, v249, v228
  v_fmac_f32 v206, v250, v228
  v_fmac_f32 v207, v251, v228
  v_fmac_f32 v208, v236, v229
  v_fmac_f32 v209, v237, v229
  v_fmac_f32 v210, v238, v229
  v_fmac_f32 v211, v239, v229
  v_fmac_f32 v212, v240, v229
  v_fmac_f32 v213, v241, v229
  v_fmac_f32 v214, v242, v229
  v_fmac_f32 v215, v243, v229
  v_fmac_f32 v216, v244, v229
  v_fmac_f32 v217, v245, v229
  v_fmac_f32 v218, v246, v229
  v_fmac_f32 v219, v247, v229
  v_fmac_f32 v220, v248, v229
  v_fmac_f32 v221, v249, v229
  v_fmac_f32 v222, v250, v229
  v_fmac_f32 v223, v251, v229
  s_branch .fz_kernel_q_pback
.fz_kernel_q_prod2:
  s_mov_b64 s[8:9], s[4:5]
  s_mov_b64 s[10:11], s[6:7]
  s_lshl_b32 s35, s17, 6
  s_and_b32 s31, s16, 1
  s_add_u32 s35, s35, s31
  s_lshl_b32 s35, s35, 12
  s_add_u32 s35, s35, s73
  s_lshr_b32 s33, s17, 3
  s_add_u32 s29, s18, s33
  s_lshl1_add_u32 s29, s17, s29
  s_and_b32 s29, s29, 15
  s_mov_b32 s22, 16384
  s_mov_b32 s23, 8192
  s_lshl_b32 s36, 1, s18
  s_add_u32 s37, s19, s74
  s_add_u32 s37, s37, 8
  v_mov_b32 v40, v3
  v_mov_b32 v41, v3
  v_mov_b32 v42, v3
  v_mov_b32 v43, v3
  s_branch .fz_kernel_q_pc
.fz_kernel_xok1w:
  s_call_b64 s[68:69], .fz_kernel_q_xw
  s_branch .fz_kernel_xok1
.fz_kernel_q_iw:
  s_mov_b32 m0, s30
  s_add_u32 s30, s30, 12288
  buffer_load_dwordx4 v32, s[12:15], s33 offen offset:0 lds
  s_nop 0
  buffer_load_dwordx4 v33, s[12:15], s33 offen offset:1024 lds
  s_nop 0
  buffer_load_dwordx4 v34, s[12:15], s33 offen offset:2048 lds
  s_nop 0
  buffer_load_dwordx4 v35, s[12:15], s33 offen offset:3072 lds
  s_add_u32 m0, m0, 4096
  s_nop 0
  buffer_load_dwordx4 v36, s[12:15], s33 offen offset:0 lds
  buffer_load_dwordx4 v37, s[12:15], s33 offen offset:1024 lds
  s_add_u32 s33, s33, 196608
  s_cmp_eq_u32 s33, s39
  s_cselect_b32 s33, s32, s33
  s_cmp_eq_u32 s30, s26
  s_cselect_b32 s30, s25, s30
  s_sub_u32 s34, s34, 1
  s_cmp_eq_u32 s34, 0
  s_cselect_b32 s27, -1, s27
  s_cselect_b32 s28, -1, s28
  s_setpc_b64 s[0:1]
.fz_kernel_q_ix:
  s_bfe_u32 s24, s29, 0x40001
  s_mul_i32 s20, s24, s22
  s_bitcmp1_b32 s29, 0
  s_cselect_b32 s31, s23, 0
  s_add_u32 s20, s20, s35
  s_add_u32 s20, s20, s31
  s_bitcmp1_b32 s36, s24
  s_cbranch_scc0 .fz_kernel_xok1w
.fz_kernel_xok1:
  s_mov_b32 m0, s21
  s_add_u32 s21, s21, 8192
  buffer_load_dwordx4 v40, s[8:11], s20 offen offset:0 lds
  buffer_load_dwordx4 v41, s[8:11], s20 offen offset:1024 lds
  buffer_load_dwordx4 v42, s[8:11], s20 offen offset:2048 lds
  buffer_load_dwordx4 v43, s[8:11], s20 offen offset:3072 lds
  s_and_b32 s21, s21, 0xffff
  s_add_u32 s29, s29, 1
  s_setpc_b64 s[0:1]
.fz_kernel_q_xw:
  s_mov_b64 exec, 1
  s_mov_b32 s38, 0
.fz_kernel_q_xwl:
  buffer_load_dword v11, v4, s[4:7], s37 offen sc1
  s_add_u32 s38, s38, 1
  s_waitcnt vmcnt(0)
  v_readfirstlane_b32 s36, v11
  s_bitcmp1_b32 s36, s24
  s_cbranch_scc1 .fz_kernel_q_xwd
  s_cmp_lt_u32 s38, 131072
  s_cbranch_scc1 .fz_kernel_q_xwl
  s_mov_b32 s36, -1
.fz_kernel_q_xwd:
  s_mov_b64 exec, -1
  s_nop 4
  s_setpc_b64 s[68:69]
.fz_kernel_xok2w:
  s_call_b64 s[68:69], .fz_kernel_q_xw
  s_branch .fz_kernel_xok2
.fz_kernel_lz21a:
  v_lshlrev_b32 v16, 3, v2
  buffer_atomic_and_x2 v[12:13], v16, s[4:7], s36 offen offset:0 sc1
  buffer_atomic_and_x2 v[12:13], v16, s[4:7], s36 offen offset:512 sc1
  buffer_atomic_and_x2 v[12:13], v16, s[4:7], s36 offen offset:1024 sc1
  buffer_atomic_and_x2 v[12:13], v16, s[4:7], s36 offen offset:1536 sc1
  buffer_atomic_and_x2 v[12:13], v16, s[4:7], s36 offen offset:2048 sc1
  buffer_atomic_and_x2 v[12:13], v16, s[4:7], s36 offen offset:2560 sc1
  buffer_atomic_and_x2 v[12:13], v16, s[4:7], s36 offen offset:3072 sc1
  buffer_atomic_and_x2 v[12:13], v16, s[4:7], s36 offen offset:3584 sc1
  s_branch .fz_kernel_lz21
.fz_kernel_pk28c:
  s_call_b64 s[68:69], .fz_kernel_pick
  s_branch .fz_kernel_pk28
.fz_kernel_pk29c:
  s_call_b64 s[68:69], .fz_kernel_pick
  s_branch .fz_kernel_pk29
.fz_kernel_pk30c:
  s_call_b64 s[68:69], .fz_kernel_pick
  s_branch .fz_kernel_pk30
.fz_kernel_pk31c:
  s_call_b64 s[68:69], .fz_kernel_pick
  s_branch .fz_kernel_pk31
.fz_kernel_pk32c:
  s_call_b64 s[68:69], .fz_kernel_pick
  s_branch .fz_kernel_pk32
.fz_kernel_pk33c:
  s_call_b64 s[68:69], .fz_kernel_pick
  s_branch .fz_kernel_pk33
.fz_kernel_pk35c:
  s_call_b64 s[68:69], .fz_kernel_pick
  s_branch .fz_kernel_pk35
.fz_kernel_pk36c:
  s_call_b64 s[68:69], .fz_kernel_pick
  s_branch .fz_kernel_pk36
.fz_kernel_pk37c:
  s_call_b64 s[68:69], .fz_kernel_pick
  s_branch .fz_kernel_pk37
.fz_kernel_pk40c:
  s_call_b64 s[68:69], .fz_kernel_pick
  s_branch .fz_kernel_pk40
.fz_kernel_a_t3:
  s_cmp_lg_u32 s32, 3
  s_cbranch_scc1 .fz_kernel_a_t2
  s_mov_b32 s8, s54
  s_mov_b32 s9, s55
  s_mov_b32 s10, 0x700000
  s_mov_b32 s11, 0x00020000
  s_lshl3_add_u32 s12, s17, s16
  s_lshl_b32 s12, s12, 16
  s_lshl_b32 s13, s62, 30
  s_add_u32 s12, s12, s13
  s_and_b32 s12, s12, -4
  v_mov_b32 v15, v13
  s_mov_b32 s13, 0x4000
  s_branch .fz_kernel_a_loop
.fz_kernel_a_t2:
  s_cmp_lg_u32 s32, 2
  s_cbranch_scc1 .fz_kernel_a_t1
  s_mov_b32 s8, s54
  s_mov_b32 s9, s55
  s_mov_b32 s10, 0x0
  s_mov_b32 s11, 0x00020000
  s_mov_b32 s12, 0
  s_mov_b32 s13, 0
  v_mov_b32 v15, 0
  s_branch .fz_kernel_a_loop
.fz_kernel_a_t1:
  s_bitcmp1_b32 s18, 0
  s_cselect_b32 s8, s52, s50
  s_cselect_b32 s9, s53, s51
  s_mov_b32 s10, 0x700000
  s_mov_b32 s11, 0x00020000
  s_lshl_b32 s12, s16, 6
  s_and_b32 s12, s12, 511
  s_and_b32 s31, s18, 2
  s_lshl_b32 s31, s31, 8
  s_add_u32 s12, s12, s31
  s_mul_i32 s12, s12, 7168
  s_lshl_b32 s31, s17, 2
  s_lshr_b32 s33, s18, 2
  s_add_u32 s31, s31, s33
  s_lshl_b32 s31, s31, 7
  s_add_u32 s12, s12, s31
  v_lshrrev_b32 v15, 2, v2
  v_mul_u32_u24 v15, 7168, v15
  v_and_b32 v11, 3, v2
  v_lshl_add_u32 v15, v11, 5, v15
  s_mov_b32 s13, 114688
  s_branch .fz_kernel_a_loop
.fz_kernel_a_cw:
  s_mov_b32 s38, 0
.fz_kernel_a_cwl:
  s_sleep 1
  ds_read_b32 v7, v6 offset:0x100
  s_add_u32 s38, s38, 1
  s_waitcnt lgkmcnt(0)
  v_cmp_gt_u32 vcc, 8, v7
  s_cbranch_vccz .fz_kernel_a_cb
  s_cmp_lt_u32 s38, 524288
  s_cbranch_scc1 .fz_kernel_a_cwl
  s_branch .fz_kernel_a_cb
.fz_kernel_a_slow:
  s_waitcnt vmcnt(0)
  s_lshl_b32 s36, s18, 1
  s_add_u32 s36, s36, s39
  s_lshl_b32 s36, s36, 18
  s_add_u32 s36, s36, s63
  s_mov_b32 s30, s36
  s_mov_b32 s33, 64
  v_mov_b32 v12, 0xff800000
.fz_kernel_a_s1:
  buffer_load_dwordx4 v[184:187], v3, s[4:7], s30 offen offset:0
  buffer_load_dwordx4 v[188:191], v3, s[4:7], s30 offen offset:1024
  s_waitcnt vmcnt(0)
  v_mfma_f32_32x32x16_bf16 v[144:159], v[184:187], v[32:35], 0
  v_mfma_f32_32x32x16_bf16 v[144:159], v[188:191], v[36:39], v[144:159]
  s_nop 11
  v_max3_f32 v12, v12, v144, v145
  v_max3_f32 v12, v12, v146, v147
  v_max3_f32 v12, v12, v148, v149
  v_max3_f32 v12, v12, v150, v151
  v_max3_f32 v12, v12, v152, v153
  v_max3_f32 v12, v12, v154, v155
  v_max3_f32 v12, v12, v156, v157
  v_max3_f32 v12, v12, v158, v159
  s_add_u32 s30, s30, 4096
  s_sub_u32 s33, s33, 1
  s_cmp_lg_u32 s33, 0
  s_cbranch_scc1 .fz_kernel_a_s1
  v_mov_b32 v11, v12
  s_nop 1
  v_permlane32_swap_b32 v11, v12
  v_max_f32 v12, v12, v11
  v_sub_f32 v12, 0, v12
  v_mov_b32 v160, v12
  v_mov_b32 v64, 0
  v_mov_b32 v161, v12
  v_mov_b32 v65, 0
  v_mov_b32 v162, v12
  v_mov_b32 v66, 0
  v_mov_b32 v163, v12
  v_mov_b32 v67, 0
  v_mov_b32 v164, v12
  v_mov_b32 v68, 0
  v_mov_b32 v165, v12
  v_mov_b32 v69, 0
  v_mov_b32 v166, v12
  v_mov_b32 v70, 0
  v_mov_b32 v167, v12
  v_mov_b32 v71, 0
  v_mov_b32 v168, v12
  v_mov_b32 v72, 0
  v_mov_b32 v169, v12
  v_mov_b32 v73, 0
  v_mov_b32 v170, v12
  v_mov_b32 v74, 0
  v_mov_b32 v171, v12
  v_mov_b32 v75, 0
  v_mov_b32 v172, v12
  v_mov_b32 v76, 0
  v_mov_b32 v173, v12
  v_mov_b32 v77, 0
  v_mov_b32 v174, v12
  v_mov_b32 v78, 0
  v_mov_b32 v175, v12
  v_mov_b32 v79, 0
  v_mov_b32 v128, 0
  v_mov_b32 v129, 0
  v_mov_b32 v130, 0
  v_mov_b32 v131, 0
  s_mov_b32 s30, s36
  s_mov_b32 s33, 64
.fz_kernel_a_s2:
  buffer_load_dwordx4 v[184:187], v3, s[4:7], s30 offen offset:0
  buffer_load_dwordx4 v[188:191], v3, s[4:7], s30 offen offset:1024
  buffer_load_dwordx4 v[192:195], v3, s[4:7], s30 offen offset:2048
  buffer_load_dwordx4 v[196:199], v3, s[4:7], s30 offen offset:3072
  s_waitcnt vmcnt(0)
  v_mfma_f32_32x32x16_bf16 v[144:159], v[184:187], v[32:35], v[160:175]
  v_mfma_f32_32x32x16_bf16 v[144:159], v[188:191], v[36:39], v[144:159]
  s_nop 11
  v_exp_f32 v144, v144
  v_exp_f32 v145, v145
  v_exp_f32 v146, v146
  v_exp_f32 v147, v147
  v_exp_f32 v148, v148
  v_exp_f32 v149, v149
  v_exp_f32 v150, v150
  v_exp_f32 v151, v151
  v_exp_f32 v152, v152
  v_exp_f32 v153, v153
  v_exp_f32 v154, v154
  v_exp_f32 v155, v155
  v_exp_f32 v156, v156
  v_exp_f32 v157, v157
  v_exp_f32 v158, v158
  v_exp_f32 v159, v159
  v_cvt_pk_bf16_f32 v176, v144, v145
  v_cvt_pk_bf16_f32 v177, v146, v147
  v_cvt_pk_bf16_f32 v178, v148, v149
  v_cvt_pk_bf16_f32 v179, v150, v151
  v_cvt_pk_bf16_f32 v180, v152, v153
  v_cvt_pk_bf16_f32 v181, v154, v155
  v_cvt_pk_bf16_f32 v182, v156, v157
  v_cvt_pk_bf16_f32 v183, v158, v159
  v_mfma_f32_32x32x16_bf16 v[64:79], v[192:195], v[176:179], v[64:79]
  s_nop 0
  v_mfma_f32_32x32x16_bf16 v[64:79], v[196:199], v[180:183], v[64:79]
  v_smfmac_f32_16x16x64_bf16 v[128:131], v[28:31], v[176:183], v27
  s_add_u32 s30, s30, 4096
  s_sub_u32 s33, s33, 1
  s_cmp_lg_u32 s33, 0
  s_cbranch_scc1 .fz_kernel_a_s2
  s_nop 7
  v_add_f32 v128, v128, v130
  v_add_f32 v129, v129, v131
  v_cndmask_b32 v9, v128, v129, s[34:35]
  s_branch .fz_kernel_a_fin
.fz_kernel_w_ld:
  s_and_b32 s30, s16, 1
  s_mul_i32 s30, s30, 12
  s_add_u32 s31, s30, 104
  s_waitcnt vmcnt(0)
  s_barrier
  s_lshl_b32 s33, s31, 14
  s_lshl_b32 s38, s18, 7
  s_add_u32 s38, s33, s38
  s_lshl_b32 s31, s31, 10
  s_add_u32 m0, s31, 0
  s_add_u32 s33, s38, 0
  buffer_load_dwordx4 v10, s[24:27], s33 offen lds
  s_add_u32 m0, s31, 1024
  s_add_u32 s33, s38, 16384
  buffer_load_dwordx4 v10, s[24:27], s33 offen lds
  s_add_u32 m0, s31, 2048
  s_add_u32 s33, s38, 32768
  buffer_load_dwordx4 v10, s[24:27], s33 offen lds
  s_add_u32 m0, s31, 3072
  s_add_u32 s33, s38, 49152
  buffer_load_dwordx4 v10, s[24:27], s33 offen lds
  s_add_u32 m0, s31, 4096
  s_add_u32 s33, s38, 65536
  buffer_load_dwordx4 v10, s[24:27], s33 offen lds
  s_add_u32 m0, s31, 5120
  s_add_u32 s33, s38, 81920
  buffer_load_dwordx4 v10, s[24:27], s33 offen lds
  s_add_u32 m0, s31, 6144
  s_add_u32 s33, s38, 98304
  buffer_load_dwordx4 v10, s[24:27], s33 offen lds
  s_add_u32 m0, s31, 7168
  s_add_u32 s33, s38, 114688
  buffer_load_dwordx4 v10, s[24:27], s33 offen lds
  s_add_u32 m0, s31, 8192
  s_add_u32 s33, s38, 131072
  buffer_load_dwordx4 v10, s[24:27], s33 offen lds
  s_add_u32 m0, s31, 9216
  s_add_u32 s33, s38, 147456
  buffer_load_dwordx4 v10, s[24:27], s33 offen lds
  s_add_u32 m0, s31, 10240
  s_add_u32 s33, s38, 163840
  buffer_load_dwordx4 v10, s[24:27], s33 offen lds
  s_add_u32 m0, s31, 11264
  s_add_u32 s33, s38, 180224
  buffer_load_dwordx4 v10, s[24:27], s33 offen lds
  s_waitcnt vmcnt(0)
  s_barrier
  s_mov_b32 s72, s66
  s_mov_b32 s73, s65
  s_mov_b32 s74, s67
  s_mov_b32 s75, s62
  s_cmp_lg_u32 s62, 0
  s_cbranch_scc1 .fz_kernel_w_lt
  s_mov_b32 s62, 1
  s_mov_b32 s63, 0x2000000
  s_mov_b32 s64, 0x2800000
  s_mov_b32 s65, 0x1400000
  s_mov_b32 s66, 0x1c42000
  s_mov_b32 s67, 12
  s_mov_b32 s71, 159776
  v_mov_b32 v6, 159832
  s_branch .fz_kernel_q_prod2
.fz_kernel_w_lt:
  s_barrier
  s_barrier
  s_barrier
  s_branch .fz_kernel_fin
.fz_kernel_pk41c:
  s_call_b64 s[68:69], .fz_kernel_pick
  s_branch .fz_kernel_pk41
.fz_kernel_w_pt:
  v_lshlrev_b32 v44, 5, v17
  v_add_u32 v44, 155648, v44
  s_mov_b64 exec, vcc
  ds_read_b128 v[240:243], v44 offset:7424
  ds_read_b128 v[244:247], v44 offset:7440
  ds_read_b128 v[248:251], v44 offset:7488
  ds_read_b128 v[252:255], v44 offset:7504
  s_waitcnt lgkmcnt(0)
  v_pk_add_f32 v[64:65], v[64:65], v[240:241]
  v_pk_add_f32 v[66:67], v[66:67], v[242:243]
  v_pk_add_f32 v[68:69], v[68:69], v[244:245]
  v_pk_add_f32 v[70:71], v[70:71], v[246:247]
  v_pk_add_f32 v[72:73], v[72:73], v[248:249]
  v_pk_add_f32 v[74:75], v[74:75], v[250:251]
  v_pk_add_f32 v[76:77], v[76:77], v[252:253]
  v_pk_add_f32 v[78:79], v[78:79], v[254:255]
  ds_read_b128 v[240:243], v44 offset:7552
  ds_read_b128 v[244:247], v44 offset:7568
  ds_read_b128 v[248:251], v44 offset:7616
  ds_read_b128 v[252:255], v44 offset:7632
  s_waitcnt lgkmcnt(0)
  v_pk_add_f32 v[80:81], v[80:81], v[240:241]
  v_pk_add_f32 v[82:83], v[82:83], v[242:243]
  v_pk_add_f32 v[84:85], v[84:85], v[244:245]
  v_pk_add_f32 v[86:87], v[86:87], v[246:247]
  v_pk_add_f32 v[88:89], v[88:89], v[248:249]
  v_pk_add_f32 v[90:91], v[90:91], v[250:251]
  v_pk_add_f32 v[92:93], v[92:93], v[252:253]
  v_pk_add_f32 v[94:95], v[94:95], v[254:255]
  s_mov_b64 exec, -1
  s_branch .fz_kernel_w_pb
.fz_kernel_pk42c:
  s_call_b64 s[68:69], .fz_kernel_pick
  s_branch .fz_kernel_pk42
.fz_kernel_pk43c:
  s_call_b64 s[68:69], .fz_kernel_pick
  s_branch .fz_kernel_pk43
.fz_kernel_pk44c:
  s_call_b64 s[68:69], .fz_kernel_pick
  s_branch .fz_kernel_pk44
.fz_kernel_pk45c:
  s_call_b64 s[68:69], .fz_kernel_pick
  s_branch .fz_kernel_pk45
.fz_kernel_pk46c:
  s_call_b64 s[68:69], .fz_kernel_pick
  s_branch .fz_kernel_pk46
.fz_kernel_pk47c:
  s_call_b64 s[68:69], .fz_kernel_pick
  s_branch .fz_kernel_pk47
.fz_kernel_pk48c:
  s_call_b64 s[68:69], .fz_kernel_pick
  s_branch .fz_kernel_pk48
.fz_kernel_pk49c:
  s_call_b64 s[68:69], .fz_kernel_pick
  s_branch .fz_kernel_pk49
.fz_kernel_pk50c:
  s_call_b64 s[68:69], .fz_kernel_pick
  s_branch .fz_kernel_pk50
.fz_kernel_pk51c:
  s_call_b64 s[68:69], .fz_kernel_pick
  s_branch .fz_kernel_pk51
.fz_kernel_pk52c:
  s_call_b64 s[68:69], .fz_kernel_pick
  s_branch .fz_kernel_pk52
.fz_kernel_pk53c:
  s_call_b64 s[68:69], .fz_kernel_pick
  s_branch .fz_kernel_pk53
.fz_kernel_pk54c:
  s_call_b64 s[68:69], .fz_kernel_pick
  s_branch .fz_kernel_pk54
.fz_kernel_pk55c:
  s_call_b64 s[68:69], .fz_kernel_pick
  s_branch .fz_kernel_pk55
.fz_kernel_pk56c:
  s_call_b64 s[68:69], .fz_kernel_pick
  s_branch .fz_kernel_pk56
.fz_kernel_c_nl:
  s_waitcnt vmcnt(0)
  s_barrier
  s_barrier
  s_branch .fz_kernel_c_np
.fz_kernel_c_coef:
  v_fma_f32 v254, -v252, v252, v254
  v_fma_f32 v255, -v253, v253, v255
  v_rsq_f32 v240, abs(v254)
  v_rsq_f32 v241, abs(v255)
  v_add_u32 v31, 155648, v16
  v_mul_f32 v246, v252, v240
  v_sub_f32 v246, 0, v246
  v_mov_b32 v244, 1.0
  v_fmac_f32 v244, 0x44800000, v240
  v_fma_f32 v254, v254, v29, -v30
  v_max_f32 v254, 0, v254
  v_mul_f32 v240, v244, v244
  v_fma_f32 v240, v240, v254, v30
  v_rsq_f32 v240, v240
  v_mul_f32 v252, v28, v252
  v_mul_f32 v240, v240, v244
  v_mul_f32 v242, v240, v252
  v_sub_f32 v242, 0, v242
  v_mul_f32 v247, v253, v241
  v_sub_f32 v247, 0, v247
  v_mov_b32 v245, 1.0
  s_cmp_eq_u32 s3, 0
  s_cbranch_scc1 .fz_kernel_hb61
  s_barrier
  s_sub_u32 s3, s3, 1
.fz_kernel_hb61:
  v_fmac_f32 v245, 0x44800000, v241
  v_fma_f32 v255, v255, v29, -v30
  v_max_f32 v255, 0, v255
  v_mul_f32 v241, v245, v245
  v_fma_f32 v241, v241, v255, v30
  v_rsq_f32 v241, v241
  v_mul_f32 v253, v28, v253
  v_mul_f32 v241, v241, v245
  v_mul_f32 v243, v241, v253
  v_sub_f32 v243, 0, v243
  v_lshlrev_b32 v232, 16, v248
  v_and_b32 v233, 0xffff0000, v248
  v_lshlrev_b32 v234, 16, v249
  v_and_b32 v235, 0xffff0000, v249
  v_lshlrev_b32 v236, 16, v250
  v_and_b32 v237, 0xffff0000, v250
  v_lshlrev_b32 v238, 16, v251
  v_and_b32 v239, 0xffff0000, v251
  v_fma_f32 v232, v232, v226, v227
  v_fma_f32 v233, v233, v226, v227
  v_fma_f32 v234, v234, v226, v227
  v_fma_f32 v235, v235, v226, v227
  v_fma_f32 v236, v236, v226, v227
  v_fma_f32 v237, v237, v226, v227
  v_fma_f32 v238, v238, v226, v227
  v_fma_f32 v239, v239, v226, v227
  s_setpc_b64 s[68:69]
.fz_kernel_c_gur:
  v_cmp_eq_u32 s[8:9], 0, v192
  v_cmp_eq_u32 s[10:11], 0, v194
  v_cmp_eq_u32 s[12:13], 0, v196
  v_cmp_eq_u32 s[14:15], 0, v198
  v_cmp_eq_u32 s[22:23], 0, v200
  v_cmp_eq_u32 s[24:25], 0, v202
  v_cmp_eq_u32 s[28:29], 0, v204
  v_cmp_eq_u32 s[30:31], 0, v206
  s_add_u32 s38, s38, 1
  s_cmp_ge_u32 s38, 131072
  s_cbranch_scc1 .fz_kernel_c_gud
  s_or_b64 exec, s[8:9], 1
  buffer_load_dwordx2 v[192:193], v16, s[4:7], s21 offen offset:0 sc1
  s_or_b64 exec, s[10:11], 1
  buffer_load_dwordx2 v[194:195], v16, s[4:7], s21 offen offset:512 sc1
  s_or_b64 exec, s[12:13], 1
  buffer_load_dwordx2 v[196:197], v16, s[4:7], s21 offen offset:1024 sc1
  s_or_b64 exec, s[14:15], 1
  buffer_load_dwordx2 v[198:199], v16, s[4:7], s21 offen offset:1536 sc1
  s_or_b64 exec, s[22:23], 1
  buffer_load_dwordx2 v[200:201], v16, s[4:7], s21 offen offset:2048 sc1
  s_or_b64 exec, s[24:25], 1
  buffer_load_dwordx2 v[202:203], v16, s[4:7], s21 offen offset:2560 sc1
  s_or_b64 exec, s[28:29], 1
  buffer_load_dwordx2 v[204:205], v16, s[4:7], s21 offen offset:3072 sc1
  s_or_b64 exec, s[30:31], 1
  buffer_load_dwordx2 v[206:207], v16, s[4:7], s21 offen offset:3584 sc1
  s_mov_b64 exec, -1
  s_branch .fz_kernel_c_gu
.fz_kernel_c_pur:
  v_min3_u32 v9, v192, v194, v196
  v_min_u32 v9, v9, v198
  v_cmp_eq_u32 s[8:9], 0, v9
  v_min3_u32 v9, v200, v202, v204
  v_min_u32 v9, v9, v206
  v_cmp_eq_u32 s[10:11], 0, v9
  v_min3_u32 v9, v208, v210, v212
  v_min_u32 v9, v9, v214
  v_cmp_eq_u32 s[12:13], 0, v9
  v_min3_u32 v9, v216, v218, v220
  v_min_u32 v9, v9, v222
  v_cmp_eq_u32 s[14:15], 0, v9
  s_cmp_eq_u32 s3, 0
  s_cbranch_scc1 .fz_kernel_hb63
  s_barrier
  s_sub_u32 s3, s3, 1
.fz_kernel_hb63:
  s_add_u32 s38, s38, 1
  s_cmp_ge_u32 s38, 131072
  s_cbranch_scc1 .fz_kernel_c_pud
  s_or_b64 exec, s[8:9], 1
  buffer_load_dwordx4 v[192:195], v10, s[4:7], s21 offen offset:0 sc1
  buffer_load_dwordx4 v[196:199], v10, s[4:7], s21 offen offset:16 sc1
  s_or_b64 exec, s[10:11], 1
  buffer_load_dwordx4 v[200:203], v10, s[4:7], s21 offen offset:2048 sc1
  buffer_load_dwordx4 v[204:207], v10, s[4:7], s21 offen offset:2064 sc1
  s_or_b64 exec, s[12:13], 1
  buffer_load_dwordx4 v[208:211], v10, s[4:7], s22 offen offset:0 sc1
  buffer_load_dwordx4 v[212:215], v10, s[4:7], s22 offen offset:16 sc1
  s_or_b64 exec, s[14:15], 1
  buffer_load_dwordx4 v[216:219], v10, s[4:7], s22 offen offset:2048 sc1
  buffer_load_dwordx4 v[220:223], v10, s[4:7], s22 offen offset:2064 sc1
  s_mov_b64 exec, -1
  s_branch .fz_kernel_c_pu

.section .rodata,"a"
.p2align 6
.amdhsa_kernel fz_kernel
  .amdhsa_next_free_vgpr 256
  .amdhsa_next_free_sgpr 102
  .amdhsa_accum_offset 256
  .amdhsa_group_segment_fixed_size 0
  .amdhsa_kernarg_size 88
  .amdhsa_user_sgpr_count 2
  .amdhsa_user_sgpr_kernarg_segment_ptr 1
  .amdhsa_system_sgpr_workgroup_id_x 1
.end_amdhsa_kernel
```

```asm
; @launch kernel=fz_kernel grid=(256,1,1) block=(512,1,1) lds=163840
.amdgcn_target "amdgcn-amd-amdhsa--gfx950"
.text
.globl fz_kernel
.p2align 8
.type fz_kernel,@function
fz_kernel:
  s_cmp_ge_u32 s2, 256
  s_cbranch_scc1 .fz_kernel_end
  s_load_dwordx16 s[40:55], s[0:1], 0
  s_load_dwordx4 s[56:59], s[0:1], 64
  s_load_dwordx2 s[60:61], s[0:1], 80
  v_lshrrev_b32 v1, 6, v0
  v_and_b32 v2, 63, v0
  v_readfirstlane_b32 s16, v1
  s_and_b32 s21, s2, 7
  s_lshr_b32 s22, s2, 3
  s_and_b32 s23, s21, 3
  s_lshl_b32 s23, s23, 2
  s_and_b32 s24, s22, 3
  s_add_u32 s18, s23, s24
  s_lshr_b32 s24, s21, 2
  s_lshl_b32 s24, s24, 3
  s_lshr_b32 s25, s22, 2
  s_add_u32 s17, s24, s25
  s_lshl_b32 s19, s18, 4
  s_add_u32 s19, s19, s17
  s_lshl_b32 s19, s19, 7
  s_add_u32 s19, s19, 0x1800000
  v_lshlrev_b32 v3, 4, v2
  v_mov_b32 v4, 0
  v_mov_b32 v5, 1
  s_waitcnt lgkmcnt(0)
  s_mov_b32 s4, s60
  s_mov_b32 s5, s61
  s_mov_b32 s6, 0x2c00000
  s_mov_b32 s7, 0x00020000
  s_mov_b32 s62, 0
  s_mov_b32 s63, 0x400000
  s_mov_b32 s64, 0xc00000
  s_mov_b32 s65, 0x1000000
  s_mov_b32 s66, 0x1c00000
  s_mov_b32 s67, 0
  s_mov_b32 s71, 159744
  v_mov_b32 v6, 159808
  s_cmp_lt_u32 s16, 4
  s_cbranch_scc1 .fz_kernel_q_cons1
  s_cmp_ge_u32 s16, 6
  s_cbranch_scc1 .fz_kernel_q_help1
  s_mov_b32 s8, s40
  s_mov_b32 s9, s41
  s_mov_b32 s10, 0x400000
  s_mov_b32 s11, 0x00020000
  v_lshrrev_b32 v20, 3, v2
  v_and_b32 v21, 7, v2
  v_lshrrev_b32 v22, 4, v2
  v_xor_b32 v23, v21, v22
  v_lshlrev_b32 v23, 4, v23
  v_lshl_add_u32 v24, v20, 11, v23
  v_xor_b32 v25, 64, v24
  s_lshl_b32 s35, s17, 2
  s_and_b32 s31, s16, 1
  s_add_u32 s35, s35, s31
  s_lshl_b32 s35, s35, 16
  s_and_b32 s29, s18, 12
  s_lshr_b32 s33, s17, 3
  s_lshl1_add_u32 s29, s33, s29
  s_lshl2_add_u32 s29, s17, s29
  s_and_b32 s29, s29, 15
  s_mov_b32 s22, 128
  s_mov_b32 s23, 131072
  s_mov_b32 s36, -1
  v_add_u32 v40, 0, v24
  v_add_u32 v41, 15360, v25
  v_add_u32 v42, 30720, v24
  v_add_u32 v43, 46080, v25
.fz_kernel_q_pc:
  s_mov_b32 s12, s42
  s_mov_b32 s13, s43
  s_mov_b32 s14, 0x600000
  s_mov_b32 s15, 0x00020000
  v_lshrrev_b32 v28, 3, v2
  v_and_b32 v29, 7, v2
  v_bfe_u32 v30, v2, 4, 1
  v_lshlrev_b32 v30, 1, v30
  v_xor_b32 v31, v29, v30
  v_lshlrev_b32 v31, 4, v31
  v_mul_u32_u24 v28, 6144, v28
  v_add_u32 v28, v28, v31
  v_xor_b32 v29, 64, v28
  s_lshl_b32 s32, s18, 7
  s_add_u32 s39, s32, 6291456
  s_mul_i32 s33, s29, 393216
  s_add_u32 s33, s33, s32
  s_lshl_b32 s29, s29, 1
  s_mul_i32 s25, s31, 6144
  s_add_u32 s25, s25, 65536
  s_mov_b32 s30, s25
  s_add_u32 s26, s25, 49152
  s_lshl_b32 s21, s31, 12
  s_cmp_eq_u32 s31, 0
  s_mov_b32 s24, 100352
  s_cselect_b32 s24, 0, s24
  v_add_u32 v32, s24, v28
  s_mov_b32 s24, 148480
  s_cselect_b32 s24, 48128, s24
  v_add_u32 v33, s24, v29
  s_mov_b32 s24, 2048
  s_cselect_b32 s24, 96256, s24
  v_add_u32 v34, s24, v28
  s_mov_b32 s24, 50176
  s_cselect_b32 s24, 144384, s24
  v_add_u32 v35, s24, v29
  s_mov_b32 s24, 102400
  s_cselect_b32 s24, 2048, s24
  v_add_u32 v36, s24, v28
  s_mov_b32 s24, 150528
  s_cselect_b32 s24, 50176, s24
  v_add_u32 v37, s24, v29
  s_cmp_lg_u32 s62, 0
  s_cbranch_scc1 .fz_kernel_q_st2
  s_mov_b32 s34, 32
  s_call_b64 s[0:1], .fz_kernel_q_ix
  s_call_b64 s[0:1], .fz_kernel_q_iu
  s_waitcnt vmcnt(14)
  s_barrier
  s_call_b64 s[0:1], .fz_kernel_q_iu
  s_call_b64 s[0:1], .fz_kernel_q_iu
  s_call_b64 s[0:1], .fz_kernel_q_iu
  s_waitcnt vmcnt(30)
  s_barrier
  s_branch .fz_kernel_q_pl
.fz_kernel_q_ix:
  s_bfe_u32 s24, s29, 0x40001
  s_mul_i32 s20, s24, s22
  s_bitcmp1_b32 s29, 0
  s_cselect_b32 s31, s23, 0
  s_add_u32 s20, s20, s35
  s_add_u32 s20, s20, s31
  s_bitcmp1_b32 s36, s24
  s_cbranch_scc0 .fz_kernel_xok1w
.fz_kernel_xok1:
  s_mov_b32 m0, s21
  s_add_u32 s21, s21, 8192
  s_and_b32 s21, s21, 0xffff
  s_add_u32 s29, s29, 1
  buffer_load_dwordx4 v40, s[8:11], s20 offen offset:0 lds
  buffer_load_dwordx4 v41, s[8:11], s20 offen offset:1024 lds
  buffer_load_dwordx4 v42, s[8:11], s20 offen offset:2048 lds
  buffer_load_dwordx4 v43, s[8:11], s20 offen offset:3072 lds
  s_setpc_b64 s[0:1]
.fz_kernel_q_iu:
  s_mov_b32 m0, s30
  s_add_u32 s30, s30, 12288
  buffer_load_dwordx4 v32, s[12:15], s33 offen offset:0 lds
  s_bfe_u32 s24, s29, 0x40001
  buffer_load_dwordx4 v33, s[12:15], s33 offen offset:1024 lds
  s_mul_i32 s20, s24, s22
  buffer_load_dwordx4 v34, s[12:15], s33 offen offset:2048 lds
  s_bitcmp1_b32 s29, 0
  s_cselect_b32 s31, s23, 0
  buffer_load_dwordx4 v35, s[12:15], s33 offen offset:3072 lds
  s_add_u32 m0, m0, 4096
  s_add_u32 s20, s20, s35
  buffer_load_dwordx4 v36, s[12:15], s33 offen offset:0 lds
  s_add_u32 s20, s20, s31
  buffer_load_dwordx4 v37, s[12:15], s33 offen offset:1024 lds
  s_bitcmp1_b32 s36, s24
  s_cbranch_scc0 .fz_kernel_xok2w
.fz_kernel_xok2:
  s_mov_b32 m0, s21
  s_add_u32 s21, s21, 8192
  s_and_b32 s21, s21, 0xffff
  s_add_u32 s29, s29, 1
  buffer_load_dwordx4 v40, s[8:11], s20 offen offset:0 lds
  s_add_u32 s33, s33, 196608
  s_cmp_eq_u32 s33, s39
  s_cselect_b32 s33, s32, s33
  buffer_load_dwordx4 v41, s[8:11], s20 offen offset:1024 lds
  s_cmp_eq_u32 s30, s26
  s_cselect_b32 s30, s25, s30
  buffer_load_dwordx4 v42, s[8:11], s20 offen offset:2048 lds
  s_sub_u32 s34, s34, 1
  s_cmp_lg_u32 s34, 0
  buffer_load_dwordx4 v43, s[8:11], s20 offen offset:3072 lds
  s_setpc_b64 s[0:1]
.fz_kernel_q_iw:
  s_mov_b32 m0, s30
  s_add_u32 s30, s30, 12288
  buffer_load_dwordx4 v32, s[12:15], s33 offen offset:0 lds
  s_nop 0
  buffer_load_dwordx4 v33, s[12:15], s33 offen offset:1024 lds
  s_nop 0
  buffer_load_dwordx4 v34, s[12:15], s33 offen offset:2048 lds
  s_nop 0
  buffer_load_dwordx4 v35, s[12:15], s33 offen offset:3072 lds
  s_add_u32 m0, m0, 4096
  s_nop 0
  buffer_load_dwordx4 v36, s[12:15], s33 offen offset:0 lds
  buffer_load_dwordx4 v37, s[12:15], s33 offen offset:1024 lds
  s_add_u32 s33, s33, 196608
  s_cmp_eq_u32 s33, s39
  s_cselect_b32 s33, s32, s33
  s_cmp_eq_u32 s30, s26
  s_cselect_b32 s30, s25, s30
  s_sub_u32 s34, s34, 1
  s_cmp_lg_u32 s34, 0
  s_setpc_b64 s[0:1]
.fz_kernel_q_st2:
  s_mov_b32 s34, 32
  s_waitcnt vmcnt(0)
  s_barrier
  s_call_b64 s[0:1], .fz_kernel_q_iw
  s_call_b64 s[0:1], .fz_kernel_q_iw
  s_call_b64 s[0:1], .fz_kernel_q_iw
  s_waitcnt vmcnt(6)
  s_barrier
  s_call_b64 s[0:1], .fz_kernel_q_iw
  s_call_b64 s[0:1], .fz_kernel_q_ix
  s_call_b64 s[0:1], .fz_kernel_q_ix
  s_call_b64 s[0:1], .fz_kernel_q_ix
  s_call_b64 s[0:1], .fz_kernel_q_ix
  s_waitcnt vmcnt(8)
  s_barrier
  s_waitcnt vmcnt(8)
  s_barrier
  s_call_b64 s[0:1], .fz_kernel_q_ix
  s_call_b64 s[0:1], .fz_kernel_q_iu
  s_waitcnt vmcnt(14)
  s_barrier
  s_call_b64 s[0:1], .fz_kernel_q_iu
  s_waitcnt vmcnt(20)
  s_barrier
  s_call_b64 s[0:1], .fz_kernel_q_iu
.fz_kernel_q_pl:
  s_waitcnt vmcnt(20)
  s_barrier
  s_mov_b32 m0, s30
  s_add_u32 s30, s30, 12288
  buffer_load_dwordx4 v32, s[12:15], s33 offen offset:0 lds
  s_bfe_u32 s24, s29, 0x40001
  buffer_load_dwordx4 v33, s[12:15], s33 offen offset:1024 lds
  s_mul_i32 s20, s24, s22
  buffer_load_dwordx4 v34, s[12:15], s33 offen offset:2048 lds
  s_bitcmp1_b32 s29, 0
  s_cselect_b32 s31, s23, 0
  buffer_load_dwordx4 v35, s[12:15], s33 offen offset:3072 lds
  s_add_u32 m0, m0, 4096
  s_add_u32 s20, s20, s35
  buffer_load_dwordx4 v36, s[12:15], s33 offen offset:0 lds
  s_add_u32 s20, s20, s31
  buffer_load_dwordx4 v37, s[12:15], s33 offen offset:1024 lds
  s_bitcmp1_b32 s36, s24
  s_cbranch_scc0 .fz_kernel_xok3w
.fz_kernel_xok3:
  s_mov_b32 m0, s21
  s_add_u32 s21, s21, 8192
  s_and_b32 s21, s21, 0xffff
  s_add_u32 s29, s29, 1
  buffer_load_dwordx4 v40, s[8:11], s20 offen offset:0 lds
  s_add_u32 s33, s33, 196608
  s_cmp_eq_u32 s33, s39
  s_cselect_b32 s33, s32, s33
  buffer_load_dwordx4 v41, s[8:11], s20 offen offset:1024 lds
  s_cmp_eq_u32 s30, s26
  s_cselect_b32 s30, s25, s30
  buffer_load_dwordx4 v42, s[8:11], s20 offen offset:2048 lds
  s_sub_u32 s34, s34, 1
  s_cmp_lg_u32 s34, 0
  buffer_load_dwordx4 v43, s[8:11], s20 offen offset:3072 lds
  s_cbranch_scc1 .fz_kernel_q_pl
  s_waitcnt vmcnt(20)
  s_barrier
  s_waitcnt vmcnt(10)
  s_barrier
  s_waitcnt vmcnt(0)
  s_barrier
  s_barrier
  s_branch .fz_kernel_serv
.fz_kernel_q_cons1:
  v_lshlrev_b32 v20, 2, v0
  v_add_u32 v20, 159744, v20
  s_cmp_ge_u32 s16, 2
  s_cbranch_scc1 .fz_kernel_q_nz
  ds_write_b32 v20, v4
.fz_kernel_q_nz:
  s_lshr_b32 s26, s16, 1
  s_lshl_b32 s28, s26, 13
  v_and_b32 v20, 15, v2
  v_lshrrev_b32 v21, 4, v2
  v_bfe_u32 v22, v2, 1, 3
  v_xor_b32 v22, v22, v21
  v_lshlrev_b32 v20, 7, v20
  v_lshl_add_u32 v20, v22, 4, v20
  v_add_u32 v8, s28, v20
  v_xor_b32 v9, 64, v8
.fz_kernel_q_cs:
  s_and_b32 s27, s16, 1
  s_lshl_b32 s28, s27, 1
  v_lshrrev_b32 v14, 4, v2
  v_bfe_u32 v15, v2, 2, 2
  v_lshl_add_u32 v16, v14, 3, v15
  v_lshlrev_b32 v16, 7, v16
  v_and_b32 v14, 1, v14
  v_lshrrev_b32 v15, 1, v15
  v_lshl_add_u32 v14, v14, 1, v15
  v_xor_b32 v14, s28, v14
  v_lshl_add_u32 v16, v14, 5, v16
  v_and_b32 v14, 3, v2
  v_lshl_add_u32 v16, v14, 3, v16
  v_add_u32 v12, 65536, v16
  v_xor_b32 v13, 32, v12
  v_mov_b32 v10, v12
  v_mov_b32 v11, v13
  s_mov_b32 s29, 16
  s_mov_b32 s30, 0
  v_mov_b32 v128, 0
  v_mov_b32 v129, 0
  v_mov_b32 v130, 0
  v_mov_b32 v131, 0
  v_mov_b32 v132, 0
  v_mov_b32 v133, 0
  v_mov_b32 v134, 0
  v_mov_b32 v135, 0
  v_mov_b32 v136, 0
  v_mov_b32 v137, 0
  v_mov_b32 v138, 0
  v_mov_b32 v139, 0
  v_mov_b32 v140, 0
  v_mov_b32 v141, 0
  v_mov_b32 v142, 0
  v_mov_b32 v143, 0
  v_mov_b32 v144, 0
  v_mov_b32 v145, 0
  v_mov_b32 v146, 0
  v_mov_b32 v147, 0
  v_mov_b32 v148, 0
  v_mov_b32 v149, 0
  v_mov_b32 v150, 0
  v_mov_b32 v151, 0
  v_mov_b32 v152, 0
  v_mov_b32 v153, 0
  v_mov_b32 v154, 0
  v_mov_b32 v155, 0
  v_mov_b32 v156, 0
  v_mov_b32 v157, 0
  v_mov_b32 v158, 0
  v_mov_b32 v159, 0
  v_mov_b32 v160, 0
  v_mov_b32 v161, 0
  v_mov_b32 v162, 0
  v_mov_b32 v163, 0
  v_mov_b32 v164, 0
  v_mov_b32 v165, 0
  v_mov_b32 v166, 0
  v_mov_b32 v167, 0
  v_mov_b32 v168, 0
  v_mov_b32 v169, 0
  v_mov_b32 v170, 0
  v_mov_b32 v171, 0
  v_mov_b32 v172, 0
  v_mov_b32 v173, 0
  v_mov_b32 v174, 0
  v_mov_b32 v175, 0
  v_mov_b32 v176, 0
  v_mov_b32 v177, 0
  v_mov_b32 v178, 0
  v_mov_b32 v179, 0
  v_mov_b32 v180, 0
  v_mov_b32 v181, 0
  v_mov_b32 v182, 0
  v_mov_b32 v183, 0
  v_mov_b32 v184, 0
  v_mov_b32 v185, 0
  v_mov_b32 v186, 0
  v_mov_b32 v187, 0
  v_mov_b32 v188, 0
  v_mov_b32 v189, 0
  v_mov_b32 v190, 0
  v_mov_b32 v191, 0
  v_mov_b32 v192, 0
  v_mov_b32 v193, 0
  v_mov_b32 v194, 0
  v_mov_b32 v195, 0
  v_mov_b32 v196, 0
  v_mov_b32 v197, 0
  v_mov_b32 v198, 0
  v_mov_b32 v199, 0
  v_mov_b32 v200, 0
  v_mov_b32 v201, 0
  v_mov_b32 v202, 0
  v_mov_b32 v203, 0
  v_mov_b32 v204, 0
  v_mov_b32 v205, 0
  v_mov_b32 v206, 0
  v_mov_b32 v207, 0
  v_mov_b32 v208, 0
  v_mov_b32 v209, 0
  v_mov_b32 v210, 0
  v_mov_b32 v211, 0
  v_mov_b32 v212, 0
  v_mov_b32 v213, 0
  v_mov_b32 v214, 0
  v_mov_b32 v215, 0
  v_mov_b32 v216, 0
  v_mov_b32 v217, 0
  v_mov_b32 v218, 0
  v_mov_b32 v219, 0
  v_mov_b32 v220, 0
  v_mov_b32 v221, 0
  v_mov_b32 v222, 0
  v_mov_b32 v223, 0
  s_waitcnt vmcnt(0) lgkmcnt(0)
  s_barrier
  s_barrier
  ds_read_b64_tr_b16 v[56:57], v10 offset:4096
  ds_read_b64_tr_b16 v[58:59], v10 offset:4608
  ds_read_b128 v[32:35], v8 offset:0
  ds_read_b128 v[36:39], v8 offset:2048
  ds_read_b128 v[40:43], v8 offset:4096
  ds_read_b128 v[44:47], v8 offset:6144
  ds_read_b64_tr_b16 v[60:61], v11 offset:4096
  ds_read_b64_tr_b16 v[62:63], v11 offset:4608
  ds_read_b64_tr_b16 v[64:65], v10 offset:8192
  ds_read_b64_tr_b16 v[66:67], v10 offset:8704
  ds_read_b64_tr_b16 v[68:69], v11 offset:8192
  ds_read_b64_tr_b16 v[70:71], v11 offset:8704
  ds_read_b64_tr_b16 v[48:49], v10 offset:0
  ds_read_b64_tr_b16 v[50:51], v10 offset:512
  ds_read_b64_tr_b16 v[52:53], v11 offset:0
  ds_read_b64_tr_b16 v[54:55], v11 offset:512
  s_add_u32 s30, s30, 12288
  s_cmp_eq_u32 s30, 49152
  s_cselect_b32 s30, 0, s30
  v_add_u32 v8, 0x4000, v8
  v_add_u32 v10, s30, v12
  v_add_u32 v11, s30, v13
  v_and_b32 v8, 0xffff, v8
  s_waitcnt lgkmcnt(0)
  s_branch .fz_kernel_q_l0
  .p2align 6
.fz_kernel_q_loop:
  s_barrier
  v_mfma_f32_16x16x32_bf16 v[160:163], v[96:99], v[72:75], v[160:163]
  ds_read_b64_tr_b16 v[56:57], v10 offset:4096
  v_mfma_f32_16x16x32_bf16 v[164:167], v[96:99], v[76:79], v[164:167]
  ds_read_b64_tr_b16 v[58:59], v10 offset:4608
  v_mfma_f32_16x16x32_bf16 v[168:171], v[96:99], v[80:83], v[168:171]
  ds_read_b128 v[32:35], v8 offset:0
  v_mfma_f32_16x16x32_bf16 v[172:175], v[96:99], v[84:87], v[172:175]
  ds_read_b128 v[36:39], v8 offset:2048
  v_mfma_f32_16x16x32_bf16 v[176:179], v[100:103], v[72:75], v[176:179]
  ds_read_b128 v[40:43], v8 offset:4096
  v_mfma_f32_16x16x32_bf16 v[180:183], v[100:103], v[76:79], v[180:183]
  ds_read_b128 v[44:47], v8 offset:6144
  v_mfma_f32_16x16x32_bf16 v[184:187], v[100:103], v[80:83], v[184:187]
  ds_read_b64_tr_b16 v[60:61], v11 offset:4096
  v_mfma_f32_16x16x32_bf16 v[188:191], v[100:103], v[84:87], v[188:191]
  ds_read_b64_tr_b16 v[62:63], v11 offset:4608
  v_mfma_f32_16x16x32_bf16 v[192:195], v[72:75], v[104:107], v[192:195]
  ds_read_b64_tr_b16 v[64:65], v10 offset:8192
  v_mfma_f32_16x16x32_bf16 v[196:199], v[76:79], v[104:107], v[196:199]
  ds_read_b64_tr_b16 v[66:67], v10 offset:8704
  v_mfma_f32_16x16x32_bf16 v[200:203], v[80:83], v[104:107], v[200:203]
  ds_read_b64_tr_b16 v[68:69], v11 offset:8192
  v_mfma_f32_16x16x32_bf16 v[204:207], v[84:87], v[104:107], v[204:207]
  ds_read_b64_tr_b16 v[70:71], v11 offset:8704
  v_mfma_f32_16x16x32_bf16 v[208:211], v[72:75], v[108:111], v[208:211]
  ds_read_b64_tr_b16 v[48:49], v10 offset:0
  v_mfma_f32_16x16x32_bf16 v[212:215], v[76:79], v[108:111], v[212:215]
  ds_read_b64_tr_b16 v[50:51], v10 offset:512
  v_mfma_f32_16x16x32_bf16 v[216:219], v[80:83], v[108:111], v[216:219]
  ds_read_b64_tr_b16 v[52:53], v11 offset:0
  v_mfma_f32_16x16x32_bf16 v[220:223], v[84:87], v[108:111], v[220:223]
  ds_read_b64_tr_b16 v[54:55], v11 offset:512
  v_mfma_f32_16x16x32_bf16 v[128:131], v[88:91], v[72:75], v[128:131]
  s_add_u32 s30, s30, 12288
  s_cmp_eq_u32 s30, 49152
  s_cselect_b32 s30, 0, s30
  v_add_u32 v8, 0x4000, v8
  v_mfma_f32_16x16x32_bf16 v[132:135], v[88:91], v[76:79], v[132:135]
  v_add_u32 v10, s30, v12
  v_mfma_f32_16x16x32_bf16 v[136:139], v[88:91], v[80:83], v[136:139]
  v_add_u32 v11, s30, v13
  v_mfma_f32_16x16x32_bf16 v[140:143], v[88:91], v[84:87], v[140:143]
  v_and_b32 v8, 0xffff, v8
  v_mfma_f32_16x16x32_bf16 v[144:147], v[92:95], v[72:75], v[144:147]
  v_mfma_f32_16x16x32_bf16 v[148:151], v[92:95], v[76:79], v[148:151]
  v_mfma_f32_16x16x32_bf16 v[152:155], v[92:95], v[80:83], v[152:155]
  v_mfma_f32_16x16x32_bf16 v[156:159], v[92:95], v[84:87], v[156:159]
  s_waitcnt lgkmcnt(0)
.fz_kernel_q_l0:
  s_barrier
  v_mfma_f32_16x16x32_bf16 v[160:163], v[56:59], v[32:35], v[160:163]
  ds_read_b64_tr_b16 v[96:97], v10 offset:4096
  v_mfma_f32_16x16x32_bf16 v[164:167], v[56:59], v[36:39], v[164:167]
  ds_read_b64_tr_b16 v[98:99], v10 offset:4608
  v_mfma_f32_16x16x32_bf16 v[168:171], v[56:59], v[40:43], v[168:171]
  ds_read_b128 v[72:75], v9 offset:0
  v_mfma_f32_16x16x32_bf16 v[172:175], v[56:59], v[44:47], v[172:175]
  ds_read_b128 v[76:79], v9 offset:2048
  v_mfma_f32_16x16x32_bf16 v[176:179], v[60:63], v[32:35], v[176:179]
  ds_read_b128 v[80:83], v9 offset:4096
  v_mfma_f32_16x16x32_bf16 v[180:183], v[60:63], v[36:39], v[180:183]
  ds_read_b128 v[84:87], v9 offset:6144
  v_mfma_f32_16x16x32_bf16 v[184:187], v[60:63], v[40:43], v[184:187]
  ds_read_b64_tr_b16 v[100:101], v11 offset:4096
  v_mfma_f32_16x16x32_bf16 v[188:191], v[60:63], v[44:47], v[188:191]
  ds_read_b64_tr_b16 v[102:103], v11 offset:4608
  v_mfma_f32_16x16x32_bf16 v[192:195], v[32:35], v[64:67], v[192:195]
  ds_read_b64_tr_b16 v[104:105], v10 offset:8192
  v_mfma_f32_16x16x32_bf16 v[196:199], v[36:39], v[64:67], v[196:199]
  ds_read_b64_tr_b16 v[106:107], v10 offset:8704
  v_mfma_f32_16x16x32_bf16 v[200:203], v[40:43], v[64:67], v[200:203]
  ds_read_b64_tr_b16 v[108:109], v11 offset:8192
  v_mfma_f32_16x16x32_bf16 v[204:207], v[44:47], v[64:67], v[204:207]
  ds_read_b64_tr_b16 v[110:111], v11 offset:8704
  v_mfma_f32_16x16x32_bf16 v[208:211], v[32:35], v[68:71], v[208:211]
  ds_read_b64_tr_b16 v[88:89], v10 offset:0
  v_mfma_f32_16x16x32_bf16 v[212:215], v[36:39], v[68:71], v[212:215]
  ds_read_b64_tr_b16 v[90:91], v10 offset:512
  v_mfma_f32_16x16x32_bf16 v[216:219], v[40:43], v[68:71], v[216:219]
  ds_read_b64_tr_b16 v[92:93], v11 offset:0
  v_mfma_f32_16x16x32_bf16 v[220:223], v[44:47], v[68:71], v[220:223]
  ds_read_b64_tr_b16 v[94:95], v11 offset:512
  v_mfma_f32_16x16x32_bf16 v[128:131], v[48:51], v[32:35], v[128:131]
  s_add_u32 s30, s30, 12288
  s_cmp_eq_u32 s30, 49152
  s_cselect_b32 s30, 0, s30
  v_add_u32 v9, 0x4000, v9
  v_mfma_f32_16x16x32_bf16 v[132:135], v[48:51], v[36:39], v[132:135]
  v_add_u32 v10, s30, v12
  v_mfma_f32_16x16x32_bf16 v[136:139], v[48:51], v[40:43], v[136:139]
  v_add_u32 v11, s30, v13
  v_mfma_f32_16x16x32_bf16 v[140:143], v[48:51], v[44:47], v[140:143]
  v_and_b32 v9, 0xffff, v9
  v_mfma_f32_16x16x32_bf16 v[144:147], v[52:55], v[32:35], v[144:147]
  s_sub_u32 s29, s29, 1
  s_cmp_lg_u32 s29, 0
  v_mfma_f32_16x16x32_bf16 v[148:151], v[52:55], v[36:39], v[148:151]
  v_mfma_f32_16x16x32_bf16 v[152:155], v[52:55], v[40:43], v[152:155]
  v_mfma_f32_16x16x32_bf16 v[156:159], v[52:55], v[44:47], v[156:159]
  s_waitcnt lgkmcnt(0)
  s_cbranch_scc1 .fz_kernel_q_loop
  s_barrier
  v_mfma_f32_16x16x32_bf16 v[160:163], v[96:99], v[72:75], v[160:163]
  s_lshl_b32 s31, s26, 8
  s_add_u32 s31, s31, 155648
  v_and_b32 v14, 15, v2
  v_and_b32 v15, 48, v2
  v_mfma_f32_16x16x32_bf16 v[164:167], v[96:99], v[76:79], v[164:167]
  s_lshl_b32 s33, s27, 7
  s_add_u32 s33, s33, 155648
  v_lshlrev_b32 v14, 2, v14
  v_mov_b32 v1, 159952
  v_mfma_f32_16x16x32_bf16 v[168:171], v[96:99], v[80:83], v[168:171]
  v_add_u32 v29, s33, v14
  v_add_u32 v14, s31, v14
  v_mfma_f32_16x16x32_bf16 v[172:175], v[96:99], v[84:87], v[172:175]
  v_add_u32 v28, s33, v15
  v_add_u32 v15, s31, v15
  v_mfma_f32_16x16x32_bf16 v[176:179], v[100:103], v[72:75], v[176:179]
  ds_read_b32 v1, v1
  v_add_u32 v64, 4608, v14
  v_mfma_f32_16x16x32_bf16 v[180:183], v[100:103], v[76:79], v[180:183]
  ds_read_b128 v[120:123], v28 offset:5888
  v_mfma_f32_16x16x32_bf16 v[184:187], v[100:103], v[80:83], v[184:187]
  ds_read_b128 v[124:127], v28 offset:5952
  v_mfma_f32_16x16x32_bf16 v[188:191], v[100:103], v[84:87], v[188:191]
  ds_read2_b32 v[16:17], v64 offset0:0 offset1:128
  v_mfma_f32_16x16x32_bf16 v[192:195], v[72:75], v[104:107], v[192:195]
  ds_read2_b32 v[18:19], v64 offset0:16 offset1:144
  v_mfma_f32_16x16x32_bf16 v[196:199], v[76:79], v[104:107], v[196:199]
  ds_read2_b32 v[20:21], v64 offset0:32 offset1:160
  v_mfma_f32_16x16x32_bf16 v[200:203], v[80:83], v[104:107], v[200:203]
  ds_read2_b32 v[22:23], v64 offset0:48 offset1:176
  v_mfma_f32_16x16x32_bf16 v[204:207], v[84:87], v[104:107], v[204:207]
  ds_read_b32 v24, v29 offset:6144
  v_mfma_f32_16x16x32_bf16 v[208:211], v[72:75], v[108:111], v[208:211]
  ds_read_b32 v26, v29 offset:6208
  v_mfma_f32_16x16x32_bf16 v[212:215], v[76:79], v[108:111], v[212:215]
  ds_read_b128 v[32:35], v15 offset:4608
  ds_read_b128 v[48:51], v15 offset:5120
  v_mfma_f32_16x16x32_bf16 v[216:219], v[80:83], v[108:111], v[216:219]
  ds_read_b128 v[36:39], v15 offset:4672
  ds_read_b128 v[52:55], v15 offset:5184
  v_mfma_f32_16x16x32_bf16 v[220:223], v[84:87], v[108:111], v[220:223]
  ds_read_b128 v[40:43], v15 offset:4736
  ds_read_b128 v[56:59], v15 offset:5248
  v_mfma_f32_16x16x32_bf16 v[128:131], v[88:91], v[72:75], v[128:131]
  ds_read_b128 v[44:47], v15 offset:4800
  ds_read_b128 v[60:63], v15 offset:5312
  v_mfma_f32_16x16x32_bf16 v[132:135], v[88:91], v[76:79], v[132:135]
  ds_read_b128 v[112:115], v28 offset:5632
  ds_read_b128 v[116:119], v28 offset:5696
  v_mfma_f32_16x16x32_bf16 v[136:139], v[88:91], v[80:83], v[136:139]
  s_lshl_b32 s34, s18, 1
  s_add_u32 s34, s34, s27
  s_lshl_b32 s34, s34, 4
  s_add_u32 s34, s34, s17
  v_lshrrev_b32 v30, 3, v2
  v_and_b32 v31, 7, v2
  v_mfma_f32_16x16x32_bf16 v[140:143], v[88:91], v[84:87], v[140:143]
  s_lshl_b32 s34, s34, 1
  s_add_u32 s34, s34, s26
  s_lshl_b32 s36, s34, 13
  s_add_u32 s36, s36, s63
  v_lshlrev_b32 v31, 4, v31
  v_lshl_add_u32 v30, v30, 8, v31
  v_mfma_f32_16x16x32_bf16 v[144:147], v[92:95], v[72:75], v[144:147]
  s_add_u32 s37, s36, 4096
  s_lshl_b32 s34, s27, 1
  s_add_u32 s34, s34, s26
  s_lshl_b32 s35, s34, 13
  v_lshrrev_b32 v224, 4, v2
  v_and_b32 v31, 0xf0, v3
  v_mfma_f32_16x16x32_bf16 v[148:151], v[92:95], v[76:79], v[148:151]
  s_add_u32 s35, s35, 122880
  s_lshl_b32 s34, s34, 12
  s_add_u32 s34, s34, 106496
  v_lshl_add_u32 v31, v224, 9, v31
  v_add_u32 v224, s35, v30
  v_mfma_f32_16x16x32_bf16 v[152:155], v[92:95], v[80:83], v[152:155]
  v_add_u32 v225, s35, v31
  v_add_u32 v226, s34, v31
  v_mfma_f32_16x16x32_bf16 v[156:159], v[92:95], v[84:87], v[156:159]
  s_waitcnt lgkmcnt(12)
  v_cmp_ne_u32 vcc, 0, v1
  s_cbranch_vccnz .fz_kernel_q_patch
.fz_kernel_q_pback:
  v_pk_mul_f32 v[64:65], v[120:121], v[16:17] op_sel:[0,1] op_sel_hi:[1,1]
  v_pk_fma_f32 v[160:161], v[160:161], v[16:17], v[64:65] op_sel_hi:[1,0,1]
  v_pk_mul_f32 v[66:67], v[122:123], v[16:17] op_sel:[0,1] op_sel_hi:[1,1]
  v_pk_fma_f32 v[162:163], v[162:163], v[16:17], v[66:67] op_sel_hi:[1,0,1]
  v_pk_mul_f32 v[68:69], v[124:125], v[16:17] op_sel:[0,1] op_sel_hi:[1,1]
  v_pk_fma_f32 v[176:177], v[176:177], v[16:17], v[68:69] op_sel_hi:[1,0,1]
  v_pk_mul_f32 v[70:71], v[126:127], v[16:17] op_sel:[0,1] op_sel_hi:[1,1]
  v_pk_fma_f32 v[178:179], v[178:179], v[16:17], v[70:71] op_sel_hi:[1,0,1]
  v_cvt_pk_bf16_f32 v160, v160, v161
  v_cvt_pk_bf16_f32 v161, v162, v163
  v_cvt_pk_bf16_f32 v162, v176, v177
  v_cvt_pk_bf16_f32 v163, v178, v179
  buffer_store_dwordx4 v[160:163], v30, s[4:7], s36 offen offset:0 sc1
  ds_write_b128 v224, v[160:163] offset:0
  v_pk_mul_f32 v[64:65], v[120:121], v[18:19] op_sel:[0,1] op_sel_hi:[1,1]
  v_pk_fma_f32 v[164:165], v[164:165], v[18:19], v[64:65] op_sel_hi:[1,0,1]
  v_pk_mul_f32 v[66:67], v[122:123], v[18:19] op_sel:[0,1] op_sel_hi:[1,1]
  v_pk_fma_f32 v[166:167], v[166:167], v[18:19], v[66:67] op_sel_hi:[1,0,1]
  v_pk_mul_f32 v[68:69], v[124:125], v[18:19] op_sel:[0,1] op_sel_hi:[1,1]
  v_pk_fma_f32 v[180:181], v[180:181], v[18:19], v[68:69] op_sel_hi:[1,0,1]
  v_pk_mul_f32 v[70:71], v[126:127], v[18:19] op_sel:[0,1] op_sel_hi:[1,1]
  v_pk_fma_f32 v[182:183], v[182:183], v[18:19], v[70:71] op_sel_hi:[1,0,1]
  v_cvt_pk_bf16_f32 v164, v164, v165
  v_cvt_pk_bf16_f32 v165, v166, v167
  v_cvt_pk_bf16_f32 v166, v180, v181
  v_cvt_pk_bf16_f32 v167, v182, v183
  buffer_store_dwordx4 v[164:167], v30, s[4:7], s36 offen offset:128 sc1
  ds_write_b128 v224, v[164:167] offset:128
  v_pk_mul_f32 v[64:65], v[120:121], v[20:21] op_sel:[0,1] op_sel_hi:[1,1]
  v_pk_fma_f32 v[168:169], v[168:169], v[20:21], v[64:65] op_sel_hi:[1,0,1]
  v_pk_mul_f32 v[66:67], v[122:123], v[20:21] op_sel:[0,1] op_sel_hi:[1,1]
  v_pk_fma_f32 v[170:171], v[170:171], v[20:21], v[66:67] op_sel_hi:[1,0,1]
  v_pk_mul_f32 v[68:69], v[124:125], v[20:21] op_sel:[0,1] op_sel_hi:[1,1]
  v_pk_fma_f32 v[184:185], v[184:185], v[20:21], v[68:69] op_sel_hi:[1,0,1]
  v_pk_mul_f32 v[70:71], v[126:127], v[20:21] op_sel:[0,1] op_sel_hi:[1,1]
  v_pk_fma_f32 v[186:187], v[186:187], v[20:21], v[70:71] op_sel_hi:[1,0,1]
  v_cvt_pk_bf16_f32 v168, v168, v169
  v_cvt_pk_bf16_f32 v169, v170, v171
  v_cvt_pk_bf16_f32 v170, v184, v185
  v_cvt_pk_bf16_f32 v171, v186, v187
  buffer_store_dwordx4 v[168:171], v30, s[4:7], s37 offen offset:0 sc1
  ds_write_b128 v224, v[168:171] offset:4096
  v_pk_mul_f32 v[64:65], v[120:121], v[22:23] op_sel:[0,1] op_sel_hi:[1,1]
  v_pk_fma_f32 v[172:173], v[172:173], v[22:23], v[64:65] op_sel_hi:[1,0,1]
  v_pk_mul_f32 v[66:67], v[122:123], v[22:23] op_sel:[0,1] op_sel_hi:[1,1]
  v_pk_fma_f32 v[174:175], v[174:175], v[22:23], v[66:67] op_sel_hi:[1,0,1]
  v_pk_mul_f32 v[68:69], v[124:125], v[22:23] op_sel:[0,1] op_sel_hi:[1,1]
  v_pk_fma_f32 v[188:189], v[188:189], v[22:23], v[68:69] op_sel_hi:[1,0,1]
  v_pk_mul_f32 v[70:71], v[126:127], v[22:23] op_sel:[0,1] op_sel_hi:[1,1]
  v_pk_fma_f32 v[190:191], v[190:191], v[22:23], v[70:71] op_sel_hi:[1,0,1]
  v_cvt_pk_bf16_f32 v172, v172, v173
  v_cvt_pk_bf16_f32 v173, v174, v175
  v_cvt_pk_bf16_f32 v174, v188, v189
  v_cvt_pk_bf16_f32 v175, v190, v191
  buffer_store_dwordx4 v[172:175], v30, s[4:7], s37 offen offset:128 sc1
  ds_write_b128 v224, v[172:175] offset:4224
  s_waitcnt lgkmcnt(4)
  v_pk_mul_f32 v[64:65], v[48:49], v[24:25] op_sel_hi:[1,0]
  v_pk_fma_f32 v[192:193], v[192:193], v[32:33], v[64:65]
  v_pk_mul_f32 v[66:67], v[50:51], v[24:25] op_sel_hi:[1,0]
  v_pk_fma_f32 v[194:195], v[194:195], v[34:35], v[66:67]
  v_pk_mul_f32 v[68:69], v[52:53], v[24:25] op_sel_hi:[1,0]
  v_pk_fma_f32 v[196:197], v[196:197], v[36:37], v[68:69]
  v_pk_mul_f32 v[70:71], v[54:55], v[24:25] op_sel_hi:[1,0]
  v_pk_fma_f32 v[198:199], v[198:199], v[38:39], v[70:71]
  v_cvt_pk_bf16_f32 v192, v192, v193
  v_cvt_pk_bf16_f32 v193, v194, v195
  v_cvt_pk_bf16_f32 v194, v196, v197
  v_cvt_pk_bf16_f32 v195, v198, v199
  buffer_store_dwordx4 v[192:195], v31, s[4:7], s36 offen offset:2048 sc1
  ds_write_b128 v225, v[192:195] offset:2048
  v_pk_mul_f32 v[64:65], v[48:49], v[26:27] op_sel_hi:[1,0]
  v_pk_fma_f32 v[208:209], v[208:209], v[32:33], v[64:65]
  v_pk_mul_f32 v[66:67], v[50:51], v[26:27] op_sel_hi:[1,0]
  v_pk_fma_f32 v[210:211], v[210:211], v[34:35], v[66:67]
  v_pk_mul_f32 v[68:69], v[52:53], v[26:27] op_sel_hi:[1,0]
  v_pk_fma_f32 v[212:213], v[212:213], v[36:37], v[68:69]
  v_pk_mul_f32 v[70:71], v[54:55], v[26:27] op_sel_hi:[1,0]
  v_pk_fma_f32 v[214:215], v[214:215], v[38:39], v[70:71]
  v_cvt_pk_bf16_f32 v208, v208, v209
  v_cvt_pk_bf16_f32 v209, v210, v211
  v_cvt_pk_bf16_f32 v210, v212, v213
  v_cvt_pk_bf16_f32 v211, v214, v215
  buffer_store_dwordx4 v[208:211], v31, s[4:7], s36 offen offset:2304 sc1
  ds_write_b128 v225, v[208:211] offset:2304
  v_pk_mul_f32 v[64:65], v[56:57], v[24:25] op_sel_hi:[1,0]
  v_pk_fma_f32 v[200:201], v[200:201], v[40:41], v[64:65]
  v_pk_mul_f32 v[66:67], v[58:59], v[24:25] op_sel_hi:[1,0]
  v_pk_fma_f32 v[202:203], v[202:203], v[42:43], v[66:67]
  v_pk_mul_f32 v[68:69], v[60:61], v[24:25] op_sel_hi:[1,0]
  v_pk_fma_f32 v[204:205], v[204:205], v[44:45], v[68:69]
  v_pk_mul_f32 v[70:71], v[62:63], v[24:25] op_sel_hi:[1,0]
  v_pk_fma_f32 v[206:207], v[206:207], v[46:47], v[70:71]
  v_cvt_pk_bf16_f32 v200, v200, v201
  v_cvt_pk_bf16_f32 v201, v202, v203
  v_cvt_pk_bf16_f32 v202, v204, v205
  v_cvt_pk_bf16_f32 v203, v206, v207
  buffer_store_dwordx4 v[200:203], v31, s[4:7], s37 offen offset:2048 sc1
  ds_write_b128 v225, v[200:203] offset:6144
  v_pk_mul_f32 v[64:65], v[56:57], v[26:27] op_sel_hi:[1,0]
  v_pk_fma_f32 v[216:217], v[216:217], v[40:41], v[64:65]
  v_pk_mul_f32 v[66:67], v[58:59], v[26:27] op_sel_hi:[1,0]
  v_pk_fma_f32 v[218:219], v[218:219], v[42:43], v[66:67]
  v_pk_mul_f32 v[68:69], v[60:61], v[26:27] op_sel_hi:[1,0]
  v_pk_fma_f32 v[220:221], v[220:221], v[44:45], v[68:69]
  v_pk_mul_f32 v[70:71], v[62:63], v[26:27] op_sel_hi:[1,0]
  v_pk_fma_f32 v[222:223], v[222:223], v[46:47], v[70:71]
  v_cvt_pk_bf16_f32 v216, v216, v217
  v_cvt_pk_bf16_f32 v217, v218, v219
  v_cvt_pk_bf16_f32 v218, v220, v221
  v_cvt_pk_bf16_f32 v219, v222, v223
  buffer_store_dwordx4 v[216:219], v31, s[4:7], s37 offen offset:2304 sc1
  ds_write_b128 v225, v[216:219] offset:6400
  v_mul_f32 v16, 0.25503486164919736, v16
  v_mul_f32 v17, 0.25503486164919736, v17
  v_mul_f32 v18, 0.25503486164919736, v18
  v_mul_f32 v19, 0.25503486164919736, v19
  v_mul_f32 v20, 0.25503486164919736, v20
  v_mul_f32 v21, 0.25503486164919736, v21
  v_mul_f32 v22, 0.25503486164919736, v22
  v_mul_f32 v23, 0.25503486164919736, v23
  v_pk_mul_f32 v[64:65], v[112:113], v[16:17] op_sel:[0,1] op_sel_hi:[1,1]
  v_pk_fma_f32 v[128:129], v[128:129], v[16:17], v[64:65] op_sel_hi:[1,0,1]
  v_pk_mul_f32 v[66:67], v[114:115], v[16:17] op_sel:[0,1] op_sel_hi:[1,1]
  v_pk_fma_f32 v[130:131], v[130:131], v[16:17], v[66:67] op_sel_hi:[1,0,1]
  v_pk_mul_f32 v[68:69], v[116:117], v[16:17] op_sel:[0,1] op_sel_hi:[1,1]
  v_pk_fma_f32 v[144:145], v[144:145], v[16:17], v[68:69] op_sel_hi:[1,0,1]
  v_pk_mul_f32 v[70:71], v[118:119], v[16:17] op_sel:[0,1] op_sel_hi:[1,1]
  v_pk_fma_f32 v[146:147], v[146:147], v[16:17], v[70:71] op_sel_hi:[1,0,1]
  v_cvt_pk_bf16_f32 v128, v128, v129
  v_cvt_pk_bf16_f32 v129, v130, v131
  v_cvt_pk_bf16_f32 v130, v144, v145
  v_cvt_pk_bf16_f32 v131, v146, v147
  ds_write_b128 v226, v[128:131] offset:0
  v_pk_mul_f32 v[64:65], v[112:113], v[18:19] op_sel:[0,1] op_sel_hi:[1,1]
  v_pk_fma_f32 v[132:133], v[132:133], v[18:19], v[64:65] op_sel_hi:[1,0,1]
  v_pk_mul_f32 v[66:67], v[114:115], v[18:19] op_sel:[0,1] op_sel_hi:[1,1]
  v_pk_fma_f32 v[134:135], v[134:135], v[18:19], v[66:67] op_sel_hi:[1,0,1]
  v_pk_mul_f32 v[68:69], v[116:117], v[18:19] op_sel:[0,1] op_sel_hi:[1,1]
  v_pk_fma_f32 v[148:149], v[148:149], v[18:19], v[68:69] op_sel_hi:[1,0,1]
  v_pk_mul_f32 v[70:71], v[118:119], v[18:19] op_sel:[0,1] op_sel_hi:[1,1]
  v_pk_fma_f32 v[150:151], v[150:151], v[18:19], v[70:71] op_sel_hi:[1,0,1]
  v_cvt_pk_bf16_f32 v132, v132, v133
  v_cvt_pk_bf16_f32 v133, v134, v135
  v_cvt_pk_bf16_f32 v134, v148, v149
  v_cvt_pk_bf16_f32 v135, v150, v151
  ds_write_b128 v226, v[132:135] offset:256
  v_pk_mul_f32 v[64:65], v[112:113], v[20:21] op_sel:[0,1] op_sel_hi:[1,1]
  v_pk_fma_f32 v[136:137], v[136:137], v[20:21], v[64:65] op_sel_hi:[1,0,1]
  v_pk_mul_f32 v[66:67], v[114:115], v[20:21] op_sel:[0,1] op_sel_hi:[1,1]
  v_pk_fma_f32 v[138:139], v[138:139], v[20:21], v[66:67] op_sel_hi:[1,0,1]
  v_pk_mul_f32 v[68:69], v[116:117], v[20:21] op_sel:[0,1] op_sel_hi:[1,1]
  v_pk_fma_f32 v[152:153], v[152:153], v[20:21], v[68:69] op_sel_hi:[1,0,1]
  v_pk_mul_f32 v[70:71], v[118:119], v[20:21] op_sel:[0,1] op_sel_hi:[1,1]
  v_pk_fma_f32 v[154:155], v[154:155], v[20:21], v[70:71] op_sel_hi:[1,0,1]
  v_cvt_pk_bf16_f32 v136, v136, v137
  v_cvt_pk_bf16_f32 v137, v138, v139
  v_cvt_pk_bf16_f32 v138, v152, v153
  v_cvt_pk_bf16_f32 v139, v154, v155
  ds_write_b128 v226, v[136:139] offset:2048
  v_pk_mul_f32 v[64:65], v[112:113], v[22:23] op_sel:[0,1] op_sel_hi:[1,1]
  v_pk_fma_f32 v[140:141], v[140:141], v[22:23], v[64:65] op_sel_hi:[1,0,1]
  v_pk_mul_f32 v[66:67], v[114:115], v[22:23] op_sel:[0,1] op_sel_hi:[1,1]
  v_pk_fma_f32 v[142:143], v[142:143], v[22:23], v[66:67] op_sel_hi:[1,0,1]
  v_pk_mul_f32 v[68:69], v[116:117], v[22:23] op_sel:[0,1] op_sel_hi:[1,1]
  v_pk_fma_f32 v[156:157], v[156:157], v[22:23], v[68:69] op_sel_hi:[1,0,1]
  v_pk_mul_f32 v[70:71], v[118:119], v[22:23] op_sel:[0,1] op_sel_hi:[1,1]
  v_pk_fma_f32 v[158:159], v[158:159], v[22:23], v[70:71] op_sel_hi:[1,0,1]
  v_cvt_pk_bf16_f32 v140, v140, v141
  v_cvt_pk_bf16_f32 v141, v142, v143
  v_cvt_pk_bf16_f32 v142, v156, v157
  v_cvt_pk_bf16_f32 v143, v158, v159
  ds_write_b128 v226, v[140:143] offset:2304
  s_waitcnt lgkmcnt(0)
  s_barrier
  s_branch .fz_kernel_att
.fz_kernel_q_help1:
  s_mov_b32 s3, 32
  s_cmp_eq_u32 s16, 7
  s_cbranch_scc1 .fz_kernel_q_h7
  s_getpc_b64 s[0:1]
.fz_kernel_ct4:
  s_sub_u32 s0, s0, .fz_kernel_ct4-fz_kernel
  s_subb_u32 s1, s1, 0
  s_lshr_b32 s31, s2, 3
  s_mulk_i32 s31, 0x500
  v_lshl_add_u32 v1, v2, 7, s31
  v_min_u32 v1, .fz_kernel_last-fz_kernel, v1
  s_mov_b64 exec, 0x3ff
  global_load_dword v1, v1, s[0:1]
  s_mov_b64 exec, -1
.fz_kernel_ct4e:
  s_mov_b32 s12, s58
  s_mov_b32 s13, s59
  s_mov_b32 s14, 0x100
  s_mov_b32 s15, 0x00020000
  s_and_b32 s31, s18, 3
  s_lshl_b32 s30, s31, 14
  v_and_b32 v20, 15, v2
  v_lshrrev_b32 v21, 4, v2
  v_bfe_u32 v22, v2, 1, 3
  v_xor_b32 v22, v22, v21
  v_lshlrev_b32 v21, 7, v20
  v_lshl_add_u32 v21, v22, 4, v21
  v_add_u32 v21, s30, v21
  v_xor_b32 v22, 64, v21
  v_lshlrev_b32 v20, 3, v20
  s_lshl_b32 s30, s17, 4
  s_add_u32 s30, s30, s18
  s_lshl_b32 s30, s30, 10
  s_add_u32 s30, s30, 0x1880000
  s_mov_b32 s34, 0x00f0000f
  s_mov_b32 s35, 0xf0000f00
  v_mov_b32 v24, 0x3f803f80
  v_mov_b32 v25, v24
  v_mov_b32 v26, v24
  v_mov_b32 v27, v24
  s_lshl_b32 s31, s31, 1
  s_sub_u32 s31, 31, s31
  s_barrier
.fz_kernel_xs5:
  s_barrier
  s_sub_u32 s3, s3, 1
  s_cmp_lg_u32 s3, s31
  s_cbranch_scc1 .fz_kernel_xs5
  ds_read_b128 v[64:67], v21 offset:0
  ds_read_b128 v[72:75], v21 offset:2048
  ds_read_b128 v[80:83], v21 offset:4096
  ds_read_b128 v[88:91], v21 offset:6144
  ds_read_b128 v[96:99], v21 offset:8192
  ds_read_b128 v[104:107], v21 offset:10240
  ds_read_b128 v[112:115], v21 offset:12288
  ds_read_b128 v[120:123], v21 offset:14336
  ds_read_b128 v[68:71], v22 offset:0
  ds_read_b128 v[76:79], v22 offset:2048
  ds_read_b128 v[84:87], v22 offset:4096
  ds_read_b128 v[92:95], v22 offset:6144
  ds_read_b128 v[100:103], v22 offset:8192
  ds_read_b128 v[108:111], v22 offset:10240
  ds_read_b128 v[116:119], v22 offset:12288
  ds_read_b128 v[124:127], v22 offset:14336
  s_waitcnt lgkmcnt(0)
  s_cmp_eq_u32 s3, 0
  s_cbranch_scc1 .fz_kernel_hb6
  s_barrier
  s_sub_u32 s3, s3, 1
.fz_kernel_hb6:
  s_setprio 2
  v_mfma_f32_16x16x32_bf16 v[128:131], v[24:27], v[64:67], 0
  v_mfma_f32_16x16x32_bf16 v[160:163], v[64:67], v[64:67], 0
  v_mfma_f32_16x16x32_bf16 v[132:135], v[24:27], v[72:75], 0
  v_mfma_f32_16x16x32_bf16 v[164:167], v[72:75], v[72:75], 0
  v_mfma_f32_16x16x32_bf16 v[136:139], v[24:27], v[80:83], 0
  v_mfma_f32_16x16x32_bf16 v[168:171], v[80:83], v[80:83], 0
  v_mfma_f32_16x16x32_bf16 v[140:143], v[24:27], v[88:91], 0
  v_mfma_f32_16x16x32_bf16 v[172:175], v[88:91], v[88:91], 0
  v_mfma_f32_16x16x32_bf16 v[144:147], v[24:27], v[96:99], 0
  v_mfma_f32_16x16x32_bf16 v[176:179], v[96:99], v[96:99], 0
  v_mfma_f32_16x16x32_bf16 v[148:151], v[24:27], v[104:107], 0
  v_mfma_f32_16x16x32_bf16 v[180:183], v[104:107], v[104:107], 0
  v_mfma_f32_16x16x32_bf16 v[152:155], v[24:27], v[112:115], 0
  v_mfma_f32_16x16x32_bf16 v[184:187], v[112:115], v[112:115], 0
  v_mfma_f32_16x16x32_bf16 v[156:159], v[24:27], v[120:123], 0
  v_mfma_f32_16x16x32_bf16 v[188:191], v[120:123], v[120:123], 0
  v_mfma_f32_16x16x32_bf16 v[128:131], v[24:27], v[68:71], v[128:131]
  v_mfma_f32_16x16x32_bf16 v[160:163], v[68:71], v[68:71], v[160:163]
  v_mfma_f32_16x16x32_bf16 v[132:135], v[24:27], v[76:79], v[132:135]
  v_mfma_f32_16x16x32_bf16 v[164:167], v[76:79], v[76:79], v[164:167]
  v_mfma_f32_16x16x32_bf16 v[136:139], v[24:27], v[84:87], v[136:139]
  v_mfma_f32_16x16x32_bf16 v[168:171], v[84:87], v[84:87], v[168:171]
  v_mfma_f32_16x16x32_bf16 v[140:143], v[24:27], v[92:95], v[140:143]
  v_mfma_f32_16x16x32_bf16 v[172:175], v[92:95], v[92:95], v[172:175]
  v_mfma_f32_16x16x32_bf16 v[144:147], v[24:27], v[100:103], v[144:147]
  v_mfma_f32_16x16x32_bf16 v[176:179], v[100:103], v[100:103], v[176:179]
  v_mfma_f32_16x16x32_bf16 v[148:151], v[24:27], v[108:111], v[148:151]
  v_mfma_f32_16x16x32_bf16 v[180:183], v[108:111], v[108:111], v[180:183]
  v_mfma_f32_16x16x32_bf16 v[152:155], v[24:27], v[116:119], v[152:155]
  v_mfma_f32_16x16x32_bf16 v[184:187], v[116:119], v[116:119], v[184:187]
  v_mfma_f32_16x16x32_bf16 v[156:159], v[24:27], v[124:127], v[156:159]
  v_mfma_f32_16x16x32_bf16 v[188:191], v[124:127], v[124:127], v[188:191]
  s_setprio 0
  s_cmp_eq_u32 s3, 0
  s_cbranch_scc1 .fz_kernel_hb7
  s_barrier
  s_sub_u32 s3, s3, 1
.fz_kernel_hb7:
  s_mov_b32 exec_lo, 0x11111111
  s_mov_b32 exec_hi, 0x11111111
  v_mov_b32 v129, v160
  v_mov_b32 v133, v164
  v_mov_b32 v137, v168
  v_mov_b32 v141, v172
  v_mov_b32 v145, v176
  v_mov_b32 v149, v180
  v_mov_b32 v153, v184
  v_mov_b32 v157, v188
  s_mov_b32 exec_lo, 0x22222222
  s_mov_b32 exec_hi, 0x22222222
  v_mov_b32 v129, v161
  v_mov_b32 v133, v165
  v_mov_b32 v137, v169
  v_mov_b32 v141, v173
  v_mov_b32 v145, v177
  v_mov_b32 v149, v181
  v_mov_b32 v153, v185
  v_mov_b32 v157, v189
  s_mov_b32 exec_lo, 0x44444444
  s_mov_b32 exec_hi, 0x44444444
  v_mov_b32 v129, v162
  v_mov_b32 v133, v166
  v_mov_b32 v137, v170
  v_mov_b32 v141, v174
  v_mov_b32 v145, v178
  v_mov_b32 v149, v182
  v_mov_b32 v153, v186
  v_mov_b32 v157, v190
  s_mov_b32 exec_lo, 0x88888888
  s_mov_b32 exec_hi, 0x88888888
  v_mov_b32 v129, v163
  v_mov_b32 v133, v167
  v_mov_b32 v137, v171
  v_mov_b32 v141, v175
  v_mov_b32 v145, v179
  v_mov_b32 v149, v183
  v_mov_b32 v153, v187
  v_mov_b32 v157, v191
  s_cmp_eq_u32 s3, 0
  s_cbranch_scc1 .fz_kernel_hb8
  s_barrier
  s_sub_u32 s3, s3, 1
.fz_kernel_hb8:
  s_mov_b64 exec, s[34:35]
  buffer_store_dwordx2 v[128:129], v20, s[4:7], s30 offen offset:0 sc1
  buffer_store_dwordx2 v[132:133], v20, s[4:7], s30 offen offset:128 sc1
  buffer_store_dwordx2 v[136:137], v20, s[4:7], s30 offen offset:256 sc1
  buffer_store_dwordx2 v[140:141], v20, s[4:7], s30 offen offset:384 sc1
  buffer_store_dwordx2 v[144:145], v20, s[4:7], s30 offen offset:512 sc1
  buffer_store_dwordx2 v[148:149], v20, s[4:7], s30 offen offset:640 sc1
  buffer_store_dwordx2 v[152:153], v20, s[4:7], s30 offen offset:768 sc1
  buffer_store_dwordx2 v[156:157], v20, s[4:7], s30 offen offset:896 sc1
  buffer_load_dword v9, v4, s[12:15], 0 offen sc1
  s_mov_b64 exec, 1
  s_mov_b32 s38, 0
.fz_kernel_pw9:
  s_mov_b32 s46, 0
  s_call_b64 s[0:1], .fz_kernel_hw
  s_waitcnt vmcnt(0)
  v_readfirstlane_b32 s31, v9
  s_cmp_eq_u32 s31, 32
  s_cbranch_scc1 .fz_kernel_pw9d
  s_cmp_eq_u32 s3, 0
  s_cbranch_scc1 .fz_kernel_hb10
  s_barrier
  s_sub_u32 s3, s3, 1
.fz_kernel_hb10:
  s_cmp_eq_u32 s3, 0
  s_cbranch_scc1 .fz_kernel_hb11
  s_barrier
  s_sub_u32 s3, s3, 1
.fz_kernel_hb11:
  buffer_load_dword v9, v4, s[12:15], 0 offen sc1
  s_add_u32 s38, s38, 1
  s_cmp_lt_u32 s38, 131072
  s_cbranch_scc1 .fz_kernel_pw9
  s_waitcnt vmcnt(0)
.fz_kernel_pw9d:
  s_mov_b64 exec, -1
  v_lshlrev_b32 v7, 11, v2
  s_lshl_b32 s31, s17, 7
  s_lshl_b32 s33, 1, s18
  s_add_u32 s31, s31, s67
  s_add_u32 s31, s31, 0x1800018
  v_mov_b32 v8, s33
  s_mov_b64 exec, 0xffff
  buffer_atomic_or v8, v7, s[4:7], s31 offen sc1
  s_mov_b64 exec, -1
  s_mov_b32 s20, s48
  s_mov_b32 s21, s49
  s_mov_b32 s22, 0x800
  s_mov_b32 s23, 0x00020000
  v_lshlrev_b32 v20, 5, v2
  buffer_load_dwordx4 v[24:27], v20, s[20:23], 0 offen
  buffer_load_dwordx4 v[28:31], v20, s[20:23], 0 offen offset:16
  v_mov_b32 v20, 0
  s_mov_b32 s46, 0
  s_call_b64 s[0:1], .fz_kernel_hw
  s_waitcnt vmcnt(0)
  v_lshlrev_b32 v21, 16, v24
  v_and_b32 v22, 0xffff0000, v24
  v_add_f32 v20, v20, v21
  v_add_f32 v20, v20, v22
  v_lshlrev_b32 v21, 16, v25
  v_and_b32 v22, 0xffff0000, v25
  v_add_f32 v20, v20, v21
  v_add_f32 v20, v20, v22
  v_lshlrev_b32 v21, 16, v26
  v_and_b32 v22, 0xffff0000, v26
  v_add_f32 v20, v20, v21
  v_add_f32 v20, v20, v22
  v_lshlrev_b32 v21, 16, v27
  v_and_b32 v22, 0xffff0000, v27
  v_add_f32 v20, v20, v21
  v_add_f32 v20, v20, v22
  v_lshlrev_b32 v21, 16, v28
  v_and_b32 v22, 0xffff0000, v28
  v_add_f32 v20, v20, v21
  v_add_f32 v20, v20, v22
  v_lshlrev_b32 v21, 16, v29
  v_and_b32 v22, 0xffff0000, v29
  v_add_f32 v20, v20, v21
  v_add_f32 v20, v20, v22
  v_lshlrev_b32 v21, 16, v30
  v_and_b32 v22, 0xffff0000, v30
  v_add_f32 v20, v20, v21
  v_add_f32 v20, v20, v22
  v_lshlrev_b32 v21, 16, v31
  v_and_b32 v22, 0xffff0000, v31
  v_add_f32 v20, v20, v21
  v_add_f32 v20, v20, v22
  s_nop 1
  v_add_f32 v20, v20, v20 quad_perm:[1,0,3,2] row_mask:0xf bank_mask:0xf
  s_nop 1
  v_add_f32 v20, v20, v20 quad_perm:[2,3,0,1] row_mask:0xf bank_mask:0xf
  s_nop 1
  v_add_f32 v20, v20, v20 row_half_mirror row_mask:0xf bank_mask:0xf
  s_nop 1
  v_add_f32 v20, v20, v20 row_mirror row_mask:0xf bank_mask:0xf
  s_nop 0
  v_readlane_b32 s20, v20, 16
  v_readlane_b32 s21, v20, 32
  v_readlane_b32 s22, v20, 48
  v_add_f32 v20, s20, v20
  v_add_f32 v20, s21, v20
  v_add_f32 v20, s22, v20
  v_mul_f32 v20, 0x3a800000, v20
  s_nop 0
  v_readfirstlane_b32 s76, v20
  s_add_u32 s37, s19, 24
  v_mov_b32 v9, 0
  s_mov_b64 exec, 1
  s_mov_b32 s38, 0
.fz_kernel_pw12:
  s_mov_b32 s46, 0
  s_call_b64 s[0:1], .fz_kernel_hw
  s_waitcnt vmcnt(0)
  v_readfirstlane_b32 s31, v9
  s_cmp_eq_u32 s31, 65535
  s_cbranch_scc1 .fz_kernel_pw12d
  s_cmp_eq_u32 s3, 0
  s_cbranch_scc1 .fz_kernel_hb13
  s_barrier
  s_sub_u32 s3, s3, 1
.fz_kernel_hb13:
  s_cmp_eq_u32 s3, 0
  s_cbranch_scc1 .fz_kernel_hb14
  s_barrier
  s_sub_u32 s3, s3, 1
.fz_kernel_hb14:
  buffer_load_dword v9, v4, s[4:7], s37 offen sc1
  s_add_u32 s38, s38, 1
  s_cmp_lt_u32 s38, 131072
  s_cbranch_scc1 .fz_kernel_pw12
  s_waitcnt vmcnt(0)
.fz_kernel_pw12d:
  s_mov_b64 exec, -1
  s_lshl_b32 s30, s17, 14
  s_add_u32 s30, s30, 0x1880000
  buffer_load_dwordx4 v[64:67], v3, s[4:7], s30 offen offset:0
  buffer_load_dwordx4 v[68:71], v3, s[4:7], s30 offen offset:1024
  buffer_load_dwordx4 v[72:75], v3, s[4:7], s30 offen offset:2048
  buffer_load_dwordx4 v[76:79], v3, s[4:7], s30 offen offset:3072
  s_add_u32 s30, s30, 4096
  buffer_load_dwordx4 v[80:83], v3, s[4:7], s30 offen offset:0
  buffer_load_dwordx4 v[84:87], v3, s[4:7], s30 offen offset:1024
  buffer_load_dwordx4 v[88:91], v3, s[4:7], s30 offen offset:2048
  buffer_load_dwordx4 v[92:95], v3, s[4:7], s30 offen offset:3072
  s_add_u32 s30, s30, 4096
  buffer_load_dwordx4 v[96:99], v3, s[4:7], s30 offen offset:0
  buffer_load_dwordx4 v[100:103], v3, s[4:7], s30 offen offset:1024
  buffer_load_dwordx4 v[104:107], v3, s[4:7], s30 offen offset:2048
  buffer_load_dwordx4 v[108:111], v3, s[4:7], s30 offen offset:3072
  s_add_u32 s30, s30, 4096
  buffer_load_dwordx4 v[112:115], v3, s[4:7], s30 offen offset:0
  buffer_load_dwordx4 v[116:119], v3, s[4:7], s30 offen offset:1024
  buffer_load_dwordx4 v[120:123], v3, s[4:7], s30 offen offset:2048
  buffer_load_dwordx4 v[124:127], v3, s[4:7], s30 offen offset:3072
  s_add_u32 s30, s30, 4096
  s_mov_b32 s46, 0
  s_call_b64 s[0:1], .fz_kernel_hw
  s_waitcnt vmcnt(0)
  v_add_f32 v64, v64, v68
  v_add_f32 v65, v65, v69
  v_add_f32 v66, v66, v70
  v_add_f32 v67, v67, v71
  v_add_f32 v64, v64, v72
  v_add_f32 v65, v65, v73
  v_add_f32 v66, v66, v74
  v_add_f32 v67, v67, v75
  v_add_f32 v64, v64, v76
  v_add_f32 v65, v65, v77
  v_add_f32 v66, v66, v78
  v_add_f32 v67, v67, v79
  s_cmp_eq_u32 s3, 0
  s_cbranch_scc1 .fz_kernel_hb15
  s_barrier
  s_sub_u32 s3, s3, 1
.fz_kernel_hb15:
  v_add_f32 v64, v64, v80
  v_add_f32 v65, v65, v81
  v_add_f32 v66, v66, v82
  v_add_f32 v67, v67, v83
  v_add_f32 v64, v64, v84
  v_add_f32 v65, v65, v85
  v_add_f32 v66, v66, v86
  v_add_f32 v67, v67, v87
  v_add_f32 v64, v64, v88
  v_add_f32 v65, v65, v89
  v_add_f32 v66, v66, v90
  v_add_f32 v67, v67, v91
  v_add_f32 v64, v64, v92
  v_add_f32 v65, v65, v93
  v_add_f32 v66, v66, v94
  v_add_f32 v67, v67, v95
  v_add_f32 v64, v64, v96
  v_add_f32 v65, v65, v97
  v_add_f32 v66, v66, v98
  v_add_f32 v67, v67, v99
  v_add_f32 v64, v64, v100
  v_add_f32 v65, v65, v101
  v_add_f32 v66, v66, v102
  v_add_f32 v67, v67, v103
  v_add_f32 v64, v64, v104
  v_add_f32 v65, v65, v105
  v_add_f32 v66, v66, v106
  v_add_f32 v67, v67, v107
  s_cmp_eq_u32 s3, 0
  s_cbranch_scc1 .fz_kernel_hb16
  s_barrier
  s_sub_u32 s3, s3, 1
.fz_kernel_hb16:
  v_add_f32 v64, v64, v108
  v_add_f32 v65, v65, v109
  v_add_f32 v66, v66, v110
  v_add_f32 v67, v67, v111
  v_add_f32 v64, v64, v112
  v_add_f32 v65, v65, v113
  v_add_f32 v66, v66, v114
  v_add_f32 v67, v67, v115
  v_add_f32 v64, v64, v116
  v_add_f32 v65, v65, v117
  v_add_f32 v66, v66, v118
  v_add_f32 v67, v67, v119
  v_add_f32 v64, v64, v120
  v_add_f32 v65, v65, v121
  v_add_f32 v66, v66, v122
  v_add_f32 v67, v67, v123
  v_add_f32 v64, v64, v124
  v_add_f32 v65, v65, v125
  v_add_f32 v66, v66, v126
  v_add_f32 v67, v67, v127
  s_cmp_eq_u32 s3, 0
  s_cbranch_scc1 .fz_kernel_hb17
  s_barrier
  s_sub_u32 s3, s3, 1
.fz_kernel_hb17:
  v_mov_b32 v26, 0.0009765625
  v_mul_f32 v20, v26, v64
  v_mul_f32 v27, v20, v20
  v_fma_f32 v22, v65, v26, -v27
  v_max_f32 v22, 0, v22
  v_add_f32 v22, 1e-05, v22
  v_rsq_f32 v22, v22
  s_nop 0
  v_mul_f32 v20, v20, v22
  v_sub_f32 v20, 0, v20
  v_mul_f32 v21, v26, v66
  v_mul_f32 v27, v21, v21
  v_fma_f32 v23, v67, v26, -v27
  v_max_f32 v23, 0, v23
  v_add_f32 v23, 1e-05, v23
  v_rsq_f32 v23, v23
  s_nop 0
  v_mul_f32 v21, v21, v23
  v_sub_f32 v21, 0, v21
  v_lshlrev_b32 v24, 3, v2
  v_add_u32 v24, 155648, v24
  ds_write_b64 v24, v[22:23] offset:4608
  ds_write_b64 v24, v[20:21] offset:5120
  v_mov_b32 v20, 1.0
  v_mov_b32 v21, 1.0
  v_mov_b32 v22, 0
  v_mov_b32 v23, 0
  ds_write_b64 v24, v[20:21] offset:6400
  ds_write_b64 v24, v[22:23] offset:6912
  v_mov_b32 v24, 159952
  v_mov_b32 v25, s76
  ds_write_b32 v24, v25 offset:8
  s_waitcnt lgkmcnt(0)
.fz_kernel_q_hw2:
  s_add_u32 s3, s3, 2
.fz_kernel_q_he:
  s_cmp_eq_u32 s3, 0
  s_cbranch_scc1 .fz_kernel_chain
  s_barrier
  s_sub_u32 s3, s3, 1
  s_branch .fz_kernel_q_he
.fz_kernel_q_h7:
  s_mov_b32 s8, s58
  s_mov_b32 s9, s59
  s_mov_b32 s10, 0x100
  s_mov_b32 s11, 0x00020000
  v_mov_b32 v12, 0
  v_mov_b32 v13, 0
  v_mov_b32 v14, 0
  v_mov_b32 v15, 0
  s_cmp_ge_u32 s2, 32
  s_cbranch_scc1 .fz_kernel_q_nzero
  s_lshl_b32 s36, s2, 10
  s_add_u32 s36, s36, 0x1800000
  buffer_store_dwordx4 v[12:15], v3, s[4:7], s36 offen sc1
.fz_kernel_q_nzero:
  v_and_b32 v21, 7, v2
  v_and_b32 v20, 16, v2
  v_lshlrev_b32 v20, 1, v20
  v_xor_b32 v20, v20, v3
  s_bfe_u32 s33, s17, 0x10002
  s_lshl_b32 s33, s33, 1
  s_mul_i32 s31, s33, 12288
  s_add_u32 s31, s31, 65536
  v_add_u32 v16, s31, v20
  v_xor_b32 v17, 64, v16
  s_add_u32 s31, s31, 12288
  s_cmp_eq_u32 s33, 6
  s_cselect_b32 s31, 65536, s31
  v_add_u32 v18, s31, v20
  v_xor_b32 v19, 64, v18
  s_sub_u32 s33, 31, s33
  v_lshlrev_b32 v21, 5, v21
  v_and_b32 v22, 16, v2
  v_add_u32 v21, v22, v21
  s_lshl_b32 s30, s18, 4
  s_add_u32 s30, s30, s17
  s_mul_i32 s30, s30, 768
  s_add_u32 s30, s30, 0x18c0000
  v_and_b32 v22, 1, v2
  v_lshlrev_b32 v22, 4, v22
  v_mov_b32 v23, 0x3f80
  v_lshlrev_b32 v22, v22, v23
  v_mov_b32 v24, 0
  v_mov_b32 v25, 0
  v_mov_b32 v26, 0
  v_mov_b32 v27, 0
  s_mov_b32 exec_lo, 0x30003
  s_mov_b32 exec_hi, 0x30003
  v_mov_b32 v24, v22
  s_mov_b32 exec_lo, 0xc000c
  s_mov_b32 exec_hi, 0xc000c
  v_mov_b32 v25, v22
  s_mov_b32 exec_lo, 0x300030
  s_mov_b32 exec_hi, 0x300030
  v_mov_b32 v26, v22
  s_mov_b32 exec_lo, 0xc000c0
  s_mov_b32 exec_hi, 0xc000c0
  v_mov_b32 v27, v22
  s_mov_b64 exec, -1
  s_barrier
  s_cmp_ge_u32 s2, 32
  s_cbranch_scc1 .fz_kernel_nz2
  s_mov_b64 exec, 1
  s_waitcnt vmcnt(0)
  buffer_atomic_add v5, v4, s[8:11], 0 offen sc1
  s_mov_b64 exec, -1
.fz_kernel_nz2:
  s_barrier
  s_sub_u32 s3, s3, 1
  s_cmp_lg_u32 s3, s33
  s_cbranch_scc1 .fz_kernel_nz2
  ds_read_b128 v[64:67], v16 offset:0
  ds_read_b128 v[68:71], v16 offset:4096
  ds_read_b128 v[72:75], v16 offset:8192
  ds_read_b128 v[76:79], v17 offset:1024
  ds_read_b128 v[80:83], v17 offset:5120
  ds_read_b128 v[84:87], v17 offset:9216
  ds_read_b128 v[88:91], v16 offset:2048
  ds_read_b128 v[92:95], v16 offset:6144
  ds_read_b128 v[96:99], v16 offset:10240
  ds_read_b128 v[100:103], v17 offset:3072
  ds_read_b128 v[104:107], v17 offset:7168
  ds_read_b128 v[108:111], v17 offset:11264
  s_waitcnt lgkmcnt(0)
  s_cmp_eq_u32 s3, 0
  s_cbranch_scc1 .fz_kernel_hb18
  s_barrier
  s_sub_u32 s3, s3, 1
.fz_kernel_hb18:
  ds_read_b128 v[112:115], v18 offset:0
  ds_read_b128 v[116:119], v18 offset:4096
  ds_read_b128 v[120:123], v18 offset:8192
  ds_read_b128 v[124:127], v19 offset:1024
  ds_read_b128 v[128:131], v19 offset:5120
  ds_read_b128 v[132:135], v19 offset:9216
  ds_read_b128 v[136:139], v18 offset:2048
  ds_read_b128 v[140:143], v18 offset:6144
  ds_read_b128 v[144:147], v18 offset:10240
  ds_read_b128 v[148:151], v19 offset:3072
  ds_read_b128 v[152:155], v19 offset:7168
  ds_read_b128 v[156:159], v19 offset:11264
  s_waitcnt lgkmcnt(0)
  s_cmp_eq_u32 s3, 0
  s_cbranch_scc1 .fz_kernel_hb19
  s_barrier
  s_sub_u32 s3, s3, 1
.fz_kernel_hb19:
  s_setprio 2
  v_mfma_f32_16x16x32_bf16 v[160:163], v[24:27], v[64:67], 0
  v_mfma_f32_16x16x32_bf16 v[164:167], v[24:27], v[68:71], 0
  v_mfma_f32_16x16x32_bf16 v[168:171], v[24:27], v[72:75], 0
  v_mfma_f32_16x16x32_bf16 v[160:163], v[24:27], v[76:79], v[160:163]
  v_mfma_f32_16x16x32_bf16 v[164:167], v[24:27], v[80:83], v[164:167]
  v_mfma_f32_16x16x32_bf16 v[168:171], v[24:27], v[84:87], v[168:171]
  v_mfma_f32_16x16x32_bf16 v[160:163], v[24:27], v[88:91], v[160:163]
  v_mfma_f32_16x16x32_bf16 v[164:167], v[24:27], v[92:95], v[164:167]
  v_mfma_f32_16x16x32_bf16 v[168:171], v[24:27], v[96:99], v[168:171]
  v_mfma_f32_16x16x32_bf16 v[160:163], v[24:27], v[100:103], v[160:163]
  v_mfma_f32_16x16x32_bf16 v[164:167], v[24:27], v[104:107], v[164:167]
  v_mfma_f32_16x16x32_bf16 v[168:171], v[24:27], v[108:111], v[168:171]
  v_mfma_f32_16x16x32_bf16 v[160:163], v[24:27], v[112:115], v[160:163]
  v_mfma_f32_16x16x32_bf16 v[164:167], v[24:27], v[116:119], v[164:167]
  v_mfma_f32_16x16x32_bf16 v[168:171], v[24:27], v[120:123], v[168:171]
  v_mfma_f32_16x16x32_bf16 v[160:163], v[24:27], v[124:127], v[160:163]
  v_mfma_f32_16x16x32_bf16 v[164:167], v[24:27], v[128:131], v[164:167]
  v_mfma_f32_16x16x32_bf16 v[168:171], v[24:27], v[132:135], v[168:171]
  v_mfma_f32_16x16x32_bf16 v[160:163], v[24:27], v[136:139], v[160:163]
  v_mfma_f32_16x16x32_bf16 v[164:167], v[24:27], v[140:143], v[164:167]
  v_mfma_f32_16x16x32_bf16 v[168:171], v[24:27], v[144:147], v[168:171]
  v_mfma_f32_16x16x32_bf16 v[160:163], v[24:27], v[148:151], v[160:163]
  v_mfma_f32_16x16x32_bf16 v[164:167], v[24:27], v[152:155], v[164:167]
  v_mfma_f32_16x16x32_bf16 v[168:171], v[24:27], v[156:159], v[168:171]
  s_setprio 0
  s_nop 4
  v_add_f32 v160, v160, v160 row_ror:8 row_mask:0xf bank_mask:0xf
  v_add_f32 v161, v161, v161 row_ror:8 row_mask:0xf bank_mask:0xf
  v_add_f32 v162, v162, v162 row_ror:8 row_mask:0xf bank_mask:0xf
  v_add_f32 v163, v163, v163 row_ror:8 row_mask:0xf bank_mask:0xf
  v_add_f32 v164, v164, v164 row_ror:8 row_mask:0xf bank_mask:0xf
  v_add_f32 v165, v165, v165 row_ror:8 row_mask:0xf bank_mask:0xf
  v_add_f32 v166, v166, v166 row_ror:8 row_mask:0xf bank_mask:0xf
  v_add_f32 v167, v167, v167 row_ror:8 row_mask:0xf bank_mask:0xf
  v_add_f32 v168, v168, v168 row_ror:8 row_mask:0xf bank_mask:0xf
  v_add_f32 v169, v169, v169 row_ror:8 row_mask:0xf bank_mask:0xf
  v_add_f32 v170, v170, v170 row_ror:8 row_mask:0xf bank_mask:0xf
  v_add_f32 v171, v171, v171 row_ror:8 row_mask:0xf bank_mask:0xf
  s_mov_b64 exec, 0x00ff00ff
  buffer_store_dwordx4 v[160:163], v21, s[4:7], s30 offen offset:0 sc1
  buffer_store_dwordx4 v[164:167], v21, s[4:7], s30 offen offset:256 sc1
  buffer_store_dwordx4 v[168:171], v21, s[4:7], s30 offen offset:512 sc1
  buffer_load_dword v9, v4, s[8:11], 0 offen sc1
  s_mov_b64 exec, 1
  s_mov_b32 s38, 0
.fz_kernel_pw20:
  s_mov_b32 s46, 0
  s_call_b64 s[0:1], .fz_kernel_hw
  s_waitcnt vmcnt(0)
  v_readfirstlane_b32 s31, v9
  s_cmp_eq_u32 s31, 32
  s_cbranch_scc1 .fz_kernel_pw20d
  s_cmp_eq_u32 s3, 0
  s_cbranch_scc1 .fz_kernel_hb21
  s_barrier
  s_sub_u32 s3, s3, 1
.fz_kernel_hb21:
  s_cmp_eq_u32 s3, 0
  s_cbranch_scc1 .fz_kernel_hb22
  s_barrier
  s_sub_u32 s3, s3, 1
.fz_kernel_hb22:
  buffer_load_dword v9, v4, s[8:11], 0 offen sc1
  s_add_u32 s38, s38, 1
  s_cmp_lt_u32 s38, 131072
  s_cbranch_scc1 .fz_kernel_pw20
  s_waitcnt vmcnt(0)
.fz_kernel_pw20d:
  s_mov_b64 exec, -1
  v_lshlrev_b32 v7, 7, v2
  s_lshl_b32 s31, s18, 11
  s_lshl_b32 s33, 1, s17
  s_add_u32 s31, s31, s67
  s_add_u32 s31, s31, 0x180001c
  v_mov_b32 v8, s33
  s_mov_b64 exec, 0xffff
  buffer_atomic_or v8, v7, s[4:7], s31 offen sc1
  s_mov_b64 exec, -1
  s_cmp_ge_u32 s2, 196
  s_cbranch_scc1 .fz_kernel_lz23
  s_lshl_b32 s36, s2, 12
  s_add_u32 s36, s36, 0x1c00000
  s_sub_u32 s31, s2, 66
  s_min_u32 s31, s31, s2
  s_sub_u32 s31, s31, 4
  s_cmp_lt_u32 s31, 6
  s_cbranch_scc1 .fz_kernel_lz23a
  buffer_store_dwordx4 v[12:15], v3, s[4:7], s36 offen sc1
  buffer_store_dwordx4 v[12:15], v3, s[4:7], s36 offen offset:1024 sc1
  buffer_store_dwordx4 v[12:15], v3, s[4:7], s36 offen offset:2048 sc1
  buffer_store_dwordx4 v[12:15], v3, s[4:7], s36 offen offset:3072 sc1
.fz_kernel_lz23:
  s_add_u32 s37, s19, 28
  v_mov_b32 v9, 0
  s_mov_b64 exec, 1
  s_mov_b32 s38, 0
.fz_kernel_pw24:
  s_mov_b32 s46, 0
  s_call_b64 s[0:1], .fz_kernel_hw
  s_waitcnt vmcnt(0)
  v_readfirstlane_b32 s31, v9
  s_cmp_eq_u32 s31, 65535
  s_cbranch_scc1 .fz_kernel_pw24d
  s_cmp_eq_u32 s3, 0
  s_cbranch_scc1 .fz_kernel_hb25
  s_barrier
  s_sub_u32 s3, s3, 1
.fz_kernel_hb25:
  s_cmp_eq_u32 s3, 0
  s_cbranch_scc1 .fz_kernel_hb26
  s_barrier
  s_sub_u32 s3, s3, 1
.fz_kernel_hb26:
  buffer_load_dword v9, v4, s[4:7], s37 offen sc1
  s_add_u32 s38, s38, 1
  s_cmp_lt_u32 s38, 131072
  s_cbranch_scc1 .fz_kernel_pw24
  s_waitcnt vmcnt(0)
.fz_kernel_pw24d:
  s_mov_b64 exec, -1
  s_mul_i32 s30, s18, 12288
  s_add_u32 s30, s30, 0x18c0000
  buffer_load_dwordx4 v[64:67], v3, s[4:7], s30 offen offset:0
  buffer_load_dwordx4 v[68:71], v3, s[4:7], s30 offen offset:768
  buffer_load_dwordx4 v[72:75], v3, s[4:7], s30 offen offset:1536
  buffer_load_dwordx4 v[76:79], v3, s[4:7], s30 offen offset:2304
  s_add_u32 s30, s30, 3072
  buffer_load_dwordx4 v[80:83], v3, s[4:7], s30 offen offset:0
  buffer_load_dwordx4 v[84:87], v3, s[4:7], s30 offen offset:768
  buffer_load_dwordx4 v[88:91], v3, s[4:7], s30 offen offset:1536
  buffer_load_dwordx4 v[92:95], v3, s[4:7], s30 offen offset:2304
  s_add_u32 s30, s30, 3072
  buffer_load_dwordx4 v[96:99], v3, s[4:7], s30 offen offset:0
  buffer_load_dwordx4 v[100:103], v3, s[4:7], s30 offen offset:768
  buffer_load_dwordx4 v[104:107], v3, s[4:7], s30 offen offset:1536
  buffer_load_dwordx4 v[108:111], v3, s[4:7], s30 offen offset:2304
  s_add_u32 s30, s30, 3072
  buffer_load_dwordx4 v[112:115], v3, s[4:7], s30 offen offset:0
  buffer_load_dwordx4 v[116:119], v3, s[4:7], s30 offen offset:768
  buffer_load_dwordx4 v[120:123], v3, s[4:7], s30 offen offset:1536
  buffer_load_dwordx4 v[124:127], v3, s[4:7], s30 offen offset:2304
  s_add_u32 s30, s30, 3072
  s_mov_b32 s46, 0
  s_call_b64 s[0:1], .fz_kernel_hw
  s_waitcnt vmcnt(0)
  v_add_f32 v64, v64, v68
  v_add_f32 v65, v65, v69
  v_add_f32 v66, v66, v70
  v_add_f32 v67, v67, v71
  v_add_f32 v64, v64, v72
  v_add_f32 v65, v65, v73
  v_add_f32 v66, v66, v74
  v_add_f32 v67, v67, v75
  v_add_f32 v64, v64, v76
  v_add_f32 v65, v65, v77
  v_add_f32 v66, v66, v78
  v_add_f32 v67, v67, v79
  s_cmp_eq_u32 s3, 0
  s_cbranch_scc1 .fz_kernel_hb27
  s_barrier
  s_sub_u32 s3, s3, 1
.fz_kernel_hb27:
  v_add_f32 v64, v64, v80
  v_add_f32 v65, v65, v81
  v_add_f32 v66, v66, v82
  v_add_f32 v67, v67, v83
  v_add_f32 v64, v64, v84
  v_add_f32 v65, v65, v85
  v_add_f32 v66, v66, v86
  v_add_f32 v67, v67, v87
  v_add_f32 v64, v64, v88
  v_add_f32 v65, v65, v89
  v_add_f32 v66, v66, v90
  v_add_f32 v67, v67, v91
  v_add_f32 v64, v64, v92
  v_add_f32 v65, v65, v93
  v_add_f32 v66, v66, v94
  v_add_f32 v67, v67, v95
  v_add_f32 v64, v64, v96
  v_add_f32 v65, v65, v97
  v_add_f32 v66, v66, v98
  v_add_f32 v67, v67, v99
  v_add_f32 v64, v64, v100
  v_add_f32 v65, v65, v101
  v_add_f32 v66, v66, v102
  v_add_f32 v67, v67, v103
  v_add_f32 v64, v64, v104
  v_add_f32 v65, v65, v105
  v_add_f32 v66, v66, v106
  v_add_f32 v67, v67, v107
  s_cmp_eq_u32 s3, 0
  s_cbranch_scc1 .fz_kernel_hb28
  s_barrier
  s_sub_u32 s3, s3, 1
.fz_kernel_hb28:
  v_add_f32 v64, v64, v108
  v_add_f32 v65, v65, v109
  v_add_f32 v66, v66, v110
  v_add_f32 v67, v67, v111
  v_add_f32 v64, v64, v112
  v_add_f32 v65, v65, v113
  v_add_f32 v66, v66, v114
  v_add_f32 v67, v67, v115
  v_add_f32 v64, v64, v116
  v_add_f32 v65, v65, v117
  v_add_f32 v66, v66, v118
  v_add_f32 v67, v67, v119
  v_add_f32 v64, v64, v120
  v_add_f32 v65, v65, v121
  v_add_f32 v66, v66, v122
  v_add_f32 v67, v67, v123
  v_add_f32 v64, v64, v124
  v_add_f32 v65, v65, v125
  v_add_f32 v66, v66, v126
  v_add_f32 v67, v67, v127
  s_cmp_eq_u32 s3, 0
  s_cbranch_scc1 .fz_kernel_hb29
  s_barrier
  s_sub_u32 s3, s3, 1
.fz_kernel_hb29:
  v_add_u32 v24, 155648, v3
  s_mov_b32 exec_hi, 0xffff
  ds_write_b128 v24, v[64:67] offset:5632
  s_mov_b64 exec, -1
  s_waitcnt lgkmcnt(0)
  s_getpc_b64 s[0:1]
.fz_kernel_ct30:
  s_sub_u32 s0, s0, .fz_kernel_ct30-fz_kernel
  s_subb_u32 s1, s1, 0
  s_lshr_b32 s31, s2, 3
  s_mulk_i32 s31, 0x500
  v_lshl_add_u32 v1, v2, 7, s31
  v_min_u32 v1, .fz_kernel_last-fz_kernel, v1
  s_mov_b64 exec, 0x3ff
  global_load_dword v1, v1, s[0:1]
  s_mov_b64 exec, -1
.fz_kernel_ct30e:
  s_branch .fz_kernel_q_hw2
.fz_kernel_att:
  s_setprio 3
  s_and_b32 s39, s16, 1
  s_lshr_b32 s32, s16, 1
  s_lshl1_add_u32 s31, s39, s32
  s_lshl_b32 s33, s31, 13
  s_add_u32 s33, s33, 122880
  v_add_u32 v8, s33, v3
  s_lshl_b32 s33, s31, 12
  s_add_u32 s33, s33, 106496
  v_add_u32 v9, s33, v3
  v_xor_b32 v10, 4096, v9
  ds_read_b128 v[168:171], v8 offset:0
  ds_read_b128 v[172:175], v8 offset:1024
  ds_read_b128 v[16:19], v9 offset:0
  ds_read_b128 v[20:23], v9 offset:1024
  ds_read_b128 v[24:27], v9 offset:2048
  ds_read_b128 v[28:31], v9 offset:3072
  ds_read_b128 v[176:179], v8 offset:2048
  ds_read_b128 v[180:183], v8 offset:3072
  ds_read_b128 v[32:35], v10 offset:0
  ds_read_b128 v[36:39], v10 offset:1024
  ds_read_b128 v[40:43], v10 offset:2048
  ds_read_b128 v[44:47], v10 offset:3072
  s_lshl1_add_u32 s35, s18, s39
  s_lshl_b32 s35, s35, 5
  s_add_u32 s35, s35, s32
  s_lshl_b32 s35, s35, 13
  s_add_u32 s35, s35, s63
  s_lshl_b32 s34, 1, s17
  s_mov_b32 s36, 0
  v_add_u32 v10, 4096, v3
  s_waitcnt lgkmcnt(8)
  v_mfma_f32_32x32x16_bf16 v[128:143], v[168:171], v[16:19], 0
  ds_read_b128 v[184:187], v8 offset:4096
  ds_read_b128 v[188:191], v8 offset:5120
  ds_read_b128 v[192:195], v8 offset:6144
  ds_read_b128 v[196:199], v8 offset:7168
  v_mfma_f32_32x32x16_bf16 v[128:143], v[172:175], v[20:23], v[128:143]
  v_mov_b32 v1, 0x3f803f80
  v_mov_b32 v11, 0x4444
  v_mov_b32 v12, v1
  v_mov_b32 v14, 0
  s_mov_b32 exec_lo, 0xaaaaaaaa
  s_mov_b32 exec_hi, 0xaaaaaaaa
  v_mov_b32 v12, 0
  v_mov_b32 v14, v1
  s_mov_b32 exec_lo, 0xcccccccc
  s_mov_b32 exec_hi, 0xcccccccc
  v_mov_b32 v11, 0xeeee
  s_mov_b64 exec, -1
  v_mov_b32 v13, v12
  v_mov_b32 v15, v14
  v_mov_b32 v112, 0
  v_mov_b32 v113, 0
  v_mov_b32 v114, 0
  v_mov_b32 v115, 0
  v_mov_b32 v116, 0
  v_mov_b32 v117, 0
  v_mov_b32 v118, 0
  v_mov_b32 v119, 0
  v_mov_b32 v120, 0
  v_mov_b32 v121, 0
  v_mov_b32 v122, 0
  v_mov_b32 v123, 0
  v_mov_b32 v124, 0
  v_mov_b32 v125, 0
  v_mov_b32 v126, 0
  v_mov_b32 v127, 0
  s_waitcnt lgkmcnt(0)
  v_mfma_f32_32x32x16_bf16 v[144:159], v[168:171], v[24:27], 0
  v_exp_f32 v128, v128
  v_exp_f32 v129, v129
  v_exp_f32 v130, v130
  v_exp_f32 v131, v131
  v_exp_f32 v132, v132
  v_exp_f32 v133, v133
  v_exp_f32 v134, v134
  v_exp_f32 v135, v135
  v_mfma_f32_32x32x16_bf16 v[144:159], v[172:175], v[28:31], v[144:159]
  v_cvt_pk_bf16_f32 v160, v128, v129
  v_cvt_pk_bf16_f32 v161, v130, v131
  v_cvt_pk_bf16_f32 v162, v132, v133
  v_cvt_pk_bf16_f32 v163, v134, v135
  v_exp_f32 v136, v136
  v_exp_f32 v137, v137
  v_exp_f32 v138, v138
  v_exp_f32 v139, v139
  v_mfma_f32_32x32x16_bf16 v[48:63], v[176:179], v[160:163], 0
  v_exp_f32 v140, v140
  v_exp_f32 v141, v141
  v_exp_f32 v142, v142
  v_exp_f32 v143, v143
  v_cvt_pk_bf16_f32 v164, v136, v137
  v_cvt_pk_bf16_f32 v165, v138, v139
  v_cvt_pk_bf16_f32 v166, v140, v141
  v_cvt_pk_bf16_f32 v167, v142, v143
  s_mov_b64 exec, 1
  s_waitcnt vmcnt(0)
  ds_add_u32 v6, v5 offset:0x100
  s_mov_b64 exec, -1
  v_mfma_f32_32x32x16_bf16 v[128:143], v[168:171], v[32:35], 0
  v_exp_f32 v144, v144
  v_exp_f32 v145, v145
  v_exp_f32 v146, v146
  v_exp_f32 v147, v147
  v_mfma_f32_32x32x16_bf16 v[48:63], v[180:183], v[164:167], v[48:63]
  v_exp_f32 v148, v148
  v_exp_f32 v149, v149
  v_exp_f32 v150, v150
  v_smfmac_f32_16x16x64_bf16 v[112:115], v[12:15], v[160:167], v11
  v_exp_f32 v151, v151
  v_mfma_f32_32x32x16_bf16 v[128:143], v[172:175], v[36:39], v[128:143]
  v_cvt_pk_bf16_f32 v160, v144, v145
  v_cvt_pk_bf16_f32 v161, v146, v147
  v_cvt_pk_bf16_f32 v162, v148, v149
  v_cvt_pk_bf16_f32 v163, v150, v151
  v_exp_f32 v152, v152
  v_exp_f32 v153, v153
  v_exp_f32 v154, v154
  v_exp_f32 v155, v155
  v_mfma_f32_32x32x16_bf16 v[64:79], v[176:179], v[160:163], 0
  v_exp_f32 v156, v156
  v_exp_f32 v157, v157
  v_exp_f32 v158, v158
  v_exp_f32 v159, v159
  v_cvt_pk_bf16_f32 v164, v152, v153
  v_cvt_pk_bf16_f32 v165, v154, v155
  v_cvt_pk_bf16_f32 v166, v156, v157
  v_cvt_pk_bf16_f32 v167, v158, v159
  v_mfma_f32_32x32x16_bf16 v[144:159], v[168:171], v[40:43], 0
  v_exp_f32 v128, v128
  v_exp_f32 v129, v129
  v_exp_f32 v130, v130
  v_exp_f32 v131, v131
  v_mfma_f32_32x32x16_bf16 v[64:79], v[180:183], v[164:167], v[64:79]
  v_exp_f32 v132, v132
  v_exp_f32 v133, v133
  v_exp_f32 v134, v134
  v_smfmac_f32_16x16x64_bf16 v[116:119], v[12:15], v[160:167], v11
  v_exp_f32 v135, v135
  v_mfma_f32_32x32x16_bf16 v[144:159], v[172:175], v[44:47], v[144:159]
  v_cvt_pk_bf16_f32 v160, v128, v129
  v_cvt_pk_bf16_f32 v161, v130, v131
  v_cvt_pk_bf16_f32 v162, v132, v133
  v_cvt_pk_bf16_f32 v163, v134, v135
  v_exp_f32 v136, v136
  v_exp_f32 v137, v137
  v_exp_f32 v138, v138
  v_exp_f32 v139, v139
  v_mfma_f32_32x32x16_bf16 v[80:95], v[176:179], v[160:163], 0
  v_exp_f32 v140, v140
  v_exp_f32 v141, v141
  v_exp_f32 v142, v142
  v_exp_f32 v143, v143
  v_cvt_pk_bf16_f32 v164, v136, v137
  v_cvt_pk_bf16_f32 v165, v138, v139
  v_cvt_pk_bf16_f32 v166, v140, v141
  v_cvt_pk_bf16_f32 v167, v142, v143
  v_mfma_f32_32x32x16_bf16 v[128:143], v[184:187], v[16:19], 0
  v_exp_f32 v144, v144
  v_exp_f32 v145, v145
  v_exp_f32 v146, v146
  v_exp_f32 v147, v147
  v_mfma_f32_32x32x16_bf16 v[80:95], v[180:183], v[164:167], v[80:95]
  v_exp_f32 v148, v148
  v_exp_f32 v149, v149
  v_exp_f32 v150, v150
  v_smfmac_f32_16x16x64_bf16 v[120:123], v[12:15], v[160:167], v11
  v_exp_f32 v151, v151
  v_mfma_f32_32x32x16_bf16 v[128:143], v[188:191], v[20:23], v[128:143]
  v_cvt_pk_bf16_f32 v160, v144, v145
  v_cvt_pk_bf16_f32 v161, v146, v147
  v_cvt_pk_bf16_f32 v162, v148, v149
  v_cvt_pk_bf16_f32 v163, v150, v151
  v_exp_f32 v152, v152
  v_exp_f32 v153, v153
  v_exp_f32 v154, v154
  v_exp_f32 v155, v155
  v_mfma_f32_32x32x16_bf16 v[96:111], v[176:179], v[160:163], 0
  v_exp_f32 v156, v156
  v_exp_f32 v157, v157
  v_exp_f32 v158, v158
  v_exp_f32 v159, v159
  v_cvt_pk_bf16_f32 v164, v152, v153
  v_cvt_pk_bf16_f32 v165, v154, v155
  v_cvt_pk_bf16_f32 v166, v156, v157
  v_cvt_pk_bf16_f32 v167, v158, v159
  v_mfma_f32_32x32x16_bf16 v[144:159], v[184:187], v[24:27], 0
  v_exp_f32 v128, v128
  v_exp_f32 v129, v129
  v_exp_f32 v130, v130
  v_exp_f32 v131, v131
  v_mfma_f32_32x32x16_bf16 v[96:111], v[180:183], v[164:167], v[96:111]
  v_exp_f32 v132, v132
  v_exp_f32 v133, v133
  v_exp_f32 v134, v134
  v_smfmac_f32_16x16x64_bf16 v[124:127], v[12:15], v[160:167], v11
  v_exp_f32 v135, v135
  v_mfma_f32_32x32x16_bf16 v[144:159], v[188:191], v[28:31], v[144:159]
  v_cvt_pk_bf16_f32 v160, v128, v129
  v_cvt_pk_bf16_f32 v161, v130, v131
  v_cvt_pk_bf16_f32 v162, v132, v133
  v_cvt_pk_bf16_f32 v163, v134, v135
  v_exp_f32 v136, v136
  ds_read_b32 v7, v6
  v_exp_f32 v137, v137
  v_exp_f32 v138, v138
  v_exp_f32 v139, v139
  v_mfma_f32_32x32x16_bf16 v[48:63], v[192:195], v[160:163], v[48:63]
  v_exp_f32 v140, v140
  v_exp_f32 v141, v141
  v_exp_f32 v142, v142
  v_exp_f32 v143, v143
  v_cvt_pk_bf16_f32 v164, v136, v137
  v_cvt_pk_bf16_f32 v165, v138, v139
  v_cvt_pk_bf16_f32 v166, v140, v141
  v_cvt_pk_bf16_f32 v167, v142, v143
  s_waitcnt lgkmcnt(0)
  v_readfirstlane_b32 s39, v7
  s_andn2_b32 s39, s39, s34
  s_cbranch_scc0 .fz_kernel_a_p0
  s_ff1_i32_b32 s33, s36
  s_bitset0_b32 s36, s33
  s_lshl_b32 s33, s33, 14
  s_add_u32 s30, s33, s35
  s_cbranch_scc1 .fz_kernel_pk31c
.fz_kernel_pk31:
  buffer_load_dwordx4 v[200:203], v3, s[4:7], s30 offen offset:0
  buffer_load_dwordx4 v[204:207], v3, s[4:7], s30 offen offset:1024
  buffer_load_dwordx4 v[208:211], v3, s[4:7], s30 offen offset:2048
  buffer_load_dwordx4 v[212:215], v3, s[4:7], s30 offen offset:3072
  buffer_load_dwordx4 v[216:219], v10, s[4:7], s30 offen offset:0
  buffer_load_dwordx4 v[220:223], v10, s[4:7], s30 offen offset:1024
  buffer_load_dwordx4 v[224:227], v10, s[4:7], s30 offen offset:2048
  buffer_load_dwordx4 v[228:231], v10, s[4:7], s30 offen offset:3072
.fz_kernel_a_p0:
  v_mfma_f32_32x32x16_bf16 v[128:143], v[184:187], v[32:35], 0
  v_exp_f32 v144, v144
  v_exp_f32 v145, v145
  v_exp_f32 v146, v146
  v_exp_f32 v147, v147
  v_mfma_f32_32x32x16_bf16 v[48:63], v[196:199], v[164:167], v[48:63]
  v_exp_f32 v148, v148
  v_exp_f32 v149, v149
  v_exp_f32 v150, v150
  v_smfmac_f32_16x16x64_bf16 v[112:115], v[12:15], v[160:167], v11
  v_exp_f32 v151, v151
  v_mfma_f32_32x32x16_bf16 v[128:143], v[188:191], v[36:39], v[128:143]
  v_cvt_pk_bf16_f32 v160, v144, v145
  v_cvt_pk_bf16_f32 v161, v146, v147
  v_cvt_pk_bf16_f32 v162, v148, v149
  v_cvt_pk_bf16_f32 v163, v150, v151
  v_exp_f32 v152, v152
  v_exp_f32 v153, v153
  v_exp_f32 v154, v154
  v_exp_f32 v155, v155
  v_mfma_f32_32x32x16_bf16 v[64:79], v[192:195], v[160:163], v[64:79]
  v_exp_f32 v156, v156
  v_exp_f32 v157, v157
  v_exp_f32 v158, v158
  v_exp_f32 v159, v159
  v_cvt_pk_bf16_f32 v164, v152, v153
  v_cvt_pk_bf16_f32 v165, v154, v155
  v_cvt_pk_bf16_f32 v166, v156, v157
  v_cvt_pk_bf16_f32 v167, v158, v159
  v_mfma_f32_32x32x16_bf16 v[144:159], v[184:187], v[40:43], 0
  v_exp_f32 v128, v128
  v_exp_f32 v129, v129
  v_exp_f32 v130, v130
  v_exp_f32 v131, v131
  v_mfma_f32_32x32x16_bf16 v[64:79], v[196:199], v[164:167], v[64:79]
  v_exp_f32 v132, v132
  v_exp_f32 v133, v133
  v_exp_f32 v134, v134
  v_smfmac_f32_16x16x64_bf16 v[116:119], v[12:15], v[160:167], v11
  v_exp_f32 v135, v135
  v_mfma_f32_32x32x16_bf16 v[144:159], v[188:191], v[44:47], v[144:159]
  v_cvt_pk_bf16_f32 v160, v128, v129
  v_cvt_pk_bf16_f32 v161, v130, v131
  v_cvt_pk_bf16_f32 v162, v132, v133
  v_cvt_pk_bf16_f32 v163, v134, v135
  v_exp_f32 v136, v136
  v_exp_f32 v137, v137
  v_exp_f32 v138, v138
  v_exp_f32 v139, v139
  v_mfma_f32_32x32x16_bf16 v[80:95], v[192:195], v[160:163], v[80:95]
  v_exp_f32 v140, v140
  v_exp_f32 v141, v141
  v_exp_f32 v142, v142
  v_exp_f32 v143, v143
  v_cvt_pk_bf16_f32 v164, v136, v137
  v_cvt_pk_bf16_f32 v165, v138, v139
  v_cvt_pk_bf16_f32 v166, v140, v141
  v_cvt_pk_bf16_f32 v167, v142, v143
  v_exp_f32 v144, v144
  v_exp_f32 v145, v145
  v_exp_f32 v146, v146
  v_exp_f32 v147, v147
  v_mfma_f32_32x32x16_bf16 v[80:95], v[196:199], v[164:167], v[80:95]
  v_exp_f32 v148, v148
  v_exp_f32 v149, v149
  v_exp_f32 v150, v150
  v_smfmac_f32_16x16x64_bf16 v[120:123], v[12:15], v[160:167], v11
  v_exp_f32 v151, v151
  v_cvt_pk_bf16_f32 v160, v144, v145
  v_cvt_pk_bf16_f32 v161, v146, v147
  v_cvt_pk_bf16_f32 v162, v148, v149
  v_cvt_pk_bf16_f32 v163, v150, v151
  v_exp_f32 v152, v152
  v_exp_f32 v153, v153
  v_exp_f32 v154, v154
  v_exp_f32 v155, v155
  v_mfma_f32_32x32x16_bf16 v[96:111], v[192:195], v[160:163], v[96:111]
  v_exp_f32 v156, v156
  v_exp_f32 v157, v157
  v_exp_f32 v158, v158
  v_exp_f32 v159, v159
  v_cvt_pk_bf16_f32 v164, v152, v153
  v_cvt_pk_bf16_f32 v165, v154, v155
  v_cvt_pk_bf16_f32 v166, v156, v157
  v_cvt_pk_bf16_f32 v167, v158, v159
  s_cmp_lg_u32 s39, 0
  s_cbranch_scc1 .fz_kernel_a_p1
  s_ff1_i32_b32 s33, s36
  s_bitset0_b32 s36, s33
  s_lshl_b32 s33, s33, 14
  s_add_u32 s30, s33, s35
  s_cbranch_scc1 .fz_kernel_pk32c
.fz_kernel_pk32:
  buffer_load_dwordx4 v[200:203], v3, s[4:7], s30 offen offset:0
  buffer_load_dwordx4 v[204:207], v3, s[4:7], s30 offen offset:1024
  buffer_load_dwordx4 v[208:211], v3, s[4:7], s30 offen offset:2048
  buffer_load_dwordx4 v[212:215], v3, s[4:7], s30 offen offset:3072
  buffer_load_dwordx4 v[216:219], v10, s[4:7], s30 offen offset:0
  buffer_load_dwordx4 v[220:223], v10, s[4:7], s30 offen offset:1024
  buffer_load_dwordx4 v[224:227], v10, s[4:7], s30 offen offset:2048
  buffer_load_dwordx4 v[228:231], v10, s[4:7], s30 offen offset:3072
.fz_kernel_a_p1:
  s_ff1_i32_b32 s33, s36
  s_bitset0_b32 s36, s33
  s_lshl_b32 s33, s33, 14
  s_add_u32 s30, s33, s35
  s_cbranch_scc1 .fz_kernel_pk33c
.fz_kernel_pk33:
  buffer_load_dwordx4 v[168:171], v3, s[4:7], s30 offen offset:0
  buffer_load_dwordx4 v[172:175], v3, s[4:7], s30 offen offset:1024
  buffer_load_dwordx4 v[176:179], v3, s[4:7], s30 offen offset:2048
  buffer_load_dwordx4 v[180:183], v3, s[4:7], s30 offen offset:3072
  v_and_b32 v8, 1, v2
  v_lshlrev_b32 v8, 4, v8
  v_mov_b32 v9, 0x3f80
  v_lshlrev_b32 v8, v8, v9
  v_mov_b32 v248, 0
  v_mov_b32 v249, 0
  v_mov_b32 v250, 0
  v_mov_b32 v251, 0
  v_mov_b32 v252, 0
  v_mov_b32 v253, 0
  v_mov_b32 v254, 0
  v_mov_b32 v255, 0
  s_mov_b32 exec_lo, 0x3
  s_mov_b32 exec_hi, 0x30
  v_mov_b32 v248, v8
  s_mov_b32 exec_lo, 0xc
  s_mov_b32 exec_hi, 0xc0
  v_mov_b32 v249, v8
  s_mov_b32 exec_lo, 0x300
  s_mov_b32 exec_hi, 0x3000
  v_mov_b32 v250, v8
  s_mov_b32 exec_lo, 0xc00
  s_mov_b32 exec_hi, 0xc000
  v_mov_b32 v251, v8
  s_mov_b32 exec_lo, 0x30000
  s_mov_b32 exec_hi, 0x300000
  v_mov_b32 v252, v8
  s_mov_b32 exec_lo, 0xc0000
  s_mov_b32 exec_hi, 0xc00000
  v_mov_b32 v253, v8
  s_mov_b32 exec_lo, 0x3000000
  s_mov_b32 exec_hi, 0x30000000
  v_mov_b32 v254, v8
  s_mov_b32 exec_lo, 0xc000000
  s_mov_b32 exec_hi, 0xc0000000
  v_mov_b32 v255, v8
  s_mov_b64 exec, -1
  s_waitcnt vmcnt(10)
  v_mfma_f32_32x32x16_bf16 v[128:143], v[200:203], v[16:19], 0
  v_mfma_f32_32x32x16_bf16 v[128:143], v[204:207], v[20:23], v[128:143]
  s_waitcnt vmcnt(8)
  s_mov_b32 s32, 8
  s_nop 9
  s_branch .fz_kernel_a_b2
  .p2align 6
.fz_kernel_a_loop:
  v_mfma_f32_32x32x16_bf16 v[144:159], v[168:171], v[24:27], 0
  v_exp_f32 v128, v128
  v_exp_f32 v129, v129
  v_exp_f32 v130, v130
  v_exp_f32 v131, v131
  v_mfma_f32_32x32x16_bf16 v[96:111], v[228:231], v[164:167], v[96:111]
  v_exp_f32 v132, v132
  v_exp_f32 v133, v133
  buffer_load_dwordx4 v[216:219], v10, s[4:7], s30 offen offset:0
  v_exp_f32 v134, v134
  buffer_load_dwordx4 v[220:223], v10, s[4:7], s30 offen offset:1024
  v_smfmac_f32_16x16x64_bf16 v[124:127], v[12:15], v[160:167], v11
  v_exp_f32 v135, v135
  buffer_load_dwordx4 v[224:227], v10, s[4:7], s30 offen offset:2048
  v_mfma_f32_32x32x16_bf16 v[144:159], v[172:175], v[28:31], v[144:159]
  v_cvt_pk_bf16_f32 v160, v128, v129
  v_cvt_pk_bf16_f32 v161, v130, v131
  v_cvt_pk_bf16_f32 v162, v132, v133
  v_cvt_pk_bf16_f32 v163, v134, v135
  v_exp_f32 v136, v136
  buffer_load_dwordx4 v[228:231], v10, s[4:7], s30 offen offset:3072
  v_exp_f32 v137, v137
  v_exp_f32 v138, v138
  v_exp_f32 v139, v139
  v_mfma_f32_32x32x16_bf16 v[48:63], v[176:179], v[160:163], v[48:63]
  v_exp_f32 v140, v140
  v_exp_f32 v141, v141
  v_exp_f32 v142, v142
  v_exp_f32 v143, v143
  v_cvt_pk_bf16_f32 v164, v136, v137
  v_cvt_pk_bf16_f32 v165, v138, v139
  v_cvt_pk_bf16_f32 v166, v140, v141
  v_cvt_pk_bf16_f32 v167, v142, v143
  v_mfma_f32_32x32x16_bf16 v[128:143], v[168:171], v[32:35], 0
  v_exp_f32 v144, v144
  v_exp_f32 v145, v145
  v_exp_f32 v146, v146
  v_exp_f32 v147, v147
  v_mfma_f32_32x32x16_bf16 v[48:63], v[180:183], v[164:167], v[48:63]
  v_exp_f32 v148, v148
  v_exp_f32 v149, v149
  v_exp_f32 v150, v150
  v_smfmac_f32_16x16x64_bf16 v[112:115], v[12:15], v[160:167], v11
  v_exp_f32 v151, v151
  v_mfma_f32_32x32x16_bf16 v[128:143], v[172:175], v[36:39], v[128:143]
  v_cvt_pk_bf16_f32 v160, v144, v145
  v_cvt_pk_bf16_f32 v161, v146, v147
  v_cvt_pk_bf16_f32 v162, v148, v149
  v_cvt_pk_bf16_f32 v163, v150, v151
  v_exp_f32 v152, v152
  v_exp_f32 v153, v153
  v_exp_f32 v154, v154
  v_exp_f32 v155, v155
  v_mfma_f32_32x32x16_bf16 v[64:79], v[176:179], v[160:163], v[64:79]
  v_exp_f32 v156, v156
  v_exp_f32 v157, v157
  v_exp_f32 v158, v158
  v_exp_f32 v159, v159
  v_cvt_pk_bf16_f32 v164, v152, v153
  v_cvt_pk_bf16_f32 v165, v154, v155
  v_cvt_pk_bf16_f32 v166, v156, v157
  v_cvt_pk_bf16_f32 v167, v158, v159
  v_mfma_f32_32x32x16_bf16 v[144:159], v[168:171], v[40:43], 0
  v_exp_f32 v128, v128
  v_exp_f32 v129, v129
  v_exp_f32 v130, v130
  v_exp_f32 v131, v131
  v_mfma_f32_32x32x16_bf16 v[64:79], v[180:183], v[164:167], v[64:79]
  v_exp_f32 v132, v132
  v_exp_f32 v133, v133
  v_exp_f32 v134, v134
  v_smfmac_f32_16x16x64_bf16 v[116:119], v[12:15], v[160:167], v11
  v_exp_f32 v135, v135
  v_mfma_f32_32x32x16_bf16 v[144:159], v[172:175], v[44:47], v[144:159]
  v_cvt_pk_bf16_f32 v160, v128, v129
  v_cvt_pk_bf16_f32 v161, v130, v131
  v_cvt_pk_bf16_f32 v162, v132, v133
  v_cvt_pk_bf16_f32 v163, v134, v135
  v_exp_f32 v136, v136
  v_exp_f32 v137, v137
  v_exp_f32 v138, v138
  v_exp_f32 v139, v139
  v_mfma_f32_32x32x16_bf16 v[80:95], v[176:179], v[160:163], v[80:95]
  v_exp_f32 v140, v140
  v_exp_f32 v141, v141
  v_exp_f32 v142, v142
  v_exp_f32 v143, v143
  v_cvt_pk_bf16_f32 v164, v136, v137
  v_cvt_pk_bf16_f32 v165, v138, v139
  v_cvt_pk_bf16_f32 v166, v140, v141
  v_cvt_pk_bf16_f32 v167, v142, v143
  s_waitcnt vmcnt(8)
  v_mfma_f32_32x32x16_bf16 v[128:143], v[184:187], v[16:19], 0
  v_exp_f32 v144, v144
  v_exp_f32 v145, v145
  v_exp_f32 v146, v146
  v_exp_f32 v147, v147
  v_mfma_f32_32x32x16_bf16 v[80:95], v[180:183], v[164:167], v[80:95]
  v_exp_f32 v148, v148
  v_exp_f32 v149, v149
  v_exp_f32 v150, v150
  v_smfmac_f32_16x16x64_bf16 v[120:123], v[12:15], v[160:167], v11
  v_exp_f32 v151, v151
  v_mfma_f32_32x32x16_bf16 v[128:143], v[188:191], v[20:23], v[128:143]
  v_cvt_pk_bf16_f32 v160, v144, v145
  v_cvt_pk_bf16_f32 v161, v146, v147
  v_cvt_pk_bf16_f32 v162, v148, v149
  v_cvt_pk_bf16_f32 v163, v150, v151
  v_exp_f32 v152, v152
  v_exp_f32 v153, v153
  v_exp_f32 v154, v154
  v_exp_f32 v155, v155
  v_mfma_f32_32x32x16_bf16 v[96:111], v[176:179], v[160:163], v[96:111]
  v_exp_f32 v156, v156
  v_exp_f32 v157, v157
  v_exp_f32 v158, v158
  v_exp_f32 v159, v159
  v_cvt_pk_bf16_f32 v164, v152, v153
  v_cvt_pk_bf16_f32 v165, v154, v155
  v_cvt_pk_bf16_f32 v166, v156, v157
  v_cvt_pk_bf16_f32 v167, v158, v159
  v_mfma_f32_32x32x16_bf16 v[144:159], v[184:187], v[24:27], 0
  v_exp_f32 v128, v128
  v_exp_f32 v129, v129
  s_ff1_i32_b32 s33, s36
  v_exp_f32 v130, v130
  s_bitset0_b32 s36, s33
  v_exp_f32 v131, v131
  s_lshl_b32 s33, s33, 14
  v_mfma_f32_32x32x16_bf16 v[96:111], v[180:183], v[164:167], v[96:111]
  v_exp_f32 v132, v132
  s_add_u32 s30, s33, s35
  s_cbranch_scc1 .fz_kernel_pk34c
.fz_kernel_pk34:
  v_exp_f32 v133, v133
  buffer_load_dwordx4 v[168:171], v3, s[4:7], s30 offen offset:0
  v_exp_f32 v134, v134
  buffer_load_dwordx4 v[172:175], v3, s[4:7], s30 offen offset:1024
  v_smfmac_f32_16x16x64_bf16 v[124:127], v[12:15], v[160:167], v11
  v_exp_f32 v135, v135
  buffer_load_dwordx4 v[176:179], v3, s[4:7], s30 offen offset:2048
  v_mfma_f32_32x32x16_bf16 v[144:159], v[188:191], v[28:31], v[144:159]
  v_cvt_pk_bf16_f32 v160, v128, v129
  v_cvt_pk_bf16_f32 v161, v130, v131
  v_cvt_pk_bf16_f32 v162, v132, v133
  v_cvt_pk_bf16_f32 v163, v134, v135
  v_exp_f32 v136, v136
  buffer_load_dwordx4 v[180:183], v3, s[4:7], s30 offen offset:3072
  v_exp_f32 v137, v137
  v_exp_f32 v138, v138
  v_exp_f32 v139, v139
  v_mfma_f32_32x32x16_bf16 v[48:63], v[192:195], v[160:163], v[48:63]
  v_exp_f32 v140, v140
  v_exp_f32 v141, v141
  v_exp_f32 v142, v142
  v_exp_f32 v143, v143
  v_cvt_pk_bf16_f32 v164, v136, v137
  v_cvt_pk_bf16_f32 v165, v138, v139
  v_cvt_pk_bf16_f32 v166, v140, v141
  v_cvt_pk_bf16_f32 v167, v142, v143
  v_mfma_f32_32x32x16_bf16 v[128:143], v[184:187], v[32:35], 0
  v_exp_f32 v144, v144
  v_exp_f32 v145, v145
  v_exp_f32 v146, v146
  v_exp_f32 v147, v147
  v_mfma_f32_32x32x16_bf16 v[48:63], v[196:199], v[164:167], v[48:63]
  v_exp_f32 v148, v148
  v_exp_f32 v149, v149
  v_exp_f32 v150, v150
  v_smfmac_f32_16x16x64_bf16 v[112:115], v[12:15], v[160:167], v11
  v_exp_f32 v151, v151
  v_mfma_f32_32x32x16_bf16 v[128:143], v[188:191], v[36:39], v[128:143]
  v_cvt_pk_bf16_f32 v160, v144, v145
  v_cvt_pk_bf16_f32 v161, v146, v147
  v_cvt_pk_bf16_f32 v162, v148, v149
  v_cvt_pk_bf16_f32 v163, v150, v151
  v_exp_f32 v152, v152
  v_exp_f32 v153, v153
  v_exp_f32 v154, v154
  v_exp_f32 v155, v155
  v_mfma_f32_32x32x16_bf16 v[64:79], v[192:195], v[160:163], v[64:79]
  v_exp_f32 v156, v156
  v_exp_f32 v157, v157
  v_exp_f32 v158, v158
  v_exp_f32 v159, v159
  v_cvt_pk_bf16_f32 v164, v152, v153
  v_cvt_pk_bf16_f32 v165, v154, v155
  v_cvt_pk_bf16_f32 v166, v156, v157
  v_cvt_pk_bf16_f32 v167, v158, v159
  v_mfma_f32_32x32x16_bf16 v[144:159], v[184:187], v[40:43], 0
  v_exp_f32 v128, v128
  v_exp_f32 v129, v129
  v_exp_f32 v130, v130
  v_exp_f32 v131, v131
  v_mfma_f32_32x32x16_bf16 v[64:79], v[196:199], v[164:167], v[64:79]
  v_exp_f32 v132, v132
  v_exp_f32 v133, v133
  v_exp_f32 v134, v134
  v_smfmac_f32_16x16x64_bf16 v[116:119], v[12:15], v[160:167], v11
  v_exp_f32 v135, v135
  v_mfma_f32_32x32x16_bf16 v[144:159], v[188:191], v[44:47], v[144:159]
  v_cvt_pk_bf16_f32 v160, v128, v129
  v_cvt_pk_bf16_f32 v161, v130, v131
  v_cvt_pk_bf16_f32 v162, v132, v133
  v_cvt_pk_bf16_f32 v163, v134, v135
  v_exp_f32 v136, v136
  v_exp_f32 v137, v137
  v_exp_f32 v138, v138
  v_exp_f32 v139, v139
  v_mfma_f32_32x32x16_bf16 v[80:95], v[192:195], v[160:163], v[80:95]
  v_exp_f32 v140, v140
  v_exp_f32 v141, v141
  v_exp_f32 v142, v142
  v_exp_f32 v143, v143
  v_cvt_pk_bf16_f32 v164, v136, v137
  v_cvt_pk_bf16_f32 v165, v138, v139
  v_cvt_pk_bf16_f32 v166, v140, v141
  v_cvt_pk_bf16_f32 v167, v142, v143
  s_waitcnt vmcnt(8)
  v_mfma_f32_32x32x16_bf16 v[128:143], v[200:203], v[16:19], 0
  v_exp_f32 v144, v144
  v_exp_f32 v145, v145
  v_exp_f32 v146, v146
  v_exp_f32 v147, v147
  v_mfma_f32_32x32x16_bf16 v[80:95], v[196:199], v[164:167], v[80:95]
  v_exp_f32 v148, v148
  v_exp_f32 v149, v149
  v_exp_f32 v150, v150
  v_smfmac_f32_16x16x64_bf16 v[120:123], v[12:15], v[160:167], v11
  v_exp_f32 v151, v151
  v_mfma_f32_32x32x16_bf16 v[128:143], v[204:207], v[20:23], v[128:143]
  v_cvt_pk_bf16_f32 v160, v144, v145
  v_cvt_pk_bf16_f32 v161, v146, v147
  v_cvt_pk_bf16_f32 v162, v148, v149
  v_cvt_pk_bf16_f32 v163, v150, v151
  v_exp_f32 v152, v152
  v_exp_f32 v153, v153
  v_exp_f32 v154, v154
  v_exp_f32 v155, v155
  v_mfma_f32_32x32x16_bf16 v[96:111], v[192:195], v[160:163], v[96:111]
  v_exp_f32 v156, v156
  v_exp_f32 v157, v157
  v_exp_f32 v158, v158
  v_exp_f32 v159, v159
  v_cvt_pk_bf16_f32 v164, v152, v153
  v_cvt_pk_bf16_f32 v165, v154, v155
  v_cvt_pk_bf16_f32 v166, v156, v157
  v_cvt_pk_bf16_f32 v167, v158, v159
.fz_kernel_a_b2:
  v_mfma_f32_32x32x16_bf16 v[144:159], v[200:203], v[24:27], 0
  v_exp_f32 v128, v128
  v_exp_f32 v129, v129
  v_exp_f32 v130, v130
  v_exp_f32 v131, v131
  v_mfma_f32_32x32x16_bf16 v[96:111], v[196:199], v[164:167], v[96:111]
  v_exp_f32 v132, v132
  v_exp_f32 v133, v133
  buffer_load_dwordx4 v[184:187], v10, s[4:7], s30 offen offset:0
  v_exp_f32 v134, v134
  buffer_load_dwordx4 v[188:191], v10, s[4:7], s30 offen offset:1024
  v_smfmac_f32_16x16x64_bf16 v[124:127], v[12:15], v[160:167], v11
  v_exp_f32 v135, v135
  buffer_load_dwordx4 v[192:195], v10, s[4:7], s30 offen offset:2048
  v_mfma_f32_32x32x16_bf16 v[144:159], v[204:207], v[28:31], v[144:159]
  v_cvt_pk_bf16_f32 v160, v128, v129
  v_cvt_pk_bf16_f32 v161, v130, v131
  v_cvt_pk_bf16_f32 v162, v132, v133
  v_cvt_pk_bf16_f32 v163, v134, v135
  v_exp_f32 v136, v136
  buffer_load_dwordx4 v[196:199], v10, s[4:7], s30 offen offset:3072
  v_exp_f32 v137, v137
  v_exp_f32 v138, v138
  v_exp_f32 v139, v139
  v_mfma_f32_32x32x16_bf16 v[48:63], v[208:211], v[160:163], v[48:63]
  v_exp_f32 v140, v140
  v_exp_f32 v141, v141
  v_exp_f32 v142, v142
  v_exp_f32 v143, v143
  v_cvt_pk_bf16_f32 v164, v136, v137
  v_cvt_pk_bf16_f32 v165, v138, v139
  v_cvt_pk_bf16_f32 v166, v140, v141
  v_cvt_pk_bf16_f32 v167, v142, v143
  v_mfma_f32_32x32x16_bf16 v[128:143], v[200:203], v[32:35], 0
  v_exp_f32 v144, v144
  v_exp_f32 v145, v145
  v_exp_f32 v146, v146
  v_exp_f32 v147, v147
  v_mfma_f32_32x32x16_bf16 v[48:63], v[212:215], v[164:167], v[48:63]
  v_exp_f32 v148, v148
  v_exp_f32 v149, v149
  v_exp_f32 v150, v150
  v_smfmac_f32_16x16x64_bf16 v[112:115], v[12:15], v[160:167], v11
  v_exp_f32 v151, v151
  v_mfma_f32_32x32x16_bf16 v[128:143], v[204:207], v[36:39], v[128:143]
  v_cvt_pk_bf16_f32 v160, v144, v145
  v_cvt_pk_bf16_f32 v161, v146, v147
  v_cvt_pk_bf16_f32 v162, v148, v149
  v_cvt_pk_bf16_f32 v163, v150, v151
  v_exp_f32 v152, v152
  v_exp_f32 v153, v153
  v_exp_f32 v154, v154
  v_exp_f32 v155, v155
  v_mfma_f32_32x32x16_bf16 v[64:79], v[208:211], v[160:163], v[64:79]
  v_exp_f32 v156, v156
  v_exp_f32 v157, v157
  v_exp_f32 v158, v158
  v_exp_f32 v159, v159
  v_cvt_pk_bf16_f32 v164, v152, v153
  v_cvt_pk_bf16_f32 v165, v154, v155
  v_cvt_pk_bf16_f32 v166, v156, v157
  v_cvt_pk_bf16_f32 v167, v158, v159
  v_mfma_f32_32x32x16_bf16 v[144:159], v[200:203], v[40:43], 0
  v_exp_f32 v128, v128
  v_exp_f32 v129, v129
  v_exp_f32 v130, v130
  v_exp_f32 v131, v131
  v_mfma_f32_32x32x16_bf16 v[64:79], v[212:215], v[164:167], v[64:79]
  v_exp_f32 v132, v132
  v_exp_f32 v133, v133
  v_exp_f32 v134, v134
  v_smfmac_f32_16x16x64_bf16 v[116:119], v[12:15], v[160:167], v11
  v_exp_f32 v135, v135
  v_mfma_f32_32x32x16_bf16 v[144:159], v[204:207], v[44:47], v[144:159]
  v_cvt_pk_bf16_f32 v160, v128, v129
  v_cvt_pk_bf16_f32 v161, v130, v131
  v_cvt_pk_bf16_f32 v162, v132, v133
  v_cvt_pk_bf16_f32 v163, v134, v135
  v_exp_f32 v136, v136
  v_exp_f32 v137, v137
  v_exp_f32 v138, v138
  v_exp_f32 v139, v139
  v_mfma_f32_32x32x16_bf16 v[80:95], v[208:211], v[160:163], v[80:95]
  v_exp_f32 v140, v140
  v_exp_f32 v141, v141
  v_exp_f32 v142, v142
  v_exp_f32 v143, v143
  v_cvt_pk_bf16_f32 v164, v136, v137
  v_cvt_pk_bf16_f32 v165, v138, v139
  v_cvt_pk_bf16_f32 v166, v140, v141
  v_cvt_pk_bf16_f32 v167, v142, v143
  s_waitcnt vmcnt(8)
  v_mfma_f32_32x32x16_bf16 v[128:143], v[216:219], v[16:19], 0
  v_exp_f32 v144, v144
  v_exp_f32 v145, v145
  v_exp_f32 v146, v146
  v_exp_f32 v147, v147
  v_mfma_f32_32x32x16_bf16 v[80:95], v[212:215], v[164:167], v[80:95]
  v_exp_f32 v148, v148
  v_exp_f32 v149, v149
  v_exp_f32 v150, v150
  v_smfmac_f32_16x16x64_bf16 v[120:123], v[12:15], v[160:167], v11
  v_exp_f32 v151, v151
  v_mfma_f32_32x32x16_bf16 v[128:143], v[220:223], v[20:23], v[128:143]
  v_cvt_pk_bf16_f32 v160, v144, v145
  v_cvt_pk_bf16_f32 v161, v146, v147
  v_cvt_pk_bf16_f32 v162, v148, v149
  v_cvt_pk_bf16_f32 v163, v150, v151
  v_exp_f32 v152, v152
  v_exp_f32 v153, v153
  v_exp_f32 v154, v154
  v_exp_f32 v155, v155
  v_mfma_f32_32x32x16_bf16 v[96:111], v[208:211], v[160:163], v[96:111]
  v_exp_f32 v156, v156
  v_exp_f32 v157, v157
  v_exp_f32 v158, v158
  v_exp_f32 v159, v159
  v_cvt_pk_bf16_f32 v164, v152, v153
  v_cvt_pk_bf16_f32 v165, v154, v155
  v_cvt_pk_bf16_f32 v166, v156, v157
  v_cvt_pk_bf16_f32 v167, v158, v159
  v_mfma_f32_32x32x16_bf16 v[144:159], v[216:219], v[24:27], 0
  v_exp_f32 v128, v128
  v_exp_f32 v129, v129
  s_ff1_i32_b32 s33, s36
  v_exp_f32 v130, v130
  s_bitset0_b32 s36, s33
  v_exp_f32 v131, v131
  s_lshl_b32 s33, s33, 14
  v_mfma_f32_32x32x16_bf16 v[96:111], v[212:215], v[164:167], v[96:111]
  v_exp_f32 v132, v132
  s_add_u32 s30, s33, s35
  s_cbranch_scc1 .fz_kernel_pk35c
.fz_kernel_pk35:
  v_exp_f32 v133, v133
  buffer_load_dwordx4 v[200:203], v3, s[4:7], s30 offen offset:0
  v_exp_f32 v134, v134
  buffer_load_dwordx4 v[204:207], v3, s[4:7], s30 offen offset:1024
  v_smfmac_f32_16x16x64_bf16 v[124:127], v[12:15], v[160:167], v11
  v_exp_f32 v135, v135
  buffer_load_dwordx4 v[208:211], v3, s[4:7], s30 offen offset:2048
  v_mfma_f32_32x32x16_bf16 v[144:159], v[220:223], v[28:31], v[144:159]
  v_cvt_pk_bf16_f32 v160, v128, v129
  v_cvt_pk_bf16_f32 v161, v130, v131
  v_cvt_pk_bf16_f32 v162, v132, v133
  v_cvt_pk_bf16_f32 v163, v134, v135
  v_exp_f32 v136, v136
  buffer_load_dwordx4 v[212:215], v3, s[4:7], s30 offen offset:3072
  v_exp_f32 v137, v137
  v_exp_f32 v138, v138
  v_exp_f32 v139, v139
  v_mfma_f32_32x32x16_bf16 v[48:63], v[224:227], v[160:163], v[48:63]
  v_exp_f32 v140, v140
  v_exp_f32 v141, v141
  v_exp_f32 v142, v142
  v_exp_f32 v143, v143
  v_cvt_pk_bf16_f32 v164, v136, v137
  v_cvt_pk_bf16_f32 v165, v138, v139
  v_cvt_pk_bf16_f32 v166, v140, v141
  v_cvt_pk_bf16_f32 v167, v142, v143
  v_mfma_f32_32x32x16_bf16 v[128:143], v[216:219], v[32:35], 0
  v_exp_f32 v144, v144
  v_exp_f32 v145, v145
  v_exp_f32 v146, v146
  v_exp_f32 v147, v147
  v_mfma_f32_32x32x16_bf16 v[48:63], v[228:231], v[164:167], v[48:63]
  v_exp_f32 v148, v148
  v_exp_f32 v149, v149
  v_exp_f32 v150, v150
  v_smfmac_f32_16x16x64_bf16 v[112:115], v[12:15], v[160:167], v11
  v_exp_f32 v151, v151
  v_mfma_f32_32x32x16_bf16 v[128:143], v[220:223], v[36:39], v[128:143]
  v_cvt_pk_bf16_f32 v160, v144, v145
  v_cvt_pk_bf16_f32 v161, v146, v147
  v_cvt_pk_bf16_f32 v162, v148, v149
  v_cvt_pk_bf16_f32 v163, v150, v151
  v_exp_f32 v152, v152
  v_exp_f32 v153, v153
  v_exp_f32 v154, v154
  v_exp_f32 v155, v155
  v_mfma_f32_32x32x16_bf16 v[64:79], v[224:227], v[160:163], v[64:79]
  v_exp_f32 v156, v156
  v_exp_f32 v157, v157
  v_exp_f32 v158, v158
  v_exp_f32 v159, v159
  v_cvt_pk_bf16_f32 v164, v152, v153
  v_cvt_pk_bf16_f32 v165, v154, v155
  v_cvt_pk_bf16_f32 v166, v156, v157
  v_cvt_pk_bf16_f32 v167, v158, v159
  v_mfma_f32_32x32x16_bf16 v[144:159], v[216:219], v[40:43], 0
  v_exp_f32 v128, v128
  v_exp_f32 v129, v129
  v_exp_f32 v130, v130
  v_exp_f32 v131, v131
  v_mfma_f32_32x32x16_bf16 v[64:79], v[228:231], v[164:167], v[64:79]
  v_exp_f32 v132, v132
  v_exp_f32 v133, v133
  v_exp_f32 v134, v134
  v_smfmac_f32_16x16x64_bf16 v[116:119], v[12:15], v[160:167], v11
  v_exp_f32 v135, v135
  v_mfma_f32_32x32x16_bf16 v[144:159], v[220:223], v[44:47], v[144:159]
  v_cvt_pk_bf16_f32 v160, v128, v129
  v_cvt_pk_bf16_f32 v161, v130, v131
  v_cvt_pk_bf16_f32 v162, v132, v133
  v_cvt_pk_bf16_f32 v163, v134, v135
  v_exp_f32 v136, v136
  v_exp_f32 v137, v137
  v_exp_f32 v138, v138
  v_exp_f32 v139, v139
  v_mfma_f32_32x32x16_bf16 v[80:95], v[224:227], v[160:163], v[80:95]
  v_exp_f32 v140, v140
  v_exp_f32 v141, v141
  v_exp_f32 v142, v142
  v_exp_f32 v143, v143
  v_cvt_pk_bf16_f32 v164, v136, v137
  v_cvt_pk_bf16_f32 v165, v138, v139
  v_cvt_pk_bf16_f32 v166, v140, v141
  v_cvt_pk_bf16_f32 v167, v142, v143
  s_waitcnt vmcnt(8)
  v_mfma_f32_32x32x16_bf16 v[128:143], v[168:171], v[16:19], 0
  v_exp_f32 v144, v144
  v_exp_f32 v145, v145
  v_exp_f32 v146, v146
  v_exp_f32 v147, v147
  v_mfma_f32_32x32x16_bf16 v[80:95], v[228:231], v[164:167], v[80:95]
  v_exp_f32 v148, v148
  v_exp_f32 v149, v149
  v_exp_f32 v150, v150
  v_smfmac_f32_16x16x64_bf16 v[120:123], v[12:15], v[160:167], v11
  v_exp_f32 v151, v151
  v_mfma_f32_32x32x16_bf16 v[128:143], v[172:175], v[20:23], v[128:143]
  v_cvt_pk_bf16_f32 v160, v144, v145
  v_cvt_pk_bf16_f32 v161, v146, v147
  v_cvt_pk_bf16_f32 v162, v148, v149
  v_cvt_pk_bf16_f32 v163, v150, v151
  v_exp_f32 v152, v152
  s_sub_u32 s32, s32, 1
  s_cmp_lg_u32 s32, 0
  v_exp_f32 v153, v153
  v_exp_f32 v154, v154
  v_exp_f32 v155, v155
  v_mfma_f32_32x32x16_bf16 v[96:111], v[224:227], v[160:163], v[96:111]
  v_exp_f32 v156, v156
  v_exp_f32 v157, v157
  v_exp_f32 v158, v158
  v_exp_f32 v159, v159
  v_cvt_pk_bf16_f32 v164, v152, v153
  v_cvt_pk_bf16_f32 v165, v154, v155
  v_cvt_pk_bf16_f32 v166, v156, v157
  v_cvt_pk_bf16_f32 v167, v158, v159
  s_cbranch_scc1 .fz_kernel_a_loop
  v_cvt_pk_bf16_f32 v80, v80, v81
  v_cvt_pk_bf16_f32 v81, v82, v83
  v_mfma_f32_32x32x16_bf16 v[96:111], v[228:231], v[164:167], v[96:111]
  v_cvt_pk_bf16_f32 v82, v84, v85
  v_cvt_pk_bf16_f32 v83, v86, v87
  v_cvt_pk_bf16_f32 v84, v88, v89
  v_cvt_pk_bf16_f32 v85, v90, v91
  v_cvt_pk_bf16_f32 v86, v92, v93
  v_smfmac_f32_16x16x64_bf16 v[124:127], v[12:15], v[160:167], v11
  v_cvt_pk_bf16_f32 v87, v94, v95
  s_lshl_b32 s33, s16, 12
  s_add_u32 s33, s33, 131072
  v_add_u32 v36, s33, v3
  ds_write_b128 v36, v[80:83]
  ds_write_b128 v36, v[84:87] offset:1024
  s_and_b32 s39, s16, 1
  v_and_b32 v32, 16, v2
  v_cmp_ne_u32 s[34:35], 0, v32
  v_and_b32 v35, 31, v2
  v_lshlrev_b32 v35, 3, v35
  s_lshl_b32 s33, s16, 8
  s_add_u32 s33, s33, 147456
  v_add_u32 v37, s33, v35
  v_cvt_pk_bf16_f32 v96, v96, v97
  v_cvt_pk_bf16_f32 v97, v98, v99
  v_cvt_pk_bf16_f32 v98, v100, v101
  v_cvt_pk_bf16_f32 v99, v102, v103
  v_cvt_pk_bf16_f32 v100, v104, v105
  v_cvt_pk_bf16_f32 v101, v106, v107
  v_cvt_pk_bf16_f32 v102, v108, v109
  v_cvt_pk_bf16_f32 v103, v110, v111
  ds_write_b128 v36, v[96:99] offset:2048
  ds_write_b128 v36, v[100:103] offset:3072
  v_add_f32 v120, v120, v122
  v_add_f32 v121, v121, v123
  v_add_f32 v124, v124, v126
  v_add_f32 v125, v125, v127
  v_cndmask_b32 v38, v120, v121, s[34:35]
  v_cndmask_b32 v39, v124, v125, s[34:35]
  ds_write_b64 v37, v[38:39]
  v_add_f32 v112, v112, v114
  v_add_f32 v113, v113, v115
  v_add_f32 v116, v116, v118
  v_add_f32 v117, v117, v119
  v_cndmask_b32 v32, v112, v113, s[34:35]
  v_cndmask_b32 v33, v116, v117, s[34:35]
  v_xor_b32 v36, 8192, v36
  v_xor_b32 v37, 512, v37
  s_waitcnt lgkmcnt(0)
  s_barrier
  ds_read_b128 v[128:131], v36 offset:0
  ds_read_b128 v[132:135], v36 offset:1024
  ds_read_b128 v[136:139], v36 offset:2048
  ds_read_b128 v[140:143], v36 offset:3072
  ds_read_b64 v[38:39], v37
  v_mov_b32 v41, 8.673617379884035e-19
  v_mov_b32 v42, 1.152921504606847e+18
  s_and_b32 s32, s16, 2
  s_lshl2_add_u32 s31, s17, s32
  s_lshl_b32 s31, s31, 4
  s_add_u32 s31, s31, s18
  s_lshl1_add_u32 s31, s31, s39
  s_lshl_b32 s31, s31, 11
  s_add_u32 s28, s31, s64
  s_add_u32 s29, s28, 65536
  s_waitcnt lgkmcnt(4)
  v_mfma_f32_32x32x16_bf16 v[48:63], v[248:251], v[128:131], v[48:63]
  s_waitcnt lgkmcnt(3)
  v_mfma_f32_32x32x16_bf16 v[48:63], v[252:255], v[132:135], v[48:63]
  s_waitcnt lgkmcnt(2)
  v_mfma_f32_32x32x16_bf16 v[64:79], v[248:251], v[136:139], v[64:79]
  s_waitcnt lgkmcnt(1)
  v_mfma_f32_32x32x16_bf16 v[64:79], v[252:255], v[140:143], v[64:79]
  s_waitcnt lgkmcnt(0)
  v_add_f32 v32, v32, v38
  v_add_f32 v33, v33, v39
  s_mov_b32 s73, 0
.fz_kernel_a_fin:
  v_rcp_f32 v34, v32
  v_rcp_f32 v36, v33
  v_min_f32 v38, v32, v33
  v_max_f32 v39, v32, v33
  v_cmp_o_f32 s[36:37], v32, v33
  v_cmp_ge_f32 vcc, v38, v41
  s_and_b64 s[36:37], s[36:37], vcc
  v_cmp_le_f32 vcc, v39, v42
  s_and_b64 s[36:37], s[36:37], vcc
  v_pk_mul_f32 v[48:49], v[48:49], v[34:35] op_sel_hi:[1,0]
  v_pk_mul_f32 v[50:51], v[50:51], v[34:35] op_sel_hi:[1,0]
  v_pk_mul_f32 v[52:53], v[52:53], v[34:35] op_sel_hi:[1,0]
  v_pk_mul_f32 v[54:55], v[54:55], v[34:35] op_sel_hi:[1,0]
  v_cvt_pk_bf16_f32 v128, v48, v49
  v_cvt_pk_bf16_f32 v129, v50, v51
  v_cvt_pk_bf16_f32 v130, v52, v53
  v_cvt_pk_bf16_f32 v131, v54, v55
  buffer_store_dwordx4 v[128:131], v3, s[4:7], s28 offen offset:0 sc1
  v_pk_mul_f32 v[56:57], v[56:57], v[34:35] op_sel_hi:[1,0]
  v_pk_mul_f32 v[58:59], v[58:59], v[34:35] op_sel_hi:[1,0]
  v_pk_mul_f32 v[60:61], v[60:61], v[34:35] op_sel_hi:[1,0]
  v_pk_mul_f32 v[62:63], v[62:63], v[34:35] op_sel_hi:[1,0]
  v_cvt_pk_bf16_f32 v132, v56, v57
  v_cvt_pk_bf16_f32 v133, v58, v59
  v_cvt_pk_bf16_f32 v134, v60, v61
  v_cvt_pk_bf16_f32 v135, v62, v63
  buffer_store_dwordx4 v[132:135], v3, s[4:7], s28 offen offset:1024 sc1
  v_pk_mul_f32 v[64:65], v[64:65], v[36:37] op_sel_hi:[1,0]
  v_pk_mul_f32 v[66:67], v[66:67], v[36:37] op_sel_hi:[1,0]
  v_pk_mul_f32 v[68:69], v[68:69], v[36:37] op_sel_hi:[1,0]
  v_pk_mul_f32 v[70:71], v[70:71], v[36:37] op_sel_hi:[1,0]
  v_cvt_pk_bf16_f32 v136, v64, v65
  v_cvt_pk_bf16_f32 v137, v66, v67
  v_cvt_pk_bf16_f32 v138, v68, v69
  v_cvt_pk_bf16_f32 v139, v70, v71
  buffer_store_dwordx4 v[136:139], v3, s[4:7], s29 offen offset:0 sc1
  v_pk_mul_f32 v[72:73], v[72:73], v[36:37] op_sel_hi:[1,0]
  v_pk_mul_f32 v[74:75], v[74:75], v[36:37] op_sel_hi:[1,0]
  v_pk_mul_f32 v[76:77], v[76:77], v[36:37] op_sel_hi:[1,0]
  v_pk_mul_f32 v[78:79], v[78:79], v[36:37] op_sel_hi:[1,0]
  v_cvt_pk_bf16_f32 v140, v72, v73
  v_cvt_pk_bf16_f32 v141, v74, v75
  v_cvt_pk_bf16_f32 v142, v76, v77
  v_cvt_pk_bf16_f32 v143, v78, v79
  buffer_store_dwordx4 v[140:143], v3, s[4:7], s29 offen offset:1024 sc1
  v_pk_fma_f32 v[144:145], v[48:49], 0, 0 op_sel_hi:[1,0,0]
  v_pk_fma_f32 v[146:147], v[50:51], 0, 0 op_sel_hi:[1,0,0]
  v_pk_fma_f32 v[144:145], v[52:53], 0, v[144:145] op_sel_hi:[1,0,1]
  v_pk_fma_f32 v[146:147], v[54:55], 0, v[146:147] op_sel_hi:[1,0,1]
  v_pk_fma_f32 v[144:145], v[56:57], 0, v[144:145] op_sel_hi:[1,0,1]
  v_pk_fma_f32 v[146:147], v[58:59], 0, v[146:147] op_sel_hi:[1,0,1]
  v_pk_fma_f32 v[144:145], v[60:61], 0, v[144:145] op_sel_hi:[1,0,1]
  v_pk_fma_f32 v[146:147], v[62:63], 0, v[146:147] op_sel_hi:[1,0,1]
  v_pk_fma_f32 v[144:145], v[64:65], 0, v[144:145] op_sel_hi:[1,0,1]
  v_pk_fma_f32 v[146:147], v[66:67], 0, v[146:147] op_sel_hi:[1,0,1]
  v_pk_fma_f32 v[144:145], v[68:69], 0, v[144:145] op_sel_hi:[1,0,1]
  v_pk_fma_f32 v[146:147], v[70:71], 0, v[146:147] op_sel_hi:[1,0,1]
  v_pk_fma_f32 v[144:145], v[72:73], 0, v[144:145] op_sel_hi:[1,0,1]
  v_pk_fma_f32 v[146:147], v[74:75], 0, v[146:147] op_sel_hi:[1,0,1]
  v_pk_fma_f32 v[144:145], v[76:77], 0, v[144:145] op_sel_hi:[1,0,1]
  v_pk_fma_f32 v[146:147], v[78:79], 0, v[146:147] op_sel_hi:[1,0,1]
  v_pk_add_f32 v[144:145], v[144:145], v[146:147]
  v_cmp_o_f32 vcc, v144, v145
  s_and_b64 s[36:37], s[36:37], vcc
  s_cmp_eq_u64 s[36:37], -1
  s_cbranch_scc0 .fz_kernel_a_slow
.fz_kernel_a_ok:
  s_mov_b32 s8, s48
  s_mov_b32 s9, s49
  s_mov_b32 s10, 0x800
  s_mov_b32 s11, 0x00020000
  s_mov_b32 s12, s40
  s_mov_b32 s13, s41
  s_mov_b32 s14, 0x400000
  s_mov_b32 s15, 0x00020000
  v_lshrrev_b32 v17, 5, v2
  v_and_b32 v18, 31, v2
  v_lshlrev_b32 v19, 4, v17
  s_lshl_b32 s32, s17, 2
  s_add_u32 s32, s32, s16
  s_lshl_b32 s22, s18, 7
  s_lshl_b32 s39, s17, 4
  s_add_u32 s39, s39, s18
  s_lshl_b32 s39, s39, 2
  s_add_u32 s39, s39, s16
  s_lshl_b32 s39, s39, 12
  v_and_b32 v16, 16, v2
  v_lshlrev_b32 v16, 7, v16
  v_lshl_add_u32 v16, v17, 8, v16
  v_and_b32 v1, 0xf0, v3
  v_add_u32 v16, v16, v1
  s_cmp_lg_u32 s62, 0
  s_cbranch_scc1 .fz_kernel_wx2
  v_lshl_add_u32 v11, v18, 11, v19
  s_lshl_b32 s23, s32, 16
  s_add_u32 s23, s22, s23
  buffer_load_dwordx4 v[240:243], v11, s[12:15], s23 offen offset:0
  buffer_load_dwordx4 v[244:247], v11, s[12:15], s23 offen offset:32
  buffer_load_dwordx4 v[248:251], v11, s[12:15], s23 offen offset:64
  buffer_load_dwordx4 v[252:255], v11, s[12:15], s23 offen offset:96
  s_branch .fz_kernel_wx3
.fz_kernel_wx2:
  s_add_u32 s23, s39, 0x1000000
  buffer_load_dwordx4 v[240:243], v16, s[4:7], s23 offen offset:0
  buffer_load_dwordx4 v[244:247], v16, s[4:7], s23 offen offset:512
  buffer_load_dwordx4 v[248:251], v16, s[4:7], s23 offen offset:1024
  buffer_load_dwordx4 v[252:255], v16, s[4:7], s23 offen offset:1536
.fz_kernel_wx3:
  buffer_load_dwordx4 v[48:51], v19, s[8:11], s22 offen offset:0
  buffer_load_dwordx4 v[52:55], v19, s[8:11], s22 offen offset:32
  buffer_load_dwordx4 v[56:59], v19, s[8:11], s22 offen offset:64
  buffer_load_dwordx4 v[60:63], v19, s[8:11], s22 offen offset:96
  s_add_u32 s39, s39, s65
  s_lshl_b32 s31, s16, 5
  v_add_u32 v45, s31, v18
  v_lshlrev_b32 v11, 2, v45
  v_add_u32 v11, 155648, v11
  v_mov_b32 v44, 159952
  ds_read_b32 v40, v11 offset:6400
  ds_read_b32 v42, v11 offset:6912
  ds_read_b32 v46, v44 offset:8
  ds_read_b32 v44, v44
  v_mov_b32 v47, 0.32768
  v_add_u32 v45, 1, v45
  v_bfe_u32 v11, v2, 2, 2
  v_lshl_add_u32 v12, v17, 2, v11
  v_lshlrev_b32 v12, 7, v12
  v_lshrrev_b32 v13, 1, v11
  v_lshl_add_u32 v12, v13, 6, v12
  v_bfe_u32 v13, v2, 4, 1
  v_lshl_add_u32 v12, v13, 5, v12
  v_and_b32 v13, 1, v2
  v_lshl_add_u32 v12, v13, 4, v12
  v_bfe_u32 v13, v2, 1, 1
  v_lshl_add_u32 v14, v13, 3, v12
  v_xor_b32 v15, 64, v14
  s_lshl_b32 s35, s32, 16
  s_add_u32 s35, s35, s64
  s_mov_b32 s34, 0
  s_mov_b32 s36, 0
  v_add_u32 v6, 8, v6
  s_mov_b64 exec, 1
  s_waitcnt vmcnt(8)
  ds_add_u32 v6, v5 offset:0x100
  s_mov_b64 exec, -1
  s_waitcnt vmcnt(4) lgkmcnt(0)
  v_lshlrev_b32 v64, 16, v240
  v_and_b32 v65, 0xffff0000, v240
  v_lshlrev_b32 v66, 16, v241
  v_and_b32 v67, 0xffff0000, v241
  v_lshlrev_b32 v68, 16, v242
  v_and_b32 v69, 0xffff0000, v242
  v_lshlrev_b32 v70, 16, v243
  v_and_b32 v71, 0xffff0000, v243
  v_lshlrev_b32 v72, 16, v244
  v_and_b32 v73, 0xffff0000, v244
  v_lshlrev_b32 v74, 16, v245
  v_and_b32 v75, 0xffff0000, v245
  v_lshlrev_b32 v76, 16, v246
  v_and_b32 v77, 0xffff0000, v246
  v_lshlrev_b32 v78, 16, v247
  v_and_b32 v79, 0xffff0000, v247
  v_lshlrev_b32 v80, 16, v248
  v_and_b32 v81, 0xffff0000, v248
  v_lshlrev_b32 v82, 16, v249
  v_and_b32 v83, 0xffff0000, v249
  v_lshlrev_b32 v84, 16, v250
  v_and_b32 v85, 0xffff0000, v250
  v_lshlrev_b32 v86, 16, v251
  v_and_b32 v87, 0xffff0000, v251
  v_lshlrev_b32 v88, 16, v252
  v_and_b32 v89, 0xffff0000, v252
  v_lshlrev_b32 v90, 16, v253
  v_and_b32 v91, 0xffff0000, v253
  v_lshlrev_b32 v92, 16, v254
  v_and_b32 v93, 0xffff0000, v254
  v_lshlrev_b32 v94, 16, v255
  v_and_b32 v95, 0xffff0000, v255
  v_pk_fma_f32 v[64:65], v[64:65], v[40:41], v[42:43] op_sel_hi:[1,0,0]
  v_pk_fma_f32 v[66:67], v[66:67], v[40:41], v[42:43] op_sel_hi:[1,0,0]
  v_pk_fma_f32 v[68:69], v[68:69], v[40:41], v[42:43] op_sel_hi:[1,0,0]
  v_pk_fma_f32 v[70:71], v[70:71], v[40:41], v[42:43] op_sel_hi:[1,0,0]
  v_pk_fma_f32 v[72:73], v[72:73], v[40:41], v[42:43] op_sel_hi:[1,0,0]
  v_pk_fma_f32 v[74:75], v[74:75], v[40:41], v[42:43] op_sel_hi:[1,0,0]
  v_pk_fma_f32 v[76:77], v[76:77], v[40:41], v[42:43] op_sel_hi:[1,0,0]
  v_pk_fma_f32 v[78:79], v[78:79], v[40:41], v[42:43] op_sel_hi:[1,0,0]
  v_pk_fma_f32 v[80:81], v[80:81], v[40:41], v[42:43] op_sel_hi:[1,0,0]
  v_pk_fma_f32 v[82:83], v[82:83], v[40:41], v[42:43] op_sel_hi:[1,0,0]
  v_pk_fma_f32 v[84:85], v[84:85], v[40:41], v[42:43] op_sel_hi:[1,0,0]
  v_pk_fma_f32 v[86:87], v[86:87], v[40:41], v[42:43] op_sel_hi:[1,0,0]
  v_pk_fma_f32 v[88:89], v[88:89], v[40:41], v[42:43] op_sel_hi:[1,0,0]
  v_pk_fma_f32 v[90:91], v[90:91], v[40:41], v[42:43] op_sel_hi:[1,0,0]
  v_pk_fma_f32 v[92:93], v[92:93], v[40:41], v[42:43] op_sel_hi:[1,0,0]
  v_pk_fma_f32 v[94:95], v[94:95], v[40:41], v[42:43] op_sel_hi:[1,0,0]
  v_cmp_eq_u32 vcc, v44, v45
  s_cbranch_vccnz .fz_kernel_w_pt
.fz_kernel_w_pb:
  s_andn2_b32 s33, s36, s34
  s_cbranch_scc0 .fz_kernel_pk42c
.fz_kernel_pk42:
  s_ff1_i32_b32 s33, s33
  s_bitset1_b32 s34, s33
  s_lshl_b32 s20, s33, 13
  s_lshl_b32 s33, s33, 12
  s_add_u32 s30, s33, s35
  buffer_load_dwordx4 v[96:99], v3, s[4:7], s30 offen offset:0
  buffer_load_dwordx4 v[100:103], v3, s[4:7], s30 offen offset:1024
  buffer_load_dwordx4 v[104:107], v3, s[4:7], s30 offen offset:2048
  buffer_load_dwordx4 v[108:111], v3, s[4:7], s30 offen offset:3072
  s_andn2_b32 s33, s36, s34
  s_cbranch_scc0 .fz_kernel_pk43c
.fz_kernel_pk43:
  s_ff1_i32_b32 s33, s33
  s_bitset1_b32 s34, s33
  s_lshl_b32 s21, s33, 13
  s_lshl_b32 s33, s33, 12
  s_add_u32 s30, s33, s35
  buffer_load_dwordx4 v[112:115], v3, s[4:7], s30 offen offset:0
  buffer_load_dwordx4 v[116:119], v3, s[4:7], s30 offen offset:1024
  buffer_load_dwordx4 v[120:123], v3, s[4:7], s30 offen offset:2048
  buffer_load_dwordx4 v[124:127], v3, s[4:7], s30 offen offset:3072
  s_andn2_b32 s33, s36, s34
  s_cbranch_scc0 .fz_kernel_pk44c
.fz_kernel_pk44:
  s_ff1_i32_b32 s33, s33
  s_bitset1_b32 s34, s33
  s_lshl_b32 s22, s33, 13
  s_lshl_b32 s33, s33, 12
  s_add_u32 s30, s33, s35
  buffer_load_dwordx4 v[128:131], v3, s[4:7], s30 offen offset:0
  buffer_load_dwordx4 v[132:135], v3, s[4:7], s30 offen offset:1024
  buffer_load_dwordx4 v[136:139], v3, s[4:7], s30 offen offset:2048
  buffer_load_dwordx4 v[140:143], v3, s[4:7], s30 offen offset:3072
  v_add_u32 v10, s20, v14
  v_add_u32 v11, s20, v15
  ds_read_b64_tr_b16 v[224:225], v10 offset:0
  ds_read_b64_tr_b16 v[226:227], v10 offset:1024
  ds_read_b64_tr_b16 v[228:229], v11 offset:0
  ds_read_b64_tr_b16 v[230:231], v11 offset:1024
  ds_read_b64_tr_b16 v[232:233], v10 offset:2048
  ds_read_b64_tr_b16 v[234:235], v10 offset:3072
  ds_read_b64_tr_b16 v[236:237], v11 offset:2048
  ds_read_b64_tr_b16 v[238:239], v11 offset:3072
  s_andn2_b32 s33, s36, s34
  s_cbranch_scc0 .fz_kernel_pk45c
.fz_kernel_pk45:
  s_ff1_i32_b32 s33, s33
  s_bitset1_b32 s34, s33
  s_lshl_b32 s23, s33, 13
  s_lshl_b32 s33, s33, 12
  s_add_u32 s30, s33, s35
  s_waitcnt vmcnt(11) lgkmcnt(6)
  v_mfma_f32_32x32x16_bf16 v[64:79], v[224:227], v[96:99], v[64:79]
  v_add_u32 v12, s21, v14
  v_add_u32 v13, s21, v15
  ds_read_b64_tr_b16 v[240:241], v10 offset:4096
  ds_read_b64_tr_b16 v[242:243], v10 offset:5120
  buffer_load_dwordx4 v[144:147], v3, s[4:7], s30 offen offset:0
  s_waitcnt lgkmcnt(6)
  v_mfma_f32_32x32x16_bf16 v[80:95], v[228:231], v[96:99], v[80:95]
  ds_read_b64_tr_b16 v[244:245], v11 offset:4096
  ds_read_b64_tr_b16 v[246:247], v11 offset:5120
  s_waitcnt vmcnt(11) lgkmcnt(6)
  v_mfma_f32_32x32x16_bf16 v[64:79], v[232:235], v[100:103], v[64:79]
  ds_read_b64_tr_b16 v[248:249], v10 offset:6144
  ds_read_b64_tr_b16 v[250:251], v10 offset:7168
  buffer_load_dwordx4 v[148:151], v3, s[4:7], s30 offen offset:1024
  s_waitcnt lgkmcnt(6)
  v_mfma_f32_32x32x16_bf16 v[80:95], v[236:239], v[100:103], v[80:95]
  ds_read_b64_tr_b16 v[252:253], v11 offset:6144
  ds_read_b64_tr_b16 v[254:255], v11 offset:7168
  s_waitcnt vmcnt(11) lgkmcnt(6)
  v_mfma_f32_32x32x16_bf16 v[64:79], v[240:243], v[104:107], v[64:79]
  ds_read_b64_tr_b16 v[224:225], v12 offset:0
  ds_read_b64_tr_b16 v[226:227], v12 offset:1024
  buffer_load_dwordx4 v[152:155], v3, s[4:7], s30 offen offset:2048
  s_waitcnt lgkmcnt(6)
  v_mfma_f32_32x32x16_bf16 v[80:95], v[244:247], v[104:107], v[80:95]
  ds_read_b64_tr_b16 v[228:229], v13 offset:0
  ds_read_b64_tr_b16 v[230:231], v13 offset:1024
  s_waitcnt vmcnt(11) lgkmcnt(6)
  v_mfma_f32_32x32x16_bf16 v[64:79], v[248:251], v[108:111], v[64:79]
  ds_read_b64_tr_b16 v[232:233], v12 offset:2048
  ds_read_b64_tr_b16 v[234:235], v12 offset:3072
  buffer_load_dwordx4 v[156:159], v3, s[4:7], s30 offen offset:3072
  s_waitcnt lgkmcnt(6)
  v_mfma_f32_32x32x16_bf16 v[80:95], v[252:255], v[108:111], v[80:95]
  ds_read_b64_tr_b16 v[236:237], v13 offset:2048
  ds_read_b64_tr_b16 v[238:239], v13 offset:3072
  s_andn2_b32 s33, s36, s34
  s_cbranch_scc0 .fz_kernel_pk46c
.fz_kernel_pk46:
  s_ff1_i32_b32 s33, s33
  s_bitset1_b32 s34, s33
  s_lshl_b32 s24, s33, 13
  s_lshl_b32 s33, s33, 12
  s_add_u32 s30, s33, s35
  s_waitcnt vmcnt(11) lgkmcnt(6)
  v_mfma_f32_32x32x16_bf16 v[64:79], v[224:227], v[112:115], v[64:79]
  v_add_u32 v10, s22, v14
  v_add_u32 v11, s22, v15
  ds_read_b64_tr_b16 v[240:241], v12 offset:4096
  ds_read_b64_tr_b16 v[242:243], v12 offset:5120
  buffer_load_dwordx4 v[160:163], v3, s[4:7], s30 offen offset:0
  s_waitcnt lgkmcnt(6)
  v_mfma_f32_32x32x16_bf16 v[80:95], v[228:231], v[112:115], v[80:95]
  ds_read_b64_tr_b16 v[244:245], v13 offset:4096
  ds_read_b64_tr_b16 v[246:247], v13 offset:5120
  s_waitcnt vmcnt(11) lgkmcnt(6)
  v_mfma_f32_32x32x16_bf16 v[64:79], v[232:235], v[116:119], v[64:79]
  ds_read_b64_tr_b16 v[248:249], v12 offset:6144
  ds_read_b64_tr_b16 v[250:251], v12 offset:7168
  buffer_load_dwordx4 v[164:167], v3, s[4:7], s30 offen offset:1024
  s_waitcnt lgkmcnt(6)
  v_mfma_f32_32x32x16_bf16 v[80:95], v[236:239], v[116:119], v[80:95]
  ds_read_b64_tr_b16 v[252:253], v13 offset:6144
  ds_read_b64_tr_b16 v[254:255], v13 offset:7168
  s_waitcnt vmcnt(11) lgkmcnt(6)
  v_mfma_f32_32x32x16_bf16 v[64:79], v[240:243], v[120:123], v[64:79]
  ds_read_b64_tr_b16 v[224:225], v10 offset:0
  ds_read_b64_tr_b16 v[226:227], v10 offset:1024
  buffer_load_dwordx4 v[168:171], v3, s[4:7], s30 offen offset:2048
  s_waitcnt lgkmcnt(6)
  v_mfma_f32_32x32x16_bf16 v[80:95], v[244:247], v[120:123], v[80:95]
  ds_read_b64_tr_b16 v[228:229], v11 offset:0
  ds_read_b64_tr_b16 v[230:231], v11 offset:1024
  s_waitcnt vmcnt(11) lgkmcnt(6)
  v_mfma_f32_32x32x16_bf16 v[64:79], v[248:251], v[124:127], v[64:79]
  ds_read_b64_tr_b16 v[232:233], v10 offset:2048
  ds_read_b64_tr_b16 v[234:235], v10 offset:3072
  buffer_load_dwordx4 v[172:175], v3, s[4:7], s30 offen offset:3072
  s_waitcnt lgkmcnt(6)
  v_mfma_f32_32x32x16_bf16 v[80:95], v[252:255], v[124:127], v[80:95]
  ds_read_b64_tr_b16 v[236:237], v11 offset:2048
  ds_read_b64_tr_b16 v[238:239], v11 offset:3072
  s_andn2_b32 s33, s36, s34
  s_cbranch_scc0 .fz_kernel_pk47c
.fz_kernel_pk47:
  s_ff1_i32_b32 s33, s33
  s_bitset1_b32 s34, s33
  s_lshl_b32 s25, s33, 13
  s_lshl_b32 s33, s33, 12
  s_add_u32 s30, s33, s35
  s_waitcnt vmcnt(11) lgkmcnt(6)
  v_mfma_f32_32x32x16_bf16 v[64:79], v[224:227], v[128:131], v[64:79]
  v_add_u32 v12, s23, v14
  v_add_u32 v13, s23, v15
  ds_read_b64_tr_b16 v[240:241], v10 offset:4096
  ds_read_b64_tr_b16 v[242:243], v10 offset:5120
  buffer_load_dwordx4 v[176:179], v3, s[4:7], s30 offen offset:0
  s_waitcnt lgkmcnt(6)
  v_mfma_f32_32x32x16_bf16 v[80:95], v[228:231], v[128:131], v[80:95]
  ds_read_b64_tr_b16 v[244:245], v11 offset:4096
  ds_read_b64_tr_b16 v[246:247], v11 offset:5120
  s_waitcnt vmcnt(11) lgkmcnt(6)
  v_mfma_f32_32x32x16_bf16 v[64:79], v[232:235], v[132:135], v[64:79]
  ds_read_b64_tr_b16 v[248:249], v10 offset:6144
  ds_read_b64_tr_b16 v[250:251], v10 offset:7168
  buffer_load_dwordx4 v[180:183], v3, s[4:7], s30 offen offset:1024
  s_waitcnt lgkmcnt(6)
  v_mfma_f32_32x32x16_bf16 v[80:95], v[236:239], v[132:135], v[80:95]
  ds_read_b64_tr_b16 v[252:253], v11 offset:6144
  ds_read_b64_tr_b16 v[254:255], v11 offset:7168
  s_waitcnt vmcnt(11) lgkmcnt(6)
  v_mfma_f32_32x32x16_bf16 v[64:79], v[240:243], v[136:139], v[64:79]
  ds_read_b64_tr_b16 v[224:225], v12 offset:0
  ds_read_b64_tr_b16 v[226:227], v12 offset:1024
  buffer_load_dwordx4 v[184:187], v3, s[4:7], s30 offen offset:2048
  s_waitcnt lgkmcnt(6)
  v_mfma_f32_32x32x16_bf16 v[80:95], v[244:247], v[136:139], v[80:95]
  ds_read_b64_tr_b16 v[228:229], v13 offset:0
  ds_read_b64_tr_b16 v[230:231], v13 offset:1024
  s_waitcnt vmcnt(11) lgkmcnt(6)
  v_mfma_f32_32x32x16_bf16 v[64:79], v[248:251], v[140:143], v[64:79]
  ds_read_b64_tr_b16 v[232:233], v12 offset:2048
  ds_read_b64_tr_b16 v[234:235], v12 offset:3072
  buffer_load_dwordx4 v[188:191], v3, s[4:7], s30 offen offset:3072
  s_waitcnt lgkmcnt(6)
  v_mfma_f32_32x32x16_bf16 v[80:95], v[252:255], v[140:143], v[80:95]
  ds_read_b64_tr_b16 v[236:237], v13 offset:2048
  ds_read_b64_tr_b16 v[238:239], v13 offset:3072
  s_andn2_b32 s33, s36, s34
  s_cbranch_scc0 .fz_kernel_pk48c
.fz_kernel_pk48:
  s_ff1_i32_b32 s33, s33
  s_bitset1_b32 s34, s33
  s_lshl_b32 s26, s33, 13
  s_lshl_b32 s33, s33, 12
  s_add_u32 s30, s33, s35
  s_waitcnt vmcnt(11) lgkmcnt(6)
  v_mfma_f32_32x32x16_bf16 v[64:79], v[224:227], v[144:147], v[64:79]
  v_add_u32 v10, s24, v14
  v_add_u32 v11, s24, v15
  ds_read_b64_tr_b16 v[240:241], v12 offset:4096
  ds_read_b64_tr_b16 v[242:243], v12 offset:5120
  buffer_load_dwordx4 v[192:195], v3, s[4:7], s30 offen offset:0
  s_waitcnt lgkmcnt(6)
  v_mfma_f32_32x32x16_bf16 v[80:95], v[228:231], v[144:147], v[80:95]
  ds_read_b64_tr_b16 v[244:245], v13 offset:4096
  ds_read_b64_tr_b16 v[246:247], v13 offset:5120
  s_waitcnt vmcnt(11) lgkmcnt(6)
  v_mfma_f32_32x32x16_bf16 v[64:79], v[232:235], v[148:151], v[64:79]
  ds_read_b64_tr_b16 v[248:249], v12 offset:6144
  ds_read_b64_tr_b16 v[250:251], v12 offset:7168
  buffer_load_dwordx4 v[196:199], v3, s[4:7], s30 offen offset:1024
  s_waitcnt lgkmcnt(6)
  v_mfma_f32_32x32x16_bf16 v[80:95], v[236:239], v[148:151], v[80:95]
  ds_read_b64_tr_b16 v[252:253], v13 offset:6144
  ds_read_b64_tr_b16 v[254:255], v13 offset:7168
  s_waitcnt vmcnt(11) lgkmcnt(6)
  v_mfma_f32_32x32x16_bf16 v[64:79], v[240:243], v[152:155], v[64:79]
  ds_read_b64_tr_b16 v[224:225], v10 offset:0
  ds_read_b64_tr_b16 v[226:227], v10 offset:1024
  buffer_load_dwordx4 v[200:203], v3, s[4:7], s30 offen offset:2048
  s_waitcnt lgkmcnt(6)
  v_mfma_f32_32x32x16_bf16 v[80:95], v[244:247], v[152:155], v[80:95]
  ds_read_b64_tr_b16 v[228:229], v11 offset:0
  ds_read_b64_tr_b16 v[230:231], v11 offset:1024
  s_waitcnt vmcnt(11) lgkmcnt(6)
  v_mfma_f32_32x32x16_bf16 v[64:79], v[248:251], v[156:159], v[64:79]
  ds_read_b64_tr_b16 v[232:233], v10 offset:2048
  ds_read_b64_tr_b16 v[234:235], v10 offset:3072
  buffer_load_dwordx4 v[204:207], v3, s[4:7], s30 offen offset:3072
  s_waitcnt lgkmcnt(6)
  v_mfma_f32_32x32x16_bf16 v[80:95], v[252:255], v[156:159], v[80:95]
  ds_read_b64_tr_b16 v[236:237], v11 offset:2048
  ds_read_b64_tr_b16 v[238:239], v11 offset:3072
  s_andn2_b32 s33, s36, s34
  s_cbranch_scc0 .fz_kernel_pk49c
.fz_kernel_pk49:
  s_ff1_i32_b32 s33, s33
  s_bitset1_b32 s34, s33
  s_lshl_b32 s27, s33, 13
  s_lshl_b32 s33, s33, 12
  s_add_u32 s30, s33, s35
  s_waitcnt vmcnt(11) lgkmcnt(6)
  v_mfma_f32_32x32x16_bf16 v[64:79], v[224:227], v[160:163], v[64:79]
  v_add_u32 v12, s25, v14
  v_add_u32 v13, s25, v15
  ds_read_b64_tr_b16 v[240:241], v10 offset:4096
  ds_read_b64_tr_b16 v[242:243], v10 offset:5120
  buffer_load_dwordx4 v[208:211], v3, s[4:7], s30 offen offset:0
  s_waitcnt lgkmcnt(6)
  v_mfma_f32_32x32x16_bf16 v[80:95], v[228:231], v[160:163], v[80:95]
  ds_read_b64_tr_b16 v[244:245], v11 offset:4096
  ds_read_b64_tr_b16 v[246:247], v11 offset:5120
  s_waitcnt vmcnt(11) lgkmcnt(6)
  v_mfma_f32_32x32x16_bf16 v[64:79], v[232:235], v[164:167], v[64:79]
  ds_read_b64_tr_b16 v[248:249], v10 offset:6144
  ds_read_b64_tr_b16 v[250:251], v10 offset:7168
  buffer_load_dwordx4 v[212:215], v3, s[4:7], s30 offen offset:1024
  s_waitcnt lgkmcnt(6)
  v_mfma_f32_32x32x16_bf16 v[80:95], v[236:239], v[164:167], v[80:95]
  ds_read_b64_tr_b16 v[252:253], v11 offset:6144
  ds_read_b64_tr_b16 v[254:255], v11 offset:7168
  s_waitcnt vmcnt(11) lgkmcnt(6)
  v_mfma_f32_32x32x16_bf16 v[64:79], v[240:243], v[168:171], v[64:79]
  ds_read_b64_tr_b16 v[224:225], v12 offset:0
  ds_read_b64_tr_b16 v[226:227], v12 offset:1024
  buffer_load_dwordx4 v[216:219], v3, s[4:7], s30 offen offset:2048
  s_waitcnt lgkmcnt(6)
  v_mfma_f32_32x32x16_bf16 v[80:95], v[244:247], v[168:171], v[80:95]
  ds_read_b64_tr_b16 v[228:229], v13 offset:0
  ds_read_b64_tr_b16 v[230:231], v13 offset:1024
  s_waitcnt vmcnt(11) lgkmcnt(6)
  v_mfma_f32_32x32x16_bf16 v[64:79], v[248:251], v[172:175], v[64:79]
  ds_read_b64_tr_b16 v[232:233], v12 offset:2048
  ds_read_b64_tr_b16 v[234:235], v12 offset:3072
  buffer_load_dwordx4 v[220:223], v3, s[4:7], s30 offen offset:3072
  s_waitcnt lgkmcnt(6)
  v_mfma_f32_32x32x16_bf16 v[80:95], v[252:255], v[172:175], v[80:95]
  ds_read_b64_tr_b16 v[236:237], v13 offset:2048
  ds_read_b64_tr_b16 v[238:239], v13 offset:3072
  s_andn2_b32 s33, s36, s34
  s_cbranch_scc0 .fz_kernel_pk50c
.fz_kernel_pk50:
  s_ff1_i32_b32 s33, s33
  s_bitset1_b32 s34, s33
  s_lshl_b32 s20, s33, 13
  s_lshl_b32 s33, s33, 12
  s_add_u32 s30, s33, s35
  s_waitcnt vmcnt(11) lgkmcnt(6)
  v_mfma_f32_32x32x16_bf16 v[64:79], v[224:227], v[176:179], v[64:79]
  v_add_u32 v10, s26, v14
  v_add_u32 v11, s26, v15
  ds_read_b64_tr_b16 v[240:241], v12 offset:4096
  ds_read_b64_tr_b16 v[242:243], v12 offset:5120
  buffer_load_dwordx4 v[96:99], v3, s[4:7], s30 offen offset:0
  s_waitcnt lgkmcnt(6)
  v_mfma_f32_32x32x16_bf16 v[80:95], v[228:231], v[176:179], v[80:95]
  ds_read_b64_tr_b16 v[244:245], v13 offset:4096
  ds_read_b64_tr_b16 v[246:247], v13 offset:5120
  s_waitcnt vmcnt(11) lgkmcnt(6)
  v_mfma_f32_32x32x16_bf16 v[64:79], v[232:235], v[180:183], v[64:79]
  ds_read_b64_tr_b16 v[248:249], v12 offset:6144
  ds_read_b64_tr_b16 v[250:251], v12 offset:7168
  buffer_load_dwordx4 v[100:103], v3, s[4:7], s30 offen offset:1024
  s_waitcnt lgkmcnt(6)
  v_mfma_f32_32x32x16_bf16 v[80:95], v[236:239], v[180:183], v[80:95]
  ds_read_b64_tr_b16 v[252:253], v13 offset:6144
  ds_read_b64_tr_b16 v[254:255], v13 offset:7168
  s_waitcnt vmcnt(11) lgkmcnt(6)
  v_mfma_f32_32x32x16_bf16 v[64:79], v[240:243], v[184:187], v[64:79]
  ds_read_b64_tr_b16 v[224:225], v10 offset:0
  ds_read_b64_tr_b16 v[226:227], v10 offset:1024
  buffer_load_dwordx4 v[104:107], v3, s[4:7], s30 offen offset:2048
  s_waitcnt lgkmcnt(6)
  v_mfma_f32_32x32x16_bf16 v[80:95], v[244:247], v[184:187], v[80:95]
  ds_read_b64_tr_b16 v[228:229], v11 offset:0
  ds_read_b64_tr_b16 v[230:231], v11 offset:1024
  s_waitcnt vmcnt(11) lgkmcnt(6)
  v_mfma_f32_32x32x16_bf16 v[64:79], v[248:251], v[188:191], v[64:79]
  ds_read_b64_tr_b16 v[232:233], v10 offset:2048
  ds_read_b64_tr_b16 v[234:235], v10 offset:3072
  buffer_load_dwordx4 v[108:111], v3, s[4:7], s30 offen offset:3072
  s_waitcnt lgkmcnt(6)
  v_mfma_f32_32x32x16_bf16 v[80:95], v[252:255], v[188:191], v[80:95]
  ds_read_b64_tr_b16 v[236:237], v11 offset:2048
  ds_read_b64_tr_b16 v[238:239], v11 offset:3072
  s_andn2_b32 s33, s36, s34
  s_cbranch_scc0 .fz_kernel_pk51c
.fz_kernel_pk51:
  s_ff1_i32_b32 s33, s33
  s_bitset1_b32 s34, s33
  s_lshl_b32 s21, s33, 13
  s_lshl_b32 s33, s33, 12
  s_add_u32 s30, s33, s35
  s_waitcnt vmcnt(11) lgkmcnt(6)
  v_mfma_f32_32x32x16_bf16 v[64:79], v[224:227], v[192:195], v[64:79]
  v_add_u32 v12, s27, v14
  v_add_u32 v13, s27, v15
  ds_read_b64_tr_b16 v[240:241], v10 offset:4096
  ds_read_b64_tr_b16 v[242:243], v10 offset:5120
  buffer_load_dwordx4 v[112:115], v3, s[4:7], s30 offen offset:0
  s_waitcnt lgkmcnt(6)
  v_mfma_f32_32x32x16_bf16 v[80:95], v[228:231], v[192:195], v[80:95]
  ds_read_b64_tr_b16 v[244:245], v11 offset:4096
  ds_read_b64_tr_b16 v[246:247], v11 offset:5120
  s_waitcnt vmcnt(11) lgkmcnt(6)
  v_mfma_f32_32x32x16_bf16 v[64:79], v[232:235], v[196:199], v[64:79]
  ds_read_b64_tr_b16 v[248:249], v10 offset:6144
  ds_read_b64_tr_b16 v[250:251], v10 offset:7168
  buffer_load_dwordx4 v[116:119], v3, s[4:7], s30 offen offset:1024
  s_waitcnt lgkmcnt(6)
  v_mfma_f32_32x32x16_bf16 v[80:95], v[236:239], v[196:199], v[80:95]
  ds_read_b64_tr_b16 v[252:253], v11 offset:6144
  ds_read_b64_tr_b16 v[254:255], v11 offset:7168
  s_waitcnt vmcnt(11) lgkmcnt(6)
  v_mfma_f32_32x32x16_bf16 v[64:79], v[240:243], v[200:203], v[64:79]
  ds_read_b64_tr_b16 v[224:225], v12 offset:0
  ds_read_b64_tr_b16 v[226:227], v12 offset:1024
  buffer_load_dwordx4 v[120:123], v3, s[4:7], s30 offen offset:2048
  s_waitcnt lgkmcnt(6)
  v_mfma_f32_32x32x16_bf16 v[80:95], v[244:247], v[200:203], v[80:95]
  ds_read_b64_tr_b16 v[228:229], v13 offset:0
  ds_read_b64_tr_b16 v[230:231], v13 offset:1024
  s_waitcnt vmcnt(11) lgkmcnt(6)
  v_mfma_f32_32x32x16_bf16 v[64:79], v[248:251], v[204:207], v[64:79]
  ds_read_b64_tr_b16 v[232:233], v12 offset:2048
  ds_read_b64_tr_b16 v[234:235], v12 offset:3072
  buffer_load_dwordx4 v[124:127], v3, s[4:7], s30 offen offset:3072
  s_waitcnt lgkmcnt(6)
  v_mfma_f32_32x32x16_bf16 v[80:95], v[252:255], v[204:207], v[80:95]
  ds_read_b64_tr_b16 v[236:237], v13 offset:2048
  ds_read_b64_tr_b16 v[238:239], v13 offset:3072
  s_andn2_b32 s33, s36, s34
  s_cbranch_scc0 .fz_kernel_pk52c
.fz_kernel_pk52:
  s_ff1_i32_b32 s33, s33
  s_bitset1_b32 s34, s33
  s_lshl_b32 s22, s33, 13
  s_lshl_b32 s33, s33, 12
  s_add_u32 s30, s33, s35
  s_waitcnt vmcnt(11) lgkmcnt(6)
  v_mfma_f32_32x32x16_bf16 v[64:79], v[224:227], v[208:211], v[64:79]
  v_add_u32 v10, s20, v14
  v_add_u32 v11, s20, v15
  ds_read_b64_tr_b16 v[240:241], v12 offset:4096
  ds_read_b64_tr_b16 v[242:243], v12 offset:5120
  buffer_load_dwordx4 v[128:131], v3, s[4:7], s30 offen offset:0
  s_waitcnt lgkmcnt(6)
  v_mfma_f32_32x32x16_bf16 v[80:95], v[228:231], v[208:211], v[80:95]
  ds_read_b64_tr_b16 v[244:245], v13 offset:4096
  ds_read_b64_tr_b16 v[246:247], v13 offset:5120
  s_waitcnt vmcnt(11) lgkmcnt(6)
  v_mfma_f32_32x32x16_bf16 v[64:79], v[232:235], v[212:215], v[64:79]
  ds_read_b64_tr_b16 v[248:249], v12 offset:6144
  ds_read_b64_tr_b16 v[250:251], v12 offset:7168
  buffer_load_dwordx4 v[132:135], v3, s[4:7], s30 offen offset:1024
  s_waitcnt lgkmcnt(6)
  v_mfma_f32_32x32x16_bf16 v[80:95], v[236:239], v[212:215], v[80:95]
  ds_read_b64_tr_b16 v[252:253], v13 offset:6144
  ds_read_b64_tr_b16 v[254:255], v13 offset:7168
  s_waitcnt vmcnt(11) lgkmcnt(6)
  v_mfma_f32_32x32x16_bf16 v[64:79], v[240:243], v[216:219], v[64:79]
  ds_read_b64_tr_b16 v[224:225], v10 offset:0
  ds_read_b64_tr_b16 v[226:227], v10 offset:1024
  buffer_load_dwordx4 v[136:139], v3, s[4:7], s30 offen offset:2048
  s_waitcnt lgkmcnt(6)
  v_mfma_f32_32x32x16_bf16 v[80:95], v[244:247], v[216:219], v[80:95]
  ds_read_b64_tr_b16 v[228:229], v11 offset:0
  ds_read_b64_tr_b16 v[230:231], v11 offset:1024
  s_waitcnt vmcnt(11) lgkmcnt(6)
  v_mfma_f32_32x32x16_bf16 v[64:79], v[248:251], v[220:223], v[64:79]
  ds_read_b64_tr_b16 v[232:233], v10 offset:2048
  ds_read_b64_tr_b16 v[234:235], v10 offset:3072
  buffer_load_dwordx4 v[140:143], v3, s[4:7], s30 offen offset:3072
  s_waitcnt lgkmcnt(6)
  v_mfma_f32_32x32x16_bf16 v[80:95], v[252:255], v[220:223], v[80:95]
  ds_read_b64_tr_b16 v[236:237], v11 offset:2048
  ds_read_b64_tr_b16 v[238:239], v11 offset:3072
  s_andn2_b32 s33, s36, s34
  s_cbranch_scc0 .fz_kernel_pk53c
.fz_kernel_pk53:
  s_ff1_i32_b32 s33, s33
  s_bitset1_b32 s34, s33
  s_lshl_b32 s23, s33, 13
  s_lshl_b32 s33, s33, 12
  s_add_u32 s30, s33, s35
  s_waitcnt vmcnt(11) lgkmcnt(6)
  v_mfma_f32_32x32x16_bf16 v[64:79], v[224:227], v[96:99], v[64:79]
  v_add_u32 v12, s21, v14
  v_add_u32 v13, s21, v15
  ds_read_b64_tr_b16 v[240:241], v10 offset:4096
  ds_read_b64_tr_b16 v[242:243], v10 offset:5120
  buffer_load_dwordx4 v[144:147], v3, s[4:7], s30 offen offset:0
  s_waitcnt lgkmcnt(6)
  v_mfma_f32_32x32x16_bf16 v[80:95], v[228:231], v[96:99], v[80:95]
  ds_read_b64_tr_b16 v[244:245], v11 offset:4096
  ds_read_b64_tr_b16 v[246:247], v11 offset:5120
  s_waitcnt vmcnt(11) lgkmcnt(6)
  v_mfma_f32_32x32x16_bf16 v[64:79], v[232:235], v[100:103], v[64:79]
  ds_read_b64_tr_b16 v[248:249], v10 offset:6144
  ds_read_b64_tr_b16 v[250:251], v10 offset:7168
  buffer_load_dwordx4 v[148:151], v3, s[4:7], s30 offen offset:1024
  s_waitcnt lgkmcnt(6)
  v_mfma_f32_32x32x16_bf16 v[80:95], v[236:239], v[100:103], v[80:95]
  ds_read_b64_tr_b16 v[252:253], v11 offset:6144
  ds_read_b64_tr_b16 v[254:255], v11 offset:7168
  s_waitcnt vmcnt(11) lgkmcnt(6)
  v_mfma_f32_32x32x16_bf16 v[64:79], v[240:243], v[104:107], v[64:79]
  ds_read_b64_tr_b16 v[224:225], v12 offset:0
  ds_read_b64_tr_b16 v[226:227], v12 offset:1024
  buffer_load_dwordx4 v[152:155], v3, s[4:7], s30 offen offset:2048
  s_waitcnt lgkmcnt(6)
  v_mfma_f32_32x32x16_bf16 v[80:95], v[244:247], v[104:107], v[80:95]
  ds_read_b64_tr_b16 v[228:229], v13 offset:0
  ds_read_b64_tr_b16 v[230:231], v13 offset:1024
  s_waitcnt vmcnt(11) lgkmcnt(6)
  v_mfma_f32_32x32x16_bf16 v[64:79], v[248:251], v[108:111], v[64:79]
  ds_read_b64_tr_b16 v[232:233], v12 offset:2048
  ds_read_b64_tr_b16 v[234:235], v12 offset:3072
  buffer_load_dwordx4 v[156:159], v3, s[4:7], s30 offen offset:3072
  s_waitcnt lgkmcnt(6)
  v_mfma_f32_32x32x16_bf16 v[80:95], v[252:255], v[108:111], v[80:95]
  ds_read_b64_tr_b16 v[236:237], v13 offset:2048
  ds_read_b64_tr_b16 v[238:239], v13 offset:3072
  s_andn2_b32 s33, s36, s34
  s_cbranch_scc0 .fz_kernel_pk54c
.fz_kernel_pk54:
  s_ff1_i32_b32 s33, s33
  s_bitset1_b32 s34, s33
  s_lshl_b32 s24, s33, 13
  s_lshl_b32 s33, s33, 12
  s_add_u32 s30, s33, s35
  s_waitcnt vmcnt(11) lgkmcnt(6)
  v_mfma_f32_32x32x16_bf16 v[64:79], v[224:227], v[112:115], v[64:79]
  v_add_u32 v10, s22, v14
  v_add_u32 v11, s22, v15
  ds_read_b64_tr_b16 v[240:241], v12 offset:4096
  ds_read_b64_tr_b16 v[242:243], v12 offset:5120
  buffer_load_dwordx4 v[160:163], v3, s[4:7], s30 offen offset:0
  s_waitcnt lgkmcnt(6)
  v_mfma_f32_32x32x16_bf16 v[80:95], v[228:231], v[112:115], v[80:95]
  ds_read_b64_tr_b16 v[244:245], v13 offset:4096
  ds_read_b64_tr_b16 v[246:247], v13 offset:5120
  s_waitcnt vmcnt(11) lgkmcnt(6)
  v_mfma_f32_32x32x16_bf16 v[64:79], v[232:235], v[116:119], v[64:79]
  ds_read_b64_tr_b16 v[248:249], v12 offset:6144
  ds_read_b64_tr_b16 v[250:251], v12 offset:7168
  buffer_load_dwordx4 v[164:167], v3, s[4:7], s30 offen offset:1024
  s_waitcnt lgkmcnt(6)
  v_mfma_f32_32x32x16_bf16 v[80:95], v[236:239], v[116:119], v[80:95]
  ds_read_b64_tr_b16 v[252:253], v13 offset:6144
  ds_read_b64_tr_b16 v[254:255], v13 offset:7168
  s_waitcnt vmcnt(11) lgkmcnt(6)
  v_mfma_f32_32x32x16_bf16 v[64:79], v[240:243], v[120:123], v[64:79]
  ds_read_b64_tr_b16 v[224:225], v10 offset:0
  ds_read_b64_tr_b16 v[226:227], v10 offset:1024
  buffer_load_dwordx4 v[168:171], v3, s[4:7], s30 offen offset:2048
  s_waitcnt lgkmcnt(6)
  v_mfma_f32_32x32x16_bf16 v[80:95], v[244:247], v[120:123], v[80:95]
  ds_read_b64_tr_b16 v[228:229], v11 offset:0
  ds_read_b64_tr_b16 v[230:231], v11 offset:1024
  s_waitcnt vmcnt(11) lgkmcnt(6)
  v_mfma_f32_32x32x16_bf16 v[64:79], v[248:251], v[124:127], v[64:79]
  ds_read_b64_tr_b16 v[232:233], v10 offset:2048
  ds_read_b64_tr_b16 v[234:235], v10 offset:3072
  buffer_load_dwordx4 v[172:175], v3, s[4:7], s30 offen offset:3072
  s_waitcnt lgkmcnt(6)
  v_mfma_f32_32x32x16_bf16 v[80:95], v[252:255], v[124:127], v[80:95]
  ds_read_b64_tr_b16 v[236:237], v11 offset:2048
  ds_read_b64_tr_b16 v[238:239], v11 offset:3072
  s_andn2_b32 s33, s36, s34
  s_cbranch_scc0 .fz_kernel_pk55c
.fz_kernel_pk55:
  s_ff1_i32_b32 s33, s33
  s_bitset1_b32 s34, s33
  s_lshl_b32 s25, s33, 13
  s_lshl_b32 s33, s33, 12
  s_add_u32 s30, s33, s35
  s_waitcnt vmcnt(11) lgkmcnt(6)
  v_mfma_f32_32x32x16_bf16 v[64:79], v[224:227], v[128:131], v[64:79]
  v_add_u32 v12, s23, v14
  v_add_u32 v13, s23, v15
  ds_read_b64_tr_b16 v[240:241], v10 offset:4096
  ds_read_b64_tr_b16 v[242:243], v10 offset:5120
  buffer_load_dwordx4 v[176:179], v3, s[4:7], s30 offen offset:0
  s_waitcnt lgkmcnt(6)
  v_mfma_f32_32x32x16_bf16 v[80:95], v[228:231], v[128:131], v[80:95]
  ds_read_b64_tr_b16 v[244:245], v11 offset:4096
  ds_read_b64_tr_b16 v[246:247], v11 offset:5120
  s_waitcnt vmcnt(11) lgkmcnt(6)
  v_mfma_f32_32x32x16_bf16 v[64:79], v[232:235], v[132:135], v[64:79]
  ds_read_b64_tr_b16 v[248:249], v10 offset:6144
  ds_read_b64_tr_b16 v[250:251], v10 offset:7168
  buffer_load_dwordx4 v[180:183], v3, s[4:7], s30 offen offset:1024
  s_waitcnt lgkmcnt(6)
  v_mfma_f32_32x32x16_bf16 v[80:95], v[236:239], v[132:135], v[80:95]
  ds_read_b64_tr_b16 v[252:253], v11 offset:6144
  ds_read_b64_tr_b16 v[254:255], v11 offset:7168
  s_waitcnt vmcnt(11) lgkmcnt(6)
  v_mfma_f32_32x32x16_bf16 v[64:79], v[240:243], v[136:139], v[64:79]
  ds_read_b64_tr_b16 v[224:225], v12 offset:0
  ds_read_b64_tr_b16 v[226:227], v12 offset:1024
  buffer_load_dwordx4 v[184:187], v3, s[4:7], s30 offen offset:2048
  s_waitcnt lgkmcnt(6)
  v_mfma_f32_32x32x16_bf16 v[80:95], v[244:247], v[136:139], v[80:95]
  ds_read_b64_tr_b16 v[228:229], v13 offset:0
  ds_read_b64_tr_b16 v[230:231], v13 offset:1024
  s_waitcnt vmcnt(11) lgkmcnt(6)
  v_mfma_f32_32x32x16_bf16 v[64:79], v[248:251], v[140:143], v[64:79]
  ds_read_b64_tr_b16 v[232:233], v12 offset:2048
  ds_read_b64_tr_b16 v[234:235], v12 offset:3072
  buffer_load_dwordx4 v[188:191], v3, s[4:7], s30 offen offset:3072
  s_waitcnt lgkmcnt(6)
  v_mfma_f32_32x32x16_bf16 v[80:95], v[252:255], v[140:143], v[80:95]
  ds_read_b64_tr_b16 v[236:237], v13 offset:2048
  ds_read_b64_tr_b16 v[238:239], v13 offset:3072
  s_andn2_b32 s33, s36, s34
  s_cbranch_scc0 .fz_kernel_pk56c
.fz_kernel_pk56:
  s_ff1_i32_b32 s33, s33
  s_bitset1_b32 s34, s33
  s_lshl_b32 s26, s33, 13
  s_lshl_b32 s33, s33, 12
  s_add_u32 s30, s33, s35
  s_waitcnt vmcnt(11) lgkmcnt(6)
  v_mfma_f32_32x32x16_bf16 v[64:79], v[224:227], v[144:147], v[64:79]
  v_add_u32 v10, s24, v14
  v_add_u32 v11, s24, v15
  ds_read_b64_tr_b16 v[240:241], v12 offset:4096
  ds_read_b64_tr_b16 v[242:243], v12 offset:5120
  buffer_load_dwordx4 v[192:195], v3, s[4:7], s30 offen offset:0
  s_waitcnt lgkmcnt(6)
  v_mfma_f32_32x32x16_bf16 v[80:95], v[228:231], v[144:147], v[80:95]
  ds_read_b64_tr_b16 v[244:245], v13 offset:4096
  ds_read_b64_tr_b16 v[246:247], v13 offset:5120
  s_waitcnt vmcnt(11) lgkmcnt(6)
  v_mfma_f32_32x32x16_bf16 v[64:79], v[232:235], v[148:151], v[64:79]
  ds_read_b64_tr_b16 v[248:249], v12 offset:6144
  ds_read_b64_tr_b16 v[250:251], v12 offset:7168
  buffer_load_dwordx4 v[196:199], v3, s[4:7], s30 offen offset:1024
  s_waitcnt lgkmcnt(6)
  v_mfma_f32_32x32x16_bf16 v[80:95], v[236:239], v[148:151], v[80:95]
  ds_read_b64_tr_b16 v[252:253], v13 offset:6144
  ds_read_b64_tr_b16 v[254:255], v13 offset:7168
  s_waitcnt vmcnt(11) lgkmcnt(6)
  v_mfma_f32_32x32x16_bf16 v[64:79], v[240:243], v[152:155], v[64:79]
  ds_read_b64_tr_b16 v[224:225], v10 offset:0
  ds_read_b64_tr_b16 v[226:227], v10 offset:1024
  buffer_load_dwordx4 v[200:203], v3, s[4:7], s30 offen offset:2048
  s_waitcnt lgkmcnt(6)
  v_mfma_f32_32x32x16_bf16 v[80:95], v[244:247], v[152:155], v[80:95]
  ds_read_b64_tr_b16 v[228:229], v11 offset:0
  ds_read_b64_tr_b16 v[230:231], v11 offset:1024
  s_waitcnt vmcnt(11) lgkmcnt(6)
  v_mfma_f32_32x32x16_bf16 v[64:79], v[248:251], v[156:159], v[64:79]
  ds_read_b64_tr_b16 v[232:233], v10 offset:2048
  ds_read_b64_tr_b16 v[234:235], v10 offset:3072
  buffer_load_dwordx4 v[204:207], v3, s[4:7], s30 offen offset:3072
  s_waitcnt lgkmcnt(6)
  v_mfma_f32_32x32x16_bf16 v[80:95], v[252:255], v[156:159], v[80:95]
  ds_read_b64_tr_b16 v[236:237], v11 offset:2048
  ds_read_b64_tr_b16 v[238:239], v11 offset:3072
  s_andn2_b32 s33, s36, s34
  s_cbranch_scc0 .fz_kernel_pk57c
.fz_kernel_pk57:
  s_ff1_i32_b32 s33, s33
  s_bitset1_b32 s34, s33
  s_lshl_b32 s27, s33, 13
  s_lshl_b32 s33, s33, 12
  s_add_u32 s30, s33, s35
  s_waitcnt vmcnt(11) lgkmcnt(6)
  v_mfma_f32_32x32x16_bf16 v[64:79], v[224:227], v[160:163], v[64:79]
  v_add_u32 v12, s25, v14
  v_add_u32 v13, s25, v15
  ds_read_b64_tr_b16 v[240:241], v10 offset:4096
  ds_read_b64_tr_b16 v[242:243], v10 offset:5120
  buffer_load_dwordx4 v[208:211], v3, s[4:7], s30 offen offset:0
  s_waitcnt lgkmcnt(6)
  v_mfma_f32_32x32x16_bf16 v[80:95], v[228:231], v[160:163], v[80:95]
  ds_read_b64_tr_b16 v[244:245], v11 offset:4096
  ds_read_b64_tr_b16 v[246:247], v11 offset:5120
  s_waitcnt vmcnt(11) lgkmcnt(6)
  v_mfma_f32_32x32x16_bf16 v[64:79], v[232:235], v[164:167], v[64:79]
  ds_read_b64_tr_b16 v[248:249], v10 offset:6144
  ds_read_b64_tr_b16 v[250:251], v10 offset:7168
  buffer_load_dwordx4 v[212:215], v3, s[4:7], s30 offen offset:1024
  s_waitcnt lgkmcnt(6)
  v_mfma_f32_32x32x16_bf16 v[80:95], v[236:239], v[164:167], v[80:95]
  ds_read_b64_tr_b16 v[252:253], v11 offset:6144
  ds_read_b64_tr_b16 v[254:255], v11 offset:7168
  s_waitcnt vmcnt(11) lgkmcnt(6)
  v_mfma_f32_32x32x16_bf16 v[64:79], v[240:243], v[168:171], v[64:79]
  ds_read_b64_tr_b16 v[224:225], v12 offset:0
  ds_read_b64_tr_b16 v[226:227], v12 offset:1024
  buffer_load_dwordx4 v[216:219], v3, s[4:7], s30 offen offset:2048
  s_waitcnt lgkmcnt(6)
  v_mfma_f32_32x32x16_bf16 v[80:95], v[244:247], v[168:171], v[80:95]
  ds_read_b64_tr_b16 v[228:229], v13 offset:0
  ds_read_b64_tr_b16 v[230:231], v13 offset:1024
  s_waitcnt vmcnt(11) lgkmcnt(6)
  v_mfma_f32_32x32x16_bf16 v[64:79], v[248:251], v[172:175], v[64:79]
  ds_read_b64_tr_b16 v[232:233], v12 offset:2048
  ds_read_b64_tr_b16 v[234:235], v12 offset:3072
  buffer_load_dwordx4 v[220:223], v3, s[4:7], s30 offen offset:3072
  s_waitcnt lgkmcnt(6)
  v_mfma_f32_32x32x16_bf16 v[80:95], v[252:255], v[172:175], v[80:95]
  ds_read_b64_tr_b16 v[236:237], v13 offset:2048
  ds_read_b64_tr_b16 v[238:239], v13 offset:3072
  s_waitcnt vmcnt(11) lgkmcnt(6)
  v_mfma_f32_32x32x16_bf16 v[64:79], v[224:227], v[176:179], v[64:79]
  v_add_u32 v10, s26, v14
  v_add_u32 v11, s26, v15
  ds_read_b64_tr_b16 v[240:241], v12 offset:4096
  ds_read_b64_tr_b16 v[242:243], v12 offset:5120
  s_waitcnt lgkmcnt(6)
  v_mfma_f32_32x32x16_bf16 v[80:95], v[228:231], v[176:179], v[80:95]
  ds_read_b64_tr_b16 v[244:245], v13 offset:4096
  ds_read_b64_tr_b16 v[246:247], v13 offset:5120
  s_waitcnt vmcnt(10) lgkmcnt(6)
  v_mfma_f32_32x32x16_bf16 v[64:79], v[232:235], v[180:183], v[64:79]
  ds_read_b64_tr_b16 v[248:249], v12 offset:6144
  ds_read_b64_tr_b16 v[250:251], v12 offset:7168
  s_waitcnt lgkmcnt(6)
  v_mfma_f32_32x32x16_bf16 v[80:95], v[236:239], v[180:183], v[80:95]
  ds_read_b64_tr_b16 v[252:253], v13 offset:6144
  ds_read_b64_tr_b16 v[254:255], v13 offset:7168
  s_waitcnt vmcnt(9) lgkmcnt(6)
  v_mfma_f32_32x32x16_bf16 v[64:79], v[240:243], v[184:187], v[64:79]
  ds_read_b64_tr_b16 v[224:225], v10 offset:0
  ds_read_b64_tr_b16 v[226:227], v10 offset:1024
  s_waitcnt lgkmcnt(6)
  v_mfma_f32_32x32x16_bf16 v[80:95], v[244:247], v[184:187], v[80:95]
  ds_read_b64_tr_b16 v[228:229], v11 offset:0
  ds_read_b64_tr_b16 v[230:231], v11 offset:1024
  s_waitcnt vmcnt(8) lgkmcnt(6)
  v_mfma_f32_32x32x16_bf16 v[64:79], v[248:251], v[188:191], v[64:79]
  ds_read_b64_tr_b16 v[232:233], v10 offset:2048
  ds_read_b64_tr_b16 v[234:235], v10 offset:3072
  s_waitcnt lgkmcnt(6)
  v_mfma_f32_32x32x16_bf16 v[80:95], v[252:255], v[188:191], v[80:95]
  ds_read_b64_tr_b16 v[236:237], v11 offset:2048
  ds_read_b64_tr_b16 v[238:239], v11 offset:3072
  s_waitcnt vmcnt(7) lgkmcnt(6)
  v_mfma_f32_32x32x16_bf16 v[64:79], v[224:227], v[192:195], v[64:79]
  v_add_u32 v12, s27, v14
  v_add_u32 v13, s27, v15
  ds_read_b64_tr_b16 v[240:241], v10 offset:4096
  ds_read_b64_tr_b16 v[242:243], v10 offset:5120
  s_waitcnt lgkmcnt(6)
  v_mfma_f32_32x32x16_bf16 v[80:95], v[228:231], v[192:195], v[80:95]
  ds_read_b64_tr_b16 v[244:245], v11 offset:4096
  ds_read_b64_tr_b16 v[246:247], v11 offset:5120
  s_waitcnt vmcnt(6) lgkmcnt(6)
  v_mfma_f32_32x32x16_bf16 v[64:79], v[232:235], v[196:199], v[64:79]
  ds_read_b64_tr_b16 v[248:249], v10 offset:6144
  ds_read_b64_tr_b16 v[250:251], v10 offset:7168
  s_waitcnt lgkmcnt(6)
  v_mfma_f32_32x32x16_bf16 v[80:95], v[236:239], v[196:199], v[80:95]
  ds_read_b64_tr_b16 v[252:253], v11 offset:6144
  ds_read_b64_tr_b16 v[254:255], v11 offset:7168
  s_waitcnt vmcnt(5) lgkmcnt(6)
  v_mfma_f32_32x32x16_bf16 v[64:79], v[240:243], v[200:203], v[64:79]
  ds_read_b64_tr_b16 v[224:225], v12 offset:0
  ds_read_b64_tr_b16 v[226:227], v12 offset:1024
  s_waitcnt lgkmcnt(6)
  v_mfma_f32_32x32x16_bf16 v[80:95], v[244:247], v[200:203], v[80:95]
  ds_read_b64_tr_b16 v[228:229], v13 offset:0
  ds_read_b64_tr_b16 v[230:231], v13 offset:1024
  s_waitcnt vmcnt(4) lgkmcnt(6)
  v_mfma_f32_32x32x16_bf16 v[64:79], v[248:251], v[204:207], v[64:79]
  ds_read_b64_tr_b16 v[232:233], v12 offset:2048
  ds_read_b64_tr_b16 v[234:235], v12 offset:3072
  s_waitcnt lgkmcnt(6)
  v_mfma_f32_32x32x16_bf16 v[80:95], v[252:255], v[204:207], v[80:95]
  ds_read_b64_tr_b16 v[236:237], v13 offset:2048
  ds_read_b64_tr_b16 v[238:239], v13 offset:3072
  s_waitcnt vmcnt(3) lgkmcnt(6)
  v_mfma_f32_32x32x16_bf16 v[64:79], v[224:227], v[208:211], v[64:79]
  ds_read_b64_tr_b16 v[240:241], v12 offset:4096
  ds_read_b64_tr_b16 v[242:243], v12 offset:5120
  s_waitcnt lgkmcnt(6)
  v_mfma_f32_32x32x16_bf16 v[80:95], v[228:231], v[208:211], v[80:95]
  ds_read_b64_tr_b16 v[244:245], v13 offset:4096
  ds_read_b64_tr_b16 v[246:247], v13 offset:5120
  s_waitcnt vmcnt(2) lgkmcnt(6)
  v_mfma_f32_32x32x16_bf16 v[64:79], v[232:235], v[212:215], v[64:79]
  ds_read_b64_tr_b16 v[248:249], v12 offset:6144
  ds_read_b64_tr_b16 v[250:251], v12 offset:7168
  s_waitcnt lgkmcnt(6)
  v_mfma_f32_32x32x16_bf16 v[80:95], v[236:239], v[212:215], v[80:95]
  ds_read_b64_tr_b16 v[252:253], v13 offset:6144
  ds_read_b64_tr_b16 v[254:255], v13 offset:7168
  s_waitcnt vmcnt(1) lgkmcnt(6)
  v_mfma_f32_32x32x16_bf16 v[64:79], v[240:243], v[216:219], v[64:79]
  s_waitcnt lgkmcnt(4)
  v_mfma_f32_32x32x16_bf16 v[80:95], v[244:247], v[216:219], v[80:95]
  s_waitcnt vmcnt(0) lgkmcnt(0)
  s_barrier
  v_mfma_f32_32x32x16_bf16 v[64:79], v[248:251], v[220:223], v[64:79]
  v_mfma_f32_32x32x16_bf16 v[80:95], v[252:255], v[220:223], v[80:95]
  s_mov_b32 s36, 0x3f803f80
  v_mov_b32 v8, 0
  v_mov_b32 v9, 0
  v_mov_b32 v10, 0
  v_mov_b32 v11, 0
  v_mov_b32 v12, 0
  v_mov_b32 v13, 0
  v_lshlrev_b32 v19, 2, v18
  v_lshl_add_u32 v19, v17, 13, v19
  s_lshl_b32 s34, s32, 7
  s_add_u32 s34, s34, s66
  s_add_u32 s34, s34, 16384
  s_add_u32 s37, s34, 16384
  v_cvt_pk_bf16_f32 v20, v64, v65
  v_cvt_pk_bf16_f32 v21, v66, v67
  v_cvt_pk_bf16_f32 v22, v68, v69
  v_cvt_pk_bf16_f32 v23, v70, v71
  buffer_store_dwordx4 v[20:23], v16, s[4:7], s39 offen offset:0 sc1
  v_cvt_pk_bf16_f32 v24, v72, v73
  v_cvt_pk_bf16_f32 v25, v74, v75
  v_cvt_pk_bf16_f32 v26, v76, v77
  v_cvt_pk_bf16_f32 v27, v78, v79
  buffer_store_dwordx4 v[24:27], v16, s[4:7], s39 offen offset:512 sc1
  v_cvt_pk_bf16_f32 v28, v80, v81
  v_cvt_pk_bf16_f32 v29, v82, v83
  v_cvt_pk_bf16_f32 v30, v84, v85
  v_cvt_pk_bf16_f32 v31, v86, v87
  buffer_store_dwordx4 v[28:31], v16, s[4:7], s39 offen offset:1024 sc1
  v_cvt_pk_bf16_f32 v32, v88, v89
  v_cvt_pk_bf16_f32 v33, v90, v91
  v_cvt_pk_bf16_f32 v34, v92, v93
  v_cvt_pk_bf16_f32 v35, v94, v95
  buffer_store_dwordx4 v[32:35], v16, s[4:7], s39 offen offset:1536 sc1
  v_dot2c_f32_bf16 v8, s36, v20
  v_dot2c_f32_bf16 v9, v20, v20
  v_dot2c_f32_bf16 v10, v20, v48
  v_dot2c_f32_bf16 v11, s36, v21
  v_dot2c_f32_bf16 v12, v21, v21
  v_dot2c_f32_bf16 v13, v21, v49
  v_dot2c_f32_bf16 v8, s36, v22
  v_dot2c_f32_bf16 v9, v22, v22
  v_dot2c_f32_bf16 v10, v22, v50
  v_dot2c_f32_bf16 v11, s36, v23
  v_dot2c_f32_bf16 v12, v23, v23
  v_dot2c_f32_bf16 v13, v23, v51
  v_dot2c_f32_bf16 v8, s36, v24
  v_dot2c_f32_bf16 v9, v24, v24
  v_dot2c_f32_bf16 v10, v24, v52
  v_dot2c_f32_bf16 v11, s36, v25
  v_dot2c_f32_bf16 v12, v25, v25
  v_dot2c_f32_bf16 v13, v25, v53
  v_dot2c_f32_bf16 v8, s36, v26
  v_dot2c_f32_bf16 v9, v26, v26
  v_dot2c_f32_bf16 v10, v26, v54
  v_dot2c_f32_bf16 v11, s36, v27
  v_dot2c_f32_bf16 v12, v27, v27
  v_dot2c_f32_bf16 v13, v27, v55
  v_dot2c_f32_bf16 v8, s36, v28
  v_dot2c_f32_bf16 v9, v28, v28
  v_dot2c_f32_bf16 v10, v28, v56
  v_dot2c_f32_bf16 v11, s36, v29
  v_dot2c_f32_bf16 v12, v29, v29
  v_dot2c_f32_bf16 v13, v29, v57
  v_dot2c_f32_bf16 v8, s36, v30
  v_dot2c_f32_bf16 v9, v30, v30
  v_dot2c_f32_bf16 v10, v30, v58
  v_dot2c_f32_bf16 v11, s36, v31
  v_dot2c_f32_bf16 v12, v31, v31
  v_dot2c_f32_bf16 v13, v31, v59
  v_dot2c_f32_bf16 v8, s36, v32
  v_dot2c_f32_bf16 v9, v32, v32
  v_dot2c_f32_bf16 v10, v32, v60
  v_dot2c_f32_bf16 v11, s36, v33
  v_dot2c_f32_bf16 v12, v33, v33
  v_dot2c_f32_bf16 v13, v33, v61
  v_dot2c_f32_bf16 v8, s36, v34
  v_dot2c_f32_bf16 v9, v34, v34
  v_dot2c_f32_bf16 v10, v34, v62
  v_dot2c_f32_bf16 v11, s36, v35
  v_dot2c_f32_bf16 v12, v35, v35
  v_dot2c_f32_bf16 v13, v35, v63
  s_nop 0
  v_add_f32 v36, v8, v11
  v_add_f32 v37, v9, v12
  v_add_f32 v38, v10, v13
  v_fma_f32 v38, -v36, v46, v38
  v_fmac_f32 v47, 0x44800000, v37
  v_mov_b32 v39, v38
  s_nop 0
  v_permlane32_swap_b32 v36, v47
  v_permlane32_swap_b32 v38, v39
  v_add_f32 v36, v36, v47
  v_add_f32 v38, v38, v39
  buffer_atomic_add_f32 v36, v19, s[4:7], s34 offen sc1
  s_mov_b32 exec_hi, 0
  buffer_atomic_add_f32 v38, v19, s[4:7], s37 offen sc1
  s_mov_b64 exec, -1
  s_mov_b32 s72, s66
  s_mov_b32 s73, s65
  s_mov_b32 s74, s67
  s_mov_b32 s75, s62
  s_cmp_lg_u32 s62, 0
  s_cbranch_scc1 .fz_kernel_tail
  s_mov_b32 s62, 1
  s_mov_b32 s63, 0x2000000
  s_mov_b32 s64, 0x2800000
  s_mov_b32 s65, 0x1400000
  s_mov_b32 s66, 0x1c42000
  s_mov_b32 s67, 12
  s_mov_b32 s71, 159776
  v_mov_b32 v6, 159832
  s_branch .fz_kernel_q_cons2
.fz_kernel_tail:
  s_mov_b32 s28, s56
  s_mov_b32 s29, s57
  s_mov_b32 s30, 0x400000
  s_mov_b32 s31, 0x00020000
  v_lshlrev_b32 v37, 2, v45
  v_add_u32 v37, 155644, v37
  v_mov_b32 v36, 159952
  v_lshlrev_b32 v38, 11, v18
  v_lshl_add_u32 v38, v17, 4, v38
  s_lshl_b32 s32, s32, 16
  s_lshl_b32 s33, s18, 7
  s_add_u32 s32, s32, s33
  v_lshlrev_b32 v64, 16, v20
  v_and_b32 v65, 0xffff0000, v20
  v_lshlrev_b32 v66, 16, v21
  v_and_b32 v67, 0xffff0000, v21
  v_lshlrev_b32 v68, 16, v22
  v_and_b32 v69, 0xffff0000, v22
  v_lshlrev_b32 v70, 16, v23
  v_and_b32 v71, 0xffff0000, v23
  v_lshlrev_b32 v72, 16, v24
  v_and_b32 v73, 0xffff0000, v24
  v_lshlrev_b32 v74, 16, v25
  v_and_b32 v75, 0xffff0000, v25
  v_lshlrev_b32 v76, 16, v26
  v_and_b32 v77, 0xffff0000, v26
  v_lshlrev_b32 v78, 16, v27
  v_and_b32 v79, 0xffff0000, v27
  v_lshlrev_b32 v80, 16, v28
  v_and_b32 v81, 0xffff0000, v28
  v_lshlrev_b32 v82, 16, v29
  v_and_b32 v83, 0xffff0000, v29
  v_lshlrev_b32 v84, 16, v30
  v_and_b32 v85, 0xffff0000, v30
  v_lshlrev_b32 v86, 16, v31
  v_and_b32 v87, 0xffff0000, v31
  v_lshlrev_b32 v88, 16, v32
  v_and_b32 v89, 0xffff0000, v32
  v_lshlrev_b32 v90, 16, v33
  v_and_b32 v91, 0xffff0000, v33
  v_lshlrev_b32 v92, 16, v34
  v_and_b32 v93, 0xffff0000, v34
  v_lshlrev_b32 v94, 16, v35
  v_and_b32 v95, 0xffff0000, v35
  s_waitcnt vmcnt(0)
  s_barrier
  s_barrier
  ds_read_b32 v40, v37 offset:6400
  ds_read_b32 v42, v37 offset:6912
  ds_read_b32 v36, v36
  s_waitcnt lgkmcnt(0)
  v_cmp_ne_u32 vcc, v36, v45
  s_mov_b64 exec, vcc
  v_pk_fma_f32 v[64:65], v[64:65], v[40:41], v[42:43] op_sel_hi:[1,0,0]
  v_pk_fma_f32 v[66:67], v[66:67], v[40:41], v[42:43] op_sel_hi:[1,0,0]
  v_pk_fma_f32 v[68:69], v[68:69], v[40:41], v[42:43] op_sel_hi:[1,0,0]
  v_pk_fma_f32 v[70:71], v[70:71], v[40:41], v[42:43] op_sel_hi:[1,0,0]
  v_cvt_pk_bf16_f32 v20, v64, v65
  v_cvt_pk_bf16_f32 v21, v66, v67
  v_cvt_pk_bf16_f32 v22, v68, v69
  v_cvt_pk_bf16_f32 v23, v70, v71
  buffer_store_dwordx4 v[20:23], v38, s[28:31], s32 offen offset:0
  v_pk_fma_f32 v[72:73], v[72:73], v[40:41], v[42:43] op_sel_hi:[1,0,0]
  v_pk_fma_f32 v[74:75], v[74:75], v[40:41], v[42:43] op_sel_hi:[1,0,0]
  v_pk_fma_f32 v[76:77], v[76:77], v[40:41], v[42:43] op_sel_hi:[1,0,0]
  v_pk_fma_f32 v[78:79], v[78:79], v[40:41], v[42:43] op_sel_hi:[1,0,0]
  v_cvt_pk_bf16_f32 v24, v72, v73
  v_cvt_pk_bf16_f32 v25, v74, v75
  v_cvt_pk_bf16_f32 v26, v76, v77
  v_cvt_pk_bf16_f32 v27, v78, v79
  buffer_store_dwordx4 v[24:27], v38, s[28:31], s32 offen offset:32
  v_pk_fma_f32 v[80:81], v[80:81], v[40:41], v[42:43] op_sel_hi:[1,0,0]
  v_pk_fma_f32 v[82:83], v[82:83], v[40:41], v[42:43] op_sel_hi:[1,0,0]
  v_pk_fma_f32 v[84:85], v[84:85], v[40:41], v[42:43] op_sel_hi:[1,0,0]
  v_pk_fma_f32 v[86:87], v[86:87], v[40:41], v[42:43] op_sel_hi:[1,0,0]
  v_cvt_pk_bf16_f32 v28, v80, v81
  v_cvt_pk_bf16_f32 v29, v82, v83
  v_cvt_pk_bf16_f32 v30, v84, v85
  v_cvt_pk_bf16_f32 v31, v86, v87
  buffer_store_dwordx4 v[28:31], v38, s[28:31], s32 offen offset:64
  v_pk_fma_f32 v[88:89], v[88:89], v[40:41], v[42:43] op_sel_hi:[1,0,0]
  v_pk_fma_f32 v[90:91], v[90:91], v[40:41], v[42:43] op_sel_hi:[1,0,0]
  v_pk_fma_f32 v[92:93], v[92:93], v[40:41], v[42:43] op_sel_hi:[1,0,0]
  v_pk_fma_f32 v[94:95], v[94:95], v[40:41], v[42:43] op_sel_hi:[1,0,0]
  v_cvt_pk_bf16_f32 v32, v88, v89
  v_cvt_pk_bf16_f32 v33, v90, v91
  v_cvt_pk_bf16_f32 v34, v92, v93
  v_cvt_pk_bf16_f32 v35, v94, v95
  buffer_store_dwordx4 v[32:35], v38, s[28:31], s32 offen offset:96
  s_mov_b64 exec, -1
  s_branch .fz_kernel_fin
.fz_kernel_chain:
  s_setprio 0
  s_bitcmp1_b32 s18, 0
  s_cselect_b32 s8, s52, s50
  s_cselect_b32 s9, s53, s51
  s_mov_b32 s10, 0x700000
  s_mov_b32 s11, 0x00020000
  s_lshl_b32 s12, s16, 8
  s_and_b32 s12, s12, 511
  s_and_b32 s31, s18, 2
  s_lshl_b32 s31, s31, 8
  s_add_u32 s12, s12, s31
  s_mul_i32 s12, s12, 7168
  s_lshl_b32 s31, s17, 2
  s_lshr_b32 s33, s18, 2
  s_add_u32 s31, s31, s33
  s_lshl_b32 s31, s31, 7
  s_add_u32 s12, s12, s31
  v_lshrrev_b32 v13, 3, v2
  v_mul_u32_u24 v13, 229376, v13
  v_and_b32 v11, 7, v2
  v_lshl_add_u32 v13, v11, 4, v13
  s_mov_b32 s24, s44
  s_mov_b32 s25, s45
  s_mov_b32 s26, 0x200000
  s_mov_b32 s27, 0x00020000
  v_lshrrev_b32 v8, 3, v2
  v_and_b32 v9, 7, v2
  v_bfe_u32 v10, v2, 4, 1
  v_lshlrev_b32 v10, 2, v10
  v_xor_b32 v9, v9, v10
  v_lshlrev_b32 v9, 4, v9
  v_lshl_add_u32 v10, v8, 11, v9
  s_mov_b32 s24, s54
  s_mov_b32 s25, s55
  s_mov_b32 s26, 0x700000
  s_mov_b32 s27, 0x00020000
  s_mov_b32 s36, 0x05040100
  s_mov_b32 s37, 0x07060302
  s_and_b32 s20, s16, 1
  s_lshl1_add_u32 s13, s17, s20
  s_lshl_b32 s13, s13, 18
  s_lshl_b32 s14, s18, 7
  s_add_u32 s13, s13, s14
  s_cmp_ge_u32 s17, 14
  s_cbranch_scc1 .fz_kernel_c_nl
  s_mov_b32 s38, 0
.fz_kernel_kw58:
  s_sleep 2
  ds_read_b32 v7, v6
  s_add_u32 s38, s38, 1
  s_waitcnt lgkmcnt(0)
  v_readfirstlane_b32 s31, v7
  s_bcnt1_i32_b32 s31, s31
  s_cmp_ge_u32 s31, 8
  s_cbranch_scc1 .fz_kernel_kw58d
  s_cmp_lt_u32 s38, 1048576
  s_cbranch_scc1 .fz_kernel_kw58
.fz_kernel_kw58d:
  buffer_load_dwordx4 v[112:115], v13, s[8:11], s12 offen
  s_add_u32 s12, s12, 7168
  s_waitcnt vmcnt(2)
  buffer_load_dwordx4 v[116:119], v13, s[8:11], s12 offen
  s_add_u32 s12, s12, 7168
  s_waitcnt vmcnt(2)
  buffer_load_dwordx4 v[120:123], v13, s[8:11], s12 offen
  s_add_u32 s12, s12, 7168
  s_waitcnt vmcnt(2)
  buffer_load_dwordx4 v[124:127], v13, s[8:11], s12 offen
  s_add_u32 s12, s12, 7168
  s_waitcnt vmcnt(2)
  buffer_load_dwordx4 v[128:131], v13, s[8:11], s12 offen
  s_add_u32 s12, s12, 7168
  s_waitcnt vmcnt(2)
  buffer_load_dwordx4 v[132:135], v13, s[8:11], s12 offen
  s_add_u32 s12, s12, 7168
  s_waitcnt vmcnt(2)
  buffer_load_dwordx4 v[136:139], v13, s[8:11], s12 offen
  s_add_u32 s12, s12, 7168
  s_waitcnt vmcnt(2)
  buffer_load_dwordx4 v[140:143], v13, s[8:11], s12 offen
  s_add_u32 s12, s12, 7168
  s_waitcnt vmcnt(2)
  buffer_load_dwordx4 v[144:147], v13, s[8:11], s12 offen
  s_add_u32 s12, s12, 7168
  s_waitcnt vmcnt(2)
  buffer_load_dwordx4 v[148:151], v13, s[8:11], s12 offen
  s_add_u32 s12, s12, 7168
  s_waitcnt vmcnt(2)
  buffer_load_dwordx4 v[152:155], v13, s[8:11], s12 offen
  s_add_u32 s12, s12, 7168
  s_waitcnt vmcnt(2)
  buffer_load_dwordx4 v[156:159], v13, s[8:11], s12 offen
  s_add_u32 s12, s12, 7168
  s_waitcnt vmcnt(2)
  buffer_load_dwordx4 v[160:163], v13, s[8:11], s12 offen
  s_add_u32 s12, s12, 7168
  s_waitcnt vmcnt(2)
  buffer_load_dwordx4 v[164:167], v13, s[8:11], s12 offen
  s_add_u32 s12, s12, 7168
  s_waitcnt vmcnt(2)
  buffer_load_dwordx4 v[168:171], v13, s[8:11], s12 offen
  s_add_u32 s12, s12, 7168
  s_waitcnt vmcnt(2)
  buffer_load_dwordx4 v[172:175], v13, s[8:11], s12 offen
  s_add_u32 s12, s12, 7168
  s_waitcnt vmcnt(2)
  buffer_load_dwordx4 v[176:179], v13, s[8:11], s12 offen
  s_add_u32 s12, s12, 7168
  s_waitcnt vmcnt(2)
  buffer_load_dwordx4 v[180:183], v13, s[8:11], s12 offen
  s_add_u32 s12, s12, 7168
  s_waitcnt vmcnt(2)
  buffer_load_dwordx4 v[184:187], v13, s[8:11], s12 offen
  s_add_u32 s12, s12, 7168
  s_waitcnt vmcnt(2)
  buffer_load_dwordx4 v[188:191], v13, s[8:11], s12 offen
  s_add_u32 s12, s12, 7168
  s_waitcnt vmcnt(2)
  buffer_load_dwordx4 v[192:195], v13, s[8:11], s12 offen
  s_add_u32 s12, s12, 7168
  s_waitcnt vmcnt(2)
  buffer_load_dwordx4 v[196:199], v13, s[8:11], s12 offen
  s_add_u32 s12, s12, 7168
  s_waitcnt vmcnt(2)
  buffer_load_dwordx4 v[200:203], v13, s[8:11], s12 offen
  s_add_u32 s12, s12, 7168
  s_waitcnt vmcnt(2)
  buffer_load_dwordx4 v[204:207], v13, s[8:11], s12 offen
  s_add_u32 s12, s12, 7168
  s_waitcnt vmcnt(2)
  buffer_load_dwordx4 v[208:211], v13, s[8:11], s12 offen
  s_add_u32 s12, s12, 7168
  s_waitcnt vmcnt(2)
  buffer_load_dwordx4 v[212:215], v13, s[8:11], s12 offen
  s_add_u32 s12, s12, 7168
  s_waitcnt vmcnt(2)
  buffer_load_dwordx4 v[216:219], v13, s[8:11], s12 offen
  s_add_u32 s12, s12, 7168
  s_waitcnt vmcnt(2)
  buffer_load_dwordx4 v[220:223], v13, s[8:11], s12 offen
  s_add_u32 s12, s12, 7168
  s_waitcnt vmcnt(2)
  buffer_load_dwordx4 v[224:227], v13, s[8:11], s12 offen
  s_add_u32 s12, s12, 7168
  s_waitcnt vmcnt(2)
  buffer_load_dwordx4 v[228:231], v13, s[8:11], s12 offen
  s_add_u32 s12, s12, 7168
  s_waitcnt vmcnt(2)
  buffer_load_dwordx4 v[232:235], v13, s[8:11], s12 offen
  s_add_u32 s12, s12, 7168
  s_waitcnt vmcnt(2)
  buffer_load_dwordx4 v[236:239], v13, s[8:11], s12 offen
  s_add_u32 s12, s12, 7168
  s_waitcnt vmcnt(2)
  buffer_load_dwordx4 v[32:35], v10, s[24:27], s13 offen
  s_add_u32 s13, s13, 16384
  s_waitcnt vmcnt(2)
  buffer_load_dwordx4 v[36:39], v10, s[24:27], s13 offen
  s_add_u32 s13, s13, 16384
  s_waitcnt vmcnt(2)
  buffer_load_dwordx4 v[40:43], v10, s[24:27], s13 offen
  s_add_u32 s13, s13, 16384
  s_waitcnt vmcnt(2)
  buffer_load_dwordx4 v[44:47], v10, s[24:27], s13 offen
  s_add_u32 s13, s13, 16384
  s_waitcnt vmcnt(2)
  buffer_load_dwordx4 v[48:51], v10, s[24:27], s13 offen
  s_add_u32 s13, s13, 16384
  s_waitcnt vmcnt(2)
  buffer_load_dwordx4 v[52:55], v10, s[24:27], s13 offen
  s_add_u32 s13, s13, 16384
  s_waitcnt vmcnt(2)
  buffer_load_dwordx4 v[56:59], v10, s[24:27], s13 offen
  s_add_u32 s13, s13, 16384
  s_waitcnt vmcnt(2)
  buffer_load_dwordx4 v[60:63], v10, s[24:27], s13 offen
  s_add_u32 s13, s13, 16384
  s_waitcnt vmcnt(2)
  buffer_load_dwordx4 v[64:67], v10, s[24:27], s13 offen
  s_add_u32 s13, s13, 16384
  s_waitcnt vmcnt(2)
  buffer_load_dwordx4 v[68:71], v10, s[24:27], s13 offen
  s_add_u32 s13, s13, 16384
  s_waitcnt vmcnt(2)
  buffer_load_dwordx4 v[72:75], v10, s[24:27], s13 offen
  s_add_u32 s13, s13, 16384
  s_waitcnt vmcnt(2)
  buffer_load_dwordx4 v[76:79], v10, s[24:27], s13 offen
  s_add_u32 s13, s13, 16384
  s_waitcnt vmcnt(2)
  buffer_load_dwordx4 v[240:243], v10, s[24:27], s13 offen
  s_add_u32 s13, s13, 16384
  s_waitcnt vmcnt(2)
  buffer_load_dwordx4 v[244:247], v10, s[24:27], s13 offen
  s_add_u32 s13, s13, 16384
  s_waitcnt vmcnt(2)
  buffer_load_dwordx4 v[248:251], v10, s[24:27], s13 offen
  s_add_u32 s13, s13, 16384
  s_waitcnt vmcnt(2)
  buffer_load_dwordx4 v[252:255], v10, s[24:27], s13 offen
  s_add_u32 s13, s13, 16384
  s_waitcnt vmcnt(2)
  v_mov_b32 v16, 0x3f803f80
  v_mov_b32 v17, 0x3f803f80
  v_mov_b32 v18, 0x3f803f80
  v_mov_b32 v19, 0x3f803f80
  s_waitcnt vmcnt(0)
  s_barrier
  v_perm_b32 v80, v116, v112, s36
  v_perm_b32 v84, v116, v112, s37
  v_perm_b32 v88, v117, v113, s36
  v_perm_b32 v92, v117, v113, s37
  v_perm_b32 v96, v118, v114, s36
  v_perm_b32 v100, v118, v114, s37
  v_perm_b32 v104, v119, v115, s36
  v_perm_b32 v108, v119, v115, s37
  v_perm_b32 v81, v124, v120, s36
  v_perm_b32 v85, v124, v120, s37
  v_perm_b32 v89, v125, v121, s36
  v_perm_b32 v93, v125, v121, s37
  v_perm_b32 v97, v126, v122, s36
  v_perm_b32 v101, v126, v122, s37
  v_perm_b32 v105, v127, v123, s36
  v_perm_b32 v109, v127, v123, s37
  v_perm_b32 v82, v132, v128, s36
  v_perm_b32 v86, v132, v128, s37
  v_perm_b32 v90, v133, v129, s36
  v_perm_b32 v94, v133, v129, s37
  v_perm_b32 v98, v134, v130, s36
  v_perm_b32 v102, v134, v130, s37
  v_perm_b32 v106, v135, v131, s36
  v_perm_b32 v110, v135, v131, s37
  v_perm_b32 v83, v140, v136, s36
  v_perm_b32 v87, v140, v136, s37
  v_perm_b32 v91, v141, v137, s36
  v_perm_b32 v95, v141, v137, s37
  v_perm_b32 v99, v142, v138, s36
  v_perm_b32 v103, v142, v138, s37
  v_perm_b32 v107, v143, v139, s36
  v_perm_b32 v111, v143, v139, s37
  v_perm_b32 v112, v148, v144, s36
  v_perm_b32 v116, v148, v144, s37
  v_perm_b32 v120, v149, v145, s36
  v_perm_b32 v124, v149, v145, s37
  v_perm_b32 v128, v150, v146, s36
  v_perm_b32 v132, v150, v146, s37
  v_perm_b32 v136, v151, v147, s36
  v_perm_b32 v140, v151, v147, s37
  v_perm_b32 v113, v156, v152, s36
  v_perm_b32 v117, v156, v152, s37
  v_perm_b32 v121, v157, v153, s36
  v_perm_b32 v125, v157, v153, s37
  v_perm_b32 v129, v158, v154, s36
  v_perm_b32 v133, v158, v154, s37
  v_perm_b32 v137, v159, v155, s36
  v_perm_b32 v141, v159, v155, s37
  v_perm_b32 v114, v164, v160, s36
  v_perm_b32 v118, v164, v160, s37
  v_perm_b32 v122, v165, v161, s36
  v_perm_b32 v126, v165, v161, s37
  v_perm_b32 v130, v166, v162, s36
  v_perm_b32 v134, v166, v162, s37
  v_perm_b32 v138, v167, v163, s36
  v_perm_b32 v142, v167, v163, s37
  v_perm_b32 v115, v172, v168, s36
  v_perm_b32 v119, v172, v168, s37
  v_perm_b32 v123, v173, v169, s36
  v_perm_b32 v127, v173, v169, s37
  v_perm_b32 v131, v174, v170, s36
  v_perm_b32 v135, v174, v170, s37
  v_perm_b32 v139, v175, v171, s36
  v_perm_b32 v143, v175, v171, s37
  v_perm_b32 v144, v180, v176, s36
  v_perm_b32 v148, v180, v176, s37
  v_perm_b32 v152, v181, v177, s36
  v_perm_b32 v156, v181, v177, s37
  v_perm_b32 v160, v182, v178, s36
  v_perm_b32 v164, v182, v178, s37
  v_perm_b32 v168, v183, v179, s36
  v_perm_b32 v172, v183, v179, s37
  v_perm_b32 v145, v188, v184, s36
  v_perm_b32 v149, v188, v184, s37
  v_perm_b32 v153, v189, v185, s36
  v_perm_b32 v157, v189, v185, s37
  v_perm_b32 v161, v190, v186, s36
  v_perm_b32 v165, v190, v186, s37
  v_perm_b32 v169, v191, v187, s36
  v_perm_b32 v173, v191, v187, s37
  v_perm_b32 v146, v196, v192, s36
  v_perm_b32 v150, v196, v192, s37
  v_perm_b32 v154, v197, v193, s36
  v_perm_b32 v158, v197, v193, s37
  v_perm_b32 v162, v198, v194, s36
  v_perm_b32 v166, v198, v194, s37
  v_perm_b32 v170, v199, v195, s36
  v_perm_b32 v174, v199, v195, s37
  v_perm_b32 v147, v204, v200, s36
  v_perm_b32 v151, v204, v200, s37
  v_perm_b32 v155, v205, v201, s36
  v_perm_b32 v159, v205, v201, s37
  v_perm_b32 v163, v206, v202, s36
  v_perm_b32 v167, v206, v202, s37
  v_perm_b32 v171, v207, v203, s36
  v_perm_b32 v175, v207, v203, s37
  v_perm_b32 v176, v212, v208, s36
  v_perm_b32 v180, v212, v208, s37
  v_perm_b32 v184, v213, v209, s36
  v_perm_b32 v188, v213, v209, s37
  v_perm_b32 v192, v214, v210, s36
  v_perm_b32 v196, v214, v210, s37
  v_perm_b32 v200, v215, v211, s36
  v_perm_b32 v204, v215, v211, s37
  v_perm_b32 v177, v220, v216, s36
  v_perm_b32 v181, v220, v216, s37
  v_perm_b32 v185, v221, v217, s36
  v_perm_b32 v189, v221, v217, s37
  v_perm_b32 v193, v222, v218, s36
  v_perm_b32 v197, v222, v218, s37
  v_perm_b32 v201, v223, v219, s36
  v_perm_b32 v205, v223, v219, s37
  v_perm_b32 v178, v228, v224, s36
  v_perm_b32 v182, v228, v224, s37
  v_perm_b32 v186, v229, v225, s36
  v_perm_b32 v190, v229, v225, s37
  v_perm_b32 v194, v230, v226, s36
  v_perm_b32 v198, v230, v226, s37
  v_perm_b32 v202, v231, v227, s36
  v_perm_b32 v206, v231, v227, s37
  v_perm_b32 v179, v236, v232, s36
  v_perm_b32 v183, v236, v232, s37
  v_perm_b32 v187, v237, v233, s36
  v_perm_b32 v191, v237, v233, s37
  v_perm_b32 v195, v238, v234, s36
  v_perm_b32 v199, v238, v234, s37
  v_perm_b32 v203, v239, v235, s36
  v_perm_b32 v207, v239, v235, s37
  v_mfma_f32_16x16x32_bf16 v[208:211], v[16:19], v[80:83], 0
  v_mfma_f32_16x16x32_bf16 v[212:215], v[16:19], v[84:87], 0
  v_mfma_f32_16x16x32_bf16 v[216:219], v[16:19], v[88:91], 0
  v_mfma_f32_16x16x32_bf16 v[220:223], v[16:19], v[92:95], 0
  v_mfma_f32_16x16x32_bf16 v[224:227], v[16:19], v[96:99], 0
  v_mfma_f32_16x16x32_bf16 v[228:231], v[16:19], v[100:103], 0
  v_mfma_f32_16x16x32_bf16 v[232:235], v[16:19], v[104:107], 0
  v_mfma_f32_16x16x32_bf16 v[236:239], v[16:19], v[108:111], 0
  v_mfma_f32_16x16x32_bf16 v[208:211], v[16:19], v[112:115], v[208:211]
  v_mfma_f32_16x16x32_bf16 v[212:215], v[16:19], v[116:119], v[212:215]
  v_mfma_f32_16x16x32_bf16 v[216:219], v[16:19], v[120:123], v[216:219]
  v_mfma_f32_16x16x32_bf16 v[220:223], v[16:19], v[124:127], v[220:223]
  v_mfma_f32_16x16x32_bf16 v[224:227], v[16:19], v[128:131], v[224:227]
  v_mfma_f32_16x16x32_bf16 v[228:231], v[16:19], v[132:135], v[228:231]
  v_mfma_f32_16x16x32_bf16 v[232:235], v[16:19], v[136:139], v[232:235]
  v_mfma_f32_16x16x32_bf16 v[236:239], v[16:19], v[140:143], v[236:239]
  v_mfma_f32_16x16x32_bf16 v[208:211], v[16:19], v[144:147], v[208:211]
  v_mfma_f32_16x16x32_bf16 v[212:215], v[16:19], v[148:151], v[212:215]
  v_mfma_f32_16x16x32_bf16 v[216:219], v[16:19], v[152:155], v[216:219]
  v_mfma_f32_16x16x32_bf16 v[220:223], v[16:19], v[156:159], v[220:223]
  v_mfma_f32_16x16x32_bf16 v[224:227], v[16:19], v[160:163], v[224:227]
  v_mfma_f32_16x16x32_bf16 v[228:231], v[16:19], v[164:167], v[228:231]
  v_mfma_f32_16x16x32_bf16 v[232:235], v[16:19], v[168:171], v[232:235]
  v_mfma_f32_16x16x32_bf16 v[236:239], v[16:19], v[172:175], v[236:239]
  v_mfma_f32_16x16x32_bf16 v[208:211], v[16:19], v[176:179], v[208:211]
  v_mfma_f32_16x16x32_bf16 v[212:215], v[16:19], v[180:183], v[212:215]
  v_mfma_f32_16x16x32_bf16 v[216:219], v[16:19], v[184:187], v[216:219]
  v_mfma_f32_16x16x32_bf16 v[220:223], v[16:19], v[188:191], v[220:223]
  v_mfma_f32_16x16x32_bf16 v[224:227], v[16:19], v[192:195], v[224:227]
  v_mfma_f32_16x16x32_bf16 v[228:231], v[16:19], v[196:199], v[228:231]
  v_mfma_f32_16x16x32_bf16 v[232:235], v[16:19], v[200:203], v[232:235]
  v_mfma_f32_16x16x32_bf16 v[236:239], v[16:19], v[204:207], v[236:239]
  s_nop 0
  v_add_f32 v28, v209, v208 row_ror:8 row_mask:0xf bank_mask:0x3
  v_add_f32 v29, v213, v212 row_ror:8 row_mask:0xf bank_mask:0x3
  v_add_f32 v30, v217, v216 row_ror:8 row_mask:0xf bank_mask:0x3
  v_add_f32 v31, v221, v220 row_ror:8 row_mask:0xf bank_mask:0x3
  v_add_f32 v28, v224, v225 row_ror:8 row_mask:0xf bank_mask:0xc
  v_add_f32 v29, v228, v229 row_ror:8 row_mask:0xf bank_mask:0xc
  v_add_f32 v30, v232, v233 row_ror:8 row_mask:0xf bank_mask:0xc
  v_add_f32 v31, v236, v237 row_ror:8 row_mask:0xf bank_mask:0xc
  v_mul_f32 v28, 0.0009765625, v28
  v_mul_f32 v29, 0.0009765625, v29
  v_mul_f32 v30, 0.0009765625, v30
  v_mul_f32 v31, 0.0009765625, v31
.fz_kernel_c_np:
  s_mov_b32 s72, s66
  s_mov_b32 s73, s65
  s_mov_b32 s74, s67
  s_mov_b32 s75, s62
  s_cmp_lg_u32 s62, 0
  s_cbranch_scc1 .fz_kernel_c_n2
  s_mov_b32 s62, 1
  s_mov_b32 s63, 0x2000000
  s_mov_b32 s64, 0x2800000
  s_mov_b32 s65, 0x1400000
  s_mov_b32 s66, 0x1c42000
  s_mov_b32 s67, 12
  s_mov_b32 s71, 159776
  v_mov_b32 v6, 159832
.fz_kernel_c_n2:
  s_lshr_b32 s21, s17, 3
  s_add_u32 s70, s18, s21
  s_lshl1_add_u32 s70, s17, s70
  s_and_b32 s70, s70, 15
  s_cmp_eq_u32 s75, 0
  s_cselect_b32 s3, 32, 0
  s_cselect_b32 s70, s70, s18
  s_and_b32 s20, s16, 1
  s_mov_b32 s34, 0x00030003
  s_mov_b32 s35, 0x00030003
  s_mov_b32 s71, 0
  s_lshl1_add_u32 s26, s17, s20
  v_lshrrev_b32 v8, 4, v2
  v_bfe_u32 v12, v2, 3, 1
  v_lshl_add_u32 v12, v12, 2, v8
  v_lshlrev_b32 v10, 7, v2
  s_lshl_b32 s25, s20, 1
  v_lshrrev_b32 v14, 4, v2
  v_bfe_u32 v15, v2, 2, 2
  v_lshl_add_u32 v16, v14, 3, v15
  v_lshlrev_b32 v16, 7, v16
  v_and_b32 v14, 1, v14
  v_lshrrev_b32 v15, 1, v15
  v_lshl_add_u32 v14, v14, 1, v15
  v_xor_b32 v14, s25, v14
  v_lshl_add_u32 v16, v14, 5, v16
  v_and_b32 v14, 3, v2
  v_lshl_add_u32 v16, v14, 3, v16
  v_add_u32 v7, 65536, v16
  v_xor_b32 v9, 32, v7
  s_add_u32 s21, s74, 0x1800008
  s_sub_u32 s22, s72, 32768
  v_mov_b32 v14, s21
  v_mov_b32 v15, s22
  v_cmp_gt_u32 vcc, 16, v2
  s_nop 1
  v_cndmask_b32 v14, v15, v14, vcc
  v_lshl_add_u32 v14, v2, 11, v14
  s_lshl_b32 s25, s17, 7
  s_lshl_b32 s22, 1, s18
  v_mov_b32 v15, s22
  v_lshlrev_b32 v16, 3, v2
  s_and_b32 s21, s2, 7
  s_lshl_b32 s21, s21, 11
  s_lshl_b32 s22, s20, 10
  s_add_u32 s21, s21, s22
  s_add_u32 s21, s21, s72
  s_lshl_b32 s22, s20, 12
  s_add_u32 s22, s22, s72
  s_add_u32 s22, s22, 16384
  s_add_u32 s23, s22, 8192
  s_add_u32 s24, s22, 16384
  v_and_b32 v17, 1, v8
  v_lshlrev_b32 v17, 13, v17
  v_lshrrev_b32 v18, 1, v8
  v_mul_u32_u24 v18, 320, v18
  v_add_u32 v17, v17, v18
  v_bfe_u32 v18, v2, 3, 1
  v_lshl_add_u32 v17, v18, 9, v17
  v_bfe_u32 v18, v2, 2, 1
  v_lshl_add_u32 v17, v18, 7, v17
  v_and_b32 v18, 3, v2
  v_lshl_add_u32 v17, v18, 3, v17
  s_lshl_b32 s27, s20, 14
  s_add_u32 s27, s27, 114688
  v_add_u32 v17, s27, v17
  v_xor_b32 v18, 64, v17
  v_and_b32 v19, 15, v2
  v_lshlrev_b32 v19, 6, v19
  v_lshl_add_u32 v19, v8, 4, v19
  v_and_b32 v20, 7, v2
  v_lshlrev_b32 v20, 5, v20
  v_and_b32 v21, 8, v2
  v_lshl_add_u32 v20, v21, 1, v20
  v_and_b32 v21, 31, v2
  v_lshlrev_b32 v21, 4, v21
  v_lshrrev_b32 v22, 5, v2
  v_lshl_add_u32 v21, v22, 11, v21
  v_mov_b32 v23, 0.0009765625
  v_mov_b32 v24, 9.5367431640625e-07
  v_mov_b32 v25, 1e-05
  v_add_u32 v26, 155648, v16
  s_lshl_b32 s14, s17, 9
  s_add_u32 s14, s14, s72
  s_add_u32 s14, s14, 16384
  s_add_u32 s15, s14, 8192
  v_add_u32 v13, s27, v3
  s_barrier
  ds_write_b128 v13, v[32:35] offset:0
  ds_write_b128 v13, v[36:39] offset:1024
  ds_write_b128 v13, v[40:43] offset:2048
  ds_write_b128 v13, v[44:47] offset:3072
  ds_write_b128 v13, v[48:51] offset:4096
  ds_write_b128 v13, v[52:55] offset:5120
  ds_write_b128 v13, v[56:59] offset:6144
  ds_write_b128 v13, v[60:63] offset:7168
  ds_write_b128 v13, v[64:67] offset:8192
  ds_write_b128 v13, v[68:71] offset:9216
  ds_write_b128 v13, v[72:75] offset:10240
  ds_write_b128 v13, v[76:79] offset:11264
  ds_write_b128 v13, v[240:243] offset:12288
  ds_write_b128 v13, v[244:247] offset:13312
  ds_write_b128 v13, v[248:251] offset:14336
  ds_write_b128 v13, v[252:255] offset:15360
.fz_kernel_c_n3:
  s_mov_b32 s13, 0xffffff
  s_cmp_eq_u32 s20, 0
  s_barrier
  s_cbranch_scc1 .fz_kernel_c_nf
  s_cmp_eq_u32 s75, 0
  s_cselect_b32 exec_lo, 0xffff, s13
  s_mov_b32 exec_hi, 0
  buffer_atomic_or v15, v14, s[4:7], s25 offen sc1
  s_mov_b64 exec, -1
.fz_kernel_c_nf:
  v_and_b32 v14, 1, v2
  v_lshlrev_b32 v14, 10, v14
  v_lshl_add_u32 v14, v8, 14, v14
  s_waitcnt lgkmcnt(0)
  s_cmp_lg_u32 s75, 0
  s_cbranch_scc1 .fz_kernel_c_nw
  ds_read_b64_tr_b16 v[32:33], v7 offset:0
  ds_read_b64_tr_b16 v[34:35], v7 offset:512
  ds_read_b64_tr_b16 v[36:37], v9 offset:0
  ds_read_b64_tr_b16 v[38:39], v9 offset:512
  ds_read_b64_tr_b16 v[40:41], v7 offset:4096
  ds_read_b64_tr_b16 v[42:43], v7 offset:4608
  ds_read_b64_tr_b16 v[44:45], v9 offset:4096
  ds_read_b64_tr_b16 v[46:47], v9 offset:4608
  ds_read_b64_tr_b16 v[48:49], v7 offset:8192
  ds_read_b64_tr_b16 v[50:51], v7 offset:8704
  ds_read_b64_tr_b16 v[52:53], v9 offset:8192
  ds_read_b64_tr_b16 v[54:55], v9 offset:8704
  s_waitcnt lgkmcnt(0)
  ds_read_b64_tr_b16 v[56:57], v7 offset:12288
  ds_read_b64_tr_b16 v[58:59], v7 offset:12800
  ds_read_b64_tr_b16 v[60:61], v9 offset:12288
  ds_read_b64_tr_b16 v[62:63], v9 offset:12800
  ds_read_b64_tr_b16 v[64:65], v7 offset:16384
  ds_read_b64_tr_b16 v[66:67], v7 offset:16896
  ds_read_b64_tr_b16 v[68:69], v9 offset:16384
  ds_read_b64_tr_b16 v[70:71], v9 offset:16896
  ds_read_b64_tr_b16 v[72:73], v7 offset:20480
  ds_read_b64_tr_b16 v[74:75], v7 offset:20992
  ds_read_b64_tr_b16 v[76:77], v9 offset:20480
  ds_read_b64_tr_b16 v[78:79], v9 offset:20992
  s_waitcnt lgkmcnt(0)
  s_lshl_b32 s21, s18, 8
  s_add_u32 s21, s21, s72
  s_cmp_lg_u32 s20, 0
  s_cbranch_scc1 .fz_kernel_c_c2
  s_add_u32 s22, s19, s74
  s_add_u32 s23, s14, 16384
  s_mov_b64 exec, 1
  s_mov_b32 s38, 0
.fz_kernel_c_c0:
  buffer_load_dword v9, v4, s[4:7], s22 offen offset:8 sc1
  s_add_u32 s38, s38, 1
  s_waitcnt vmcnt(0)
  v_cmp_ne_u32 vcc, 0xffff, v9
  s_cbranch_vccz .fz_kernel_c_c1
  s_cmp_lt_u32 s38, 131072
  s_cbranch_scc1 .fz_kernel_c_c0
.fz_kernel_c_c1:
  s_mov_b64 exec, -1
  buffer_load_dwordx2 v[240:241], v16, s[4:7], s14 offen
  buffer_load_dwordx2 v[242:243], v16, s[4:7], s15 offen
  buffer_load_dwordx2 v[244:245], v16, s[4:7], s23 offen
  s_lshl_b32 s23, s17, 4
  s_add_u32 s23, s23, s21
  s_lshl_b32 s24, s17, 7
  s_add_u32 s24, s24, 1
  s_waitcnt vmcnt(0)
  v_fma_f32 v208, -v240, v240, v242
  v_fma_f32 v209, -v241, v241, v243
  v_rsq_f32 v208, abs(v208)
  v_rsq_f32 v209, abs(v209)
  v_mul_f32 v208, v208, v244
  v_mul_f32 v209, v209, v245
  v_and_b32 v208, -2, v208
  v_or_b32 v209, 1, v209
  v_cmp_gt_f32 vcc, v209, v208
  v_max_f32 v9, v208, v209
  s_nop 0
  v_cndmask_b32 v210, v240, v241, vcc
  v_max_f32 v7, v9, v9 row_ror:8 row_mask:0xf bank_mask:0xf
  v_cndmask_b32 v211, v242, v243, vcc
  s_nop 0
  v_max_f32 v7, v7, v7 row_ror:4 row_mask:0xf bank_mask:0xf
  s_nop 1
  v_max_f32 v7, v7, v7 row_ror:2 row_mask:0xf bank_mask:0xf
  s_nop 1
  v_max_f32 v7, v7, v7 row_ror:1 row_mask:0xf bank_mask:0xf
  s_nop 1
  v_max_f32 v7, v7, v7 row_bcast:15 row_mask:0xa bank_mask:0xf
  s_nop 1
  v_max_f32 v7, v7, v7 row_bcast:31 row_mask:0xc bank_mask:0xf
  v_and_b32 v209, 1, v9
  v_lshl_add_u32 v209, v2, 1, v209
  v_readlane_b32 s22, v7, 63
  v_add_u32 v209, s24, v209
  v_mov_b32 v208, v9
  v_cmp_eq_u32 vcc, s22, v9
  s_ff1_i32_b64 s22, vcc
  s_lshl_b64 exec, 1, s22
  buffer_store_dwordx4 v[208:211], v4, s[4:7], s23 offen sc1
  s_mov_b64 exec, -1
  s_call_b64 s[68:69], .fz_kernel_c_coef
  ds_write_b64 v26, v[248:249] offset:4608
  ds_write_b64 v26, v[250:251] offset:5120
  ds_write_b64 v26, v[252:253] offset:6400
  ds_write_b64 v26, v[254:255] offset:6912
.fz_kernel_c_c2:
  s_cmp_eq_u32 s3, 0
  s_cbranch_scc1 .fz_kernel_hb59
  s_barrier
  s_sub_u32 s3, s3, 1
.fz_kernel_hb59:
.fz_kernel_c_c3:
  s_mov_b64 exec, 0xffff
  s_mov_b32 s38, 0
.fz_kernel_c_c4:
  buffer_load_dwordx4 v[224:227], v3, s[4:7], s21 offen sc1
  s_add_u32 s38, s38, 1
  s_mov_b32 s46, 0
  s_call_b64 s[0:1], .fz_kernel_hw
  s_waitcnt vmcnt(0)
  v_min_u32 v9, v225, v227
  v_max_f32 v7, v224, v224 row_ror:8 row_mask:0xf bank_mask:0xf
  v_cmp_eq_u32 vcc, 0, v9
  s_cbranch_vccz .fz_kernel_c_c5
  s_cmp_lt_u32 s38, 131072
  s_cbranch_scc1 .fz_kernel_c_c4
.fz_kernel_c_c5:
  s_waitcnt lgkmcnt(0)
  v_max_f32 v7, v7, v7 row_ror:4 row_mask:0xf bank_mask:0xf
  s_nop 1
  v_max_f32 v7, v7, v7 row_ror:2 row_mask:0xf bank_mask:0xf
  s_nop 1
  v_max_f32 v7, v7, v7 row_ror:1 row_mask:0xf bank_mask:0xf
  v_cmp_eq_u32 vcc, v7, v224
  s_or_b32 s22, vcc_lo, 0x8000
  s_ff1_i32_b32 s22, s22
  v_readlane_b32 s77, v225, s22
  v_readlane_b32 s27, v224, s22
  v_readlane_b32 s23, v226, s22
  v_readlane_b32 s24, v227, s22
  s_mov_b64 exec, -1
  v_mov_b32 v11, s23
  v_mov_b32 v15, s24
  s_branch .fz_kernel_c_idx
.fz_kernel_c_nw:
  s_mov_b64 exec, 0xff
  s_mov_b32 s38, 0
.fz_kernel_c_gm:
  buffer_load_dword v9, v10, s[4:7], s21 offen sc1
  s_add_u32 s38, s38, 1
  s_mov_b32 s46, 0
  s_call_b64 s[0:1], .fz_kernel_hw
  s_waitcnt vmcnt(0)
  v_cmp_ne_u32 vcc, 0xffff, v9
  s_cbranch_vccz .fz_kernel_c_gmd
  s_cmp_eq_u32 s3, 0
  s_cbranch_scc1 .fz_kernel_hb60
  s_barrier
  s_sub_u32 s3, s3, 1
.fz_kernel_hb60:
  s_cmp_lt_u32 s38, 131072
  s_cbranch_scc1 .fz_kernel_c_gm
.fz_kernel_c_gmd:
  s_mov_b64 exec, -1
  buffer_load_dwordx4 v[208:211], v3, s[4:7], s22 offen offset:0
  buffer_load_dwordx4 v[212:215], v3, s[4:7], s23 offen offset:0
  buffer_load_dwordx4 v[216:219], v3, s[4:7], s24 offen offset:0
  buffer_load_dwordx4 v[220:223], v3, s[4:7], s22 offen offset:1024
  buffer_load_dwordx4 v[224:227], v3, s[4:7], s23 offen offset:1024
  buffer_load_dwordx4 v[228:231], v3, s[4:7], s24 offen offset:1024
  buffer_load_dwordx4 v[232:235], v3, s[4:7], s22 offen offset:2048
  buffer_load_dwordx4 v[236:239], v3, s[4:7], s23 offen offset:2048
  buffer_load_dwordx4 v[240:243], v3, s[4:7], s24 offen offset:2048
  buffer_load_dwordx4 v[244:247], v3, s[4:7], s22 offen offset:3072
  buffer_load_dwordx4 v[248:251], v3, s[4:7], s23 offen offset:3072
  buffer_load_dwordx4 v[252:255], v3, s[4:7], s24 offen offset:3072
  s_lshl_b32 s21, s75, 4
  s_add_u32 s21, s21, 159968
  v_mov_b32 v10, s21
  s_lshl_b32 s22, s20, 3
  v_add_u32 v13, s22, v10
  s_mov_b32 s46, 6
  s_call_b64 s[0:1], .fz_kernel_hw
  s_waitcnt vmcnt(6)
  s_waitcnt vmcnt(10)
  v_fma_f32 v212, -v208, v208, v212
  v_fma_f32 v213, -v209, v209, v213
  v_fma_f32 v214, -v210, v210, v214
  v_fma_f32 v215, -v211, v211, v215
  s_cmp_eq_u32 s3, 0
  s_cbranch_scc1 .fz_kernel_hb68
  s_barrier
  s_sub_u32 s3, s3, 1
.fz_kernel_hb68:
  v_rsq_f32 v212, abs(v212)
  v_rsq_f32 v213, abs(v213)
  v_rsq_f32 v214, abs(v214)
  v_rsq_f32 v215, abs(v215)
  s_waitcnt vmcnt(9)
  v_mul_f32 v216, v216, v212
  v_mul_f32 v217, v217, v213
  v_mul_f32 v218, v218, v214
  v_mul_f32 v219, v219, v215
  v_and_or_b32 v216, v216, -16, 0
  v_and_or_b32 v217, v217, -16, 1
  v_and_or_b32 v218, v218, -16, 2
  v_and_or_b32 v219, v219, -16, 3
  v_max3_f32 v9, v216, v217, v218
  v_max_f32 v9, v9, v219
  s_waitcnt vmcnt(7)
  v_fma_f32 v224, -v220, v220, v224
  v_fma_f32 v225, -v221, v221, v225
  v_fma_f32 v226, -v222, v222, v226
  v_fma_f32 v227, -v223, v223, v227
  v_rsq_f32 v224, abs(v224)
  v_rsq_f32 v225, abs(v225)
  v_rsq_f32 v226, abs(v226)
  v_rsq_f32 v227, abs(v227)
  s_waitcnt vmcnt(6)
  v_mul_f32 v228, v228, v224
  v_mul_f32 v229, v229, v225
  v_mul_f32 v230, v230, v226
  v_mul_f32 v231, v231, v227
  s_cmp_eq_u32 s3, 0
  s_cbranch_scc1 .fz_kernel_hb69
  s_barrier
  s_sub_u32 s3, s3, 1
.fz_kernel_hb69:
  v_and_or_b32 v228, v228, -16, 4
  v_and_or_b32 v229, v229, -16, 5
  v_and_or_b32 v230, v230, -16, 6
  v_and_or_b32 v231, v231, -16, 7
  v_max3_f32 v9, v9, v228, v229
  v_max3_f32 v9, v9, v230, v231
  s_waitcnt vmcnt(4)
  v_fma_f32 v236, -v232, v232, v236
  v_fma_f32 v237, -v233, v233, v237
  v_fma_f32 v238, -v234, v234, v238
  v_fma_f32 v239, -v235, v235, v239
  v_rsq_f32 v236, abs(v236)
  v_rsq_f32 v237, abs(v237)
  v_rsq_f32 v238, abs(v238)
  v_rsq_f32 v239, abs(v239)
  s_waitcnt vmcnt(3)
  v_mul_f32 v240, v240, v236
  v_mul_f32 v241, v241, v237
  v_mul_f32 v242, v242, v238
  v_mul_f32 v243, v243, v239
  v_and_or_b32 v240, v240, -16, 8
  v_and_or_b32 v241, v241, -16, 9
  v_and_or_b32 v242, v242, -16, 10
  v_and_or_b32 v243, v243, -16, 11
  v_max3_f32 v9, v9, v240, v241
  v_max3_f32 v9, v9, v242, v243
  s_waitcnt vmcnt(1)
  v_fma_f32 v248, -v244, v244, v248
  v_fma_f32 v249, -v245, v245, v249
  v_fma_f32 v250, -v246, v246, v250
  v_fma_f32 v251, -v247, v247, v251
  v_rsq_f32 v248, abs(v248)
  s_cmp_eq_u32 s3, 0
  s_cbranch_scc1 .fz_kernel_hb70
  s_barrier
  s_sub_u32 s3, s3, 1
.fz_kernel_hb70:
  v_rsq_f32 v249, abs(v249)
  v_rsq_f32 v250, abs(v250)
  v_rsq_f32 v251, abs(v251)
  s_waitcnt vmcnt(0)
  v_mul_f32 v252, v252, v248
  v_mul_f32 v253, v253, v249
  v_mul_f32 v254, v254, v250
  v_mul_f32 v255, v255, v251
  v_and_or_b32 v252, v252, -16, 12
  v_and_or_b32 v253, v253, -16, 13
  v_and_or_b32 v254, v254, -16, 14
  v_and_or_b32 v255, v255, -16, 15
  v_max3_f32 v9, v9, v252, v253
  v_max3_f32 v9, v9, v254, v255
  s_nop 1
  v_max_f32 v7, v9, v9 row_ror:8 row_mask:0xf bank_mask:0xf
  s_nop 1
  v_max_f32 v7, v7, v7 row_ror:4 row_mask:0xf bank_mask:0xf
  s_nop 1
  v_max_f32 v7, v7, v7 row_ror:2 row_mask:0xf bank_mask:0xf
  s_nop 1
  v_max_f32 v7, v7, v7 row_ror:1 row_mask:0xf bank_mask:0xf
  s_nop 1
  v_max_f32 v7, v7, v7 row_bcast:15 row_mask:0xa bank_mask:0xf
  s_nop 1
  v_max_f32 v7, v7, v7 row_bcast:31 row_mask:0xc bank_mask:0xf
  s_nop 0
  v_readlane_b32 s21, v7, 63
  s_nop 1
  v_cmp_eq_u32 vcc, s21, v9
  s_ff1_i32_b64 s22, vcc
  s_lshl_b32 s22, s22, 2
  s_and_b32 s23, s21, 3
  s_add_u32 s22, s22, s23
  s_and_b32 s23, s21, 12
  s_lshl_b32 s23, s23, 6
  s_add_u32 s22, s22, s23
  s_and_b32 s22, s22, 1023
  s_lshl_b32 s23, s20, 10
  s_add_u32 s22, s22, s23
  s_add_u32 s22, s22, 1
  v_mov_b32 v224, s21
  v_mov_b32 v225, s22
  s_mov_b64 exec, 1
  ds_write_b64 v13, v[224:225]
  s_mov_b32 s38, 0
.fz_kernel_c_am:
  s_cmp_eq_u32 s3, 0
  s_cbranch_scc1 .fz_kernel_hb71
  s_barrier
  s_sub_u32 s3, s3, 1
.fz_kernel_hb71:
  ds_read_b128 v[224:227], v10
  s_add_u32 s38, s38, 1
  s_waitcnt lgkmcnt(0)
  v_min_u32 v9, v225, v227
  v_cmp_eq_u32 vcc, 0, v9
  s_cbranch_vccz .fz_kernel_c_amd
  s_cmp_eq_u32 s3, 0
  s_cbranch_scc1 .fz_kernel_hb61
  s_barrier
  s_sub_u32 s3, s3, 1
.fz_kernel_hb61:
  s_cmp_lt_u32 s38, 524288
  s_cbranch_scc1 .fz_kernel_c_am
.fz_kernel_c_amd:
  v_cmp_gt_f32 vcc, v226, v224
  s_nop 1
  v_cndmask_b32 v225, v225, v227, vcc
  v_cndmask_b32 v224, v224, v226, vcc
  v_readfirstlane_b32 s77, v225
  v_readfirstlane_b32 s27, v224
  s_mov_b64 exec, -1
  s_sub_u32 s21, s77, 1
  s_and_b32 s21, s21, 2047
  s_lshl_b32 s21, s21, 2
  s_add_u32 s21, s21, s72
  s_add_u32 s21, s21, 16384
  s_add_u32 s22, s21, 8192
  buffer_load_dword v11, v4, s[4:7], s21 offen
  buffer_load_dword v15, v4, s[4:7], s22 offen
.fz_kernel_c_idx:
  s_mov_b64 exec, s[34:35]
  s_sub_u32 s77, s77, 1
  s_and_b32 s77, s77, 2047
  s_lshr_b32 s78, s77, 7
  s_lshl_b32 s78, s78, 18
  s_and_b32 s21, s77, 0x70
  s_lshl_b32 s21, s21, 7
  s_add_u32 s78, s78, s21
  s_and_b32 s21, s77, 15
  s_lshl_b32 s21, s21, 4
  s_add_u32 s78, s78, s21
  s_add_u32 s78, s78, s73
  s_and_b32 s25, s18, 2
  s_add_u32 s25, s25, s20
  s_lshl_b32 s21, s25, 16
  s_add_u32 s21, s21, s78
  buffer_load_dwordx4 v[208:211], v14, s[4:7], s21 offen offset:0
  buffer_load_dwordx4 v[212:215], v14, s[4:7], s21 offen offset:256
  buffer_load_dwordx4 v[216:219], v14, s[4:7], s21 offen offset:512
  buffer_load_dwordx4 v[220:223], v14, s[4:7], s21 offen offset:768
  s_mov_b64 exec, -1
  s_lshr_b32 s21, s77, 7
  s_and_b32 s79, s77, 127
  s_add_u32 s79, s79, 1
  s_cmp_eq_u32 s21, s17
  s_cselect_b32 s79, s79, 0
  s_and_b32 s21, s18, 1
  s_lshl_b32 s21, s21, 2
  s_add_u32 s21, s21, s25
  s_lshl_b32 s21, s21, 9
  s_lshl_b32 s22, s17, 13
  s_add_u32 s21, s21, s22
  s_and_b32 s22, s18, 8
  s_lshl_b32 s22, s22, 9
  s_add_u32 s21, s21, s22
  s_and_b32 s22, s18, 4
  s_lshl_b32 s22, s22, 6
  s_add_u32 s21, s21, s22
  s_add_u32 s21, s21, s72
  s_add_u32 s21, s21, 40960
  s_cmp_eq_u32 s3, 0
  s_cbranch_scc1 .fz_kernel_hb72
  s_barrier
  s_sub_u32 s3, s3, 1
.fz_kernel_hb72:
  v_mov_b32 v1, -1477.3197218702985
  v_mul_f32 v1, s27, v1
  v_exp_f32 v1, v1
  s_nop 0
  v_add_f32 v1, 1.0, v1
  v_rcp_f32 v1, v1
  v_and_b32 v14, 8, v2
  v_lshlrev_b32 v14, 7, v14
  v_lshl_add_u32 v14, v8, 8, v14
  s_lshl_b32 s23, s70, 14
  s_add_u32 s23, s23, s78
  s_mov_b32 s46, 0
  s_call_b64 s[0:1], .fz_kernel_hw
  s_waitcnt vmcnt(0)
  s_cmp_ge_u32 s17, 14
  s_cbranch_scc1 .fz_kernel_c_ng
  s_setprio 2
  v_mfma_f32_16x16x32_bf16 v[224:227], v[208:211], v[80:83], 0
  v_mfma_f32_16x16x32_bf16 v[228:231], v[208:211], v[84:87], 0
  v_mfma_f32_16x16x32_bf16 v[232:235], v[208:211], v[88:91], 0
  v_mfma_f32_16x16x32_bf16 v[236:239], v[208:211], v[92:95], 0
  v_mfma_f32_16x16x32_bf16 v[240:243], v[208:211], v[96:99], 0
  v_mfma_f32_16x16x32_bf16 v[244:247], v[208:211], v[100:103], 0
  v_mfma_f32_16x16x32_bf16 v[248:251], v[208:211], v[104:107], 0
  v_mfma_f32_16x16x32_bf16 v[252:255], v[208:211], v[108:111], 0
  v_mfma_f32_16x16x32_bf16 v[224:227], v[212:215], v[112:115], v[224:227]
  v_mfma_f32_16x16x32_bf16 v[228:231], v[212:215], v[116:119], v[228:231]
  v_mfma_f32_16x16x32_bf16 v[232:235], v[212:215], v[120:123], v[232:235]
  v_mfma_f32_16x16x32_bf16 v[236:239], v[212:215], v[124:127], v[236:239]
  v_mfma_f32_16x16x32_bf16 v[240:243], v[212:215], v[128:131], v[240:243]
  v_mfma_f32_16x16x32_bf16 v[244:247], v[212:215], v[132:135], v[244:247]
  v_mfma_f32_16x16x32_bf16 v[248:251], v[212:215], v[136:139], v[248:251]
  v_mfma_f32_16x16x32_bf16 v[252:255], v[212:215], v[140:143], v[252:255]
  v_mfma_f32_16x16x32_bf16 v[224:227], v[216:219], v[144:147], v[224:227]
  v_mfma_f32_16x16x32_bf16 v[228:231], v[216:219], v[148:151], v[228:231]
  v_mfma_f32_16x16x32_bf16 v[232:235], v[216:219], v[152:155], v[232:235]
  v_mfma_f32_16x16x32_bf16 v[236:239], v[216:219], v[156:159], v[236:239]
  v_mfma_f32_16x16x32_bf16 v[240:243], v[216:219], v[160:163], v[240:243]
  v_mfma_f32_16x16x32_bf16 v[244:247], v[216:219], v[164:167], v[244:247]
  v_mfma_f32_16x16x32_bf16 v[248:251], v[216:219], v[168:171], v[248:251]
  v_mfma_f32_16x16x32_bf16 v[252:255], v[216:219], v[172:175], v[252:255]
  v_mfma_f32_16x16x32_bf16 v[224:227], v[220:223], v[176:179], v[224:227]
  v_mfma_f32_16x16x32_bf16 v[228:231], v[220:223], v[180:183], v[228:231]
  v_mfma_f32_16x16x32_bf16 v[232:235], v[220:223], v[184:187], v[232:235]
  v_mfma_f32_16x16x32_bf16 v[236:239], v[220:223], v[188:191], v[236:239]
  v_mfma_f32_16x16x32_bf16 v[240:243], v[220:223], v[192:195], v[240:243]
  v_mfma_f32_16x16x32_bf16 v[244:247], v[220:223], v[196:199], v[244:247]
  v_mfma_f32_16x16x32_bf16 v[248:251], v[220:223], v[200:203], v[248:251]
  v_mfma_f32_16x16x32_bf16 v[252:255], v[220:223], v[204:207], v[252:255]
  s_nop 0
  v_add_f32 v208, v225, v224 row_ror:8 row_mask:0xf bank_mask:0x3
  v_add_f32 v209, v229, v228 row_ror:8 row_mask:0xf bank_mask:0x3
  v_add_f32 v210, v233, v232 row_ror:8 row_mask:0xf bank_mask:0x3
  v_add_f32 v211, v237, v236 row_ror:8 row_mask:0xf bank_mask:0x3
  v_add_f32 v208, v240, v241 row_ror:8 row_mask:0xf bank_mask:0xc
  v_add_f32 v209, v244, v245 row_ror:8 row_mask:0xf bank_mask:0xc
  v_add_f32 v210, v248, v249 row_ror:8 row_mask:0xf bank_mask:0xc
  v_add_f32 v211, v252, v253 row_ror:8 row_mask:0xf bank_mask:0xc
  v_fma_f32 v208, -v11, v28, v208
  v_fma_f32 v209, -v11, v29, v209
  v_or_b32 v208, 1, v208
  v_fma_f32 v210, -v11, v30, v210
  v_fma_f32 v211, -v11, v31, v211
  v_or_b32 v210, 1, v210
  s_mov_b64 exec, 0xffff
  buffer_store_dwordx4 v[208:211], v20, s[4:7], s21 offen offset:0 sc1
  s_mov_b64 exec, -1
  s_setprio 0
  s_cmp_eq_u32 s3, 0
  s_cbranch_scc1 .fz_kernel_hb62
  s_barrier
  s_sub_u32 s3, s3, 1
.fz_kernel_hb62:
.fz_kernel_c_ng:
  s_cmp_eq_u32 s20, 0
  s_cbranch_scc1 .fz_kernel_c_ng1
  buffer_load_dwordx4 v[200:203], v14, s[4:7], s23 offen
  s_branch .fz_kernel_c_ng2
.fz_kernel_c_ng1:
  s_cmp_eq_u32 s75, 0
  s_cbranch_scc1 .fz_kernel_c_ng2
  buffer_load_dwordx2 v[240:241], v16, s[4:7], s14 offen
  buffer_load_dwordx2 v[242:243], v16, s[4:7], s15 offen
.fz_kernel_c_ng2:
  s_cmp_ge_u32 s17, 14
  s_cbranch_scc1 .fz_kernel_c_g1
  ds_read_b64_tr_b16 v[80:81], v17 offset:0
  ds_read_b64_tr_b16 v[82:83], v17 offset:1024
  ds_read_b64_tr_b16 v[84:85], v17 offset:32
  ds_read_b64_tr_b16 v[86:87], v17 offset:1056
  ds_read_b64_tr_b16 v[88:89], v18 offset:0
  ds_read_b64_tr_b16 v[90:91], v18 offset:1024
  ds_read_b64_tr_b16 v[92:93], v18 offset:32
  ds_read_b64_tr_b16 v[94:95], v18 offset:1056
  ds_read_b64_tr_b16 v[96:97], v17 offset:2048
  ds_read_b64_tr_b16 v[98:99], v17 offset:3072
  ds_read_b64_tr_b16 v[100:101], v17 offset:2080
  ds_read_b64_tr_b16 v[102:103], v17 offset:3104
  ds_read_b64_tr_b16 v[104:105], v18 offset:2048
  s_cmp_eq_u32 s3, 0
  s_cbranch_scc1 .fz_kernel_hb73
  s_barrier
  s_sub_u32 s3, s3, 1
.fz_kernel_hb73:
  ds_read_b64_tr_b16 v[106:107], v18 offset:3072
  ds_read_b64_tr_b16 v[108:109], v18 offset:2080
  ds_read_b64_tr_b16 v[110:111], v18 offset:3104
  s_waitcnt lgkmcnt(4)
  ds_read_b64_tr_b16 v[112:113], v17 offset:4096
  ds_read_b64_tr_b16 v[114:115], v17 offset:5120
  ds_read_b64_tr_b16 v[116:117], v17 offset:4128
  ds_read_b64_tr_b16 v[118:119], v17 offset:5152
  ds_read_b64_tr_b16 v[120:121], v18 offset:4096
  ds_read_b64_tr_b16 v[122:123], v18 offset:5120
  ds_read_b64_tr_b16 v[124:125], v18 offset:4128
  ds_read_b64_tr_b16 v[126:127], v18 offset:5152
  ds_read_b64_tr_b16 v[128:129], v17 offset:6144
  ds_read_b64_tr_b16 v[130:131], v17 offset:7168
  ds_read_b64_tr_b16 v[132:133], v17 offset:6176
  ds_read_b64_tr_b16 v[134:135], v17 offset:7200
  ds_read_b64_tr_b16 v[136:137], v18 offset:6144
  ds_read_b64_tr_b16 v[138:139], v18 offset:7168
  s_cmp_eq_u32 s3, 0
  s_cbranch_scc1 .fz_kernel_hb74
  s_barrier
  s_sub_u32 s3, s3, 1
.fz_kernel_hb74:
  ds_read_b64_tr_b16 v[140:141], v18 offset:6176
  ds_read_b64_tr_b16 v[142:143], v18 offset:7200
.fz_kernel_c_g1:
  v_fma_f32 v15, -v11, v11, v15
  v_rsq_f32 v15, abs(v15)
  s_nop 0
  v_mul_f32 v179, v11, v15
  v_mul_f32 v15, 0x44800000, v15
  v_sub_f32 v179, 0, v179
  v_add_f32 v178, 1.0, v15
  v_mul_f32 v177, -1.4426950408889634, v15
  v_mul_f32 v15, v15, v15
  v_mul_f32 v1, v1, v15
  s_cmp_eq_u32 s75, 0
  s_cbranch_scc1 .fz_kernel_c_d0
  s_cmp_lg_u32 s20, 0
  s_cbranch_scc1 .fz_kernel_c_t2
  s_waitcnt vmcnt(0)
  s_call_b64 s[68:69], .fz_kernel_c_coef
  v_mov_b32 v9, 159952
  v_mov_b32 v7, s79
  ds_write_b64 v26, v[252:253] offset:6400
  ds_write_b64 v26, v[254:255] offset:6912
  ds_write_b32 v9, v7
  s_waitcnt lgkmcnt(0)
.fz_kernel_c_t2:
  s_barrier
.fz_kernel_c_d0:
  s_cmp_ge_u32 s17, 14
  s_cbranch_scc1 .fz_kernel_c_nd
  s_lshl_b32 s21, s26, 12
  s_add_u32 s21, s21, s72
  s_add_u32 s21, s21, 40960
  s_mul_i32 s27, s18, 28
  s_add_u32 s27, s27, s26
  s_lshl_b32 s27, s27, 8
  s_add_u32 s27, s27, s72
  s_add_u32 s27, s27, 155648
  s_cmp_eq_u32 s3, 0
  s_cbranch_scc1 .fz_kernel_hb64
  s_barrier
  s_sub_u32 s3, s3, 1
.fz_kernel_hb64:
  buffer_load_dwordx4 v[144:147], v21, s[4:7], s21 offen offset:0 sc1
  buffer_load_dwordx4 v[148:151], v21, s[4:7], s21 offen offset:512 sc1
  buffer_load_dwordx4 v[152:155], v21, s[4:7], s21 offen offset:1024 sc1
  buffer_load_dwordx4 v[156:159], v21, s[4:7], s21 offen offset:1536 sc1
  s_mov_b32 s38, 0
.fz_kernel_c_gu:
  s_mov_b32 s46, 0
  s_call_b64 s[0:1], .fz_kernel_hw
  s_waitcnt vmcnt(0)
  v_min3_u32 v9, v144, v146, v148
  v_min3_u32 v9, v9, v150, v152
  v_min3_u32 v9, v9, v154, v156
  v_min_u32 v9, v9, v158
  v_cmp_eq_u32 vcc, 0, v9
  v_add_f32 v160, v144, v148
  v_add_f32 v161, v145, v149
  v_add_f32 v162, v146, v150
  v_add_f32 v163, v147, v151
  s_cbranch_vccnz .fz_kernel_c_gur
.fz_kernel_c_gud:
  v_add_f32 v152, v152, v156
  v_add_f32 v153, v153, v157
  v_add_f32 v154, v154, v158
  v_add_f32 v155, v155, v159
  v_add_f32 v144, v152, v160
  v_add_f32 v145, v153, v161
  v_add_f32 v146, v154, v162
  v_add_f32 v147, v155, v163
  s_nop 0
  v_permlane32_swap_b32 v144, v146
  v_permlane32_swap_b32 v145, v147
  v_mul_f32 v148, v144, v177
  v_mul_f32 v149, v145, v177
  v_exp_f32 v148, v148
  s_cmp_eq_u32 s3, 0
  s_cbranch_scc1 .fz_kernel_hb75
  s_barrier
  s_sub_u32 s3, s3, 1
.fz_kernel_hb75:
  v_exp_f32 v149, v149
  v_mul_f32 v144, v144, v146
  v_add_f32 v148, 1.0, v148
  v_add_f32 v149, 1.0, v149
  v_rcp_f32 v148, v148
  v_rcp_f32 v149, v149
  v_mul_f32 v145, v145, v147
  v_mul_f32 v144, v144, v148
  v_mul_f32 v145, v145, v149
  v_cvt_pk_bf16_f32 v144, v144, v145
  s_waitcnt lgkmcnt(0)
  s_setprio 2
  v_mov_b32 v160, v144 row_newbcast:0 row_mask:0xf bank_mask:0xf
  v_mov_b32 v161, v144 row_newbcast:1 row_mask:0xf bank_mask:0xf
  v_mov_b32 v162, v144 row_newbcast:2 row_mask:0xf bank_mask:0xf
  v_mov_b32 v163, v144 row_newbcast:3 row_mask:0xf bank_mask:0xf
  v_mov_b32 v164, v144 row_newbcast:4 row_mask:0xf bank_mask:0xf
  v_mov_b32 v165, v144 row_newbcast:5 row_mask:0xf bank_mask:0xf
  v_mov_b32 v166, v144 row_newbcast:6 row_mask:0xf bank_mask:0xf
  v_mov_b32 v167, v144 row_newbcast:7 row_mask:0xf bank_mask:0xf
  v_mfma_f32_16x16x32_bf16 v[208:211], v[80:83], v[160:163], 0
  v_mfma_f32_16x16x32_bf16 v[212:215], v[84:87], v[160:163], 0
  v_mfma_f32_16x16x32_bf16 v[216:219], v[88:91], v[160:163], 0
  v_mfma_f32_16x16x32_bf16 v[220:223], v[92:95], v[160:163], 0
  v_mov_b32 v168, v144 row_newbcast:8 row_mask:0xf bank_mask:0xf
  v_mov_b32 v169, v144 row_newbcast:9 row_mask:0xf bank_mask:0xf
  v_mov_b32 v170, v144 row_newbcast:10 row_mask:0xf bank_mask:0xf
  v_mov_b32 v171, v144 row_newbcast:11 row_mask:0xf bank_mask:0xf
  v_mfma_f32_16x16x32_bf16 v[208:211], v[96:99], v[164:167], v[208:211]
  v_mfma_f32_16x16x32_bf16 v[212:215], v[100:103], v[164:167], v[212:215]
  v_mfma_f32_16x16x32_bf16 v[216:219], v[104:107], v[164:167], v[216:219]
  v_mfma_f32_16x16x32_bf16 v[220:223], v[108:111], v[164:167], v[220:223]
  v_mov_b32 v172, v144 row_newbcast:12 row_mask:0xf bank_mask:0xf
  v_mov_b32 v173, v144 row_newbcast:13 row_mask:0xf bank_mask:0xf
  v_mov_b32 v174, v144 row_newbcast:14 row_mask:0xf bank_mask:0xf
  v_mov_b32 v175, v144 row_newbcast:15 row_mask:0xf bank_mask:0xf
  v_mfma_f32_16x16x32_bf16 v[208:211], v[112:115], v[168:171], v[208:211]
  v_mfma_f32_16x16x32_bf16 v[212:215], v[116:119], v[168:171], v[212:215]
  v_mfma_f32_16x16x32_bf16 v[216:219], v[120:123], v[168:171], v[216:219]
  v_mfma_f32_16x16x32_bf16 v[220:223], v[124:127], v[168:171], v[220:223]
  v_mfma_f32_16x16x32_bf16 v[208:211], v[128:131], v[172:175], v[208:211]
  v_mfma_f32_16x16x32_bf16 v[212:215], v[132:135], v[172:175], v[212:215]
  v_mfma_f32_16x16x32_bf16 v[216:219], v[136:139], v[172:175], v[216:219]
  v_mfma_f32_16x16x32_bf16 v[220:223], v[140:143], v[172:175], v[220:223]
  s_mov_b32 exec_lo, 0x20002
  s_mov_b32 exec_hi, 0x20002
  s_nop 3
  v_mov_b32 v208, v212
  v_mov_b32 v209, v213
  v_mov_b32 v210, v214
  v_mov_b32 v211, v215
  s_mov_b32 exec_lo, 0x40004
  s_mov_b32 exec_hi, 0x40004
  v_mov_b32 v208, v216
  v_mov_b32 v209, v217
  v_mov_b32 v210, v218
  v_mov_b32 v211, v219
  s_mov_b32 exec_lo, 0x80008
  s_mov_b32 exec_hi, 0x80008
  v_mov_b32 v208, v220
  v_mov_b32 v209, v221
  v_mov_b32 v210, v222
  v_mov_b32 v211, v223
  s_mov_b32 exec_lo, 0xf000f
  s_mov_b32 exec_hi, 0xf000f
  v_or_b32 v208, 1, v208
  v_or_b32 v210, 1, v210
  buffer_store_dwordx4 v[208:211], v19, s[4:7], s27 offen sc1
  s_mov_b64 exec, -1
  s_setprio 0
.fz_kernel_c_nd:
  s_cmp_eq_u32 s75, 0
  s_cbranch_scc1 .fz_kernel_c_m0
  s_lshl_b32 s21, s17, 1
  s_add_u32 s21, s21, s20
  s_cmp_lg_u32 s21, 31
  s_cbranch_scc1 .fz_kernel_fin
  s_branch .fz_kernel_c_pp
.fz_kernel_c_m0:
  s_cmp_eq_u32 s79, 0
  s_cselect_b32 s21, 2, 0
  s_add_u32 s3, s3, s21
.fz_kernel_c_pp:
  s_cmp_eq_u32 s3, 0
  s_cbranch_scc1 .fz_kernel_hb76
  s_barrier
  s_sub_u32 s3, s3, 1
.fz_kernel_hb76:
  v_and_b32 v10, 7, v2
  v_lshlrev_b32 v10, 8, v10
  v_lshl_add_u32 v10, v12, 5, v10
  s_mul_i32 s21, s70, 7168
  s_add_u32 s21, s21, s72
  s_add_u32 s21, s21, 155648
  s_add_u32 s22, s21, 4096
  s_mov_b32 s24, 0x0f0f0f0f
  s_mov_b32 s25, 0x0f0f0f0f
  s_lshl_b32 s27, s18, 4
  s_add_u32 s27, s27, s17
  s_lshl_b32 s27, s27, 10
  s_add_u32 s27, s27, 0x1c84000
  v_mov_b32 v168, 1
  v_mov_b32 v169, 1
  v_mov_b32 v170, 1
  v_mov_b32 v171, 1
  v_mov_b32 v172, 1
  v_mov_b32 v173, 1
  v_mov_b32 v174, 1
  v_mov_b32 v175, 1
  s_cmp_eq_u32 s3, 0
  s_cbranch_scc1 .fz_kernel_hb65
  s_barrier
  s_sub_u32 s3, s3, 1
.fz_kernel_hb65:
  s_cmp_eq_u32 s3, 0
  s_cbranch_scc1 .fz_kernel_hb66
  s_barrier
  s_sub_u32 s3, s3, 1
.fz_kernel_hb66:
  buffer_load_dwordx4 v[144:147], v10, s[4:7], s21 offen offset:0 sc1
  buffer_load_dwordx4 v[148:151], v10, s[4:7], s21 offen offset:16 sc1
  buffer_load_dwordx4 v[152:155], v10, s[4:7], s21 offen offset:2048 sc1
  buffer_load_dwordx4 v[156:159], v10, s[4:7], s21 offen offset:2064 sc1
  buffer_load_dwordx4 v[160:163], v10, s[4:7], s22 offen offset:0 sc1
  buffer_load_dwordx4 v[164:167], v10, s[4:7], s22 offen offset:16 sc1
  s_mov_b64 exec, s[24:25]
  buffer_load_dwordx4 v[168:171], v10, s[4:7], s22 offen offset:2048 sc1
  buffer_load_dwordx4 v[172:175], v10, s[4:7], s22 offen offset:2064 sc1
  s_mov_b64 exec, -1
  s_mov_b32 s38, 0
  s_cmp_eq_u32 s20, 0
  s_cbranch_scc1 .fz_kernel_c_pu
  s_waitcnt vmcnt(8)
  v_lshlrev_b32 v184, 16, v200
  v_and_b32 v185, 0xffff0000, v200
  v_lshlrev_b32 v186, 16, v201
  v_and_b32 v187, 0xffff0000, v201
  v_lshlrev_b32 v188, 16, v202
  v_and_b32 v189, 0xffff0000, v202
  v_lshlrev_b32 v190, 16, v203
  v_and_b32 v191, 0xffff0000, v203
  v_fma_f32 v184, v184, v178, v179
  v_fma_f32 v185, v185, v178, v179
  v_fma_f32 v186, v186, v178, v179
  v_fma_f32 v187, v187, v178, v179
  v_fma_f32 v188, v188, v178, v179
  v_fma_f32 v189, v189, v178, v179
  v_fma_f32 v190, v190, v178, v179
  v_fma_f32 v191, v191, v178, v179
.fz_kernel_c_pu:
  s_mov_b32 s46, 0
  s_call_b64 s[0:1], .fz_kernel_hw
  s_waitcnt vmcnt(0)
  s_cmp_eq_u32 s3, 0
  s_cbranch_scc1 .fz_kernel_hb77
  s_barrier
  s_sub_u32 s3, s3, 1
.fz_kernel_hb77:
  v_min3_u32 v9, v144, v146, v148
  v_min3_u32 v9, v9, v150, v152
  v_min3_u32 v9, v9, v154, v156
  v_min3_u32 v9, v9, v158, v160
  v_min3_u32 v9, v9, v162, v164
  v_min3_u32 v9, v9, v166, v168
  v_min3_u32 v9, v9, v170, v172
  v_min_u32 v9, v9, v174
  v_cmp_eq_u32 vcc, 0, v9
  v_add_f32 v236, v144, v152
  v_add_f32 v237, v145, v153
  v_add_f32 v238, v146, v154
  v_add_f32 v239, v147, v155
  s_cbranch_vccnz .fz_kernel_c_pur
.fz_kernel_c_pud:
  v_add_f32 v240, v148, v156
  v_add_f32 v241, v149, v157
  v_add_f32 v242, v150, v158
  v_add_f32 v243, v151, v159
  v_add_f32 v160, v160, v168
  v_add_f32 v161, v161, v169
  v_add_f32 v162, v162, v170
  v_add_f32 v163, v163, v171
  v_add_f32 v164, v164, v172
  v_add_f32 v165, v165, v173
  v_add_f32 v166, v166, v174
  v_add_f32 v167, v167, v175
  v_add_f32 v144, v236, v160
  v_add_f32 v145, v237, v161
  v_add_f32 v146, v238, v162
  v_add_f32 v147, v239, v163
  v_add_f32 v148, v240, v164
  v_add_f32 v149, v241, v165
  v_add_f32 v150, v242, v166
  v_add_f32 v151, v243, v167
  v_add_f32 v144, v144, v144 quad_perm:[1,0,3,2] row_mask:0xf bank_mask:0xf
  v_add_f32 v145, v145, v145 quad_perm:[1,0,3,2] row_mask:0xf bank_mask:0xf
  s_cmp_eq_u32 s3, 0
  s_cbranch_scc1 .fz_kernel_hb78
  s_barrier
  s_sub_u32 s3, s3, 1
.fz_kernel_hb78:
  v_add_f32 v146, v146, v146 quad_perm:[1,0,3,2] row_mask:0xf bank_mask:0xf
  v_add_f32 v147, v147, v147 quad_perm:[1,0,3,2] row_mask:0xf bank_mask:0xf
  v_add_f32 v148, v148, v148 quad_perm:[1,0,3,2] row_mask:0xf bank_mask:0xf
  v_add_f32 v149, v149, v149 quad_perm:[1,0,3,2] row_mask:0xf bank_mask:0xf
  v_add_f32 v150, v150, v150 quad_perm:[1,0,3,2] row_mask:0xf bank_mask:0xf
  v_add_f32 v151, v151, v151 quad_perm:[1,0,3,2] row_mask:0xf bank_mask:0xf
  v_add_f32 v144, v144, v144 quad_perm:[2,3,0,1] row_mask:0xf bank_mask:0xf
  v_add_f32 v145, v145, v145 quad_perm:[2,3,0,1] row_mask:0xf bank_mask:0xf
  v_add_f32 v146, v146, v146 quad_perm:[2,3,0,1] row_mask:0xf bank_mask:0xf
  v_add_f32 v147, v147, v147 quad_perm:[2,3,0,1] row_mask:0xf bank_mask:0xf
  v_add_f32 v148, v148, v148 quad_perm:[2,3,0,1] row_mask:0xf bank_mask:0xf
  v_add_f32 v149, v149, v149 quad_perm:[2,3,0,1] row_mask:0xf bank_mask:0xf
  v_add_f32 v150, v150, v150 quad_perm:[2,3,0,1] row_mask:0xf bank_mask:0xf
  v_add_f32 v151, v151, v151 quad_perm:[2,3,0,1] row_mask:0xf bank_mask:0xf
  v_add_f32 v144, v144, v144 row_half_mirror row_mask:0xf bank_mask:0xf
  v_add_f32 v145, v145, v145 row_half_mirror row_mask:0xf bank_mask:0xf
  v_add_f32 v146, v146, v146 row_half_mirror row_mask:0xf bank_mask:0xf
  v_add_f32 v147, v147, v147 row_half_mirror row_mask:0xf bank_mask:0xf
  v_add_f32 v148, v148, v148 row_half_mirror row_mask:0xf bank_mask:0xf
  v_add_f32 v149, v149, v149 row_half_mirror row_mask:0xf bank_mask:0xf
  v_add_f32 v150, v150, v150 row_half_mirror row_mask:0xf bank_mask:0xf
  v_add_f32 v151, v151, v151 row_half_mirror row_mask:0xf bank_mask:0xf
  v_mul_f32 v144, v144, v1
  v_mul_f32 v145, v145, v1
  v_mul_f32 v146, v146, v1
  v_mul_f32 v147, v147, v1
  v_mul_f32 v148, v148, v1
  v_mul_f32 v149, v149, v1
  v_mul_f32 v150, v150, v1
  v_mul_f32 v151, v151, v1
  v_cvt_pk_bf16_f32 v180, v144, v145
  v_cvt_pk_bf16_f32 v181, v146, v147
  v_cvt_pk_bf16_f32 v182, v148, v149
  v_cvt_pk_bf16_f32 v183, v150, v151
  s_or_b32 s21, s75, s71
  s_cbranch_scc1 .fz_kernel_c_w7
  s_mul_i32 s21, s20, 384
  s_add_u32 s21, s21, s27
  s_setprio 2
  v_mfma_f32_16x16x32_bf16 v[208:211], v[180:183], v[32:35], 0
  v_mov_b32 v232, v180 row_ror:8 row_mask:0xf bank_mask:0xf
  v_mfma_f32_16x16x32_bf16 v[212:215], v[180:183], v[36:39], 0
  v_mov_b32 v233, v181 row_ror:8 row_mask:0xf bank_mask:0xf
  v_mfma_f32_16x16x32_bf16 v[216:219], v[180:183], v[40:43], 0
  v_mov_b32 v234, v182 row_ror:8 row_mask:0xf bank_mask:0xf
  v_mfma_f32_16x16x32_bf16 v[220:223], v[180:183], v[44:47], 0
  v_mov_b32 v235, v183 row_ror:8 row_mask:0xf bank_mask:0xf
  v_mfma_f32_16x16x32_bf16 v[224:227], v[180:183], v[48:51], 0
  v_mfma_f32_16x16x32_bf16 v[228:231], v[180:183], v[52:55], 0
  v_mfma_f32_16x16x32_bf16 v[208:211], v[232:235], v[56:59], v[208:211]
  v_mfma_f32_16x16x32_bf16 v[212:215], v[232:235], v[60:63], v[212:215]
  v_mfma_f32_16x16x32_bf16 v[216:219], v[232:235], v[64:67], v[216:219]
  v_mfma_f32_16x16x32_bf16 v[220:223], v[232:235], v[68:71], v[220:223]
  v_mfma_f32_16x16x32_bf16 v[224:227], v[232:235], v[72:75], v[224:227]
  v_mfma_f32_16x16x32_bf16 v[228:231], v[232:235], v[76:79], v[228:231]
  s_nop 2
  v_or_b32 v208, 1, v208
  v_mov_b32 v209, v212
  v_or_b32 v210, 1, v216
  v_mov_b32 v211, v220
  s_mov_b64 exec, 0xffff
  buffer_store_dwordx4 v[208:211], v3, s[4:7], s21 offen offset:0 sc1
  v_or_b32 v224, 1, v224
  v_mov_b32 v225, v228
  buffer_store_dwordx2 v[224:225], v16, s[4:7], s21 offen offset:256 sc1
  s_mov_b64 exec, -1
  s_setprio 0
  s_cmp_lg_u32 s20, 0
  s_cbranch_scc1 .fz_kernel_c_w7
  s_cmp_eq_u32 s79, 0
  s_cbranch_scc1 .fz_kernel_c_no2
  s_cmp_eq_u32 s3, 0
  s_cbranch_scc1 .fz_kernel_hb79
  s_barrier
  s_sub_u32 s3, s3, 1
.fz_kernel_hb79:
  v_add_u32 v13, 155648, v3
  s_lshl_b32 s21, s18, 14
  s_add_u32 s21, s21, 0x1c84000
  s_add_u32 s22, s21, 4096
  s_add_u32 s23, s21, 8192
  s_add_u32 s24, s21, 12288
  v_rcp_f32 v144, v178
  v_lshlrev_b32 v146, 1, v2
  v_sub_u32 v146, s79, v146
  v_cmp_eq_u32 s[28:29], 1, v146
  v_cmp_eq_u32 s[30:31], 2, v146
  s_nop 0
  v_cndmask_b32 v148, 0, v144, s[28:29]
  v_cndmask_b32 v149, 0, v144, s[30:31]
  s_bfm_b64 exec, 49, 0
  s_mov_b32 s38, 0
.fz_kernel_c_pd:
  buffer_load_dwordx4 v[80:83], v3, s[4:7], s21 offen offset:0 sc1
  buffer_load_dwordx4 v[84:87], v3, s[4:7], s21 offen offset:1024 sc1
  buffer_load_dwordx4 v[88:91], v3, s[4:7], s21 offen offset:2048 sc1
  buffer_load_dwordx4 v[92:95], v3, s[4:7], s21 offen offset:3072 sc1
  buffer_load_dwordx4 v[96:99], v3, s[4:7], s22 offen offset:0 sc1
  buffer_load_dwordx4 v[100:103], v3, s[4:7], s22 offen offset:1024 sc1
  buffer_load_dwordx4 v[104:107], v3, s[4:7], s22 offen offset:2048 sc1
  buffer_load_dwordx4 v[108:111], v3, s[4:7], s22 offen offset:3072 sc1
  buffer_load_dwordx4 v[112:115], v3, s[4:7], s23 offen offset:0 sc1
  buffer_load_dwordx4 v[116:119], v3, s[4:7], s23 offen offset:1024 sc1
  buffer_load_dwordx4 v[120:123], v3, s[4:7], s23 offen offset:2048 sc1
  s_cmp_eq_u32 s3, 0
  s_cbranch_scc1 .fz_kernel_hb80
  s_barrier
  s_sub_u32 s3, s3, 1
.fz_kernel_hb80:
  buffer_load_dwordx4 v[124:127], v3, s[4:7], s23 offen offset:3072 sc1
  buffer_load_dwordx4 v[128:131], v3, s[4:7], s24 offen offset:0 sc1
  buffer_load_dwordx4 v[132:135], v3, s[4:7], s24 offen offset:1024 sc1
  buffer_load_dwordx4 v[136:139], v3, s[4:7], s24 offen offset:2048 sc1
  buffer_load_dwordx4 v[140:143], v3, s[4:7], s24 offen offset:3072 sc1
  s_add_u32 s38, s38, 1
  s_mov_b32 s46, 0
  s_call_b64 s[0:1], .fz_kernel_hw
  s_waitcnt vmcnt(0)
  v_min3_u32 v9, v80, v82, v84
  v_min3_u32 v9, v9, v86, v88
  v_min3_u32 v9, v9, v90, v92
  v_min3_u32 v9, v9, v94, v96
  v_min3_u32 v9, v9, v98, v100
  v_min3_u32 v9, v9, v102, v104
  v_min3_u32 v9, v9, v106, v108
  v_min3_u32 v9, v9, v110, v112
  v_min3_u32 v9, v9, v114, v116
  v_min3_u32 v9, v9, v118, v120
  v_min3_u32 v9, v9, v122, v124
  v_min3_u32 v9, v9, v126, v128
  v_min3_u32 v9, v9, v130, v132
  v_min3_u32 v9, v9, v134, v136
  v_min3_u32 v9, v9, v138, v140
  v_min_u32 v9, v9, v142
  v_cmp_eq_u32 vcc, 0, v9
  s_cbranch_vccz .fz_kernel_c_pdd
  s_cmp_lt_u32 s38, 131072
  s_cbranch_scc1 .fz_kernel_c_pd
.fz_kernel_c_pdd:
  v_add_f32 v80, v80, v112
  v_add_f32 v81, v81, v113
  v_add_f32 v82, v82, v114
  v_add_f32 v83, v83, v115
  v_add_f32 v84, v84, v116
  s_cmp_eq_u32 s3, 0
  s_cbranch_scc1 .fz_kernel_hb81
  s_barrier
  s_sub_u32 s3, s3, 1
.fz_kernel_hb81:
  v_add_f32 v85, v85, v117
  v_add_f32 v86, v86, v118
  v_add_f32 v87, v87, v119
  v_add_f32 v88, v88, v120
  v_add_f32 v89, v89, v121
  v_add_f32 v90, v90, v122
  v_add_f32 v91, v91, v123
  v_add_f32 v92, v92, v124
  v_add_f32 v93, v93, v125
  v_add_f32 v94, v94, v126
  v_add_f32 v95, v95, v127
  v_add_f32 v96, v96, v128
  v_add_f32 v97, v97, v129
  v_add_f32 v98, v98, v130
  v_add_f32 v99, v99, v131
  v_add_f32 v100, v100, v132
  v_add_f32 v101, v101, v133
  v_add_f32 v102, v102, v134
  v_add_f32 v103, v103, v135
  v_add_f32 v104, v104, v136
  v_add_f32 v105, v105, v137
  v_add_f32 v106, v106, v138
  v_add_f32 v107, v107, v139
  v_add_f32 v108, v108, v140
  v_add_f32 v109, v109, v141
  v_add_f32 v110, v110, v142
  v_add_f32 v111, v111, v143
  v_add_f32 v80, v80, v96
  v_add_f32 v81, v81, v97
  v_add_f32 v82, v82, v98
  v_add_f32 v83, v83, v99
  v_add_f32 v84, v84, v100
  v_add_f32 v85, v85, v101
  v_add_f32 v86, v86, v102
  v_add_f32 v87, v87, v103
  v_add_f32 v88, v88, v104
  s_cmp_eq_u32 s3, 0
  s_cbranch_scc1 .fz_kernel_hb82
  s_barrier
  s_sub_u32 s3, s3, 1
.fz_kernel_hb82:
  v_add_f32 v89, v89, v105
  v_add_f32 v90, v90, v106
  v_add_f32 v91, v91, v107
  v_add_f32 v92, v92, v108
  v_add_f32 v93, v93, v109
  v_add_f32 v94, v94, v110
  v_add_f32 v95, v95, v111
  v_add_f32 v80, v80, v88
  v_add_f32 v81, v81, v89
  v_add_f32 v82, v82, v90
  v_add_f32 v83, v83, v91
  v_add_f32 v84, v84, v92
  v_add_f32 v85, v85, v93
  v_add_f32 v86, v86, v94
  v_add_f32 v87, v87, v95
  v_add_f32 v80, v80, v84
  v_add_f32 v81, v81, v85
  v_add_f32 v82, v82, v86
  v_add_f32 v83, v83, v87
  s_mov_b64 exec, -1
  v_readlane_b32 s21, v80, 48
  v_readlane_b32 s22, v82, 48
  s_nop 0
  v_mul_f32 v144, s21, v23
  v_fma_f32 v145, s22, v23, v25
  v_fma_f32 v145, -v144, v144, v145
  v_rsq_f32 v145, abs(v145)
  v_sub_f32 v144, v179, v144
  v_mul_f32 v146, v145, v178
  v_mul_f32 v147, v145, v144
  s_lshl_b32 s21, s79, 2
  s_add_u32 s21, s21, 155644
  v_mov_b32 v9, s21
  ds_write_b32 v9, v146 offset:4608
  ds_write_b32 v9, v147 offset:5120
  s_cmp_eq_u32 s3, 0
  s_cbranch_scc1 .fz_kernel_hb83
  s_barrier
  s_sub_u32 s3, s3, 1
.fz_kernel_hb83:
  v_mov_b32 v9, 159952
  v_mov_b32 v7, s79
  ds_write_b32 v9, v7
  ds_write_b64 v26, v[148:149] offset:512
  s_mov_b32 exec_hi, 0xffff
  ds_write_b128 v13, v[80:83] offset:1536
  s_mov_b64 exec, -1
  s_waitcnt lgkmcnt(0)
  s_add_u32 s3, s3, 2
.fz_kernel_c_no2:
  s_branch .fz_kernel_q_he
.fz_kernel_c_w7:
  v_lshlrev_b32 v144, 16, v180
  v_and_b32 v145, 0xffff0000, v180
  v_lshlrev_b32 v146, 16, v181
  v_and_b32 v147, 0xffff0000, v181
  v_lshlrev_b32 v148, 16, v182
  v_and_b32 v149, 0xffff0000, v182
  v_lshlrev_b32 v150, 16, v183
  v_and_b32 v151, 0xffff0000, v183
  s_cmp_lg_u32 s71, 0
  s_cbranch_scc1 .fz_kernel_c_eu
  v_add_f32 v184, v184, v144
  v_add_f32 v185, v185, v145
  v_add_f32 v186, v186, v146
  v_add_f32 v187, v187, v147
  v_add_f32 v188, v188, v148
  v_add_f32 v189, v189, v149
  v_add_f32 v190, v190, v150
  v_add_f32 v191, v191, v151
  s_cmp_lg_u32 s75, 0
  s_cbranch_scc1 .fz_kernel_c_t3
  v_mul_f32 v152, v184, v184
  v_add_f32 v154, v184, v185
  v_fmac_f32 v152, v185, v185
  v_fmac_f32 v152, v186, v186
  v_add_f32 v154, v154, v186
  v_fmac_f32 v152, v187, v187
  v_add_f32 v154, v154, v187
  s_cmp_eq_u32 s3, 0
  s_cbranch_scc1 .fz_kernel_hb84
  s_barrier
  s_sub_u32 s3, s3, 1
.fz_kernel_hb84:
  v_fmac_f32 v152, v188, v188
  v_add_f32 v154, v154, v188
  v_fmac_f32 v152, v189, v189
  v_add_f32 v154, v154, v189
  v_fmac_f32 v152, v190, v190
  v_add_f32 v154, v154, v190
  v_fmac_f32 v152, v191, v191
  v_add_f32 v154, v154, v191
  v_lshrrev_b32 v9, 5, v2
  v_lshlrev_b32 v9, 3, v9
  v_permlane32_swap_b32 v154, v152
  v_add_f32 v154, v154, v152
  s_nop 1
  v_add_f32 v154, v154, v154 row_ror:8 row_mask:0xf bank_mask:0xf
  s_nop 1
  v_add_f32 v154, v154, v154 row_bcast:15 row_mask:0xa bank_mask:0xf
  v_or_b32 v154, 1, v154
  s_mov_b32 exec_lo, 0x10000
  s_mov_b32 exec_hi, 0x10000
  buffer_store_dword v154, v9, s[4:7], s27 offen offset:768 sc1
  s_mov_b64 exec, -1
  s_cmp_eq_u32 s79, 0
  s_cbranch_scc1 .fz_kernel_q_he
  s_add_u32 s3, s3, 2
  s_mov_b32 s71, 1
  s_mov_b32 s70, s18
  s_branch .fz_kernel_c_pp
.fz_kernel_c_eu:
  v_lshlrev_b32 v9, 5, v12
  v_add_u32 v9, 155648, v9
  s_mov_b32 exec_lo, 0x01010101
  s_mov_b32 exec_hi, 0x01010101
  ds_write_b128 v9, v[144:147] offset:7424
  ds_write_b128 v9, v[148:151] offset:7440
  s_mov_b64 exec, -1
  s_waitcnt lgkmcnt(0)
  s_branch .fz_kernel_q_he
.fz_kernel_c_t3:
  s_mov_b32 s28, s56
  s_mov_b32 s29, s57
  s_mov_b32 s30, 0x400000
  s_mov_b32 s31, 0x00020000
  v_cvt_pk_bf16_f32 v144, v184, v185
  v_cvt_pk_bf16_f32 v145, v186, v187
  v_cvt_pk_bf16_f32 v146, v188, v189
  v_cvt_pk_bf16_f32 v147, v190, v191
  s_cmp_eq_u32 s3, 0
  s_cbranch_scc1 .fz_kernel_hb85
  s_barrier
  s_sub_u32 s3, s3, 1
.fz_kernel_hb85:
  v_lshlrev_b32 v9, 4, v12
  s_lshl_b32 s21, s77, 11
  s_lshl_b32 s22, s18, 7
  s_add_u32 s21, s21, s22
  s_mov_b32 exec_lo, 0x01010101
  s_mov_b32 exec_hi, 0x01010101
  buffer_store_dwordx4 v[144:147], v9, s[28:31], s21 offen
  s_mov_b64 exec, -1
.fz_kernel_fin:
.fz_kernel_end:
  s_endpgm
.fz_kernel_pick:
  s_mov_b32 s33, 1
  s_cmp_eq_u32 s34, 0xffff
  s_cselect_b32 s35, 0x40000000, s35
  s_cbranch_scc1 .fz_kernel_pick_ret
  s_mov_b32 s38, 0
.fz_kernel_pick_l:
  ds_read_b32 v7, v6
  s_add_u32 s38, s38, 1
  s_waitcnt lgkmcnt(0)
  v_readfirstlane_b32 s36, v7
  s_andn2_b32 s33, s36, s34
  s_cbranch_scc1 .fz_kernel_pick_ret
  s_cmp_lt_u32 s38, 1048576
  s_cbranch_scc1 .fz_kernel_pick_l
  s_mov_b32 s36, 0xffff
  s_andn2_b32 s33, s36, s34
.fz_kernel_pick_ret:
  s_nop 4
  s_setpc_b64 s[68:69]
.fz_kernel_hw:
  s_mov_b32 s47, 0
.fz_kernel_hwl:
  s_getreg_b32 s100, hwreg(HW_REG_IB_STS)
  s_bfe_u32 s101, s100, 0x20016
  s_and_b32 s100, s100, 15
  s_lshl4_add_u32 s100, s101, s100
  s_cmp_le_u32 s100, s46
  s_cbranch_scc1 .fz_kernel_hwr
  s_sub_u32 s47, s47, 1
  s_cbranch_scc0 .fz_kernel_hwl
  s_cmp_eq_u32 s3, 0
  s_cbranch_scc1 .fz_kernel_hwr
  s_barrier
  s_sub_u32 s3, s3, 1
  s_mov_b32 s47, 2
  s_branch .fz_kernel_hwl
.fz_kernel_hwr:
  s_setpc_b64 s[0:1]
.fz_kernel_q_cons2:
  s_setprio 0
  s_lshr_b32 s26, s16, 1
  s_lshl_b32 s28, s26, 13
  v_add_u32 v8, s28, v3
  v_add_u32 v9, 1024, v8
  s_branch .fz_kernel_q_cs
.fz_kernel_q_patch:
  s_mul_i32 s31, s27, 384
  s_add_u32 s31, s31, 155648
  v_and_b32 v229, 48, v2
  v_lshlrev_b32 v229, 2, v229
  v_add_u32 v229, s31, v229
  v_and_b32 v231, 15, v2
  v_lshlrev_b32 v231, 3, v231
  v_add_u32 v231, s31, v231
  ds_read_b32 v228, v14 offset:512
  ds_read_b32 v230, v14 offset:576
  ds_read_b32 v232, v14 offset:640
  ds_read_b32 v234, v14 offset:704
  ds_read_b128 v[236:239], v229 offset:1536
  ds_read_b128 v[240:243], v229 offset:1552
  ds_read_b128 v[244:247], v229 offset:1568
  ds_read_b128 v[248:251], v229 offset:1584
  s_waitcnt lgkmcnt(0)
  v_fmac_f32 v160, v238, v228
  v_fmac_f32 v161, v242, v228
  v_fmac_f32 v162, v246, v228
  v_fmac_f32 v163, v250, v228
  v_fmac_f32 v164, v238, v230
  v_fmac_f32 v165, v242, v230
  v_fmac_f32 v166, v246, v230
  v_fmac_f32 v167, v250, v230
  v_fmac_f32 v168, v238, v232
  v_fmac_f32 v169, v242, v232
  v_fmac_f32 v170, v246, v232
  v_fmac_f32 v171, v250, v232
  v_fmac_f32 v172, v238, v234
  v_fmac_f32 v173, v242, v234
  v_fmac_f32 v174, v246, v234
  v_fmac_f32 v175, v250, v234
  v_fmac_f32 v176, v239, v228
  v_fmac_f32 v177, v243, v228
  v_fmac_f32 v178, v247, v228
  v_fmac_f32 v179, v251, v228
  v_fmac_f32 v180, v239, v230
  v_fmac_f32 v181, v243, v230
  v_fmac_f32 v182, v247, v230
  v_fmac_f32 v183, v251, v230
  v_fmac_f32 v184, v239, v232
  v_fmac_f32 v185, v243, v232
  v_fmac_f32 v186, v247, v232
  v_fmac_f32 v187, v251, v232
  v_fmac_f32 v188, v239, v234
  v_fmac_f32 v189, v243, v234
  v_fmac_f32 v190, v247, v234
  v_fmac_f32 v191, v251, v234
  v_fmac_f32 v128, v236, v228
  v_fmac_f32 v129, v240, v228
  v_fmac_f32 v130, v244, v228
  v_fmac_f32 v131, v248, v228
  v_fmac_f32 v132, v236, v230
  v_fmac_f32 v133, v240, v230
  v_fmac_f32 v134, v244, v230
  v_fmac_f32 v135, v248, v230
  v_fmac_f32 v136, v236, v232
  v_fmac_f32 v137, v240, v232
  v_fmac_f32 v138, v244, v232
  v_fmac_f32 v139, v248, v232
  v_fmac_f32 v140, v236, v234
  v_fmac_f32 v141, v240, v234
  v_fmac_f32 v142, v244, v234
  v_fmac_f32 v143, v248, v234
  v_fmac_f32 v144, v237, v228
  v_fmac_f32 v145, v241, v228
  v_fmac_f32 v146, v245, v228
  v_fmac_f32 v147, v249, v228
  v_fmac_f32 v148, v237, v230
  v_fmac_f32 v149, v241, v230
  v_fmac_f32 v150, v245, v230
  v_fmac_f32 v151, v249, v230
  v_fmac_f32 v152, v237, v232
  v_fmac_f32 v153, v241, v232
  v_fmac_f32 v154, v245, v232
  v_fmac_f32 v155, v249, v232
  v_fmac_f32 v156, v237, v234
  v_fmac_f32 v157, v241, v234
  v_fmac_f32 v158, v245, v234
  v_fmac_f32 v159, v249, v234
  ds_read_b128 v[236:239], v15 offset:512
  ds_read_b128 v[240:243], v15 offset:576
  ds_read_b128 v[244:247], v15 offset:640
  ds_read_b128 v[248:251], v15 offset:704
  ds_read_b64 v[228:229], v231 offset:1792
  s_waitcnt lgkmcnt(0)
  v_fmac_f32 v192, v236, v228
  v_fmac_f32 v193, v237, v228
  v_fmac_f32 v194, v238, v228
  v_fmac_f32 v195, v239, v228
  v_fmac_f32 v196, v240, v228
  v_fmac_f32 v197, v241, v228
  v_fmac_f32 v198, v242, v228
  v_fmac_f32 v199, v243, v228
  v_fmac_f32 v200, v244, v228
  v_fmac_f32 v201, v245, v228
  v_fmac_f32 v202, v246, v228
  v_fmac_f32 v203, v247, v228
  v_fmac_f32 v204, v248, v228
  v_fmac_f32 v205, v249, v228
  v_fmac_f32 v206, v250, v228
  v_fmac_f32 v207, v251, v228
  v_fmac_f32 v208, v236, v229
  v_fmac_f32 v209, v237, v229
  v_fmac_f32 v210, v238, v229
  v_fmac_f32 v211, v239, v229
  v_fmac_f32 v212, v240, v229
  v_fmac_f32 v213, v241, v229
  v_fmac_f32 v214, v242, v229
  v_fmac_f32 v215, v243, v229
  v_fmac_f32 v216, v244, v229
  v_fmac_f32 v217, v245, v229
  v_fmac_f32 v218, v246, v229
  v_fmac_f32 v219, v247, v229
  v_fmac_f32 v220, v248, v229
  v_fmac_f32 v221, v249, v229
  v_fmac_f32 v222, v250, v229
  v_fmac_f32 v223, v251, v229
  s_branch .fz_kernel_q_pback
.fz_kernel_q_prod2:
  s_mov_b64 s[8:9], s[4:5]
  s_mov_b64 s[10:11], s[6:7]
  s_lshl_b32 s35, s17, 6
  s_and_b32 s31, s16, 1
  s_add_u32 s35, s35, s31
  s_lshl_b32 s35, s35, 12
  s_add_u32 s35, s35, s73
  s_lshr_b32 s33, s17, 3
  s_add_u32 s29, s18, s33
  s_lshl1_add_u32 s29, s17, s29
  s_and_b32 s29, s29, 15
  s_mov_b32 s22, 16384
  s_mov_b32 s23, 8192
  s_lshl_b32 s36, 1, s18
  s_add_u32 s37, s19, s74
  s_add_u32 s37, s37, 8
  v_mov_b32 v40, v3
  v_mov_b32 v41, v3
  v_mov_b32 v42, v3
  v_mov_b32 v43, v3
  s_branch .fz_kernel_q_pc
.fz_kernel_xok1w:
  s_call_b64 s[68:69], .fz_kernel_q_xw
  s_branch .fz_kernel_xok1
.fz_kernel_xok2w:
  s_call_b64 s[68:69], .fz_kernel_q_xw
  s_branch .fz_kernel_xok2
.fz_kernel_q_xw:
  s_mov_b64 exec, 1
  s_mov_b32 s38, 0
.fz_kernel_q_xwl:
  buffer_load_dword v11, v4, s[4:7], s37 offen sc1
  s_add_u32 s38, s38, 1
  s_waitcnt vmcnt(0)
  v_readfirstlane_b32 s36, v11
  s_bitcmp1_b32 s36, s24
  s_cbranch_scc1 .fz_kernel_q_xwd
  s_cmp_lt_u32 s38, 131072
  s_cbranch_scc1 .fz_kernel_q_xwl
  s_mov_b32 s36, -1
.fz_kernel_q_xwd:
  s_mov_b64 exec, -1
  s_nop 4
  s_setpc_b64 s[68:69]
.fz_kernel_xok3w:
  s_call_b64 s[68:69], .fz_kernel_q_xw
  s_branch .fz_kernel_xok3
.fz_kernel_lz23a:
  v_lshlrev_b32 v16, 3, v2
  buffer_atomic_and_x2 v[12:13], v16, s[4:7], s36 offen offset:0 sc1
  buffer_atomic_and_x2 v[12:13], v16, s[4:7], s36 offen offset:512 sc1
  buffer_atomic_and_x2 v[12:13], v16, s[4:7], s36 offen offset:1024 sc1
  buffer_atomic_and_x2 v[12:13], v16, s[4:7], s36 offen offset:1536 sc1
  buffer_atomic_and_x2 v[12:13], v16, s[4:7], s36 offen offset:2048 sc1
  buffer_atomic_and_x2 v[12:13], v16, s[4:7], s36 offen offset:2560 sc1
  buffer_atomic_and_x2 v[12:13], v16, s[4:7], s36 offen offset:3072 sc1
  buffer_atomic_and_x2 v[12:13], v16, s[4:7], s36 offen offset:3584 sc1
  s_branch .fz_kernel_lz23
.fz_kernel_a_pick:
  s_mov_b32 s30, 0x40000000
  s_cmp_eq_u32 s34, 0xffff
  s_cbranch_scc1 .fz_kernel_a_pickr
  s_mov_b32 s38, 0
.fz_kernel_a_pickl:
  ds_read_b32 v7, v6
  s_add_u32 s38, s38, 1
  s_waitcnt lgkmcnt(0)
  v_readfirstlane_b32 s33, v7
  s_cmp_lt_u32 s38, 1048576
  s_cselect_b32 s33, s33, 0xffff
  s_andn2_b32 s36, s33, s34
  s_cbranch_scc0 .fz_kernel_a_pickl
  s_or_b32 s34, s34, s33
  s_ff1_i32_b32 s33, s36
  s_bitset0_b32 s36, s33
  s_lshl_b32 s33, s33, 14
  s_add_u32 s30, s33, s35
.fz_kernel_a_pickr:
  s_setpc_b64 s[68:69]
.fz_kernel_pk31c:
  s_call_b64 s[68:69], .fz_kernel_a_pick
  s_branch .fz_kernel_pk31
.fz_kernel_pk32c:
  s_call_b64 s[68:69], .fz_kernel_a_pick
  s_branch .fz_kernel_pk32
.fz_kernel_pk33c:
  s_call_b64 s[68:69], .fz_kernel_a_pick
  s_branch .fz_kernel_pk33
.fz_kernel_pk34c:
  s_call_b64 s[68:69], .fz_kernel_a_pick
  s_branch .fz_kernel_pk34
.fz_kernel_pk35c:
  s_call_b64 s[68:69], .fz_kernel_a_pick
  s_branch .fz_kernel_pk35
.fz_kernel_a_slow:
  s_cmp_lg_u32 s73, 0
  s_cbranch_scc1 .fz_kernel_a_ok
  s_mov_b32 s73, 1
  s_call_b64 s[68:69], .fz_kernel_a_sl
  v_mov_b32 v32, v33
  v_mov_b32 v80, v48
  v_mov_b32 v81, v49
  v_mov_b32 v82, v50
  v_mov_b32 v83, v51
  v_mov_b32 v84, v52
  v_mov_b32 v85, v53
  v_mov_b32 v86, v54
  v_mov_b32 v87, v55
  v_mov_b32 v88, v56
  v_mov_b32 v89, v57
  v_mov_b32 v90, v58
  v_mov_b32 v91, v59
  v_mov_b32 v92, v60
  v_mov_b32 v93, v61
  v_mov_b32 v94, v62
  v_mov_b32 v95, v63
  v_mov_b32 v16, v24
  v_mov_b32 v17, v25
  v_mov_b32 v18, v26
  v_mov_b32 v19, v27
  v_mov_b32 v20, v28
  v_mov_b32 v21, v29
  v_mov_b32 v22, v30
  v_mov_b32 v23, v31
  s_call_b64 s[68:69], .fz_kernel_a_sl
  v_mov_b32 v64, v48
  v_mov_b32 v48, v80
  v_mov_b32 v65, v49
  v_mov_b32 v49, v81
  v_mov_b32 v66, v50
  v_mov_b32 v50, v82
  v_mov_b32 v67, v51
  v_mov_b32 v51, v83
  v_mov_b32 v68, v52
  v_mov_b32 v52, v84
  v_mov_b32 v69, v53
  v_mov_b32 v53, v85
  v_mov_b32 v70, v54
  v_mov_b32 v54, v86
  v_mov_b32 v71, v55
  v_mov_b32 v55, v87
  v_mov_b32 v72, v56
  v_mov_b32 v56, v88
  v_mov_b32 v73, v57
  v_mov_b32 v57, v89
  v_mov_b32 v74, v58
  v_mov_b32 v58, v90
  v_mov_b32 v75, v59
  v_mov_b32 v59, v91
  v_mov_b32 v76, v60
  v_mov_b32 v60, v92
  v_mov_b32 v77, v61
  v_mov_b32 v61, v93
  v_mov_b32 v78, v62
  v_mov_b32 v62, v94
  v_mov_b32 v79, v63
  v_mov_b32 v63, v95
  s_branch .fz_kernel_a_fin
.fz_kernel_a_sl:
  s_waitcnt vmcnt(0)
  s_lshl_b32 s36, s18, 1
  s_add_u32 s36, s36, s39
  s_lshl_b32 s36, s36, 18
  s_add_u32 s36, s36, s63
  s_mov_b32 s30, s36
  s_mov_b32 s33, 64
  v_mov_b32 v36, 0xff800000
.fz_kernel_a_s1:
  buffer_load_dwordx4 v[168:171], v3, s[4:7], s30 offen offset:0
  buffer_load_dwordx4 v[172:175], v3, s[4:7], s30 offen offset:1024
  s_waitcnt vmcnt(0)
  v_mfma_f32_32x32x16_bf16 v[128:143], v[168:171], v[16:19], 0
  v_mfma_f32_32x32x16_bf16 v[128:143], v[172:175], v[20:23], v[128:143]
  s_nop 11
  v_max3_f32 v36, v36, v128, v129
  v_max3_f32 v36, v36, v130, v131
  v_max3_f32 v36, v36, v132, v133
  v_max3_f32 v36, v36, v134, v135
  v_max3_f32 v36, v36, v136, v137
  v_max3_f32 v36, v36, v138, v139
  v_max3_f32 v36, v36, v140, v141
  v_max3_f32 v36, v36, v142, v143
  s_add_u32 s30, s30, 4096
  s_sub_u32 s33, s33, 1
  s_cmp_lg_u32 s33, 0
  s_cbranch_scc1 .fz_kernel_a_s1
  v_mov_b32 v35, v36
  s_nop 1
  v_permlane32_swap_b32 v35, v36
  v_max_f32 v36, v36, v35
  v_sub_f32 v36, 0, v36
  v_mov_b32 v144, v36
  v_mov_b32 v48, 0
  v_mov_b32 v145, v36
  v_mov_b32 v49, 0
  v_mov_b32 v146, v36
  v_mov_b32 v50, 0
  v_mov_b32 v147, v36
  v_mov_b32 v51, 0
  v_mov_b32 v148, v36
  v_mov_b32 v52, 0
  v_mov_b32 v149, v36
  v_mov_b32 v53, 0
  v_mov_b32 v150, v36
  v_mov_b32 v54, 0
  v_mov_b32 v151, v36
  v_mov_b32 v55, 0
  v_mov_b32 v152, v36
  v_mov_b32 v56, 0
  v_mov_b32 v153, v36
  v_mov_b32 v57, 0
  v_mov_b32 v154, v36
  v_mov_b32 v58, 0
  v_mov_b32 v155, v36
  v_mov_b32 v59, 0
  v_mov_b32 v156, v36
  v_mov_b32 v60, 0
  v_mov_b32 v157, v36
  v_mov_b32 v61, 0
  v_mov_b32 v158, v36
  v_mov_b32 v62, 0
  v_mov_b32 v159, v36
  v_mov_b32 v63, 0
  v_mov_b32 v112, 0
  v_mov_b32 v113, 0
  v_mov_b32 v114, 0
  v_mov_b32 v115, 0
  s_mov_b32 s30, s36
  s_mov_b32 s33, 64
.fz_kernel_a_s2:
  buffer_load_dwordx4 v[168:171], v3, s[4:7], s30 offen offset:0
  buffer_load_dwordx4 v[172:175], v3, s[4:7], s30 offen offset:1024
  buffer_load_dwordx4 v[176:179], v3, s[4:7], s30 offen offset:2048
  buffer_load_dwordx4 v[180:183], v3, s[4:7], s30 offen offset:3072
  s_waitcnt vmcnt(0)
  v_mfma_f32_32x32x16_bf16 v[128:143], v[168:171], v[16:19], v[144:159]
  v_mfma_f32_32x32x16_bf16 v[128:143], v[172:175], v[20:23], v[128:143]
  s_nop 11
  v_exp_f32 v128, v128
  v_exp_f32 v129, v129
  v_exp_f32 v130, v130
  v_exp_f32 v131, v131
  v_exp_f32 v132, v132
  v_exp_f32 v133, v133
  v_exp_f32 v134, v134
  v_exp_f32 v135, v135
  v_exp_f32 v136, v136
  v_exp_f32 v137, v137
  v_exp_f32 v138, v138
  v_exp_f32 v139, v139
  v_exp_f32 v140, v140
  v_exp_f32 v141, v141
  v_exp_f32 v142, v142
  v_exp_f32 v143, v143
  v_cvt_pk_bf16_f32 v160, v128, v129
  v_cvt_pk_bf16_f32 v161, v130, v131
  v_cvt_pk_bf16_f32 v162, v132, v133
  v_cvt_pk_bf16_f32 v163, v134, v135
  v_cvt_pk_bf16_f32 v164, v136, v137
  v_cvt_pk_bf16_f32 v165, v138, v139
  v_cvt_pk_bf16_f32 v166, v140, v141
  v_cvt_pk_bf16_f32 v167, v142, v143
  v_mfma_f32_32x32x16_bf16 v[48:63], v[176:179], v[160:163], v[48:63]
  s_nop 0
  v_mfma_f32_32x32x16_bf16 v[48:63], v[180:183], v[164:167], v[48:63]
  v_smfmac_f32_16x16x64_bf16 v[112:115], v[12:15], v[160:167], v11
  s_add_u32 s30, s30, 4096
  s_sub_u32 s33, s33, 1
  s_cmp_lg_u32 s33, 0
  s_cbranch_scc1 .fz_kernel_a_s2
  s_nop 7
  v_add_f32 v112, v112, v114
  v_add_f32 v113, v113, v115
  v_cndmask_b32 v33, v112, v113, s[34:35]
  s_nop 7
  s_setpc_b64 s[68:69]
.fz_kernel_serv:
  s_mov_b32 s24, s44
  s_mov_b32 s25, s45
  s_mov_b32 s26, 0x200000
  s_mov_b32 s27, 0x00020000
  v_lshrrev_b32 v8, 3, v2
  v_and_b32 v9, 7, v2
  v_bfe_u32 v10, v2, 4, 1
  v_lshlrev_b32 v10, 2, v10
  v_xor_b32 v9, v9, v10
  v_lshlrev_b32 v9, 4, v9
  v_lshl_add_u32 v10, v8, 11, v9
  s_barrier
  s_cmp_eq_u32 s16, 5
  s_cbranch_scc1 .fz_kernel_sv1
  s_mov_b32 s38, 0
.fz_kernel_cw36:
  ds_read_b32 v7, v6 offset:256
  s_add_u32 s38, s38, 1
  s_waitcnt lgkmcnt(0)
  v_cmp_gt_u32 vcc, 4, v7
  s_cbranch_vccz .fz_kernel_cw36d
  s_cmp_lt_u32 s38, 8388608
  s_cbranch_scc1 .fz_kernel_cw36
.fz_kernel_cw36d:
  v_lshlrev_b32 v7, 7, v2
  s_lshl_b32 s31, s18, 11
  s_lshl_b32 s33, 1, s17
  s_add_u32 s31, s31, s67
  s_add_u32 s31, s31, 0x1800000
  v_mov_b32 v8, s33
  s_mov_b64 exec, 0xffff
  buffer_atomic_or v8, v7, s[4:7], s31 offen sc1
  s_mov_b64 exec, -1
  s_mov_b32 s38, 0
.fz_kernel_kw37:
  s_sleep 2
  ds_read_b32 v7, v6
  s_add_u32 s38, s38, 1
  s_waitcnt lgkmcnt(0)
  v_readfirstlane_b32 s31, v7
  s_bcnt1_i32_b32 s31, s31
  s_cmp_ge_u32 s31, 8
  s_cbranch_scc1 .fz_kernel_kw37d
  s_cmp_lt_u32 s38, 1048576
  s_cbranch_scc1 .fz_kernel_kw37
.fz_kernel_kw37d:
  s_branch .fz_kernel_sv2
.fz_kernel_sv1:
  s_add_u32 s37, s19, s67
  s_mov_b64 exec, 1
  s_mov_b32 s38, 0
.fz_kernel_po38:
  buffer_load_dword v7, v4, s[4:7], s37 offen offset:0 sc1
  s_add_u32 s38, s38, 1
  s_waitcnt vmcnt(0)
  ds_or_b32 v6, v7 offset:0
  v_cmp_ne_u32 vcc, 0xffff, v7
  s_cbranch_vccz .fz_kernel_po38d
  s_cmp_lt_u32 s38, 131072
  s_cbranch_scc1 .fz_kernel_po38
.fz_kernel_po38d:
  s_mov_b64 exec, -1
.fz_kernel_sv2:
  s_and_b32 s30, s16, 1
  s_lshl_b32 s30, s30, 16
  s_add_u32 s32, s30, 65536
  s_lshl_b32 s31, s18, 7
  v_add_u32 v10, s31, v10
.fz_kernel_sv3:
  s_mov_b32 m0, s30
  s_lshl_b32 s31, s30, 4
  s_add_u32 s30, s30, 1024
  buffer_load_dwordx4 v10, s[24:27], s31 offen lds
  s_cmp_lg_u32 s30, s32
  s_waitcnt vmcnt(3)
  s_cbranch_scc1 .fz_kernel_sv3
  s_cmp_lg_u32 s16, 4
  s_cbranch_scc1 .fz_kernel_ct39e
  s_getpc_b64 s[0:1]
.fz_kernel_ct39:
  s_sub_u32 s0, s0, .fz_kernel_ct39-fz_kernel
  s_subb_u32 s1, s1, 0
  s_lshr_b32 s31, s2, 3
  s_mulk_i32 s31, 0x500
  v_lshl_add_u32 v1, v2, 7, s31
  v_min_u32 v1, .fz_kernel_last-fz_kernel, v1
  s_mov_b64 exec, 0x3ff
  global_load_dword v1, v1, s[0:1]
  s_mov_b64 exec, -1
.fz_kernel_ct39e:
  s_waitcnt vmcnt(0)
  s_barrier
  s_cmp_eq_u32 s16, 5
  s_cbranch_scc1 .fz_kernel_sv4
  s_mov_b32 s38, 0
.fz_kernel_cw40:
  ds_read_b32 v7, v6 offset:264
  s_add_u32 s38, s38, 1
  s_waitcnt lgkmcnt(0)
  v_cmp_gt_u32 vcc, 4, v7
  s_cbranch_vccz .fz_kernel_cw40d
  s_cmp_lt_u32 s38, 8388608
  s_cbranch_scc1 .fz_kernel_cw40
.fz_kernel_cw40d:
  v_lshlrev_b32 v7, 11, v2
  s_lshl_b32 s31, s17, 7
  s_lshl_b32 s33, 1, s18
  s_add_u32 s31, s31, s67
  s_add_u32 s31, s31, 0x1800004
  v_mov_b32 v8, s33
  s_mov_b64 exec, 0xffff
  buffer_atomic_or v8, v7, s[4:7], s31 offen sc1
  s_mov_b64 exec, -1
  s_mov_b64 exec, 1
  ds_or_b32 v6, v8 offset:8
  s_mov_b64 exec, -1
  s_branch .fz_kernel_sv5
.fz_kernel_sv4:
  s_add_u32 s37, s19, s67
  s_mov_b64 exec, 1
  s_mov_b32 s38, 0
.fz_kernel_po41:
  buffer_load_dword v7, v4, s[4:7], s37 offen offset:4 sc1
  s_add_u32 s38, s38, 1
  s_waitcnt vmcnt(0)
  ds_or_b32 v6, v7 offset:8
  v_cmp_ne_u32 vcc, 0xffff, v7
  s_cbranch_vccz .fz_kernel_po41d
  s_cmp_lt_u32 s38, 131072
  s_cbranch_scc1 .fz_kernel_po41
.fz_kernel_po41d:
  s_mov_b64 exec, -1
.fz_kernel_sv5:
  s_mov_b32 s72, s66
  s_mov_b32 s73, s65
  s_mov_b32 s74, s67
  s_mov_b32 s75, s62
  s_cmp_lg_u32 s62, 0
  s_cbranch_scc1 .fz_kernel_w_lt
  s_mov_b32 s62, 1
  s_mov_b32 s63, 0x2000000
  s_mov_b32 s64, 0x2800000
  s_mov_b32 s65, 0x1400000
  s_mov_b32 s66, 0x1c42000
  s_mov_b32 s67, 12
  s_mov_b32 s71, 159776
  v_mov_b32 v6, 159832
  s_branch .fz_kernel_q_prod2
.fz_kernel_w_lt:
  s_barrier
  s_barrier
  s_barrier
  s_branch .fz_kernel_fin
.fz_kernel_w_pt:
  v_lshlrev_b32 v44, 5, v17
  v_add_u32 v44, 155648, v44
  s_mov_b64 exec, vcc
  ds_read_b128 v[240:243], v44 offset:7424
  ds_read_b128 v[244:247], v44 offset:7440
  ds_read_b128 v[248:251], v44 offset:7488
  ds_read_b128 v[252:255], v44 offset:7504
  s_waitcnt lgkmcnt(0)
  v_pk_add_f32 v[64:65], v[64:65], v[240:241]
  v_pk_add_f32 v[66:67], v[66:67], v[242:243]
  v_pk_add_f32 v[68:69], v[68:69], v[244:245]
  v_pk_add_f32 v[70:71], v[70:71], v[246:247]
  v_pk_add_f32 v[72:73], v[72:73], v[248:249]
  v_pk_add_f32 v[74:75], v[74:75], v[250:251]
  v_pk_add_f32 v[76:77], v[76:77], v[252:253]
  v_pk_add_f32 v[78:79], v[78:79], v[254:255]
  ds_read_b128 v[240:243], v44 offset:7552
  ds_read_b128 v[244:247], v44 offset:7568
  ds_read_b128 v[248:251], v44 offset:7616
  ds_read_b128 v[252:255], v44 offset:7632
  s_waitcnt lgkmcnt(0)
  v_pk_add_f32 v[80:81], v[80:81], v[240:241]
  v_pk_add_f32 v[82:83], v[82:83], v[242:243]
  v_pk_add_f32 v[84:85], v[84:85], v[244:245]
  v_pk_add_f32 v[86:87], v[86:87], v[246:247]
  v_pk_add_f32 v[88:89], v[88:89], v[248:249]
  v_pk_add_f32 v[90:91], v[90:91], v[250:251]
  v_pk_add_f32 v[92:93], v[92:93], v[252:253]
  v_pk_add_f32 v[94:95], v[94:95], v[254:255]
  s_mov_b64 exec, -1
  s_branch .fz_kernel_w_pb
.fz_kernel_pk42c:
  s_call_b64 s[68:69], .fz_kernel_pick
  s_branch .fz_kernel_pk42
.fz_kernel_pk43c:
  s_call_b64 s[68:69], .fz_kernel_pick
  s_branch .fz_kernel_pk43
.fz_kernel_pk44c:
  s_call_b64 s[68:69], .fz_kernel_pick
  s_branch .fz_kernel_pk44
.fz_kernel_pk45c:
  s_call_b64 s[68:69], .fz_kernel_pick
  s_branch .fz_kernel_pk45
.fz_kernel_pk46c:
  s_call_b64 s[68:69], .fz_kernel_pick
  s_branch .fz_kernel_pk46
.fz_kernel_pk47c:
  s_call_b64 s[68:69], .fz_kernel_pick
  s_branch .fz_kernel_pk47
.fz_kernel_pk48c:
  s_call_b64 s[68:69], .fz_kernel_pick
  s_branch .fz_kernel_pk48
.fz_kernel_pk49c:
  s_call_b64 s[68:69], .fz_kernel_pick
  s_branch .fz_kernel_pk49
.fz_kernel_pk50c:
  s_call_b64 s[68:69], .fz_kernel_pick
  s_branch .fz_kernel_pk50
.fz_kernel_pk51c:
  s_call_b64 s[68:69], .fz_kernel_pick
  s_branch .fz_kernel_pk51
.fz_kernel_pk52c:
  s_call_b64 s[68:69], .fz_kernel_pick
  s_branch .fz_kernel_pk52
.fz_kernel_pk53c:
  s_call_b64 s[68:69], .fz_kernel_pick
  s_branch .fz_kernel_pk53
.fz_kernel_pk54c:
  s_call_b64 s[68:69], .fz_kernel_pick
  s_branch .fz_kernel_pk54
.fz_kernel_pk55c:
  s_call_b64 s[68:69], .fz_kernel_pick
  s_branch .fz_kernel_pk55
.fz_kernel_pk56c:
  s_call_b64 s[68:69], .fz_kernel_pick
  s_branch .fz_kernel_pk56
.fz_kernel_pk57c:
  s_call_b64 s[68:69], .fz_kernel_pick
  s_branch .fz_kernel_pk57
.fz_kernel_c_nl:
  s_barrier
  s_branch .fz_kernel_c_np
.fz_kernel_c_coef:
  v_fma_f32 v242, -v240, v240, v242
  v_fma_f32 v243, -v241, v241, v243
  v_rsq_f32 v248, abs(v242)
  v_rsq_f32 v249, abs(v243)
  v_mul_f32 v254, v240, v248
  v_sub_f32 v254, 0, v254
  v_mov_b32 v252, 1.0
  v_fmac_f32 v252, 0x44800000, v248
  v_fma_f32 v242, v242, v24, -v25
  v_max_f32 v242, 0, v242
  v_mul_f32 v248, v252, v252
  v_fma_f32 v248, v248, v242, v25
  v_rsq_f32 v248, v248
  v_mul_f32 v240, v23, v240
  v_mul_f32 v248, v248, v252
  v_mul_f32 v250, v248, v240
  v_sub_f32 v250, 0, v250
  v_mul_f32 v255, v241, v249
  v_sub_f32 v255, 0, v255
  v_mov_b32 v253, 1.0
  v_fmac_f32 v253, 0x44800000, v249
  s_cmp_eq_u32 s3, 0
  s_cbranch_scc1 .fz_kernel_hb63
  s_barrier
  s_sub_u32 s3, s3, 1
.fz_kernel_hb63:
  v_fma_f32 v243, v243, v24, -v25
  v_max_f32 v243, 0, v243
  v_mul_f32 v249, v253, v253
  v_fma_f32 v249, v249, v243, v25
  v_rsq_f32 v249, v249
  v_mul_f32 v241, v23, v241
  v_mul_f32 v249, v249, v253
  v_mul_f32 v251, v249, v241
  v_sub_f32 v251, 0, v251
  s_setpc_b64 s[68:69]
.fz_kernel_c_gur:
  v_min_u32 v9, v144, v146
  v_cmp_eq_u32 s[8:9], 0, v9
  v_min_u32 v9, v148, v150
  v_cmp_eq_u32 s[10:11], 0, v9
  v_min_u32 v9, v152, v154
  v_cmp_eq_u32 s[12:13], 0, v9
  v_min_u32 v9, v156, v158
  v_cmp_eq_u32 s[14:15], 0, v9
  s_add_u32 s38, s38, 1
  s_cmp_ge_u32 s38, 131072
  s_cbranch_scc1 .fz_kernel_c_gud
  s_or_b64 exec, s[8:9], 1
  buffer_load_dwordx4 v[144:147], v21, s[4:7], s21 offen offset:0 sc1
  s_or_b64 exec, s[10:11], 1
  buffer_load_dwordx4 v[148:151], v21, s[4:7], s21 offen offset:512 sc1
  s_or_b64 exec, s[12:13], 1
  buffer_load_dwordx4 v[152:155], v21, s[4:7], s21 offen offset:1024 sc1
  s_or_b64 exec, s[14:15], 1
  buffer_load_dwordx4 v[156:159], v21, s[4:7], s21 offen offset:1536 sc1
  s_mov_b64 exec, -1
  s_branch .fz_kernel_c_gu
.fz_kernel_c_pur:
  v_min3_u32 v9, v144, v146, v148
  v_min_u32 v9, v9, v150
  v_cmp_eq_u32 s[8:9], 0, v9
  v_min3_u32 v9, v152, v154, v156
  v_min_u32 v9, v9, v158
  v_cmp_eq_u32 s[10:11], 0, v9
  v_min3_u32 v9, v160, v162, v164
  v_min_u32 v9, v9, v166
  v_cmp_eq_u32 s[12:13], 0, v9
  v_min3_u32 v9, v168, v170, v172
  v_min_u32 v9, v9, v174
  v_cmp_eq_u32 s[14:15], 0, v9
  s_cmp_eq_u32 s3, 0
  s_cbranch_scc1 .fz_kernel_hb67
  s_barrier
  s_sub_u32 s3, s3, 1
.fz_kernel_hb67:
  s_add_u32 s38, s38, 1
  s_cmp_ge_u32 s38, 131072
  s_cbranch_scc1 .fz_kernel_c_pud
  s_or_b64 exec, s[8:9], 1
  buffer_load_dwordx4 v[144:147], v10, s[4:7], s21 offen offset:0 sc1
  buffer_load_dwordx4 v[148:151], v10, s[4:7], s21 offen offset:16 sc1
  s_or_b64 exec, s[10:11], 1
  buffer_load_dwordx4 v[152:155], v10, s[4:7], s21 offen offset:2048 sc1
  buffer_load_dwordx4 v[156:159], v10, s[4:7], s21 offen offset:2064 sc1
  s_or_b64 exec, s[12:13], 1
  buffer_load_dwordx4 v[160:163], v10, s[4:7], s22 offen offset:0 sc1
  buffer_load_dwordx4 v[164:167], v10, s[4:7], s22 offen offset:16 sc1
  s_or_b64 exec, s[14:15], 1
  buffer_load_dwordx4 v[168:171], v10, s[4:7], s22 offen offset:2048 sc1
  buffer_load_dwordx4 v[172:175], v10, s[4:7], s22 offen offset:2064 sc1
  s_mov_b64 exec, -1
  s_branch .fz_kernel_c_pu
.fz_kernel_last:
  s_endpgm

.section .rodata,"a"
.p2align 6
.amdhsa_kernel fz_kernel
  .amdhsa_next_free_vgpr 256
  .amdhsa_next_free_sgpr 102
  .amdhsa_accum_offset 256
  .amdhsa_group_segment_fixed_size 0
  .amdhsa_kernarg_size 88
  .amdhsa_user_sgpr_count 2
  .amdhsa_user_sgpr_kernarg_segment_ptr 1
  .amdhsa_system_sgpr_workgroup_id_x 1
.end_amdhsa_kernel
```

```asm
; @launch kernel=fz_kernel grid=(256,1,1) block=(512,1,1) lds=163840
.amdgcn_target "amdgcn-amd-amdhsa--gfx950"
.text
.globl fz_kernel
.p2align 8
.type fz_kernel,@function
fz_kernel:
  s_cmp_ge_u32 s2, 256
  s_cbranch_scc1 .fz_kernel_end
  s_load_dwordx16 s[40:55], s[0:1], 0
  s_load_dwordx4 s[56:59], s[0:1], 64
  s_load_dwordx2 s[60:61], s[0:1], 80
  v_lshrrev_b32 v1, 6, v0
  v_and_b32 v2, 63, v0
  v_readfirstlane_b32 s16, v1
  s_and_b32 s21, s2, 7
  s_lshr_b32 s22, s2, 3
  s_and_b32 s23, s21, 3
  s_lshl_b32 s23, s23, 2
  s_and_b32 s24, s22, 3
  s_add_u32 s18, s23, s24
  s_lshr_b32 s24, s21, 2
  s_lshl_b32 s24, s24, 3
  s_lshr_b32 s25, s22, 2
  s_add_u32 s17, s24, s25
  s_lshl_b32 s19, s18, 4
  s_add_u32 s19, s19, s17
  s_lshl_b32 s19, s19, 7
  s_add_u32 s19, s19, 0x1800000
  v_lshlrev_b32 v3, 4, v2
  v_mov_b32 v4, 0
  v_mov_b32 v5, 1
  s_waitcnt lgkmcnt(0)
  s_mov_b32 s4, s60
  s_mov_b32 s5, s61
  s_mov_b32 s6, 0x2c00000
  s_mov_b32 s7, 0x00020000
  s_mov_b32 s62, 0
  s_mov_b32 s63, 0x400000
  s_mov_b32 s64, 0xc00000
  s_mov_b32 s65, 0x1000000
  s_mov_b32 s66, 0x1c00000
  s_mov_b32 s67, 0
  s_mov_b32 s71, 159744
  v_mov_b32 v6, 159808
  s_cmp_lt_u32 s16, 4
  s_cbranch_scc1 .fz_kernel_q_cons1
  s_cmp_ge_u32 s16, 6
  s_cbranch_scc1 .fz_kernel_q_help1
  s_mov_b32 s8, s40
  s_mov_b32 s9, s41
  s_mov_b32 s10, 0x400000
  s_mov_b32 s11, 0x00020000
  v_lshrrev_b32 v20, 3, v2
  v_and_b32 v21, 7, v2
  v_lshrrev_b32 v22, 4, v2
  v_xor_b32 v23, v21, v22
  v_lshlrev_b32 v23, 4, v23
  v_lshl_add_u32 v24, v20, 11, v23
  v_xor_b32 v25, 64, v24
  s_lshl_b32 s35, s17, 2
  s_and_b32 s31, s16, 1
  s_add_u32 s35, s35, s31
  s_lshl_b32 s35, s35, 16
  s_and_b32 s29, s18, 12
  s_lshr_b32 s33, s17, 3
  s_lshl1_add_u32 s29, s33, s29
  s_lshl2_add_u32 s29, s17, s29
  s_and_b32 s29, s29, 15
  s_mov_b32 s22, 128
  s_mov_b32 s23, 131072
  s_mov_b32 s36, -1
  v_add_u32 v40, 0, v24
  v_add_u32 v41, 15360, v25
  v_add_u32 v42, 30720, v24
  v_add_u32 v43, 46080, v25
.fz_kernel_q_pc:
  s_mov_b32 s12, s42
  s_mov_b32 s13, s43
  s_mov_b32 s14, 0x600000
  s_mov_b32 s15, 0x00020000
  v_lshrrev_b32 v28, 3, v2
  v_and_b32 v29, 7, v2
  v_bfe_u32 v30, v2, 4, 1
  v_lshlrev_b32 v30, 1, v30
  v_xor_b32 v31, v29, v30
  v_lshlrev_b32 v31, 4, v31
  v_mul_u32_u24 v28, 6144, v28
  v_add_u32 v28, v28, v31
  v_xor_b32 v29, 64, v28
  s_lshl_b32 s32, s18, 7
  s_add_u32 s39, s32, 6291456
  s_mul_i32 s33, s29, 393216
  s_add_u32 s33, s33, s32
  s_lshl_b32 s29, s29, 1
  s_mul_i32 s25, s31, 6144
  s_add_u32 s25, s25, 65536
  s_mov_b32 s30, s25
  s_add_u32 s26, s25, 49152
  s_lshl_b32 s21, s31, 12
  s_cmp_eq_u32 s31, 0
  s_mov_b32 s24, 100352
  s_cselect_b32 s24, 0, s24
  v_add_u32 v32, s24, v28
  s_mov_b32 s24, 148480
  s_cselect_b32 s24, 48128, s24
  v_add_u32 v33, s24, v29
  s_mov_b32 s24, 2048
  s_cselect_b32 s24, 96256, s24
  v_add_u32 v34, s24, v28
  s_mov_b32 s24, 50176
  s_cselect_b32 s24, 144384, s24
  v_add_u32 v35, s24, v29
  s_mov_b32 s24, 102400
  s_cselect_b32 s24, 2048, s24
  v_add_u32 v36, s24, v28
  s_mov_b32 s24, 150528
  s_cselect_b32 s24, 50176, s24
  v_add_u32 v37, s24, v29
  s_cmp_lg_u32 s62, 0
  s_cbranch_scc1 .fz_kernel_q_st2
  s_mov_b32 s34, 32
  s_call_b64 s[0:1], .fz_kernel_q_ix
  s_call_b64 s[0:1], .fz_kernel_q_iu
  s_call_b64 s[0:1], .fz_kernel_q_iu
  s_call_b64 s[0:1], .fz_kernel_q_iu
  s_waitcnt vmcnt(20)
  s_barrier
  s_call_b64 s[0:1], .fz_kernel_q_iu
  s_waitcnt vmcnt(24)
  s_barrier
  s_call_b64 s[0:1], .fz_kernel_q_iu
  s_branch .fz_kernel_q_pl
.fz_kernel_q_ix:
  s_bfe_u32 s24, s29, 0x40001
  s_mul_i32 s20, s24, s22
  s_bitcmp1_b32 s29, 0
  s_cselect_b32 s31, s23, 0
  s_add_u32 s20, s20, s35
  s_add_u32 s20, s20, s31
  s_bitcmp1_b32 s36, s24
  s_cbranch_scc0 .fz_kernel_xok1w
.fz_kernel_xok1:
  s_mov_b32 m0, s21
  s_add_u32 s21, s21, 8192
  s_and_b32 s21, s21, 0xffff
  s_add_u32 s29, s29, 1
  buffer_load_dwordx4 v40, s[8:11], s20 offen offset:0 lds
  buffer_load_dwordx4 v41, s[8:11], s20 offen offset:1024 lds
  buffer_load_dwordx4 v42, s[8:11], s20 offen offset:2048 lds
  buffer_load_dwordx4 v43, s[8:11], s20 offen offset:3072 lds
  s_setpc_b64 s[0:1]
.fz_kernel_q_iu:
  s_mov_b32 m0, s30
  s_add_u32 s30, s30, 12288
  buffer_load_dwordx4 v32, s[12:15], s33 offen offset:0 lds
  s_bfe_u32 s24, s29, 0x40001
  buffer_load_dwordx4 v33, s[12:15], s33 offen offset:1024 lds
  s_mul_i32 s20, s24, s22
  buffer_load_dwordx4 v34, s[12:15], s33 offen offset:2048 lds
  s_bitcmp1_b32 s29, 0
  s_cselect_b32 s31, s23, 0
  buffer_load_dwordx4 v35, s[12:15], s33 offen offset:3072 lds
  s_add_u32 m0, m0, 4096
  s_add_u32 s20, s20, s35
  buffer_load_dwordx4 v36, s[12:15], s33 offen offset:0 lds
  s_add_u32 s20, s20, s31
  buffer_load_dwordx4 v37, s[12:15], s33 offen offset:1024 lds
  s_bitcmp1_b32 s36, s24
  s_cbranch_scc0 .fz_kernel_xok2w
.fz_kernel_xok2:
  s_mov_b32 m0, s21
  s_add_u32 s21, s21, 8192
  s_and_b32 s21, s21, 0xffff
  s_add_u32 s29, s29, 1
  buffer_load_dwordx4 v40, s[8:11], s20 offen offset:0 lds
  s_add_u32 s33, s33, 196608
  s_cmp_eq_u32 s33, s39
  s_cselect_b32 s33, s32, s33
  buffer_load_dwordx4 v41, s[8:11], s20 offen offset:1024 lds
  s_cmp_eq_u32 s30, s26
  s_cselect_b32 s30, s25, s30
  buffer_load_dwordx4 v42, s[8:11], s20 offen offset:2048 lds
  s_sub_u32 s34, s34, 1
  s_cmp_lg_u32 s34, 0
  buffer_load_dwordx4 v43, s[8:11], s20 offen offset:3072 lds
  s_setpc_b64 s[0:1]
.fz_kernel_q_iw:
  s_mov_b32 m0, s30
  s_add_u32 s30, s30, 12288
  buffer_load_dwordx4 v32, s[12:15], s33 offen offset:0 lds
  s_nop 0
  buffer_load_dwordx4 v33, s[12:15], s33 offen offset:1024 lds
  s_nop 0
  buffer_load_dwordx4 v34, s[12:15], s33 offen offset:2048 lds
  s_nop 0
  buffer_load_dwordx4 v35, s[12:15], s33 offen offset:3072 lds
  s_add_u32 m0, m0, 4096
  s_nop 0
  buffer_load_dwordx4 v36, s[12:15], s33 offen offset:0 lds
  buffer_load_dwordx4 v37, s[12:15], s33 offen offset:1024 lds
  s_add_u32 s33, s33, 196608
  s_cmp_eq_u32 s33, s39
  s_cselect_b32 s33, s32, s33
  s_cmp_eq_u32 s30, s26
  s_cselect_b32 s30, s25, s30
  s_sub_u32 s34, s34, 1
  s_cmp_lg_u32 s34, 0
  s_setpc_b64 s[0:1]
.fz_kernel_q_st2:
  s_mov_b32 s34, 32
  s_waitcnt vmcnt(0)
  s_barrier
  s_call_b64 s[0:1], .fz_kernel_q_iw
  s_call_b64 s[0:1], .fz_kernel_q_iw
  s_mov_b64 exec, 1
  s_waitcnt vmcnt(0)
  ds_add_u32 v6, v5 offset:0x110
  s_mov_b64 exec, -1
  v_mov_b32 v12, 0x100
  s_call_b64 s[0:1], .fz_kernel_q_ix
  s_call_b64 s[0:1], .fz_kernel_q_ix
  s_call_b64 s[0:1], .fz_kernel_q_iw
  s_call_b64 s[0:1], .fz_kernel_q_iw
  s_call_b64 s[0:1], .fz_kernel_q_ix
  s_call_b64 s[0:1], .fz_kernel_q_ix
  s_waitcnt vmcnt(20)
  s_mov_b64 exec, 1
  ds_add_u32 v6, v12 offset:0x110
  s_mov_b64 exec, -1
  s_barrier
  s_waitcnt vmcnt(20)
  s_barrier
  s_call_b64 s[0:1], .fz_kernel_q_ix
  s_call_b64 s[0:1], .fz_kernel_q_iu
  s_waitcnt vmcnt(14)
  s_barrier
  s_call_b64 s[0:1], .fz_kernel_q_iu
  s_waitcnt vmcnt(20)
  s_barrier
  s_call_b64 s[0:1], .fz_kernel_q_iu
.fz_kernel_q_pl:
  s_waitcnt vmcnt(20)
  s_barrier
  s_mov_b32 m0, s30
  s_add_u32 s30, s30, 12288
  buffer_load_dwordx4 v32, s[12:15], s33 offen offset:0 lds
  s_bfe_u32 s24, s29, 0x40001
  buffer_load_dwordx4 v33, s[12:15], s33 offen offset:1024 lds
  s_mul_i32 s20, s24, s22
  buffer_load_dwordx4 v34, s[12:15], s33 offen offset:2048 lds
  s_bitcmp1_b32 s29, 0
  s_cselect_b32 s31, s23, 0
  buffer_load_dwordx4 v35, s[12:15], s33 offen offset:3072 lds
  s_add_u32 m0, m0, 4096
  s_add_u32 s20, s20, s35
  buffer_load_dwordx4 v36, s[12:15], s33 offen offset:0 lds
  s_add_u32 s20, s20, s31
  buffer_load_dwordx4 v37, s[12:15], s33 offen offset:1024 lds
  s_bitcmp1_b32 s36, s24
  s_cbranch_scc0 .fz_kernel_xok3w
.fz_kernel_xok3:
  s_mov_b32 m0, s21
  s_add_u32 s21, s21, 8192
  s_and_b32 s21, s21, 0xffff
  s_add_u32 s29, s29, 1
  buffer_load_dwordx4 v40, s[8:11], s20 offen offset:0 lds
  s_add_u32 s33, s33, 196608
  s_cmp_eq_u32 s33, s39
  s_cselect_b32 s33, s32, s33
  buffer_load_dwordx4 v41, s[8:11], s20 offen offset:1024 lds
  s_cmp_eq_u32 s30, s26
  s_cselect_b32 s30, s25, s30
  buffer_load_dwordx4 v42, s[8:11], s20 offen offset:2048 lds
  s_sub_u32 s34, s34, 1
  s_cmp_lg_u32 s34, 0
  buffer_load_dwordx4 v43, s[8:11], s20 offen offset:3072 lds
  s_cbranch_scc1 .fz_kernel_q_pl
  s_waitcnt vmcnt(20)
  s_barrier
  s_waitcnt vmcnt(10)
  s_barrier
  s_waitcnt vmcnt(0)
  s_barrier
  s_barrier
  s_branch .fz_kernel_serv
.fz_kernel_q_cons1:
  s_mov_b32 s12, s42
  s_mov_b32 s13, s43
  s_mov_b32 s14, 0x600000
  s_mov_b32 s15, 0x00020000
  s_and_b32 s20, s18, 4
  s_add_u32 s20, s20, s16
  s_cmp_ge_u32 s20, 3
  s_cbranch_scc1 .fz_kernel_q_nsp
  s_and_b32 s20, s17, 7
  s_and_b32 s21, s18, 3
  s_lshl2_add_u32 s20, s20, s21
  s_mul_i32 s20, s20, 196608
  s_or_b32 s21, s18, 3
  s_lshl4_add_u32 s21, s16, s21
  s_lshl_b32 s21, s21, 7
  s_add_u32 s20, s20, s21
  v_mul_u32_u24 v20, 6144, v2
  s_mov_b32 exec_hi, 0
  buffer_load_dword v231, v20, s[12:15], s20 offen
  s_mov_b32 exec_hi, -1
.fz_kernel_q_nsp:
  v_lshlrev_b32 v20, 2, v0
  v_add_u32 v20, 159744, v20
  s_cmp_ge_u32 s16, 2
  s_cbranch_scc1 .fz_kernel_q_nz
  ds_write_b32 v20, v4
.fz_kernel_q_nz:
  s_lshr_b32 s26, s16, 1
  s_lshl_b32 s28, s26, 13
  v_and_b32 v20, 15, v2
  v_lshrrev_b32 v21, 4, v2
  v_bfe_u32 v22, v2, 1, 3
  v_xor_b32 v22, v22, v21
  v_lshlrev_b32 v20, 7, v20
  v_lshl_add_u32 v20, v22, 4, v20
  v_add_u32 v8, s28, v20
  v_xor_b32 v9, 64, v8
.fz_kernel_q_cs:
  s_and_b32 s27, s16, 1
  s_lshl_b32 s28, s27, 1
  v_lshrrev_b32 v14, 4, v2
  v_bfe_u32 v15, v2, 2, 2
  v_lshl_add_u32 v16, v14, 3, v15
  v_lshlrev_b32 v16, 7, v16
  v_and_b32 v14, 1, v14
  v_lshrrev_b32 v15, 1, v15
  v_lshl_add_u32 v14, v14, 1, v15
  v_xor_b32 v14, s28, v14
  v_lshl_add_u32 v16, v14, 5, v16
  v_and_b32 v14, 3, v2
  v_lshl_add_u32 v16, v14, 3, v16
  v_add_u32 v12, 65536, v16
  v_xor_b32 v13, 32, v12
  v_mov_b32 v10, v12
  v_mov_b32 v11, v13
  s_mov_b32 s29, 16
  s_mov_b32 s30, 0
  v_mov_b32 v128, 0
  v_mov_b32 v129, 0
  v_mov_b32 v130, 0
  v_mov_b32 v131, 0
  v_mov_b32 v132, 0
  v_mov_b32 v133, 0
  v_mov_b32 v134, 0
  v_mov_b32 v135, 0
  v_mov_b32 v136, 0
  v_mov_b32 v137, 0
  v_mov_b32 v138, 0
  v_mov_b32 v139, 0
  v_mov_b32 v140, 0
  v_mov_b32 v141, 0
  v_mov_b32 v142, 0
  v_mov_b32 v143, 0
  v_mov_b32 v144, 0
  v_mov_b32 v145, 0
  v_mov_b32 v146, 0
  v_mov_b32 v147, 0
  v_mov_b32 v148, 0
  v_mov_b32 v149, 0
  v_mov_b32 v150, 0
  v_mov_b32 v151, 0
  v_mov_b32 v152, 0
  v_mov_b32 v153, 0
  v_mov_b32 v154, 0
  v_mov_b32 v155, 0
  v_mov_b32 v156, 0
  v_mov_b32 v157, 0
  v_mov_b32 v158, 0
  v_mov_b32 v159, 0
  v_mov_b32 v160, 0
  v_mov_b32 v161, 0
  v_mov_b32 v162, 0
  v_mov_b32 v163, 0
  v_mov_b32 v164, 0
  v_mov_b32 v165, 0
  v_mov_b32 v166, 0
  v_mov_b32 v167, 0
  v_mov_b32 v168, 0
  v_mov_b32 v169, 0
  v_mov_b32 v170, 0
  v_mov_b32 v171, 0
  v_mov_b32 v172, 0
  v_mov_b32 v173, 0
  v_mov_b32 v174, 0
  v_mov_b32 v175, 0
  v_mov_b32 v176, 0
  v_mov_b32 v177, 0
  v_mov_b32 v178, 0
  v_mov_b32 v179, 0
  v_mov_b32 v180, 0
  v_mov_b32 v181, 0
  v_mov_b32 v182, 0
  v_mov_b32 v183, 0
  v_mov_b32 v184, 0
  v_mov_b32 v185, 0
  v_mov_b32 v186, 0
  v_mov_b32 v187, 0
  v_mov_b32 v188, 0
  v_mov_b32 v189, 0
  v_mov_b32 v190, 0
  v_mov_b32 v191, 0
  v_mov_b32 v192, 0
  v_mov_b32 v193, 0
  v_mov_b32 v194, 0
  v_mov_b32 v195, 0
  v_mov_b32 v196, 0
  v_mov_b32 v197, 0
  v_mov_b32 v198, 0
  v_mov_b32 v199, 0
  v_mov_b32 v200, 0
  v_mov_b32 v201, 0
  v_mov_b32 v202, 0
  v_mov_b32 v203, 0
  v_mov_b32 v204, 0
  v_mov_b32 v205, 0
  v_mov_b32 v206, 0
  v_mov_b32 v207, 0
  v_mov_b32 v208, 0
  v_mov_b32 v209, 0
  v_mov_b32 v210, 0
  v_mov_b32 v211, 0
  v_mov_b32 v212, 0
  v_mov_b32 v213, 0
  v_mov_b32 v214, 0
  v_mov_b32 v215, 0
  v_mov_b32 v216, 0
  v_mov_b32 v217, 0
  v_mov_b32 v218, 0
  v_mov_b32 v219, 0
  v_mov_b32 v220, 0
  v_mov_b32 v221, 0
  v_mov_b32 v222, 0
  v_mov_b32 v223, 0
  s_cmp_eq_u32 s62, 0
  s_cbranch_scc1 .fz_kernel_q_i1
  s_mov_b64 exec, 1
  s_waitcnt vmcnt(0)
  ds_add_u32 v1, v5 offset:0x100
  s_mov_b64 exec, -1
.fz_kernel_q_i1:
  v_and_b32 v14, 1, v2
  v_lshlrev_b32 v14, 4, v14
  v_mov_b32 v15, 0x3f80
  v_lshlrev_b32 v14, v14, v15
  v_mov_b32 v248, 0
  v_mov_b32 v249, 0
  v_mov_b32 v250, 0
  v_mov_b32 v251, 0
  v_mov_b32 v252, 0
  v_mov_b32 v253, 0
  v_mov_b32 v254, 0
  v_mov_b32 v255, 0
  s_mov_b32 exec_lo, 0x3
  s_mov_b32 exec_hi, 0x30
  v_mov_b32 v248, v14
  s_mov_b32 exec_lo, 0xc
  s_mov_b32 exec_hi, 0xc0
  v_mov_b32 v249, v14
  s_mov_b32 exec_lo, 0x300
  s_mov_b32 exec_hi, 0x3000
  v_mov_b32 v250, v14
  s_mov_b32 exec_lo, 0xc00
  s_mov_b32 exec_hi, 0xc000
  v_mov_b32 v251, v14
  s_mov_b32 exec_lo, 0x30000
  s_mov_b32 exec_hi, 0x300000
  v_mov_b32 v252, v14
  s_mov_b32 exec_lo, 0xc0000
  s_mov_b32 exec_hi, 0xc00000
  v_mov_b32 v253, v14
  s_mov_b32 exec_lo, 0x3000000
  s_mov_b32 exec_hi, 0x30000000
  v_mov_b32 v254, v14
  s_mov_b32 exec_lo, 0xc000000
  s_mov_b32 exec_hi, 0xc0000000
  v_mov_b32 v255, v14
  s_mov_b64 exec, -1
  s_mov_b32 s12, s40
  s_mov_b32 s13, s41
  s_mov_b32 s14, 0x400000
  s_mov_b32 s15, 0x00020000
  v_lshrrev_b32 v14, 5, v2
  v_and_b32 v15, 31, v2
  v_lshlrev_b32 v14, 4, v14
  v_lshl_add_u32 v15, v15, 11, v14
  s_lshl2_add_u32 s23, s17, s16
  s_lshl_b32 s23, s23, 16
  s_lshl_b32 s22, s18, 7
  s_add_u32 s23, s22, s23
  s_waitcnt lgkmcnt(0)
  s_barrier
  ds_read_b64_tr_b16 v[56:57], v10 offset:4096
  ds_read_b64_tr_b16 v[58:59], v10 offset:4608
  ds_read_b128 v[32:35], v8 offset:0
  ds_read_b128 v[36:39], v8 offset:2048
  ds_read_b128 v[40:43], v8 offset:4096
  ds_read_b128 v[44:47], v8 offset:6144
  ds_read_b64_tr_b16 v[60:61], v11 offset:4096
  ds_read_b64_tr_b16 v[62:63], v11 offset:4608
  ds_read_b64_tr_b16 v[64:65], v10 offset:8192
  ds_read_b64_tr_b16 v[66:67], v10 offset:8704
  ds_read_b64_tr_b16 v[68:69], v11 offset:8192
  ds_read_b64_tr_b16 v[70:71], v11 offset:8704
  ds_read_b64_tr_b16 v[48:49], v10 offset:0
  ds_read_b64_tr_b16 v[50:51], v10 offset:512
  ds_read_b64_tr_b16 v[52:53], v11 offset:0
  ds_read_b64_tr_b16 v[54:55], v11 offset:512
  s_add_u32 s30, s30, 12288
  s_cmp_eq_u32 s30, 49152
  s_cselect_b32 s30, 0, s30
  v_add_u32 v8, 0x4000, v8
  v_add_u32 v10, s30, v12
  v_add_u32 v11, s30, v13
  v_and_b32 v8, 0xffff, v8
  s_waitcnt lgkmcnt(0)
  s_branch .fz_kernel_q_l0
  .p2align 6
.fz_kernel_q_loop:
  s_barrier
  v_mfma_f32_16x16x32_bf16 v[160:163], v[96:99], v[72:75], v[160:163]
  ds_read_b64_tr_b16 v[56:57], v10 offset:4096
  v_mfma_f32_16x16x32_bf16 v[164:167], v[96:99], v[76:79], v[164:167]
  ds_read_b64_tr_b16 v[58:59], v10 offset:4608
  v_mfma_f32_16x16x32_bf16 v[168:171], v[96:99], v[80:83], v[168:171]
  ds_read_b128 v[32:35], v8 offset:0
  v_mfma_f32_16x16x32_bf16 v[172:175], v[96:99], v[84:87], v[172:175]
  ds_read_b128 v[36:39], v8 offset:2048
  v_mfma_f32_16x16x32_bf16 v[176:179], v[100:103], v[72:75], v[176:179]
  ds_read_b128 v[40:43], v8 offset:4096
  v_mfma_f32_16x16x32_bf16 v[180:183], v[100:103], v[76:79], v[180:183]
  ds_read_b128 v[44:47], v8 offset:6144
  v_mfma_f32_16x16x32_bf16 v[184:187], v[100:103], v[80:83], v[184:187]
  ds_read_b64_tr_b16 v[60:61], v11 offset:4096
  v_mfma_f32_16x16x32_bf16 v[188:191], v[100:103], v[84:87], v[188:191]
  ds_read_b64_tr_b16 v[62:63], v11 offset:4608
  v_mfma_f32_16x16x32_bf16 v[192:195], v[72:75], v[104:107], v[192:195]
  ds_read_b64_tr_b16 v[64:65], v10 offset:8192
  v_mfma_f32_16x16x32_bf16 v[196:199], v[76:79], v[104:107], v[196:199]
  ds_read_b64_tr_b16 v[66:67], v10 offset:8704
  v_mfma_f32_16x16x32_bf16 v[200:203], v[80:83], v[104:107], v[200:203]
  ds_read_b64_tr_b16 v[68:69], v11 offset:8192
  v_mfma_f32_16x16x32_bf16 v[204:207], v[84:87], v[104:107], v[204:207]
  ds_read_b64_tr_b16 v[70:71], v11 offset:8704
  v_mfma_f32_16x16x32_bf16 v[208:211], v[72:75], v[108:111], v[208:211]
  ds_read_b64_tr_b16 v[48:49], v10 offset:0
  v_mfma_f32_16x16x32_bf16 v[212:215], v[76:79], v[108:111], v[212:215]
  ds_read_b64_tr_b16 v[50:51], v10 offset:512
  v_mfma_f32_16x16x32_bf16 v[216:219], v[80:83], v[108:111], v[216:219]
  ds_read_b64_tr_b16 v[52:53], v11 offset:0
  v_mfma_f32_16x16x32_bf16 v[220:223], v[84:87], v[108:111], v[220:223]
  ds_read_b64_tr_b16 v[54:55], v11 offset:512
  v_mfma_f32_16x16x32_bf16 v[128:131], v[88:91], v[72:75], v[128:131]
  s_add_u32 s30, s30, 12288
  s_cmp_eq_u32 s30, 49152
  s_cselect_b32 s30, 0, s30
  v_add_u32 v8, 0x4000, v8
  v_mfma_f32_16x16x32_bf16 v[132:135], v[88:91], v[76:79], v[132:135]
  v_add_u32 v10, s30, v12
  v_mfma_f32_16x16x32_bf16 v[136:139], v[88:91], v[80:83], v[136:139]
  v_add_u32 v11, s30, v13
  v_mfma_f32_16x16x32_bf16 v[140:143], v[88:91], v[84:87], v[140:143]
  v_and_b32 v8, 0xffff, v8
  v_mfma_f32_16x16x32_bf16 v[144:147], v[92:95], v[72:75], v[144:147]
  v_mfma_f32_16x16x32_bf16 v[148:151], v[92:95], v[76:79], v[148:151]
  v_mfma_f32_16x16x32_bf16 v[152:155], v[92:95], v[80:83], v[152:155]
  v_mfma_f32_16x16x32_bf16 v[156:159], v[92:95], v[84:87], v[156:159]
  s_waitcnt lgkmcnt(0)
.fz_kernel_q_l0:
  s_barrier
  v_mfma_f32_16x16x32_bf16 v[160:163], v[56:59], v[32:35], v[160:163]
  ds_read_b64_tr_b16 v[96:97], v10 offset:4096
  v_mfma_f32_16x16x32_bf16 v[164:167], v[56:59], v[36:39], v[164:167]
  ds_read_b64_tr_b16 v[98:99], v10 offset:4608
  v_mfma_f32_16x16x32_bf16 v[168:171], v[56:59], v[40:43], v[168:171]
  ds_read_b128 v[72:75], v9 offset:0
  v_mfma_f32_16x16x32_bf16 v[172:175], v[56:59], v[44:47], v[172:175]
  ds_read_b128 v[76:79], v9 offset:2048
  v_mfma_f32_16x16x32_bf16 v[176:179], v[60:63], v[32:35], v[176:179]
  ds_read_b128 v[80:83], v9 offset:4096
  v_mfma_f32_16x16x32_bf16 v[180:183], v[60:63], v[36:39], v[180:183]
  ds_read_b128 v[84:87], v9 offset:6144
  v_mfma_f32_16x16x32_bf16 v[184:187], v[60:63], v[40:43], v[184:187]
  ds_read_b64_tr_b16 v[100:101], v11 offset:4096
  v_mfma_f32_16x16x32_bf16 v[188:191], v[60:63], v[44:47], v[188:191]
  ds_read_b64_tr_b16 v[102:103], v11 offset:4608
  v_mfma_f32_16x16x32_bf16 v[192:195], v[32:35], v[64:67], v[192:195]
  ds_read_b64_tr_b16 v[104:105], v10 offset:8192
  v_mfma_f32_16x16x32_bf16 v[196:199], v[36:39], v[64:67], v[196:199]
  ds_read_b64_tr_b16 v[106:107], v10 offset:8704
  v_mfma_f32_16x16x32_bf16 v[200:203], v[40:43], v[64:67], v[200:203]
  ds_read_b64_tr_b16 v[108:109], v11 offset:8192
  v_mfma_f32_16x16x32_bf16 v[204:207], v[44:47], v[64:67], v[204:207]
  ds_read_b64_tr_b16 v[110:111], v11 offset:8704
  v_mfma_f32_16x16x32_bf16 v[208:211], v[32:35], v[68:71], v[208:211]
  ds_read_b64_tr_b16 v[88:89], v10 offset:0
  v_mfma_f32_16x16x32_bf16 v[212:215], v[36:39], v[68:71], v[212:215]
  ds_read_b64_tr_b16 v[90:91], v10 offset:512
  v_mfma_f32_16x16x32_bf16 v[216:219], v[40:43], v[68:71], v[216:219]
  ds_read_b64_tr_b16 v[92:93], v11 offset:0
  v_mfma_f32_16x16x32_bf16 v[220:223], v[44:47], v[68:71], v[220:223]
  ds_read_b64_tr_b16 v[94:95], v11 offset:512
  v_mfma_f32_16x16x32_bf16 v[128:131], v[48:51], v[32:35], v[128:131]
  s_add_u32 s30, s30, 12288
  s_cmp_eq_u32 s30, 49152
  s_cselect_b32 s30, 0, s30
  v_add_u32 v9, 0x4000, v9
  v_mfma_f32_16x16x32_bf16 v[132:135], v[48:51], v[36:39], v[132:135]
  v_add_u32 v10, s30, v12
  v_mfma_f32_16x16x32_bf16 v[136:139], v[48:51], v[40:43], v[136:139]
  v_add_u32 v11, s30, v13
  v_mfma_f32_16x16x32_bf16 v[140:143], v[48:51], v[44:47], v[140:143]
  v_and_b32 v9, 0xffff, v9
  v_mfma_f32_16x16x32_bf16 v[144:147], v[52:55], v[32:35], v[144:147]
  s_sub_u32 s29, s29, 1
  s_cmp_lg_u32 s29, 0
  v_mfma_f32_16x16x32_bf16 v[148:151], v[52:55], v[36:39], v[148:151]
  v_mfma_f32_16x16x32_bf16 v[152:155], v[52:55], v[40:43], v[152:155]
  v_mfma_f32_16x16x32_bf16 v[156:159], v[52:55], v[44:47], v[156:159]
  s_waitcnt lgkmcnt(0)
  s_cbranch_scc1 .fz_kernel_q_loop
  s_cmp_lg_u32 s62, 0
  s_cbranch_scc1 .fz_kernel_q_nr
  buffer_load_dwordx4 v[232:235], v15, s[12:15], s23 offen offset:0
  buffer_load_dwordx4 v[236:239], v15, s[12:15], s23 offen offset:32
  buffer_load_dwordx4 v[240:243], v15, s[12:15], s23 offen offset:64
  buffer_load_dwordx4 v[244:247], v15, s[12:15], s23 offen offset:96
.fz_kernel_q_nr:
  s_barrier
  v_mfma_f32_16x16x32_bf16 v[160:163], v[96:99], v[72:75], v[160:163]
  s_lshl_b32 s31, s26, 8
  s_add_u32 s31, s31, 155648
  v_and_b32 v14, 15, v2
  v_and_b32 v15, 48, v2
  v_mfma_f32_16x16x32_bf16 v[164:167], v[96:99], v[76:79], v[164:167]
  s_lshl_b32 s33, s27, 7
  s_add_u32 s33, s33, 155648
  v_lshlrev_b32 v14, 2, v14
  v_mov_b32 v1, 159952
  v_mfma_f32_16x16x32_bf16 v[168:171], v[96:99], v[80:83], v[168:171]
  v_add_u32 v29, s33, v14
  v_add_u32 v14, s31, v14
  v_mfma_f32_16x16x32_bf16 v[172:175], v[96:99], v[84:87], v[172:175]
  v_add_u32 v28, s33, v15
  v_add_u32 v15, s31, v15
  v_mfma_f32_16x16x32_bf16 v[176:179], v[100:103], v[72:75], v[176:179]
  ds_read_b32 v1, v1
  v_add_u32 v64, 4608, v14
  v_mfma_f32_16x16x32_bf16 v[180:183], v[100:103], v[76:79], v[180:183]
  ds_read_b128 v[120:123], v28 offset:5888
  v_mfma_f32_16x16x32_bf16 v[184:187], v[100:103], v[80:83], v[184:187]
  ds_read_b128 v[124:127], v28 offset:5952
  v_mfma_f32_16x16x32_bf16 v[188:191], v[100:103], v[84:87], v[188:191]
  ds_read2_b32 v[224:225], v64 offset0:0 offset1:128
  v_mfma_f32_16x16x32_bf16 v[192:195], v[72:75], v[104:107], v[192:195]
  ds_read2_b32 v[226:227], v64 offset0:16 offset1:144
  v_mfma_f32_16x16x32_bf16 v[196:199], v[76:79], v[104:107], v[196:199]
  ds_read2_b32 v[228:229], v64 offset0:32 offset1:160
  v_mfma_f32_16x16x32_bf16 v[200:203], v[80:83], v[104:107], v[200:203]
  ds_read2_b32 v[230:231], v64 offset0:48 offset1:176
  v_mfma_f32_16x16x32_bf16 v[204:207], v[84:87], v[104:107], v[204:207]
  ds_read_b32 v24, v29 offset:6144
  v_mfma_f32_16x16x32_bf16 v[208:211], v[72:75], v[108:111], v[208:211]
  ds_read_b32 v26, v29 offset:6208
  v_mfma_f32_16x16x32_bf16 v[212:215], v[76:79], v[108:111], v[212:215]
  ds_read_b128 v[32:35], v15 offset:4608
  ds_read_b128 v[48:51], v15 offset:5120
  v_mfma_f32_16x16x32_bf16 v[216:219], v[80:83], v[108:111], v[216:219]
  ds_read_b128 v[36:39], v15 offset:4672
  ds_read_b128 v[52:55], v15 offset:5184
  v_mfma_f32_16x16x32_bf16 v[220:223], v[84:87], v[108:111], v[220:223]
  ds_read_b128 v[40:43], v15 offset:4736
  ds_read_b128 v[56:59], v15 offset:5248
  v_mfma_f32_16x16x32_bf16 v[128:131], v[88:91], v[72:75], v[128:131]
  ds_read_b128 v[44:47], v15 offset:4800
  ds_read_b128 v[60:63], v15 offset:5312
  v_mfma_f32_16x16x32_bf16 v[132:135], v[88:91], v[76:79], v[132:135]
  ds_read_b128 v[112:115], v28 offset:5632
  ds_read_b128 v[116:119], v28 offset:5696
  v_mfma_f32_16x16x32_bf16 v[136:139], v[88:91], v[80:83], v[136:139]
  s_lshl1_add_u32 s34, s18, s27
  s_lshl4_add_u32 s34, s34, s17
  s_lshl1_add_u32 s34, s34, s26
  v_mfma_f32_16x16x32_bf16 v[140:143], v[88:91], v[84:87], v[140:143]
  s_lshl_b32 s36, s34, 13
  s_add_u32 s36, s36, s63
  s_add_u32 s37, s36, 4096
  v_mfma_f32_16x16x32_bf16 v[144:147], v[92:95], v[72:75], v[144:147]
  s_lshl_b32 s34, s16, 12
  s_add_u32 s34, s34, 131072
  v_add_u32 v9, s34, v3
  v_mfma_f32_16x16x32_bf16 v[148:151], v[92:95], v[76:79], v[148:151]
  v_xor_b32 v8, 8192, v9
  v_mfma_f32_16x16x32_bf16 v[152:155], v[92:95], v[80:83], v[152:155]
  v_mfma_f32_16x16x32_bf16 v[156:159], v[92:95], v[84:87], v[156:159]
  s_waitcnt lgkmcnt(12)
  v_cmp_ne_u32 vcc, 0, v1
  s_cbranch_vccnz .fz_kernel_q_patch
.fz_kernel_q_pback:
  v_pk_mul_f32 v[64:65], v[120:121], v[224:225] op_sel:[0,1] op_sel_hi:[1,1]
  v_pk_fma_f32 v[160:161], v[160:161], v[224:225], v[64:65] op_sel_hi:[1,0,1]
  v_pk_mul_f32 v[66:67], v[122:123], v[224:225] op_sel:[0,1] op_sel_hi:[1,1]
  v_pk_fma_f32 v[162:163], v[162:163], v[224:225], v[66:67] op_sel_hi:[1,0,1]
  v_pk_mul_f32 v[68:69], v[124:125], v[224:225] op_sel:[0,1] op_sel_hi:[1,1]
  v_pk_fma_f32 v[176:177], v[176:177], v[224:225], v[68:69] op_sel_hi:[1,0,1]
  v_pk_mul_f32 v[70:71], v[126:127], v[224:225] op_sel:[0,1] op_sel_hi:[1,1]
  v_pk_fma_f32 v[178:179], v[178:179], v[224:225], v[70:71] op_sel_hi:[1,0,1]
  v_cvt_pk_bf16_f32 v80, v160, v161
  v_cvt_pk_bf16_f32 v81, v162, v163
  v_cvt_pk_bf16_f32 v82, v176, v177
  v_cvt_pk_bf16_f32 v83, v178, v179
  v_pk_mul_f32 v[64:65], v[120:121], v[226:227] op_sel:[0,1] op_sel_hi:[1,1]
  v_pk_fma_f32 v[164:165], v[164:165], v[226:227], v[64:65] op_sel_hi:[1,0,1]
  v_pk_mul_f32 v[66:67], v[122:123], v[226:227] op_sel:[0,1] op_sel_hi:[1,1]
  v_pk_fma_f32 v[166:167], v[166:167], v[226:227], v[66:67] op_sel_hi:[1,0,1]
  v_pk_mul_f32 v[68:69], v[124:125], v[226:227] op_sel:[0,1] op_sel_hi:[1,1]
  v_pk_fma_f32 v[180:181], v[180:181], v[226:227], v[68:69] op_sel_hi:[1,0,1]
  v_pk_mul_f32 v[70:71], v[126:127], v[226:227] op_sel:[0,1] op_sel_hi:[1,1]
  v_pk_fma_f32 v[182:183], v[182:183], v[226:227], v[70:71] op_sel_hi:[1,0,1]
  v_cvt_pk_bf16_f32 v84, v164, v165
  v_cvt_pk_bf16_f32 v85, v166, v167
  v_cvt_pk_bf16_f32 v86, v180, v181
  v_cvt_pk_bf16_f32 v87, v182, v183
  v_permlane16_swap_b32 v80, v84
  v_permlane16_swap_b32 v81, v85
  v_permlane16_swap_b32 v82, v86
  v_permlane16_swap_b32 v83, v87
  buffer_store_dwordx4 v[80:83], v3, s[4:7], s36 offen offset:0 sc1
  buffer_store_dwordx4 v[84:87], v3, s[4:7], s36 offen offset:1024 sc1
  v_pk_mul_f32 v[64:65], v[120:121], v[228:229] op_sel:[0,1] op_sel_hi:[1,1]
  v_pk_fma_f32 v[168:169], v[168:169], v[228:229], v[64:65] op_sel_hi:[1,0,1]
  v_pk_mul_f32 v[66:67], v[122:123], v[228:229] op_sel:[0,1] op_sel_hi:[1,1]
  v_pk_fma_f32 v[170:171], v[170:171], v[228:229], v[66:67] op_sel_hi:[1,0,1]
  v_pk_mul_f32 v[68:69], v[124:125], v[228:229] op_sel:[0,1] op_sel_hi:[1,1]
  v_pk_fma_f32 v[184:185], v[184:185], v[228:229], v[68:69] op_sel_hi:[1,0,1]
  v_pk_mul_f32 v[70:71], v[126:127], v[228:229] op_sel:[0,1] op_sel_hi:[1,1]
  v_pk_fma_f32 v[186:187], v[186:187], v[228:229], v[70:71] op_sel_hi:[1,0,1]
  v_cvt_pk_bf16_f32 v96, v168, v169
  v_cvt_pk_bf16_f32 v97, v170, v171
  v_cvt_pk_bf16_f32 v98, v184, v185
  v_cvt_pk_bf16_f32 v99, v186, v187
  v_pk_mul_f32 v[64:65], v[120:121], v[230:231] op_sel:[0,1] op_sel_hi:[1,1]
  v_pk_fma_f32 v[172:173], v[172:173], v[230:231], v[64:65] op_sel_hi:[1,0,1]
  v_pk_mul_f32 v[66:67], v[122:123], v[230:231] op_sel:[0,1] op_sel_hi:[1,1]
  v_pk_fma_f32 v[174:175], v[174:175], v[230:231], v[66:67] op_sel_hi:[1,0,1]
  v_pk_mul_f32 v[68:69], v[124:125], v[230:231] op_sel:[0,1] op_sel_hi:[1,1]
  v_pk_fma_f32 v[188:189], v[188:189], v[230:231], v[68:69] op_sel_hi:[1,0,1]
  v_pk_mul_f32 v[70:71], v[126:127], v[230:231] op_sel:[0,1] op_sel_hi:[1,1]
  v_pk_fma_f32 v[190:191], v[190:191], v[230:231], v[70:71] op_sel_hi:[1,0,1]
  v_cvt_pk_bf16_f32 v100, v172, v173
  v_cvt_pk_bf16_f32 v101, v174, v175
  v_cvt_pk_bf16_f32 v102, v188, v189
  v_cvt_pk_bf16_f32 v103, v190, v191
  v_permlane16_swap_b32 v96, v100
  v_permlane16_swap_b32 v97, v101
  v_permlane16_swap_b32 v98, v102
  v_permlane16_swap_b32 v99, v103
  buffer_store_dwordx4 v[96:99], v3, s[4:7], s37 offen offset:0 sc1
  buffer_store_dwordx4 v[100:103], v3, s[4:7], s37 offen offset:1024 sc1
  s_waitcnt lgkmcnt(0)
  v_pk_mul_f32 v[64:65], v[48:49], v[24:25] op_sel_hi:[1,0]
  v_pk_fma_f32 v[192:193], v[192:193], v[32:33], v[64:65]
  v_pk_mul_f32 v[66:67], v[50:51], v[24:25] op_sel_hi:[1,0]
  v_pk_fma_f32 v[194:195], v[194:195], v[34:35], v[66:67]
  v_pk_mul_f32 v[68:69], v[48:49], v[26:27] op_sel_hi:[1,0]
  v_pk_fma_f32 v[208:209], v[208:209], v[32:33], v[68:69]
  v_pk_mul_f32 v[70:71], v[50:51], v[26:27] op_sel_hi:[1,0]
  v_pk_fma_f32 v[210:211], v[210:211], v[34:35], v[70:71]
  v_cvt_pk_bf16_f32 v88, v192, v193
  v_cvt_pk_bf16_f32 v90, v208, v209
  v_cvt_pk_bf16_f32 v89, v194, v195
  v_cvt_pk_bf16_f32 v91, v210, v211
  v_pk_mul_f32 v[64:65], v[52:53], v[24:25] op_sel_hi:[1,0]
  v_pk_fma_f32 v[196:197], v[196:197], v[36:37], v[64:65]
  v_pk_mul_f32 v[66:67], v[54:55], v[24:25] op_sel_hi:[1,0]
  v_pk_fma_f32 v[198:199], v[198:199], v[38:39], v[66:67]
  v_pk_mul_f32 v[68:69], v[52:53], v[26:27] op_sel_hi:[1,0]
  v_pk_fma_f32 v[212:213], v[212:213], v[36:37], v[68:69]
  v_pk_mul_f32 v[70:71], v[54:55], v[26:27] op_sel_hi:[1,0]
  v_pk_fma_f32 v[214:215], v[214:215], v[38:39], v[70:71]
  v_cvt_pk_bf16_f32 v92, v196, v197
  v_cvt_pk_bf16_f32 v94, v212, v213
  v_cvt_pk_bf16_f32 v93, v198, v199
  v_cvt_pk_bf16_f32 v95, v214, v215
  v_permlane16_swap_b32 v88, v90
  v_permlane16_swap_b32 v89, v91
  v_permlane16_swap_b32 v92, v94
  v_permlane16_swap_b32 v93, v95
  v_permlane32_swap_b32 v88, v90
  v_permlane32_swap_b32 v89, v91
  v_permlane32_swap_b32 v92, v94
  v_permlane32_swap_b32 v93, v95
  buffer_store_dwordx4 v[88:91], v3, s[4:7], s36 offen offset:2048 sc1
  buffer_store_dwordx4 v[92:95], v3, s[4:7], s36 offen offset:3072 sc1
  v_pk_mul_f32 v[64:65], v[56:57], v[24:25] op_sel_hi:[1,0]
  v_pk_fma_f32 v[200:201], v[200:201], v[40:41], v[64:65]
  v_pk_mul_f32 v[66:67], v[58:59], v[24:25] op_sel_hi:[1,0]
  v_pk_fma_f32 v[202:203], v[202:203], v[42:43], v[66:67]
  v_pk_mul_f32 v[68:69], v[56:57], v[26:27] op_sel_hi:[1,0]
  v_pk_fma_f32 v[216:217], v[216:217], v[40:41], v[68:69]
  v_pk_mul_f32 v[70:71], v[58:59], v[26:27] op_sel_hi:[1,0]
  v_pk_fma_f32 v[218:219], v[218:219], v[42:43], v[70:71]
  v_cvt_pk_bf16_f32 v104, v200, v201
  v_cvt_pk_bf16_f32 v106, v216, v217
  v_cvt_pk_bf16_f32 v105, v202, v203
  v_cvt_pk_bf16_f32 v107, v218, v219
  v_pk_mul_f32 v[64:65], v[60:61], v[24:25] op_sel_hi:[1,0]
  v_pk_fma_f32 v[204:205], v[204:205], v[44:45], v[64:65]
  v_pk_mul_f32 v[66:67], v[62:63], v[24:25] op_sel_hi:[1,0]
  v_pk_fma_f32 v[206:207], v[206:207], v[46:47], v[66:67]
  v_pk_mul_f32 v[68:69], v[60:61], v[26:27] op_sel_hi:[1,0]
  v_pk_fma_f32 v[220:221], v[220:221], v[44:45], v[68:69]
  v_pk_mul_f32 v[70:71], v[62:63], v[26:27] op_sel_hi:[1,0]
  v_pk_fma_f32 v[222:223], v[222:223], v[46:47], v[70:71]
  v_cvt_pk_bf16_f32 v108, v204, v205
  v_cvt_pk_bf16_f32 v110, v220, v221
  v_cvt_pk_bf16_f32 v109, v206, v207
  v_cvt_pk_bf16_f32 v111, v222, v223
  v_permlane16_swap_b32 v104, v106
  v_permlane16_swap_b32 v105, v107
  v_permlane16_swap_b32 v108, v110
  v_permlane16_swap_b32 v109, v111
  v_permlane32_swap_b32 v104, v106
  v_permlane32_swap_b32 v105, v107
  v_permlane32_swap_b32 v108, v110
  v_permlane32_swap_b32 v109, v111
  buffer_store_dwordx4 v[104:107], v3, s[4:7], s37 offen offset:2048 sc1
  buffer_store_dwordx4 v[108:111], v3, s[4:7], s37 offen offset:3072 sc1
  v_mul_f32 v224, 0.25503486164919736, v224
  v_mul_f32 v225, 0.25503486164919736, v225
  v_mul_f32 v226, 0.25503486164919736, v226
  v_mul_f32 v227, 0.25503486164919736, v227
  v_mul_f32 v228, 0.25503486164919736, v228
  v_mul_f32 v229, 0.25503486164919736, v229
  v_mul_f32 v230, 0.25503486164919736, v230
  v_mul_f32 v231, 0.25503486164919736, v231
  v_pk_mul_f32 v[64:65], v[112:113], v[224:225] op_sel:[0,1] op_sel_hi:[1,1]
  v_pk_fma_f32 v[128:129], v[128:129], v[224:225], v[64:65] op_sel_hi:[1,0,1]
  v_pk_mul_f32 v[66:67], v[114:115], v[224:225] op_sel:[0,1] op_sel_hi:[1,1]
  v_pk_fma_f32 v[130:131], v[130:131], v[224:225], v[66:67] op_sel_hi:[1,0,1]
  v_pk_mul_f32 v[68:69], v[116:117], v[224:225] op_sel:[0,1] op_sel_hi:[1,1]
  v_pk_fma_f32 v[144:145], v[144:145], v[224:225], v[68:69] op_sel_hi:[1,0,1]
  v_pk_mul_f32 v[70:71], v[118:119], v[224:225] op_sel:[0,1] op_sel_hi:[1,1]
  v_pk_fma_f32 v[146:147], v[146:147], v[224:225], v[70:71] op_sel_hi:[1,0,1]
  v_cvt_pk_bf16_f32 v16, v128, v129
  v_cvt_pk_bf16_f32 v17, v130, v131
  v_cvt_pk_bf16_f32 v18, v144, v145
  v_cvt_pk_bf16_f32 v19, v146, v147
  v_pk_mul_f32 v[64:65], v[112:113], v[226:227] op_sel:[0,1] op_sel_hi:[1,1]
  v_pk_fma_f32 v[132:133], v[132:133], v[226:227], v[64:65] op_sel_hi:[1,0,1]
  v_pk_mul_f32 v[66:67], v[114:115], v[226:227] op_sel:[0,1] op_sel_hi:[1,1]
  v_pk_fma_f32 v[134:135], v[134:135], v[226:227], v[66:67] op_sel_hi:[1,0,1]
  v_pk_mul_f32 v[68:69], v[116:117], v[226:227] op_sel:[0,1] op_sel_hi:[1,1]
  v_pk_fma_f32 v[148:149], v[148:149], v[226:227], v[68:69] op_sel_hi:[1,0,1]
  v_pk_mul_f32 v[70:71], v[118:119], v[226:227] op_sel:[0,1] op_sel_hi:[1,1]
  v_pk_fma_f32 v[150:151], v[150:151], v[226:227], v[70:71] op_sel_hi:[1,0,1]
  v_cvt_pk_bf16_f32 v20, v132, v133
  v_cvt_pk_bf16_f32 v21, v134, v135
  v_cvt_pk_bf16_f32 v22, v148, v149
  v_cvt_pk_bf16_f32 v23, v150, v151
  v_permlane16_swap_b32 v16, v20
  v_permlane16_swap_b32 v17, v21
  v_permlane16_swap_b32 v18, v22
  v_permlane16_swap_b32 v19, v23
  ds_write_b128 v8, v[16:19] offset:0
  ds_write_b128 v8, v[20:23] offset:1024
  v_pk_mul_f32 v[64:65], v[112:113], v[228:229] op_sel:[0,1] op_sel_hi:[1,1]
  v_pk_fma_f32 v[136:137], v[136:137], v[228:229], v[64:65] op_sel_hi:[1,0,1]
  v_pk_mul_f32 v[66:67], v[114:115], v[228:229] op_sel:[0,1] op_sel_hi:[1,1]
  v_pk_fma_f32 v[138:139], v[138:139], v[228:229], v[66:67] op_sel_hi:[1,0,1]
  v_pk_mul_f32 v[68:69], v[116:117], v[228:229] op_sel:[0,1] op_sel_hi:[1,1]
  v_pk_fma_f32 v[152:153], v[152:153], v[228:229], v[68:69] op_sel_hi:[1,0,1]
  v_pk_mul_f32 v[70:71], v[118:119], v[228:229] op_sel:[0,1] op_sel_hi:[1,1]
  v_pk_fma_f32 v[154:155], v[154:155], v[228:229], v[70:71] op_sel_hi:[1,0,1]
  v_cvt_pk_bf16_f32 v24, v136, v137
  v_cvt_pk_bf16_f32 v25, v138, v139
  v_cvt_pk_bf16_f32 v26, v152, v153
  v_cvt_pk_bf16_f32 v27, v154, v155
  v_pk_mul_f32 v[64:65], v[112:113], v[230:231] op_sel:[0,1] op_sel_hi:[1,1]
  v_pk_fma_f32 v[140:141], v[140:141], v[230:231], v[64:65] op_sel_hi:[1,0,1]
  v_pk_mul_f32 v[66:67], v[114:115], v[230:231] op_sel:[0,1] op_sel_hi:[1,1]
  v_pk_fma_f32 v[142:143], v[142:143], v[230:231], v[66:67] op_sel_hi:[1,0,1]
  v_pk_mul_f32 v[68:69], v[116:117], v[230:231] op_sel:[0,1] op_sel_hi:[1,1]
  v_pk_fma_f32 v[156:157], v[156:157], v[230:231], v[68:69] op_sel_hi:[1,0,1]
  v_pk_mul_f32 v[70:71], v[118:119], v[230:231] op_sel:[0,1] op_sel_hi:[1,1]
  v_pk_fma_f32 v[158:159], v[158:159], v[230:231], v[70:71] op_sel_hi:[1,0,1]
  v_cvt_pk_bf16_f32 v28, v140, v141
  v_cvt_pk_bf16_f32 v29, v142, v143
  v_cvt_pk_bf16_f32 v30, v156, v157
  v_cvt_pk_bf16_f32 v31, v158, v159
  v_permlane16_swap_b32 v24, v28
  v_permlane16_swap_b32 v25, v29
  v_permlane16_swap_b32 v26, v30
  v_permlane16_swap_b32 v27, v31
  ds_write_b128 v8, v[24:27] offset:2048
  ds_write_b128 v8, v[28:31] offset:3072
  s_branch .fz_kernel_att
.fz_kernel_q_help1:
  s_mov_b32 s3, 32
  s_cmp_eq_u32 s16, 7
  s_cbranch_scc1 .fz_kernel_q_h7
  s_getpc_b64 s[0:1]
.fz_kernel_ct4:
  s_sub_u32 s0, s0, .fz_kernel_ct4-fz_kernel
  s_subb_u32 s1, s1, 0
  s_lshr_b32 s31, s2, 3
  s_mulk_i32 s31, 0x500
  v_lshl_add_u32 v1, v2, 7, s31
  v_min_u32 v1, .fz_kernel_last-fz_kernel, v1
  s_mov_b64 exec, 0x3ff
  global_load_dword v1, v1, s[0:1]
  s_mov_b64 exec, -1
.fz_kernel_ct4e:
  s_mov_b32 s12, s58
  s_mov_b32 s13, s59
  s_mov_b32 s14, 0x100
  s_mov_b32 s15, 0x00020000
  s_mov_b32 s30, 0
  s_and_b32 s31, s18, 3
  s_sub_u32 s31, s31, s30
  s_and_b32 s30, s31, 3
  s_lshl_b32 s30, s30, 14
  v_and_b32 v20, 15, v2
  v_lshrrev_b32 v21, 4, v2
  v_bfe_u32 v22, v2, 1, 3
  v_xor_b32 v22, v22, v21
  v_lshlrev_b32 v21, 7, v20
  v_lshl_add_u32 v21, v22, 4, v21
  v_add_u32 v21, s30, v21
  v_xor_b32 v22, 64, v21
  v_lshlrev_b32 v20, 3, v20
  s_lshl_b32 s30, s17, 10
  s_add_u32 s30, s30, 0x1808000
  s_mov_b32 exec_lo, 0x00f0000f
  s_mov_b32 exec_hi, 0xf0000f00
  v_add_u32 v20, 4, v20
  s_mov_b64 exec, -1
  v_mov_b32 v24, 0x3f803f80
  v_mov_b32 v25, v24
  v_mov_b32 v26, v24
  v_mov_b32 v27, v24
  s_lshl_b32 s31, s31, 1
  s_sub_u32 s31, 31, s31
  s_mov_b32 s20, s48
  s_mov_b32 s21, s49
  s_mov_b32 s22, 0x800
  s_mov_b32 s23, 0x00020000
  v_lshlrev_b32 v40, 5, v2
  buffer_load_dwordx4 v[44:47], v40, s[20:23], 0 offen
  buffer_load_dwordx4 v[48:51], v40, s[20:23], 0 offen offset:16
  v_mov_b32 v40, 0
  s_waitcnt vmcnt(0)
  v_lshlrev_b32 v41, 16, v44
  v_and_b32 v42, 0xffff0000, v44
  v_add_f32 v40, v40, v41
  v_add_f32 v40, v40, v42
  v_lshlrev_b32 v41, 16, v45
  v_and_b32 v42, 0xffff0000, v45
  v_add_f32 v40, v40, v41
  v_add_f32 v40, v40, v42
  v_lshlrev_b32 v41, 16, v46
  v_and_b32 v42, 0xffff0000, v46
  v_add_f32 v40, v40, v41
  v_add_f32 v40, v40, v42
  v_lshlrev_b32 v41, 16, v47
  v_and_b32 v42, 0xffff0000, v47
  v_add_f32 v40, v40, v41
  v_add_f32 v40, v40, v42
  v_lshlrev_b32 v41, 16, v48
  v_and_b32 v42, 0xffff0000, v48
  v_add_f32 v40, v40, v41
  v_add_f32 v40, v40, v42
  v_lshlrev_b32 v41, 16, v49
  v_and_b32 v42, 0xffff0000, v49
  v_add_f32 v40, v40, v41
  v_add_f32 v40, v40, v42
  v_lshlrev_b32 v41, 16, v50
  v_and_b32 v42, 0xffff0000, v50
  v_add_f32 v40, v40, v41
  v_add_f32 v40, v40, v42
  v_lshlrev_b32 v41, 16, v51
  v_and_b32 v42, 0xffff0000, v51
  v_add_f32 v40, v40, v41
  v_add_f32 v40, v40, v42
  s_nop 1
  v_add_f32 v40, v40, v40 quad_perm:[1,0,3,2] row_mask:0xf bank_mask:0xf
  s_nop 1
  v_add_f32 v40, v40, v40 quad_perm:[2,3,0,1] row_mask:0xf bank_mask:0xf
  s_nop 1
  v_add_f32 v40, v40, v40 row_half_mirror row_mask:0xf bank_mask:0xf
  s_nop 1
  v_add_f32 v40, v40, v40 row_mirror row_mask:0xf bank_mask:0xf
  s_nop 0
  v_readlane_b32 s20, v40, 16
  v_readlane_b32 s21, v40, 32
  v_readlane_b32 s22, v40, 48
  v_add_f32 v40, s20, v40
  v_add_f32 v40, s21, v40
  v_add_f32 v40, s22, v40
  v_mul_f32 v40, 0x3a800000, v40
  s_nop 0
  v_readfirstlane_b32 s76, v40
.fz_kernel_xs5:
  s_barrier
  s_sub_u32 s3, s3, 1
  s_cmp_lg_u32 s3, s31
  s_cbranch_scc1 .fz_kernel_xs5
  ds_read_b128 v[64:67], v21 offset:0
  ds_read_b128 v[72:75], v21 offset:2048
  ds_read_b128 v[80:83], v21 offset:4096
  ds_read_b128 v[88:91], v21 offset:6144
  ds_read_b128 v[96:99], v21 offset:8192
  ds_read_b128 v[104:107], v21 offset:10240
  ds_read_b128 v[112:115], v21 offset:12288
  ds_read_b128 v[120:123], v21 offset:14336
  ds_read_b128 v[68:71], v22 offset:0
  ds_read_b128 v[76:79], v22 offset:2048
  ds_read_b128 v[84:87], v22 offset:4096
  ds_read_b128 v[92:95], v22 offset:6144
  ds_read_b128 v[100:103], v22 offset:8192
  ds_read_b128 v[108:111], v22 offset:10240
  ds_read_b128 v[116:119], v22 offset:12288
  ds_read_b128 v[124:127], v22 offset:14336
  s_waitcnt lgkmcnt(0)
  s_cmp_eq_u32 s3, 0
  s_cbranch_scc1 .fz_kernel_hb6
  s_barrier
  s_sub_u32 s3, s3, 1
.fz_kernel_hb6:
  s_setprio 2
  v_mfma_f32_16x16x32_bf16 v[128:131], v[24:27], v[64:67], 0
  v_mfma_f32_16x16x32_bf16 v[160:163], v[64:67], v[64:67], 0
  v_mfma_f32_16x16x32_bf16 v[132:135], v[24:27], v[72:75], 0
  v_mfma_f32_16x16x32_bf16 v[164:167], v[72:75], v[72:75], 0
  v_mfma_f32_16x16x32_bf16 v[136:139], v[24:27], v[80:83], 0
  v_mfma_f32_16x16x32_bf16 v[168:171], v[80:83], v[80:83], 0
  v_mfma_f32_16x16x32_bf16 v[140:143], v[24:27], v[88:91], 0
  v_mfma_f32_16x16x32_bf16 v[172:175], v[88:91], v[88:91], 0
  v_mfma_f32_16x16x32_bf16 v[144:147], v[24:27], v[96:99], 0
  v_mfma_f32_16x16x32_bf16 v[176:179], v[96:99], v[96:99], 0
  v_mfma_f32_16x16x32_bf16 v[148:151], v[24:27], v[104:107], 0
  v_mfma_f32_16x16x32_bf16 v[180:183], v[104:107], v[104:107], 0
  v_mfma_f32_16x16x32_bf16 v[152:155], v[24:27], v[112:115], 0
  v_mfma_f32_16x16x32_bf16 v[184:187], v[112:115], v[112:115], 0
  v_mfma_f32_16x16x32_bf16 v[156:159], v[24:27], v[120:123], 0
  v_mfma_f32_16x16x32_bf16 v[188:191], v[120:123], v[120:123], 0
  v_mfma_f32_16x16x32_bf16 v[128:131], v[24:27], v[68:71], v[128:131]
  v_mfma_f32_16x16x32_bf16 v[160:163], v[68:71], v[68:71], v[160:163]
  v_mfma_f32_16x16x32_bf16 v[132:135], v[24:27], v[76:79], v[132:135]
  v_mfma_f32_16x16x32_bf16 v[164:167], v[76:79], v[76:79], v[164:167]
  v_mfma_f32_16x16x32_bf16 v[136:139], v[24:27], v[84:87], v[136:139]
  v_mfma_f32_16x16x32_bf16 v[168:171], v[84:87], v[84:87], v[168:171]
  v_mfma_f32_16x16x32_bf16 v[140:143], v[24:27], v[92:95], v[140:143]
  v_mfma_f32_16x16x32_bf16 v[172:175], v[92:95], v[92:95], v[172:175]
  v_mfma_f32_16x16x32_bf16 v[144:147], v[24:27], v[100:103], v[144:147]
  v_mfma_f32_16x16x32_bf16 v[176:179], v[100:103], v[100:103], v[176:179]
  v_mfma_f32_16x16x32_bf16 v[148:151], v[24:27], v[108:111], v[148:151]
  v_mfma_f32_16x16x32_bf16 v[180:183], v[108:111], v[108:111], v[180:183]
  v_mfma_f32_16x16x32_bf16 v[152:155], v[24:27], v[116:119], v[152:155]
  v_mfma_f32_16x16x32_bf16 v[184:187], v[116:119], v[116:119], v[184:187]
  v_mfma_f32_16x16x32_bf16 v[156:159], v[24:27], v[124:127], v[156:159]
  v_mfma_f32_16x16x32_bf16 v[188:191], v[124:127], v[124:127], v[188:191]
  s_setprio 0
  s_cmp_eq_u32 s3, 0
  s_cbranch_scc1 .fz_kernel_hb7
  s_barrier
  s_sub_u32 s3, s3, 1
.fz_kernel_hb7:
  s_mov_b32 exec_lo, 0x100001
  s_mov_b32 exec_hi, 0x10000100
  buffer_load_dword v9, v4, s[12:15], 0 offen sc1
  v_mov_b32 v128, v160
  v_mov_b32 v132, v164
  v_mov_b32 v136, v168
  v_mov_b32 v140, v172
  v_mov_b32 v144, v176
  v_mov_b32 v148, v180
  v_mov_b32 v152, v184
  v_mov_b32 v156, v188
  s_mov_b32 exec_lo, 0x200002
  s_mov_b32 exec_hi, 0x20000200
  v_mov_b32 v128, v161
  v_mov_b32 v132, v165
  v_mov_b32 v136, v169
  v_mov_b32 v140, v173
  v_mov_b32 v144, v177
  v_mov_b32 v148, v181
  v_mov_b32 v152, v185
  v_mov_b32 v156, v189
  s_mov_b32 exec_lo, 0x400004
  s_mov_b32 exec_hi, 0x40000400
  v_mov_b32 v128, v162
  v_mov_b32 v132, v166
  v_mov_b32 v136, v170
  v_mov_b32 v140, v174
  v_mov_b32 v144, v178
  v_mov_b32 v148, v182
  v_mov_b32 v152, v186
  v_mov_b32 v156, v190
  s_mov_b32 exec_lo, 0x800008
  s_mov_b32 exec_hi, 0x80000800
  v_mov_b32 v128, v163
  v_mov_b32 v132, v167
  v_mov_b32 v136, v171
  v_mov_b32 v140, v175
  v_mov_b32 v144, v179
  v_mov_b32 v148, v183
  v_mov_b32 v152, v187
  v_mov_b32 v156, v191
  s_mov_b64 exec, 1
  s_mov_b32 s38, 0
.fz_kernel_pw8:
  s_mov_b32 s46, 0
  s_call_b64 s[0:1], .fz_kernel_hw
  s_waitcnt vmcnt(0)
  v_readfirstlane_b32 s31, v9
  s_cmp_eq_u32 s31, 64
  s_cbranch_scc1 .fz_kernel_pw8d
  s_cmp_eq_u32 s3, 0
  s_cbranch_scc1 .fz_kernel_hb9
  s_barrier
  s_sub_u32 s3, s3, 1
.fz_kernel_hb9:
  s_cmp_eq_u32 s3, 0
  s_cbranch_scc1 .fz_kernel_hb10
  s_barrier
  s_sub_u32 s3, s3, 1
.fz_kernel_hb10:
  buffer_load_dword v9, v4, s[12:15], 0 offen sc1
  s_add_u32 s38, s38, 1
  s_cmp_lt_u32 s38, 131072
  s_cbranch_scc1 .fz_kernel_pw8
  s_waitcnt vmcnt(0)
.fz_kernel_pw8d:
  s_mov_b64 exec, -1
  s_mov_b32 exec_lo, 0x00fff00f
  s_mov_b32 exec_hi, 0xff000ff0
  buffer_atomic_add_f32 v128, v20, s[4:7], s30 offen offset:0 sc1
  buffer_atomic_add_f32 v132, v20, s[4:7], s30 offen offset:128 sc1
  buffer_atomic_add_f32 v136, v20, s[4:7], s30 offen offset:256 sc1
  buffer_atomic_add_f32 v140, v20, s[4:7], s30 offen offset:384 sc1
  buffer_atomic_add_f32 v144, v20, s[4:7], s30 offen offset:512 sc1
  buffer_atomic_add_f32 v148, v20, s[4:7], s30 offen offset:640 sc1
  buffer_atomic_add_f32 v152, v20, s[4:7], s30 offen offset:768 sc1
  buffer_atomic_add_f32 v156, v20, s[4:7], s30 offen offset:896 sc1
  s_mov_b64 exec, -1
  s_mov_b32 s46, 0
  s_call_b64 s[0:1], .fz_kernel_hw
  s_waitcnt vmcnt(0)
  v_lshlrev_b32 v7, 11, v2
  s_lshl_b32 s31, s17, 7
  s_lshl_b32 s33, 1, s18
  s_add_u32 s31, s31, s67
  s_add_u32 s31, s31, 0x1800018
  v_mov_b32 v8, s33
  s_mov_b64 exec, 0xffff
  buffer_atomic_or v8, v7, s[4:7], s31 offen sc1
  s_mov_b64 exec, -1
  s_add_u32 s37, s19, 24
.fz_kernel_f111:
  s_cmp_le_u32 s3, 8
  s_cbranch_scc1 .fz_kernel_f111d
  s_barrier
  s_sub_u32 s3, s3, 1
  s_branch .fz_kernel_f111
.fz_kernel_f111d:
  s_mov_b64 exec, 1
  buffer_load_dword v9, v4, s[4:7], s37 offen sc1
  s_mov_b64 exec, 1
  s_mov_b32 s38, 0
.fz_kernel_pw12:
  s_mov_b32 s46, 0
  s_call_b64 s[0:1], .fz_kernel_hw
  s_waitcnt vmcnt(0)
  v_readfirstlane_b32 s31, v9
  s_cmp_eq_u32 s31, 65535
  s_cbranch_scc1 .fz_kernel_pw12d
  s_cmp_eq_u32 s3, 0
  s_cbranch_scc1 .fz_kernel_hb13
  s_barrier
  s_sub_u32 s3, s3, 1
.fz_kernel_hb13:
  s_cmp_eq_u32 s3, 0
  s_cbranch_scc1 .fz_kernel_hb14
  s_barrier
  s_sub_u32 s3, s3, 1
.fz_kernel_hb14:
  buffer_load_dword v9, v4, s[4:7], s37 offen sc1
  s_add_u32 s38, s38, 1
  s_cmp_lt_u32 s38, 131072
  s_cbranch_scc1 .fz_kernel_pw12
  s_waitcnt vmcnt(0)
.fz_kernel_pw12d:
  s_mov_b64 exec, -1
  buffer_load_dwordx4 v[64:67], v3, s[4:7], s30 offen sc1
  s_mov_b32 s46, 0
  s_call_b64 s[0:1], .fz_kernel_hw
  s_waitcnt vmcnt(0)
  v_mov_b32 v26, 0.0009765625
  v_mul_f32 v20, v26, v64
  v_mul_f32 v27, v20, v20
  v_fma_f32 v22, v65, v26, -v27
  v_max_f32 v22, 0, v22
  v_add_f32 v22, 1e-05, v22
  v_rsq_f32 v22, v22
  s_nop 0
  v_mul_f32 v20, v20, v22
  v_sub_f32 v20, 0, v20
  v_mul_f32 v21, v26, v66
  v_mul_f32 v27, v21, v21
  v_fma_f32 v23, v67, v26, -v27
  v_max_f32 v23, 0, v23
  v_add_f32 v23, 1e-05, v23
  v_rsq_f32 v23, v23
  s_nop 0
  v_mul_f32 v21, v21, v23
  v_sub_f32 v21, 0, v21
  v_lshlrev_b32 v24, 3, v2
  v_add_u32 v24, 155648, v24
  ds_write_b64 v24, v[22:23] offset:4608
  ds_write_b64 v24, v[20:21] offset:5120
  v_mov_b32 v20, 1.0
  v_mov_b32 v21, 1.0
  v_mov_b32 v22, 0
  v_mov_b32 v23, 0
  ds_write_b64 v24, v[20:21] offset:6400
  ds_write_b64 v24, v[22:23] offset:6912
  v_mov_b32 v24, 159952
  v_mov_b32 v25, s76
  ds_write_b32 v24, v25 offset:8
  s_waitcnt lgkmcnt(0)
.fz_kernel_q_hw2:
  s_add_u32 s3, s3, 2
.fz_kernel_q_he:
  s_cmp_eq_u32 s3, 0
  s_cbranch_scc1 .fz_kernel_chain
  s_barrier
  s_sub_u32 s3, s3, 1
  s_branch .fz_kernel_q_he
.fz_kernel_q_h7:
  s_mov_b32 s8, s58
  s_mov_b32 s9, s59
  s_mov_b32 s10, 0x100
  s_mov_b32 s11, 0x00020000
  v_mov_b32 v12, 0
  v_mov_b32 v13, 0
  v_mov_b32 v14, 0
  v_mov_b32 v15, 0
  s_cmp_ge_u32 s2, 64
  s_cbranch_scc1 .fz_kernel_q_nzero
  s_lshl_b32 s36, s2, 10
  s_add_u32 s36, s36, 0x1800000
  buffer_store_dwordx4 v[12:15], v3, s[4:7], s36 offen sc1
.fz_kernel_q_nzero:
  v_and_b32 v21, 7, v2
  v_and_b32 v20, 16, v2
  v_lshlrev_b32 v20, 1, v20
  v_xor_b32 v20, v20, v3
  s_bfe_u32 s33, s17, 0x10002
  s_lshl_b32 s33, s33, 1
  s_and_b32 s31, s33, 3
  s_mul_i32 s31, s31, 12288
  s_add_u32 s31, s31, 65536
  v_add_u32 v16, s31, v20
  v_xor_b32 v17, 64, v16
  s_add_u32 s31, s31, 12288
  v_add_u32 v18, s31, v20
  v_xor_b32 v19, 64, v18
  s_sub_u32 s33, 31, s33
  v_lshlrev_b32 v21, 5, v21
  v_and_b32 v22, 24, v2
  v_add_u32 v21, v22, v21
  v_lshrrev_b32 v22, 5, v2
  v_lshl_add_u32 v21, v22, 2, v21
  s_lshl_b32 s30, s18, 10
  s_add_u32 s30, s30, 0x180c000
  v_and_b32 v22, 1, v2
  v_lshlrev_b32 v22, 4, v22
  v_mov_b32 v23, 0x3f80
  v_lshlrev_b32 v22, v22, v23
  v_mov_b32 v24, 0
  v_mov_b32 v25, 0
  v_mov_b32 v26, 0
  v_mov_b32 v27, 0
  s_mov_b32 exec_lo, 0x3030303
  s_mov_b32 exec_hi, 0x3030303
  v_mov_b32 v24, v22
  s_mov_b32 exec_lo, 0xc0c0c0c
  s_mov_b32 exec_hi, 0xc0c0c0c
  v_mov_b32 v25, v22
  s_mov_b32 exec_lo, 0x30303030
  s_mov_b32 exec_hi, 0x30303030
  v_mov_b32 v26, v22
  s_mov_b32 exec_lo, 0xc0c0c0c0
  s_mov_b32 exec_hi, 0xc0c0c0c0
  v_mov_b32 v27, v22
  s_mov_b64 exec, -1
  s_cmp_ge_u32 s2, 64
  s_cbranch_scc1 .fz_kernel_nz2
  s_mov_b64 exec, 1
  s_waitcnt vmcnt(0)
  buffer_atomic_add v5, v4, s[8:11], 0 offen sc1
  s_mov_b64 exec, -1
.fz_kernel_nz2:
  s_barrier
  s_sub_u32 s3, s3, 1
  s_cmp_lg_u32 s3, s33
  s_cbranch_scc1 .fz_kernel_nz2
  ds_read_b128 v[64:67], v16 offset:0
  ds_read_b128 v[68:71], v16 offset:4096
  ds_read_b128 v[72:75], v16 offset:8192
  ds_read_b128 v[76:79], v17 offset:1024
  ds_read_b128 v[80:83], v17 offset:5120
  ds_read_b128 v[84:87], v17 offset:9216
  ds_read_b128 v[88:91], v16 offset:2048
  ds_read_b128 v[92:95], v16 offset:6144
  ds_read_b128 v[96:99], v16 offset:10240
  ds_read_b128 v[100:103], v17 offset:3072
  ds_read_b128 v[104:107], v17 offset:7168
  ds_read_b128 v[108:111], v17 offset:11264
  s_waitcnt lgkmcnt(0)
  s_cmp_eq_u32 s3, 0
  s_cbranch_scc1 .fz_kernel_hb15
  s_barrier
  s_sub_u32 s3, s3, 1
.fz_kernel_hb15:
  ds_read_b128 v[112:115], v18 offset:0
  ds_read_b128 v[116:119], v18 offset:4096
  ds_read_b128 v[120:123], v18 offset:8192
  ds_read_b128 v[124:127], v19 offset:1024
  ds_read_b128 v[128:131], v19 offset:5120
  ds_read_b128 v[132:135], v19 offset:9216
  ds_read_b128 v[136:139], v18 offset:2048
  ds_read_b128 v[140:143], v18 offset:6144
  ds_read_b128 v[144:147], v18 offset:10240
  ds_read_b128 v[148:151], v19 offset:3072
  ds_read_b128 v[152:155], v19 offset:7168
  ds_read_b128 v[156:159], v19 offset:11264
  s_waitcnt lgkmcnt(0)
  s_cmp_eq_u32 s3, 0
  s_cbranch_scc1 .fz_kernel_hb16
  s_barrier
  s_sub_u32 s3, s3, 1
.fz_kernel_hb16:
  s_setprio 2
  v_mfma_f32_16x16x32_bf16 v[160:163], v[24:27], v[64:67], 0
  v_mfma_f32_16x16x32_bf16 v[164:167], v[24:27], v[68:71], 0
  v_mfma_f32_16x16x32_bf16 v[168:171], v[24:27], v[72:75], 0
  v_mfma_f32_16x16x32_bf16 v[160:163], v[24:27], v[76:79], v[160:163]
  v_mfma_f32_16x16x32_bf16 v[164:167], v[24:27], v[80:83], v[164:167]
  v_mfma_f32_16x16x32_bf16 v[168:171], v[24:27], v[84:87], v[168:171]
  v_mfma_f32_16x16x32_bf16 v[160:163], v[24:27], v[88:91], v[160:163]
  v_mfma_f32_16x16x32_bf16 v[164:167], v[24:27], v[92:95], v[164:167]
  v_mfma_f32_16x16x32_bf16 v[168:171], v[24:27], v[96:99], v[168:171]
  v_mfma_f32_16x16x32_bf16 v[160:163], v[24:27], v[100:103], v[160:163]
  v_mfma_f32_16x16x32_bf16 v[164:167], v[24:27], v[104:107], v[164:167]
  v_mfma_f32_16x16x32_bf16 v[168:171], v[24:27], v[108:111], v[168:171]
  v_mfma_f32_16x16x32_bf16 v[160:163], v[24:27], v[112:115], v[160:163]
  v_mfma_f32_16x16x32_bf16 v[164:167], v[24:27], v[116:119], v[164:167]
  v_mfma_f32_16x16x32_bf16 v[168:171], v[24:27], v[120:123], v[168:171]
  v_mfma_f32_16x16x32_bf16 v[160:163], v[24:27], v[124:127], v[160:163]
  v_mfma_f32_16x16x32_bf16 v[164:167], v[24:27], v[128:131], v[164:167]
  v_mfma_f32_16x16x32_bf16 v[168:171], v[24:27], v[132:135], v[168:171]
  v_mfma_f32_16x16x32_bf16 v[160:163], v[24:27], v[136:139], v[160:163]
  v_mfma_f32_16x16x32_bf16 v[164:167], v[24:27], v[140:143], v[164:167]
  v_mfma_f32_16x16x32_bf16 v[168:171], v[24:27], v[144:147], v[168:171]
  v_mfma_f32_16x16x32_bf16 v[160:163], v[24:27], v[148:151], v[160:163]
  v_mfma_f32_16x16x32_bf16 v[164:167], v[24:27], v[152:155], v[164:167]
  v_mfma_f32_16x16x32_bf16 v[168:171], v[24:27], v[156:159], v[168:171]
  s_setprio 0
  s_mov_b64 exec, 1
  buffer_load_dword v9, v4, s[8:11], 0 offen sc1
  s_mov_b64 exec, -1
  s_nop 1
  v_add_f32 v160, v160, v160 row_ror:8 row_mask:0xf bank_mask:0xf
  v_add_f32 v161, v161, v161 row_ror:8 row_mask:0xf bank_mask:0xf
  v_add_f32 v162, v162, v162 row_ror:8 row_mask:0xf bank_mask:0xf
  v_add_f32 v163, v163, v163 row_ror:8 row_mask:0xf bank_mask:0xf
  v_add_f32 v164, v164, v164 row_ror:8 row_mask:0xf bank_mask:0xf
  v_add_f32 v165, v165, v165 row_ror:8 row_mask:0xf bank_mask:0xf
  v_add_f32 v166, v166, v166 row_ror:8 row_mask:0xf bank_mask:0xf
  v_add_f32 v167, v167, v167 row_ror:8 row_mask:0xf bank_mask:0xf
  v_add_f32 v168, v168, v168 row_ror:8 row_mask:0xf bank_mask:0xf
  v_add_f32 v169, v169, v169 row_ror:8 row_mask:0xf bank_mask:0xf
  v_add_f32 v170, v170, v170 row_ror:8 row_mask:0xf bank_mask:0xf
  v_add_f32 v171, v171, v171 row_ror:8 row_mask:0xf bank_mask:0xf
  s_mov_b32 exec_lo, 0x0
  s_mov_b32 exec_hi, 0xff00ff
  v_mov_b32 v160, v161
  v_mov_b32 v164, v165
  v_mov_b32 v168, v169
  s_mov_b32 exec_lo, 0xff00ff00
  s_mov_b32 exec_hi, 0x0
  v_mov_b32 v160, v162
  v_mov_b32 v164, v166
  v_mov_b32 v168, v170
  s_mov_b32 exec_lo, 0x0
  s_mov_b32 exec_hi, 0xff00ff00
  v_mov_b32 v160, v163
  v_mov_b32 v164, v167
  v_mov_b32 v168, v171
  s_mov_b64 exec, 1
  s_mov_b32 s38, 0
.fz_kernel_pw17:
  s_mov_b32 s46, 0
  s_call_b64 s[0:1], .fz_kernel_hw
  s_waitcnt vmcnt(0)
  v_readfirstlane_b32 s31, v9
  s_cmp_eq_u32 s31, 64
  s_cbranch_scc1 .fz_kernel_pw17d
  s_cmp_eq_u32 s3, 0
  s_cbranch_scc1 .fz_kernel_hb18
  s_barrier
  s_sub_u32 s3, s3, 1
.fz_kernel_hb18:
  s_cmp_eq_u32 s3, 0
  s_cbranch_scc1 .fz_kernel_hb19
  s_barrier
  s_sub_u32 s3, s3, 1
.fz_kernel_hb19:
  buffer_load_dword v9, v4, s[8:11], 0 offen sc1
  s_add_u32 s38, s38, 1
  s_cmp_lt_u32 s38, 131072
  s_cbranch_scc1 .fz_kernel_pw17
  s_waitcnt vmcnt(0)
.fz_kernel_pw17d:
  s_mov_b64 exec, -1
  buffer_atomic_add_f32 v160, v21, s[4:7], s30 offen offset:0 sc1
  buffer_atomic_add_f32 v164, v21, s[4:7], s30 offen offset:256 sc1
  buffer_atomic_add_f32 v168, v21, s[4:7], s30 offen offset:512 sc1
  s_mov_b32 s46, 0
  s_call_b64 s[0:1], .fz_kernel_hw
  s_waitcnt vmcnt(0)
  v_lshlrev_b32 v7, 7, v2
  s_lshl_b32 s31, s18, 11
  s_lshl_b32 s33, 1, s17
  s_add_u32 s31, s31, s67
  s_add_u32 s31, s31, 0x180001c
  v_mov_b32 v8, s33
  s_mov_b64 exec, 0xffff
  buffer_atomic_or v8, v7, s[4:7], s31 offen sc1
  s_mov_b64 exec, -1
  s_cmp_ge_u32 s2, 196
  s_cbranch_scc1 .fz_kernel_lz20
  s_lshl_b32 s36, s2, 12
  s_add_u32 s36, s36, 0x1c00000
  s_sub_u32 s31, s2, 66
  s_min_u32 s31, s31, s2
  s_sub_u32 s31, s31, 4
  s_cmp_lt_u32 s31, 6
  s_cbranch_scc1 .fz_kernel_lz20a
  buffer_store_dwordx4 v[12:15], v3, s[4:7], s36 offen sc1
  buffer_store_dwordx4 v[12:15], v3, s[4:7], s36 offen offset:1024 sc1
  buffer_store_dwordx4 v[12:15], v3, s[4:7], s36 offen offset:2048 sc1
  buffer_store_dwordx4 v[12:15], v3, s[4:7], s36 offen offset:3072 sc1
.fz_kernel_lz20:
  s_add_u32 s37, s19, 28
.fz_kernel_f121:
  s_cmp_le_u32 s3, 8
  s_cbranch_scc1 .fz_kernel_f121d
  s_barrier
  s_sub_u32 s3, s3, 1
  s_branch .fz_kernel_f121
.fz_kernel_f121d:
  s_mov_b64 exec, 1
  buffer_load_dword v9, v4, s[4:7], s37 offen sc1
  s_mov_b64 exec, 1
  s_mov_b32 s38, 0
.fz_kernel_pw22:
  s_mov_b32 s46, 0
  s_call_b64 s[0:1], .fz_kernel_hw
  s_waitcnt vmcnt(0)
  v_readfirstlane_b32 s31, v9
  s_cmp_eq_u32 s31, 65535
  s_cbranch_scc1 .fz_kernel_pw22d
  s_cmp_eq_u32 s3, 0
  s_cbranch_scc1 .fz_kernel_hb23
  s_barrier
  s_sub_u32 s3, s3, 1
.fz_kernel_hb23:
  s_cmp_eq_u32 s3, 0
  s_cbranch_scc1 .fz_kernel_hb24
  s_barrier
  s_sub_u32 s3, s3, 1
.fz_kernel_hb24:
  buffer_load_dword v9, v4, s[4:7], s37 offen sc1
  s_add_u32 s38, s38, 1
  s_cmp_lt_u32 s38, 131072
  s_cbranch_scc1 .fz_kernel_pw22
  s_waitcnt vmcnt(0)
.fz_kernel_pw22d:
  s_mov_b64 exec, -1
  buffer_load_dwordx4 v[64:67], v3, s[4:7], s30 offen sc1
  s_mov_b32 s46, 0
  s_call_b64 s[0:1], .fz_kernel_hw
  s_waitcnt vmcnt(0)
  v_add_u32 v24, 155648, v3
  s_mov_b32 exec_hi, 0xffff
  ds_write_b128 v24, v[64:67] offset:5632
  s_mov_b64 exec, -1
  s_waitcnt lgkmcnt(0)
  s_getpc_b64 s[0:1]
.fz_kernel_ct25:
  s_sub_u32 s0, s0, .fz_kernel_ct25-fz_kernel
  s_subb_u32 s1, s1, 0
  s_lshr_b32 s31, s2, 3
  s_mulk_i32 s31, 0x500
  v_lshl_add_u32 v1, v2, 7, s31
  v_min_u32 v1, .fz_kernel_last-fz_kernel, v1
  s_mov_b64 exec, 0x3ff
  global_load_dword v1, v1, s[0:1]
  s_mov_b64 exec, -1
.fz_kernel_ct25e:
  s_branch .fz_kernel_q_hw2
.fz_kernel_att:
  s_setprio 1
  s_and_b32 s39, s16, 1
  s_lshr_b32 s32, s16, 1
  s_lshl1_add_u32 s35, s18, s39
  s_lshl_b32 s35, s35, 5
  s_add_u32 s35, s35, s32
  s_lshl_b32 s35, s35, 13
  s_add_u32 s35, s35, s63
  s_lshl_b32 s34, 1, s17
  s_mov_b32 s36, 0
  v_add_u32 v10, 4096, v3
  v_mfma_f32_32x32x16_bf16 v[48:63], v[80:83], v[16:19], 0
  v_mfma_f32_32x32x16_bf16 v[48:63], v[84:87], v[20:23], v[48:63]
  v_mov_b32 v1, 0x3f803f80
  v_mov_b32 v11, 0x4444
  v_mov_b32 v12, v1
  v_mov_b32 v14, 0
  s_mov_b32 exec_lo, 0xaaaaaaaa
  s_mov_b32 exec_hi, 0xaaaaaaaa
  v_mov_b32 v12, 0
  v_mov_b32 v14, v1
  s_mov_b32 exec_lo, 0xcccccccc
  s_mov_b32 exec_hi, 0xcccccccc
  v_mov_b32 v11, 0xeeee
  s_mov_b64 exec, -1
  v_mov_b32 v13, v12
  v_mov_b32 v15, v14
  v_mov_b32 v208, 0
  v_mov_b32 v209, 0
  v_mov_b32 v210, 0
  v_mov_b32 v211, 0
  v_mov_b32 v212, 0
  v_mov_b32 v213, 0
  v_mov_b32 v214, 0
  v_mov_b32 v215, 0
  v_mov_b32 v216, 0
  v_mov_b32 v217, 0
  v_mov_b32 v218, 0
  v_mov_b32 v219, 0
  v_mov_b32 v220, 0
  v_mov_b32 v221, 0
  v_mov_b32 v222, 0
  v_mov_b32 v223, 0
  s_mov_b32 s32, 8
  s_waitcnt lgkmcnt(0)
  s_barrier
  ds_read_b128 v[32:35], v9 offset:0
  ds_read_b128 v[36:39], v9 offset:1024
  ds_read_b128 v[40:43], v9 offset:2048
  ds_read_b128 v[44:47], v9 offset:3072
  v_mfma_f32_32x32x16_bf16 v[64:79], v[80:83], v[24:27], 0
  v_exp_f32 v48, v48
  v_exp_f32 v49, v49
  v_exp_f32 v50, v50
  v_exp_f32 v51, v51
  v_exp_f32 v52, v52
  v_exp_f32 v53, v53
  v_exp_f32 v54, v54
  v_exp_f32 v55, v55
  v_mfma_f32_32x32x16_bf16 v[64:79], v[84:87], v[28:31], v[64:79]
  v_cvt_pk_bf16_f32 v224, v48, v49
  v_cvt_pk_bf16_f32 v225, v50, v51
  v_cvt_pk_bf16_f32 v226, v52, v53
  v_cvt_pk_bf16_f32 v227, v54, v55
  v_exp_f32 v56, v56
  v_exp_f32 v57, v57
  v_exp_f32 v58, v58
  v_exp_f32 v59, v59
  v_mfma_f32_32x32x16_bf16 v[144:159], v[88:91], v[224:227], 0
  v_exp_f32 v60, v60
  v_exp_f32 v61, v61
  v_exp_f32 v62, v62
  v_exp_f32 v63, v63
  v_cvt_pk_bf16_f32 v228, v56, v57
  v_cvt_pk_bf16_f32 v229, v58, v59
  v_cvt_pk_bf16_f32 v230, v60, v61
  v_cvt_pk_bf16_f32 v231, v62, v63
  s_waitcnt lgkmcnt(0)
  v_mfma_f32_32x32x16_bf16 v[48:63], v[80:83], v[32:35], 0
  v_exp_f32 v64, v64
  v_exp_f32 v65, v65
  v_exp_f32 v66, v66
  v_exp_f32 v67, v67
  v_mfma_f32_32x32x16_bf16 v[144:159], v[92:95], v[228:231], v[144:159]
  v_exp_f32 v68, v68
  v_exp_f32 v69, v69
  v_exp_f32 v70, v70
  v_smfmac_f32_16x16x64_bf16 v[208:211], v[12:15], v[224:231], v11
  v_exp_f32 v71, v71
  v_mfma_f32_32x32x16_bf16 v[48:63], v[84:87], v[36:39], v[48:63]
  v_cvt_pk_bf16_f32 v224, v64, v65
  v_cvt_pk_bf16_f32 v225, v66, v67
  v_cvt_pk_bf16_f32 v226, v68, v69
  v_cvt_pk_bf16_f32 v227, v70, v71
  v_exp_f32 v72, v72
  v_exp_f32 v73, v73
  v_exp_f32 v74, v74
  v_exp_f32 v75, v75
  v_mfma_f32_32x32x16_bf16 v[160:175], v[88:91], v[224:227], 0
  v_exp_f32 v76, v76
  v_exp_f32 v77, v77
  v_exp_f32 v78, v78
  v_exp_f32 v79, v79
  v_cvt_pk_bf16_f32 v228, v72, v73
  v_cvt_pk_bf16_f32 v229, v74, v75
  v_cvt_pk_bf16_f32 v230, v76, v77
  v_cvt_pk_bf16_f32 v231, v78, v79
  s_mov_b64 exec, 1
  s_waitcnt vmcnt(0)
  ds_add_u32 v6, v5 offset:0x100
  s_mov_b64 exec, -1
  v_mfma_f32_32x32x16_bf16 v[64:79], v[80:83], v[40:43], 0
  v_exp_f32 v48, v48
  v_exp_f32 v49, v49
  v_exp_f32 v50, v50
  v_exp_f32 v51, v51
  v_mfma_f32_32x32x16_bf16 v[160:175], v[92:95], v[228:231], v[160:175]
  v_exp_f32 v52, v52
  v_exp_f32 v53, v53
  v_exp_f32 v54, v54
  v_smfmac_f32_16x16x64_bf16 v[212:215], v[12:15], v[224:231], v11
  v_exp_f32 v55, v55
  v_mfma_f32_32x32x16_bf16 v[64:79], v[84:87], v[44:47], v[64:79]
  v_cvt_pk_bf16_f32 v224, v48, v49
  v_cvt_pk_bf16_f32 v225, v50, v51
  v_cvt_pk_bf16_f32 v226, v52, v53
  v_cvt_pk_bf16_f32 v227, v54, v55
  v_exp_f32 v56, v56
  v_exp_f32 v57, v57
  v_exp_f32 v58, v58
  v_exp_f32 v59, v59
  v_mfma_f32_32x32x16_bf16 v[176:191], v[88:91], v[224:227], 0
  ds_read_b32 v7, v6
  v_exp_f32 v60, v60
  v_exp_f32 v61, v61
  v_exp_f32 v62, v62
  v_exp_f32 v63, v63
  v_cvt_pk_bf16_f32 v228, v56, v57
  v_cvt_pk_bf16_f32 v229, v58, v59
  v_cvt_pk_bf16_f32 v230, v60, v61
  v_cvt_pk_bf16_f32 v231, v62, v63
  s_waitcnt lgkmcnt(0)
  v_readfirstlane_b32 s39, v7
  s_andn2_b32 s33, s39, s34
  s_bcnt1_i32_b32 s31, s33
  s_cmp_ge_u32 s31, 2
  s_cbranch_scc1 .fz_kernel_a_e
  v_mfma_f32_32x32x16_bf16 v[48:63], v[96:99], v[16:19], 0
  v_exp_f32 v64, v64
  v_exp_f32 v65, v65
  v_exp_f32 v66, v66
  v_exp_f32 v67, v67
  v_mfma_f32_32x32x16_bf16 v[176:191], v[92:95], v[228:231], v[176:191]
  v_exp_f32 v68, v68
  v_exp_f32 v69, v69
  v_exp_f32 v70, v70
  v_smfmac_f32_16x16x64_bf16 v[216:219], v[12:15], v[224:231], v11
  v_exp_f32 v71, v71
  v_mfma_f32_32x32x16_bf16 v[48:63], v[100:103], v[20:23], v[48:63]
  v_cvt_pk_bf16_f32 v224, v64, v65
  v_cvt_pk_bf16_f32 v225, v66, v67
  v_cvt_pk_bf16_f32 v226, v68, v69
  v_cvt_pk_bf16_f32 v227, v70, v71
  v_exp_f32 v72, v72
  v_exp_f32 v73, v73
  v_exp_f32 v74, v74
  v_exp_f32 v75, v75
  v_mfma_f32_32x32x16_bf16 v[192:207], v[88:91], v[224:227], 0
  v_exp_f32 v76, v76
  v_exp_f32 v77, v77
  v_exp_f32 v78, v78
  v_exp_f32 v79, v79
  v_cvt_pk_bf16_f32 v228, v72, v73
  v_cvt_pk_bf16_f32 v229, v74, v75
  v_cvt_pk_bf16_f32 v230, v76, v77
  v_cvt_pk_bf16_f32 v231, v78, v79
  v_mfma_f32_32x32x16_bf16 v[64:79], v[96:99], v[24:27], 0
  v_exp_f32 v48, v48
  v_exp_f32 v49, v49
  v_exp_f32 v50, v50
  v_exp_f32 v51, v51
  v_mfma_f32_32x32x16_bf16 v[192:207], v[92:95], v[228:231], v[192:207]
  v_exp_f32 v52, v52
  v_exp_f32 v53, v53
  v_exp_f32 v54, v54
  v_smfmac_f32_16x16x64_bf16 v[220:223], v[12:15], v[224:231], v11
  v_exp_f32 v55, v55
  v_mfma_f32_32x32x16_bf16 v[64:79], v[100:103], v[28:31], v[64:79]
  v_cvt_pk_bf16_f32 v224, v48, v49
  v_cvt_pk_bf16_f32 v225, v50, v51
  v_cvt_pk_bf16_f32 v226, v52, v53
  v_cvt_pk_bf16_f32 v227, v54, v55
  v_exp_f32 v56, v56
  v_exp_f32 v57, v57
  v_exp_f32 v58, v58
  v_exp_f32 v59, v59
  v_mfma_f32_32x32x16_bf16 v[144:159], v[104:107], v[224:227], v[144:159]
  v_exp_f32 v60, v60
  v_exp_f32 v61, v61
  v_exp_f32 v62, v62
  v_exp_f32 v63, v63
  v_cvt_pk_bf16_f32 v228, v56, v57
  v_cvt_pk_bf16_f32 v229, v58, v59
  v_cvt_pk_bf16_f32 v230, v60, v61
  v_cvt_pk_bf16_f32 v231, v62, v63
  v_mfma_f32_32x32x16_bf16 v[48:63], v[96:99], v[32:35], 0
  v_exp_f32 v64, v64
  v_exp_f32 v65, v65
  v_exp_f32 v66, v66
  v_exp_f32 v67, v67
  v_mfma_f32_32x32x16_bf16 v[144:159], v[108:111], v[228:231], v[144:159]
  v_exp_f32 v68, v68
  v_exp_f32 v69, v69
  v_exp_f32 v70, v70
  v_smfmac_f32_16x16x64_bf16 v[208:211], v[12:15], v[224:231], v11
  v_exp_f32 v71, v71
  v_mfma_f32_32x32x16_bf16 v[48:63], v[100:103], v[36:39], v[48:63]
  v_cvt_pk_bf16_f32 v224, v64, v65
  v_cvt_pk_bf16_f32 v225, v66, v67
  v_cvt_pk_bf16_f32 v226, v68, v69
  v_cvt_pk_bf16_f32 v227, v70, v71
  v_exp_f32 v72, v72
  v_exp_f32 v73, v73
  v_exp_f32 v74, v74
  v_exp_f32 v75, v75
  v_mfma_f32_32x32x16_bf16 v[160:175], v[104:107], v[224:227], v[160:175]
  ds_read_b32 v7, v6
  v_exp_f32 v76, v76
  v_exp_f32 v77, v77
  v_exp_f32 v78, v78
  v_exp_f32 v79, v79
  v_cvt_pk_bf16_f32 v228, v72, v73
  v_cvt_pk_bf16_f32 v229, v74, v75
  v_cvt_pk_bf16_f32 v230, v76, v77
  v_cvt_pk_bf16_f32 v231, v78, v79
  s_waitcnt lgkmcnt(0)
  v_readfirstlane_b32 s39, v7
  s_andn2_b32 s39, s39, s34
  s_cbranch_scc0 .fz_kernel_a_p0
  s_ff1_i32_b32 s33, s36
  s_bitset0_b32 s36, s33
  s_lshl_b32 s33, s33, 14
  s_add_u32 s30, s33, s35
  s_cbranch_scc1 .fz_kernel_pk26c
.fz_kernel_pk26:
  buffer_load_dwordx4 v[112:115], v3, s[4:7], s30 offen offset:0
  buffer_load_dwordx4 v[116:119], v3, s[4:7], s30 offen offset:1024
  buffer_load_dwordx4 v[120:123], v3, s[4:7], s30 offen offset:2048
  buffer_load_dwordx4 v[124:127], v3, s[4:7], s30 offen offset:3072
  buffer_load_dwordx4 v[128:131], v10, s[4:7], s30 offen offset:0
  buffer_load_dwordx4 v[132:135], v10, s[4:7], s30 offen offset:1024
  buffer_load_dwordx4 v[136:139], v10, s[4:7], s30 offen offset:2048
  buffer_load_dwordx4 v[140:143], v10, s[4:7], s30 offen offset:3072
.fz_kernel_a_p0:
  v_mfma_f32_32x32x16_bf16 v[64:79], v[96:99], v[40:43], 0
  v_exp_f32 v48, v48
  v_exp_f32 v49, v49
  v_exp_f32 v50, v50
  v_exp_f32 v51, v51
  v_mfma_f32_32x32x16_bf16 v[160:175], v[108:111], v[228:231], v[160:175]
  v_exp_f32 v52, v52
  v_exp_f32 v53, v53
  v_exp_f32 v54, v54
  v_smfmac_f32_16x16x64_bf16 v[212:215], v[12:15], v[224:231], v11
  v_exp_f32 v55, v55
  v_mfma_f32_32x32x16_bf16 v[64:79], v[100:103], v[44:47], v[64:79]
  v_cvt_pk_bf16_f32 v224, v48, v49
  v_cvt_pk_bf16_f32 v225, v50, v51
  v_cvt_pk_bf16_f32 v226, v52, v53
  v_cvt_pk_bf16_f32 v227, v54, v55
  v_exp_f32 v56, v56
  v_exp_f32 v57, v57
  v_exp_f32 v58, v58
  v_exp_f32 v59, v59
  v_mfma_f32_32x32x16_bf16 v[176:191], v[104:107], v[224:227], v[176:191]
  v_exp_f32 v60, v60
  v_exp_f32 v61, v61
  v_exp_f32 v62, v62
  v_exp_f32 v63, v63
  v_cvt_pk_bf16_f32 v228, v56, v57
  v_cvt_pk_bf16_f32 v229, v58, v59
  v_cvt_pk_bf16_f32 v230, v60, v61
  v_cvt_pk_bf16_f32 v231, v62, v63
  v_exp_f32 v64, v64
  v_exp_f32 v65, v65
  v_exp_f32 v66, v66
  v_exp_f32 v67, v67
  v_mfma_f32_32x32x16_bf16 v[176:191], v[108:111], v[228:231], v[176:191]
  v_exp_f32 v68, v68
  v_exp_f32 v69, v69
  v_exp_f32 v70, v70
  v_smfmac_f32_16x16x64_bf16 v[216:219], v[12:15], v[224:231], v11
  v_exp_f32 v71, v71
  v_cvt_pk_bf16_f32 v224, v64, v65
  v_cvt_pk_bf16_f32 v225, v66, v67
  v_cvt_pk_bf16_f32 v226, v68, v69
  v_cvt_pk_bf16_f32 v227, v70, v71
  v_exp_f32 v72, v72
  v_exp_f32 v73, v73
  v_exp_f32 v74, v74
  v_exp_f32 v75, v75
  v_mfma_f32_32x32x16_bf16 v[192:207], v[104:107], v[224:227], v[192:207]
  v_exp_f32 v76, v76
  v_exp_f32 v77, v77
  v_exp_f32 v78, v78
  v_exp_f32 v79, v79
  v_cvt_pk_bf16_f32 v228, v72, v73
  v_cvt_pk_bf16_f32 v229, v74, v75
  v_cvt_pk_bf16_f32 v230, v76, v77
  v_cvt_pk_bf16_f32 v231, v78, v79
  s_cmp_lg_u32 s39, 0
  s_cbranch_scc1 .fz_kernel_a_p1
  s_ff1_i32_b32 s33, s36
  s_bitset0_b32 s36, s33
  s_lshl_b32 s33, s33, 14
  s_add_u32 s30, s33, s35
  s_cbranch_scc1 .fz_kernel_pk27c
.fz_kernel_pk27:
  buffer_load_dwordx4 v[112:115], v3, s[4:7], s30 offen offset:0
  buffer_load_dwordx4 v[116:119], v3, s[4:7], s30 offen offset:1024
  buffer_load_dwordx4 v[120:123], v3, s[4:7], s30 offen offset:2048
  buffer_load_dwordx4 v[124:127], v3, s[4:7], s30 offen offset:3072
  buffer_load_dwordx4 v[128:131], v10, s[4:7], s30 offen offset:0
  buffer_load_dwordx4 v[132:135], v10, s[4:7], s30 offen offset:1024
  buffer_load_dwordx4 v[136:139], v10, s[4:7], s30 offen offset:2048
  buffer_load_dwordx4 v[140:143], v10, s[4:7], s30 offen offset:3072
.fz_kernel_a_p1:
  s_ff1_i32_b32 s33, s36
  s_bitset0_b32 s36, s33
  s_lshl_b32 s33, s33, 14
  s_add_u32 s30, s33, s35
  s_cbranch_scc1 .fz_kernel_pk28c
.fz_kernel_pk28:
  buffer_load_dwordx4 v[80:83], v3, s[4:7], s30 offen offset:0
  buffer_load_dwordx4 v[84:87], v3, s[4:7], s30 offen offset:1024
  buffer_load_dwordx4 v[88:91], v3, s[4:7], s30 offen offset:2048
  buffer_load_dwordx4 v[92:95], v3, s[4:7], s30 offen offset:3072
  buffer_load_dwordx4 v[96:99], v10, s[4:7], s30 offen offset:0
  s_waitcnt vmcnt(11)
  v_mfma_f32_32x32x16_bf16 v[48:63], v[112:115], v[16:19], 0
  v_mfma_f32_32x32x16_bf16 v[48:63], v[116:119], v[20:23], v[48:63]
  s_nop 9
  s_branch .fz_kernel_a_b2
.fz_kernel_a_e:
  s_mov_b32 s36, s33
  s_or_b32 s34, s34, s39
  s_ff1_i32_b32 s33, s36
  s_bitset0_b32 s36, s33
  s_lshl_b32 s33, s33, 14
  s_add_u32 s30, s33, s35
  v_mfma_f32_32x32x16_bf16 v[48:63], v[96:99], v[16:19], 0
  buffer_load_dwordx4 v[112:115], v3, s[4:7], s30 offen offset:0
  v_exp_f32 v64, v64
  v_exp_f32 v65, v65
  v_exp_f32 v66, v66
  v_exp_f32 v67, v67
  v_mfma_f32_32x32x16_bf16 v[176:191], v[92:95], v[228:231], v[176:191]
  buffer_load_dwordx4 v[116:119], v3, s[4:7], s30 offen offset:1024
  v_exp_f32 v68, v68
  v_exp_f32 v69, v69
  v_exp_f32 v70, v70
  v_smfmac_f32_16x16x64_bf16 v[216:219], v[12:15], v[224:231], v11
  buffer_load_dwordx4 v[120:123], v3, s[4:7], s30 offen offset:2048
  v_exp_f32 v71, v71
  v_mfma_f32_32x32x16_bf16 v[48:63], v[100:103], v[20:23], v[48:63]
  buffer_load_dwordx4 v[124:127], v3, s[4:7], s30 offen offset:3072
  v_cvt_pk_bf16_f32 v224, v64, v65
  v_cvt_pk_bf16_f32 v225, v66, v67
  v_cvt_pk_bf16_f32 v226, v68, v69
  v_cvt_pk_bf16_f32 v227, v70, v71
  v_exp_f32 v72, v72
  v_exp_f32 v73, v73
  v_exp_f32 v74, v74
  v_exp_f32 v75, v75
  v_mfma_f32_32x32x16_bf16 v[192:207], v[88:91], v[224:227], 0
  buffer_load_dwordx4 v[128:131], v10, s[4:7], s30 offen offset:0
  v_exp_f32 v76, v76
  v_exp_f32 v77, v77
  v_exp_f32 v78, v78
  v_exp_f32 v79, v79
  v_cvt_pk_bf16_f32 v228, v72, v73
  v_cvt_pk_bf16_f32 v229, v74, v75
  v_cvt_pk_bf16_f32 v230, v76, v77
  v_cvt_pk_bf16_f32 v231, v78, v79
  v_mfma_f32_32x32x16_bf16 v[64:79], v[96:99], v[24:27], 0
  buffer_load_dwordx4 v[132:135], v10, s[4:7], s30 offen offset:1024
  v_exp_f32 v48, v48
  v_exp_f32 v49, v49
  v_exp_f32 v50, v50
  v_exp_f32 v51, v51
  v_mfma_f32_32x32x16_bf16 v[192:207], v[92:95], v[228:231], v[192:207]
  buffer_load_dwordx4 v[136:139], v10, s[4:7], s30 offen offset:2048
  v_exp_f32 v52, v52
  v_exp_f32 v53, v53
  v_exp_f32 v54, v54
  v_smfmac_f32_16x16x64_bf16 v[220:223], v[12:15], v[224:231], v11
  buffer_load_dwordx4 v[140:143], v10, s[4:7], s30 offen offset:3072
  v_exp_f32 v55, v55
  v_mfma_f32_32x32x16_bf16 v[64:79], v[100:103], v[28:31], v[64:79]
  s_ff1_i32_b32 s33, s36
  v_cvt_pk_bf16_f32 v224, v48, v49
  v_cvt_pk_bf16_f32 v225, v50, v51
  v_cvt_pk_bf16_f32 v226, v52, v53
  v_cvt_pk_bf16_f32 v227, v54, v55
  v_exp_f32 v56, v56
  v_exp_f32 v57, v57
  v_exp_f32 v58, v58
  v_exp_f32 v59, v59
  v_mfma_f32_32x32x16_bf16 v[144:159], v[104:107], v[224:227], v[144:159]
  s_bitset0_b32 s36, s33
  v_exp_f32 v60, v60
  v_exp_f32 v61, v61
  v_exp_f32 v62, v62
  v_exp_f32 v63, v63
  v_cvt_pk_bf16_f32 v228, v56, v57
  v_cvt_pk_bf16_f32 v229, v58, v59
  v_cvt_pk_bf16_f32 v230, v60, v61
  v_cvt_pk_bf16_f32 v231, v62, v63
  v_mfma_f32_32x32x16_bf16 v[48:63], v[96:99], v[32:35], 0
  s_lshl_b32 s33, s33, 14
  v_exp_f32 v64, v64
  v_exp_f32 v65, v65
  v_exp_f32 v66, v66
  v_exp_f32 v67, v67
  v_mfma_f32_32x32x16_bf16 v[144:159], v[108:111], v[228:231], v[144:159]
  s_add_u32 s30, s33, s35
  v_exp_f32 v68, v68
  v_exp_f32 v69, v69
  v_exp_f32 v70, v70
  v_smfmac_f32_16x16x64_bf16 v[208:211], v[12:15], v[224:231], v11
  buffer_load_dwordx4 v[80:83], v3, s[4:7], s30 offen offset:0
  v_exp_f32 v71, v71
  v_mfma_f32_32x32x16_bf16 v[48:63], v[100:103], v[36:39], v[48:63]
  buffer_load_dwordx4 v[84:87], v3, s[4:7], s30 offen offset:1024
  v_cvt_pk_bf16_f32 v224, v64, v65
  v_cvt_pk_bf16_f32 v225, v66, v67
  v_cvt_pk_bf16_f32 v226, v68, v69
  v_cvt_pk_bf16_f32 v227, v70, v71
  v_exp_f32 v72, v72
  v_exp_f32 v73, v73
  v_exp_f32 v74, v74
  v_exp_f32 v75, v75
  v_mfma_f32_32x32x16_bf16 v[160:175], v[104:107], v[224:227], v[160:175]
  buffer_load_dwordx4 v[88:91], v3, s[4:7], s30 offen offset:2048
  v_exp_f32 v76, v76
  v_exp_f32 v77, v77
  v_exp_f32 v78, v78
  v_exp_f32 v79, v79
  v_cvt_pk_bf16_f32 v228, v72, v73
  v_cvt_pk_bf16_f32 v229, v74, v75
  v_cvt_pk_bf16_f32 v230, v76, v77
  v_cvt_pk_bf16_f32 v231, v78, v79
  v_mfma_f32_32x32x16_bf16 v[64:79], v[96:99], v[40:43], 0
  buffer_load_dwordx4 v[92:95], v3, s[4:7], s30 offen offset:3072
  v_exp_f32 v48, v48
  v_exp_f32 v49, v49
  v_exp_f32 v50, v50
  v_exp_f32 v51, v51
  v_mfma_f32_32x32x16_bf16 v[160:175], v[108:111], v[228:231], v[160:175]
  v_exp_f32 v52, v52
  v_exp_f32 v53, v53
  v_exp_f32 v54, v54
  v_smfmac_f32_16x16x64_bf16 v[212:215], v[12:15], v[224:231], v11
  v_exp_f32 v55, v55
  v_mfma_f32_32x32x16_bf16 v[64:79], v[100:103], v[44:47], v[64:79]
  v_cvt_pk_bf16_f32 v224, v48, v49
  v_cvt_pk_bf16_f32 v225, v50, v51
  v_cvt_pk_bf16_f32 v226, v52, v53
  v_cvt_pk_bf16_f32 v227, v54, v55
  v_exp_f32 v56, v56
  v_exp_f32 v57, v57
  v_exp_f32 v58, v58
  v_exp_f32 v59, v59
  v_mfma_f32_32x32x16_bf16 v[176:191], v[104:107], v[224:227], v[176:191]
  s_waitcnt vmcnt(10)
  v_exp_f32 v60, v60
  v_exp_f32 v61, v61
  v_exp_f32 v62, v62
  v_exp_f32 v63, v63
  v_cvt_pk_bf16_f32 v228, v56, v57
  v_cvt_pk_bf16_f32 v229, v58, v59
  v_cvt_pk_bf16_f32 v230, v60, v61
  v_cvt_pk_bf16_f32 v231, v62, v63
  v_mfma_f32_32x32x16_bf16 v[48:63], v[112:115], v[16:19], 0
  v_exp_f32 v64, v64
  v_exp_f32 v65, v65
  v_exp_f32 v66, v66
  v_exp_f32 v67, v67
  v_mfma_f32_32x32x16_bf16 v[176:191], v[108:111], v[228:231], v[176:191]
  buffer_load_dwordx4 v[96:99], v10, s[4:7], s30 offen offset:0
  v_exp_f32 v68, v68
  v_exp_f32 v69, v69
  v_exp_f32 v70, v70
  v_smfmac_f32_16x16x64_bf16 v[216:219], v[12:15], v[224:231], v11
  v_exp_f32 v71, v71
  v_mfma_f32_32x32x16_bf16 v[48:63], v[116:119], v[20:23], v[48:63]
  v_cvt_pk_bf16_f32 v224, v64, v65
  v_cvt_pk_bf16_f32 v225, v66, v67
  v_cvt_pk_bf16_f32 v226, v68, v69
  v_cvt_pk_bf16_f32 v227, v70, v71
  v_exp_f32 v72, v72
  v_exp_f32 v73, v73
  v_exp_f32 v74, v74
  v_exp_f32 v75, v75
  v_mfma_f32_32x32x16_bf16 v[192:207], v[104:107], v[224:227], v[192:207]
  v_exp_f32 v76, v76
  v_exp_f32 v77, v77
  v_exp_f32 v78, v78
  v_exp_f32 v79, v79
  v_cvt_pk_bf16_f32 v228, v72, v73
  v_cvt_pk_bf16_f32 v229, v74, v75
  v_cvt_pk_bf16_f32 v230, v76, v77
  v_cvt_pk_bf16_f32 v231, v78, v79
  s_branch .fz_kernel_a_b2
  .p2align 6
.fz_kernel_a_loop:
  v_mfma_f32_32x32x16_bf16 v[64:79], v[80:83], v[24:27], 0
  v_exp_f32 v48, v48
  v_exp_f32 v49, v49
  v_exp_f32 v50, v50
  v_exp_f32 v51, v51
  v_mfma_f32_32x32x16_bf16 v[192:207], v[140:143], v[228:231], v[192:207]
  v_exp_f32 v52, v52
  v_exp_f32 v53, v53
  v_exp_f32 v54, v54
  v_smfmac_f32_16x16x64_bf16 v[220:223], v[12:15], v[224:231], v11
  buffer_load_dwordx4 v[132:135], v10, s[4:7], s30 offen offset:1024
  v_exp_f32 v55, v55
  v_mfma_f32_32x32x16_bf16 v[64:79], v[84:87], v[28:31], v[64:79]
  s_waitcnt vmcnt(10)
  v_cvt_pk_bf16_f32 v224, v48, v49
  v_cvt_pk_bf16_f32 v225, v50, v51
  v_cvt_pk_bf16_f32 v226, v52, v53
  v_cvt_pk_bf16_f32 v227, v54, v55
  v_exp_f32 v56, v56
  v_exp_f32 v57, v57
  v_exp_f32 v58, v58
  v_exp_f32 v59, v59
  v_mfma_f32_32x32x16_bf16 v[144:159], v[88:91], v[224:227], v[144:159]
  v_exp_f32 v60, v60
  v_exp_f32 v61, v61
  v_exp_f32 v62, v62
  v_exp_f32 v63, v63
  v_cvt_pk_bf16_f32 v228, v56, v57
  v_cvt_pk_bf16_f32 v229, v58, v59
  v_cvt_pk_bf16_f32 v230, v60, v61
  v_cvt_pk_bf16_f32 v231, v62, v63
  v_mfma_f32_32x32x16_bf16 v[48:63], v[80:83], v[32:35], 0
  v_exp_f32 v64, v64
  v_exp_f32 v65, v65
  v_exp_f32 v66, v66
  v_exp_f32 v67, v67
  v_mfma_f32_32x32x16_bf16 v[144:159], v[92:95], v[228:231], v[144:159]
  v_exp_f32 v68, v68
  v_exp_f32 v69, v69
  v_exp_f32 v70, v70
  v_smfmac_f32_16x16x64_bf16 v[208:211], v[12:15], v[224:231], v11
  buffer_load_dwordx4 v[136:139], v10, s[4:7], s30 offen offset:2048
  v_exp_f32 v71, v71
  v_mfma_f32_32x32x16_bf16 v[48:63], v[84:87], v[36:39], v[48:63]
  s_ff1_i32_b32 s33, s36
  v_cvt_pk_bf16_f32 v224, v64, v65
  v_cvt_pk_bf16_f32 v225, v66, v67
  v_cvt_pk_bf16_f32 v226, v68, v69
  v_cvt_pk_bf16_f32 v227, v70, v71
  v_exp_f32 v72, v72
  v_exp_f32 v73, v73
  v_exp_f32 v74, v74
  v_exp_f32 v75, v75
  v_mfma_f32_32x32x16_bf16 v[160:175], v[88:91], v[224:227], v[160:175]
  s_bitset0_b32 s36, s33
  v_exp_f32 v76, v76
  v_exp_f32 v77, v77
  v_exp_f32 v78, v78
  v_exp_f32 v79, v79
  v_cvt_pk_bf16_f32 v228, v72, v73
  v_cvt_pk_bf16_f32 v229, v74, v75
  v_cvt_pk_bf16_f32 v230, v76, v77
  v_cvt_pk_bf16_f32 v231, v78, v79
  v_mfma_f32_32x32x16_bf16 v[64:79], v[80:83], v[40:43], 0
  s_lshl_b32 s33, s33, 14
  v_exp_f32 v48, v48
  v_exp_f32 v49, v49
  v_exp_f32 v50, v50
  v_exp_f32 v51, v51
  v_mfma_f32_32x32x16_bf16 v[160:175], v[92:95], v[228:231], v[160:175]
  v_exp_f32 v52, v52
  v_exp_f32 v53, v53
  v_exp_f32 v54, v54
  v_smfmac_f32_16x16x64_bf16 v[212:215], v[12:15], v[224:231], v11
  buffer_load_dwordx4 v[140:143], v10, s[4:7], s30 offen offset:3072
  v_exp_f32 v55, v55
  v_mfma_f32_32x32x16_bf16 v[64:79], v[84:87], v[44:47], v[64:79]
  s_add_u32 s30, s33, s35
  v_cvt_pk_bf16_f32 v224, v48, v49
  v_cvt_pk_bf16_f32 v225, v50, v51
  v_cvt_pk_bf16_f32 v226, v52, v53
  v_cvt_pk_bf16_f32 v227, v54, v55
  v_exp_f32 v56, v56
  v_exp_f32 v57, v57
  v_exp_f32 v58, v58
  v_exp_f32 v59, v59
  v_mfma_f32_32x32x16_bf16 v[176:191], v[88:91], v[224:227], v[176:191]
  s_waitcnt vmcnt(10)
  v_exp_f32 v60, v60
  v_exp_f32 v61, v61
  v_exp_f32 v62, v62
  v_exp_f32 v63, v63
  v_cvt_pk_bf16_f32 v228, v56, v57
  v_cvt_pk_bf16_f32 v229, v58, v59
  v_cvt_pk_bf16_f32 v230, v60, v61
  v_cvt_pk_bf16_f32 v231, v62, v63
  v_mfma_f32_32x32x16_bf16 v[48:63], v[96:99], v[16:19], 0
  s_cbranch_scc1 .fz_kernel_pk31c
.fz_kernel_pk31:
  v_exp_f32 v64, v64
  v_exp_f32 v65, v65
  v_exp_f32 v66, v66
  v_exp_f32 v67, v67
  v_mfma_f32_32x32x16_bf16 v[176:191], v[92:95], v[228:231], v[176:191]
  v_exp_f32 v68, v68
  v_exp_f32 v69, v69
  v_exp_f32 v70, v70
  v_smfmac_f32_16x16x64_bf16 v[216:219], v[12:15], v[224:231], v11
  buffer_load_dwordx4 v[80:83], v3, s[4:7], s30 offen offset:0
  v_exp_f32 v71, v71
  v_mfma_f32_32x32x16_bf16 v[48:63], v[100:103], v[20:23], v[48:63]
  v_cvt_pk_bf16_f32 v224, v64, v65
  v_cvt_pk_bf16_f32 v225, v66, v67
  v_cvt_pk_bf16_f32 v226, v68, v69
  v_cvt_pk_bf16_f32 v227, v70, v71
  v_exp_f32 v72, v72
  v_exp_f32 v73, v73
  v_exp_f32 v74, v74
  v_exp_f32 v75, v75
  v_mfma_f32_32x32x16_bf16 v[192:207], v[88:91], v[224:227], v[192:207]
  v_exp_f32 v76, v76
  v_exp_f32 v77, v77
  v_exp_f32 v78, v78
  v_exp_f32 v79, v79
  v_cvt_pk_bf16_f32 v228, v72, v73
  v_cvt_pk_bf16_f32 v229, v74, v75
  v_cvt_pk_bf16_f32 v230, v76, v77
  v_cvt_pk_bf16_f32 v231, v78, v79
  v_mfma_f32_32x32x16_bf16 v[64:79], v[96:99], v[24:27], 0
  v_exp_f32 v48, v48
  v_exp_f32 v49, v49
  v_exp_f32 v50, v50
  v_exp_f32 v51, v51
  v_mfma_f32_32x32x16_bf16 v[192:207], v[92:95], v[228:231], v[192:207]
  v_exp_f32 v52, v52
  v_exp_f32 v53, v53
  v_exp_f32 v54, v54
  v_smfmac_f32_16x16x64_bf16 v[220:223], v[12:15], v[224:231], v11
  buffer_load_dwordx4 v[84:87], v3, s[4:7], s30 offen offset:1024
  v_exp_f32 v55, v55
  v_mfma_f32_32x32x16_bf16 v[64:79], v[100:103], v[28:31], v[64:79]
  s_waitcnt vmcnt(10)
  v_cvt_pk_bf16_f32 v224, v48, v49
  v_cvt_pk_bf16_f32 v225, v50, v51
  v_cvt_pk_bf16_f32 v226, v52, v53
  v_cvt_pk_bf16_f32 v227, v54, v55
  v_exp_f32 v56, v56
  v_exp_f32 v57, v57
  v_exp_f32 v58, v58
  v_exp_f32 v59, v59
  v_mfma_f32_32x32x16_bf16 v[144:159], v[104:107], v[224:227], v[144:159]
  v_exp_f32 v60, v60
  v_exp_f32 v61, v61
  v_exp_f32 v62, v62
  v_exp_f32 v63, v63
  v_cvt_pk_bf16_f32 v228, v56, v57
  v_cvt_pk_bf16_f32 v229, v58, v59
  v_cvt_pk_bf16_f32 v230, v60, v61
  v_cvt_pk_bf16_f32 v231, v62, v63
  v_mfma_f32_32x32x16_bf16 v[48:63], v[96:99], v[32:35], 0
  v_exp_f32 v64, v64
  v_exp_f32 v65, v65
  v_exp_f32 v66, v66
  v_exp_f32 v67, v67
  v_mfma_f32_32x32x16_bf16 v[144:159], v[108:111], v[228:231], v[144:159]
  v_exp_f32 v68, v68
  v_exp_f32 v69, v69
  v_exp_f32 v70, v70
  v_smfmac_f32_16x16x64_bf16 v[208:211], v[12:15], v[224:231], v11
  buffer_load_dwordx4 v[88:91], v3, s[4:7], s30 offen offset:2048
  v_exp_f32 v71, v71
  v_mfma_f32_32x32x16_bf16 v[48:63], v[100:103], v[36:39], v[48:63]
  v_cvt_pk_bf16_f32 v224, v64, v65
  v_cvt_pk_bf16_f32 v225, v66, v67
  v_cvt_pk_bf16_f32 v226, v68, v69
  v_cvt_pk_bf16_f32 v227, v70, v71
  v_exp_f32 v72, v72
  v_exp_f32 v73, v73
  v_exp_f32 v74, v74
  v_exp_f32 v75, v75
  v_mfma_f32_32x32x16_bf16 v[160:175], v[104:107], v[224:227], v[160:175]
  v_exp_f32 v76, v76
  v_exp_f32 v77, v77
  v_exp_f32 v78, v78
  v_exp_f32 v79, v79
  v_cvt_pk_bf16_f32 v228, v72, v73
  v_cvt_pk_bf16_f32 v229, v74, v75
  v_cvt_pk_bf16_f32 v230, v76, v77
  v_cvt_pk_bf16_f32 v231, v78, v79
  v_mfma_f32_32x32x16_bf16 v[64:79], v[96:99], v[40:43], 0
  v_exp_f32 v48, v48
  v_exp_f32 v49, v49
  v_exp_f32 v50, v50
  v_exp_f32 v51, v51
  v_mfma_f32_32x32x16_bf16 v[160:175], v[108:111], v[228:231], v[160:175]
  v_exp_f32 v52, v52
  v_exp_f32 v53, v53
  v_exp_f32 v54, v54
  v_smfmac_f32_16x16x64_bf16 v[212:215], v[12:15], v[224:231], v11
  buffer_load_dwordx4 v[92:95], v3, s[4:7], s30 offen offset:3072
  v_exp_f32 v55, v55
  v_mfma_f32_32x32x16_bf16 v[64:79], v[100:103], v[44:47], v[64:79]
  v_cvt_pk_bf16_f32 v224, v48, v49
  v_cvt_pk_bf16_f32 v225, v50, v51
  v_cvt_pk_bf16_f32 v226, v52, v53
  v_cvt_pk_bf16_f32 v227, v54, v55
  v_exp_f32 v56, v56
  v_exp_f32 v57, v57
  v_exp_f32 v58, v58
  v_exp_f32 v59, v59
  v_mfma_f32_32x32x16_bf16 v[176:191], v[104:107], v[224:227], v[176:191]
  s_waitcnt vmcnt(10)
  v_exp_f32 v60, v60
  v_exp_f32 v61, v61
  v_exp_f32 v62, v62
  v_exp_f32 v63, v63
  v_cvt_pk_bf16_f32 v228, v56, v57
  v_cvt_pk_bf16_f32 v229, v58, v59
  v_cvt_pk_bf16_f32 v230, v60, v61
  v_cvt_pk_bf16_f32 v231, v62, v63
  v_mfma_f32_32x32x16_bf16 v[48:63], v[112:115], v[16:19], 0
  v_exp_f32 v64, v64
  v_exp_f32 v65, v65
  v_exp_f32 v66, v66
  v_exp_f32 v67, v67
  v_mfma_f32_32x32x16_bf16 v[176:191], v[108:111], v[228:231], v[176:191]
  v_exp_f32 v68, v68
  v_exp_f32 v69, v69
  v_exp_f32 v70, v70
  v_smfmac_f32_16x16x64_bf16 v[216:219], v[12:15], v[224:231], v11
  buffer_load_dwordx4 v[96:99], v10, s[4:7], s30 offen offset:0
  v_exp_f32 v71, v71
  v_mfma_f32_32x32x16_bf16 v[48:63], v[116:119], v[20:23], v[48:63]
  v_cvt_pk_bf16_f32 v224, v64, v65
  v_cvt_pk_bf16_f32 v225, v66, v67
  v_cvt_pk_bf16_f32 v226, v68, v69
  v_cvt_pk_bf16_f32 v227, v70, v71
  v_exp_f32 v72, v72
  v_exp_f32 v73, v73
  v_exp_f32 v74, v74
  v_exp_f32 v75, v75
  v_mfma_f32_32x32x16_bf16 v[192:207], v[104:107], v[224:227], v[192:207]
  v_exp_f32 v76, v76
  v_exp_f32 v77, v77
  v_exp_f32 v78, v78
  v_exp_f32 v79, v79
  v_cvt_pk_bf16_f32 v228, v72, v73
  v_cvt_pk_bf16_f32 v229, v74, v75
  v_cvt_pk_bf16_f32 v230, v76, v77
  v_cvt_pk_bf16_f32 v231, v78, v79
.fz_kernel_a_b2:
  v_mfma_f32_32x32x16_bf16 v[64:79], v[112:115], v[24:27], 0
  v_exp_f32 v48, v48
  v_exp_f32 v49, v49
  v_exp_f32 v50, v50
  v_exp_f32 v51, v51
  v_mfma_f32_32x32x16_bf16 v[192:207], v[108:111], v[228:231], v[192:207]
  v_exp_f32 v52, v52
  v_exp_f32 v53, v53
  v_exp_f32 v54, v54
  v_smfmac_f32_16x16x64_bf16 v[220:223], v[12:15], v[224:231], v11
  buffer_load_dwordx4 v[100:103], v10, s[4:7], s30 offen offset:1024
  v_exp_f32 v55, v55
  v_mfma_f32_32x32x16_bf16 v[64:79], v[116:119], v[28:31], v[64:79]
  s_waitcnt vmcnt(10)
  v_cvt_pk_bf16_f32 v224, v48, v49
  v_cvt_pk_bf16_f32 v225, v50, v51
  v_cvt_pk_bf16_f32 v226, v52, v53
  v_cvt_pk_bf16_f32 v227, v54, v55
  v_exp_f32 v56, v56
  v_exp_f32 v57, v57
  v_exp_f32 v58, v58
  v_exp_f32 v59, v59
  v_mfma_f32_32x32x16_bf16 v[144:159], v[120:123], v[224:227], v[144:159]
  v_exp_f32 v60, v60
  v_exp_f32 v61, v61
  v_exp_f32 v62, v62
  v_exp_f32 v63, v63
  v_cvt_pk_bf16_f32 v228, v56, v57
  v_cvt_pk_bf16_f32 v229, v58, v59
  v_cvt_pk_bf16_f32 v230, v60, v61
  v_cvt_pk_bf16_f32 v231, v62, v63
  v_mfma_f32_32x32x16_bf16 v[48:63], v[112:115], v[32:35], 0
  v_exp_f32 v64, v64
  v_exp_f32 v65, v65
  v_exp_f32 v66, v66
  v_exp_f32 v67, v67
  v_mfma_f32_32x32x16_bf16 v[144:159], v[124:127], v[228:231], v[144:159]
  v_exp_f32 v68, v68
  v_exp_f32 v69, v69
  v_exp_f32 v70, v70
  v_smfmac_f32_16x16x64_bf16 v[208:211], v[12:15], v[224:231], v11
  buffer_load_dwordx4 v[104:107], v10, s[4:7], s30 offen offset:2048
  v_exp_f32 v71, v71
  v_mfma_f32_32x32x16_bf16 v[48:63], v[116:119], v[36:39], v[48:63]
  s_ff1_i32_b32 s33, s36
  v_cvt_pk_bf16_f32 v224, v64, v65
  v_cvt_pk_bf16_f32 v225, v66, v67
  v_cvt_pk_bf16_f32 v226, v68, v69
  v_cvt_pk_bf16_f32 v227, v70, v71
  v_exp_f32 v72, v72
  v_exp_f32 v73, v73
  v_exp_f32 v74, v74
  v_exp_f32 v75, v75
  v_mfma_f32_32x32x16_bf16 v[160:175], v[120:123], v[224:227], v[160:175]
  s_bitset0_b32 s36, s33
  v_exp_f32 v76, v76
  v_exp_f32 v77, v77
  v_exp_f32 v78, v78
  v_exp_f32 v79, v79
  v_cvt_pk_bf16_f32 v228, v72, v73
  v_cvt_pk_bf16_f32 v229, v74, v75
  v_cvt_pk_bf16_f32 v230, v76, v77
  v_cvt_pk_bf16_f32 v231, v78, v79
  v_mfma_f32_32x32x16_bf16 v[64:79], v[112:115], v[40:43], 0
  s_lshl_b32 s33, s33, 14
  v_exp_f32 v48, v48
  v_exp_f32 v49, v49
  v_exp_f32 v50, v50
  v_exp_f32 v51, v51
  v_mfma_f32_32x32x16_bf16 v[160:175], v[124:127], v[228:231], v[160:175]
  v_exp_f32 v52, v52
  v_exp_f32 v53, v53
  v_exp_f32 v54, v54
  v_smfmac_f32_16x16x64_bf16 v[212:215], v[12:15], v[224:231], v11
  buffer_load_dwordx4 v[108:111], v10, s[4:7], s30 offen offset:3072
  v_exp_f32 v55, v55
  v_mfma_f32_32x32x16_bf16 v[64:79], v[116:119], v[44:47], v[64:79]
  s_add_u32 s30, s33, s35
  v_cvt_pk_bf16_f32 v224, v48, v49
  v_cvt_pk_bf16_f32 v225, v50, v51
  v_cvt_pk_bf16_f32 v226, v52, v53
  v_cvt_pk_bf16_f32 v227, v54, v55
  v_exp_f32 v56, v56
  v_exp_f32 v57, v57
  v_exp_f32 v58, v58
  v_exp_f32 v59, v59
  v_mfma_f32_32x32x16_bf16 v[176:191], v[120:123], v[224:227], v[176:191]
  s_waitcnt vmcnt(10)
  v_exp_f32 v60, v60
  v_exp_f32 v61, v61
  v_exp_f32 v62, v62
  v_exp_f32 v63, v63
  v_cvt_pk_bf16_f32 v228, v56, v57
  v_cvt_pk_bf16_f32 v229, v58, v59
  v_cvt_pk_bf16_f32 v230, v60, v61
  v_cvt_pk_bf16_f32 v231, v62, v63
  v_mfma_f32_32x32x16_bf16 v[48:63], v[128:131], v[16:19], 0
  s_cbranch_scc1 .fz_kernel_pk32c
.fz_kernel_pk32:
  v_exp_f32 v64, v64
  v_exp_f32 v65, v65
  v_exp_f32 v66, v66
  v_exp_f32 v67, v67
  v_mfma_f32_32x32x16_bf16 v[176:191], v[124:127], v[228:231], v[176:191]
  v_exp_f32 v68, v68
  v_exp_f32 v69, v69
  v_exp_f32 v70, v70
  v_smfmac_f32_16x16x64_bf16 v[216:219], v[12:15], v[224:231], v11
  buffer_load_dwordx4 v[112:115], v3, s[4:7], s30 offen offset:0
  v_exp_f32 v71, v71
  v_mfma_f32_32x32x16_bf16 v[48:63], v[132:135], v[20:23], v[48:63]
  v_cvt_pk_bf16_f32 v224, v64, v65
  v_cvt_pk_bf16_f32 v225, v66, v67
  v_cvt_pk_bf16_f32 v226, v68, v69
  v_cvt_pk_bf16_f32 v227, v70, v71
  v_exp_f32 v72, v72
  v_exp_f32 v73, v73
  v_exp_f32 v74, v74
  v_exp_f32 v75, v75
  v_mfma_f32_32x32x16_bf16 v[192:207], v[120:123], v[224:227], v[192:207]
  v_exp_f32 v76, v76
  v_exp_f32 v77, v77
  v_exp_f32 v78, v78
  v_exp_f32 v79, v79
  v_cvt_pk_bf16_f32 v228, v72, v73
  v_cvt_pk_bf16_f32 v229, v74, v75
  v_cvt_pk_bf16_f32 v230, v76, v77
  v_cvt_pk_bf16_f32 v231, v78, v79
  v_mfma_f32_32x32x16_bf16 v[64:79], v[128:131], v[24:27], 0
  v_exp_f32 v48, v48
  v_exp_f32 v49, v49
  v_exp_f32 v50, v50
  v_exp_f32 v51, v51
  v_mfma_f32_32x32x16_bf16 v[192:207], v[124:127], v[228:231], v[192:207]
  v_exp_f32 v52, v52
  v_exp_f32 v53, v53
  v_exp_f32 v54, v54
  v_smfmac_f32_16x16x64_bf16 v[220:223], v[12:15], v[224:231], v11
  buffer_load_dwordx4 v[116:119], v3, s[4:7], s30 offen offset:1024
  v_exp_f32 v55, v55
  v_mfma_f32_32x32x16_bf16 v[64:79], v[132:135], v[28:31], v[64:79]
  s_waitcnt vmcnt(10)
  v_cvt_pk_bf16_f32 v224, v48, v49
  v_cvt_pk_bf16_f32 v225, v50, v51
  v_cvt_pk_bf16_f32 v226, v52, v53
  v_cvt_pk_bf16_f32 v227, v54, v55
  v_exp_f32 v56, v56
  v_exp_f32 v57, v57
  v_exp_f32 v58, v58
  v_exp_f32 v59, v59
  v_mfma_f32_32x32x16_bf16 v[144:159], v[136:139], v[224:227], v[144:159]
  v_exp_f32 v60, v60
  v_exp_f32 v61, v61
  v_exp_f32 v62, v62
  v_exp_f32 v63, v63
  v_cvt_pk_bf16_f32 v228, v56, v57
  v_cvt_pk_bf16_f32 v229, v58, v59
  v_cvt_pk_bf16_f32 v230, v60, v61
  v_cvt_pk_bf16_f32 v231, v62, v63
  v_mfma_f32_32x32x16_bf16 v[48:63], v[128:131], v[32:35], 0
  v_exp_f32 v64, v64
  v_exp_f32 v65, v65
  v_exp_f32 v66, v66
  v_exp_f32 v67, v67
  v_mfma_f32_32x32x16_bf16 v[144:159], v[140:143], v[228:231], v[144:159]
  v_exp_f32 v68, v68
  v_exp_f32 v69, v69
  v_exp_f32 v70, v70
  v_smfmac_f32_16x16x64_bf16 v[208:211], v[12:15], v[224:231], v11
  buffer_load_dwordx4 v[120:123], v3, s[4:7], s30 offen offset:2048
  v_exp_f32 v71, v71
  v_mfma_f32_32x32x16_bf16 v[48:63], v[132:135], v[36:39], v[48:63]
  v_cvt_pk_bf16_f32 v224, v64, v65
  v_cvt_pk_bf16_f32 v225, v66, v67
  v_cvt_pk_bf16_f32 v226, v68, v69
  v_cvt_pk_bf16_f32 v227, v70, v71
  v_exp_f32 v72, v72
  v_exp_f32 v73, v73
  v_exp_f32 v74, v74
  v_exp_f32 v75, v75
  v_mfma_f32_32x32x16_bf16 v[160:175], v[136:139], v[224:227], v[160:175]
  v_exp_f32 v76, v76
  v_exp_f32 v77, v77
  v_exp_f32 v78, v78
  v_exp_f32 v79, v79
  v_cvt_pk_bf16_f32 v228, v72, v73
  v_cvt_pk_bf16_f32 v229, v74, v75
  v_cvt_pk_bf16_f32 v230, v76, v77
  v_cvt_pk_bf16_f32 v231, v78, v79
  v_mfma_f32_32x32x16_bf16 v[64:79], v[128:131], v[40:43], 0
  v_exp_f32 v48, v48
  v_exp_f32 v49, v49
  v_exp_f32 v50, v50
  v_exp_f32 v51, v51
  v_mfma_f32_32x32x16_bf16 v[160:175], v[140:143], v[228:231], v[160:175]
  v_exp_f32 v52, v52
  v_exp_f32 v53, v53
  v_exp_f32 v54, v54
  v_smfmac_f32_16x16x64_bf16 v[212:215], v[12:15], v[224:231], v11
  buffer_load_dwordx4 v[124:127], v3, s[4:7], s30 offen offset:3072
  v_exp_f32 v55, v55
  v_mfma_f32_32x32x16_bf16 v[64:79], v[132:135], v[44:47], v[64:79]
  v_cvt_pk_bf16_f32 v224, v48, v49
  v_cvt_pk_bf16_f32 v225, v50, v51
  v_cvt_pk_bf16_f32 v226, v52, v53
  v_cvt_pk_bf16_f32 v227, v54, v55
  v_exp_f32 v56, v56
  v_exp_f32 v57, v57
  v_exp_f32 v58, v58
  v_exp_f32 v59, v59
  v_mfma_f32_32x32x16_bf16 v[176:191], v[136:139], v[224:227], v[176:191]
  s_waitcnt vmcnt(10)
  v_exp_f32 v60, v60
  v_exp_f32 v61, v61
  v_exp_f32 v62, v62
  v_exp_f32 v63, v63
  v_cvt_pk_bf16_f32 v228, v56, v57
  v_cvt_pk_bf16_f32 v229, v58, v59
  v_cvt_pk_bf16_f32 v230, v60, v61
  v_cvt_pk_bf16_f32 v231, v62, v63
  v_mfma_f32_32x32x16_bf16 v[48:63], v[80:83], v[16:19], 0
  v_exp_f32 v64, v64
  v_exp_f32 v65, v65
  v_exp_f32 v66, v66
  v_exp_f32 v67, v67
  v_mfma_f32_32x32x16_bf16 v[176:191], v[140:143], v[228:231], v[176:191]
  v_exp_f32 v68, v68
  v_exp_f32 v69, v69
  v_exp_f32 v70, v70
  v_smfmac_f32_16x16x64_bf16 v[216:219], v[12:15], v[224:231], v11
  buffer_load_dwordx4 v[128:131], v10, s[4:7], s30 offen offset:0
  v_exp_f32 v71, v71
  v_mfma_f32_32x32x16_bf16 v[48:63], v[84:87], v[20:23], v[48:63]
  s_sub_u32 s32, s32, 1
  v_cvt_pk_bf16_f32 v224, v64, v65
  v_cvt_pk_bf16_f32 v225, v66, v67
  v_cvt_pk_bf16_f32 v226, v68, v69
  v_cvt_pk_bf16_f32 v227, v70, v71
  v_exp_f32 v72, v72
  v_exp_f32 v73, v73
  v_exp_f32 v74, v74
  v_exp_f32 v75, v75
  v_mfma_f32_32x32x16_bf16 v[192:207], v[136:139], v[224:227], v[192:207]
  s_cmp_lg_u32 s32, 0
  v_exp_f32 v76, v76
  v_exp_f32 v77, v77
  v_exp_f32 v78, v78
  v_exp_f32 v79, v79
  v_cvt_pk_bf16_f32 v228, v72, v73
  v_cvt_pk_bf16_f32 v229, v74, v75
  v_cvt_pk_bf16_f32 v230, v76, v77
  v_cvt_pk_bf16_f32 v231, v78, v79
  s_cbranch_scc1 .fz_kernel_a_loop
  v_cvt_pk_bf16_f32 v176, v176, v177
  v_cvt_pk_bf16_f32 v177, v178, v179
  v_mfma_f32_32x32x16_bf16 v[192:207], v[140:143], v[228:231], v[192:207]
  v_cvt_pk_bf16_f32 v178, v180, v181
  v_cvt_pk_bf16_f32 v179, v182, v183
  v_cvt_pk_bf16_f32 v180, v184, v185
  v_cvt_pk_bf16_f32 v181, v186, v187
  v_cvt_pk_bf16_f32 v182, v188, v189
  v_smfmac_f32_16x16x64_bf16 v[220:223], v[12:15], v[224:231], v11
  v_cvt_pk_bf16_f32 v183, v190, v191
  s_lshl_b32 s33, s16, 12
  s_add_u32 s33, s33, 131072
  v_add_u32 v36, s33, v3
  ds_write_b128 v36, v[176:179]
  ds_write_b128 v36, v[180:183] offset:1024
  s_and_b32 s39, s16, 1
  v_and_b32 v32, 16, v2
  v_cmp_ne_u32 s[34:35], 0, v32
  v_and_b32 v35, 31, v2
  v_lshlrev_b32 v35, 3, v35
  s_lshl_b32 s33, s16, 8
  s_add_u32 s33, s33, 147456
  v_add_u32 v37, s33, v35
  v_cvt_pk_bf16_f32 v192, v192, v193
  v_cvt_pk_bf16_f32 v193, v194, v195
  v_cvt_pk_bf16_f32 v194, v196, v197
  v_cvt_pk_bf16_f32 v195, v198, v199
  v_cvt_pk_bf16_f32 v196, v200, v201
  v_cvt_pk_bf16_f32 v197, v202, v203
  v_cvt_pk_bf16_f32 v198, v204, v205
  v_cvt_pk_bf16_f32 v199, v206, v207
  ds_write_b128 v36, v[192:195] offset:2048
  ds_write_b128 v36, v[196:199] offset:3072
  v_add_f32 v216, v216, v218
  v_add_f32 v217, v217, v219
  v_add_f32 v220, v220, v222
  v_add_f32 v221, v221, v223
  v_cndmask_b32 v38, v216, v217, s[34:35]
  v_cndmask_b32 v39, v220, v221, s[34:35]
  ds_write_b64 v37, v[38:39]
  v_add_f32 v208, v208, v210
  v_add_f32 v209, v209, v211
  v_add_f32 v212, v212, v214
  v_add_f32 v213, v213, v215
  v_cndmask_b32 v32, v208, v209, s[34:35]
  v_cndmask_b32 v33, v212, v213, s[34:35]
  v_xor_b32 v36, 8192, v36
  v_xor_b32 v37, 512, v37
  s_waitcnt vmcnt(0) lgkmcnt(0)
  s_barrier
  ds_read_b128 v[48:51], v36 offset:0
  ds_read_b128 v[52:55], v36 offset:1024
  ds_read_b128 v[56:59], v36 offset:2048
  ds_read_b128 v[60:63], v36 offset:3072
  ds_read_b64 v[38:39], v37
  v_mov_b32 v41, 8.673617379884035e-19
  v_mov_b32 v42, 1.152921504606847e+18
  s_and_b32 s32, s16, 2
  s_lshl2_add_u32 s31, s17, s32
  s_lshl_b32 s31, s31, 4
  s_add_u32 s31, s31, s18
  s_lshl1_add_u32 s31, s31, s39
  s_lshl_b32 s31, s31, 11
  s_add_u32 s28, s31, s64
  s_add_u32 s29, s28, 65536
  s_waitcnt lgkmcnt(4)
  v_mfma_f32_32x32x16_bf16 v[144:159], v[248:251], v[48:51], v[144:159]
  s_waitcnt lgkmcnt(3)
  v_mfma_f32_32x32x16_bf16 v[144:159], v[252:255], v[52:55], v[144:159]
  s_waitcnt lgkmcnt(2)
  v_mfma_f32_32x32x16_bf16 v[160:175], v[248:251], v[56:59], v[160:175]
  s_waitcnt lgkmcnt(1)
  v_mfma_f32_32x32x16_bf16 v[160:175], v[252:255], v[60:63], v[160:175]
  s_waitcnt lgkmcnt(0)
  v_add_f32 v32, v32, v38
  v_add_f32 v33, v33, v39
  s_mov_b32 s73, 0
.fz_kernel_a_fin:
  v_rcp_f32 v34, v32
  v_rcp_f32 v36, v33
  v_min_f32 v38, v32, v33
  v_max_f32 v39, v32, v33
  v_cmp_o_f32 s[36:37], v32, v33
  v_cmp_ge_f32 vcc, v38, v41
  s_and_b64 s[36:37], s[36:37], vcc
  v_cmp_le_f32 vcc, v39, v42
  s_and_b64 s[36:37], s[36:37], vcc
  v_pk_mul_f32 v[144:145], v[144:145], v[34:35] op_sel_hi:[1,0]
  v_pk_mul_f32 v[146:147], v[146:147], v[34:35] op_sel_hi:[1,0]
  v_pk_mul_f32 v[148:149], v[148:149], v[34:35] op_sel_hi:[1,0]
  v_pk_mul_f32 v[150:151], v[150:151], v[34:35] op_sel_hi:[1,0]
  v_cvt_pk_bf16_f32 v48, v144, v145
  v_cvt_pk_bf16_f32 v49, v146, v147
  v_cvt_pk_bf16_f32 v50, v148, v149
  v_cvt_pk_bf16_f32 v51, v150, v151
  buffer_store_dwordx4 v[48:51], v3, s[4:7], s28 offen offset:0 sc1
  v_pk_mul_f32 v[152:153], v[152:153], v[34:35] op_sel_hi:[1,0]
  v_pk_mul_f32 v[154:155], v[154:155], v[34:35] op_sel_hi:[1,0]
  v_pk_mul_f32 v[156:157], v[156:157], v[34:35] op_sel_hi:[1,0]
  v_pk_mul_f32 v[158:159], v[158:159], v[34:35] op_sel_hi:[1,0]
  v_cvt_pk_bf16_f32 v52, v152, v153
  v_cvt_pk_bf16_f32 v53, v154, v155
  v_cvt_pk_bf16_f32 v54, v156, v157
  v_cvt_pk_bf16_f32 v55, v158, v159
  buffer_store_dwordx4 v[52:55], v3, s[4:7], s28 offen offset:1024 sc1
  v_pk_mul_f32 v[160:161], v[160:161], v[36:37] op_sel_hi:[1,0]
  v_pk_mul_f32 v[162:163], v[162:163], v[36:37] op_sel_hi:[1,0]
  v_pk_mul_f32 v[164:165], v[164:165], v[36:37] op_sel_hi:[1,0]
  v_pk_mul_f32 v[166:167], v[166:167], v[36:37] op_sel_hi:[1,0]
  v_cvt_pk_bf16_f32 v56, v160, v161
  v_cvt_pk_bf16_f32 v57, v162, v163
  v_cvt_pk_bf16_f32 v58, v164, v165
  v_cvt_pk_bf16_f32 v59, v166, v167
  buffer_store_dwordx4 v[56:59], v3, s[4:7], s29 offen offset:0 sc1
  v_pk_mul_f32 v[168:169], v[168:169], v[36:37] op_sel_hi:[1,0]
  v_pk_mul_f32 v[170:171], v[170:171], v[36:37] op_sel_hi:[1,0]
  v_pk_mul_f32 v[172:173], v[172:173], v[36:37] op_sel_hi:[1,0]
  v_pk_mul_f32 v[174:175], v[174:175], v[36:37] op_sel_hi:[1,0]
  v_cvt_pk_bf16_f32 v60, v168, v169
  v_cvt_pk_bf16_f32 v61, v170, v171
  v_cvt_pk_bf16_f32 v62, v172, v173
  v_cvt_pk_bf16_f32 v63, v174, v175
  buffer_store_dwordx4 v[60:63], v3, s[4:7], s29 offen offset:1024 sc1
  ds_read_b32 v7, v6 offset:8
  v_pk_fma_f32 v[64:65], v[144:145], 0, 0 op_sel_hi:[1,0,0]
  v_pk_fma_f32 v[66:67], v[146:147], 0, 0 op_sel_hi:[1,0,0]
  v_pk_fma_f32 v[64:65], v[148:149], 0, v[64:65] op_sel_hi:[1,0,1]
  v_pk_fma_f32 v[66:67], v[150:151], 0, v[66:67] op_sel_hi:[1,0,1]
  v_pk_fma_f32 v[64:65], v[152:153], 0, v[64:65] op_sel_hi:[1,0,1]
  v_pk_fma_f32 v[66:67], v[154:155], 0, v[66:67] op_sel_hi:[1,0,1]
  v_pk_fma_f32 v[64:65], v[156:157], 0, v[64:65] op_sel_hi:[1,0,1]
  v_pk_fma_f32 v[66:67], v[158:159], 0, v[66:67] op_sel_hi:[1,0,1]
  v_pk_fma_f32 v[64:65], v[160:161], 0, v[64:65] op_sel_hi:[1,0,1]
  v_pk_fma_f32 v[66:67], v[162:163], 0, v[66:67] op_sel_hi:[1,0,1]
  v_pk_fma_f32 v[64:65], v[164:165], 0, v[64:65] op_sel_hi:[1,0,1]
  v_pk_fma_f32 v[66:67], v[166:167], 0, v[66:67] op_sel_hi:[1,0,1]
  v_pk_fma_f32 v[64:65], v[168:169], 0, v[64:65] op_sel_hi:[1,0,1]
  v_pk_fma_f32 v[66:67], v[170:171], 0, v[66:67] op_sel_hi:[1,0,1]
  v_pk_fma_f32 v[64:65], v[172:173], 0, v[64:65] op_sel_hi:[1,0,1]
  v_pk_fma_f32 v[66:67], v[174:175], 0, v[66:67] op_sel_hi:[1,0,1]
  v_pk_add_f32 v[64:65], v[64:65], v[66:67]
  v_cmp_o_f32 vcc, v64, v65
  s_and_b64 s[36:37], s[36:37], vcc
  s_cmp_eq_u64 s[36:37], -1
  s_cbranch_scc0 .fz_kernel_a_slow
.fz_kernel_a_ok:
  s_mov_b32 s8, s48
  s_mov_b32 s9, s49
  s_mov_b32 s10, 0x800
  s_mov_b32 s11, 0x00020000
  v_lshrrev_b32 v17, 5, v2
  v_lshlrev_b32 v19, 4, v17
  s_lshl_b32 s22, s18, 7
  s_lshl2_add_u32 s32, s17, s16
  s_lshl_b32 s35, s32, 16
  s_add_u32 s35, s35, s64
  s_mov_b32 s34, 0
  v_add_u32 v6, 8, v6
  buffer_load_dwordx4 v[48:51], v19, s[8:11], s22 offen offset:0
  buffer_load_dwordx4 v[52:55], v19, s[8:11], s22 offen offset:32
  buffer_load_dwordx4 v[56:59], v19, s[8:11], s22 offen offset:64
  buffer_load_dwordx4 v[60:63], v19, s[8:11], s22 offen offset:96
  s_waitcnt lgkmcnt(0)
  v_readfirstlane_b32 s36, v7
  s_bcnt1_i32_b32 s29, s36
  s_cmp_lt_u32 s29, 3
  s_cbranch_scc1 .fz_kernel_w_e0
  s_andn2_b32 s33, s36, s34
  s_cbranch_scc0 .fz_kernel_pk41c
.fz_kernel_pk41:
  s_ff1_i32_b32 s33, s33
  s_bitset1_b32 s34, s33
  s_lshl_b32 s20, s33, 13
  s_lshl_b32 s33, s33, 12
  s_add_u32 s30, s33, s35
  buffer_load_dwordx4 v[96:99], v3, s[4:7], s30 offen offset:0
  buffer_load_dwordx4 v[100:103], v3, s[4:7], s30 offen offset:1024
  buffer_load_dwordx4 v[104:107], v3, s[4:7], s30 offen offset:2048
  buffer_load_dwordx4 v[108:111], v3, s[4:7], s30 offen offset:3072
  s_andn2_b32 s33, s36, s34
  s_cbranch_scc0 .fz_kernel_pk42c
.fz_kernel_pk42:
  s_ff1_i32_b32 s33, s33
  s_bitset1_b32 s34, s33
  s_lshl_b32 s21, s33, 13
  s_lshl_b32 s33, s33, 12
  s_add_u32 s30, s33, s35
  buffer_load_dwordx4 v[112:115], v3, s[4:7], s30 offen offset:0
  buffer_load_dwordx4 v[116:119], v3, s[4:7], s30 offen offset:1024
  buffer_load_dwordx4 v[120:123], v3, s[4:7], s30 offen offset:2048
  buffer_load_dwordx4 v[124:127], v3, s[4:7], s30 offen offset:3072
  s_andn2_b32 s33, s36, s34
  s_cbranch_scc0 .fz_kernel_pk43c
.fz_kernel_pk43:
  s_ff1_i32_b32 s33, s33
  s_bitset1_b32 s34, s33
  s_lshl_b32 s22, s33, 13
  s_lshl_b32 s33, s33, 12
  s_add_u32 s30, s33, s35
  buffer_load_dwordx4 v[128:131], v3, s[4:7], s30 offen offset:0
  buffer_load_dwordx4 v[132:135], v3, s[4:7], s30 offen offset:1024
  buffer_load_dwordx4 v[136:139], v3, s[4:7], s30 offen offset:2048
  buffer_load_dwordx4 v[140:143], v3, s[4:7], s30 offen offset:3072
.fz_kernel_w_e0:
  v_and_b32 v18, 31, v2
  s_lshl_b32 s39, s17, 4
  s_add_u32 s39, s39, s18
  s_lshl_b32 s39, s39, 2
  s_add_u32 s39, s39, s16
  s_lshl_b32 s39, s39, 12
  v_and_b32 v16, 16, v2
  v_lshlrev_b32 v16, 7, v16
  v_lshl_add_u32 v16, v17, 8, v16
  v_and_b32 v1, 0xf0, v3
  v_add_u32 v16, v16, v1
  s_add_u32 s39, s39, s65
  s_lshl_b32 s31, s16, 5
  v_add_u32 v45, s31, v18
  v_lshlrev_b32 v11, 2, v45
  v_add_u32 v11, 155648, v11
  v_mov_b32 v44, 159952
  ds_read_b32 v40, v11 offset:6400
  ds_read_b32 v42, v11 offset:6912
  ds_read_b32 v46, v44 offset:8
  ds_read_b32 v44, v44
  v_mov_b32 v47, 0.32768
  v_add_u32 v45, 1, v45
  v_bfe_u32 v11, v2, 2, 2
  v_lshl_add_u32 v12, v17, 2, v11
  v_lshlrev_b32 v12, 7, v12
  v_lshrrev_b32 v13, 1, v11
  v_lshl_add_u32 v12, v13, 6, v12
  v_bfe_u32 v13, v2, 4, 1
  v_lshl_add_u32 v12, v13, 5, v12
  v_and_b32 v13, 1, v2
  v_lshl_add_u32 v12, v13, 4, v12
  v_bfe_u32 v13, v2, 1, 1
  v_lshl_add_u32 v14, v13, 3, v12
  v_xor_b32 v15, 64, v14
  s_waitcnt lgkmcnt(0)
  v_lshlrev_b32 v64, 16, v232
  v_and_b32 v65, 0xffff0000, v232
  v_lshlrev_b32 v66, 16, v233
  v_and_b32 v67, 0xffff0000, v233
  v_lshlrev_b32 v68, 16, v234
  v_and_b32 v69, 0xffff0000, v234
  v_lshlrev_b32 v70, 16, v235
  v_and_b32 v71, 0xffff0000, v235
  v_lshlrev_b32 v72, 16, v236
  v_and_b32 v73, 0xffff0000, v236
  v_lshlrev_b32 v74, 16, v237
  v_and_b32 v75, 0xffff0000, v237
  v_lshlrev_b32 v76, 16, v238
  v_and_b32 v77, 0xffff0000, v238
  v_lshlrev_b32 v78, 16, v239
  v_and_b32 v79, 0xffff0000, v239
  v_lshlrev_b32 v80, 16, v240
  v_and_b32 v81, 0xffff0000, v240
  v_lshlrev_b32 v82, 16, v241
  v_and_b32 v83, 0xffff0000, v241
  v_lshlrev_b32 v84, 16, v242
  v_and_b32 v85, 0xffff0000, v242
  v_lshlrev_b32 v86, 16, v243
  v_and_b32 v87, 0xffff0000, v243
  v_lshlrev_b32 v88, 16, v244
  v_and_b32 v89, 0xffff0000, v244
  v_lshlrev_b32 v90, 16, v245
  v_and_b32 v91, 0xffff0000, v245
  v_lshlrev_b32 v92, 16, v246
  v_and_b32 v93, 0xffff0000, v246
  v_lshlrev_b32 v94, 16, v247
  v_and_b32 v95, 0xffff0000, v247
  v_pk_fma_f32 v[64:65], v[64:65], v[40:41], v[42:43] op_sel_hi:[1,0,0]
  v_pk_fma_f32 v[66:67], v[66:67], v[40:41], v[42:43] op_sel_hi:[1,0,0]
  v_pk_fma_f32 v[68:69], v[68:69], v[40:41], v[42:43] op_sel_hi:[1,0,0]
  v_pk_fma_f32 v[70:71], v[70:71], v[40:41], v[42:43] op_sel_hi:[1,0,0]
  v_pk_fma_f32 v[72:73], v[72:73], v[40:41], v[42:43] op_sel_hi:[1,0,0]
  v_pk_fma_f32 v[74:75], v[74:75], v[40:41], v[42:43] op_sel_hi:[1,0,0]
  v_pk_fma_f32 v[76:77], v[76:77], v[40:41], v[42:43] op_sel_hi:[1,0,0]
  v_pk_fma_f32 v[78:79], v[78:79], v[40:41], v[42:43] op_sel_hi:[1,0,0]
  v_pk_fma_f32 v[80:81], v[80:81], v[40:41], v[42:43] op_sel_hi:[1,0,0]
  v_pk_fma_f32 v[82:83], v[82:83], v[40:41], v[42:43] op_sel_hi:[1,0,0]
  v_pk_fma_f32 v[84:85], v[84:85], v[40:41], v[42:43] op_sel_hi:[1,0,0]
  v_pk_fma_f32 v[86:87], v[86:87], v[40:41], v[42:43] op_sel_hi:[1,0,0]
  v_pk_fma_f32 v[88:89], v[88:89], v[40:41], v[42:43] op_sel_hi:[1,0,0]
  v_pk_fma_f32 v[90:91], v[90:91], v[40:41], v[42:43] op_sel_hi:[1,0,0]
  v_pk_fma_f32 v[92:93], v[92:93], v[40:41], v[42:43] op_sel_hi:[1,0,0]
  v_pk_fma_f32 v[94:95], v[94:95], v[40:41], v[42:43] op_sel_hi:[1,0,0]
  v_cmp_eq_u32 vcc, v44, v45
  s_cbranch_vccnz .fz_kernel_w_pt
.fz_kernel_w_pb:
  s_mov_b64 exec, 1
  s_cmp_lt_u32 s29, 3
  s_cbranch_scc1 .fz_kernel_w_e1
  s_waitcnt vmcnt(16)
  ds_add_u32 v6, v5 offset:0x100
  s_mov_b64 exec, -1
  s_branch .fz_kernel_w_e2
.fz_kernel_w_e1:
  s_waitcnt vmcnt(4)
  ds_add_u32 v6, v5 offset:0x100
  s_mov_b64 exec, -1
  s_andn2_b32 s33, s36, s34
  s_cbranch_scc0 .fz_kernel_pk44c
.fz_kernel_pk44:
  s_ff1_i32_b32 s33, s33
  s_bitset1_b32 s34, s33
  s_lshl_b32 s20, s33, 13
  s_lshl_b32 s33, s33, 12
  s_add_u32 s30, s33, s35
  buffer_load_dwordx4 v[96:99], v3, s[4:7], s30 offen offset:0
  buffer_load_dwordx4 v[100:103], v3, s[4:7], s30 offen offset:1024
  buffer_load_dwordx4 v[104:107], v3, s[4:7], s30 offen offset:2048
  buffer_load_dwordx4 v[108:111], v3, s[4:7], s30 offen offset:3072
  s_andn2_b32 s33, s36, s34
  s_cbranch_scc0 .fz_kernel_pk45c
.fz_kernel_pk45:
  s_ff1_i32_b32 s33, s33
  s_bitset1_b32 s34, s33
  s_lshl_b32 s21, s33, 13
  s_lshl_b32 s33, s33, 12
  s_add_u32 s30, s33, s35
  buffer_load_dwordx4 v[112:115], v3, s[4:7], s30 offen offset:0
  buffer_load_dwordx4 v[116:119], v3, s[4:7], s30 offen offset:1024
  buffer_load_dwordx4 v[120:123], v3, s[4:7], s30 offen offset:2048
  buffer_load_dwordx4 v[124:127], v3, s[4:7], s30 offen offset:3072
  s_andn2_b32 s33, s36, s34
  s_cbranch_scc0 .fz_kernel_pk46c
.fz_kernel_pk46:
  s_ff1_i32_b32 s33, s33
  s_bitset1_b32 s34, s33
  s_lshl_b32 s22, s33, 13
  s_lshl_b32 s33, s33, 12
  s_add_u32 s30, s33, s35
  buffer_load_dwordx4 v[128:131], v3, s[4:7], s30 offen offset:0
  buffer_load_dwordx4 v[132:135], v3, s[4:7], s30 offen offset:1024
  buffer_load_dwordx4 v[136:139], v3, s[4:7], s30 offen offset:2048
  buffer_load_dwordx4 v[140:143], v3, s[4:7], s30 offen offset:3072
.fz_kernel_w_e2:
  v_add_u32 v10, s20, v14
  v_add_u32 v11, s20, v15
  ds_read_b64_tr_b16 v[224:225], v10 offset:0
  ds_read_b64_tr_b16 v[226:227], v10 offset:1024
  ds_read_b64_tr_b16 v[228:229], v11 offset:0
  ds_read_b64_tr_b16 v[230:231], v11 offset:1024
  ds_read_b64_tr_b16 v[232:233], v10 offset:2048
  ds_read_b64_tr_b16 v[234:235], v10 offset:3072
  ds_read_b64_tr_b16 v[236:237], v11 offset:2048
  ds_read_b64_tr_b16 v[238:239], v11 offset:3072
  s_andn2_b32 s33, s36, s34
  s_cbranch_scc0 .fz_kernel_pk47c
.fz_kernel_pk47:
  s_ff1_i32_b32 s33, s33
  s_bitset1_b32 s34, s33
  s_lshl_b32 s23, s33, 13
  s_lshl_b32 s33, s33, 12
  s_add_u32 s30, s33, s35
  s_waitcnt vmcnt(11) lgkmcnt(6)
  v_mfma_f32_32x32x16_bf16 v[64:79], v[224:227], v[96:99], v[64:79]
  v_add_u32 v12, s21, v14
  v_add_u32 v13, s21, v15
  buffer_load_dwordx4 v[144:147], v3, s[4:7], s30 offen offset:0
  ds_read_b64_tr_b16 v[240:241], v10 offset:4096
  s_waitcnt lgkmcnt(5)
  v_mfma_f32_32x32x16_bf16 v[80:95], v[228:231], v[96:99], v[80:95]
  ds_read_b64_tr_b16 v[242:243], v10 offset:5120
  ds_read_b64_tr_b16 v[244:245], v11 offset:4096
  ds_read_b64_tr_b16 v[246:247], v11 offset:5120
  s_waitcnt vmcnt(11) lgkmcnt(6)
  v_mfma_f32_32x32x16_bf16 v[64:79], v[232:235], v[100:103], v[64:79]
  buffer_load_dwordx4 v[148:151], v3, s[4:7], s30 offen offset:1024
  ds_read_b64_tr_b16 v[248:249], v10 offset:6144
  s_waitcnt lgkmcnt(5)
  v_mfma_f32_32x32x16_bf16 v[80:95], v[236:239], v[100:103], v[80:95]
  ds_read_b64_tr_b16 v[250:251], v10 offset:7168
  ds_read_b64_tr_b16 v[252:253], v11 offset:6144
  ds_read_b64_tr_b16 v[254:255], v11 offset:7168
  s_waitcnt vmcnt(11) lgkmcnt(6)
  v_mfma_f32_32x32x16_bf16 v[64:79], v[240:243], v[104:107], v[64:79]
  buffer_load_dwordx4 v[152:155], v3, s[4:7], s30 offen offset:2048
  ds_read_b64_tr_b16 v[224:225], v12 offset:0
  s_waitcnt lgkmcnt(5)
  v_mfma_f32_32x32x16_bf16 v[80:95], v[244:247], v[104:107], v[80:95]
  ds_read_b64_tr_b16 v[226:227], v12 offset:1024
  ds_read_b64_tr_b16 v[228:229], v13 offset:0
  ds_read_b64_tr_b16 v[230:231], v13 offset:1024
  s_waitcnt vmcnt(11) lgkmcnt(6)
  v_mfma_f32_32x32x16_bf16 v[64:79], v[248:251], v[108:111], v[64:79]
  buffer_load_dwordx4 v[156:159], v3, s[4:7], s30 offen offset:3072
  ds_read_b64_tr_b16 v[232:233], v12 offset:2048
  s_waitcnt lgkmcnt(5)
  v_mfma_f32_32x32x16_bf16 v[80:95], v[252:255], v[108:111], v[80:95]
  ds_read_b64_tr_b16 v[234:235], v12 offset:3072
  ds_read_b64_tr_b16 v[236:237], v13 offset:2048
  ds_read_b64_tr_b16 v[238:239], v13 offset:3072
  s_andn2_b32 s33, s36, s34
  s_cbranch_scc0 .fz_kernel_pk48c
.fz_kernel_pk48:
  s_ff1_i32_b32 s33, s33
  s_bitset1_b32 s34, s33
  s_lshl_b32 s24, s33, 13
  s_lshl_b32 s33, s33, 12
  s_add_u32 s30, s33, s35
  s_waitcnt vmcnt(11) lgkmcnt(6)
  v_mfma_f32_32x32x16_bf16 v[64:79], v[224:227], v[112:115], v[64:79]
  v_add_u32 v10, s22, v14
  v_add_u32 v11, s22, v15
  buffer_load_dwordx4 v[160:163], v3, s[4:7], s30 offen offset:0
  ds_read_b64_tr_b16 v[240:241], v12 offset:4096
  s_waitcnt lgkmcnt(5)
  v_mfma_f32_32x32x16_bf16 v[80:95], v[228:231], v[112:115], v[80:95]
  ds_read_b64_tr_b16 v[242:243], v12 offset:5120
  ds_read_b64_tr_b16 v[244:245], v13 offset:4096
  ds_read_b64_tr_b16 v[246:247], v13 offset:5120
  s_waitcnt vmcnt(11) lgkmcnt(6)
  v_mfma_f32_32x32x16_bf16 v[64:79], v[232:235], v[116:119], v[64:79]
  buffer_load_dwordx4 v[164:167], v3, s[4:7], s30 offen offset:1024
  ds_read_b64_tr_b16 v[248:249], v12 offset:6144
  s_waitcnt lgkmcnt(5)
  v_mfma_f32_32x32x16_bf16 v[80:95], v[236:239], v[116:119], v[80:95]
  ds_read_b64_tr_b16 v[250:251], v12 offset:7168
  ds_read_b64_tr_b16 v[252:253], v13 offset:6144
  ds_read_b64_tr_b16 v[254:255], v13 offset:7168
  s_waitcnt vmcnt(11) lgkmcnt(6)
  v_mfma_f32_32x32x16_bf16 v[64:79], v[240:243], v[120:123], v[64:79]
  buffer_load_dwordx4 v[168:171], v3, s[4:7], s30 offen offset:2048
  ds_read_b64_tr_b16 v[224:225], v10 offset:0
  s_waitcnt lgkmcnt(5)
  v_mfma_f32_32x32x16_bf16 v[80:95], v[244:247], v[120:123], v[80:95]
  ds_read_b64_tr_b16 v[226:227], v10 offset:1024
  ds_read_b64_tr_b16 v[228:229], v11 offset:0
  ds_read_b64_tr_b16 v[230:231], v11 offset:1024
  s_waitcnt vmcnt(11) lgkmcnt(6)
  v_mfma_f32_32x32x16_bf16 v[64:79], v[248:251], v[124:127], v[64:79]
  buffer_load_dwordx4 v[172:175], v3, s[4:7], s30 offen offset:3072
  ds_read_b64_tr_b16 v[232:233], v10 offset:2048
  s_waitcnt lgkmcnt(5)
  v_mfma_f32_32x32x16_bf16 v[80:95], v[252:255], v[124:127], v[80:95]
  ds_read_b64_tr_b16 v[234:235], v10 offset:3072
  ds_read_b64_tr_b16 v[236:237], v11 offset:2048
  ds_read_b64_tr_b16 v[238:239], v11 offset:3072
  s_andn2_b32 s33, s36, s34
  s_cbranch_scc0 .fz_kernel_pk49c
.fz_kernel_pk49:
  s_ff1_i32_b32 s33, s33
  s_bitset1_b32 s34, s33
  s_lshl_b32 s25, s33, 13
  s_lshl_b32 s33, s33, 12
  s_add_u32 s30, s33, s35
  s_waitcnt vmcnt(11) lgkmcnt(6)
  v_mfma_f32_32x32x16_bf16 v[64:79], v[224:227], v[128:131], v[64:79]
  v_add_u32 v12, s23, v14
  v_add_u32 v13, s23, v15
  buffer_load_dwordx4 v[176:179], v3, s[4:7], s30 offen offset:0
  ds_read_b64_tr_b16 v[240:241], v10 offset:4096
  s_waitcnt lgkmcnt(5)
  v_mfma_f32_32x32x16_bf16 v[80:95], v[228:231], v[128:131], v[80:95]
  ds_read_b64_tr_b16 v[242:243], v10 offset:5120
  ds_read_b64_tr_b16 v[244:245], v11 offset:4096
  ds_read_b64_tr_b16 v[246:247], v11 offset:5120
  s_waitcnt vmcnt(11) lgkmcnt(6)
  v_mfma_f32_32x32x16_bf16 v[64:79], v[232:235], v[132:135], v[64:79]
  buffer_load_dwordx4 v[180:183], v3, s[4:7], s30 offen offset:1024
  ds_read_b64_tr_b16 v[248:249], v10 offset:6144
  s_waitcnt lgkmcnt(5)
  v_mfma_f32_32x32x16_bf16 v[80:95], v[236:239], v[132:135], v[80:95]
  ds_read_b64_tr_b16 v[250:251], v10 offset:7168
  ds_read_b64_tr_b16 v[252:253], v11 offset:6144
  ds_read_b64_tr_b16 v[254:255], v11 offset:7168
  s_waitcnt vmcnt(11) lgkmcnt(6)
  v_mfma_f32_32x32x16_bf16 v[64:79], v[240:243], v[136:139], v[64:79]
  buffer_load_dwordx4 v[184:187], v3, s[4:7], s30 offen offset:2048
  ds_read_b64_tr_b16 v[224:225], v12 offset:0
  s_waitcnt lgkmcnt(5)
  v_mfma_f32_32x32x16_bf16 v[80:95], v[244:247], v[136:139], v[80:95]
  ds_read_b64_tr_b16 v[226:227], v12 offset:1024
  ds_read_b64_tr_b16 v[228:229], v13 offset:0
  ds_read_b64_tr_b16 v[230:231], v13 offset:1024
  s_waitcnt vmcnt(11) lgkmcnt(6)
  v_mfma_f32_32x32x16_bf16 v[64:79], v[248:251], v[140:143], v[64:79]
  buffer_load_dwordx4 v[188:191], v3, s[4:7], s30 offen offset:3072
  ds_read_b64_tr_b16 v[232:233], v12 offset:2048
  s_waitcnt lgkmcnt(5)
  v_mfma_f32_32x32x16_bf16 v[80:95], v[252:255], v[140:143], v[80:95]
  ds_read_b64_tr_b16 v[234:235], v12 offset:3072
  ds_read_b64_tr_b16 v[236:237], v13 offset:2048
  ds_read_b64_tr_b16 v[238:239], v13 offset:3072
  s_andn2_b32 s33, s36, s34
  s_cbranch_scc0 .fz_kernel_pk50c
.fz_kernel_pk50:
  s_ff1_i32_b32 s33, s33
  s_bitset1_b32 s34, s33
  s_lshl_b32 s26, s33, 13
  s_lshl_b32 s33, s33, 12
  s_add_u32 s30, s33, s35
  s_waitcnt vmcnt(11) lgkmcnt(6)
  v_mfma_f32_32x32x16_bf16 v[64:79], v[224:227], v[144:147], v[64:79]
  v_add_u32 v10, s24, v14
  v_add_u32 v11, s24, v15
  buffer_load_dwordx4 v[192:195], v3, s[4:7], s30 offen offset:0
  ds_read_b64_tr_b16 v[240:241], v12 offset:4096
  s_waitcnt lgkmcnt(5)
  v_mfma_f32_32x32x16_bf16 v[80:95], v[228:231], v[144:147], v[80:95]
  ds_read_b64_tr_b16 v[242:243], v12 offset:5120
  ds_read_b64_tr_b16 v[244:245], v13 offset:4096
  ds_read_b64_tr_b16 v[246:247], v13 offset:5120
  s_waitcnt vmcnt(11) lgkmcnt(6)
  v_mfma_f32_32x32x16_bf16 v[64:79], v[232:235], v[148:151], v[64:79]
  buffer_load_dwordx4 v[196:199], v3, s[4:7], s30 offen offset:1024
  ds_read_b64_tr_b16 v[248:249], v12 offset:6144
  s_waitcnt lgkmcnt(5)
  v_mfma_f32_32x32x16_bf16 v[80:95], v[236:239], v[148:151], v[80:95]
  ds_read_b64_tr_b16 v[250:251], v12 offset:7168
  ds_read_b64_tr_b16 v[252:253], v13 offset:6144
  ds_read_b64_tr_b16 v[254:255], v13 offset:7168
  s_waitcnt vmcnt(11) lgkmcnt(6)
  v_mfma_f32_32x32x16_bf16 v[64:79], v[240:243], v[152:155], v[64:79]
  buffer_load_dwordx4 v[200:203], v3, s[4:7], s30 offen offset:2048
  ds_read_b64_tr_b16 v[224:225], v10 offset:0
  s_waitcnt lgkmcnt(5)
  v_mfma_f32_32x32x16_bf16 v[80:95], v[244:247], v[152:155], v[80:95]
  ds_read_b64_tr_b16 v[226:227], v10 offset:1024
  ds_read_b64_tr_b16 v[228:229], v11 offset:0
  ds_read_b64_tr_b16 v[230:231], v11 offset:1024
  s_waitcnt vmcnt(11) lgkmcnt(6)
  v_mfma_f32_32x32x16_bf16 v[64:79], v[248:251], v[156:159], v[64:79]
  buffer_load_dwordx4 v[204:207], v3, s[4:7], s30 offen offset:3072
  ds_read_b64_tr_b16 v[232:233], v10 offset:2048
  s_waitcnt lgkmcnt(5)
  v_mfma_f32_32x32x16_bf16 v[80:95], v[252:255], v[156:159], v[80:95]
  ds_read_b64_tr_b16 v[234:235], v10 offset:3072
  ds_read_b64_tr_b16 v[236:237], v11 offset:2048
  ds_read_b64_tr_b16 v[238:239], v11 offset:3072
  s_andn2_b32 s33, s36, s34
  s_cbranch_scc0 .fz_kernel_pk51c
.fz_kernel_pk51:
  s_ff1_i32_b32 s33, s33
  s_bitset1_b32 s34, s33
  s_lshl_b32 s27, s33, 13
  s_lshl_b32 s33, s33, 12
  s_add_u32 s30, s33, s35
  s_waitcnt vmcnt(11) lgkmcnt(6)
  v_mfma_f32_32x32x16_bf16 v[64:79], v[224:227], v[160:163], v[64:79]
  v_add_u32 v12, s25, v14
  v_add_u32 v13, s25, v15
  buffer_load_dwordx4 v[208:211], v3, s[4:7], s30 offen offset:0
  ds_read_b64_tr_b16 v[240:241], v10 offset:4096
  s_waitcnt lgkmcnt(5)
  v_mfma_f32_32x32x16_bf16 v[80:95], v[228:231], v[160:163], v[80:95]
  ds_read_b64_tr_b16 v[242:243], v10 offset:5120
  ds_read_b64_tr_b16 v[244:245], v11 offset:4096
  ds_read_b64_tr_b16 v[246:247], v11 offset:5120
  s_waitcnt vmcnt(11) lgkmcnt(6)
  v_mfma_f32_32x32x16_bf16 v[64:79], v[232:235], v[164:167], v[64:79]
  buffer_load_dwordx4 v[212:215], v3, s[4:7], s30 offen offset:1024
  ds_read_b64_tr_b16 v[248:249], v10 offset:6144
  s_waitcnt lgkmcnt(5)
  v_mfma_f32_32x32x16_bf16 v[80:95], v[236:239], v[164:167], v[80:95]
  ds_read_b64_tr_b16 v[250:251], v10 offset:7168
  ds_read_b64_tr_b16 v[252:253], v11 offset:6144
  ds_read_b64_tr_b16 v[254:255], v11 offset:7168
  s_waitcnt vmcnt(11) lgkmcnt(6)
  v_mfma_f32_32x32x16_bf16 v[64:79], v[240:243], v[168:171], v[64:79]
  buffer_load_dwordx4 v[216:219], v3, s[4:7], s30 offen offset:2048
  ds_read_b64_tr_b16 v[224:225], v12 offset:0
  s_waitcnt lgkmcnt(5)
  v_mfma_f32_32x32x16_bf16 v[80:95], v[244:247], v[168:171], v[80:95]
  ds_read_b64_tr_b16 v[226:227], v12 offset:1024
  ds_read_b64_tr_b16 v[228:229], v13 offset:0
  ds_read_b64_tr_b16 v[230:231], v13 offset:1024
  s_waitcnt vmcnt(11) lgkmcnt(6)
  v_mfma_f32_32x32x16_bf16 v[64:79], v[248:251], v[172:175], v[64:79]
  buffer_load_dwordx4 v[220:223], v3, s[4:7], s30 offen offset:3072
  ds_read_b64_tr_b16 v[232:233], v12 offset:2048
  s_waitcnt lgkmcnt(5)
  v_mfma_f32_32x32x16_bf16 v[80:95], v[252:255], v[172:175], v[80:95]
  ds_read_b64_tr_b16 v[234:235], v12 offset:3072
  ds_read_b64_tr_b16 v[236:237], v13 offset:2048
  ds_read_b64_tr_b16 v[238:239], v13 offset:3072
  s_andn2_b32 s33, s36, s34
  s_cbranch_scc0 .fz_kernel_pk52c
.fz_kernel_pk52:
  s_ff1_i32_b32 s33, s33
  s_bitset1_b32 s34, s33
  s_lshl_b32 s20, s33, 13
  s_lshl_b32 s33, s33, 12
  s_add_u32 s30, s33, s35
  s_waitcnt vmcnt(11) lgkmcnt(6)
  v_mfma_f32_32x32x16_bf16 v[64:79], v[224:227], v[176:179], v[64:79]
  v_add_u32 v10, s26, v14
  v_add_u32 v11, s26, v15
  buffer_load_dwordx4 v[96:99], v3, s[4:7], s30 offen offset:0
  ds_read_b64_tr_b16 v[240:241], v12 offset:4096
  s_waitcnt lgkmcnt(5)
  v_mfma_f32_32x32x16_bf16 v[80:95], v[228:231], v[176:179], v[80:95]
  ds_read_b64_tr_b16 v[242:243], v12 offset:5120
  ds_read_b64_tr_b16 v[244:245], v13 offset:4096
  ds_read_b64_tr_b16 v[246:247], v13 offset:5120
  s_waitcnt vmcnt(11) lgkmcnt(6)
  v_mfma_f32_32x32x16_bf16 v[64:79], v[232:235], v[180:183], v[64:79]
  buffer_load_dwordx4 v[100:103], v3, s[4:7], s30 offen offset:1024
  ds_read_b64_tr_b16 v[248:249], v12 offset:6144
  s_waitcnt lgkmcnt(5)
  v_mfma_f32_32x32x16_bf16 v[80:95], v[236:239], v[180:183], v[80:95]
  ds_read_b64_tr_b16 v[250:251], v12 offset:7168
  ds_read_b64_tr_b16 v[252:253], v13 offset:6144
  ds_read_b64_tr_b16 v[254:255], v13 offset:7168
  s_waitcnt vmcnt(11) lgkmcnt(6)
  v_mfma_f32_32x32x16_bf16 v[64:79], v[240:243], v[184:187], v[64:79]
  buffer_load_dwordx4 v[104:107], v3, s[4:7], s30 offen offset:2048
  ds_read_b64_tr_b16 v[224:225], v10 offset:0
  s_waitcnt lgkmcnt(5)
  v_mfma_f32_32x32x16_bf16 v[80:95], v[244:247], v[184:187], v[80:95]
  ds_read_b64_tr_b16 v[226:227], v10 offset:1024
  ds_read_b64_tr_b16 v[228:229], v11 offset:0
  ds_read_b64_tr_b16 v[230:231], v11 offset:1024
  s_waitcnt vmcnt(11) lgkmcnt(6)
  v_mfma_f32_32x32x16_bf16 v[64:79], v[248:251], v[188:191], v[64:79]
  buffer_load_dwordx4 v[108:111], v3, s[4:7], s30 offen offset:3072
  ds_read_b64_tr_b16 v[232:233], v10 offset:2048
  s_waitcnt lgkmcnt(5)
  v_mfma_f32_32x32x16_bf16 v[80:95], v[252:255], v[188:191], v[80:95]
  ds_read_b64_tr_b16 v[234:235], v10 offset:3072
  ds_read_b64_tr_b16 v[236:237], v11 offset:2048
  ds_read_b64_tr_b16 v[238:239], v11 offset:3072
  s_andn2_b32 s33, s36, s34
  s_cbranch_scc0 .fz_kernel_pk53c
.fz_kernel_pk53:
  s_ff1_i32_b32 s33, s33
  s_bitset1_b32 s34, s33
  s_lshl_b32 s21, s33, 13
  s_lshl_b32 s33, s33, 12
  s_add_u32 s30, s33, s35
  s_waitcnt vmcnt(11) lgkmcnt(6)
  v_mfma_f32_32x32x16_bf16 v[64:79], v[224:227], v[192:195], v[64:79]
  v_add_u32 v12, s27, v14
  v_add_u32 v13, s27, v15
  buffer_load_dwordx4 v[112:115], v3, s[4:7], s30 offen offset:0
  ds_read_b64_tr_b16 v[240:241], v10 offset:4096
  s_waitcnt lgkmcnt(5)
  v_mfma_f32_32x32x16_bf16 v[80:95], v[228:231], v[192:195], v[80:95]
  ds_read_b64_tr_b16 v[242:243], v10 offset:5120
  ds_read_b64_tr_b16 v[244:245], v11 offset:4096
  ds_read_b64_tr_b16 v[246:247], v11 offset:5120
  s_waitcnt vmcnt(11) lgkmcnt(6)
  v_mfma_f32_32x32x16_bf16 v[64:79], v[232:235], v[196:199], v[64:79]
  buffer_load_dwordx4 v[116:119], v3, s[4:7], s30 offen offset:1024
  ds_read_b64_tr_b16 v[248:249], v10 offset:6144
  s_waitcnt lgkmcnt(5)
  v_mfma_f32_32x32x16_bf16 v[80:95], v[236:239], v[196:199], v[80:95]
  ds_read_b64_tr_b16 v[250:251], v10 offset:7168
  ds_read_b64_tr_b16 v[252:253], v11 offset:6144
  ds_read_b64_tr_b16 v[254:255], v11 offset:7168
  s_waitcnt vmcnt(11) lgkmcnt(6)
  v_mfma_f32_32x32x16_bf16 v[64:79], v[240:243], v[200:203], v[64:79]
  buffer_load_dwordx4 v[120:123], v3, s[4:7], s30 offen offset:2048
  ds_read_b64_tr_b16 v[224:225], v12 offset:0
  s_waitcnt lgkmcnt(5)
  v_mfma_f32_32x32x16_bf16 v[80:95], v[244:247], v[200:203], v[80:95]
  ds_read_b64_tr_b16 v[226:227], v12 offset:1024
  ds_read_b64_tr_b16 v[228:229], v13 offset:0
  ds_read_b64_tr_b16 v[230:231], v13 offset:1024
  s_waitcnt vmcnt(11) lgkmcnt(6)
  v_mfma_f32_32x32x16_bf16 v[64:79], v[248:251], v[204:207], v[64:79]
  buffer_load_dwordx4 v[124:127], v3, s[4:7], s30 offen offset:3072
  ds_read_b64_tr_b16 v[232:233], v12 offset:2048
  s_waitcnt lgkmcnt(5)
  v_mfma_f32_32x32x16_bf16 v[80:95], v[252:255], v[204:207], v[80:95]
  ds_read_b64_tr_b16 v[234:235], v12 offset:3072
  ds_read_b64_tr_b16 v[236:237], v13 offset:2048
  ds_read_b64_tr_b16 v[238:239], v13 offset:3072
  s_andn2_b32 s33, s36, s34
  s_cbranch_scc0 .fz_kernel_pk54c
.fz_kernel_pk54:
  s_ff1_i32_b32 s33, s33
  s_bitset1_b32 s34, s33
  s_lshl_b32 s22, s33, 13
  s_lshl_b32 s33, s33, 12
  s_add_u32 s30, s33, s35
  s_waitcnt vmcnt(11) lgkmcnt(6)
  v_mfma_f32_32x32x16_bf16 v[64:79], v[224:227], v[208:211], v[64:79]
  v_add_u32 v10, s20, v14
  v_add_u32 v11, s20, v15
  buffer_load_dwordx4 v[128:131], v3, s[4:7], s30 offen offset:0
  ds_read_b64_tr_b16 v[240:241], v12 offset:4096
  s_waitcnt lgkmcnt(5)
  v_mfma_f32_32x32x16_bf16 v[80:95], v[228:231], v[208:211], v[80:95]
  ds_read_b64_tr_b16 v[242:243], v12 offset:5120
  ds_read_b64_tr_b16 v[244:245], v13 offset:4096
  ds_read_b64_tr_b16 v[246:247], v13 offset:5120
  s_waitcnt vmcnt(11) lgkmcnt(6)
  v_mfma_f32_32x32x16_bf16 v[64:79], v[232:235], v[212:215], v[64:79]
  buffer_load_dwordx4 v[132:135], v3, s[4:7], s30 offen offset:1024
  ds_read_b64_tr_b16 v[248:249], v12 offset:6144
  s_waitcnt lgkmcnt(5)
  v_mfma_f32_32x32x16_bf16 v[80:95], v[236:239], v[212:215], v[80:95]
  ds_read_b64_tr_b16 v[250:251], v12 offset:7168
  ds_read_b64_tr_b16 v[252:253], v13 offset:6144
  ds_read_b64_tr_b16 v[254:255], v13 offset:7168
  s_waitcnt vmcnt(11) lgkmcnt(6)
  v_mfma_f32_32x32x16_bf16 v[64:79], v[240:243], v[216:219], v[64:79]
  buffer_load_dwordx4 v[136:139], v3, s[4:7], s30 offen offset:2048
  ds_read_b64_tr_b16 v[224:225], v10 offset:0
  s_waitcnt lgkmcnt(5)
  v_mfma_f32_32x32x16_bf16 v[80:95], v[244:247], v[216:219], v[80:95]
  ds_read_b64_tr_b16 v[226:227], v10 offset:1024
  ds_read_b64_tr_b16 v[228:229], v11 offset:0
  ds_read_b64_tr_b16 v[230:231], v11 offset:1024
  s_waitcnt vmcnt(11) lgkmcnt(6)
  v_mfma_f32_32x32x16_bf16 v[64:79], v[248:251], v[220:223], v[64:79]
  buffer_load_dwordx4 v[140:143], v3, s[4:7], s30 offen offset:3072
  ds_read_b64_tr_b16 v[232:233], v10 offset:2048
  s_waitcnt lgkmcnt(5)
  v_mfma_f32_32x32x16_bf16 v[80:95], v[252:255], v[220:223], v[80:95]
  ds_read_b64_tr_b16 v[234:235], v10 offset:3072
  ds_read_b64_tr_b16 v[236:237], v11 offset:2048
  ds_read_b64_tr_b16 v[238:239], v11 offset:3072
  s_andn2_b32 s33, s36, s34
  s_cbranch_scc0 .fz_kernel_pk55c
.fz_kernel_pk55:
  s_ff1_i32_b32 s33, s33
  s_bitset1_b32 s34, s33
  s_lshl_b32 s23, s33, 13
  s_lshl_b32 s33, s33, 12
  s_add_u32 s30, s33, s35
  s_waitcnt vmcnt(11) lgkmcnt(6)
  v_mfma_f32_32x32x16_bf16 v[64:79], v[224:227], v[96:99], v[64:79]
  v_add_u32 v12, s21, v14
  v_add_u32 v13, s21, v15
  buffer_load_dwordx4 v[144:147], v3, s[4:7], s30 offen offset:0
  ds_read_b64_tr_b16 v[240:241], v10 offset:4096
  s_waitcnt lgkmcnt(5)
  v_mfma_f32_32x32x16_bf16 v[80:95], v[228:231], v[96:99], v[80:95]
  ds_read_b64_tr_b16 v[242:243], v10 offset:5120
  ds_read_b64_tr_b16 v[244:245], v11 offset:4096
  ds_read_b64_tr_b16 v[246:247], v11 offset:5120
  s_waitcnt vmcnt(11) lgkmcnt(6)
  v_mfma_f32_32x32x16_bf16 v[64:79], v[232:235], v[100:103], v[64:79]
  buffer_load_dwordx4 v[148:151], v3, s[4:7], s30 offen offset:1024
  ds_read_b64_tr_b16 v[248:249], v10 offset:6144
  s_waitcnt lgkmcnt(5)
  v_mfma_f32_32x32x16_bf16 v[80:95], v[236:239], v[100:103], v[80:95]
  ds_read_b64_tr_b16 v[250:251], v10 offset:7168
  ds_read_b64_tr_b16 v[252:253], v11 offset:6144
  ds_read_b64_tr_b16 v[254:255], v11 offset:7168
  s_waitcnt vmcnt(11) lgkmcnt(6)
  v_mfma_f32_32x32x16_bf16 v[64:79], v[240:243], v[104:107], v[64:79]
  buffer_load_dwordx4 v[152:155], v3, s[4:7], s30 offen offset:2048
  ds_read_b64_tr_b16 v[224:225], v12 offset:0
  s_waitcnt lgkmcnt(5)
  v_mfma_f32_32x32x16_bf16 v[80:95], v[244:247], v[104:107], v[80:95]
  ds_read_b64_tr_b16 v[226:227], v12 offset:1024
  ds_read_b64_tr_b16 v[228:229], v13 offset:0
  ds_read_b64_tr_b16 v[230:231], v13 offset:1024
  s_waitcnt vmcnt(11) lgkmcnt(6)
  v_mfma_f32_32x32x16_bf16 v[64:79], v[248:251], v[108:111], v[64:79]
  buffer_load_dwordx4 v[156:159], v3, s[4:7], s30 offen offset:3072
  ds_read_b64_tr_b16 v[232:233], v12 offset:2048
  s_waitcnt lgkmcnt(5)
  v_mfma_f32_32x32x16_bf16 v[80:95], v[252:255], v[108:111], v[80:95]
  ds_read_b64_tr_b16 v[234:235], v12 offset:3072
  ds_read_b64_tr_b16 v[236:237], v13 offset:2048
  ds_read_b64_tr_b16 v[238:239], v13 offset:3072
  s_andn2_b32 s33, s36, s34
  s_cbranch_scc0 .fz_kernel_pk56c
.fz_kernel_pk56:
  s_ff1_i32_b32 s33, s33
  s_bitset1_b32 s34, s33
  s_lshl_b32 s24, s33, 13
  s_lshl_b32 s33, s33, 12
  s_add_u32 s30, s33, s35
  s_waitcnt vmcnt(11) lgkmcnt(6)
  v_mfma_f32_32x32x16_bf16 v[64:79], v[224:227], v[112:115], v[64:79]
  v_add_u32 v10, s22, v14
  v_add_u32 v11, s22, v15
  buffer_load_dwordx4 v[160:163], v3, s[4:7], s30 offen offset:0
  ds_read_b64_tr_b16 v[240:241], v12 offset:4096
  s_waitcnt lgkmcnt(5)
  v_mfma_f32_32x32x16_bf16 v[80:95], v[228:231], v[112:115], v[80:95]
  ds_read_b64_tr_b16 v[242:243], v12 offset:5120
  ds_read_b64_tr_b16 v[244:245], v13 offset:4096
  ds_read_b64_tr_b16 v[246:247], v13 offset:5120
  s_waitcnt vmcnt(11) lgkmcnt(6)
  v_mfma_f32_32x32x16_bf16 v[64:79], v[232:235], v[116:119], v[64:79]
  buffer_load_dwordx4 v[164:167], v3, s[4:7], s30 offen offset:1024
  ds_read_b64_tr_b16 v[248:249], v12 offset:6144
  s_waitcnt lgkmcnt(5)
  v_mfma_f32_32x32x16_bf16 v[80:95], v[236:239], v[116:119], v[80:95]
  ds_read_b64_tr_b16 v[250:251], v12 offset:7168
  ds_read_b64_tr_b16 v[252:253], v13 offset:6144
  ds_read_b64_tr_b16 v[254:255], v13 offset:7168
  s_waitcnt vmcnt(11) lgkmcnt(6)
  v_mfma_f32_32x32x16_bf16 v[64:79], v[240:243], v[120:123], v[64:79]
  buffer_load_dwordx4 v[168:171], v3, s[4:7], s30 offen offset:2048
  ds_read_b64_tr_b16 v[224:225], v10 offset:0
  s_waitcnt lgkmcnt(5)
  v_mfma_f32_32x32x16_bf16 v[80:95], v[244:247], v[120:123], v[80:95]
  ds_read_b64_tr_b16 v[226:227], v10 offset:1024
  ds_read_b64_tr_b16 v[228:229], v11 offset:0
  ds_read_b64_tr_b16 v[230:231], v11 offset:1024
  s_waitcnt vmcnt(11) lgkmcnt(6)
  v_mfma_f32_32x32x16_bf16 v[64:79], v[248:251], v[124:127], v[64:79]
  buffer_load_dwordx4 v[172:175], v3, s[4:7], s30 offen offset:3072
  ds_read_b64_tr_b16 v[232:233], v10 offset:2048
  s_waitcnt lgkmcnt(5)
  v_mfma_f32_32x32x16_bf16 v[80:95], v[252:255], v[124:127], v[80:95]
  ds_read_b64_tr_b16 v[234:235], v10 offset:3072
  ds_read_b64_tr_b16 v[236:237], v11 offset:2048
  ds_read_b64_tr_b16 v[238:239], v11 offset:3072
  s_andn2_b32 s33, s36, s34
  s_cbranch_scc0 .fz_kernel_pk57c
.fz_kernel_pk57:
  s_ff1_i32_b32 s33, s33
  s_bitset1_b32 s34, s33
  s_lshl_b32 s25, s33, 13
  s_lshl_b32 s33, s33, 12
  s_add_u32 s30, s33, s35
  s_waitcnt vmcnt(11) lgkmcnt(6)
  v_mfma_f32_32x32x16_bf16 v[64:79], v[224:227], v[128:131], v[64:79]
  v_add_u32 v12, s23, v14
  v_add_u32 v13, s23, v15
  buffer_load_dwordx4 v[176:179], v3, s[4:7], s30 offen offset:0
  ds_read_b64_tr_b16 v[240:241], v10 offset:4096
  s_waitcnt lgkmcnt(5)
  v_mfma_f32_32x32x16_bf16 v[80:95], v[228:231], v[128:131], v[80:95]
  ds_read_b64_tr_b16 v[242:243], v10 offset:5120
  ds_read_b64_tr_b16 v[244:245], v11 offset:4096
  ds_read_b64_tr_b16 v[246:247], v11 offset:5120
  s_waitcnt vmcnt(11) lgkmcnt(6)
  v_mfma_f32_32x32x16_bf16 v[64:79], v[232:235], v[132:135], v[64:79]
  buffer_load_dwordx4 v[180:183], v3, s[4:7], s30 offen offset:1024
  ds_read_b64_tr_b16 v[248:249], v10 offset:6144
  s_waitcnt lgkmcnt(5)
  v_mfma_f32_32x32x16_bf16 v[80:95], v[236:239], v[132:135], v[80:95]
  ds_read_b64_tr_b16 v[250:251], v10 offset:7168
  ds_read_b64_tr_b16 v[252:253], v11 offset:6144
  ds_read_b64_tr_b16 v[254:255], v11 offset:7168
  s_waitcnt vmcnt(11) lgkmcnt(6)
  v_mfma_f32_32x32x16_bf16 v[64:79], v[240:243], v[136:139], v[64:79]
  buffer_load_dwordx4 v[184:187], v3, s[4:7], s30 offen offset:2048
  ds_read_b64_tr_b16 v[224:225], v12 offset:0
  s_waitcnt lgkmcnt(5)
  v_mfma_f32_32x32x16_bf16 v[80:95], v[244:247], v[136:139], v[80:95]
  ds_read_b64_tr_b16 v[226:227], v12 offset:1024
  ds_read_b64_tr_b16 v[228:229], v13 offset:0
  ds_read_b64_tr_b16 v[230:231], v13 offset:1024
  s_waitcnt vmcnt(11) lgkmcnt(6)
  v_mfma_f32_32x32x16_bf16 v[64:79], v[248:251], v[140:143], v[64:79]
  buffer_load_dwordx4 v[188:191], v3, s[4:7], s30 offen offset:3072
  ds_read_b64_tr_b16 v[232:233], v12 offset:2048
  s_waitcnt lgkmcnt(5)
  v_mfma_f32_32x32x16_bf16 v[80:95], v[252:255], v[140:143], v[80:95]
  ds_read_b64_tr_b16 v[234:235], v12 offset:3072
  ds_read_b64_tr_b16 v[236:237], v13 offset:2048
  ds_read_b64_tr_b16 v[238:239], v13 offset:3072
  s_andn2_b32 s33, s36, s34
  s_cbranch_scc0 .fz_kernel_pk58c
.fz_kernel_pk58:
  s_ff1_i32_b32 s33, s33
  s_bitset1_b32 s34, s33
  s_lshl_b32 s26, s33, 13
  s_lshl_b32 s33, s33, 12
  s_add_u32 s30, s33, s35
  s_waitcnt vmcnt(11) lgkmcnt(6)
  v_mfma_f32_32x32x16_bf16 v[64:79], v[224:227], v[144:147], v[64:79]
  v_add_u32 v10, s24, v14
  v_add_u32 v11, s24, v15
  buffer_load_dwordx4 v[192:195], v3, s[4:7], s30 offen offset:0
  ds_read_b64_tr_b16 v[240:241], v12 offset:4096
  s_waitcnt lgkmcnt(5)
  v_mfma_f32_32x32x16_bf16 v[80:95], v[228:231], v[144:147], v[80:95]
  ds_read_b64_tr_b16 v[242:243], v12 offset:5120
  ds_read_b64_tr_b16 v[244:245], v13 offset:4096
  ds_read_b64_tr_b16 v[246:247], v13 offset:5120
  s_waitcnt vmcnt(11) lgkmcnt(6)
  v_mfma_f32_32x32x16_bf16 v[64:79], v[232:235], v[148:151], v[64:79]
  buffer_load_dwordx4 v[196:199], v3, s[4:7], s30 offen offset:1024
  ds_read_b64_tr_b16 v[248:249], v12 offset:6144
  s_waitcnt lgkmcnt(5)
  v_mfma_f32_32x32x16_bf16 v[80:95], v[236:239], v[148:151], v[80:95]
  ds_read_b64_tr_b16 v[250:251], v12 offset:7168
  ds_read_b64_tr_b16 v[252:253], v13 offset:6144
  ds_read_b64_tr_b16 v[254:255], v13 offset:7168
  s_waitcnt vmcnt(11) lgkmcnt(6)
  v_mfma_f32_32x32x16_bf16 v[64:79], v[240:243], v[152:155], v[64:79]
  buffer_load_dwordx4 v[200:203], v3, s[4:7], s30 offen offset:2048
  ds_read_b64_tr_b16 v[224:225], v10 offset:0
  s_waitcnt lgkmcnt(5)
  v_mfma_f32_32x32x16_bf16 v[80:95], v[244:247], v[152:155], v[80:95]
  ds_read_b64_tr_b16 v[226:227], v10 offset:1024
  ds_read_b64_tr_b16 v[228:229], v11 offset:0
  ds_read_b64_tr_b16 v[230:231], v11 offset:1024
  s_waitcnt vmcnt(11) lgkmcnt(6)
  v_mfma_f32_32x32x16_bf16 v[64:79], v[248:251], v[156:159], v[64:79]
  buffer_load_dwordx4 v[204:207], v3, s[4:7], s30 offen offset:3072
  ds_read_b64_tr_b16 v[232:233], v10 offset:2048
  s_waitcnt lgkmcnt(5)
  v_mfma_f32_32x32x16_bf16 v[80:95], v[252:255], v[156:159], v[80:95]
  ds_read_b64_tr_b16 v[234:235], v10 offset:3072
  ds_read_b64_tr_b16 v[236:237], v11 offset:2048
  ds_read_b64_tr_b16 v[238:239], v11 offset:3072
  s_andn2_b32 s33, s36, s34
  s_cbranch_scc0 .fz_kernel_pk59c
.fz_kernel_pk59:
  s_ff1_i32_b32 s33, s33
  s_bitset1_b32 s34, s33
  s_lshl_b32 s27, s33, 13
  s_lshl_b32 s33, s33, 12
  s_add_u32 s30, s33, s35
  s_waitcnt vmcnt(11) lgkmcnt(6)
  v_mfma_f32_32x32x16_bf16 v[64:79], v[224:227], v[160:163], v[64:79]
  v_add_u32 v12, s25, v14
  v_add_u32 v13, s25, v15
  buffer_load_dwordx4 v[208:211], v3, s[4:7], s30 offen offset:0
  ds_read_b64_tr_b16 v[240:241], v10 offset:4096
  s_waitcnt lgkmcnt(5)
  v_mfma_f32_32x32x16_bf16 v[80:95], v[228:231], v[160:163], v[80:95]
  ds_read_b64_tr_b16 v[242:243], v10 offset:5120
  ds_read_b64_tr_b16 v[244:245], v11 offset:4096
  ds_read_b64_tr_b16 v[246:247], v11 offset:5120
  s_waitcnt vmcnt(11) lgkmcnt(6)
  v_mfma_f32_32x32x16_bf16 v[64:79], v[232:235], v[164:167], v[64:79]
  buffer_load_dwordx4 v[212:215], v3, s[4:7], s30 offen offset:1024
  ds_read_b64_tr_b16 v[248:249], v10 offset:6144
  s_waitcnt lgkmcnt(5)
  v_mfma_f32_32x32x16_bf16 v[80:95], v[236:239], v[164:167], v[80:95]
  ds_read_b64_tr_b16 v[250:251], v10 offset:7168
  ds_read_b64_tr_b16 v[252:253], v11 offset:6144
  ds_read_b64_tr_b16 v[254:255], v11 offset:7168
  s_waitcnt vmcnt(11) lgkmcnt(6)
  v_mfma_f32_32x32x16_bf16 v[64:79], v[240:243], v[168:171], v[64:79]
  buffer_load_dwordx4 v[216:219], v3, s[4:7], s30 offen offset:2048
  ds_read_b64_tr_b16 v[224:225], v12 offset:0
  s_waitcnt lgkmcnt(5)
  v_mfma_f32_32x32x16_bf16 v[80:95], v[244:247], v[168:171], v[80:95]
  ds_read_b64_tr_b16 v[226:227], v12 offset:1024
  ds_read_b64_tr_b16 v[228:229], v13 offset:0
  ds_read_b64_tr_b16 v[230:231], v13 offset:1024
  s_waitcnt vmcnt(11) lgkmcnt(6)
  v_mfma_f32_32x32x16_bf16 v[64:79], v[248:251], v[172:175], v[64:79]
  buffer_load_dwordx4 v[220:223], v3, s[4:7], s30 offen offset:3072
  ds_read_b64_tr_b16 v[232:233], v12 offset:2048
  s_waitcnt lgkmcnt(5)
  v_mfma_f32_32x32x16_bf16 v[80:95], v[252:255], v[172:175], v[80:95]
  ds_read_b64_tr_b16 v[234:235], v12 offset:3072
  ds_read_b64_tr_b16 v[236:237], v13 offset:2048
  ds_read_b64_tr_b16 v[238:239], v13 offset:3072
  s_waitcnt vmcnt(11) lgkmcnt(6)
  v_mfma_f32_32x32x16_bf16 v[64:79], v[224:227], v[176:179], v[64:79]
  v_add_u32 v10, s26, v14
  v_add_u32 v11, s26, v15
  ds_read_b64_tr_b16 v[240:241], v12 offset:4096
  s_waitcnt lgkmcnt(5)
  v_mfma_f32_32x32x16_bf16 v[80:95], v[228:231], v[176:179], v[80:95]
  ds_read_b64_tr_b16 v[242:243], v12 offset:5120
  ds_read_b64_tr_b16 v[244:245], v13 offset:4096
  ds_read_b64_tr_b16 v[246:247], v13 offset:5120
  s_waitcnt vmcnt(10) lgkmcnt(6)
  v_mfma_f32_32x32x16_bf16 v[64:79], v[232:235], v[180:183], v[64:79]
  ds_read_b64_tr_b16 v[248:249], v12 offset:6144
  s_waitcnt lgkmcnt(5)
  v_mfma_f32_32x32x16_bf16 v[80:95], v[236:239], v[180:183], v[80:95]
  ds_read_b64_tr_b16 v[250:251], v12 offset:7168
  ds_read_b64_tr_b16 v[252:253], v13 offset:6144
  ds_read_b64_tr_b16 v[254:255], v13 offset:7168
  s_waitcnt vmcnt(9) lgkmcnt(6)
  v_mfma_f32_32x32x16_bf16 v[64:79], v[240:243], v[184:187], v[64:79]
  ds_read_b64_tr_b16 v[224:225], v10 offset:0
  s_waitcnt lgkmcnt(5)
  v_mfma_f32_32x32x16_bf16 v[80:95], v[244:247], v[184:187], v[80:95]
  ds_read_b64_tr_b16 v[226:227], v10 offset:1024
  ds_read_b64_tr_b16 v[228:229], v11 offset:0
  ds_read_b64_tr_b16 v[230:231], v11 offset:1024
  s_waitcnt vmcnt(8) lgkmcnt(6)
  v_mfma_f32_32x32x16_bf16 v[64:79], v[248:251], v[188:191], v[64:79]
  ds_read_b64_tr_b16 v[232:233], v10 offset:2048
  s_waitcnt lgkmcnt(5)
  v_mfma_f32_32x32x16_bf16 v[80:95], v[252:255], v[188:191], v[80:95]
  ds_read_b64_tr_b16 v[234:235], v10 offset:3072
  ds_read_b64_tr_b16 v[236:237], v11 offset:2048
  ds_read_b64_tr_b16 v[238:239], v11 offset:3072
  s_waitcnt vmcnt(7) lgkmcnt(6)
  v_mfma_f32_32x32x16_bf16 v[64:79], v[224:227], v[192:195], v[64:79]
  v_add_u32 v12, s27, v14
  v_add_u32 v13, s27, v15
  ds_read_b64_tr_b16 v[240:241], v10 offset:4096
  s_waitcnt lgkmcnt(5)
  v_mfma_f32_32x32x16_bf16 v[80:95], v[228:231], v[192:195], v[80:95]
  ds_read_b64_tr_b16 v[242:243], v10 offset:5120
  ds_read_b64_tr_b16 v[244:245], v11 offset:4096
  ds_read_b64_tr_b16 v[246:247], v11 offset:5120
  s_waitcnt vmcnt(6) lgkmcnt(6)
  v_mfma_f32_32x32x16_bf16 v[64:79], v[232:235], v[196:199], v[64:79]
  ds_read_b64_tr_b16 v[248:249], v10 offset:6144
  s_waitcnt lgkmcnt(5)
  v_mfma_f32_32x32x16_bf16 v[80:95], v[236:239], v[196:199], v[80:95]
  ds_read_b64_tr_b16 v[250:251], v10 offset:7168
  ds_read_b64_tr_b16 v[252:253], v11 offset:6144
  ds_read_b64_tr_b16 v[254:255], v11 offset:7168
  s_waitcnt vmcnt(5) lgkmcnt(6)
  v_mfma_f32_32x32x16_bf16 v[64:79], v[240:243], v[200:203], v[64:79]
  ds_read_b64_tr_b16 v[224:225], v12 offset:0
  s_waitcnt lgkmcnt(5)
  v_mfma_f32_32x32x16_bf16 v[80:95], v[244:247], v[200:203], v[80:95]
  ds_read_b64_tr_b16 v[226:227], v12 offset:1024
  ds_read_b64_tr_b16 v[228:229], v13 offset:0
  ds_read_b64_tr_b16 v[230:231], v13 offset:1024
  s_waitcnt vmcnt(4) lgkmcnt(6)
  v_mfma_f32_32x32x16_bf16 v[64:79], v[248:251], v[204:207], v[64:79]
  ds_read_b64_tr_b16 v[232:233], v12 offset:2048
  s_waitcnt lgkmcnt(5)
  v_mfma_f32_32x32x16_bf16 v[80:95], v[252:255], v[204:207], v[80:95]
  ds_read_b64_tr_b16 v[234:235], v12 offset:3072
  ds_read_b64_tr_b16 v[236:237], v13 offset:2048
  ds_read_b64_tr_b16 v[238:239], v13 offset:3072
  s_waitcnt vmcnt(3) lgkmcnt(6)
  v_mfma_f32_32x32x16_bf16 v[64:79], v[224:227], v[208:211], v[64:79]
  ds_read_b64_tr_b16 v[240:241], v12 offset:4096
  s_waitcnt lgkmcnt(5)
  v_mfma_f32_32x32x16_bf16 v[80:95], v[228:231], v[208:211], v[80:95]
  ds_read_b64_tr_b16 v[242:243], v12 offset:5120
  ds_read_b64_tr_b16 v[244:245], v13 offset:4096
  ds_read_b64_tr_b16 v[246:247], v13 offset:5120
  s_waitcnt vmcnt(2) lgkmcnt(6)
  v_mfma_f32_32x32x16_bf16 v[64:79], v[232:235], v[212:215], v[64:79]
  ds_read_b64_tr_b16 v[248:249], v12 offset:6144
  s_waitcnt lgkmcnt(5)
  v_mfma_f32_32x32x16_bf16 v[80:95], v[236:239], v[212:215], v[80:95]
  ds_read_b64_tr_b16 v[250:251], v12 offset:7168
  ds_read_b64_tr_b16 v[252:253], v13 offset:6144
  ds_read_b64_tr_b16 v[254:255], v13 offset:7168
  s_waitcnt vmcnt(1) lgkmcnt(6)
  v_mfma_f32_32x32x16_bf16 v[64:79], v[240:243], v[216:219], v[64:79]
  s_waitcnt lgkmcnt(4)
  v_mfma_f32_32x32x16_bf16 v[80:95], v[244:247], v[216:219], v[80:95]
  s_waitcnt vmcnt(0) lgkmcnt(0)
  v_mfma_f32_32x32x16_bf16 v[64:79], v[248:251], v[220:223], v[64:79]
  v_mfma_f32_32x32x16_bf16 v[80:95], v[252:255], v[220:223], v[80:95]
  s_mov_b32 s36, 0x3f803f80
  v_mov_b32 v8, 0
  v_mov_b32 v9, 0
  v_mov_b32 v10, 0
  v_mov_b32 v11, 0
  v_mov_b32 v12, 0
  v_mov_b32 v13, 0
  v_lshlrev_b32 v19, 2, v18
  v_lshl_add_u32 v19, v17, 13, v19
  s_lshl_b32 s34, s32, 7
  s_add_u32 s34, s34, s66
  s_add_u32 s34, s34, 16384
  s_add_u32 s37, s34, 16384
  v_cvt_pk_bf16_f32 v20, v64, v65
  v_cvt_pk_bf16_f32 v21, v66, v67
  v_cvt_pk_bf16_f32 v22, v68, v69
  v_cvt_pk_bf16_f32 v23, v70, v71
  buffer_store_dwordx4 v[20:23], v16, s[4:7], s39 offen offset:0 sc1
  v_cvt_pk_bf16_f32 v24, v72, v73
  v_cvt_pk_bf16_f32 v25, v74, v75
  v_cvt_pk_bf16_f32 v26, v76, v77
  v_cvt_pk_bf16_f32 v27, v78, v79
  buffer_store_dwordx4 v[24:27], v16, s[4:7], s39 offen offset:512 sc1
  v_cvt_pk_bf16_f32 v28, v80, v81
  v_cvt_pk_bf16_f32 v29, v82, v83
  v_cvt_pk_bf16_f32 v30, v84, v85
  v_cvt_pk_bf16_f32 v31, v86, v87
  buffer_store_dwordx4 v[28:31], v16, s[4:7], s39 offen offset:1024 sc1
  v_cvt_pk_bf16_f32 v32, v88, v89
  v_cvt_pk_bf16_f32 v33, v90, v91
  v_cvt_pk_bf16_f32 v34, v92, v93
  v_cvt_pk_bf16_f32 v35, v94, v95
  buffer_store_dwordx4 v[32:35], v16, s[4:7], s39 offen offset:1536 sc1
  v_dot2c_f32_bf16 v8, s36, v20
  v_dot2c_f32_bf16 v9, v20, v20
  v_dot2c_f32_bf16 v10, v20, v48
  v_dot2c_f32_bf16 v11, s36, v21
  v_dot2c_f32_bf16 v12, v21, v21
  v_dot2c_f32_bf16 v13, v21, v49
  v_dot2c_f32_bf16 v8, s36, v22
  v_dot2c_f32_bf16 v9, v22, v22
  v_dot2c_f32_bf16 v10, v22, v50
  v_dot2c_f32_bf16 v11, s36, v23
  v_dot2c_f32_bf16 v12, v23, v23
  v_dot2c_f32_bf16 v13, v23, v51
  v_dot2c_f32_bf16 v8, s36, v24
  v_dot2c_f32_bf16 v9, v24, v24
  v_dot2c_f32_bf16 v10, v24, v52
  v_dot2c_f32_bf16 v11, s36, v25
  v_dot2c_f32_bf16 v12, v25, v25
  v_dot2c_f32_bf16 v13, v25, v53
  v_dot2c_f32_bf16 v8, s36, v26
  v_dot2c_f32_bf16 v9, v26, v26
  v_dot2c_f32_bf16 v10, v26, v54
  v_dot2c_f32_bf16 v11, s36, v27
  v_dot2c_f32_bf16 v12, v27, v27
  v_dot2c_f32_bf16 v13, v27, v55
  v_dot2c_f32_bf16 v8, s36, v28
  v_dot2c_f32_bf16 v9, v28, v28
  v_dot2c_f32_bf16 v10, v28, v56
  v_dot2c_f32_bf16 v11, s36, v29
  v_dot2c_f32_bf16 v12, v29, v29
  v_dot2c_f32_bf16 v13, v29, v57
  v_dot2c_f32_bf16 v8, s36, v30
  v_dot2c_f32_bf16 v9, v30, v30
  v_dot2c_f32_bf16 v10, v30, v58
  v_dot2c_f32_bf16 v11, s36, v31
  v_dot2c_f32_bf16 v12, v31, v31
  v_dot2c_f32_bf16 v13, v31, v59
  v_dot2c_f32_bf16 v8, s36, v32
  v_dot2c_f32_bf16 v9, v32, v32
  v_dot2c_f32_bf16 v10, v32, v60
  v_dot2c_f32_bf16 v11, s36, v33
  v_dot2c_f32_bf16 v12, v33, v33
  v_dot2c_f32_bf16 v13, v33, v61
  v_dot2c_f32_bf16 v8, s36, v34
  v_dot2c_f32_bf16 v9, v34, v34
  v_dot2c_f32_bf16 v10, v34, v62
  v_dot2c_f32_bf16 v11, s36, v35
  v_dot2c_f32_bf16 v12, v35, v35
  v_dot2c_f32_bf16 v13, v35, v63
  s_nop 0
  v_add_f32 v36, v8, v11
  v_add_f32 v37, v9, v12
  v_add_f32 v38, v10, v13
  v_fma_f32 v38, -v36, v46, v38
  v_fmac_f32 v47, 0x44800000, v37
  v_mov_b32 v39, v38
  s_nop 0
  v_permlane32_swap_b32 v36, v47
  v_permlane32_swap_b32 v38, v39
  v_add_f32 v36, v36, v47
  v_add_f32 v38, v38, v39
  buffer_atomic_add_f32 v36, v19, s[4:7], s34 offen sc1
  s_mov_b32 exec_hi, 0
  buffer_atomic_add_f32 v38, v19, s[4:7], s37 offen sc1
  s_mov_b64 exec, -1
  s_barrier
  v_add_u32 v1, 4, v6
  s_mov_b32 s72, s66
  s_mov_b32 s73, s65
  s_mov_b32 s74, s67
  s_mov_b32 s75, s62
  s_cmp_lg_u32 s62, 0
  s_cbranch_scc1 .fz_kernel_tail
  s_mov_b32 s62, 1
  s_mov_b32 s63, 0x2000000
  s_mov_b32 s64, 0x2800000
  s_mov_b32 s65, 0x1400000
  s_mov_b32 s66, 0x1c42000
  s_mov_b32 s67, 12
  s_mov_b32 s71, 159776
  v_mov_b32 v6, 159832
  s_branch .fz_kernel_q_cons2
.fz_kernel_tail:
  s_mov_b32 s28, s56
  s_mov_b32 s29, s57
  s_mov_b32 s30, 0x400000
  s_mov_b32 s31, 0x00020000
  v_lshlrev_b32 v37, 2, v45
  v_add_u32 v37, 155644, v37
  v_mov_b32 v36, 159952
  v_lshlrev_b32 v38, 11, v18
  v_lshl_add_u32 v38, v17, 4, v38
  s_lshl_b32 s32, s32, 16
  s_lshl_b32 s33, s18, 7
  s_add_u32 s32, s32, s33
  v_lshlrev_b32 v64, 16, v20
  v_and_b32 v65, 0xffff0000, v20
  v_lshlrev_b32 v66, 16, v21
  v_and_b32 v67, 0xffff0000, v21
  v_lshlrev_b32 v68, 16, v22
  v_and_b32 v69, 0xffff0000, v22
  v_lshlrev_b32 v70, 16, v23
  v_and_b32 v71, 0xffff0000, v23
  v_lshlrev_b32 v72, 16, v24
  v_and_b32 v73, 0xffff0000, v24
  v_lshlrev_b32 v74, 16, v25
  v_and_b32 v75, 0xffff0000, v25
  v_lshlrev_b32 v76, 16, v26
  v_and_b32 v77, 0xffff0000, v26
  v_lshlrev_b32 v78, 16, v27
  v_and_b32 v79, 0xffff0000, v27
  v_lshlrev_b32 v80, 16, v28
  v_and_b32 v81, 0xffff0000, v28
  v_lshlrev_b32 v82, 16, v29
  v_and_b32 v83, 0xffff0000, v29
  v_lshlrev_b32 v84, 16, v30
  v_and_b32 v85, 0xffff0000, v30
  v_lshlrev_b32 v86, 16, v31
  v_and_b32 v87, 0xffff0000, v31
  v_lshlrev_b32 v88, 16, v32
  v_and_b32 v89, 0xffff0000, v32
  v_lshlrev_b32 v90, 16, v33
  v_and_b32 v91, 0xffff0000, v33
  v_lshlrev_b32 v92, 16, v34
  v_and_b32 v93, 0xffff0000, v34
  v_lshlrev_b32 v94, 16, v35
  v_and_b32 v95, 0xffff0000, v35
  s_mov_b64 exec, 1
  s_waitcnt vmcnt(0)
  ds_add_u32 v1, v5 offset:0x100
  s_mov_b64 exec, -1
  s_barrier
  ds_read_b32 v40, v37 offset:6400
  ds_read_b32 v42, v37 offset:6912
  ds_read_b32 v36, v36
  s_waitcnt lgkmcnt(0)
  v_cmp_ne_u32 vcc, v36, v45
  s_mov_b64 exec, vcc
  v_pk_fma_f32 v[64:65], v[64:65], v[40:41], v[42:43] op_sel_hi:[1,0,0]
  v_pk_fma_f32 v[66:67], v[66:67], v[40:41], v[42:43] op_sel_hi:[1,0,0]
  v_pk_fma_f32 v[68:69], v[68:69], v[40:41], v[42:43] op_sel_hi:[1,0,0]
  v_pk_fma_f32 v[70:71], v[70:71], v[40:41], v[42:43] op_sel_hi:[1,0,0]
  v_cvt_pk_bf16_f32 v20, v64, v65
  v_cvt_pk_bf16_f32 v21, v66, v67
  v_cvt_pk_bf16_f32 v22, v68, v69
  v_cvt_pk_bf16_f32 v23, v70, v71
  buffer_store_dwordx4 v[20:23], v38, s[28:31], s32 offen offset:0
  v_pk_fma_f32 v[72:73], v[72:73], v[40:41], v[42:43] op_sel_hi:[1,0,0]
  v_pk_fma_f32 v[74:75], v[74:75], v[40:41], v[42:43] op_sel_hi:[1,0,0]
  v_pk_fma_f32 v[76:77], v[76:77], v[40:41], v[42:43] op_sel_hi:[1,0,0]
  v_pk_fma_f32 v[78:79], v[78:79], v[40:41], v[42:43] op_sel_hi:[1,0,0]
  v_cvt_pk_bf16_f32 v24, v72, v73
  v_cvt_pk_bf16_f32 v25, v74, v75
  v_cvt_pk_bf16_f32 v26, v76, v77
  v_cvt_pk_bf16_f32 v27, v78, v79
  buffer_store_dwordx4 v[24:27], v38, s[28:31], s32 offen offset:32
  v_pk_fma_f32 v[80:81], v[80:81], v[40:41], v[42:43] op_sel_hi:[1,0,0]
  v_pk_fma_f32 v[82:83], v[82:83], v[40:41], v[42:43] op_sel_hi:[1,0,0]
  v_pk_fma_f32 v[84:85], v[84:85], v[40:41], v[42:43] op_sel_hi:[1,0,0]
  v_pk_fma_f32 v[86:87], v[86:87], v[40:41], v[42:43] op_sel_hi:[1,0,0]
  v_cvt_pk_bf16_f32 v28, v80, v81
  v_cvt_pk_bf16_f32 v29, v82, v83
  v_cvt_pk_bf16_f32 v30, v84, v85
  v_cvt_pk_bf16_f32 v31, v86, v87
  buffer_store_dwordx4 v[28:31], v38, s[28:31], s32 offen offset:64
  v_pk_fma_f32 v[88:89], v[88:89], v[40:41], v[42:43] op_sel_hi:[1,0,0]
  v_pk_fma_f32 v[90:91], v[90:91], v[40:41], v[42:43] op_sel_hi:[1,0,0]
  v_pk_fma_f32 v[92:93], v[92:93], v[40:41], v[42:43] op_sel_hi:[1,0,0]
  v_pk_fma_f32 v[94:95], v[94:95], v[40:41], v[42:43] op_sel_hi:[1,0,0]
  v_cvt_pk_bf16_f32 v32, v88, v89
  v_cvt_pk_bf16_f32 v33, v90, v91
  v_cvt_pk_bf16_f32 v34, v92, v93
  v_cvt_pk_bf16_f32 v35, v94, v95
  buffer_store_dwordx4 v[32:35], v38, s[28:31], s32 offen offset:96
  s_mov_b64 exec, -1
  s_branch .fz_kernel_fin
.fz_kernel_chain:
  s_setprio 0
  s_bitcmp1_b32 s18, 0
  s_cselect_b32 s8, s52, s50
  s_cselect_b32 s9, s53, s51
  s_mov_b32 s10, 0x700000
  s_mov_b32 s11, 0x00020000
  s_lshl_b32 s12, s16, 8
  s_and_b32 s12, s12, 511
  s_and_b32 s31, s18, 2
  s_lshl_b32 s31, s31, 8
  s_add_u32 s12, s12, s31
  s_mul_i32 s12, s12, 7168
  s_lshl_b32 s31, s17, 2
  s_lshr_b32 s33, s18, 2
  s_add_u32 s31, s31, s33
  s_lshl_b32 s31, s31, 7
  s_add_u32 s12, s12, s31
  v_lshrrev_b32 v13, 3, v2
  v_mul_u32_u24 v13, 229376, v13
  v_and_b32 v11, 7, v2
  v_lshl_add_u32 v13, v11, 4, v13
  s_mov_b32 s24, s44
  s_mov_b32 s25, s45
  s_mov_b32 s26, 0x200000
  s_mov_b32 s27, 0x00020000
  v_lshrrev_b32 v8, 3, v2
  v_and_b32 v9, 7, v2
  v_bfe_u32 v10, v2, 4, 1
  v_lshlrev_b32 v10, 2, v10
  v_xor_b32 v9, v9, v10
  v_lshlrev_b32 v9, 4, v9
  v_lshl_add_u32 v10, v8, 11, v9
  s_mov_b32 s24, s54
  s_mov_b32 s25, s55
  s_mov_b32 s26, 0x700000
  s_mov_b32 s27, 0x00020000
  s_mov_b32 s36, 0x05040100
  s_mov_b32 s37, 0x07060302
  s_and_b32 s20, s16, 1
  s_lshl1_add_u32 s13, s17, s20
  s_lshl_b32 s13, s13, 18
  s_lshl_b32 s14, s18, 7
  s_add_u32 s13, s13, s14
  s_cmp_ge_u32 s17, 14
  s_cbranch_scc1 .fz_kernel_c_nl
  s_mov_b32 s38, 0
.fz_kernel_kw60:
  s_sleep 2
  ds_read_b32 v7, v6 offset:0
  s_add_u32 s38, s38, 1
  s_waitcnt lgkmcnt(0)
  v_readfirstlane_b32 s31, v7
  s_bcnt1_i32_b32 s31, s31
  s_cmp_ge_u32 s31, 16
  s_cbranch_scc1 .fz_kernel_kw60d
  s_cmp_lt_u32 s38, 1048576
  s_cbranch_scc1 .fz_kernel_kw60
.fz_kernel_kw60d:
  buffer_load_dwordx4 v[112:115], v13, s[8:11], s12 offen nt
  s_add_u32 s12, s12, 7168
  s_waitcnt vmcnt(2)
  buffer_load_dwordx4 v[116:119], v13, s[8:11], s12 offen nt
  s_add_u32 s12, s12, 7168
  s_waitcnt vmcnt(2)
  buffer_load_dwordx4 v[120:123], v13, s[8:11], s12 offen nt
  s_add_u32 s12, s12, 7168
  s_waitcnt vmcnt(2)
  buffer_load_dwordx4 v[124:127], v13, s[8:11], s12 offen nt
  s_add_u32 s12, s12, 7168
  s_waitcnt vmcnt(2)
  buffer_load_dwordx4 v[128:131], v13, s[8:11], s12 offen nt
  s_add_u32 s12, s12, 7168
  s_waitcnt vmcnt(2)
  buffer_load_dwordx4 v[132:135], v13, s[8:11], s12 offen nt
  s_add_u32 s12, s12, 7168
  s_waitcnt vmcnt(2)
  buffer_load_dwordx4 v[136:139], v13, s[8:11], s12 offen nt
  s_add_u32 s12, s12, 7168
  s_waitcnt vmcnt(2)
  buffer_load_dwordx4 v[140:143], v13, s[8:11], s12 offen nt
  s_add_u32 s12, s12, 7168
  s_waitcnt vmcnt(2)
  buffer_load_dwordx4 v[144:147], v13, s[8:11], s12 offen nt
  s_add_u32 s12, s12, 7168
  s_waitcnt vmcnt(2)
  buffer_load_dwordx4 v[148:151], v13, s[8:11], s12 offen nt
  s_add_u32 s12, s12, 7168
  s_waitcnt vmcnt(2)
  buffer_load_dwordx4 v[152:155], v13, s[8:11], s12 offen nt
  s_add_u32 s12, s12, 7168
  s_waitcnt vmcnt(2)
  buffer_load_dwordx4 v[156:159], v13, s[8:11], s12 offen nt
  s_add_u32 s12, s12, 7168
  s_waitcnt vmcnt(2)
  buffer_load_dwordx4 v[160:163], v13, s[8:11], s12 offen nt
  s_add_u32 s12, s12, 7168
  s_waitcnt vmcnt(2)
  buffer_load_dwordx4 v[164:167], v13, s[8:11], s12 offen nt
  s_add_u32 s12, s12, 7168
  s_waitcnt vmcnt(2)
  buffer_load_dwordx4 v[168:171], v13, s[8:11], s12 offen nt
  s_add_u32 s12, s12, 7168
  s_waitcnt vmcnt(2)
  buffer_load_dwordx4 v[172:175], v13, s[8:11], s12 offen nt
  s_add_u32 s12, s12, 7168
  s_waitcnt vmcnt(2)
  buffer_load_dwordx4 v[176:179], v13, s[8:11], s12 offen nt
  s_add_u32 s12, s12, 7168
  s_waitcnt vmcnt(2)
  buffer_load_dwordx4 v[180:183], v13, s[8:11], s12 offen nt
  s_add_u32 s12, s12, 7168
  s_waitcnt vmcnt(2)
  buffer_load_dwordx4 v[184:187], v13, s[8:11], s12 offen nt
  s_add_u32 s12, s12, 7168
  s_waitcnt vmcnt(2)
  buffer_load_dwordx4 v[188:191], v13, s[8:11], s12 offen nt
  s_add_u32 s12, s12, 7168
  s_waitcnt vmcnt(2)
  buffer_load_dwordx4 v[192:195], v13, s[8:11], s12 offen nt
  s_add_u32 s12, s12, 7168
  s_waitcnt vmcnt(2)
  buffer_load_dwordx4 v[196:199], v13, s[8:11], s12 offen nt
  s_add_u32 s12, s12, 7168
  s_waitcnt vmcnt(2)
  buffer_load_dwordx4 v[200:203], v13, s[8:11], s12 offen nt
  s_add_u32 s12, s12, 7168
  s_waitcnt vmcnt(2)
  buffer_load_dwordx4 v[204:207], v13, s[8:11], s12 offen nt
  s_add_u32 s12, s12, 7168
  s_waitcnt vmcnt(2)
  buffer_load_dwordx4 v[208:211], v13, s[8:11], s12 offen nt
  s_add_u32 s12, s12, 7168
  s_waitcnt vmcnt(2)
  buffer_load_dwordx4 v[212:215], v13, s[8:11], s12 offen nt
  s_add_u32 s12, s12, 7168
  s_waitcnt vmcnt(2)
  buffer_load_dwordx4 v[216:219], v13, s[8:11], s12 offen nt
  s_add_u32 s12, s12, 7168
  s_waitcnt vmcnt(2)
  buffer_load_dwordx4 v[220:223], v13, s[8:11], s12 offen nt
  s_add_u32 s12, s12, 7168
  s_waitcnt vmcnt(2)
  buffer_load_dwordx4 v[224:227], v13, s[8:11], s12 offen nt
  s_add_u32 s12, s12, 7168
  s_waitcnt vmcnt(2)
  buffer_load_dwordx4 v[228:231], v13, s[8:11], s12 offen nt
  s_add_u32 s12, s12, 7168
  s_waitcnt vmcnt(2)
  buffer_load_dwordx4 v[232:235], v13, s[8:11], s12 offen nt
  s_add_u32 s12, s12, 7168
  s_waitcnt vmcnt(2)
  buffer_load_dwordx4 v[236:239], v13, s[8:11], s12 offen nt
  s_add_u32 s12, s12, 7168
  s_waitcnt vmcnt(2)
  buffer_load_dwordx4 v[32:35], v10, s[24:27], s13 offen nt
  s_add_u32 s13, s13, 16384
  s_waitcnt vmcnt(2)
  buffer_load_dwordx4 v[36:39], v10, s[24:27], s13 offen nt
  s_add_u32 s13, s13, 16384
  s_waitcnt vmcnt(2)
  buffer_load_dwordx4 v[40:43], v10, s[24:27], s13 offen nt
  s_add_u32 s13, s13, 16384
  s_waitcnt vmcnt(2)
  buffer_load_dwordx4 v[44:47], v10, s[24:27], s13 offen nt
  s_add_u32 s13, s13, 16384
  s_waitcnt vmcnt(2)
  buffer_load_dwordx4 v[48:51], v10, s[24:27], s13 offen nt
  s_add_u32 s13, s13, 16384
  s_waitcnt vmcnt(2)
  buffer_load_dwordx4 v[52:55], v10, s[24:27], s13 offen nt
  s_add_u32 s13, s13, 16384
  s_waitcnt vmcnt(2)
  buffer_load_dwordx4 v[56:59], v10, s[24:27], s13 offen nt
  s_add_u32 s13, s13, 16384
  s_waitcnt vmcnt(2)
  buffer_load_dwordx4 v[60:63], v10, s[24:27], s13 offen nt
  s_add_u32 s13, s13, 16384
  s_waitcnt vmcnt(2)
  buffer_load_dwordx4 v[64:67], v10, s[24:27], s13 offen nt
  s_add_u32 s13, s13, 16384
  s_waitcnt vmcnt(2)
  buffer_load_dwordx4 v[68:71], v10, s[24:27], s13 offen nt
  s_add_u32 s13, s13, 16384
  s_waitcnt vmcnt(2)
  buffer_load_dwordx4 v[72:75], v10, s[24:27], s13 offen nt
  s_add_u32 s13, s13, 16384
  s_waitcnt vmcnt(2)
  buffer_load_dwordx4 v[76:79], v10, s[24:27], s13 offen nt
  s_add_u32 s13, s13, 16384
  s_waitcnt vmcnt(2)
  buffer_load_dwordx4 v[240:243], v10, s[24:27], s13 offen nt
  s_add_u32 s13, s13, 16384
  s_waitcnt vmcnt(2)
  buffer_load_dwordx4 v[244:247], v10, s[24:27], s13 offen nt
  s_add_u32 s13, s13, 16384
  s_waitcnt vmcnt(2)
  buffer_load_dwordx4 v[248:251], v10, s[24:27], s13 offen nt
  s_add_u32 s13, s13, 16384
  s_waitcnt vmcnt(2)
  buffer_load_dwordx4 v[252:255], v10, s[24:27], s13 offen nt
  s_add_u32 s13, s13, 16384
  s_waitcnt vmcnt(2)
  v_mov_b32 v16, 0x3f803f80
  v_mov_b32 v17, 0x3f803f80
  v_mov_b32 v18, 0x3f803f80
  v_mov_b32 v19, 0x3f803f80
  s_waitcnt vmcnt(0)
  s_barrier
  v_perm_b32 v80, v116, v112, s36
  v_perm_b32 v84, v116, v112, s37
  v_perm_b32 v88, v117, v113, s36
  v_perm_b32 v92, v117, v113, s37
  v_perm_b32 v96, v118, v114, s36
  v_perm_b32 v100, v118, v114, s37
  v_perm_b32 v104, v119, v115, s36
  v_perm_b32 v108, v119, v115, s37
  v_perm_b32 v81, v124, v120, s36
  v_perm_b32 v85, v124, v120, s37
  v_perm_b32 v89, v125, v121, s36
  v_perm_b32 v93, v125, v121, s37
  v_perm_b32 v97, v126, v122, s36
  v_perm_b32 v101, v126, v122, s37
  v_perm_b32 v105, v127, v123, s36
  v_perm_b32 v109, v127, v123, s37
  v_perm_b32 v82, v132, v128, s36
  v_perm_b32 v86, v132, v128, s37
  v_perm_b32 v90, v133, v129, s36
  v_perm_b32 v94, v133, v129, s37
  v_perm_b32 v98, v134, v130, s36
  v_perm_b32 v102, v134, v130, s37
  v_perm_b32 v106, v135, v131, s36
  v_perm_b32 v110, v135, v131, s37
  v_perm_b32 v83, v140, v136, s36
  v_perm_b32 v87, v140, v136, s37
  v_perm_b32 v91, v141, v137, s36
  v_perm_b32 v95, v141, v137, s37
  v_perm_b32 v99, v142, v138, s36
  v_perm_b32 v103, v142, v138, s37
  v_perm_b32 v107, v143, v139, s36
  v_perm_b32 v111, v143, v139, s37
  v_perm_b32 v112, v148, v144, s36
  v_perm_b32 v116, v148, v144, s37
  v_perm_b32 v120, v149, v145, s36
  v_perm_b32 v124, v149, v145, s37
  v_perm_b32 v128, v150, v146, s36
  v_perm_b32 v132, v150, v146, s37
  v_perm_b32 v136, v151, v147, s36
  v_perm_b32 v140, v151, v147, s37
  v_perm_b32 v113, v156, v152, s36
  v_perm_b32 v117, v156, v152, s37
  v_perm_b32 v121, v157, v153, s36
  v_perm_b32 v125, v157, v153, s37
  v_perm_b32 v129, v158, v154, s36
  v_perm_b32 v133, v158, v154, s37
  v_perm_b32 v137, v159, v155, s36
  v_perm_b32 v141, v159, v155, s37
  v_perm_b32 v114, v164, v160, s36
  v_perm_b32 v118, v164, v160, s37
  v_perm_b32 v122, v165, v161, s36
  v_perm_b32 v126, v165, v161, s37
  v_perm_b32 v130, v166, v162, s36
  v_perm_b32 v134, v166, v162, s37
  v_perm_b32 v138, v167, v163, s36
  v_perm_b32 v142, v167, v163, s37
  v_perm_b32 v115, v172, v168, s36
  v_perm_b32 v119, v172, v168, s37
  v_perm_b32 v123, v173, v169, s36
  v_perm_b32 v127, v173, v169, s37
  v_perm_b32 v131, v174, v170, s36
  v_perm_b32 v135, v174, v170, s37
  v_perm_b32 v139, v175, v171, s36
  v_perm_b32 v143, v175, v171, s37
  v_perm_b32 v144, v180, v176, s36
  v_perm_b32 v148, v180, v176, s37
  v_perm_b32 v152, v181, v177, s36
  v_perm_b32 v156, v181, v177, s37
  v_perm_b32 v160, v182, v178, s36
  v_perm_b32 v164, v182, v178, s37
  v_perm_b32 v168, v183, v179, s36
  v_perm_b32 v172, v183, v179, s37
  v_perm_b32 v145, v188, v184, s36
  v_perm_b32 v149, v188, v184, s37
  v_perm_b32 v153, v189, v185, s36
  v_perm_b32 v157, v189, v185, s37
  v_perm_b32 v161, v190, v186, s36
  v_perm_b32 v165, v190, v186, s37
  v_perm_b32 v169, v191, v187, s36
  v_perm_b32 v173, v191, v187, s37
  v_perm_b32 v146, v196, v192, s36
  v_perm_b32 v150, v196, v192, s37
  v_perm_b32 v154, v197, v193, s36
  v_perm_b32 v158, v197, v193, s37
  v_perm_b32 v162, v198, v194, s36
  v_perm_b32 v166, v198, v194, s37
  v_perm_b32 v170, v199, v195, s36
  v_perm_b32 v174, v199, v195, s37
  v_perm_b32 v147, v204, v200, s36
  v_perm_b32 v151, v204, v200, s37
  v_perm_b32 v155, v205, v201, s36
  v_perm_b32 v159, v205, v201, s37
  v_perm_b32 v163, v206, v202, s36
  v_perm_b32 v167, v206, v202, s37
  v_perm_b32 v171, v207, v203, s36
  v_perm_b32 v175, v207, v203, s37
  v_perm_b32 v176, v212, v208, s36
  v_perm_b32 v180, v212, v208, s37
  v_perm_b32 v184, v213, v209, s36
  v_perm_b32 v188, v213, v209, s37
  v_perm_b32 v192, v214, v210, s36
  v_perm_b32 v196, v214, v210, s37
  v_perm_b32 v200, v215, v211, s36
  v_perm_b32 v204, v215, v211, s37
  v_perm_b32 v177, v220, v216, s36
  v_perm_b32 v181, v220, v216, s37
  v_perm_b32 v185, v221, v217, s36
  v_perm_b32 v189, v221, v217, s37
  v_perm_b32 v193, v222, v218, s36
  v_perm_b32 v197, v222, v218, s37
  v_perm_b32 v201, v223, v219, s36
  v_perm_b32 v205, v223, v219, s37
  v_perm_b32 v178, v228, v224, s36
  v_perm_b32 v182, v228, v224, s37
  v_perm_b32 v186, v229, v225, s36
  v_perm_b32 v190, v229, v225, s37
  v_perm_b32 v194, v230, v226, s36
  v_perm_b32 v198, v230, v226, s37
  v_perm_b32 v202, v231, v227, s36
  v_perm_b32 v206, v231, v227, s37
  v_perm_b32 v179, v236, v232, s36
  v_perm_b32 v183, v236, v232, s37
  v_perm_b32 v187, v237, v233, s36
  v_perm_b32 v191, v237, v233, s37
  v_perm_b32 v195, v238, v234, s36
  v_perm_b32 v199, v238, v234, s37
  v_perm_b32 v203, v239, v235, s36
  v_perm_b32 v207, v239, v235, s37
  v_mfma_f32_16x16x32_bf16 v[208:211], v[16:19], v[80:83], 0
  v_mfma_f32_16x16x32_bf16 v[212:215], v[16:19], v[84:87], 0
  v_mfma_f32_16x16x32_bf16 v[216:219], v[16:19], v[88:91], 0
  v_mfma_f32_16x16x32_bf16 v[220:223], v[16:19], v[92:95], 0
  v_mfma_f32_16x16x32_bf16 v[224:227], v[16:19], v[96:99], 0
  v_mfma_f32_16x16x32_bf16 v[228:231], v[16:19], v[100:103], 0
  v_mfma_f32_16x16x32_bf16 v[232:235], v[16:19], v[104:107], 0
  v_mfma_f32_16x16x32_bf16 v[236:239], v[16:19], v[108:111], 0
  v_mfma_f32_16x16x32_bf16 v[208:211], v[16:19], v[112:115], v[208:211]
  v_mfma_f32_16x16x32_bf16 v[212:215], v[16:19], v[116:119], v[212:215]
  v_mfma_f32_16x16x32_bf16 v[216:219], v[16:19], v[120:123], v[216:219]
  v_mfma_f32_16x16x32_bf16 v[220:223], v[16:19], v[124:127], v[220:223]
  v_mfma_f32_16x16x32_bf16 v[224:227], v[16:19], v[128:131], v[224:227]
  v_mfma_f32_16x16x32_bf16 v[228:231], v[16:19], v[132:135], v[228:231]
  v_mfma_f32_16x16x32_bf16 v[232:235], v[16:19], v[136:139], v[232:235]
  v_mfma_f32_16x16x32_bf16 v[236:239], v[16:19], v[140:143], v[236:239]
  v_mfma_f32_16x16x32_bf16 v[208:211], v[16:19], v[144:147], v[208:211]
  v_mfma_f32_16x16x32_bf16 v[212:215], v[16:19], v[148:151], v[212:215]
  v_mfma_f32_16x16x32_bf16 v[216:219], v[16:19], v[152:155], v[216:219]
  v_mfma_f32_16x16x32_bf16 v[220:223], v[16:19], v[156:159], v[220:223]
  v_mfma_f32_16x16x32_bf16 v[224:227], v[16:19], v[160:163], v[224:227]
  v_mfma_f32_16x16x32_bf16 v[228:231], v[16:19], v[164:167], v[228:231]
  v_mfma_f32_16x16x32_bf16 v[232:235], v[16:19], v[168:171], v[232:235]
  v_mfma_f32_16x16x32_bf16 v[236:239], v[16:19], v[172:175], v[236:239]
  v_mfma_f32_16x16x32_bf16 v[208:211], v[16:19], v[176:179], v[208:211]
  v_mfma_f32_16x16x32_bf16 v[212:215], v[16:19], v[180:183], v[212:215]
  v_mfma_f32_16x16x32_bf16 v[216:219], v[16:19], v[184:187], v[216:219]
  v_mfma_f32_16x16x32_bf16 v[220:223], v[16:19], v[188:191], v[220:223]
  v_mfma_f32_16x16x32_bf16 v[224:227], v[16:19], v[192:195], v[224:227]
  v_mfma_f32_16x16x32_bf16 v[228:231], v[16:19], v[196:199], v[228:231]
  v_mfma_f32_16x16x32_bf16 v[232:235], v[16:19], v[200:203], v[232:235]
  v_mfma_f32_16x16x32_bf16 v[236:239], v[16:19], v[204:207], v[236:239]
  s_nop 0
  v_add_f32 v28, v209, v208 row_ror:8 row_mask:0xf bank_mask:0x3
  v_add_f32 v29, v213, v212 row_ror:8 row_mask:0xf bank_mask:0x3
  v_add_f32 v30, v217, v216 row_ror:8 row_mask:0xf bank_mask:0x3
  v_add_f32 v31, v221, v220 row_ror:8 row_mask:0xf bank_mask:0x3
  v_add_f32 v28, v224, v225 row_ror:8 row_mask:0xf bank_mask:0xc
  v_add_f32 v29, v228, v229 row_ror:8 row_mask:0xf bank_mask:0xc
  v_add_f32 v30, v232, v233 row_ror:8 row_mask:0xf bank_mask:0xc
  v_add_f32 v31, v236, v237 row_ror:8 row_mask:0xf bank_mask:0xc
  v_mul_f32 v28, 0.0009765625, v28
  v_mul_f32 v29, 0.0009765625, v29
  v_mul_f32 v30, 0.0009765625, v30
  v_mul_f32 v31, 0.0009765625, v31
.fz_kernel_c_np:
  v_mov_b32 v27, v6
  s_mov_b32 s72, s66
  s_mov_b32 s73, s65
  s_mov_b32 s74, s67
  s_mov_b32 s75, s62
  s_cmp_lg_u32 s62, 0
  s_cbranch_scc1 .fz_kernel_c_n2
  s_mov_b32 s62, 1
  s_mov_b32 s63, 0x2000000
  s_mov_b32 s64, 0x2800000
  s_mov_b32 s65, 0x1400000
  s_mov_b32 s66, 0x1c42000
  s_mov_b32 s67, 12
  s_mov_b32 s71, 159776
  v_mov_b32 v6, 159832
.fz_kernel_c_n2:
  s_lshr_b32 s21, s17, 3
  s_add_u32 s70, s18, s21
  s_lshl1_add_u32 s70, s17, s70
  s_and_b32 s70, s70, 15
  s_cmp_eq_u32 s75, 0
  s_cselect_b32 s3, 32, 0
  s_cselect_b32 s70, s70, s18
  s_and_b32 s20, s16, 1
  s_mov_b32 s34, 0x00030003
  s_mov_b32 s35, 0x00030003
  s_mov_b32 s71, 0
  s_lshl1_add_u32 s26, s17, s20
  v_lshrrev_b32 v8, 4, v2
  v_bfe_u32 v12, v2, 3, 1
  v_lshl_add_u32 v12, v12, 2, v8
  v_lshlrev_b32 v10, 7, v2
  s_lshl_b32 s25, s20, 1
  v_lshrrev_b32 v14, 4, v2
  v_bfe_u32 v15, v2, 2, 2
  v_lshl_add_u32 v16, v14, 3, v15
  v_lshlrev_b32 v16, 7, v16
  v_and_b32 v14, 1, v14
  v_lshrrev_b32 v15, 1, v15
  v_lshl_add_u32 v14, v14, 1, v15
  v_xor_b32 v14, s25, v14
  v_lshl_add_u32 v16, v14, 5, v16
  v_and_b32 v14, 3, v2
  v_lshl_add_u32 v16, v14, 3, v16
  v_add_u32 v7, 65536, v16
  v_xor_b32 v9, 32, v7
  s_add_u32 s21, s74, 0x1800008
  s_sub_u32 s22, s72, 32768
  v_mov_b32 v14, s21
  v_mov_b32 v15, s22
  v_cmp_gt_u32 vcc, 16, v2
  s_nop 1
  v_cndmask_b32 v14, v15, v14, vcc
  v_lshl_add_u32 v14, v2, 11, v14
  s_lshl_b32 s25, s17, 7
  s_lshl_b32 s22, 1, s18
  v_mov_b32 v15, s22
  v_lshlrev_b32 v16, 3, v2
  s_and_b32 s21, s2, 7
  s_lshl_b32 s21, s21, 11
  s_lshl_b32 s22, s20, 10
  s_add_u32 s21, s21, s22
  s_add_u32 s21, s21, s72
  s_lshl_b32 s22, s20, 12
  s_add_u32 s22, s22, s72
  s_add_u32 s22, s22, 16384
  s_add_u32 s23, s22, 8192
  s_add_u32 s24, s22, 16384
  v_and_b32 v17, 1, v8
  v_lshlrev_b32 v17, 13, v17
  v_lshrrev_b32 v18, 1, v8
  v_mul_u32_u24 v18, 320, v18
  v_add_u32 v17, v17, v18
  v_bfe_u32 v18, v2, 3, 1
  v_lshl_add_u32 v17, v18, 9, v17
  v_bfe_u32 v18, v2, 2, 1
  v_lshl_add_u32 v17, v18, 7, v17
  v_and_b32 v18, 3, v2
  v_lshl_add_u32 v17, v18, 3, v17
  s_lshl_b32 s27, s20, 14
  s_add_u32 s27, s27, 114688
  v_add_u32 v17, s27, v17
  v_xor_b32 v18, 64, v17
  v_and_b32 v19, 15, v2
  v_lshlrev_b32 v19, 6, v19
  v_lshl_add_u32 v19, v8, 4, v19
  v_and_b32 v20, 7, v2
  v_lshlrev_b32 v20, 5, v20
  v_and_b32 v21, 8, v2
  v_lshl_add_u32 v20, v21, 1, v20
  v_and_b32 v21, 31, v2
  v_lshlrev_b32 v21, 4, v21
  v_lshrrev_b32 v22, 5, v2
  v_lshl_add_u32 v21, v22, 11, v21
  v_mov_b32 v23, 0.0009765625
  v_mov_b32 v24, 9.5367431640625e-07
  v_mov_b32 v25, 1e-05
  v_add_u32 v26, 155648, v16
  s_lshl_b32 s14, s17, 9
  s_add_u32 s14, s14, s72
  s_add_u32 s14, s14, 16384
  s_add_u32 s15, s14, 8192
  v_add_u32 v13, s27, v3
  s_barrier
.fz_kernel_c_n3:
  s_mov_b32 s13, 0xffffff
  s_cmp_eq_u32 s20, 0
  s_cbranch_scc1 .fz_kernel_c_nf
  s_mov_b32 s38, 0
.fz_kernel_cw61:
  s_sleep 1
  ds_read_b32 v22, v27 offset:268
  s_add_u32 s38, s38, 1
  s_waitcnt lgkmcnt(0)
  v_and_b32 v22, 0xff, v22
  v_cmp_gt_u32 vcc, 4, v22
  s_cbranch_vccz .fz_kernel_cw61d
  s_cmp_lt_u32 s38, 8388608
  s_cbranch_scc1 .fz_kernel_cw61
.fz_kernel_cw61d:
  s_cmp_eq_u32 s75, 0
  s_cselect_b32 exec_lo, 0xffff, s13
  s_mov_b32 exec_hi, 0
  buffer_atomic_or v15, v14, s[4:7], s25 offen sc1
  s_mov_b64 exec, -1
.fz_kernel_c_nf:
  ds_write_b128 v13, v[32:35] offset:0
  ds_write_b128 v13, v[36:39] offset:1024
  ds_write_b128 v13, v[40:43] offset:2048
  ds_write_b128 v13, v[44:47] offset:3072
  ds_write_b128 v13, v[48:51] offset:4096
  ds_write_b128 v13, v[52:55] offset:5120
  ds_write_b128 v13, v[56:59] offset:6144
  ds_write_b128 v13, v[60:63] offset:7168
  ds_write_b128 v13, v[64:67] offset:8192
  ds_write_b128 v13, v[68:71] offset:9216
  ds_write_b128 v13, v[72:75] offset:10240
  ds_write_b128 v13, v[76:79] offset:11264
  ds_write_b128 v13, v[240:243] offset:12288
  ds_write_b128 v13, v[244:247] offset:13312
  ds_write_b128 v13, v[248:251] offset:14336
  ds_write_b128 v13, v[252:255] offset:15360
  v_and_b32 v14, 1, v2
  v_lshlrev_b32 v14, 10, v14
  v_lshl_add_u32 v14, v8, 14, v14
  s_waitcnt lgkmcnt(0)
  s_cmp_lg_u32 s75, 0
  s_cbranch_scc1 .fz_kernel_c_nw
  s_mov_b32 s38, 0
.fz_kernel_cw62:
  s_sleep 1
  ds_read_b32 v27, v6 offset:272
  s_add_u32 s38, s38, 1
  s_waitcnt lgkmcnt(0)
  v_and_b32 v27, 0xff, v27
  v_cmp_gt_u32 vcc, 2, v27
  s_cbranch_vccz .fz_kernel_cw62d
  s_cmp_lt_u32 s38, 8388608
  s_cbranch_scc1 .fz_kernel_cw62
.fz_kernel_cw62d:
  ds_read_b64_tr_b16 v[32:33], v7 offset:0
  ds_read_b64_tr_b16 v[34:35], v7 offset:512
  ds_read_b64_tr_b16 v[36:37], v9 offset:0
  ds_read_b64_tr_b16 v[38:39], v9 offset:512
  ds_read_b64_tr_b16 v[40:41], v7 offset:4096
  ds_read_b64_tr_b16 v[42:43], v7 offset:4608
  ds_read_b64_tr_b16 v[44:45], v9 offset:4096
  ds_read_b64_tr_b16 v[46:47], v9 offset:4608
  ds_read_b64_tr_b16 v[48:49], v7 offset:8192
  ds_read_b64_tr_b16 v[50:51], v7 offset:8704
  ds_read_b64_tr_b16 v[52:53], v9 offset:8192
  ds_read_b64_tr_b16 v[54:55], v9 offset:8704
  s_waitcnt lgkmcnt(0)
  ds_read_b64_tr_b16 v[56:57], v7 offset:12288
  ds_read_b64_tr_b16 v[58:59], v7 offset:12800
  ds_read_b64_tr_b16 v[60:61], v9 offset:12288
  ds_read_b64_tr_b16 v[62:63], v9 offset:12800
  ds_read_b64_tr_b16 v[64:65], v7 offset:16384
  ds_read_b64_tr_b16 v[66:67], v7 offset:16896
  ds_read_b64_tr_b16 v[68:69], v9 offset:16384
  ds_read_b64_tr_b16 v[70:71], v9 offset:16896
  ds_read_b64_tr_b16 v[72:73], v7 offset:20480
  ds_read_b64_tr_b16 v[74:75], v7 offset:20992
  ds_read_b64_tr_b16 v[76:77], v9 offset:20480
  ds_read_b64_tr_b16 v[78:79], v9 offset:20992
  s_waitcnt lgkmcnt(0)
  s_lshl_b32 s21, s18, 10
  s_add_u32 s21, s21, s72
  s_cmp_lg_u32 s20, 0
  s_cbranch_scc1 .fz_kernel_c_c2
  s_add_u32 s22, s19, s74
  s_add_u32 s23, s14, 16384
  s_mov_b64 exec, 1
  s_mov_b32 s38, 0
.fz_kernel_c_c0:
  buffer_load_dword v9, v4, s[4:7], s22 offen offset:8 sc1
  s_add_u32 s38, s38, 1
  s_waitcnt vmcnt(0)
  v_cmp_ne_u32 vcc, 0xffff, v9
  s_cbranch_vccz .fz_kernel_c_c1
  s_cmp_lt_u32 s38, 131072
  s_cbranch_scc1 .fz_kernel_c_c0
.fz_kernel_c_c1:
  s_mov_b64 exec, -1
  buffer_load_dwordx2 v[240:241], v16, s[4:7], s14 offen
  buffer_load_dwordx2 v[242:243], v16, s[4:7], s15 offen
  buffer_load_dwordx2 v[244:245], v16, s[4:7], s23 offen
  s_lshl_b32 s23, s17, 6
  s_add_u32 s23, s23, s21
  s_lshl_b32 s24, s17, 7
  s_add_u32 s24, s24, 1
  s_waitcnt vmcnt(0)
  v_fma_f32 v208, -v240, v240, v242
  v_fma_f32 v209, -v241, v241, v243
  v_rsq_f32 v208, abs(v208)
  v_rsq_f32 v209, abs(v209)
  v_mul_f32 v208, v208, v244
  v_mul_f32 v209, v209, v245
  v_and_b32 v208, -2, v208
  v_or_b32 v209, 1, v209
  v_cmp_gt_f32 vcc, v209, v208
  v_max_f32 v9, v208, v209
  s_nop 0
  v_cndmask_b32 v210, v240, v241, vcc
  v_max_f32 v7, v9, v9 row_ror:8 row_mask:0xf bank_mask:0xf
  v_cndmask_b32 v211, v242, v243, vcc
  s_nop 0
  v_max_f32 v7, v7, v7 row_ror:4 row_mask:0xf bank_mask:0xf
  s_nop 1
  v_max_f32 v7, v7, v7 row_ror:2 row_mask:0xf bank_mask:0xf
  s_nop 1
  v_max_f32 v7, v7, v7 row_ror:1 row_mask:0xf bank_mask:0xf
  s_nop 1
  v_max_f32 v7, v7, v7 row_bcast:15 row_mask:0xa bank_mask:0xf
  s_nop 1
  v_max_f32 v7, v7, v7 row_bcast:31 row_mask:0xc bank_mask:0xf
  v_and_b32 v209, 1, v9
  v_lshl_add_u32 v209, v2, 1, v209
  v_readlane_b32 s22, v7, 63
  v_add_u32 v209, s24, v209
  v_mov_b32 v208, v9
  v_cmp_eq_u32 vcc, s22, v9
  s_ff1_i32_b64 s22, vcc
  s_lshl_b64 exec, 1, s22
  buffer_store_dwordx4 v[208:211], v4, s[4:7], s23 offen sc1
  s_mov_b64 exec, -1
.fz_kernel_c_c2:
  s_cmp_lg_u32 s20, 0
  s_cbranch_scc1 .fz_kernel_c_c21
  s_call_b64 s[68:69], .fz_kernel_c_coef
  ds_write_b64 v26, v[248:249] offset:4608
  ds_write_b64 v26, v[250:251] offset:5120
  ds_write_b64 v26, v[252:253] offset:6400
  ds_write_b64 v26, v[254:255] offset:6912
.fz_kernel_c_c21:
  s_cmp_eq_u32 s3, 0
  s_cbranch_scc1 .fz_kernel_hb63
  s_barrier
  s_sub_u32 s3, s3, 1
.fz_kernel_hb63:
  s_cmp_eq_u32 s3, 0
  s_cbranch_scc1 .fz_kernel_hb64
  s_barrier
  s_sub_u32 s3, s3, 1
.fz_kernel_hb64:
  s_cmp_eq_u32 s3, 0
  s_cbranch_scc1 .fz_kernel_hb65
  s_barrier
  s_sub_u32 s3, s3, 1
.fz_kernel_hb65:
.fz_kernel_c_c3:
  v_lshlrev_b32 v22, 6, v2
  s_mov_b64 exec, 0xffff
  s_mov_b32 s38, 0
.fz_kernel_c_c4:
  buffer_load_dwordx4 v[224:227], v22, s[4:7], s21 offen sc1
  s_add_u32 s38, s38, 1
  s_mov_b32 s46, 0
  s_call_b64 s[0:1], .fz_kernel_hw
  s_waitcnt vmcnt(0)
  v_min_u32 v9, v225, v227
  v_max_f32 v7, v224, v224 row_ror:8 row_mask:0xf bank_mask:0xf
  v_cmp_eq_u32 vcc, 0, v9
  s_cbranch_vccz .fz_kernel_c_c5
  s_cmp_lt_u32 s38, 131072
  s_cbranch_scc1 .fz_kernel_c_c4
.fz_kernel_c_c5:
  s_waitcnt lgkmcnt(0)
  v_max_f32 v7, v7, v7 row_ror:4 row_mask:0xf bank_mask:0xf
  s_nop 1
  v_max_f32 v7, v7, v7 row_ror:2 row_mask:0xf bank_mask:0xf
  s_nop 1
  v_max_f32 v7, v7, v7 row_ror:1 row_mask:0xf bank_mask:0xf
  v_cmp_eq_u32 vcc, v7, v224
  s_or_b32 s22, vcc_lo, 0x8000
  s_ff1_i32_b32 s22, s22
  v_readlane_b32 s77, v225, s22
  v_readlane_b32 s27, v224, s22
  v_readlane_b32 s23, v226, s22
  v_readlane_b32 s24, v227, s22
  s_mov_b64 exec, -1
  v_mov_b32 v11, s23
  v_mov_b32 v15, s24
  s_branch .fz_kernel_c_idx
.fz_kernel_c_nw:
  s_mov_b64 exec, 0xff
  s_mov_b32 s38, 0
.fz_kernel_c_gm:
  buffer_load_dword v9, v10, s[4:7], s21 offen sc1
  s_add_u32 s38, s38, 1
  s_mov_b32 s46, 0
  s_call_b64 s[0:1], .fz_kernel_hw
  s_waitcnt vmcnt(0)
  v_cmp_ne_u32 vcc, 0xffff, v9
  s_cbranch_vccz .fz_kernel_c_gmd
  s_cmp_eq_u32 s3, 0
  s_cbranch_scc1 .fz_kernel_hb66
  s_barrier
  s_sub_u32 s3, s3, 1
.fz_kernel_hb66:
  s_cmp_lt_u32 s38, 131072
  s_cbranch_scc1 .fz_kernel_c_gm
.fz_kernel_c_gmd:
  s_mov_b64 exec, -1
  buffer_load_dwordx4 v[208:211], v3, s[4:7], s22 offen offset:0
  buffer_load_dwordx4 v[212:215], v3, s[4:7], s23 offen offset:0
  buffer_load_dwordx4 v[216:219], v3, s[4:7], s24 offen offset:0
  buffer_load_dwordx4 v[220:223], v3, s[4:7], s22 offen offset:1024
  buffer_load_dwordx4 v[224:227], v3, s[4:7], s23 offen offset:1024
  buffer_load_dwordx4 v[228:231], v3, s[4:7], s24 offen offset:1024
  buffer_load_dwordx4 v[232:235], v3, s[4:7], s22 offen offset:2048
  buffer_load_dwordx4 v[236:239], v3, s[4:7], s23 offen offset:2048
  buffer_load_dwordx4 v[240:243], v3, s[4:7], s24 offen offset:2048
  buffer_load_dwordx4 v[244:247], v3, s[4:7], s22 offen offset:3072
  buffer_load_dwordx4 v[248:251], v3, s[4:7], s23 offen offset:3072
  buffer_load_dwordx4 v[252:255], v3, s[4:7], s24 offen offset:3072
  s_lshl_b32 s21, s75, 4
  s_add_u32 s21, s21, 159968
  v_mov_b32 v10, s21
  s_lshl_b32 s22, s20, 3
  v_add_u32 v13, s22, v10
  s_mov_b32 s46, 6
  s_call_b64 s[0:1], .fz_kernel_hw
  s_waitcnt vmcnt(6)
  s_waitcnt vmcnt(10)
  v_fma_f32 v212, -v208, v208, v212
  v_fma_f32 v213, -v209, v209, v213
  v_fma_f32 v214, -v210, v210, v214
  v_fma_f32 v215, -v211, v211, v215
  s_cmp_eq_u32 s3, 0
  s_cbranch_scc1 .fz_kernel_hb74
  s_barrier
  s_sub_u32 s3, s3, 1
.fz_kernel_hb74:
  v_rsq_f32 v212, abs(v212)
  v_rsq_f32 v213, abs(v213)
  v_rsq_f32 v214, abs(v214)
  v_rsq_f32 v215, abs(v215)
  s_waitcnt vmcnt(9)
  v_mul_f32 v216, v216, v212
  v_mul_f32 v217, v217, v213
  v_mul_f32 v218, v218, v214
  v_mul_f32 v219, v219, v215
  v_and_or_b32 v216, v216, -16, 0
  v_and_or_b32 v217, v217, -16, 1
  v_and_or_b32 v218, v218, -16, 2
  v_and_or_b32 v219, v219, -16, 3
  v_max3_f32 v9, v216, v217, v218
  v_max_f32 v9, v9, v219
  s_waitcnt vmcnt(7)
  v_fma_f32 v224, -v220, v220, v224
  v_fma_f32 v225, -v221, v221, v225
  v_fma_f32 v226, -v222, v222, v226
  v_fma_f32 v227, -v223, v223, v227
  v_rsq_f32 v224, abs(v224)
  v_rsq_f32 v225, abs(v225)
  v_rsq_f32 v226, abs(v226)
  v_rsq_f32 v227, abs(v227)
  s_waitcnt vmcnt(6)
  v_mul_f32 v228, v228, v224
  v_mul_f32 v229, v229, v225
  v_mul_f32 v230, v230, v226
  v_mul_f32 v231, v231, v227
  s_cmp_eq_u32 s3, 0
  s_cbranch_scc1 .fz_kernel_hb75
  s_barrier
  s_sub_u32 s3, s3, 1
.fz_kernel_hb75:
  v_and_or_b32 v228, v228, -16, 4
  v_and_or_b32 v229, v229, -16, 5
  v_and_or_b32 v230, v230, -16, 6
  v_and_or_b32 v231, v231, -16, 7
  v_max3_f32 v9, v9, v228, v229
  v_max3_f32 v9, v9, v230, v231
  s_waitcnt vmcnt(4)
  v_fma_f32 v236, -v232, v232, v236
  v_fma_f32 v237, -v233, v233, v237
  v_fma_f32 v238, -v234, v234, v238
  v_fma_f32 v239, -v235, v235, v239
  v_rsq_f32 v236, abs(v236)
  v_rsq_f32 v237, abs(v237)
  v_rsq_f32 v238, abs(v238)
  v_rsq_f32 v239, abs(v239)
  s_waitcnt vmcnt(3)
  v_mul_f32 v240, v240, v236
  v_mul_f32 v241, v241, v237
  v_mul_f32 v242, v242, v238
  v_mul_f32 v243, v243, v239
  v_and_or_b32 v240, v240, -16, 8
  v_and_or_b32 v241, v241, -16, 9
  v_and_or_b32 v242, v242, -16, 10
  v_and_or_b32 v243, v243, -16, 11
  v_max3_f32 v9, v9, v240, v241
  v_max3_f32 v9, v9, v242, v243
  s_waitcnt vmcnt(1)
  v_fma_f32 v248, -v244, v244, v248
  v_fma_f32 v249, -v245, v245, v249
  v_fma_f32 v250, -v246, v246, v250
  v_fma_f32 v251, -v247, v247, v251
  v_rsq_f32 v248, abs(v248)
  s_cmp_eq_u32 s3, 0
  s_cbranch_scc1 .fz_kernel_hb76
  s_barrier
  s_sub_u32 s3, s3, 1
.fz_kernel_hb76:
  v_rsq_f32 v249, abs(v249)
  v_rsq_f32 v250, abs(v250)
  v_rsq_f32 v251, abs(v251)
  s_waitcnt vmcnt(0)
  v_mul_f32 v252, v252, v248
  v_mul_f32 v253, v253, v249
  v_mul_f32 v254, v254, v250
  v_mul_f32 v255, v255, v251
  v_and_or_b32 v252, v252, -16, 12
  v_and_or_b32 v253, v253, -16, 13
  v_and_or_b32 v254, v254, -16, 14
  v_and_or_b32 v255, v255, -16, 15
  v_max3_f32 v9, v9, v252, v253
  v_max3_f32 v9, v9, v254, v255
  s_nop 1
  v_max_f32 v7, v9, v9 row_ror:8 row_mask:0xf bank_mask:0xf
  s_nop 1
  v_max_f32 v7, v7, v7 row_ror:4 row_mask:0xf bank_mask:0xf
  s_nop 1
  v_max_f32 v7, v7, v7 row_ror:2 row_mask:0xf bank_mask:0xf
  s_nop 1
  v_max_f32 v7, v7, v7 row_ror:1 row_mask:0xf bank_mask:0xf
  s_nop 1
  v_max_f32 v7, v7, v7 row_bcast:15 row_mask:0xa bank_mask:0xf
  s_nop 1
  v_max_f32 v7, v7, v7 row_bcast:31 row_mask:0xc bank_mask:0xf
  s_nop 0
  v_readlane_b32 s21, v7, 63
  s_nop 1
  v_cmp_eq_u32 vcc, s21, v9
  s_ff1_i32_b64 s22, vcc
  s_lshl_b32 s22, s22, 2
  s_and_b32 s23, s21, 3
  s_add_u32 s22, s22, s23
  s_and_b32 s23, s21, 12
  s_lshl_b32 s23, s23, 6
  s_add_u32 s22, s22, s23
  s_and_b32 s22, s22, 1023
  s_lshl_b32 s23, s20, 10
  s_add_u32 s22, s22, s23
  s_add_u32 s22, s22, 1
  v_mov_b32 v224, s21
  v_mov_b32 v225, s22
  s_mov_b64 exec, 1
  ds_write_b64 v13, v[224:225]
  s_mov_b32 s38, 0
.fz_kernel_c_am:
  s_cmp_eq_u32 s3, 0
  s_cbranch_scc1 .fz_kernel_hb77
  s_barrier
  s_sub_u32 s3, s3, 1
.fz_kernel_hb77:
  ds_read_b128 v[224:227], v10
  s_add_u32 s38, s38, 1
  s_waitcnt lgkmcnt(0)
  v_min_u32 v9, v225, v227
  v_cmp_eq_u32 vcc, 0, v9
  s_cbranch_vccz .fz_kernel_c_amd
  s_cmp_eq_u32 s3, 0
  s_cbranch_scc1 .fz_kernel_hb67
  s_barrier
  s_sub_u32 s3, s3, 1
.fz_kernel_hb67:
  s_cmp_lt_u32 s38, 524288
  s_cbranch_scc1 .fz_kernel_c_am
.fz_kernel_c_amd:
  v_cmp_gt_f32 vcc, v226, v224
  s_nop 1
  v_cndmask_b32 v225, v225, v227, vcc
  v_cndmask_b32 v224, v224, v226, vcc
  v_readfirstlane_b32 s77, v225
  v_readfirstlane_b32 s27, v224
  s_mov_b64 exec, -1
  s_sub_u32 s21, s77, 1
  s_and_b32 s21, s21, 2047
  s_lshl_b32 s21, s21, 2
  s_add_u32 s21, s21, s72
  s_add_u32 s21, s21, 16384
  s_add_u32 s22, s21, 8192
  buffer_load_dword v11, v4, s[4:7], s21 offen
  buffer_load_dword v15, v4, s[4:7], s22 offen
.fz_kernel_c_idx:
  s_mov_b64 exec, s[34:35]
  s_sub_u32 s77, s77, 1
  s_and_b32 s77, s77, 2047
  s_lshr_b32 s78, s77, 7
  s_lshl_b32 s78, s78, 18
  s_and_b32 s21, s77, 0x70
  s_lshl_b32 s21, s21, 7
  s_add_u32 s78, s78, s21
  s_and_b32 s21, s77, 15
  s_lshl_b32 s21, s21, 4
  s_add_u32 s78, s78, s21
  s_add_u32 s78, s78, s73
  s_and_b32 s25, s18, 2
  s_add_u32 s25, s25, s20
  s_lshl_b32 s21, s25, 16
  s_add_u32 s21, s21, s78
  buffer_load_dwordx4 v[208:211], v14, s[4:7], s21 offen offset:0
  buffer_load_dwordx4 v[212:215], v14, s[4:7], s21 offen offset:256
  buffer_load_dwordx4 v[216:219], v14, s[4:7], s21 offen offset:512
  buffer_load_dwordx4 v[220:223], v14, s[4:7], s21 offen offset:768
  s_mov_b64 exec, -1
  s_lshr_b32 s21, s77, 7
  s_and_b32 s79, s77, 127
  s_add_u32 s79, s79, 1
  s_cmp_eq_u32 s21, s17
  s_cselect_b32 s79, s79, 0
  s_and_b32 s21, s18, 1
  s_lshl_b32 s21, s21, 2
  s_add_u32 s21, s21, s25
  s_lshl_b32 s21, s21, 9
  s_lshl_b32 s22, s17, 13
  s_add_u32 s21, s21, s22
  s_and_b32 s22, s18, 8
  s_lshl_b32 s22, s22, 9
  s_add_u32 s21, s21, s22
  s_and_b32 s22, s18, 4
  s_lshl_b32 s22, s22, 6
  s_add_u32 s21, s21, s22
  s_add_u32 s21, s21, s72
  s_add_u32 s21, s21, 40960
  s_cmp_eq_u32 s3, 0
  s_cbranch_scc1 .fz_kernel_hb78
  s_barrier
  s_sub_u32 s3, s3, 1
.fz_kernel_hb78:
  v_mov_b32 v1, -1477.3197218702985
  v_mul_f32 v1, s27, v1
  v_exp_f32 v1, v1
  s_nop 0
  v_add_f32 v1, 1.0, v1
  v_rcp_f32 v1, v1
  v_and_b32 v14, 8, v2
  v_lshlrev_b32 v14, 7, v14
  v_lshl_add_u32 v14, v8, 8, v14
  s_lshl_b32 s23, s70, 14
  s_add_u32 s23, s23, s78
  s_mov_b32 s46, 0
  s_call_b64 s[0:1], .fz_kernel_hw
  s_waitcnt vmcnt(0)
  s_cmp_ge_u32 s17, 14
  s_cbranch_scc1 .fz_kernel_c_ng
  s_setprio 2
  v_mfma_f32_16x16x32_bf16 v[224:227], v[208:211], v[80:83], 0
  v_mfma_f32_16x16x32_bf16 v[228:231], v[208:211], v[84:87], 0
  v_mfma_f32_16x16x32_bf16 v[232:235], v[208:211], v[88:91], 0
  v_mfma_f32_16x16x32_bf16 v[236:239], v[208:211], v[92:95], 0
  v_mfma_f32_16x16x32_bf16 v[240:243], v[208:211], v[96:99], 0
  v_mfma_f32_16x16x32_bf16 v[244:247], v[208:211], v[100:103], 0
  v_mfma_f32_16x16x32_bf16 v[248:251], v[208:211], v[104:107], 0
  v_mfma_f32_16x16x32_bf16 v[252:255], v[208:211], v[108:111], 0
  v_mfma_f32_16x16x32_bf16 v[224:227], v[212:215], v[112:115], v[224:227]
  v_mfma_f32_16x16x32_bf16 v[228:231], v[212:215], v[116:119], v[228:231]
  v_mfma_f32_16x16x32_bf16 v[232:235], v[212:215], v[120:123], v[232:235]
  v_mfma_f32_16x16x32_bf16 v[236:239], v[212:215], v[124:127], v[236:239]
  v_mfma_f32_16x16x32_bf16 v[240:243], v[212:215], v[128:131], v[240:243]
  v_mfma_f32_16x16x32_bf16 v[244:247], v[212:215], v[132:135], v[244:247]
  v_mfma_f32_16x16x32_bf16 v[248:251], v[212:215], v[136:139], v[248:251]
  v_mfma_f32_16x16x32_bf16 v[252:255], v[212:215], v[140:143], v[252:255]
  v_mfma_f32_16x16x32_bf16 v[224:227], v[216:219], v[144:147], v[224:227]
  v_mfma_f32_16x16x32_bf16 v[228:231], v[216:219], v[148:151], v[228:231]
  v_mfma_f32_16x16x32_bf16 v[232:235], v[216:219], v[152:155], v[232:235]
  v_mfma_f32_16x16x32_bf16 v[236:239], v[216:219], v[156:159], v[236:239]
  v_mfma_f32_16x16x32_bf16 v[240:243], v[216:219], v[160:163], v[240:243]
  v_mfma_f32_16x16x32_bf16 v[244:247], v[216:219], v[164:167], v[244:247]
  v_mfma_f32_16x16x32_bf16 v[248:251], v[216:219], v[168:171], v[248:251]
  v_mfma_f32_16x16x32_bf16 v[252:255], v[216:219], v[172:175], v[252:255]
  v_mfma_f32_16x16x32_bf16 v[224:227], v[220:223], v[176:179], v[224:227]
  v_mfma_f32_16x16x32_bf16 v[228:231], v[220:223], v[180:183], v[228:231]
  v_mfma_f32_16x16x32_bf16 v[232:235], v[220:223], v[184:187], v[232:235]
  v_mfma_f32_16x16x32_bf16 v[236:239], v[220:223], v[188:191], v[236:239]
  v_mfma_f32_16x16x32_bf16 v[240:243], v[220:223], v[192:195], v[240:243]
  v_mfma_f32_16x16x32_bf16 v[244:247], v[220:223], v[196:199], v[244:247]
  v_mfma_f32_16x16x32_bf16 v[248:251], v[220:223], v[200:203], v[248:251]
  v_mfma_f32_16x16x32_bf16 v[252:255], v[220:223], v[204:207], v[252:255]
  s_nop 0
  v_add_f32 v208, v225, v224 row_ror:8 row_mask:0xf bank_mask:0x3
  v_add_f32 v209, v229, v228 row_ror:8 row_mask:0xf bank_mask:0x3
  v_add_f32 v210, v233, v232 row_ror:8 row_mask:0xf bank_mask:0x3
  v_add_f32 v211, v237, v236 row_ror:8 row_mask:0xf bank_mask:0x3
  v_add_f32 v208, v240, v241 row_ror:8 row_mask:0xf bank_mask:0xc
  v_add_f32 v209, v244, v245 row_ror:8 row_mask:0xf bank_mask:0xc
  v_add_f32 v210, v248, v249 row_ror:8 row_mask:0xf bank_mask:0xc
  v_add_f32 v211, v252, v253 row_ror:8 row_mask:0xf bank_mask:0xc
  v_fma_f32 v208, -v11, v28, v208
  v_fma_f32 v209, -v11, v29, v209
  v_or_b32 v208, 1, v208
  v_fma_f32 v210, -v11, v30, v210
  v_fma_f32 v211, -v11, v31, v211
  v_or_b32 v210, 1, v210
  s_mov_b64 exec, 0xffff
  buffer_store_dwordx4 v[208:211], v20, s[4:7], s21 offen offset:0 sc1
  s_mov_b64 exec, -1
  s_setprio 0
  s_cmp_eq_u32 s3, 0
  s_cbranch_scc1 .fz_kernel_hb68
  s_barrier
  s_sub_u32 s3, s3, 1
.fz_kernel_hb68:
.fz_kernel_c_ng:
  s_cmp_eq_u32 s20, 0
  s_cbranch_scc1 .fz_kernel_c_ng1
  buffer_load_dwordx4 v[200:203], v14, s[4:7], s23 offen
  s_branch .fz_kernel_c_ng2
.fz_kernel_c_ng1:
  s_cmp_eq_u32 s75, 0
  s_cbranch_scc1 .fz_kernel_c_ng2
  buffer_load_dwordx2 v[240:241], v16, s[4:7], s14 offen
  buffer_load_dwordx2 v[242:243], v16, s[4:7], s15 offen
.fz_kernel_c_ng2:
  s_cmp_ge_u32 s17, 14
  s_cbranch_scc1 .fz_kernel_c_g1
  ds_read_b64_tr_b16 v[80:81], v17 offset:0
  ds_read_b64_tr_b16 v[82:83], v17 offset:1024
  ds_read_b64_tr_b16 v[84:85], v17 offset:32
  ds_read_b64_tr_b16 v[86:87], v17 offset:1056
  ds_read_b64_tr_b16 v[88:89], v18 offset:0
  ds_read_b64_tr_b16 v[90:91], v18 offset:1024
  ds_read_b64_tr_b16 v[92:93], v18 offset:32
  ds_read_b64_tr_b16 v[94:95], v18 offset:1056
  ds_read_b64_tr_b16 v[96:97], v17 offset:2048
  ds_read_b64_tr_b16 v[98:99], v17 offset:3072
  ds_read_b64_tr_b16 v[100:101], v17 offset:2080
  ds_read_b64_tr_b16 v[102:103], v17 offset:3104
  ds_read_b64_tr_b16 v[104:105], v18 offset:2048
  s_cmp_eq_u32 s3, 0
  s_cbranch_scc1 .fz_kernel_hb79
  s_barrier
  s_sub_u32 s3, s3, 1
.fz_kernel_hb79:
  ds_read_b64_tr_b16 v[106:107], v18 offset:3072
  ds_read_b64_tr_b16 v[108:109], v18 offset:2080
  ds_read_b64_tr_b16 v[110:111], v18 offset:3104
  s_waitcnt lgkmcnt(4)
  ds_read_b64_tr_b16 v[112:113], v17 offset:4096
  ds_read_b64_tr_b16 v[114:115], v17 offset:5120
  ds_read_b64_tr_b16 v[116:117], v17 offset:4128
  ds_read_b64_tr_b16 v[118:119], v17 offset:5152
  ds_read_b64_tr_b16 v[120:121], v18 offset:4096
  ds_read_b64_tr_b16 v[122:123], v18 offset:5120
  ds_read_b64_tr_b16 v[124:125], v18 offset:4128
  ds_read_b64_tr_b16 v[126:127], v18 offset:5152
  ds_read_b64_tr_b16 v[128:129], v17 offset:6144
  ds_read_b64_tr_b16 v[130:131], v17 offset:7168
  ds_read_b64_tr_b16 v[132:133], v17 offset:6176
  ds_read_b64_tr_b16 v[134:135], v17 offset:7200
  ds_read_b64_tr_b16 v[136:137], v18 offset:6144
  ds_read_b64_tr_b16 v[138:139], v18 offset:7168
  s_cmp_eq_u32 s3, 0
  s_cbranch_scc1 .fz_kernel_hb80
  s_barrier
  s_sub_u32 s3, s3, 1
.fz_kernel_hb80:
  ds_read_b64_tr_b16 v[140:141], v18 offset:6176
  ds_read_b64_tr_b16 v[142:143], v18 offset:7200
.fz_kernel_c_g1:
  v_fma_f32 v15, -v11, v11, v15
  v_rsq_f32 v15, abs(v15)
  s_nop 0
  v_mul_f32 v179, v11, v15
  v_mul_f32 v15, 0x44800000, v15
  v_sub_f32 v179, 0, v179
  v_add_f32 v178, 1.0, v15
  v_mul_f32 v177, -1.4426950408889634, v15
  v_mul_f32 v15, v15, v15
  v_mul_f32 v1, v1, v15
  s_cmp_eq_u32 s75, 0
  s_cbranch_scc1 .fz_kernel_c_d0
  s_cmp_lg_u32 s20, 0
  s_cbranch_scc1 .fz_kernel_c_t2
  s_waitcnt vmcnt(0)
  s_call_b64 s[68:69], .fz_kernel_c_coef
  v_mov_b32 v9, 159952
  v_mov_b32 v7, s79
  ds_write_b64 v26, v[252:253] offset:6400
  ds_write_b64 v26, v[254:255] offset:6912
  ds_write_b32 v9, v7
  s_waitcnt lgkmcnt(0)
.fz_kernel_c_t2:
  s_barrier
.fz_kernel_c_d0:
  s_cmp_ge_u32 s17, 14
  s_cbranch_scc1 .fz_kernel_c_nd
  s_lshl_b32 s21, s26, 12
  s_add_u32 s21, s21, s72
  s_add_u32 s21, s21, 40960
  s_mul_i32 s27, s18, 28
  s_add_u32 s27, s27, s26
  s_lshl_b32 s27, s27, 8
  s_add_u32 s27, s27, s72
  s_add_u32 s27, s27, 155648
  s_cmp_eq_u32 s3, 0
  s_cbranch_scc1 .fz_kernel_hb70
  s_barrier
  s_sub_u32 s3, s3, 1
.fz_kernel_hb70:
  buffer_load_dwordx4 v[144:147], v21, s[4:7], s21 offen offset:0 sc1
  buffer_load_dwordx4 v[148:151], v21, s[4:7], s21 offen offset:512 sc1
  buffer_load_dwordx4 v[152:155], v21, s[4:7], s21 offen offset:1024 sc1
  buffer_load_dwordx4 v[156:159], v21, s[4:7], s21 offen offset:1536 sc1
  s_mov_b32 s38, 0
.fz_kernel_c_gu:
  s_mov_b32 s46, 0
  s_call_b64 s[0:1], .fz_kernel_hw
  s_waitcnt vmcnt(0)
  v_min3_u32 v9, v144, v146, v148
  v_min3_u32 v9, v9, v150, v152
  v_min3_u32 v9, v9, v154, v156
  v_min_u32 v9, v9, v158
  v_cmp_eq_u32 vcc, 0, v9
  v_add_f32 v160, v144, v148
  v_add_f32 v161, v145, v149
  v_add_f32 v162, v146, v150
  v_add_f32 v163, v147, v151
  s_cbranch_vccnz .fz_kernel_c_gur
.fz_kernel_c_gud:
  v_add_f32 v152, v152, v156
  v_add_f32 v153, v153, v157
  v_add_f32 v154, v154, v158
  v_add_f32 v155, v155, v159
  v_add_f32 v144, v152, v160
  v_add_f32 v145, v153, v161
  v_add_f32 v146, v154, v162
  v_add_f32 v147, v155, v163
  s_nop 0
  v_permlane32_swap_b32 v144, v146
  v_permlane32_swap_b32 v145, v147
  v_mul_f32 v148, v144, v177
  v_mul_f32 v149, v145, v177
  v_exp_f32 v148, v148
  s_cmp_eq_u32 s3, 0
  s_cbranch_scc1 .fz_kernel_hb81
  s_barrier
  s_sub_u32 s3, s3, 1
.fz_kernel_hb81:
  v_exp_f32 v149, v149
  v_mul_f32 v144, v144, v146
  v_add_f32 v148, 1.0, v148
  v_add_f32 v149, 1.0, v149
  v_rcp_f32 v148, v148
  v_rcp_f32 v149, v149
  v_mul_f32 v145, v145, v147
  v_mul_f32 v144, v144, v148
  v_mul_f32 v145, v145, v149
  v_cvt_pk_bf16_f32 v144, v144, v145
  s_waitcnt lgkmcnt(0)
  s_setprio 2
  v_mov_b32 v160, v144 row_newbcast:0 row_mask:0xf bank_mask:0xf
  v_mov_b32 v161, v144 row_newbcast:1 row_mask:0xf bank_mask:0xf
  v_mov_b32 v162, v144 row_newbcast:2 row_mask:0xf bank_mask:0xf
  v_mov_b32 v163, v144 row_newbcast:3 row_mask:0xf bank_mask:0xf
  v_mov_b32 v164, v144 row_newbcast:4 row_mask:0xf bank_mask:0xf
  v_mov_b32 v165, v144 row_newbcast:5 row_mask:0xf bank_mask:0xf
  v_mov_b32 v166, v144 row_newbcast:6 row_mask:0xf bank_mask:0xf
  v_mov_b32 v167, v144 row_newbcast:7 row_mask:0xf bank_mask:0xf
  v_mfma_f32_16x16x32_bf16 v[208:211], v[80:83], v[160:163], 0
  v_mfma_f32_16x16x32_bf16 v[212:215], v[84:87], v[160:163], 0
  v_mfma_f32_16x16x32_bf16 v[216:219], v[88:91], v[160:163], 0
  v_mfma_f32_16x16x32_bf16 v[220:223], v[92:95], v[160:163], 0
  v_mov_b32 v168, v144 row_newbcast:8 row_mask:0xf bank_mask:0xf
  v_mov_b32 v169, v144 row_newbcast:9 row_mask:0xf bank_mask:0xf
  v_mov_b32 v170, v144 row_newbcast:10 row_mask:0xf bank_mask:0xf
  v_mov_b32 v171, v144 row_newbcast:11 row_mask:0xf bank_mask:0xf
  v_mfma_f32_16x16x32_bf16 v[208:211], v[96:99], v[164:167], v[208:211]
  v_mfma_f32_16x16x32_bf16 v[212:215], v[100:103], v[164:167], v[212:215]
  v_mfma_f32_16x16x32_bf16 v[216:219], v[104:107], v[164:167], v[216:219]
  v_mfma_f32_16x16x32_bf16 v[220:223], v[108:111], v[164:167], v[220:223]
  v_mov_b32 v172, v144 row_newbcast:12 row_mask:0xf bank_mask:0xf
  v_mov_b32 v173, v144 row_newbcast:13 row_mask:0xf bank_mask:0xf
  v_mov_b32 v174, v144 row_newbcast:14 row_mask:0xf bank_mask:0xf
  v_mov_b32 v175, v144 row_newbcast:15 row_mask:0xf bank_mask:0xf
  v_mfma_f32_16x16x32_bf16 v[208:211], v[112:115], v[168:171], v[208:211]
  v_mfma_f32_16x16x32_bf16 v[212:215], v[116:119], v[168:171], v[212:215]
  v_mfma_f32_16x16x32_bf16 v[216:219], v[120:123], v[168:171], v[216:219]
  v_mfma_f32_16x16x32_bf16 v[220:223], v[124:127], v[168:171], v[220:223]
  v_mfma_f32_16x16x32_bf16 v[208:211], v[128:131], v[172:175], v[208:211]
  v_mfma_f32_16x16x32_bf16 v[212:215], v[132:135], v[172:175], v[212:215]
  v_mfma_f32_16x16x32_bf16 v[216:219], v[136:139], v[172:175], v[216:219]
  v_mfma_f32_16x16x32_bf16 v[220:223], v[140:143], v[172:175], v[220:223]
  s_mov_b32 exec_lo, 0x20002
  s_mov_b32 exec_hi, 0x20002
  s_nop 3
  v_mov_b32 v208, v212
  v_mov_b32 v209, v213
  v_mov_b32 v210, v214
  v_mov_b32 v211, v215
  s_mov_b32 exec_lo, 0x40004
  s_mov_b32 exec_hi, 0x40004
  v_mov_b32 v208, v216
  v_mov_b32 v209, v217
  v_mov_b32 v210, v218
  v_mov_b32 v211, v219
  s_mov_b32 exec_lo, 0x80008
  s_mov_b32 exec_hi, 0x80008
  v_mov_b32 v208, v220
  v_mov_b32 v209, v221
  v_mov_b32 v210, v222
  v_mov_b32 v211, v223
  s_mov_b32 exec_lo, 0xf000f
  s_mov_b32 exec_hi, 0xf000f
  v_or_b32 v208, 1, v208
  v_or_b32 v210, 1, v210
  buffer_store_dwordx4 v[208:211], v19, s[4:7], s27 offen sc1
  s_mov_b64 exec, -1
  s_setprio 0
.fz_kernel_c_nd:
  s_cmp_eq_u32 s75, 0
  s_cbranch_scc1 .fz_kernel_c_m0
  s_lshl_b32 s21, s17, 1
  s_add_u32 s21, s21, s20
  s_cmp_lg_u32 s21, 31
  s_cbranch_scc1 .fz_kernel_fin
  s_branch .fz_kernel_c_pp
.fz_kernel_c_m0:
  s_cmp_eq_u32 s79, 0
  s_cselect_b32 s21, 2, 0
  s_add_u32 s3, s3, s21
.fz_kernel_c_pp:
  s_cmp_eq_u32 s3, 0
  s_cbranch_scc1 .fz_kernel_hb82
  s_barrier
  s_sub_u32 s3, s3, 1
.fz_kernel_hb82:
  v_and_b32 v10, 7, v2
  v_lshlrev_b32 v10, 8, v10
  v_lshl_add_u32 v10, v12, 5, v10
  s_mul_i32 s21, s70, 7168
  s_add_u32 s21, s21, s72
  s_add_u32 s21, s21, 155648
  s_add_u32 s22, s21, 4096
  s_mov_b32 s24, 0x0f0f0f0f
  s_mov_b32 s25, 0x0f0f0f0f
  s_lshl_b32 s27, s18, 4
  s_add_u32 s27, s27, s17
  s_lshl_b32 s27, s27, 10
  s_add_u32 s27, s27, 0x1c84000
  v_mov_b32 v168, 1
  v_mov_b32 v169, 1
  v_mov_b32 v170, 1
  v_mov_b32 v171, 1
  v_mov_b32 v172, 1
  v_mov_b32 v173, 1
  v_mov_b32 v174, 1
  v_mov_b32 v175, 1
  s_cmp_eq_u32 s3, 0
  s_cbranch_scc1 .fz_kernel_hb71
  s_barrier
  s_sub_u32 s3, s3, 1
.fz_kernel_hb71:
  s_cmp_eq_u32 s3, 0
  s_cbranch_scc1 .fz_kernel_hb72
  s_barrier
  s_sub_u32 s3, s3, 1
.fz_kernel_hb72:
  buffer_load_dwordx4 v[144:147], v10, s[4:7], s21 offen offset:0 sc1
  buffer_load_dwordx4 v[148:151], v10, s[4:7], s21 offen offset:16 sc1
  buffer_load_dwordx4 v[152:155], v10, s[4:7], s21 offen offset:2048 sc1
  buffer_load_dwordx4 v[156:159], v10, s[4:7], s21 offen offset:2064 sc1
  buffer_load_dwordx4 v[160:163], v10, s[4:7], s22 offen offset:0 sc1
  buffer_load_dwordx4 v[164:167], v10, s[4:7], s22 offen offset:16 sc1
  s_mov_b64 exec, s[24:25]
  buffer_load_dwordx4 v[168:171], v10, s[4:7], s22 offen offset:2048 sc1
  buffer_load_dwordx4 v[172:175], v10, s[4:7], s22 offen offset:2064 sc1
  s_mov_b64 exec, -1
  s_mov_b32 s38, 0
  s_cmp_eq_u32 s20, 0
  s_cbranch_scc1 .fz_kernel_c_pu
  s_waitcnt vmcnt(8)
  v_lshlrev_b32 v184, 16, v200
  v_and_b32 v185, 0xffff0000, v200
  v_lshlrev_b32 v186, 16, v201
  v_and_b32 v187, 0xffff0000, v201
  v_lshlrev_b32 v188, 16, v202
  v_and_b32 v189, 0xffff0000, v202
  v_lshlrev_b32 v190, 16, v203
  v_and_b32 v191, 0xffff0000, v203
  v_fma_f32 v184, v184, v178, v179
  v_fma_f32 v185, v185, v178, v179
  v_fma_f32 v186, v186, v178, v179
  v_fma_f32 v187, v187, v178, v179
  v_fma_f32 v188, v188, v178, v179
  v_fma_f32 v189, v189, v178, v179
  v_fma_f32 v190, v190, v178, v179
  v_fma_f32 v191, v191, v178, v179
.fz_kernel_c_pu:
  s_mov_b32 s46, 0
  s_call_b64 s[0:1], .fz_kernel_hw
  s_waitcnt vmcnt(0)
  s_cmp_eq_u32 s3, 0
  s_cbranch_scc1 .fz_kernel_hb83
  s_barrier
  s_sub_u32 s3, s3, 1
.fz_kernel_hb83:
  v_min3_u32 v9, v144, v146, v148
  v_min3_u32 v9, v9, v150, v152
  v_min3_u32 v9, v9, v154, v156
  v_min3_u32 v9, v9, v158, v160
  v_min3_u32 v9, v9, v162, v164
  v_min3_u32 v9, v9, v166, v168
  v_min3_u32 v9, v9, v170, v172
  v_min_u32 v9, v9, v174
  v_cmp_eq_u32 vcc, 0, v9
  v_add_f32 v236, v144, v152
  v_add_f32 v237, v145, v153
  v_add_f32 v238, v146, v154
  v_add_f32 v239, v147, v155
  s_cbranch_vccnz .fz_kernel_c_pur
.fz_kernel_c_pud:
  v_add_f32 v240, v148, v156
  v_add_f32 v241, v149, v157
  v_add_f32 v242, v150, v158
  v_add_f32 v243, v151, v159
  v_add_f32 v160, v160, v168
  v_add_f32 v161, v161, v169
  v_add_f32 v162, v162, v170
  v_add_f32 v163, v163, v171
  v_add_f32 v164, v164, v172
  v_add_f32 v165, v165, v173
  v_add_f32 v166, v166, v174
  v_add_f32 v167, v167, v175
  v_add_f32 v144, v236, v160
  v_add_f32 v145, v237, v161
  v_add_f32 v146, v238, v162
  v_add_f32 v147, v239, v163
  v_add_f32 v148, v240, v164
  v_add_f32 v149, v241, v165
  v_add_f32 v150, v242, v166
  v_add_f32 v151, v243, v167
  v_add_f32 v144, v144, v144 quad_perm:[1,0,3,2] row_mask:0xf bank_mask:0xf
  v_add_f32 v145, v145, v145 quad_perm:[1,0,3,2] row_mask:0xf bank_mask:0xf
  s_cmp_eq_u32 s3, 0
  s_cbranch_scc1 .fz_kernel_hb84
  s_barrier
  s_sub_u32 s3, s3, 1
.fz_kernel_hb84:
  v_add_f32 v146, v146, v146 quad_perm:[1,0,3,2] row_mask:0xf bank_mask:0xf
  v_add_f32 v147, v147, v147 quad_perm:[1,0,3,2] row_mask:0xf bank_mask:0xf
  v_add_f32 v148, v148, v148 quad_perm:[1,0,3,2] row_mask:0xf bank_mask:0xf
  v_add_f32 v149, v149, v149 quad_perm:[1,0,3,2] row_mask:0xf bank_mask:0xf
  v_add_f32 v150, v150, v150 quad_perm:[1,0,3,2] row_mask:0xf bank_mask:0xf
  v_add_f32 v151, v151, v151 quad_perm:[1,0,3,2] row_mask:0xf bank_mask:0xf
  v_add_f32 v144, v144, v144 quad_perm:[2,3,0,1] row_mask:0xf bank_mask:0xf
  v_add_f32 v145, v145, v145 quad_perm:[2,3,0,1] row_mask:0xf bank_mask:0xf
  v_add_f32 v146, v146, v146 quad_perm:[2,3,0,1] row_mask:0xf bank_mask:0xf
  v_add_f32 v147, v147, v147 quad_perm:[2,3,0,1] row_mask:0xf bank_mask:0xf
  v_add_f32 v148, v148, v148 quad_perm:[2,3,0,1] row_mask:0xf bank_mask:0xf
  v_add_f32 v149, v149, v149 quad_perm:[2,3,0,1] row_mask:0xf bank_mask:0xf
  v_add_f32 v150, v150, v150 quad_perm:[2,3,0,1] row_mask:0xf bank_mask:0xf
  v_add_f32 v151, v151, v151 quad_perm:[2,3,0,1] row_mask:0xf bank_mask:0xf
  v_add_f32 v144, v144, v144 row_half_mirror row_mask:0xf bank_mask:0xf
  v_add_f32 v145, v145, v145 row_half_mirror row_mask:0xf bank_mask:0xf
  v_add_f32 v146, v146, v146 row_half_mirror row_mask:0xf bank_mask:0xf
  v_add_f32 v147, v147, v147 row_half_mirror row_mask:0xf bank_mask:0xf
  v_add_f32 v148, v148, v148 row_half_mirror row_mask:0xf bank_mask:0xf
  v_add_f32 v149, v149, v149 row_half_mirror row_mask:0xf bank_mask:0xf
  v_add_f32 v150, v150, v150 row_half_mirror row_mask:0xf bank_mask:0xf
  v_add_f32 v151, v151, v151 row_half_mirror row_mask:0xf bank_mask:0xf
  v_mul_f32 v144, v144, v1
  v_mul_f32 v145, v145, v1
  v_mul_f32 v146, v146, v1
  v_mul_f32 v147, v147, v1
  v_mul_f32 v148, v148, v1
  v_mul_f32 v149, v149, v1
  v_mul_f32 v150, v150, v1
  v_mul_f32 v151, v151, v1
  v_cvt_pk_bf16_f32 v180, v144, v145
  v_cvt_pk_bf16_f32 v181, v146, v147
  v_cvt_pk_bf16_f32 v182, v148, v149
  v_cvt_pk_bf16_f32 v183, v150, v151
  s_or_b32 s21, s75, s71
  s_cbranch_scc1 .fz_kernel_c_w7
  s_mul_i32 s21, s20, 384
  s_add_u32 s21, s21, s27
  s_setprio 2
  v_mfma_f32_16x16x32_bf16 v[208:211], v[180:183], v[32:35], 0
  v_mov_b32 v232, v180 row_ror:8 row_mask:0xf bank_mask:0xf
  v_mfma_f32_16x16x32_bf16 v[212:215], v[180:183], v[36:39], 0
  v_mov_b32 v233, v181 row_ror:8 row_mask:0xf bank_mask:0xf
  v_mfma_f32_16x16x32_bf16 v[216:219], v[180:183], v[40:43], 0
  v_mov_b32 v234, v182 row_ror:8 row_mask:0xf bank_mask:0xf
  v_mfma_f32_16x16x32_bf16 v[220:223], v[180:183], v[44:47], 0
  v_mov_b32 v235, v183 row_ror:8 row_mask:0xf bank_mask:0xf
  v_mfma_f32_16x16x32_bf16 v[224:227], v[180:183], v[48:51], 0
  v_mfma_f32_16x16x32_bf16 v[228:231], v[180:183], v[52:55], 0
  v_mfma_f32_16x16x32_bf16 v[208:211], v[232:235], v[56:59], v[208:211]
  v_mfma_f32_16x16x32_bf16 v[212:215], v[232:235], v[60:63], v[212:215]
  v_mfma_f32_16x16x32_bf16 v[216:219], v[232:235], v[64:67], v[216:219]
  v_mfma_f32_16x16x32_bf16 v[220:223], v[232:235], v[68:71], v[220:223]
  v_mfma_f32_16x16x32_bf16 v[224:227], v[232:235], v[72:75], v[224:227]
  v_mfma_f32_16x16x32_bf16 v[228:231], v[232:235], v[76:79], v[228:231]
  s_nop 2
  v_or_b32 v208, 1, v208
  v_mov_b32 v209, v212
  v_or_b32 v210, 1, v216
  v_mov_b32 v211, v220
  s_mov_b64 exec, 0xffff
  buffer_store_dwordx4 v[208:211], v3, s[4:7], s21 offen offset:0 sc1
  v_or_b32 v224, 1, v224
  v_mov_b32 v225, v228
  buffer_store_dwordx2 v[224:225], v16, s[4:7], s21 offen offset:256 sc1
  s_mov_b64 exec, -1
  s_setprio 0
  s_cmp_lg_u32 s20, 0
  s_cbranch_scc1 .fz_kernel_c_w7
  s_cmp_eq_u32 s79, 0
  s_cbranch_scc1 .fz_kernel_c_no2
  s_cmp_eq_u32 s3, 0
  s_cbranch_scc1 .fz_kernel_hb85
  s_barrier
  s_sub_u32 s3, s3, 1
.fz_kernel_hb85:
  v_add_u32 v13, 155648, v3
  s_lshl_b32 s21, s18, 14
  s_add_u32 s21, s21, 0x1c84000
  s_add_u32 s22, s21, 4096
  s_add_u32 s23, s21, 8192
  s_add_u32 s24, s21, 12288
  v_rcp_f32 v144, v178
  v_lshlrev_b32 v146, 1, v2
  v_sub_u32 v146, s79, v146
  v_cmp_eq_u32 s[28:29], 1, v146
  v_cmp_eq_u32 s[30:31], 2, v146
  s_nop 0
  v_cndmask_b32 v148, 0, v144, s[28:29]
  v_cndmask_b32 v149, 0, v144, s[30:31]
  s_bfm_b64 exec, 49, 0
  s_mov_b32 s38, 0
.fz_kernel_c_pd:
  buffer_load_dwordx4 v[80:83], v3, s[4:7], s21 offen offset:0 sc1
  buffer_load_dwordx4 v[84:87], v3, s[4:7], s21 offen offset:1024 sc1
  buffer_load_dwordx4 v[88:91], v3, s[4:7], s21 offen offset:2048 sc1
  buffer_load_dwordx4 v[92:95], v3, s[4:7], s21 offen offset:3072 sc1
  buffer_load_dwordx4 v[96:99], v3, s[4:7], s22 offen offset:0 sc1
  buffer_load_dwordx4 v[100:103], v3, s[4:7], s22 offen offset:1024 sc1
  buffer_load_dwordx4 v[104:107], v3, s[4:7], s22 offen offset:2048 sc1
  buffer_load_dwordx4 v[108:111], v3, s[4:7], s22 offen offset:3072 sc1
  buffer_load_dwordx4 v[112:115], v3, s[4:7], s23 offen offset:0 sc1
  buffer_load_dwordx4 v[116:119], v3, s[4:7], s23 offen offset:1024 sc1
  buffer_load_dwordx4 v[120:123], v3, s[4:7], s23 offen offset:2048 sc1
  s_cmp_eq_u32 s3, 0
  s_cbranch_scc1 .fz_kernel_hb86
  s_barrier
  s_sub_u32 s3, s3, 1
.fz_kernel_hb86:
  buffer_load_dwordx4 v[124:127], v3, s[4:7], s23 offen offset:3072 sc1
  buffer_load_dwordx4 v[128:131], v3, s[4:7], s24 offen offset:0 sc1
  buffer_load_dwordx4 v[132:135], v3, s[4:7], s24 offen offset:1024 sc1
  buffer_load_dwordx4 v[136:139], v3, s[4:7], s24 offen offset:2048 sc1
  buffer_load_dwordx4 v[140:143], v3, s[4:7], s24 offen offset:3072 sc1
  s_add_u32 s38, s38, 1
  s_mov_b32 s46, 0
  s_call_b64 s[0:1], .fz_kernel_hw
  s_waitcnt vmcnt(0)
  v_min3_u32 v9, v80, v82, v84
  v_min3_u32 v9, v9, v86, v88
  v_min3_u32 v9, v9, v90, v92
  v_min3_u32 v9, v9, v94, v96
  v_min3_u32 v9, v9, v98, v100
  v_min3_u32 v9, v9, v102, v104
  v_min3_u32 v9, v9, v106, v108
  v_min3_u32 v9, v9, v110, v112
  v_min3_u32 v9, v9, v114, v116
  v_min3_u32 v9, v9, v118, v120
  v_min3_u32 v9, v9, v122, v124
  v_min3_u32 v9, v9, v126, v128
  v_min3_u32 v9, v9, v130, v132
  v_min3_u32 v9, v9, v134, v136
  v_min3_u32 v9, v9, v138, v140
  v_min_u32 v9, v9, v142
  v_cmp_eq_u32 vcc, 0, v9
  s_cbranch_vccz .fz_kernel_c_pdd
  s_cmp_lt_u32 s38, 131072
  s_cbranch_scc1 .fz_kernel_c_pd
.fz_kernel_c_pdd:
  v_add_f32 v80, v80, v112
  v_add_f32 v81, v81, v113
  v_add_f32 v82, v82, v114
  v_add_f32 v83, v83, v115
  v_add_f32 v84, v84, v116
  s_cmp_eq_u32 s3, 0
  s_cbranch_scc1 .fz_kernel_hb87
  s_barrier
  s_sub_u32 s3, s3, 1
.fz_kernel_hb87:
  v_add_f32 v85, v85, v117
  v_add_f32 v86, v86, v118
  v_add_f32 v87, v87, v119
  v_add_f32 v88, v88, v120
  v_add_f32 v89, v89, v121
  v_add_f32 v90, v90, v122
  v_add_f32 v91, v91, v123
  v_add_f32 v92, v92, v124
  v_add_f32 v93, v93, v125
  v_add_f32 v94, v94, v126
  v_add_f32 v95, v95, v127
  v_add_f32 v96, v96, v128
  v_add_f32 v97, v97, v129
  v_add_f32 v98, v98, v130
  v_add_f32 v99, v99, v131
  v_add_f32 v100, v100, v132
  v_add_f32 v101, v101, v133
  v_add_f32 v102, v102, v134
  v_add_f32 v103, v103, v135
  v_add_f32 v104, v104, v136
  v_add_f32 v105, v105, v137
  v_add_f32 v106, v106, v138
  v_add_f32 v107, v107, v139
  v_add_f32 v108, v108, v140
  v_add_f32 v109, v109, v141
  v_add_f32 v110, v110, v142
  v_add_f32 v111, v111, v143
  v_add_f32 v80, v80, v96
  v_add_f32 v81, v81, v97
  v_add_f32 v82, v82, v98
  v_add_f32 v83, v83, v99
  v_add_f32 v84, v84, v100
  v_add_f32 v85, v85, v101
  v_add_f32 v86, v86, v102
  v_add_f32 v87, v87, v103
  v_add_f32 v88, v88, v104
  s_cmp_eq_u32 s3, 0
  s_cbranch_scc1 .fz_kernel_hb88
  s_barrier
  s_sub_u32 s3, s3, 1
.fz_kernel_hb88:
  v_add_f32 v89, v89, v105
  v_add_f32 v90, v90, v106
  v_add_f32 v91, v91, v107
  v_add_f32 v92, v92, v108
  v_add_f32 v93, v93, v109
  v_add_f32 v94, v94, v110
  v_add_f32 v95, v95, v111
  v_add_f32 v80, v80, v88
  v_add_f32 v81, v81, v89
  v_add_f32 v82, v82, v90
  v_add_f32 v83, v83, v91
  v_add_f32 v84, v84, v92
  v_add_f32 v85, v85, v93
  v_add_f32 v86, v86, v94
  v_add_f32 v87, v87, v95
  v_add_f32 v80, v80, v84
  v_add_f32 v81, v81, v85
  v_add_f32 v82, v82, v86
  v_add_f32 v83, v83, v87
  s_mov_b64 exec, -1
  v_readlane_b32 s21, v80, 48
  v_readlane_b32 s22, v82, 48
  s_nop 0
  v_mul_f32 v144, s21, v23
  v_fma_f32 v145, s22, v23, v25
  v_fma_f32 v145, -v144, v144, v145
  v_rsq_f32 v145, abs(v145)
  v_sub_f32 v144, v179, v144
  v_mul_f32 v146, v145, v178
  v_mul_f32 v147, v145, v144
  s_lshl_b32 s21, s79, 2
  s_add_u32 s21, s21, 155644
  v_mov_b32 v9, s21
  ds_write_b32 v9, v146 offset:4608
  ds_write_b32 v9, v147 offset:5120
  s_cmp_eq_u32 s3, 0
  s_cbranch_scc1 .fz_kernel_hb89
  s_barrier
  s_sub_u32 s3, s3, 1
.fz_kernel_hb89:
  v_mov_b32 v9, 159952
  v_mov_b32 v7, s79
  ds_write_b32 v9, v7
  ds_write_b64 v26, v[148:149] offset:512
  s_mov_b32 exec_hi, 0xffff
  ds_write_b128 v13, v[80:83] offset:1536
  s_mov_b64 exec, -1
  s_waitcnt lgkmcnt(0)
  s_add_u32 s3, s3, 2
.fz_kernel_c_no2:
  s_branch .fz_kernel_q_he
.fz_kernel_c_w7:
  v_lshlrev_b32 v144, 16, v180
  v_and_b32 v145, 0xffff0000, v180
  v_lshlrev_b32 v146, 16, v181
  v_and_b32 v147, 0xffff0000, v181
  v_lshlrev_b32 v148, 16, v182
  v_and_b32 v149, 0xffff0000, v182
  v_lshlrev_b32 v150, 16, v183
  v_and_b32 v151, 0xffff0000, v183
  s_cmp_lg_u32 s71, 0
  s_cbranch_scc1 .fz_kernel_c_eu
  v_add_f32 v184, v184, v144
  v_add_f32 v185, v185, v145
  v_add_f32 v186, v186, v146
  v_add_f32 v187, v187, v147
  v_add_f32 v188, v188, v148
  v_add_f32 v189, v189, v149
  v_add_f32 v190, v190, v150
  v_add_f32 v191, v191, v151
  s_cmp_lg_u32 s75, 0
  s_cbranch_scc1 .fz_kernel_c_t3
  v_mul_f32 v152, v184, v184
  v_add_f32 v154, v184, v185
  v_fmac_f32 v152, v185, v185
  v_fmac_f32 v152, v186, v186
  v_add_f32 v154, v154, v186
  v_fmac_f32 v152, v187, v187
  v_add_f32 v154, v154, v187
  s_cmp_eq_u32 s3, 0
  s_cbranch_scc1 .fz_kernel_hb90
  s_barrier
  s_sub_u32 s3, s3, 1
.fz_kernel_hb90:
  v_fmac_f32 v152, v188, v188
  v_add_f32 v154, v154, v188
  v_fmac_f32 v152, v189, v189
  v_add_f32 v154, v154, v189
  v_fmac_f32 v152, v190, v190
  v_add_f32 v154, v154, v190
  v_fmac_f32 v152, v191, v191
  v_add_f32 v154, v154, v191
  v_lshrrev_b32 v9, 5, v2
  v_lshlrev_b32 v9, 3, v9
  v_permlane32_swap_b32 v154, v152
  v_add_f32 v154, v154, v152
  s_nop 1
  v_add_f32 v154, v154, v154 row_ror:8 row_mask:0xf bank_mask:0xf
  s_nop 1
  v_add_f32 v154, v154, v154 row_bcast:15 row_mask:0xa bank_mask:0xf
  v_or_b32 v154, 1, v154
  s_mov_b32 exec_lo, 0x10000
  s_mov_b32 exec_hi, 0x10000
  buffer_store_dword v154, v9, s[4:7], s27 offen offset:768 sc1
  s_mov_b64 exec, -1
  s_cmp_eq_u32 s79, 0
  s_cbranch_scc1 .fz_kernel_q_he
  s_add_u32 s3, s3, 2
  s_mov_b32 s71, 1
  s_mov_b32 s70, s18
  s_branch .fz_kernel_c_pp
.fz_kernel_c_eu:
  v_lshlrev_b32 v9, 5, v12
  v_add_u32 v9, 155648, v9
  s_mov_b32 exec_lo, 0x01010101
  s_mov_b32 exec_hi, 0x01010101
  ds_write_b128 v9, v[144:147] offset:7424
  ds_write_b128 v9, v[148:151] offset:7440
  s_mov_b64 exec, -1
  s_waitcnt lgkmcnt(0)
  s_branch .fz_kernel_q_he
.fz_kernel_c_t3:
  s_mov_b32 s28, s56
  s_mov_b32 s29, s57
  s_mov_b32 s30, 0x400000
  s_mov_b32 s31, 0x00020000
  v_cvt_pk_bf16_f32 v144, v184, v185
  v_cvt_pk_bf16_f32 v145, v186, v187
  v_cvt_pk_bf16_f32 v146, v188, v189
  v_cvt_pk_bf16_f32 v147, v190, v191
  s_cmp_eq_u32 s3, 0
  s_cbranch_scc1 .fz_kernel_hb91
  s_barrier
  s_sub_u32 s3, s3, 1
.fz_kernel_hb91:
  v_lshlrev_b32 v9, 4, v12
  s_lshl_b32 s21, s77, 11
  s_lshl_b32 s22, s18, 7
  s_add_u32 s21, s21, s22
  s_mov_b32 exec_lo, 0x01010101
  s_mov_b32 exec_hi, 0x01010101
  buffer_store_dwordx4 v[144:147], v9, s[28:31], s21 offen
  s_mov_b64 exec, -1
.fz_kernel_fin:
.fz_kernel_end:
  s_endpgm
.fz_kernel_pick:
  s_mov_b32 s33, 1
  s_cmp_eq_u32 s34, 0xffff
  s_cselect_b32 s35, 0x40000000, s35
  s_cbranch_scc1 .fz_kernel_pick_ret
  s_mov_b32 s38, 0
.fz_kernel_pick_l:
  ds_read_b32 v7, v6
  s_add_u32 s38, s38, 1
  s_waitcnt lgkmcnt(0)
  v_readfirstlane_b32 s36, v7
  s_andn2_b32 s33, s36, s34
  s_cbranch_scc1 .fz_kernel_pick_ret
  s_cmp_lt_u32 s38, 1048576
  s_cbranch_scc1 .fz_kernel_pick_l
  s_mov_b32 s36, 0xffff
  s_andn2_b32 s33, s36, s34
.fz_kernel_pick_ret:
  s_nop 4
  s_setpc_b64 s[68:69]
.fz_kernel_hw:
  s_mov_b32 s47, 0
.fz_kernel_hwl:
  s_getreg_b32 s100, hwreg(HW_REG_IB_STS)
  s_bfe_u32 s101, s100, 0x20016
  s_and_b32 s100, s100, 15
  s_lshl4_add_u32 s100, s101, s100
  s_cmp_le_u32 s100, s46
  s_cbranch_scc1 .fz_kernel_hwr
  s_sub_u32 s47, s47, 1
  s_cbranch_scc0 .fz_kernel_hwl
  s_cmp_eq_u32 s3, 0
  s_cbranch_scc1 .fz_kernel_hwr
  s_cmp_eq_u32 s3, 32
  s_cbranch_scc1 .fz_kernel_hwp
.fz_kernel_hwb:
  s_barrier
  s_sub_u32 s3, s3, 1
  s_mov_b32 s47, 2
  s_branch .fz_kernel_hwl
.fz_kernel_hwr:
  s_setpc_b64 s[0:1]
  .fz_kernel_hwp:
  ds_read_b32 v27, v6 offset:0x110
  s_mov_b32 s47, 0
  s_waitcnt lgkmcnt(0)
  v_readfirstlane_b32 s100, v27
  s_cmp_ge_u32 s100, 0x200
  s_cbranch_scc1 .fz_kernel_hwb
  s_branch .fz_kernel_hwl
.fz_kernel_q_cons2:
  s_setprio 0
  s_lshr_b32 s26, s16, 1
  s_lshl_b32 s28, s26, 13
  v_add_u32 v8, s28, v3
  v_add_u32 v9, 1024, v8
  v_mov_b32 v232, v20
  v_mov_b32 v233, v21
  v_mov_b32 v234, v22
  v_mov_b32 v235, v23
  v_mov_b32 v236, v24
  v_mov_b32 v237, v25
  v_mov_b32 v238, v26
  v_mov_b32 v239, v27
  v_mov_b32 v240, v28
  v_mov_b32 v241, v29
  v_mov_b32 v242, v30
  v_mov_b32 v243, v31
  v_mov_b32 v244, v32
  v_mov_b32 v245, v33
  v_mov_b32 v246, v34
  v_mov_b32 v247, v35
  s_branch .fz_kernel_q_cs
.fz_kernel_q_patch:
  s_mul_i32 s31, s27, 384
  s_add_u32 s31, s31, 155648
  v_and_b32 v73, 48, v2
  v_lshlrev_b32 v73, 2, v73
  v_add_u32 v73, s31, v73
  v_and_b32 v75, 15, v2
  v_lshlrev_b32 v75, 3, v75
  v_add_u32 v75, s31, v75
  ds_read_b32 v72, v14 offset:512
  ds_read_b32 v74, v14 offset:576
  ds_read_b32 v76, v14 offset:640
  ds_read_b32 v78, v14 offset:704
  ds_read_b128 v[80:83], v73 offset:1536
  ds_read_b128 v[84:87], v73 offset:1552
  ds_read_b128 v[88:91], v73 offset:1568
  ds_read_b128 v[92:95], v73 offset:1584
  s_waitcnt lgkmcnt(0)
  v_fmac_f32 v160, v82, v72
  v_fmac_f32 v161, v86, v72
  v_fmac_f32 v162, v90, v72
  v_fmac_f32 v163, v94, v72
  v_fmac_f32 v164, v82, v74
  v_fmac_f32 v165, v86, v74
  v_fmac_f32 v166, v90, v74
  v_fmac_f32 v167, v94, v74
  v_fmac_f32 v168, v82, v76
  v_fmac_f32 v169, v86, v76
  v_fmac_f32 v170, v90, v76
  v_fmac_f32 v171, v94, v76
  v_fmac_f32 v172, v82, v78
  v_fmac_f32 v173, v86, v78
  v_fmac_f32 v174, v90, v78
  v_fmac_f32 v175, v94, v78
  v_fmac_f32 v176, v83, v72
  v_fmac_f32 v177, v87, v72
  v_fmac_f32 v178, v91, v72
  v_fmac_f32 v179, v95, v72
  v_fmac_f32 v180, v83, v74
  v_fmac_f32 v181, v87, v74
  v_fmac_f32 v182, v91, v74
  v_fmac_f32 v183, v95, v74
  v_fmac_f32 v184, v83, v76
  v_fmac_f32 v185, v87, v76
  v_fmac_f32 v186, v91, v76
  v_fmac_f32 v187, v95, v76
  v_fmac_f32 v188, v83, v78
  v_fmac_f32 v189, v87, v78
  v_fmac_f32 v190, v91, v78
  v_fmac_f32 v191, v95, v78
  v_fmac_f32 v128, v80, v72
  v_fmac_f32 v129, v84, v72
  v_fmac_f32 v130, v88, v72
  v_fmac_f32 v131, v92, v72
  v_fmac_f32 v132, v80, v74
  v_fmac_f32 v133, v84, v74
  v_fmac_f32 v134, v88, v74
  v_fmac_f32 v135, v92, v74
  v_fmac_f32 v136, v80, v76
  v_fmac_f32 v137, v84, v76
  v_fmac_f32 v138, v88, v76
  v_fmac_f32 v139, v92, v76
  v_fmac_f32 v140, v80, v78
  v_fmac_f32 v141, v84, v78
  v_fmac_f32 v142, v88, v78
  v_fmac_f32 v143, v92, v78
  v_fmac_f32 v144, v81, v72
  v_fmac_f32 v145, v85, v72
  v_fmac_f32 v146, v89, v72
  v_fmac_f32 v147, v93, v72
  v_fmac_f32 v148, v81, v74
  v_fmac_f32 v149, v85, v74
  v_fmac_f32 v150, v89, v74
  v_fmac_f32 v151, v93, v74
  v_fmac_f32 v152, v81, v76
  v_fmac_f32 v153, v85, v76
  v_fmac_f32 v154, v89, v76
  v_fmac_f32 v155, v93, v76
  v_fmac_f32 v156, v81, v78
  v_fmac_f32 v157, v85, v78
  v_fmac_f32 v158, v89, v78
  v_fmac_f32 v159, v93, v78
  ds_read_b128 v[80:83], v15 offset:512
  ds_read_b128 v[84:87], v15 offset:576
  ds_read_b128 v[88:91], v15 offset:640
  ds_read_b128 v[92:95], v15 offset:704
  ds_read_b64 v[72:73], v75 offset:1792
  s_waitcnt lgkmcnt(0)
  v_fmac_f32 v192, v80, v72
  v_fmac_f32 v193, v81, v72
  v_fmac_f32 v194, v82, v72
  v_fmac_f32 v195, v83, v72
  v_fmac_f32 v196, v84, v72
  v_fmac_f32 v197, v85, v72
  v_fmac_f32 v198, v86, v72
  v_fmac_f32 v199, v87, v72
  v_fmac_f32 v200, v88, v72
  v_fmac_f32 v201, v89, v72
  v_fmac_f32 v202, v90, v72
  v_fmac_f32 v203, v91, v72
  v_fmac_f32 v204, v92, v72
  v_fmac_f32 v205, v93, v72
  v_fmac_f32 v206, v94, v72
  v_fmac_f32 v207, v95, v72
  v_fmac_f32 v208, v80, v73
  v_fmac_f32 v209, v81, v73
  v_fmac_f32 v210, v82, v73
  v_fmac_f32 v211, v83, v73
  v_fmac_f32 v212, v84, v73
  v_fmac_f32 v213, v85, v73
  v_fmac_f32 v214, v86, v73
  v_fmac_f32 v215, v87, v73
  v_fmac_f32 v216, v88, v73
  v_fmac_f32 v217, v89, v73
  v_fmac_f32 v218, v90, v73
  v_fmac_f32 v219, v91, v73
  v_fmac_f32 v220, v92, v73
  v_fmac_f32 v221, v93, v73
  v_fmac_f32 v222, v94, v73
  v_fmac_f32 v223, v95, v73
  s_branch .fz_kernel_q_pback
.fz_kernel_q_prod2:
  s_mov_b64 s[8:9], s[4:5]
  s_mov_b64 s[10:11], s[6:7]
  s_lshl_b32 s35, s17, 6
  s_and_b32 s31, s16, 1
  s_add_u32 s35, s35, s31
  s_lshl_b32 s35, s35, 12
  s_add_u32 s35, s35, s73
  s_lshr_b32 s33, s17, 3
  s_add_u32 s29, s18, s33
  s_lshl1_add_u32 s29, s17, s29
  s_and_b32 s29, s29, 15
  s_mov_b32 s22, 16384
  s_mov_b32 s23, 8192
  s_mov_b32 s36, 0
  s_add_u32 s37, s19, s74
  s_add_u32 s37, s37, 8
  v_mov_b32 v40, v3
  v_mov_b32 v41, v3
  v_mov_b32 v42, v3
  v_mov_b32 v43, v3
  s_branch .fz_kernel_q_pc
.fz_kernel_xok1w:
  s_call_b64 s[68:69], .fz_kernel_q_xw
  s_branch .fz_kernel_xok1
.fz_kernel_xok2w:
  s_call_b64 s[68:69], .fz_kernel_q_xw
  s_branch .fz_kernel_xok2
.fz_kernel_q_xw:
  s_mov_b64 exec, 1
  s_mov_b32 s38, 0
.fz_kernel_q_xwl:
  buffer_load_dword v11, v4, s[4:7], s37 offen sc1
  s_add_u32 s38, s38, 1
  s_waitcnt vmcnt(0)
  v_readfirstlane_b32 s36, v11
  s_bitcmp1_b32 s36, s24
  s_cbranch_scc1 .fz_kernel_q_xwd
  s_cmp_lt_u32 s38, 131072
  s_cbranch_scc1 .fz_kernel_q_xwl
  s_mov_b32 s36, -1
.fz_kernel_q_xwd:
  s_mov_b64 exec, -1
  s_nop 4
  s_setpc_b64 s[68:69]
.fz_kernel_xok3w:
  s_call_b64 s[68:69], .fz_kernel_q_xw
  s_branch .fz_kernel_xok3
.fz_kernel_lz20a:
  v_lshlrev_b32 v16, 3, v2
  buffer_atomic_and_x2 v[12:13], v16, s[4:7], s36 offen offset:0 sc1
  buffer_atomic_and_x2 v[12:13], v16, s[4:7], s36 offen offset:512 sc1
  buffer_atomic_and_x2 v[12:13], v16, s[4:7], s36 offen offset:1024 sc1
  buffer_atomic_and_x2 v[12:13], v16, s[4:7], s36 offen offset:1536 sc1
  buffer_atomic_and_x2 v[12:13], v16, s[4:7], s36 offen offset:2048 sc1
  buffer_atomic_and_x2 v[12:13], v16, s[4:7], s36 offen offset:2560 sc1
  buffer_atomic_and_x2 v[12:13], v16, s[4:7], s36 offen offset:3072 sc1
  buffer_atomic_and_x2 v[12:13], v16, s[4:7], s36 offen offset:3584 sc1
  s_branch .fz_kernel_lz20
.fz_kernel_a_pick:
  s_cmp_eq_u32 s34, 0xffff
  s_cbranch_scc1 .fz_kernel_a_picke
  s_mov_b32 s38, 0
.fz_kernel_a_pickl:
  ds_read_b32 v7, v6
  s_add_u32 s38, s38, 1
  s_waitcnt lgkmcnt(0)
  v_readfirstlane_b32 s33, v7
  s_cmp_lt_u32 s38, 1048576
  s_cselect_b32 s33, s33, 0xffff
  s_andn2_b32 s36, s33, s34
  s_cbranch_scc0 .fz_kernel_a_pickl
  s_or_b32 s34, s34, s33
  s_ff1_i32_b32 s33, s36
  s_bitset0_b32 s36, s33
  s_lshl_b32 s33, s33, 14
  s_add_u32 s30, s33, s35
  s_setpc_b64 s[68:69]
.fz_kernel_a_picke:
  s_mov_b32 s30, 0x40000000
  ds_write_b32 v6, v5 offset:0x104
  s_setpc_b64 s[68:69]
.fz_kernel_pk26c:
  s_call_b64 s[68:69], .fz_kernel_a_pick
  s_branch .fz_kernel_pk26
.fz_kernel_pk27c:
  s_call_b64 s[68:69], .fz_kernel_a_pick
  s_branch .fz_kernel_pk27
.fz_kernel_pk28c:
  s_call_b64 s[68:69], .fz_kernel_a_pick
  s_branch .fz_kernel_pk28
.fz_kernel_pk31c:
  s_call_b64 s[68:69], .fz_kernel_a_pick
  s_branch .fz_kernel_pk31
.fz_kernel_pk32c:
  s_call_b64 s[68:69], .fz_kernel_a_pick
  s_branch .fz_kernel_pk32
.fz_kernel_a_slow:
  s_cmp_lg_u32 s73, 0
  s_cbranch_scc1 .fz_kernel_a_ok
  s_mov_b32 s73, 1
  s_call_b64 s[68:69], .fz_kernel_a_sl
  v_mov_b32 v32, v33
  v_mov_b32 v176, v144
  v_mov_b32 v177, v145
  v_mov_b32 v178, v146
  v_mov_b32 v179, v147
  v_mov_b32 v180, v148
  v_mov_b32 v181, v149
  v_mov_b32 v182, v150
  v_mov_b32 v183, v151
  v_mov_b32 v184, v152
  v_mov_b32 v185, v153
  v_mov_b32 v186, v154
  v_mov_b32 v187, v155
  v_mov_b32 v188, v156
  v_mov_b32 v189, v157
  v_mov_b32 v190, v158
  v_mov_b32 v191, v159
  v_mov_b32 v16, v24
  v_mov_b32 v17, v25
  v_mov_b32 v18, v26
  v_mov_b32 v19, v27
  v_mov_b32 v20, v28
  v_mov_b32 v21, v29
  v_mov_b32 v22, v30
  v_mov_b32 v23, v31
  s_call_b64 s[68:69], .fz_kernel_a_sl
  v_mov_b32 v160, v144
  v_mov_b32 v144, v176
  v_mov_b32 v161, v145
  v_mov_b32 v145, v177
  v_mov_b32 v162, v146
  v_mov_b32 v146, v178
  v_mov_b32 v163, v147
  v_mov_b32 v147, v179
  v_mov_b32 v164, v148
  v_mov_b32 v148, v180
  v_mov_b32 v165, v149
  v_mov_b32 v149, v181
  v_mov_b32 v166, v150
  v_mov_b32 v150, v182
  v_mov_b32 v167, v151
  v_mov_b32 v151, v183
  v_mov_b32 v168, v152
  v_mov_b32 v152, v184
  v_mov_b32 v169, v153
  v_mov_b32 v153, v185
  v_mov_b32 v170, v154
  v_mov_b32 v154, v186
  v_mov_b32 v171, v155
  v_mov_b32 v155, v187
  v_mov_b32 v172, v156
  v_mov_b32 v156, v188
  v_mov_b32 v173, v157
  v_mov_b32 v157, v189
  v_mov_b32 v174, v158
  v_mov_b32 v158, v190
  v_mov_b32 v175, v159
  v_mov_b32 v159, v191
  s_branch .fz_kernel_a_fin
.fz_kernel_a_sl:
  s_waitcnt vmcnt(0)
  s_lshl_b32 s36, s18, 1
  s_add_u32 s36, s36, s39
  s_lshl_b32 s36, s36, 18
  s_add_u32 s36, s36, s63
  s_mov_b32 s30, s36
  s_mov_b32 s33, 64
  v_mov_b32 v36, 0xff800000
.fz_kernel_a_s1:
  buffer_load_dwordx4 v[80:83], v3, s[4:7], s30 offen offset:0
  buffer_load_dwordx4 v[84:87], v3, s[4:7], s30 offen offset:1024
  s_waitcnt vmcnt(0)
  v_mfma_f32_32x32x16_bf16 v[48:63], v[80:83], v[16:19], 0
  v_mfma_f32_32x32x16_bf16 v[48:63], v[84:87], v[20:23], v[48:63]
  s_nop 11
  v_max3_f32 v36, v36, v48, v49
  v_max3_f32 v36, v36, v50, v51
  v_max3_f32 v36, v36, v52, v53
  v_max3_f32 v36, v36, v54, v55
  v_max3_f32 v36, v36, v56, v57
  v_max3_f32 v36, v36, v58, v59
  v_max3_f32 v36, v36, v60, v61
  v_max3_f32 v36, v36, v62, v63
  s_add_u32 s30, s30, 4096
  s_sub_u32 s33, s33, 1
  s_cmp_lg_u32 s33, 0
  s_cbranch_scc1 .fz_kernel_a_s1
  v_mov_b32 v35, v36
  s_nop 1
  v_permlane32_swap_b32 v35, v36
  v_max_f32 v36, v36, v35
  v_sub_f32 v36, 0, v36
  v_mov_b32 v64, v36
  v_mov_b32 v144, 0
  v_mov_b32 v65, v36
  v_mov_b32 v145, 0
  v_mov_b32 v66, v36
  v_mov_b32 v146, 0
  v_mov_b32 v67, v36
  v_mov_b32 v147, 0
  v_mov_b32 v68, v36
  v_mov_b32 v148, 0
  v_mov_b32 v69, v36
  v_mov_b32 v149, 0
  v_mov_b32 v70, v36
  v_mov_b32 v150, 0
  v_mov_b32 v71, v36
  v_mov_b32 v151, 0
  v_mov_b32 v72, v36
  v_mov_b32 v152, 0
  v_mov_b32 v73, v36
  v_mov_b32 v153, 0
  v_mov_b32 v74, v36
  v_mov_b32 v154, 0
  v_mov_b32 v75, v36
  v_mov_b32 v155, 0
  v_mov_b32 v76, v36
  v_mov_b32 v156, 0
  v_mov_b32 v77, v36
  v_mov_b32 v157, 0
  v_mov_b32 v78, v36
  v_mov_b32 v158, 0
  v_mov_b32 v79, v36
  v_mov_b32 v159, 0
  v_mov_b32 v208, 0
  v_mov_b32 v209, 0
  v_mov_b32 v210, 0
  v_mov_b32 v211, 0
  s_mov_b32 s30, s36
  s_mov_b32 s33, 64
.fz_kernel_a_s2:
  buffer_load_dwordx4 v[80:83], v3, s[4:7], s30 offen offset:0
  buffer_load_dwordx4 v[84:87], v3, s[4:7], s30 offen offset:1024
  buffer_load_dwordx4 v[88:91], v3, s[4:7], s30 offen offset:2048
  buffer_load_dwordx4 v[92:95], v3, s[4:7], s30 offen offset:3072
  s_waitcnt vmcnt(0)
  v_mfma_f32_32x32x16_bf16 v[48:63], v[80:83], v[16:19], v[64:79]
  v_mfma_f32_32x32x16_bf16 v[48:63], v[84:87], v[20:23], v[48:63]
  s_nop 11
  v_exp_f32 v48, v48
  v_exp_f32 v49, v49
  v_exp_f32 v50, v50
  v_exp_f32 v51, v51
  v_exp_f32 v52, v52
  v_exp_f32 v53, v53
  v_exp_f32 v54, v54
  v_exp_f32 v55, v55
  v_exp_f32 v56, v56
  v_exp_f32 v57, v57
  v_exp_f32 v58, v58
  v_exp_f32 v59, v59
  v_exp_f32 v60, v60
  v_exp_f32 v61, v61
  v_exp_f32 v62, v62
  v_exp_f32 v63, v63
  v_cvt_pk_bf16_f32 v224, v48, v49
  v_cvt_pk_bf16_f32 v225, v50, v51
  v_cvt_pk_bf16_f32 v226, v52, v53
  v_cvt_pk_bf16_f32 v227, v54, v55
  v_cvt_pk_bf16_f32 v228, v56, v57
  v_cvt_pk_bf16_f32 v229, v58, v59
  v_cvt_pk_bf16_f32 v230, v60, v61
  v_cvt_pk_bf16_f32 v231, v62, v63
  v_mfma_f32_32x32x16_bf16 v[144:159], v[88:91], v[224:227], v[144:159]
  s_nop 0
  v_mfma_f32_32x32x16_bf16 v[144:159], v[92:95], v[228:231], v[144:159]
  v_smfmac_f32_16x16x64_bf16 v[208:211], v[12:15], v[224:231], v11
  s_add_u32 s30, s30, 4096
  s_sub_u32 s33, s33, 1
  s_cmp_lg_u32 s33, 0
  s_cbranch_scc1 .fz_kernel_a_s2
  s_nop 7
  v_add_f32 v208, v208, v210
  v_add_f32 v209, v209, v211
  v_cndmask_b32 v33, v208, v209, s[34:35]
  s_nop 7
  s_setpc_b64 s[68:69]
.fz_kernel_serv:
  s_setprio 3
  s_mov_b32 s24, s44
  s_mov_b32 s25, s45
  s_mov_b32 s26, 0x200000
  s_mov_b32 s27, 0x00020000
  v_lshrrev_b32 v8, 3, v2
  v_and_b32 v9, 7, v2
  v_bfe_u32 v10, v2, 4, 1
  v_lshlrev_b32 v10, 2, v10
  v_xor_b32 v9, v9, v10
  v_lshlrev_b32 v9, 4, v9
  v_lshl_add_u32 v10, v8, 11, v9
  s_cmp_eq_u32 s16, 5
  s_cbranch_scc1 .fz_kernel_sv1
  s_barrier
  s_mov_b32 s38, 0
.fz_kernel_cw33:
  s_sleep 1
  ds_read_b32 v7, v6 offset:256
  s_add_u32 s38, s38, 1
  s_waitcnt lgkmcnt(0)
  v_and_b32 v7, 0xff, v7
  v_cmp_gt_u32 vcc, 4, v7
  s_cbranch_vccz .fz_kernel_cw33d
  s_cmp_lt_u32 s38, 8388608
  s_cbranch_scc1 .fz_kernel_cw33
.fz_kernel_cw33d:
  v_lshlrev_b32 v7, 7, v2
  s_lshl_b32 s31, s18, 11
  s_lshl_b32 s33, 1, s17
  s_add_u32 s31, s31, s67
  s_add_u32 s31, s31, 0x1800000
  v_mov_b32 v8, s33
  s_mov_b64 exec, 0xffff
  buffer_atomic_or v8, v7, s[4:7], s31 offen sc1
  s_mov_b64 exec, -1
  s_setprio 0
  s_mov_b32 s38, 0
.fz_kernel_kw34:
  s_sleep 2
  ds_read_b32 v7, v6 offset:0
  s_add_u32 s38, s38, 1
  s_waitcnt lgkmcnt(0)
  v_readfirstlane_b32 s31, v7
  s_bcnt1_i32_b32 s31, s31
  s_cmp_ge_u32 s31, 16
  s_cbranch_scc1 .fz_kernel_kw34d
  s_cmp_lt_u32 s38, 1048576
  s_cbranch_scc1 .fz_kernel_kw34
.fz_kernel_kw34d:
  s_branch .fz_kernel_sv2
.fz_kernel_sv1:
  s_add_u32 s37, s19, s67
  s_mov_b64 exec, 1
  buffer_load_dword v7, v4, s[4:7], s37 offen sc1
  s_waitcnt vmcnt(0)
  ds_or_b32 v6, v7
  buffer_load_dword v9, v4, s[4:7], s37 offen sc1
  s_barrier
  s_waitcnt vmcnt(0)
  ds_or_b32 v6, v9
  s_add_u32 s37, s19, s67
  s_mov_b64 exec, 1
  s_mov_b32 s38, 0
.fz_kernel_po35:
  buffer_load_dword v7, v4, s[4:7], s37 offen offset:0 sc1
  s_add_u32 s38, s38, 1
  s_waitcnt vmcnt(0)
  ds_or_b32 v6, v7 offset:0
  v_cmp_ne_u32 vcc, 0xffff, v7
  s_cbranch_vccz .fz_kernel_po35d
  s_cmp_lt_u32 s38, 131072
  s_cbranch_scc1 .fz_kernel_po35
.fz_kernel_po35d:
  s_mov_b64 exec, -1
  s_setprio 0
  s_mov_b32 s38, 0
.fz_kernel_kw36:
  s_sleep 2
  ds_read_b32 v7, v6 offset:0
  s_add_u32 s38, s38, 1
  s_waitcnt lgkmcnt(0)
  v_readfirstlane_b32 s31, v7
  s_bcnt1_i32_b32 s31, s31
  s_cmp_ge_u32 s31, 16
  s_cbranch_scc1 .fz_kernel_kw36d
  s_cmp_lt_u32 s38, 1048576
  s_cbranch_scc1 .fz_kernel_kw36
.fz_kernel_kw36d:
.fz_kernel_sv2:
  s_and_b32 s30, s16, 1
  s_lshl_b32 s30, s30, 16
  s_add_u32 s32, s30, 65536
  s_lshl_b32 s31, s18, 7
  v_add_u32 v10, s31, v10
.fz_kernel_sv3:
  s_mov_b32 m0, s30
  s_lshl_b32 s31, s30, 4
  s_add_u32 s30, s30, 1024
  buffer_load_dwordx4 v10, s[24:27], s31 offen  lds
  s_cmp_lg_u32 s30, s32
  s_waitcnt vmcnt(3)
  s_cbranch_scc1 .fz_kernel_sv3
  s_cmp_lg_u32 s62, 0
  s_cbranch_scc1 .fz_kernel_wt37
  s_mov_b32 s12, s42
  s_mov_b32 s13, s43
  s_mov_b32 s14, 0x600000
  s_mov_b32 s15, 0x00020000
  s_and_b32 s30, s16, 1
  s_lshl1_add_u32 s30, s17, s30
  s_and_b32 s30, s30, 15
  s_mul_i32 s30, s30, 393216
  s_lshl_b32 s31, s18, 7
  s_add_u32 s30, s30, s31
  v_mul_u32_u24 v11, 6144, v2
  buffer_load_dword v1, v11, s[12:15], s30 offen
  s_add_u32 s30, s30, 2048
  s_waitcnt vmcnt(0)
  buffer_load_dword v1, v11, s[12:15], s30 offen
  s_add_u32 s30, s30, 2048
  s_waitcnt vmcnt(0)
  buffer_load_dword v1, v11, s[12:15], s30 offen
  s_add_u32 s30, s30, 2048
  s_waitcnt vmcnt(0)
.fz_kernel_wt37:
  s_cmp_lg_u32 s16, 4
  s_cbranch_scc1 .fz_kernel_ct38e
  s_getpc_b64 s[0:1]
.fz_kernel_ct38:
  s_sub_u32 s0, s0, .fz_kernel_ct38-fz_kernel
  s_subb_u32 s1, s1, 0
  s_lshr_b32 s31, s2, 3
  s_mulk_i32 s31, 0x500
  v_lshl_add_u32 v1, v2, 7, s31
  v_min_u32 v1, .fz_kernel_last-fz_kernel, v1
  s_mov_b64 exec, 0x3ff
  global_load_dword v1, v1, s[0:1]
  s_mov_b64 exec, -1
.fz_kernel_ct38e:
  s_waitcnt vmcnt(0)
  s_cmp_lg_u32 s16, 5
  s_cbranch_scc1 .fz_kernel_sv35
  s_mov_b64 exec, 1
  s_mov_b32 s38, 0
.fz_kernel_sv34:
  s_sleep 4
  buffer_load_dword v7, v4, s[4:7], s37 offen offset:4 sc1
  ds_read_b32 v8, v6 offset:0x104
  s_add_u32 s38, s38, 1
  s_waitcnt vmcnt(0) lgkmcnt(0)
  ds_or_b32 v6, v7 offset:8
  v_cmp_ne_u32 vcc, 0, v8
  s_cbranch_vccnz .fz_kernel_sv35
  s_cmp_lt_u32 s38, 131072
  s_cbranch_scc1 .fz_kernel_sv34
.fz_kernel_sv35:
  s_mov_b64 exec, -1
  s_setprio 3
  s_barrier
  s_cmp_eq_u32 s16, 5
  s_cbranch_scc1 .fz_kernel_sv4
  s_mov_b32 s38, 0
.fz_kernel_cw39:
  s_sleep 1
  ds_read_b32 v7, v6 offset:264
  s_add_u32 s38, s38, 1
  s_waitcnt lgkmcnt(0)
  v_and_b32 v7, 0xff, v7
  v_cmp_gt_u32 vcc, 4, v7
  s_cbranch_vccz .fz_kernel_cw39d
  s_cmp_lt_u32 s38, 8388608
  s_cbranch_scc1 .fz_kernel_cw39
.fz_kernel_cw39d:
  v_lshlrev_b32 v7, 11, v2
  s_lshl_b32 s31, s17, 7
  s_lshl_b32 s33, 1, s18
  s_add_u32 s31, s31, s67
  s_add_u32 s31, s31, 0x1800004
  v_mov_b32 v8, s33
  s_mov_b64 exec, 0xffff
  buffer_atomic_or v8, v7, s[4:7], s31 offen sc1
  s_mov_b64 exec, -1
  s_mov_b64 exec, 1
  ds_or_b32 v6, v8 offset:8
  s_mov_b64 exec, -1
  s_branch .fz_kernel_sv5
.fz_kernel_sv4:
  s_add_u32 s37, s19, s67
  s_mov_b64 exec, 1
  s_mov_b32 s38, 0
.fz_kernel_po40:
  buffer_load_dword v7, v4, s[4:7], s37 offen offset:4 sc1
  s_add_u32 s38, s38, 1
  s_waitcnt vmcnt(0)
  ds_or_b32 v6, v7 offset:8
  v_cmp_ne_u32 vcc, 0xffff, v7
  s_cbranch_vccz .fz_kernel_po40d
  s_cmp_lt_u32 s38, 131072
  s_cbranch_scc1 .fz_kernel_po40
.fz_kernel_po40d:
  s_mov_b64 exec, -1
.fz_kernel_sv5:
  s_mov_b32 s72, s66
  s_mov_b32 s73, s65
  s_mov_b32 s74, s67
  s_mov_b32 s75, s62
  s_cmp_lg_u32 s62, 0
  s_cbranch_scc1 .fz_kernel_w_lt
  s_mov_b32 s62, 1
  s_mov_b32 s63, 0x2000000
  s_mov_b32 s64, 0x2800000
  s_mov_b32 s65, 0x1400000
  s_mov_b32 s66, 0x1c42000
  s_mov_b32 s67, 12
  s_mov_b32 s71, 159776
  v_mov_b32 v6, 159832
  s_branch .fz_kernel_q_prod2
.fz_kernel_w_lt:
  s_barrier
  s_barrier
  s_branch .fz_kernel_fin
.fz_kernel_pk41c:
  s_call_b64 s[68:69], .fz_kernel_pick
  s_branch .fz_kernel_pk41
.fz_kernel_pk42c:
  s_call_b64 s[68:69], .fz_kernel_pick
  s_branch .fz_kernel_pk42
.fz_kernel_pk43c:
  s_call_b64 s[68:69], .fz_kernel_pick
  s_branch .fz_kernel_pk43
.fz_kernel_w_pt:
  v_lshlrev_b32 v44, 5, v17
  v_add_u32 v44, 155648, v44
  s_mov_b64 exec, vcc
  ds_read_b128 v[232:235], v44 offset:7424
  ds_read_b128 v[236:239], v44 offset:7440
  ds_read_b128 v[240:243], v44 offset:7488
  ds_read_b128 v[244:247], v44 offset:7504
  s_waitcnt lgkmcnt(0)
  v_pk_add_f32 v[64:65], v[64:65], v[232:233]
  v_pk_add_f32 v[66:67], v[66:67], v[234:235]
  v_pk_add_f32 v[68:69], v[68:69], v[236:237]
  v_pk_add_f32 v[70:71], v[70:71], v[238:239]
  v_pk_add_f32 v[72:73], v[72:73], v[240:241]
  v_pk_add_f32 v[74:75], v[74:75], v[242:243]
  v_pk_add_f32 v[76:77], v[76:77], v[244:245]
  v_pk_add_f32 v[78:79], v[78:79], v[246:247]
  ds_read_b128 v[232:235], v44 offset:7552
  ds_read_b128 v[236:239], v44 offset:7568
  ds_read_b128 v[240:243], v44 offset:7616
  ds_read_b128 v[244:247], v44 offset:7632
  s_waitcnt lgkmcnt(0)
  v_pk_add_f32 v[80:81], v[80:81], v[232:233]
  v_pk_add_f32 v[82:83], v[82:83], v[234:235]
  v_pk_add_f32 v[84:85], v[84:85], v[236:237]
  v_pk_add_f32 v[86:87], v[86:87], v[238:239]
  v_pk_add_f32 v[88:89], v[88:89], v[240:241]
  v_pk_add_f32 v[90:91], v[90:91], v[242:243]
  v_pk_add_f32 v[92:93], v[92:93], v[244:245]
  v_pk_add_f32 v[94:95], v[94:95], v[246:247]
  s_mov_b64 exec, -1
  s_branch .fz_kernel_w_pb
.fz_kernel_pk44c:
  s_call_b64 s[68:69], .fz_kernel_pick
  s_branch .fz_kernel_pk44
.fz_kernel_pk45c:
  s_call_b64 s[68:69], .fz_kernel_pick
  s_branch .fz_kernel_pk45
.fz_kernel_pk46c:
  s_call_b64 s[68:69], .fz_kernel_pick
  s_branch .fz_kernel_pk46
.fz_kernel_pk47c:
  s_call_b64 s[68:69], .fz_kernel_pick
  s_branch .fz_kernel_pk47
.fz_kernel_pk48c:
  s_call_b64 s[68:69], .fz_kernel_pick
  s_branch .fz_kernel_pk48
.fz_kernel_pk49c:
  s_call_b64 s[68:69], .fz_kernel_pick
  s_branch .fz_kernel_pk49
.fz_kernel_pk50c:
  s_call_b64 s[68:69], .fz_kernel_pick
  s_branch .fz_kernel_pk50
.fz_kernel_pk51c:
  s_call_b64 s[68:69], .fz_kernel_pick
  s_branch .fz_kernel_pk51
.fz_kernel_pk52c:
  s_call_b64 s[68:69], .fz_kernel_pick
  s_branch .fz_kernel_pk52
.fz_kernel_pk53c:
  s_call_b64 s[68:69], .fz_kernel_pick
  s_branch .fz_kernel_pk53
.fz_kernel_pk54c:
  s_call_b64 s[68:69], .fz_kernel_pick
  s_branch .fz_kernel_pk54
.fz_kernel_pk55c:
  s_call_b64 s[68:69], .fz_kernel_pick
  s_branch .fz_kernel_pk55
.fz_kernel_pk56c:
  s_call_b64 s[68:69], .fz_kernel_pick
  s_branch .fz_kernel_pk56
.fz_kernel_pk57c:
  s_call_b64 s[68:69], .fz_kernel_pick
  s_branch .fz_kernel_pk57
.fz_kernel_pk58c:
  s_call_b64 s[68:69], .fz_kernel_pick
  s_branch .fz_kernel_pk58
.fz_kernel_pk59c:
  s_call_b64 s[68:69], .fz_kernel_pick
  s_branch .fz_kernel_pk59
.fz_kernel_c_nl:
  s_barrier
  s_branch .fz_kernel_c_np
.fz_kernel_c_coef:
  v_fma_f32 v242, -v240, v240, v242
  v_fma_f32 v243, -v241, v241, v243
  v_rsq_f32 v248, abs(v242)
  v_rsq_f32 v249, abs(v243)
  v_mul_f32 v254, v240, v248
  v_sub_f32 v254, 0, v254
  v_mov_b32 v252, 1.0
  v_fmac_f32 v252, 0x44800000, v248
  v_fma_f32 v242, v242, v24, -v25
  v_max_f32 v242, 0, v242
  v_mul_f32 v248, v252, v252
  v_fma_f32 v248, v248, v242, v25
  v_rsq_f32 v248, v248
  v_mul_f32 v240, v23, v240
  v_mul_f32 v248, v248, v252
  v_mul_f32 v250, v248, v240
  v_sub_f32 v250, 0, v250
  v_mul_f32 v255, v241, v249
  v_sub_f32 v255, 0, v255
  v_mov_b32 v253, 1.0
  v_fmac_f32 v253, 0x44800000, v249
  s_cmp_eq_u32 s3, 0
  s_cbranch_scc1 .fz_kernel_hb69
  s_barrier
  s_sub_u32 s3, s3, 1
.fz_kernel_hb69:
  v_fma_f32 v243, v243, v24, -v25
  v_max_f32 v243, 0, v243
  v_mul_f32 v249, v253, v253
  v_fma_f32 v249, v249, v243, v25
  v_rsq_f32 v249, v249
  v_mul_f32 v241, v23, v241
  v_mul_f32 v249, v249, v253
  v_mul_f32 v251, v249, v241
  v_sub_f32 v251, 0, v251
  s_setpc_b64 s[68:69]
.fz_kernel_c_gur:
  v_min_u32 v9, v144, v146
  v_cmp_eq_u32 s[8:9], 0, v9
  v_min_u32 v9, v148, v150
  v_cmp_eq_u32 s[10:11], 0, v9
  v_min_u32 v9, v152, v154
  v_cmp_eq_u32 s[12:13], 0, v9
  v_min_u32 v9, v156, v158
  v_cmp_eq_u32 s[14:15], 0, v9
  s_add_u32 s38, s38, 1
  s_cmp_ge_u32 s38, 131072
  s_cbranch_scc1 .fz_kernel_c_gud
  s_or_b64 exec, s[8:9], 1
  buffer_load_dwordx4 v[144:147], v21, s[4:7], s21 offen offset:0 sc1
  s_or_b64 exec, s[10:11], 1
  buffer_load_dwordx4 v[148:151], v21, s[4:7], s21 offen offset:512 sc1
  s_or_b64 exec, s[12:13], 1
  buffer_load_dwordx4 v[152:155], v21, s[4:7], s21 offen offset:1024 sc1
  s_or_b64 exec, s[14:15], 1
  buffer_load_dwordx4 v[156:159], v21, s[4:7], s21 offen offset:1536 sc1
  s_mov_b64 exec, -1
  s_branch .fz_kernel_c_gu
.fz_kernel_c_pur:
  v_min3_u32 v9, v144, v146, v148
  v_min_u32 v9, v9, v150
  v_cmp_eq_u32 s[8:9], 0, v9
  v_min3_u32 v9, v152, v154, v156
  v_min_u32 v9, v9, v158
  v_cmp_eq_u32 s[10:11], 0, v9
  v_min3_u32 v9, v160, v162, v164
  v_min_u32 v9, v9, v166
  v_cmp_eq_u32 s[12:13], 0, v9
  v_min3_u32 v9, v168, v170, v172
  v_min_u32 v9, v9, v174
  v_cmp_eq_u32 s[14:15], 0, v9
  s_cmp_eq_u32 s3, 0
  s_cbranch_scc1 .fz_kernel_hb73
  s_barrier
  s_sub_u32 s3, s3, 1
.fz_kernel_hb73:
  s_add_u32 s38, s38, 1
  s_cmp_ge_u32 s38, 131072
  s_cbranch_scc1 .fz_kernel_c_pud
  s_or_b64 exec, s[8:9], 1
  buffer_load_dwordx4 v[144:147], v10, s[4:7], s21 offen offset:0 sc1
  buffer_load_dwordx4 v[148:151], v10, s[4:7], s21 offen offset:16 sc1
  s_or_b64 exec, s[10:11], 1
  buffer_load_dwordx4 v[152:155], v10, s[4:7], s21 offen offset:2048 sc1
  buffer_load_dwordx4 v[156:159], v10, s[4:7], s21 offen offset:2064 sc1
  s_or_b64 exec, s[12:13], 1
  buffer_load_dwordx4 v[160:163], v10, s[4:7], s22 offen offset:0 sc1
  buffer_load_dwordx4 v[164:167], v10, s[4:7], s22 offen offset:16 sc1
  s_or_b64 exec, s[14:15], 1
  buffer_load_dwordx4 v[168:171], v10, s[4:7], s22 offen offset:2048 sc1
  buffer_load_dwordx4 v[172:175], v10, s[4:7], s22 offen offset:2064 sc1
  s_mov_b64 exec, -1
  s_branch .fz_kernel_c_pu
.fz_kernel_last:
  s_endpgm

.section .rodata,"a"
.p2align 6
.amdhsa_kernel fz_kernel
  .amdhsa_next_free_vgpr 256
  .amdhsa_next_free_sgpr 102
  .amdhsa_accum_offset 256
  .amdhsa_group_segment_fixed_size 0
  .amdhsa_kernarg_size 88
  .amdhsa_user_sgpr_count 2
  .amdhsa_user_sgpr_kernarg_segment_ptr 1
  .amdhsa_system_sgpr_workgroup_id_x 1
.end_amdhsa_kernel
```

```asm
; @launch kernel=fz_kernel grid=(256,1,1) block=(512,1,1) lds=163840
.amdgcn_target "amdgcn-amd-amdhsa--gfx950"
.text
.globl fz_kernel
.p2align 8
.type fz_kernel,@function
fz_kernel:
  s_cmp_ge_u32 s2, 256
  s_cbranch_scc1 .fz_kernel_end
  s_load_dwordx16 s[40:55], s[0:1], 0
  s_load_dwordx4 s[56:59], s[0:1], 64
  s_load_dwordx2 s[60:61], s[0:1], 80
  v_lshrrev_b32 v1, 6, v0
  v_and_b32 v2, 63, v0
  v_readfirstlane_b32 s16, v1
  s_and_b32 s21, s2, 7
  s_lshr_b32 s22, s2, 3
  s_and_b32 s23, s21, 3
  s_lshl_b32 s23, s23, 2
  s_and_b32 s24, s22, 3
  s_add_u32 s18, s23, s24
  s_lshr_b32 s24, s21, 2
  s_lshl_b32 s24, s24, 3
  s_lshr_b32 s25, s22, 2
  s_add_u32 s17, s24, s25
  s_lshl_b32 s19, s18, 4
  s_add_u32 s19, s19, s17
  s_lshl_b32 s19, s19, 7
  s_add_u32 s19, s19, 0x1800000
  v_lshlrev_b32 v3, 4, v2
  v_mov_b32 v4, 0
  v_mov_b32 v5, 1
  s_waitcnt lgkmcnt(0)
  s_mov_b32 s4, s60
  s_mov_b32 s5, s61
  s_mov_b32 s6, 0x2c00000
  s_mov_b32 s7, 0x00020000
  s_mov_b32 s62, 0
  s_mov_b32 s63, 0x400000
  s_mov_b32 s64, 0xc00000
  s_mov_b32 s65, 0x1000000
  s_mov_b32 s66, 0x1c00000
  s_mov_b32 s67, 0
  s_mov_b32 s71, 159744
  v_mov_b32 v6, 159808
  s_cmp_lt_u32 s16, 4
  s_cbranch_scc1 .fz_kernel_q_cons1
  s_cmp_ge_u32 s16, 6
  s_cbranch_scc1 .fz_kernel_q_help1
  s_mov_b32 s8, s40
  s_mov_b32 s9, s41
  s_mov_b32 s10, 0x400000
  s_mov_b32 s11, 0x00020000
  v_lshrrev_b32 v20, 3, v2
  v_and_b32 v21, 7, v2
  v_lshrrev_b32 v22, 4, v2
  v_xor_b32 v23, v21, v22
  v_lshlrev_b32 v23, 4, v23
  v_lshl_add_u32 v24, v20, 11, v23
  v_xor_b32 v25, 64, v24
  s_lshl_b32 s35, s17, 2
  s_and_b32 s31, s16, 1
  s_add_u32 s35, s35, s31
  s_lshl_b32 s35, s35, 16
  s_and_b32 s29, s18, 12
  s_lshr_b32 s33, s17, 3
  s_lshl1_add_u32 s29, s33, s29
  s_lshl2_add_u32 s29, s17, s29
  s_and_b32 s29, s29, 15
  s_mov_b32 s22, 128
  s_mov_b32 s23, 131072
  s_mov_b32 s36, -1
  v_add_u32 v40, 0, v24
  v_add_u32 v41, 15360, v25
  v_add_u32 v42, 30720, v24
  v_add_u32 v43, 46080, v25
.fz_kernel_q_pc:
  s_mov_b32 s12, s42
  s_mov_b32 s13, s43
  s_mov_b32 s14, 0x600000
  s_mov_b32 s15, 0x00020000
  v_lshrrev_b32 v28, 3, v2
  v_and_b32 v29, 7, v2
  v_bfe_u32 v30, v2, 4, 1
  v_lshlrev_b32 v30, 1, v30
  v_xor_b32 v31, v29, v30
  v_lshlrev_b32 v31, 4, v31
  v_mul_u32_u24 v28, 6144, v28
  v_add_u32 v28, v28, v31
  v_xor_b32 v29, 64, v28
  s_lshl_b32 s32, s18, 7
  s_add_u32 s39, s32, 6291456
  s_mul_i32 s33, s29, 393216
  s_add_u32 s33, s33, s32
  s_lshl_b32 s29, s29, 1
  s_mul_i32 s25, s31, 6144
  s_add_u32 s25, s25, 65536
  s_mov_b32 s30, s25
  s_add_u32 s26, s25, 49152
  s_lshl_b32 s21, s31, 12
  s_cmp_eq_u32 s31, 0
  s_mov_b32 s24, 100352
  s_cselect_b32 s24, 0, s24
  v_add_u32 v32, s24, v28
  s_mov_b32 s24, 148480
  s_cselect_b32 s24, 48128, s24
  v_add_u32 v33, s24, v29
  s_mov_b32 s24, 2048
  s_cselect_b32 s24, 96256, s24
  v_add_u32 v34, s24, v28
  s_mov_b32 s24, 50176
  s_cselect_b32 s24, 144384, s24
  v_add_u32 v35, s24, v29
  s_mov_b32 s24, 102400
  s_cselect_b32 s24, 2048, s24
  v_add_u32 v36, s24, v28
  s_mov_b32 s24, 150528
  s_cselect_b32 s24, 50176, s24
  v_add_u32 v37, s24, v29
  s_cmp_lg_u32 s62, 0
  s_cbranch_scc1 .fz_kernel_q_st2
  s_mov_b32 s34, 32
  s_call_b64 s[0:1], .fz_kernel_q_ix
  s_call_b64 s[0:1], .fz_kernel_q_iu
  s_call_b64 s[0:1], .fz_kernel_q_iu
  s_call_b64 s[0:1], .fz_kernel_q_iu
  s_waitcnt vmcnt(20)
  s_barrier
  s_call_b64 s[0:1], .fz_kernel_q_iu
  s_waitcnt vmcnt(24)
  s_barrier
  s_call_b64 s[0:1], .fz_kernel_q_iu
  s_branch .fz_kernel_q_pl
.fz_kernel_q_ix:
  s_bfe_u32 s24, s29, 0x40001
  s_mul_i32 s20, s24, s22
  s_bitcmp1_b32 s29, 0
  s_cselect_b32 s31, s23, 0
  s_add_u32 s20, s20, s35
  s_add_u32 s20, s20, s31
  s_bitcmp1_b32 s36, s24
  s_cbranch_scc0 .fz_kernel_xok1w
.fz_kernel_xok1:
  s_mov_b32 m0, s21
  s_add_u32 s21, s21, 8192
  s_and_b32 s21, s21, 0xffff
  s_add_u32 s29, s29, 1
  buffer_load_dwordx4 v40, s[8:11], s20 offen offset:0 lds
  buffer_load_dwordx4 v41, s[8:11], s20 offen offset:1024 lds
  buffer_load_dwordx4 v42, s[8:11], s20 offen offset:2048 lds
  buffer_load_dwordx4 v43, s[8:11], s20 offen offset:3072 lds
  s_setpc_b64 s[0:1]
.fz_kernel_q_iu:
  s_mov_b32 m0, s30
  s_add_u32 s30, s30, 12288
  buffer_load_dwordx4 v32, s[12:15], s33 offen offset:0 lds
  s_bfe_u32 s24, s29, 0x40001
  buffer_load_dwordx4 v33, s[12:15], s33 offen offset:1024 lds
  s_mul_i32 s20, s24, s22
  buffer_load_dwordx4 v34, s[12:15], s33 offen offset:2048 lds
  s_bitcmp1_b32 s29, 0
  s_cselect_b32 s31, s23, 0
  buffer_load_dwordx4 v35, s[12:15], s33 offen offset:3072 lds
  s_add_u32 m0, m0, 4096
  s_add_u32 s20, s20, s35
  buffer_load_dwordx4 v36, s[12:15], s33 offen offset:0 lds
  s_add_u32 s20, s20, s31
  buffer_load_dwordx4 v37, s[12:15], s33 offen offset:1024 lds
  s_bitcmp1_b32 s36, s24
  s_cbranch_scc0 .fz_kernel_xok2w
.fz_kernel_xok2:
  s_mov_b32 m0, s21
  s_add_u32 s21, s21, 8192
  s_and_b32 s21, s21, 0xffff
  s_add_u32 s29, s29, 1
  buffer_load_dwordx4 v40, s[8:11], s20 offen offset:0 lds
  s_add_u32 s33, s33, 196608
  s_cmp_eq_u32 s33, s39
  s_cselect_b32 s33, s32, s33
  buffer_load_dwordx4 v41, s[8:11], s20 offen offset:1024 lds
  s_cmp_eq_u32 s30, s26
  s_cselect_b32 s30, s25, s30
  buffer_load_dwordx4 v42, s[8:11], s20 offen offset:2048 lds
  s_sub_u32 s34, s34, 1
  s_cmp_lg_u32 s34, 0
  buffer_load_dwordx4 v43, s[8:11], s20 offen offset:3072 lds
  s_setpc_b64 s[0:1]
.fz_kernel_q_iw:
  s_mov_b32 m0, s30
  s_add_u32 s30, s30, 12288
  buffer_load_dwordx4 v32, s[12:15], s33 offen offset:0 lds
  s_nop 0
  buffer_load_dwordx4 v33, s[12:15], s33 offen offset:1024 lds
  s_nop 0
  buffer_load_dwordx4 v34, s[12:15], s33 offen offset:2048 lds
  s_nop 0
  buffer_load_dwordx4 v35, s[12:15], s33 offen offset:3072 lds
  s_add_u32 m0, m0, 4096
  s_nop 0
  buffer_load_dwordx4 v36, s[12:15], s33 offen offset:0 lds
  buffer_load_dwordx4 v37, s[12:15], s33 offen offset:1024 lds
  s_add_u32 s33, s33, 196608
  s_cmp_eq_u32 s33, s39
  s_cselect_b32 s33, s32, s33
  s_cmp_eq_u32 s30, s26
  s_cselect_b32 s30, s25, s30
  s_sub_u32 s34, s34, 1
  s_cmp_lg_u32 s34, 0
  s_setpc_b64 s[0:1]
.fz_kernel_q_st2:
  s_mov_b32 s34, 32
  s_waitcnt vmcnt(0)
  s_barrier
  s_call_b64 s[0:1], .fz_kernel_q_iw
  s_call_b64 s[0:1], .fz_kernel_q_iw
  s_mov_b64 exec, 1
  s_waitcnt vmcnt(0)
  ds_add_u32 v6, v5 offset:0x110
  s_mov_b64 exec, -1
  v_mov_b32 v12, 0x100
  s_call_b64 s[0:1], .fz_kernel_q_ix
  s_call_b64 s[0:1], .fz_kernel_q_ix
  s_call_b64 s[0:1], .fz_kernel_q_iw
  s_call_b64 s[0:1], .fz_kernel_q_iw
  s_call_b64 s[0:1], .fz_kernel_q_ix
  s_call_b64 s[0:1], .fz_kernel_q_ix
  s_waitcnt vmcnt(20)
  s_mov_b64 exec, 1
  ds_add_u32 v6, v12 offset:0x110
  s_mov_b64 exec, -1
  s_barrier
  s_waitcnt vmcnt(20)
  s_barrier
  s_call_b64 s[0:1], .fz_kernel_q_ix
  s_call_b64 s[0:1], .fz_kernel_q_iu
  s_waitcnt vmcnt(14)
  s_barrier
  s_call_b64 s[0:1], .fz_kernel_q_iu
  s_waitcnt vmcnt(20)
  s_barrier
  s_call_b64 s[0:1], .fz_kernel_q_iu
.fz_kernel_q_pl:
  s_waitcnt vmcnt(20)
  s_barrier
  s_mov_b32 m0, s30
  s_add_u32 s30, s30, 12288
  buffer_load_dwordx4 v32, s[12:15], s33 offen offset:0 lds
  s_bfe_u32 s24, s29, 0x40001
  buffer_load_dwordx4 v33, s[12:15], s33 offen offset:1024 lds
  s_mul_i32 s20, s24, s22
  buffer_load_dwordx4 v34, s[12:15], s33 offen offset:2048 lds
  s_bitcmp1_b32 s29, 0
  s_cselect_b32 s31, s23, 0
  buffer_load_dwordx4 v35, s[12:15], s33 offen offset:3072 lds
  s_add_u32 m0, m0, 4096
  s_add_u32 s20, s20, s35
  buffer_load_dwordx4 v36, s[12:15], s33 offen offset:0 lds
  s_add_u32 s20, s20, s31
  buffer_load_dwordx4 v37, s[12:15], s33 offen offset:1024 lds
  s_bitcmp1_b32 s36, s24
  s_cbranch_scc0 .fz_kernel_xok3w
.fz_kernel_xok3:
  s_mov_b32 m0, s21
  s_add_u32 s21, s21, 8192
  s_and_b32 s21, s21, 0xffff
  s_add_u32 s29, s29, 1
  buffer_load_dwordx4 v40, s[8:11], s20 offen offset:0 lds
  s_add_u32 s33, s33, 196608
  s_cmp_eq_u32 s33, s39
  s_cselect_b32 s33, s32, s33
  buffer_load_dwordx4 v41, s[8:11], s20 offen offset:1024 lds
  s_cmp_eq_u32 s30, s26
  s_cselect_b32 s30, s25, s30
  buffer_load_dwordx4 v42, s[8:11], s20 offen offset:2048 lds
  s_sub_u32 s34, s34, 1
  s_cmp_lg_u32 s34, 0
  buffer_load_dwordx4 v43, s[8:11], s20 offen offset:3072 lds
  s_cbranch_scc1 .fz_kernel_q_pl
  s_waitcnt vmcnt(20)
  s_barrier
  s_waitcnt vmcnt(10)
  s_barrier
  s_waitcnt vmcnt(0)
  s_barrier
  s_barrier
  s_branch .fz_kernel_serv
.fz_kernel_q_cons1:
  s_mov_b32 s12, s42
  s_mov_b32 s13, s43
  s_mov_b32 s14, 0x600000
  s_mov_b32 s15, 0x00020000
  s_and_b32 s20, s18, 4
  s_add_u32 s20, s20, s16
  s_cmp_ge_u32 s20, 3
  s_cbranch_scc1 .fz_kernel_q_nsp
  s_and_b32 s20, s17, 7
  s_and_b32 s21, s18, 3
  s_lshl2_add_u32 s20, s20, s21
  s_mul_i32 s20, s20, 196608
  s_or_b32 s21, s18, 3
  s_lshl4_add_u32 s21, s16, s21
  s_lshl_b32 s21, s21, 7
  s_add_u32 s20, s20, s21
  v_mul_u32_u24 v20, 6144, v2
  s_mov_b32 exec_hi, 0
  buffer_load_dword v231, v20, s[12:15], s20 offen
  s_mov_b32 exec_hi, -1
.fz_kernel_q_nsp:
  v_lshlrev_b32 v20, 2, v0
  v_add_u32 v20, 159744, v20
  s_cmp_ge_u32 s16, 2
  s_cbranch_scc1 .fz_kernel_q_nz
  ds_write_b32 v20, v4
.fz_kernel_q_nz:
  s_lshr_b32 s26, s16, 1
  s_lshl_b32 s28, s26, 13
  v_and_b32 v20, 15, v2
  v_lshrrev_b32 v21, 4, v2
  v_bfe_u32 v22, v2, 1, 3
  v_xor_b32 v22, v22, v21
  v_lshlrev_b32 v20, 7, v20
  v_lshl_add_u32 v20, v22, 4, v20
  v_add_u32 v8, s28, v20
  v_xor_b32 v9, 64, v8
.fz_kernel_q_cs:
  s_and_b32 s27, s16, 1
  s_lshl_b32 s28, s27, 1
  v_lshrrev_b32 v14, 4, v2
  v_bfe_u32 v15, v2, 2, 2
  v_lshl_add_u32 v16, v14, 3, v15
  v_lshlrev_b32 v16, 7, v16
  v_and_b32 v14, 1, v14
  v_lshrrev_b32 v15, 1, v15
  v_lshl_add_u32 v14, v14, 1, v15
  v_xor_b32 v14, s28, v14
  v_lshl_add_u32 v16, v14, 5, v16
  v_and_b32 v14, 3, v2
  v_lshl_add_u32 v16, v14, 3, v16
  v_add_u32 v12, 65536, v16
  v_xor_b32 v13, 32, v12
  v_mov_b32 v10, v12
  v_mov_b32 v11, v13
  s_mov_b32 s29, 16
  s_mov_b32 s30, 0
  v_mov_b32 v128, 0
  v_mov_b32 v129, 0
  v_mov_b32 v130, 0
  v_mov_b32 v131, 0
  v_mov_b32 v132, 0
  v_mov_b32 v133, 0
  v_mov_b32 v134, 0
  v_mov_b32 v135, 0
  v_mov_b32 v136, 0
  v_mov_b32 v137, 0
  v_mov_b32 v138, 0
  v_mov_b32 v139, 0
  v_mov_b32 v140, 0
  v_mov_b32 v141, 0
  v_mov_b32 v142, 0
  v_mov_b32 v143, 0
  v_mov_b32 v144, 0
  v_mov_b32 v145, 0
  v_mov_b32 v146, 0
  v_mov_b32 v147, 0
  v_mov_b32 v148, 0
  v_mov_b32 v149, 0
  v_mov_b32 v150, 0
  v_mov_b32 v151, 0
  v_mov_b32 v152, 0
  v_mov_b32 v153, 0
  v_mov_b32 v154, 0
  v_mov_b32 v155, 0
  v_mov_b32 v156, 0
  v_mov_b32 v157, 0
  v_mov_b32 v158, 0
  v_mov_b32 v159, 0
  v_mov_b32 v160, 0
  v_mov_b32 v161, 0
  v_mov_b32 v162, 0
  v_mov_b32 v163, 0
  v_mov_b32 v164, 0
  v_mov_b32 v165, 0
  v_mov_b32 v166, 0
  v_mov_b32 v167, 0
  v_mov_b32 v168, 0
  v_mov_b32 v169, 0
  v_mov_b32 v170, 0
  v_mov_b32 v171, 0
  v_mov_b32 v172, 0
  v_mov_b32 v173, 0
  v_mov_b32 v174, 0
  v_mov_b32 v175, 0
  s_cmp_eq_u32 s62, 0
  s_cbranch_scc1 .fz_kernel_q_i1
  s_mov_b64 exec, 1
  s_waitcnt vmcnt(0)
  ds_add_u32 v1, v5 offset:0x100
  s_mov_b64 exec, -1
.fz_kernel_q_i1:
  v_mov_b32 v176, 0
  v_mov_b32 v177, 0
  v_mov_b32 v178, 0
  v_mov_b32 v179, 0
  v_mov_b32 v180, 0
  v_mov_b32 v181, 0
  v_mov_b32 v182, 0
  v_mov_b32 v183, 0
  v_mov_b32 v184, 0
  v_mov_b32 v185, 0
  v_mov_b32 v186, 0
  v_mov_b32 v187, 0
  v_mov_b32 v188, 0
  v_mov_b32 v189, 0
  v_mov_b32 v190, 0
  v_mov_b32 v191, 0
  v_mov_b32 v192, 0
  v_mov_b32 v193, 0
  v_mov_b32 v194, 0
  v_mov_b32 v195, 0
  v_mov_b32 v196, 0
  v_mov_b32 v197, 0
  v_mov_b32 v198, 0
  v_mov_b32 v199, 0
  v_mov_b32 v200, 0
  v_mov_b32 v201, 0
  v_mov_b32 v202, 0
  v_mov_b32 v203, 0
  v_mov_b32 v204, 0
  v_mov_b32 v205, 0
  v_mov_b32 v206, 0
  v_mov_b32 v207, 0
  v_mov_b32 v208, 0
  v_mov_b32 v209, 0
  v_mov_b32 v210, 0
  v_mov_b32 v211, 0
  v_mov_b32 v212, 0
  v_mov_b32 v213, 0
  v_mov_b32 v214, 0
  v_mov_b32 v215, 0
  v_mov_b32 v216, 0
  v_mov_b32 v217, 0
  v_mov_b32 v218, 0
  v_mov_b32 v219, 0
  v_mov_b32 v220, 0
  v_mov_b32 v221, 0
  v_mov_b32 v222, 0
  v_mov_b32 v223, 0
  v_and_b32 v14, 1, v2
  v_lshlrev_b32 v14, 4, v14
  v_mov_b32 v15, 0x3f80
  v_lshlrev_b32 v14, v14, v15
  v_mov_b32 v248, 0
  v_mov_b32 v249, 0
  v_mov_b32 v250, 0
  v_mov_b32 v251, 0
  v_mov_b32 v252, 0
  v_mov_b32 v253, 0
  v_mov_b32 v254, 0
  v_mov_b32 v255, 0
  s_mov_b32 exec_lo, 0x3
  s_mov_b32 exec_hi, 0x30
  v_mov_b32 v248, v14
  s_mov_b32 exec_lo, 0xc
  s_mov_b32 exec_hi, 0xc0
  v_mov_b32 v249, v14
  s_mov_b32 exec_lo, 0x300
  s_mov_b32 exec_hi, 0x3000
  v_mov_b32 v250, v14
  s_mov_b32 exec_lo, 0xc00
  s_mov_b32 exec_hi, 0xc000
  v_mov_b32 v251, v14
  s_mov_b32 exec_lo, 0x30000
  s_mov_b32 exec_hi, 0x300000
  v_mov_b32 v252, v14
  s_mov_b32 exec_lo, 0xc0000
  s_mov_b32 exec_hi, 0xc00000
  v_mov_b32 v253, v14
  s_mov_b32 exec_lo, 0x3000000
  s_mov_b32 exec_hi, 0x30000000
  v_mov_b32 v254, v14
  s_mov_b32 exec_lo, 0xc000000
  s_mov_b32 exec_hi, 0xc0000000
  v_mov_b32 v255, v14
  s_mov_b64 exec, -1
  s_mov_b32 s12, s40
  s_mov_b32 s13, s41
  s_mov_b32 s14, 0x400000
  s_mov_b32 s15, 0x00020000
  v_lshrrev_b32 v14, 5, v2
  v_and_b32 v15, 31, v2
  v_lshlrev_b32 v14, 4, v14
  v_lshl_add_u32 v15, v15, 11, v14
  s_lshl2_add_u32 s23, s17, s16
  s_lshl_b32 s23, s23, 16
  s_lshl_b32 s22, s18, 7
  s_add_u32 s23, s22, s23
  s_waitcnt lgkmcnt(0)
  s_barrier
  ds_read_b64_tr_b16 v[56:57], v10 offset:4096
  ds_read_b64_tr_b16 v[58:59], v10 offset:4608
  ds_read_b128 v[32:35], v8 offset:0
  ds_read_b128 v[36:39], v8 offset:2048
  ds_read_b128 v[40:43], v8 offset:4096
  ds_read_b128 v[44:47], v8 offset:6144
  ds_read_b64_tr_b16 v[60:61], v11 offset:4096
  ds_read_b64_tr_b16 v[62:63], v11 offset:4608
  ds_read_b64_tr_b16 v[64:65], v10 offset:8192
  ds_read_b64_tr_b16 v[66:67], v10 offset:8704
  ds_read_b64_tr_b16 v[68:69], v11 offset:8192
  ds_read_b64_tr_b16 v[70:71], v11 offset:8704
  ds_read_b64_tr_b16 v[48:49], v10 offset:0
  ds_read_b64_tr_b16 v[50:51], v10 offset:512
  ds_read_b64_tr_b16 v[52:53], v11 offset:0
  ds_read_b64_tr_b16 v[54:55], v11 offset:512
  s_add_u32 s30, s30, 12288
  s_cmp_eq_u32 s30, 49152
  s_cselect_b32 s30, 0, s30
  v_add_u32 v8, 0x4000, v8
  v_add_u32 v10, s30, v12
  v_add_u32 v11, s30, v13
  v_and_b32 v8, 0xffff, v8
  s_waitcnt lgkmcnt(0)
  s_branch .fz_kernel_q_l0
  .p2align 6
.fz_kernel_q_loop:
  v_mfma_f32_16x16x32_bf16 v[148:151], v[52:55], v[36:39], v[148:151]
  v_mfma_f32_16x16x32_bf16 v[152:155], v[52:55], v[40:43], v[152:155]
  s_waitcnt lgkmcnt(0)
  v_mfma_f32_16x16x32_bf16 v[156:159], v[52:55], v[44:47], v[156:159]
  s_barrier
  v_mfma_f32_16x16x32_bf16 v[160:163], v[96:99], v[72:75], v[160:163]
  ds_read_b64_tr_b16 v[56:57], v10 offset:4096
  v_mfma_f32_16x16x32_bf16 v[164:167], v[96:99], v[76:79], v[164:167]
  ds_read_b64_tr_b16 v[58:59], v10 offset:4608
  v_mfma_f32_16x16x32_bf16 v[168:171], v[96:99], v[80:83], v[168:171]
  ds_read_b128 v[32:35], v8 offset:0
  v_mfma_f32_16x16x32_bf16 v[172:175], v[96:99], v[84:87], v[172:175]
  ds_read_b128 v[36:39], v8 offset:2048
  v_mfma_f32_16x16x32_bf16 v[176:179], v[100:103], v[72:75], v[176:179]
  ds_read_b128 v[40:43], v8 offset:4096
  v_mfma_f32_16x16x32_bf16 v[180:183], v[100:103], v[76:79], v[180:183]
  ds_read_b128 v[44:47], v8 offset:6144
  v_mfma_f32_16x16x32_bf16 v[184:187], v[100:103], v[80:83], v[184:187]
  ds_read_b64_tr_b16 v[60:61], v11 offset:4096
  v_mfma_f32_16x16x32_bf16 v[188:191], v[100:103], v[84:87], v[188:191]
  ds_read_b64_tr_b16 v[62:63], v11 offset:4608
  v_mfma_f32_16x16x32_bf16 v[192:195], v[72:75], v[104:107], v[192:195]
  ds_read_b64_tr_b16 v[64:65], v10 offset:8192
  s_add_u32 s30, s30, 12288
  v_mfma_f32_16x16x32_bf16 v[196:199], v[76:79], v[104:107], v[196:199]
  ds_read_b64_tr_b16 v[66:67], v10 offset:8704
  s_cmp_eq_u32 s30, 49152
  v_mfma_f32_16x16x32_bf16 v[200:203], v[80:83], v[104:107], v[200:203]
  ds_read_b64_tr_b16 v[68:69], v11 offset:8192
  s_cselect_b32 s30, 0, s30
  v_mfma_f32_16x16x32_bf16 v[204:207], v[84:87], v[104:107], v[204:207]
  ds_read_b64_tr_b16 v[70:71], v11 offset:8704
  v_mfma_f32_16x16x32_bf16 v[208:211], v[72:75], v[108:111], v[208:211]
  ds_read_b64_tr_b16 v[48:49], v10 offset:0
  v_mfma_f32_16x16x32_bf16 v[212:215], v[76:79], v[108:111], v[212:215]
  ds_read_b64_tr_b16 v[50:51], v10 offset:512
  v_mfma_f32_16x16x32_bf16 v[216:219], v[80:83], v[108:111], v[216:219]
  ds_read_b64_tr_b16 v[52:53], v11 offset:0
  v_mfma_f32_16x16x32_bf16 v[220:223], v[84:87], v[108:111], v[220:223]
  ds_read_b64_tr_b16 v[54:55], v11 offset:512
  v_mfma_f32_16x16x32_bf16 v[128:131], v[88:91], v[72:75], v[128:131]
  v_add_u32 v8, 0x4000, v8
  v_mfma_f32_16x16x32_bf16 v[132:135], v[88:91], v[76:79], v[132:135]
  v_add_u32 v10, s30, v12
  v_mfma_f32_16x16x32_bf16 v[136:139], v[88:91], v[80:83], v[136:139]
  v_add_u32 v11, s30, v13
  v_mfma_f32_16x16x32_bf16 v[140:143], v[88:91], v[84:87], v[140:143]
  v_and_b32 v8, 0xffff, v8
  v_mfma_f32_16x16x32_bf16 v[144:147], v[92:95], v[72:75], v[144:147]
  v_mfma_f32_16x16x32_bf16 v[148:151], v[92:95], v[76:79], v[148:151]
  v_mfma_f32_16x16x32_bf16 v[152:155], v[92:95], v[80:83], v[152:155]
  s_waitcnt lgkmcnt(0)
  v_mfma_f32_16x16x32_bf16 v[156:159], v[92:95], v[84:87], v[156:159]
.fz_kernel_q_l0:
  s_barrier
  v_mfma_f32_16x16x32_bf16 v[160:163], v[56:59], v[32:35], v[160:163]
  ds_read_b64_tr_b16 v[96:97], v10 offset:4096
  v_mfma_f32_16x16x32_bf16 v[164:167], v[56:59], v[36:39], v[164:167]
  ds_read_b64_tr_b16 v[98:99], v10 offset:4608
  v_mfma_f32_16x16x32_bf16 v[168:171], v[56:59], v[40:43], v[168:171]
  ds_read_b128 v[72:75], v9 offset:0
  v_mfma_f32_16x16x32_bf16 v[172:175], v[56:59], v[44:47], v[172:175]
  ds_read_b128 v[76:79], v9 offset:2048
  v_mfma_f32_16x16x32_bf16 v[176:179], v[60:63], v[32:35], v[176:179]
  ds_read_b128 v[80:83], v9 offset:4096
  v_mfma_f32_16x16x32_bf16 v[180:183], v[60:63], v[36:39], v[180:183]
  ds_read_b128 v[84:87], v9 offset:6144
  v_mfma_f32_16x16x32_bf16 v[184:187], v[60:63], v[40:43], v[184:187]
  ds_read_b64_tr_b16 v[100:101], v11 offset:4096
  v_mfma_f32_16x16x32_bf16 v[188:191], v[60:63], v[44:47], v[188:191]
  ds_read_b64_tr_b16 v[102:103], v11 offset:4608
  v_mfma_f32_16x16x32_bf16 v[192:195], v[32:35], v[64:67], v[192:195]
  ds_read_b64_tr_b16 v[104:105], v10 offset:8192
  s_add_u32 s30, s30, 12288
  v_mfma_f32_16x16x32_bf16 v[196:199], v[36:39], v[64:67], v[196:199]
  ds_read_b64_tr_b16 v[106:107], v10 offset:8704
  s_cmp_eq_u32 s30, 49152
  v_mfma_f32_16x16x32_bf16 v[200:203], v[40:43], v[64:67], v[200:203]
  ds_read_b64_tr_b16 v[108:109], v11 offset:8192
  s_cselect_b32 s30, 0, s30
  v_mfma_f32_16x16x32_bf16 v[204:207], v[44:47], v[64:67], v[204:207]
  ds_read_b64_tr_b16 v[110:111], v11 offset:8704
  s_sub_u32 s29, s29, 1
  v_mfma_f32_16x16x32_bf16 v[208:211], v[32:35], v[68:71], v[208:211]
  ds_read_b64_tr_b16 v[88:89], v10 offset:0
  s_cmp_lg_u32 s29, 0
  v_mfma_f32_16x16x32_bf16 v[212:215], v[36:39], v[68:71], v[212:215]
  ds_read_b64_tr_b16 v[90:91], v10 offset:512
  v_mfma_f32_16x16x32_bf16 v[216:219], v[40:43], v[68:71], v[216:219]
  ds_read_b64_tr_b16 v[92:93], v11 offset:0
  v_mfma_f32_16x16x32_bf16 v[220:223], v[44:47], v[68:71], v[220:223]
  ds_read_b64_tr_b16 v[94:95], v11 offset:512
  v_mfma_f32_16x16x32_bf16 v[128:131], v[48:51], v[32:35], v[128:131]
  v_add_u32 v9, 0x4000, v9
  v_mfma_f32_16x16x32_bf16 v[132:135], v[48:51], v[36:39], v[132:135]
  v_add_u32 v10, s30, v12
  v_mfma_f32_16x16x32_bf16 v[136:139], v[48:51], v[40:43], v[136:139]
  v_add_u32 v11, s30, v13
  v_mfma_f32_16x16x32_bf16 v[140:143], v[48:51], v[44:47], v[140:143]
  v_and_b32 v9, 0xffff, v9
  v_mfma_f32_16x16x32_bf16 v[144:147], v[52:55], v[32:35], v[144:147]
  s_cbranch_scc1 .fz_kernel_q_loop
  v_mfma_f32_16x16x32_bf16 v[148:151], v[52:55], v[36:39], v[148:151]
  v_mfma_f32_16x16x32_bf16 v[152:155], v[52:55], v[40:43], v[152:155]
  s_waitcnt lgkmcnt(0)
  v_mfma_f32_16x16x32_bf16 v[156:159], v[52:55], v[44:47], v[156:159]
  s_cmp_lg_u32 s62, 0
  s_cbranch_scc1 .fz_kernel_q_nr
  buffer_load_dwordx4 v[232:235], v15, s[12:15], s23 offen offset:0
  buffer_load_dwordx4 v[236:239], v15, s[12:15], s23 offen offset:32
  buffer_load_dwordx4 v[240:243], v15, s[12:15], s23 offen offset:64
  buffer_load_dwordx4 v[244:247], v15, s[12:15], s23 offen offset:96
.fz_kernel_q_nr:
  s_barrier
  v_mfma_f32_16x16x32_bf16 v[160:163], v[96:99], v[72:75], v[160:163]
  s_lshl_b32 s31, s26, 8
  s_add_u32 s31, s31, 155648
  v_and_b32 v14, 15, v2
  v_and_b32 v15, 48, v2
  v_mfma_f32_16x16x32_bf16 v[164:167], v[96:99], v[76:79], v[164:167]
  s_lshl_b32 s33, s27, 7
  s_add_u32 s33, s33, 155648
  v_lshlrev_b32 v14, 2, v14
  v_mov_b32 v1, 159952
  v_mfma_f32_16x16x32_bf16 v[168:171], v[96:99], v[80:83], v[168:171]
  v_add_u32 v29, s33, v14
  v_add_u32 v14, s31, v14
  v_mfma_f32_16x16x32_bf16 v[172:175], v[96:99], v[84:87], v[172:175]
  v_add_u32 v28, s33, v15
  v_add_u32 v15, s31, v15
  v_mfma_f32_16x16x32_bf16 v[176:179], v[100:103], v[72:75], v[176:179]
  ds_read_b32 v1, v1
  v_add_u32 v64, 4608, v14
  v_mfma_f32_16x16x32_bf16 v[180:183], v[100:103], v[76:79], v[180:183]
  ds_read_b128 v[120:123], v28 offset:5888
  v_mfma_f32_16x16x32_bf16 v[184:187], v[100:103], v[80:83], v[184:187]
  ds_read_b128 v[124:127], v28 offset:5952
  v_mfma_f32_16x16x32_bf16 v[188:191], v[100:103], v[84:87], v[188:191]
  ds_read2_b32 v[224:225], v64 offset0:0 offset1:128
  v_mfma_f32_16x16x32_bf16 v[192:195], v[72:75], v[104:107], v[192:195]
  ds_read2_b32 v[226:227], v64 offset0:16 offset1:144
  v_mfma_f32_16x16x32_bf16 v[196:199], v[76:79], v[104:107], v[196:199]
  ds_read2_b32 v[228:229], v64 offset0:32 offset1:160
  v_mfma_f32_16x16x32_bf16 v[200:203], v[80:83], v[104:107], v[200:203]
  ds_read2_b32 v[230:231], v64 offset0:48 offset1:176
  v_mfma_f32_16x16x32_bf16 v[204:207], v[84:87], v[104:107], v[204:207]
  ds_read_b32 v24, v29 offset:6144
  v_mfma_f32_16x16x32_bf16 v[208:211], v[72:75], v[108:111], v[208:211]
  ds_read_b32 v26, v29 offset:6208
  v_mfma_f32_16x16x32_bf16 v[212:215], v[76:79], v[108:111], v[212:215]
  ds_read_b128 v[32:35], v15 offset:4608
  ds_read_b128 v[48:51], v15 offset:5120
  v_mfma_f32_16x16x32_bf16 v[216:219], v[80:83], v[108:111], v[216:219]
  ds_read_b128 v[36:39], v15 offset:4672
  ds_read_b128 v[52:55], v15 offset:5184
  v_mfma_f32_16x16x32_bf16 v[220:223], v[84:87], v[108:111], v[220:223]
  ds_read_b128 v[40:43], v15 offset:4736
  ds_read_b128 v[56:59], v15 offset:5248
  v_mfma_f32_16x16x32_bf16 v[128:131], v[88:91], v[72:75], v[128:131]
  ds_read_b128 v[44:47], v15 offset:4800
  ds_read_b128 v[60:63], v15 offset:5312
  v_mfma_f32_16x16x32_bf16 v[132:135], v[88:91], v[76:79], v[132:135]
  ds_read_b128 v[112:115], v28 offset:5632
  ds_read_b128 v[116:119], v28 offset:5696
  v_mfma_f32_16x16x32_bf16 v[136:139], v[88:91], v[80:83], v[136:139]
  s_lshl1_add_u32 s34, s18, s27
  s_lshl4_add_u32 s34, s34, s17
  s_lshl1_add_u32 s34, s34, s26
  v_mfma_f32_16x16x32_bf16 v[140:143], v[88:91], v[84:87], v[140:143]
  s_lshl_b32 s36, s34, 13
  s_add_u32 s36, s36, s63
  s_add_u32 s37, s36, 4096
  v_mfma_f32_16x16x32_bf16 v[144:147], v[92:95], v[72:75], v[144:147]
  s_lshl_b32 s34, s16, 12
  s_add_u32 s34, s34, 131072
  v_add_u32 v9, s34, v3
  v_mfma_f32_16x16x32_bf16 v[148:151], v[92:95], v[76:79], v[148:151]
  v_xor_b32 v8, 8192, v9
  v_mfma_f32_16x16x32_bf16 v[152:155], v[92:95], v[80:83], v[152:155]
  v_mfma_f32_16x16x32_bf16 v[156:159], v[92:95], v[84:87], v[156:159]
  s_waitcnt lgkmcnt(12)
  v_cmp_ne_u32 vcc, 0, v1
  s_cbranch_vccnz .fz_kernel_q_patch
.fz_kernel_q_pback:
  v_pk_mul_f32 v[64:65], v[120:121], v[224:225] op_sel:[0,1] op_sel_hi:[1,1]
  v_pk_fma_f32 v[160:161], v[160:161], v[224:225], v[64:65] op_sel_hi:[1,0,1]
  v_pk_mul_f32 v[66:67], v[122:123], v[224:225] op_sel:[0,1] op_sel_hi:[1,1]
  v_pk_fma_f32 v[162:163], v[162:163], v[224:225], v[66:67] op_sel_hi:[1,0,1]
  v_pk_mul_f32 v[68:69], v[124:125], v[224:225] op_sel:[0,1] op_sel_hi:[1,1]
  v_pk_fma_f32 v[176:177], v[176:177], v[224:225], v[68:69] op_sel_hi:[1,0,1]
  v_pk_mul_f32 v[70:71], v[126:127], v[224:225] op_sel:[0,1] op_sel_hi:[1,1]
  v_pk_fma_f32 v[178:179], v[178:179], v[224:225], v[70:71] op_sel_hi:[1,0,1]
  v_cvt_pk_bf16_f32 v80, v160, v161
  v_cvt_pk_bf16_f32 v81, v162, v163
  v_cvt_pk_bf16_f32 v82, v176, v177
  v_cvt_pk_bf16_f32 v83, v178, v179
  v_pk_mul_f32 v[64:65], v[120:121], v[226:227] op_sel:[0,1] op_sel_hi:[1,1]
  v_pk_fma_f32 v[164:165], v[164:165], v[226:227], v[64:65] op_sel_hi:[1,0,1]
  v_pk_mul_f32 v[66:67], v[122:123], v[226:227] op_sel:[0,1] op_sel_hi:[1,1]
  v_pk_fma_f32 v[166:167], v[166:167], v[226:227], v[66:67] op_sel_hi:[1,0,1]
  v_pk_mul_f32 v[68:69], v[124:125], v[226:227] op_sel:[0,1] op_sel_hi:[1,1]
  v_pk_fma_f32 v[180:181], v[180:181], v[226:227], v[68:69] op_sel_hi:[1,0,1]
  v_pk_mul_f32 v[70:71], v[126:127], v[226:227] op_sel:[0,1] op_sel_hi:[1,1]
  v_pk_fma_f32 v[182:183], v[182:183], v[226:227], v[70:71] op_sel_hi:[1,0,1]
  v_cvt_pk_bf16_f32 v84, v164, v165
  v_cvt_pk_bf16_f32 v85, v166, v167
  v_cvt_pk_bf16_f32 v86, v180, v181
  v_cvt_pk_bf16_f32 v87, v182, v183
  v_permlane16_swap_b32 v80, v84
  v_permlane16_swap_b32 v81, v85
  v_permlane16_swap_b32 v82, v86
  v_permlane16_swap_b32 v83, v87
  buffer_store_dwordx4 v[80:83], v3, s[4:7], s36 offen offset:0 sc1
  buffer_store_dwordx4 v[84:87], v3, s[4:7], s36 offen offset:1024 sc1
  v_pk_mul_f32 v[64:65], v[120:121], v[228:229] op_sel:[0,1] op_sel_hi:[1,1]
  v_pk_fma_f32 v[168:169], v[168:169], v[228:229], v[64:65] op_sel_hi:[1,0,1]
  v_pk_mul_f32 v[66:67], v[122:123], v[228:229] op_sel:[0,1] op_sel_hi:[1,1]
  v_pk_fma_f32 v[170:171], v[170:171], v[228:229], v[66:67] op_sel_hi:[1,0,1]
  v_pk_mul_f32 v[68:69], v[124:125], v[228:229] op_sel:[0,1] op_sel_hi:[1,1]
  v_pk_fma_f32 v[184:185], v[184:185], v[228:229], v[68:69] op_sel_hi:[1,0,1]
  v_pk_mul_f32 v[70:71], v[126:127], v[228:229] op_sel:[0,1] op_sel_hi:[1,1]
  v_pk_fma_f32 v[186:187], v[186:187], v[228:229], v[70:71] op_sel_hi:[1,0,1]
  v_cvt_pk_bf16_f32 v96, v168, v169
  v_cvt_pk_bf16_f32 v97, v170, v171
  v_cvt_pk_bf16_f32 v98, v184, v185
  v_cvt_pk_bf16_f32 v99, v186, v187
  v_pk_mul_f32 v[64:65], v[120:121], v[230:231] op_sel:[0,1] op_sel_hi:[1,1]
  v_pk_fma_f32 v[172:173], v[172:173], v[230:231], v[64:65] op_sel_hi:[1,0,1]
  v_pk_mul_f32 v[66:67], v[122:123], v[230:231] op_sel:[0,1] op_sel_hi:[1,1]
  v_pk_fma_f32 v[174:175], v[174:175], v[230:231], v[66:67] op_sel_hi:[1,0,1]
  v_pk_mul_f32 v[68:69], v[124:125], v[230:231] op_sel:[0,1] op_sel_hi:[1,1]
  v_pk_fma_f32 v[188:189], v[188:189], v[230:231], v[68:69] op_sel_hi:[1,0,1]
  v_pk_mul_f32 v[70:71], v[126:127], v[230:231] op_sel:[0,1] op_sel_hi:[1,1]
  v_pk_fma_f32 v[190:191], v[190:191], v[230:231], v[70:71] op_sel_hi:[1,0,1]
  v_cvt_pk_bf16_f32 v100, v172, v173
  v_cvt_pk_bf16_f32 v101, v174, v175
  v_cvt_pk_bf16_f32 v102, v188, v189
  v_cvt_pk_bf16_f32 v103, v190, v191
  v_permlane16_swap_b32 v96, v100
  v_permlane16_swap_b32 v97, v101
  v_permlane16_swap_b32 v98, v102
  v_permlane16_swap_b32 v99, v103
  buffer_store_dwordx4 v[96:99], v3, s[4:7], s37 offen offset:0 sc1
  buffer_store_dwordx4 v[100:103], v3, s[4:7], s37 offen offset:1024 sc1
  s_waitcnt lgkmcnt(0)
  v_pk_mul_f32 v[64:65], v[48:49], v[24:25] op_sel_hi:[1,0]
  v_pk_fma_f32 v[192:193], v[192:193], v[32:33], v[64:65]
  v_pk_mul_f32 v[66:67], v[50:51], v[24:25] op_sel_hi:[1,0]
  v_pk_fma_f32 v[194:195], v[194:195], v[34:35], v[66:67]
  v_pk_mul_f32 v[68:69], v[48:49], v[26:27] op_sel_hi:[1,0]
  v_pk_fma_f32 v[208:209], v[208:209], v[32:33], v[68:69]
  v_pk_mul_f32 v[70:71], v[50:51], v[26:27] op_sel_hi:[1,0]
  v_pk_fma_f32 v[210:211], v[210:211], v[34:35], v[70:71]
  v_cvt_pk_bf16_f32 v88, v192, v193
  v_cvt_pk_bf16_f32 v90, v208, v209
  v_cvt_pk_bf16_f32 v89, v194, v195
  v_cvt_pk_bf16_f32 v91, v210, v211
  v_pk_mul_f32 v[64:65], v[52:53], v[24:25] op_sel_hi:[1,0]
  v_pk_fma_f32 v[196:197], v[196:197], v[36:37], v[64:65]
  v_pk_mul_f32 v[66:67], v[54:55], v[24:25] op_sel_hi:[1,0]
  v_pk_fma_f32 v[198:199], v[198:199], v[38:39], v[66:67]
  v_pk_mul_f32 v[68:69], v[52:53], v[26:27] op_sel_hi:[1,0]
  v_pk_fma_f32 v[212:213], v[212:213], v[36:37], v[68:69]
  v_pk_mul_f32 v[70:71], v[54:55], v[26:27] op_sel_hi:[1,0]
  v_pk_fma_f32 v[214:215], v[214:215], v[38:39], v[70:71]
  v_cvt_pk_bf16_f32 v92, v196, v197
  v_cvt_pk_bf16_f32 v94, v212, v213
  v_cvt_pk_bf16_f32 v93, v198, v199
  v_cvt_pk_bf16_f32 v95, v214, v215
  v_permlane16_swap_b32 v88, v90
  v_permlane16_swap_b32 v89, v91
  v_permlane16_swap_b32 v92, v94
  v_permlane16_swap_b32 v93, v95
  v_permlane32_swap_b32 v88, v90
  v_permlane32_swap_b32 v89, v91
  v_permlane32_swap_b32 v92, v94
  v_permlane32_swap_b32 v93, v95
  buffer_store_dwordx4 v[88:91], v3, s[4:7], s36 offen offset:2048 sc1
  buffer_store_dwordx4 v[92:95], v3, s[4:7], s36 offen offset:3072 sc1
  v_pk_mul_f32 v[64:65], v[56:57], v[24:25] op_sel_hi:[1,0]
  v_pk_fma_f32 v[200:201], v[200:201], v[40:41], v[64:65]
  v_pk_mul_f32 v[66:67], v[58:59], v[24:25] op_sel_hi:[1,0]
  v_pk_fma_f32 v[202:203], v[202:203], v[42:43], v[66:67]
  v_pk_mul_f32 v[68:69], v[56:57], v[26:27] op_sel_hi:[1,0]
  v_pk_fma_f32 v[216:217], v[216:217], v[40:41], v[68:69]
  v_pk_mul_f32 v[70:71], v[58:59], v[26:27] op_sel_hi:[1,0]
  v_pk_fma_f32 v[218:219], v[218:219], v[42:43], v[70:71]
  v_cvt_pk_bf16_f32 v104, v200, v201
  v_cvt_pk_bf16_f32 v106, v216, v217
  v_cvt_pk_bf16_f32 v105, v202, v203
  v_cvt_pk_bf16_f32 v107, v218, v219
  v_pk_mul_f32 v[64:65], v[60:61], v[24:25] op_sel_hi:[1,0]
  v_pk_fma_f32 v[204:205], v[204:205], v[44:45], v[64:65]
  v_pk_mul_f32 v[66:67], v[62:63], v[24:25] op_sel_hi:[1,0]
  v_pk_fma_f32 v[206:207], v[206:207], v[46:47], v[66:67]
  v_pk_mul_f32 v[68:69], v[60:61], v[26:27] op_sel_hi:[1,0]
  v_pk_fma_f32 v[220:221], v[220:221], v[44:45], v[68:69]
  v_pk_mul_f32 v[70:71], v[62:63], v[26:27] op_sel_hi:[1,0]
  v_pk_fma_f32 v[222:223], v[222:223], v[46:47], v[70:71]
  v_cvt_pk_bf16_f32 v108, v204, v205
  v_cvt_pk_bf16_f32 v110, v220, v221
  v_cvt_pk_bf16_f32 v109, v206, v207
  v_cvt_pk_bf16_f32 v111, v222, v223
  v_permlane16_swap_b32 v104, v106
  v_permlane16_swap_b32 v105, v107
  v_permlane16_swap_b32 v108, v110
  v_permlane16_swap_b32 v109, v111
  v_permlane32_swap_b32 v104, v106
  v_permlane32_swap_b32 v105, v107
  v_permlane32_swap_b32 v108, v110
  v_permlane32_swap_b32 v109, v111
  buffer_store_dwordx4 v[104:107], v3, s[4:7], s37 offen offset:2048 sc1
  buffer_store_dwordx4 v[108:111], v3, s[4:7], s37 offen offset:3072 sc1
  v_mul_f32 v224, 0.25503486164919736, v224
  v_mul_f32 v225, 0.25503486164919736, v225
  v_mul_f32 v226, 0.25503486164919736, v226
  v_mul_f32 v227, 0.25503486164919736, v227
  v_mul_f32 v228, 0.25503486164919736, v228
  v_mul_f32 v229, 0.25503486164919736, v229
  v_mul_f32 v230, 0.25503486164919736, v230
  v_mul_f32 v231, 0.25503486164919736, v231
  v_pk_mul_f32 v[64:65], v[112:113], v[224:225] op_sel:[0,1] op_sel_hi:[1,1]
  v_pk_fma_f32 v[128:129], v[128:129], v[224:225], v[64:65] op_sel_hi:[1,0,1]
  v_pk_mul_f32 v[66:67], v[114:115], v[224:225] op_sel:[0,1] op_sel_hi:[1,1]
  v_pk_fma_f32 v[130:131], v[130:131], v[224:225], v[66:67] op_sel_hi:[1,0,1]
  v_pk_mul_f32 v[68:69], v[116:117], v[224:225] op_sel:[0,1] op_sel_hi:[1,1]
  v_pk_fma_f32 v[144:145], v[144:145], v[224:225], v[68:69] op_sel_hi:[1,0,1]
  v_pk_mul_f32 v[70:71], v[118:119], v[224:225] op_sel:[0,1] op_sel_hi:[1,1]
  v_pk_fma_f32 v[146:147], v[146:147], v[224:225], v[70:71] op_sel_hi:[1,0,1]
  v_cvt_pk_bf16_f32 v16, v128, v129
  v_cvt_pk_bf16_f32 v17, v130, v131
  v_cvt_pk_bf16_f32 v18, v144, v145
  v_cvt_pk_bf16_f32 v19, v146, v147
  v_pk_mul_f32 v[64:65], v[112:113], v[226:227] op_sel:[0,1] op_sel_hi:[1,1]
  v_pk_fma_f32 v[132:133], v[132:133], v[226:227], v[64:65] op_sel_hi:[1,0,1]
  v_pk_mul_f32 v[66:67], v[114:115], v[226:227] op_sel:[0,1] op_sel_hi:[1,1]
  v_pk_fma_f32 v[134:135], v[134:135], v[226:227], v[66:67] op_sel_hi:[1,0,1]
  v_pk_mul_f32 v[68:69], v[116:117], v[226:227] op_sel:[0,1] op_sel_hi:[1,1]
  v_pk_fma_f32 v[148:149], v[148:149], v[226:227], v[68:69] op_sel_hi:[1,0,1]
  v_pk_mul_f32 v[70:71], v[118:119], v[226:227] op_sel:[0,1] op_sel_hi:[1,1]
  v_pk_fma_f32 v[150:151], v[150:151], v[226:227], v[70:71] op_sel_hi:[1,0,1]
  v_cvt_pk_bf16_f32 v20, v132, v133
  v_cvt_pk_bf16_f32 v21, v134, v135
  v_cvt_pk_bf16_f32 v22, v148, v149
  v_cvt_pk_bf16_f32 v23, v150, v151
  v_permlane16_swap_b32 v16, v20
  v_permlane16_swap_b32 v17, v21
  v_permlane16_swap_b32 v18, v22
  v_permlane16_swap_b32 v19, v23
  ds_write_b128 v8, v[16:19] offset:0
  ds_write_b128 v8, v[20:23] offset:1024
  v_pk_mul_f32 v[64:65], v[112:113], v[228:229] op_sel:[0,1] op_sel_hi:[1,1]
  v_pk_fma_f32 v[136:137], v[136:137], v[228:229], v[64:65] op_sel_hi:[1,0,1]
  v_pk_mul_f32 v[66:67], v[114:115], v[228:229] op_sel:[0,1] op_sel_hi:[1,1]
  v_pk_fma_f32 v[138:139], v[138:139], v[228:229], v[66:67] op_sel_hi:[1,0,1]
  v_pk_mul_f32 v[68:69], v[116:117], v[228:229] op_sel:[0,1] op_sel_hi:[1,1]
  v_pk_fma_f32 v[152:153], v[152:153], v[228:229], v[68:69] op_sel_hi:[1,0,1]
  v_pk_mul_f32 v[70:71], v[118:119], v[228:229] op_sel:[0,1] op_sel_hi:[1,1]
  v_pk_fma_f32 v[154:155], v[154:155], v[228:229], v[70:71] op_sel_hi:[1,0,1]
  v_cvt_pk_bf16_f32 v24, v136, v137
  v_cvt_pk_bf16_f32 v25, v138, v139
  v_cvt_pk_bf16_f32 v26, v152, v153
  v_cvt_pk_bf16_f32 v27, v154, v155
  v_pk_mul_f32 v[64:65], v[112:113], v[230:231] op_sel:[0,1] op_sel_hi:[1,1]
  v_pk_fma_f32 v[140:141], v[140:141], v[230:231], v[64:65] op_sel_hi:[1,0,1]
  v_pk_mul_f32 v[66:67], v[114:115], v[230:231] op_sel:[0,1] op_sel_hi:[1,1]
  v_pk_fma_f32 v[142:143], v[142:143], v[230:231], v[66:67] op_sel_hi:[1,0,1]
  v_pk_mul_f32 v[68:69], v[116:117], v[230:231] op_sel:[0,1] op_sel_hi:[1,1]
  v_pk_fma_f32 v[156:157], v[156:157], v[230:231], v[68:69] op_sel_hi:[1,0,1]
  v_pk_mul_f32 v[70:71], v[118:119], v[230:231] op_sel:[0,1] op_sel_hi:[1,1]
  v_pk_fma_f32 v[158:159], v[158:159], v[230:231], v[70:71] op_sel_hi:[1,0,1]
  v_cvt_pk_bf16_f32 v28, v140, v141
  v_cvt_pk_bf16_f32 v29, v142, v143
  v_cvt_pk_bf16_f32 v30, v156, v157
  v_cvt_pk_bf16_f32 v31, v158, v159
  v_permlane16_swap_b32 v24, v28
  v_permlane16_swap_b32 v25, v29
  v_permlane16_swap_b32 v26, v30
  v_permlane16_swap_b32 v27, v31
  ds_write_b128 v8, v[24:27] offset:2048
  ds_write_b128 v8, v[28:31] offset:3072
  s_branch .fz_kernel_att
.fz_kernel_q_help1:
  s_mov_b32 s3, 32
  s_cmp_eq_u32 s16, 7
  s_cbranch_scc1 .fz_kernel_q_h7
  s_getpc_b64 s[0:1]
.fz_kernel_ct4:
  s_sub_u32 s0, s0, .fz_kernel_ct4-fz_kernel
  s_subb_u32 s1, s1, 0
  s_lshr_b32 s31, s2, 3
  s_mulk_i32 s31, 0x500
  v_lshl_add_u32 v1, v2, 7, s31
  v_min_u32 v1, .fz_kernel_last-fz_kernel, v1
  s_mov_b64 exec, 0x3ff
  global_load_dword v1, v1, s[0:1]
  s_mov_b64 exec, -1
.fz_kernel_ct4e:
  s_mov_b32 s12, s58
  s_mov_b32 s13, s59
  s_mov_b32 s14, 0x100
  s_mov_b32 s15, 0x00020000
  s_mov_b32 s30, 0
  s_and_b32 s31, s18, 3
  s_sub_u32 s31, s31, s30
  s_and_b32 s30, s31, 3
  s_lshl_b32 s30, s30, 14
  v_and_b32 v20, 15, v2
  v_lshrrev_b32 v21, 4, v2
  v_bfe_u32 v22, v2, 1, 3
  v_xor_b32 v22, v22, v21
  v_lshlrev_b32 v21, 7, v20
  v_lshl_add_u32 v21, v22, 4, v21
  v_add_u32 v21, s30, v21
  v_xor_b32 v22, 64, v21
  v_lshlrev_b32 v20, 3, v20
  s_lshl_b32 s30, s17, 10
  s_add_u32 s30, s30, 0x1808000
  s_mov_b32 exec_lo, 0x00f0000f
  s_mov_b32 exec_hi, 0xf0000f00
  v_add_u32 v20, 4, v20
  s_mov_b64 exec, -1
  v_mov_b32 v24, 0x3f803f80
  v_mov_b32 v25, v24
  v_mov_b32 v26, v24
  v_mov_b32 v27, v24
  s_lshl_b32 s31, s31, 1
  s_sub_u32 s31, 31, s31
  s_mov_b32 s20, s48
  s_mov_b32 s21, s49
  s_mov_b32 s22, 0x800
  s_mov_b32 s23, 0x00020000
  v_lshlrev_b32 v40, 5, v2
  buffer_load_dwordx4 v[44:47], v40, s[20:23], 0 offen
  buffer_load_dwordx4 v[48:51], v40, s[20:23], 0 offen offset:16
  v_mov_b32 v40, 0
  s_waitcnt vmcnt(0)
  v_lshlrev_b32 v41, 16, v44
  v_and_b32 v42, 0xffff0000, v44
  v_add_f32 v40, v40, v41
  v_add_f32 v40, v40, v42
  v_lshlrev_b32 v41, 16, v45
  v_and_b32 v42, 0xffff0000, v45
  v_add_f32 v40, v40, v41
  v_add_f32 v40, v40, v42
  v_lshlrev_b32 v41, 16, v46
  v_and_b32 v42, 0xffff0000, v46
  v_add_f32 v40, v40, v41
  v_add_f32 v40, v40, v42
  v_lshlrev_b32 v41, 16, v47
  v_and_b32 v42, 0xffff0000, v47
  v_add_f32 v40, v40, v41
  v_add_f32 v40, v40, v42
  v_lshlrev_b32 v41, 16, v48
  v_and_b32 v42, 0xffff0000, v48
  v_add_f32 v40, v40, v41
  v_add_f32 v40, v40, v42
  v_lshlrev_b32 v41, 16, v49
  v_and_b32 v42, 0xffff0000, v49
  v_add_f32 v40, v40, v41
  v_add_f32 v40, v40, v42
  v_lshlrev_b32 v41, 16, v50
  v_and_b32 v42, 0xffff0000, v50
  v_add_f32 v40, v40, v41
  v_add_f32 v40, v40, v42
  v_lshlrev_b32 v41, 16, v51
  v_and_b32 v42, 0xffff0000, v51
  v_add_f32 v40, v40, v41
  v_add_f32 v40, v40, v42
  s_nop 1
  v_add_f32 v40, v40, v40 quad_perm:[1,0,3,2] row_mask:0xf bank_mask:0xf
  s_nop 1
  v_add_f32 v40, v40, v40 quad_perm:[2,3,0,1] row_mask:0xf bank_mask:0xf
  s_nop 1
  v_add_f32 v40, v40, v40 row_half_mirror row_mask:0xf bank_mask:0xf
  s_nop 1
  v_add_f32 v40, v40, v40 row_mirror row_mask:0xf bank_mask:0xf
  s_nop 0
  v_readlane_b32 s20, v40, 16
  v_readlane_b32 s21, v40, 32
  v_readlane_b32 s22, v40, 48
  v_add_f32 v40, s20, v40
  v_add_f32 v40, s21, v40
  v_add_f32 v40, s22, v40
  v_mul_f32 v40, 0x3a800000, v40
  s_nop 0
  v_readfirstlane_b32 s76, v40
.fz_kernel_xs5:
  s_barrier
  s_sub_u32 s3, s3, 1
  s_cmp_lg_u32 s3, s31
  s_cbranch_scc1 .fz_kernel_xs5
  ds_read_b128 v[64:67], v21 offset:0
  ds_read_b128 v[72:75], v21 offset:2048
  ds_read_b128 v[80:83], v21 offset:4096
  ds_read_b128 v[88:91], v21 offset:6144
  ds_read_b128 v[96:99], v21 offset:8192
  ds_read_b128 v[104:107], v21 offset:10240
  ds_read_b128 v[112:115], v21 offset:12288
  ds_read_b128 v[120:123], v21 offset:14336
  ds_read_b128 v[68:71], v22 offset:0
  ds_read_b128 v[76:79], v22 offset:2048
  ds_read_b128 v[84:87], v22 offset:4096
  ds_read_b128 v[92:95], v22 offset:6144
  ds_read_b128 v[100:103], v22 offset:8192
  ds_read_b128 v[108:111], v22 offset:10240
  ds_read_b128 v[116:119], v22 offset:12288
  ds_read_b128 v[124:127], v22 offset:14336
  s_waitcnt lgkmcnt(0)
  s_cmp_eq_u32 s3, 0
  s_cbranch_scc1 .fz_kernel_hb6
  s_barrier
  s_sub_u32 s3, s3, 1
.fz_kernel_hb6:
  s_setprio 2
  v_mfma_f32_16x16x32_bf16 v[128:131], v[24:27], v[64:67], 0
  v_mfma_f32_16x16x32_bf16 v[160:163], v[64:67], v[64:67], 0
  v_mfma_f32_16x16x32_bf16 v[132:135], v[24:27], v[72:75], 0
  v_mfma_f32_16x16x32_bf16 v[164:167], v[72:75], v[72:75], 0
  v_mfma_f32_16x16x32_bf16 v[136:139], v[24:27], v[80:83], 0
  v_mfma_f32_16x16x32_bf16 v[168:171], v[80:83], v[80:83], 0
  v_mfma_f32_16x16x32_bf16 v[140:143], v[24:27], v[88:91], 0
  v_mfma_f32_16x16x32_bf16 v[172:175], v[88:91], v[88:91], 0
  v_mfma_f32_16x16x32_bf16 v[144:147], v[24:27], v[96:99], 0
  v_mfma_f32_16x16x32_bf16 v[176:179], v[96:99], v[96:99], 0
  v_mfma_f32_16x16x32_bf16 v[148:151], v[24:27], v[104:107], 0
  v_mfma_f32_16x16x32_bf16 v[180:183], v[104:107], v[104:107], 0
  v_mfma_f32_16x16x32_bf16 v[152:155], v[24:27], v[112:115], 0
  v_mfma_f32_16x16x32_bf16 v[184:187], v[112:115], v[112:115], 0
  v_mfma_f32_16x16x32_bf16 v[156:159], v[24:27], v[120:123], 0
  v_mfma_f32_16x16x32_bf16 v[188:191], v[120:123], v[120:123], 0
  v_mfma_f32_16x16x32_bf16 v[128:131], v[24:27], v[68:71], v[128:131]
  v_mfma_f32_16x16x32_bf16 v[160:163], v[68:71], v[68:71], v[160:163]
  v_mfma_f32_16x16x32_bf16 v[132:135], v[24:27], v[76:79], v[132:135]
  v_mfma_f32_16x16x32_bf16 v[164:167], v[76:79], v[76:79], v[164:167]
  v_mfma_f32_16x16x32_bf16 v[136:139], v[24:27], v[84:87], v[136:139]
  v_mfma_f32_16x16x32_bf16 v[168:171], v[84:87], v[84:87], v[168:171]
  v_mfma_f32_16x16x32_bf16 v[140:143], v[24:27], v[92:95], v[140:143]
  v_mfma_f32_16x16x32_bf16 v[172:175], v[92:95], v[92:95], v[172:175]
  v_mfma_f32_16x16x32_bf16 v[144:147], v[24:27], v[100:103], v[144:147]
  v_mfma_f32_16x16x32_bf16 v[176:179], v[100:103], v[100:103], v[176:179]
  v_mfma_f32_16x16x32_bf16 v[148:151], v[24:27], v[108:111], v[148:151]
  v_mfma_f32_16x16x32_bf16 v[180:183], v[108:111], v[108:111], v[180:183]
  v_mfma_f32_16x16x32_bf16 v[152:155], v[24:27], v[116:119], v[152:155]
  v_mfma_f32_16x16x32_bf16 v[184:187], v[116:119], v[116:119], v[184:187]
  v_mfma_f32_16x16x32_bf16 v[156:159], v[24:27], v[124:127], v[156:159]
  v_mfma_f32_16x16x32_bf16 v[188:191], v[124:127], v[124:127], v[188:191]
  s_setprio 0
  s_cmp_eq_u32 s3, 0
  s_cbranch_scc1 .fz_kernel_hb7
  s_barrier
  s_sub_u32 s3, s3, 1
.fz_kernel_hb7:
  s_mov_b32 exec_lo, 0x100001
  s_mov_b32 exec_hi, 0x10000100
  buffer_load_dword v9, v4, s[12:15], 0 offen sc1
  v_mov_b32 v128, v160
  v_mov_b32 v132, v164
  v_mov_b32 v136, v168
  v_mov_b32 v140, v172
  v_mov_b32 v144, v176
  v_mov_b32 v148, v180
  v_mov_b32 v152, v184
  v_mov_b32 v156, v188
  s_mov_b32 exec_lo, 0x200002
  s_mov_b32 exec_hi, 0x20000200
  v_mov_b32 v128, v161
  v_mov_b32 v132, v165
  v_mov_b32 v136, v169
  v_mov_b32 v140, v173
  v_mov_b32 v144, v177
  v_mov_b32 v148, v181
  v_mov_b32 v152, v185
  v_mov_b32 v156, v189
  s_mov_b32 exec_lo, 0x400004
  s_mov_b32 exec_hi, 0x40000400
  v_mov_b32 v128, v162
  v_mov_b32 v132, v166
  v_mov_b32 v136, v170
  v_mov_b32 v140, v174
  v_mov_b32 v144, v178
  v_mov_b32 v148, v182
  v_mov_b32 v152, v186
  v_mov_b32 v156, v190
  s_mov_b32 exec_lo, 0x800008
  s_mov_b32 exec_hi, 0x80000800
  v_mov_b32 v128, v163
  v_mov_b32 v132, v167
  v_mov_b32 v136, v171
  v_mov_b32 v140, v175
  v_mov_b32 v144, v179
  v_mov_b32 v148, v183
  v_mov_b32 v152, v187
  v_mov_b32 v156, v191
  s_mov_b64 exec, 1
  s_mov_b32 s38, 0
.fz_kernel_pw8:
  s_mov_b32 s46, 0
  s_call_b64 s[0:1], .fz_kernel_hw
  s_waitcnt vmcnt(0)
  v_readfirstlane_b32 s31, v9
  s_cmp_eq_u32 s31, 64
  s_cbranch_scc1 .fz_kernel_pw8d
  s_cmp_eq_u32 s3, 0
  s_cbranch_scc1 .fz_kernel_hb9
  s_barrier
  s_sub_u32 s3, s3, 1
.fz_kernel_hb9:
  s_cmp_eq_u32 s3, 0
  s_cbranch_scc1 .fz_kernel_hb10
  s_barrier
  s_sub_u32 s3, s3, 1
.fz_kernel_hb10:
  buffer_load_dword v9, v4, s[12:15], 0 offen sc1
  s_add_u32 s38, s38, 1
  s_cmp_lt_u32 s38, 131072
  s_cbranch_scc1 .fz_kernel_pw8
  s_waitcnt vmcnt(0)
.fz_kernel_pw8d:
  s_mov_b64 exec, -1
  s_mov_b32 exec_lo, 0x00fff00f
  s_mov_b32 exec_hi, 0xff000ff0
  buffer_atomic_add_f32 v128, v20, s[4:7], s30 offen offset:0 sc1
  buffer_atomic_add_f32 v132, v20, s[4:7], s30 offen offset:128 sc1
  buffer_atomic_add_f32 v136, v20, s[4:7], s30 offen offset:256 sc1
  buffer_atomic_add_f32 v140, v20, s[4:7], s30 offen offset:384 sc1
  buffer_atomic_add_f32 v144, v20, s[4:7], s30 offen offset:512 sc1
  buffer_atomic_add_f32 v148, v20, s[4:7], s30 offen offset:640 sc1
  buffer_atomic_add_f32 v152, v20, s[4:7], s30 offen offset:768 sc1
  buffer_atomic_add_f32 v156, v20, s[4:7], s30 offen offset:896 sc1
  s_mov_b64 exec, -1
  s_mov_b32 s46, 0
  s_call_b64 s[0:1], .fz_kernel_hw
  s_waitcnt vmcnt(0)
  v_lshlrev_b32 v7, 11, v2
  s_lshl_b32 s31, s17, 7
  s_lshl_b32 s33, 1, s18
  s_add_u32 s31, s31, s67
  s_add_u32 s31, s31, 0x1800018
  v_mov_b32 v8, s33
  s_mov_b64 exec, 0xffff
  buffer_atomic_or v8, v7, s[4:7], s31 offen sc1
  s_mov_b64 exec, -1
  s_add_u32 s37, s19, 24
.fz_kernel_f111:
  s_cmp_le_u32 s3, 8
  s_cbranch_scc1 .fz_kernel_f111d
  s_barrier
  s_sub_u32 s3, s3, 1
  s_branch .fz_kernel_f111
.fz_kernel_f111d:
  s_mov_b64 exec, 1
  buffer_load_dword v9, v4, s[4:7], s37 offen sc1
  s_mov_b64 exec, 1
  s_mov_b32 s38, 0
.fz_kernel_pw12:
  s_mov_b32 s46, 0
  s_call_b64 s[0:1], .fz_kernel_hw
  s_waitcnt vmcnt(0)
  v_readfirstlane_b32 s31, v9
  s_cmp_eq_u32 s31, 65535
  s_cbranch_scc1 .fz_kernel_pw12d
  s_cmp_eq_u32 s3, 0
  s_cbranch_scc1 .fz_kernel_hb13
  s_barrier
  s_sub_u32 s3, s3, 1
.fz_kernel_hb13:
  s_cmp_eq_u32 s3, 0
  s_cbranch_scc1 .fz_kernel_hb14
  s_barrier
  s_sub_u32 s3, s3, 1
.fz_kernel_hb14:
  buffer_load_dword v9, v4, s[4:7], s37 offen sc1
  s_add_u32 s38, s38, 1
  s_cmp_lt_u32 s38, 131072
  s_cbranch_scc1 .fz_kernel_pw12
  s_waitcnt vmcnt(0)
.fz_kernel_pw12d:
  s_mov_b64 exec, -1
  buffer_load_dwordx4 v[64:67], v3, s[4:7], s30 offen sc1
  s_mov_b32 s46, 0
  s_call_b64 s[0:1], .fz_kernel_hw
  s_waitcnt vmcnt(0)
  v_mov_b32 v26, 0.0009765625
  v_mul_f32 v20, v26, v64
  v_mul_f32 v27, v20, v20
  v_fma_f32 v22, v65, v26, -v27
  v_max_f32 v22, 0, v22
  v_add_f32 v22, 1e-05, v22
  v_rsq_f32 v22, v22
  s_nop 0
  v_mul_f32 v20, v20, v22
  v_sub_f32 v20, 0, v20
  v_mul_f32 v21, v26, v66
  v_mul_f32 v27, v21, v21
  v_fma_f32 v23, v67, v26, -v27
  v_max_f32 v23, 0, v23
  v_add_f32 v23, 1e-05, v23
  v_rsq_f32 v23, v23
  s_nop 0
  v_mul_f32 v21, v21, v23
  v_sub_f32 v21, 0, v21
  v_lshlrev_b32 v24, 3, v2
  v_add_u32 v24, 155648, v24
  ds_write_b64 v24, v[22:23] offset:4608
  ds_write_b64 v24, v[20:21] offset:5120
  v_mov_b32 v20, 1.0
  v_mov_b32 v21, 1.0
  v_mov_b32 v22, 0
  v_mov_b32 v23, 0
  ds_write_b64 v24, v[20:21] offset:6400
  ds_write_b64 v24, v[22:23] offset:6912
  v_mov_b32 v24, 159952
  v_mov_b32 v25, s76
  ds_write_b32 v24, v25 offset:8
  s_waitcnt lgkmcnt(0)
.fz_kernel_q_hw2:
  s_add_u32 s3, s3, 2
.fz_kernel_q_he:
  s_cmp_eq_u32 s3, 0
  s_cbranch_scc1 .fz_kernel_chain
  s_barrier
  s_sub_u32 s3, s3, 1
  s_branch .fz_kernel_q_he
.fz_kernel_q_h7:
  s_mov_b32 s8, s58
  s_mov_b32 s9, s59
  s_mov_b32 s10, 0x100
  s_mov_b32 s11, 0x00020000
  v_mov_b32 v12, 0
  v_mov_b32 v13, 0
  v_mov_b32 v14, 0
  v_mov_b32 v15, 0
  s_cmp_ge_u32 s2, 64
  s_cbranch_scc1 .fz_kernel_q_nzero
  s_lshl_b32 s36, s2, 10
  s_add_u32 s36, s36, 0x1800000
  buffer_store_dwordx4 v[12:15], v3, s[4:7], s36 offen sc1
.fz_kernel_q_nzero:
  v_and_b32 v21, 7, v2
  v_and_b32 v20, 16, v2
  v_lshlrev_b32 v20, 1, v20
  v_xor_b32 v20, v20, v3
  s_bfe_u32 s33, s17, 0x10002
  s_lshl_b32 s33, s33, 1
  s_and_b32 s31, s33, 3
  s_mul_i32 s31, s31, 12288
  s_add_u32 s31, s31, 65536
  v_add_u32 v16, s31, v20
  v_xor_b32 v17, 64, v16
  s_add_u32 s31, s31, 12288
  v_add_u32 v18, s31, v20
  v_xor_b32 v19, 64, v18
  s_sub_u32 s33, 31, s33
  v_lshlrev_b32 v21, 5, v21
  v_and_b32 v22, 24, v2
  v_add_u32 v21, v22, v21
  v_lshrrev_b32 v22, 5, v2
  v_lshl_add_u32 v21, v22, 2, v21
  s_lshl_b32 s30, s18, 10
  s_add_u32 s30, s30, 0x180c000
  v_and_b32 v22, 1, v2
  v_lshlrev_b32 v22, 4, v22
  v_mov_b32 v23, 0x3f80
  v_lshlrev_b32 v22, v22, v23
  v_mov_b32 v24, 0
  v_mov_b32 v25, 0
  v_mov_b32 v26, 0
  v_mov_b32 v27, 0
  s_mov_b32 exec_lo, 0x3030303
  s_mov_b32 exec_hi, 0x3030303
  v_mov_b32 v24, v22
  s_mov_b32 exec_lo, 0xc0c0c0c
  s_mov_b32 exec_hi, 0xc0c0c0c
  v_mov_b32 v25, v22
  s_mov_b32 exec_lo, 0x30303030
  s_mov_b32 exec_hi, 0x30303030
  v_mov_b32 v26, v22
  s_mov_b32 exec_lo, 0xc0c0c0c0
  s_mov_b32 exec_hi, 0xc0c0c0c0
  v_mov_b32 v27, v22
  s_mov_b64 exec, -1
  s_cmp_ge_u32 s2, 64
  s_cbranch_scc1 .fz_kernel_nz2
  s_mov_b64 exec, 1
  s_waitcnt vmcnt(0)
  buffer_atomic_add v5, v4, s[8:11], 0 offen sc1
  s_mov_b64 exec, -1
.fz_kernel_nz2:
  s_barrier
  s_sub_u32 s3, s3, 1
  s_cmp_lg_u32 s3, s33
  s_cbranch_scc1 .fz_kernel_nz2
  ds_read_b128 v[64:67], v16 offset:0
  ds_read_b128 v[68:71], v16 offset:4096
  ds_read_b128 v[72:75], v16 offset:8192
  ds_read_b128 v[76:79], v17 offset:1024
  ds_read_b128 v[80:83], v17 offset:5120
  ds_read_b128 v[84:87], v17 offset:9216
  ds_read_b128 v[88:91], v16 offset:2048
  ds_read_b128 v[92:95], v16 offset:6144
  ds_read_b128 v[96:99], v16 offset:10240
  ds_read_b128 v[100:103], v17 offset:3072
  ds_read_b128 v[104:107], v17 offset:7168
  ds_read_b128 v[108:111], v17 offset:11264
  s_waitcnt lgkmcnt(0)
  s_cmp_eq_u32 s3, 0
  s_cbranch_scc1 .fz_kernel_hb15
  s_barrier
  s_sub_u32 s3, s3, 1
.fz_kernel_hb15:
  ds_read_b128 v[112:115], v18 offset:0
  ds_read_b128 v[116:119], v18 offset:4096
  ds_read_b128 v[120:123], v18 offset:8192
  ds_read_b128 v[124:127], v19 offset:1024
  ds_read_b128 v[128:131], v19 offset:5120
  ds_read_b128 v[132:135], v19 offset:9216
  ds_read_b128 v[136:139], v18 offset:2048
  ds_read_b128 v[140:143], v18 offset:6144
  ds_read_b128 v[144:147], v18 offset:10240
  ds_read_b128 v[148:151], v19 offset:3072
  ds_read_b128 v[152:155], v19 offset:7168
  ds_read_b128 v[156:159], v19 offset:11264
  s_waitcnt lgkmcnt(0)
  s_cmp_eq_u32 s3, 0
  s_cbranch_scc1 .fz_kernel_hb16
  s_barrier
  s_sub_u32 s3, s3, 1
.fz_kernel_hb16:
  s_setprio 2
  v_mfma_f32_16x16x32_bf16 v[160:163], v[24:27], v[64:67], 0
  v_mfma_f32_16x16x32_bf16 v[164:167], v[24:27], v[68:71], 0
  v_mfma_f32_16x16x32_bf16 v[168:171], v[24:27], v[72:75], 0
  v_mfma_f32_16x16x32_bf16 v[160:163], v[24:27], v[76:79], v[160:163]
  v_mfma_f32_16x16x32_bf16 v[164:167], v[24:27], v[80:83], v[164:167]
  v_mfma_f32_16x16x32_bf16 v[168:171], v[24:27], v[84:87], v[168:171]
  v_mfma_f32_16x16x32_bf16 v[160:163], v[24:27], v[88:91], v[160:163]
  v_mfma_f32_16x16x32_bf16 v[164:167], v[24:27], v[92:95], v[164:167]
  v_mfma_f32_16x16x32_bf16 v[168:171], v[24:27], v[96:99], v[168:171]
  v_mfma_f32_16x16x32_bf16 v[160:163], v[24:27], v[100:103], v[160:163]
  v_mfma_f32_16x16x32_bf16 v[164:167], v[24:27], v[104:107], v[164:167]
  v_mfma_f32_16x16x32_bf16 v[168:171], v[24:27], v[108:111], v[168:171]
  v_mfma_f32_16x16x32_bf16 v[160:163], v[24:27], v[112:115], v[160:163]
  v_mfma_f32_16x16x32_bf16 v[164:167], v[24:27], v[116:119], v[164:167]
  v_mfma_f32_16x16x32_bf16 v[168:171], v[24:27], v[120:123], v[168:171]
  v_mfma_f32_16x16x32_bf16 v[160:163], v[24:27], v[124:127], v[160:163]
  v_mfma_f32_16x16x32_bf16 v[164:167], v[24:27], v[128:131], v[164:167]
  v_mfma_f32_16x16x32_bf16 v[168:171], v[24:27], v[132:135], v[168:171]
  v_mfma_f32_16x16x32_bf16 v[160:163], v[24:27], v[136:139], v[160:163]
  v_mfma_f32_16x16x32_bf16 v[164:167], v[24:27], v[140:143], v[164:167]
  v_mfma_f32_16x16x32_bf16 v[168:171], v[24:27], v[144:147], v[168:171]
  v_mfma_f32_16x16x32_bf16 v[160:163], v[24:27], v[148:151], v[160:163]
  v_mfma_f32_16x16x32_bf16 v[164:167], v[24:27], v[152:155], v[164:167]
  v_mfma_f32_16x16x32_bf16 v[168:171], v[24:27], v[156:159], v[168:171]
  s_setprio 0
  s_mov_b64 exec, 1
  buffer_load_dword v9, v4, s[8:11], 0 offen sc1
  s_mov_b64 exec, -1
  s_nop 1
  v_add_f32 v160, v160, v160 row_ror:8 row_mask:0xf bank_mask:0xf
  v_add_f32 v161, v161, v161 row_ror:8 row_mask:0xf bank_mask:0xf
  v_add_f32 v162, v162, v162 row_ror:8 row_mask:0xf bank_mask:0xf
  v_add_f32 v163, v163, v163 row_ror:8 row_mask:0xf bank_mask:0xf
  v_add_f32 v164, v164, v164 row_ror:8 row_mask:0xf bank_mask:0xf
  v_add_f32 v165, v165, v165 row_ror:8 row_mask:0xf bank_mask:0xf
  v_add_f32 v166, v166, v166 row_ror:8 row_mask:0xf bank_mask:0xf
  v_add_f32 v167, v167, v167 row_ror:8 row_mask:0xf bank_mask:0xf
  v_add_f32 v168, v168, v168 row_ror:8 row_mask:0xf bank_mask:0xf
  v_add_f32 v169, v169, v169 row_ror:8 row_mask:0xf bank_mask:0xf
  v_add_f32 v170, v170, v170 row_ror:8 row_mask:0xf bank_mask:0xf
  v_add_f32 v171, v171, v171 row_ror:8 row_mask:0xf bank_mask:0xf
  s_mov_b32 exec_lo, 0x0
  s_mov_b32 exec_hi, 0xff00ff
  v_mov_b32 v160, v161
  v_mov_b32 v164, v165
  v_mov_b32 v168, v169
  s_mov_b32 exec_lo, 0xff00ff00
  s_mov_b32 exec_hi, 0x0
  v_mov_b32 v160, v162
  v_mov_b32 v164, v166
  v_mov_b32 v168, v170
  s_mov_b32 exec_lo, 0x0
  s_mov_b32 exec_hi, 0xff00ff00
  v_mov_b32 v160, v163
  v_mov_b32 v164, v167
  v_mov_b32 v168, v171
  s_mov_b64 exec, 1
  s_mov_b32 s38, 0
.fz_kernel_pw17:
  s_mov_b32 s46, 0
  s_call_b64 s[0:1], .fz_kernel_hw
  s_waitcnt vmcnt(0)
  v_readfirstlane_b32 s31, v9
  s_cmp_eq_u32 s31, 64
  s_cbranch_scc1 .fz_kernel_pw17d
  s_cmp_eq_u32 s3, 0
  s_cbranch_scc1 .fz_kernel_hb18
  s_barrier
  s_sub_u32 s3, s3, 1
.fz_kernel_hb18:
  s_cmp_eq_u32 s3, 0
  s_cbranch_scc1 .fz_kernel_hb19
  s_barrier
  s_sub_u32 s3, s3, 1
.fz_kernel_hb19:
  buffer_load_dword v9, v4, s[8:11], 0 offen sc1
  s_add_u32 s38, s38, 1
  s_cmp_lt_u32 s38, 131072
  s_cbranch_scc1 .fz_kernel_pw17
  s_waitcnt vmcnt(0)
.fz_kernel_pw17d:
  s_mov_b64 exec, -1
  buffer_atomic_add_f32 v160, v21, s[4:7], s30 offen offset:0 sc1
  buffer_atomic_add_f32 v164, v21, s[4:7], s30 offen offset:256 sc1
  buffer_atomic_add_f32 v168, v21, s[4:7], s30 offen offset:512 sc1
  s_mov_b32 s46, 0
  s_call_b64 s[0:1], .fz_kernel_hw
  s_waitcnt vmcnt(0)
  v_lshlrev_b32 v7, 7, v2
  s_lshl_b32 s31, s18, 11
  s_lshl_b32 s33, 1, s17
  s_add_u32 s31, s31, s67
  s_add_u32 s31, s31, 0x180001c
  v_mov_b32 v8, s33
  s_mov_b64 exec, 0xffff
  buffer_atomic_or v8, v7, s[4:7], s31 offen sc1
  s_mov_b64 exec, -1
  s_cmp_ge_u32 s2, 196
  s_cbranch_scc1 .fz_kernel_lz20
  s_lshl_b32 s36, s2, 12
  s_add_u32 s36, s36, 0x1c00000
  s_sub_u32 s31, s2, 66
  s_min_u32 s31, s31, s2
  s_sub_u32 s31, s31, 4
  s_cmp_lt_u32 s31, 6
  s_cbranch_scc1 .fz_kernel_lz20a
  buffer_store_dwordx4 v[12:15], v3, s[4:7], s36 offen sc1
  buffer_store_dwordx4 v[12:15], v3, s[4:7], s36 offen offset:1024 sc1
  buffer_store_dwordx4 v[12:15], v3, s[4:7], s36 offen offset:2048 sc1
  buffer_store_dwordx4 v[12:15], v3, s[4:7], s36 offen offset:3072 sc1
.fz_kernel_lz20:
  s_add_u32 s37, s19, 28
.fz_kernel_f121:
  s_cmp_le_u32 s3, 8
  s_cbranch_scc1 .fz_kernel_f121d
  s_barrier
  s_sub_u32 s3, s3, 1
  s_branch .fz_kernel_f121
.fz_kernel_f121d:
  s_mov_b64 exec, 1
  buffer_load_dword v9, v4, s[4:7], s37 offen sc1
  s_mov_b64 exec, 1
  s_mov_b32 s38, 0
.fz_kernel_pw22:
  s_mov_b32 s46, 0
  s_call_b64 s[0:1], .fz_kernel_hw
  s_waitcnt vmcnt(0)
  v_readfirstlane_b32 s31, v9
  s_cmp_eq_u32 s31, 65535
  s_cbranch_scc1 .fz_kernel_pw22d
  s_cmp_eq_u32 s3, 0
  s_cbranch_scc1 .fz_kernel_hb23
  s_barrier
  s_sub_u32 s3, s3, 1
.fz_kernel_hb23:
  s_cmp_eq_u32 s3, 0
  s_cbranch_scc1 .fz_kernel_hb24
  s_barrier
  s_sub_u32 s3, s3, 1
.fz_kernel_hb24:
  buffer_load_dword v9, v4, s[4:7], s37 offen sc1
  s_add_u32 s38, s38, 1
  s_cmp_lt_u32 s38, 131072
  s_cbranch_scc1 .fz_kernel_pw22
  s_waitcnt vmcnt(0)
.fz_kernel_pw22d:
  s_mov_b64 exec, -1
  buffer_load_dwordx4 v[64:67], v3, s[4:7], s30 offen sc1
  s_mov_b32 s46, 0
  s_call_b64 s[0:1], .fz_kernel_hw
  s_waitcnt vmcnt(0)
  v_add_u32 v24, 155648, v3
  s_mov_b32 exec_hi, 0xffff
  ds_write_b128 v24, v[64:67] offset:5632
  s_mov_b64 exec, -1
  s_waitcnt lgkmcnt(0)
  s_getpc_b64 s[0:1]
.fz_kernel_ct25:
  s_sub_u32 s0, s0, .fz_kernel_ct25-fz_kernel
  s_subb_u32 s1, s1, 0
  s_lshr_b32 s31, s2, 3
  s_mulk_i32 s31, 0x500
  v_lshl_add_u32 v1, v2, 7, s31
  v_min_u32 v1, .fz_kernel_last-fz_kernel, v1
  s_mov_b64 exec, 0x3ff
  global_load_dword v1, v1, s[0:1]
  s_mov_b64 exec, -1
.fz_kernel_ct25e:
  s_branch .fz_kernel_q_hw2
.fz_kernel_att:
  s_setprio 1
  s_and_b32 s39, s16, 1
  s_lshr_b32 s32, s16, 1
  s_lshl1_add_u32 s35, s18, s39
  s_lshl_b32 s35, s35, 5
  s_add_u32 s35, s35, s32
  s_lshl_b32 s35, s35, 13
  s_add_u32 s35, s35, s63
  s_lshl_b32 s34, 1, s17
  s_mov_b32 s36, 0
  v_add_u32 v10, 4096, v3
  v_mfma_f32_32x32x16_bf16 v[48:63], v[80:83], v[16:19], 0
  v_mfma_f32_32x32x16_bf16 v[48:63], v[84:87], v[20:23], v[48:63]
  v_mov_b32 v1, 0x3f803f80
  v_mov_b32 v11, 0x4444
  v_mov_b32 v12, v1
  v_mov_b32 v14, 0
  s_mov_b32 exec_lo, 0xaaaaaaaa
  s_mov_b32 exec_hi, 0xaaaaaaaa
  v_mov_b32 v12, 0
  v_mov_b32 v14, v1
  s_mov_b32 exec_lo, 0xcccccccc
  s_mov_b32 exec_hi, 0xcccccccc
  v_mov_b32 v11, 0xeeee
  s_mov_b64 exec, -1
  v_mov_b32 v13, v12
  v_mov_b32 v15, v14
  v_mov_b32 v208, 0
  v_mov_b32 v209, 0
  v_mov_b32 v210, 0
  v_mov_b32 v211, 0
  v_mov_b32 v212, 0
  v_mov_b32 v213, 0
  v_mov_b32 v214, 0
  v_mov_b32 v215, 0
  v_mov_b32 v216, 0
  v_mov_b32 v217, 0
  v_mov_b32 v218, 0
  v_mov_b32 v219, 0
  v_mov_b32 v220, 0
  v_mov_b32 v221, 0
  v_mov_b32 v222, 0
  v_mov_b32 v223, 0
  s_mov_b32 s32, 8
  s_waitcnt lgkmcnt(0)
  s_barrier
  ds_read_b128 v[32:35], v9 offset:0
  ds_read_b128 v[36:39], v9 offset:1024
  ds_read_b128 v[40:43], v9 offset:2048
  ds_read_b128 v[44:47], v9 offset:3072
  v_mfma_f32_32x32x16_bf16 v[64:79], v[80:83], v[24:27], 0
  v_exp_f32 v48, v48
  v_exp_f32 v49, v49
  v_exp_f32 v50, v50
  v_exp_f32 v51, v51
  v_exp_f32 v52, v52
  v_exp_f32 v53, v53
  v_exp_f32 v54, v54
  v_exp_f32 v55, v55
  v_mfma_f32_32x32x16_bf16 v[64:79], v[84:87], v[28:31], v[64:79]
  v_cvt_pk_bf16_f32 v224, v48, v49
  v_cvt_pk_bf16_f32 v225, v50, v51
  v_cvt_pk_bf16_f32 v226, v52, v53
  v_cvt_pk_bf16_f32 v227, v54, v55
  v_exp_f32 v56, v56
  v_exp_f32 v57, v57
  v_exp_f32 v58, v58
  v_exp_f32 v59, v59
  v_mfma_f32_32x32x16_bf16 v[144:159], v[88:91], v[224:227], 0
  v_exp_f32 v60, v60
  v_exp_f32 v61, v61
  v_exp_f32 v62, v62
  v_exp_f32 v63, v63
  v_cvt_pk_bf16_f32 v228, v56, v57
  v_cvt_pk_bf16_f32 v229, v58, v59
  v_cvt_pk_bf16_f32 v230, v60, v61
  v_cvt_pk_bf16_f32 v231, v62, v63
  s_waitcnt lgkmcnt(0)
  v_mfma_f32_32x32x16_bf16 v[48:63], v[80:83], v[32:35], 0
  v_exp_f32 v64, v64
  v_exp_f32 v65, v65
  v_exp_f32 v66, v66
  v_exp_f32 v67, v67
  v_mfma_f32_32x32x16_bf16 v[144:159], v[92:95], v[228:231], v[144:159]
  v_exp_f32 v68, v68
  v_exp_f32 v69, v69
  v_exp_f32 v70, v70
  v_smfmac_f32_16x16x64_bf16 v[208:211], v[12:15], v[224:231], v11
  v_exp_f32 v71, v71
  v_mfma_f32_32x32x16_bf16 v[48:63], v[84:87], v[36:39], v[48:63]
  v_cvt_pk_bf16_f32 v224, v64, v65
  v_cvt_pk_bf16_f32 v225, v66, v67
  v_cvt_pk_bf16_f32 v226, v68, v69
  v_cvt_pk_bf16_f32 v227, v70, v71
  v_exp_f32 v72, v72
  v_exp_f32 v73, v73
  v_exp_f32 v74, v74
  v_exp_f32 v75, v75
  v_mfma_f32_32x32x16_bf16 v[160:175], v[88:91], v[224:227], 0
  v_exp_f32 v76, v76
  v_exp_f32 v77, v77
  v_exp_f32 v78, v78
  v_exp_f32 v79, v79
  v_cvt_pk_bf16_f32 v228, v72, v73
  v_cvt_pk_bf16_f32 v229, v74, v75
  v_cvt_pk_bf16_f32 v230, v76, v77
  v_cvt_pk_bf16_f32 v231, v78, v79
  s_mov_b64 exec, 1
  s_waitcnt vmcnt(0)
  ds_add_u32 v6, v5 offset:0x100
  s_mov_b64 exec, -1
  v_mfma_f32_32x32x16_bf16 v[64:79], v[80:83], v[40:43], 0
  v_exp_f32 v48, v48
  v_exp_f32 v49, v49
  v_exp_f32 v50, v50
  v_exp_f32 v51, v51
  v_mfma_f32_32x32x16_bf16 v[160:175], v[92:95], v[228:231], v[160:175]
  v_exp_f32 v52, v52
  v_exp_f32 v53, v53
  v_exp_f32 v54, v54
  v_smfmac_f32_16x16x64_bf16 v[212:215], v[12:15], v[224:231], v11
  v_exp_f32 v55, v55
  v_mfma_f32_32x32x16_bf16 v[64:79], v[84:87], v[44:47], v[64:79]
  v_cvt_pk_bf16_f32 v224, v48, v49
  v_cvt_pk_bf16_f32 v225, v50, v51
  v_cvt_pk_bf16_f32 v226, v52, v53
  v_cvt_pk_bf16_f32 v227, v54, v55
  v_exp_f32 v56, v56
  v_exp_f32 v57, v57
  v_exp_f32 v58, v58
  v_exp_f32 v59, v59
  v_mfma_f32_32x32x16_bf16 v[176:191], v[88:91], v[224:227], 0
  ds_read_b32 v7, v6
  v_exp_f32 v60, v60
  v_exp_f32 v61, v61
  v_exp_f32 v62, v62
  v_exp_f32 v63, v63
  v_cvt_pk_bf16_f32 v228, v56, v57
  v_cvt_pk_bf16_f32 v229, v58, v59
  v_cvt_pk_bf16_f32 v230, v60, v61
  v_cvt_pk_bf16_f32 v231, v62, v63
  s_waitcnt lgkmcnt(0)
  v_readfirstlane_b32 s39, v7
  s_andn2_b32 s33, s39, s34
  s_bcnt1_i32_b32 s31, s33
  s_cmp_ge_u32 s31, 2
  s_cbranch_scc1 .fz_kernel_a_e
  v_mfma_f32_32x32x16_bf16 v[48:63], v[96:99], v[16:19], 0
  v_exp_f32 v64, v64
  v_exp_f32 v65, v65
  v_exp_f32 v66, v66
  v_exp_f32 v67, v67
  v_mfma_f32_32x32x16_bf16 v[176:191], v[92:95], v[228:231], v[176:191]
  v_exp_f32 v68, v68
  v_exp_f32 v69, v69
  v_exp_f32 v70, v70
  v_smfmac_f32_16x16x64_bf16 v[216:219], v[12:15], v[224:231], v11
  v_exp_f32 v71, v71
  v_mfma_f32_32x32x16_bf16 v[48:63], v[100:103], v[20:23], v[48:63]
  v_cvt_pk_bf16_f32 v224, v64, v65
  v_cvt_pk_bf16_f32 v225, v66, v67
  v_cvt_pk_bf16_f32 v226, v68, v69
  v_cvt_pk_bf16_f32 v227, v70, v71
  v_exp_f32 v72, v72
  v_exp_f32 v73, v73
  v_exp_f32 v74, v74
  v_exp_f32 v75, v75
  v_mfma_f32_32x32x16_bf16 v[192:207], v[88:91], v[224:227], 0
  v_exp_f32 v76, v76
  v_exp_f32 v77, v77
  v_exp_f32 v78, v78
  v_exp_f32 v79, v79
  v_cvt_pk_bf16_f32 v228, v72, v73
  v_cvt_pk_bf16_f32 v229, v74, v75
  v_cvt_pk_bf16_f32 v230, v76, v77
  v_cvt_pk_bf16_f32 v231, v78, v79
  v_mfma_f32_32x32x16_bf16 v[64:79], v[96:99], v[24:27], 0
  v_exp_f32 v48, v48
  v_exp_f32 v49, v49
  v_exp_f32 v50, v50
  v_exp_f32 v51, v51
  v_mfma_f32_32x32x16_bf16 v[192:207], v[92:95], v[228:231], v[192:207]
  v_exp_f32 v52, v52
  v_exp_f32 v53, v53
  v_exp_f32 v54, v54
  v_smfmac_f32_16x16x64_bf16 v[220:223], v[12:15], v[224:231], v11
  v_exp_f32 v55, v55
  v_mfma_f32_32x32x16_bf16 v[64:79], v[100:103], v[28:31], v[64:79]
  v_cvt_pk_bf16_f32 v224, v48, v49
  v_cvt_pk_bf16_f32 v225, v50, v51
  v_cvt_pk_bf16_f32 v226, v52, v53
  v_cvt_pk_bf16_f32 v227, v54, v55
  v_exp_f32 v56, v56
  v_exp_f32 v57, v57
  v_exp_f32 v58, v58
  v_exp_f32 v59, v59
  v_mfma_f32_32x32x16_bf16 v[144:159], v[104:107], v[224:227], v[144:159]
  v_exp_f32 v60, v60
  v_exp_f32 v61, v61
  v_exp_f32 v62, v62
  v_exp_f32 v63, v63
  v_cvt_pk_bf16_f32 v228, v56, v57
  v_cvt_pk_bf16_f32 v229, v58, v59
  v_cvt_pk_bf16_f32 v230, v60, v61
  v_cvt_pk_bf16_f32 v231, v62, v63
  v_mfma_f32_32x32x16_bf16 v[48:63], v[96:99], v[32:35], 0
  v_exp_f32 v64, v64
  v_exp_f32 v65, v65
  v_exp_f32 v66, v66
  v_exp_f32 v67, v67
  v_mfma_f32_32x32x16_bf16 v[144:159], v[108:111], v[228:231], v[144:159]
  v_exp_f32 v68, v68
  v_exp_f32 v69, v69
  v_exp_f32 v70, v70
  v_smfmac_f32_16x16x64_bf16 v[208:211], v[12:15], v[224:231], v11
  v_exp_f32 v71, v71
  v_mfma_f32_32x32x16_bf16 v[48:63], v[100:103], v[36:39], v[48:63]
  v_cvt_pk_bf16_f32 v224, v64, v65
  v_cvt_pk_bf16_f32 v225, v66, v67
  v_cvt_pk_bf16_f32 v226, v68, v69
  v_cvt_pk_bf16_f32 v227, v70, v71
  v_exp_f32 v72, v72
  v_exp_f32 v73, v73
  v_exp_f32 v74, v74
  v_exp_f32 v75, v75
  v_mfma_f32_32x32x16_bf16 v[160:175], v[104:107], v[224:227], v[160:175]
  ds_read_b32 v7, v6
  v_exp_f32 v76, v76
  v_exp_f32 v77, v77
  v_exp_f32 v78, v78
  v_exp_f32 v79, v79
  v_cvt_pk_bf16_f32 v228, v72, v73
  v_cvt_pk_bf16_f32 v229, v74, v75
  v_cvt_pk_bf16_f32 v230, v76, v77
  v_cvt_pk_bf16_f32 v231, v78, v79
  s_waitcnt lgkmcnt(0)
  v_readfirstlane_b32 s39, v7
  s_andn2_b32 s39, s39, s34
  s_cbranch_scc0 .fz_kernel_a_p0
  s_ff1_i32_b32 s33, s36
  s_bitset0_b32 s36, s33
  s_lshl_b32 s33, s33, 14
  s_add_u32 s30, s33, s35
  s_cbranch_scc1 .fz_kernel_pk26c
.fz_kernel_pk26:
  buffer_load_dwordx4 v[112:115], v3, s[4:7], s30 offen offset:0
  buffer_load_dwordx4 v[116:119], v3, s[4:7], s30 offen offset:1024
  buffer_load_dwordx4 v[120:123], v3, s[4:7], s30 offen offset:2048
  buffer_load_dwordx4 v[124:127], v3, s[4:7], s30 offen offset:3072
  buffer_load_dwordx4 v[128:131], v10, s[4:7], s30 offen offset:0
  buffer_load_dwordx4 v[132:135], v10, s[4:7], s30 offen offset:1024
  buffer_load_dwordx4 v[136:139], v10, s[4:7], s30 offen offset:2048
  buffer_load_dwordx4 v[140:143], v10, s[4:7], s30 offen offset:3072
.fz_kernel_a_p0:
  v_mfma_f32_32x32x16_bf16 v[64:79], v[96:99], v[40:43], 0
  v_exp_f32 v48, v48
  v_exp_f32 v49, v49
  v_exp_f32 v50, v50
  v_exp_f32 v51, v51
  v_mfma_f32_32x32x16_bf16 v[160:175], v[108:111], v[228:231], v[160:175]
  v_exp_f32 v52, v52
  v_exp_f32 v53, v53
  v_exp_f32 v54, v54
  v_smfmac_f32_16x16x64_bf16 v[212:215], v[12:15], v[224:231], v11
  v_exp_f32 v55, v55
  v_mfma_f32_32x32x16_bf16 v[64:79], v[100:103], v[44:47], v[64:79]
  v_cvt_pk_bf16_f32 v224, v48, v49
  v_cvt_pk_bf16_f32 v225, v50, v51
  v_cvt_pk_bf16_f32 v226, v52, v53
  v_cvt_pk_bf16_f32 v227, v54, v55
  v_exp_f32 v56, v56
  v_exp_f32 v57, v57
  v_exp_f32 v58, v58
  v_exp_f32 v59, v59
  v_mfma_f32_32x32x16_bf16 v[176:191], v[104:107], v[224:227], v[176:191]
  v_exp_f32 v60, v60
  v_exp_f32 v61, v61
  v_exp_f32 v62, v62
  v_exp_f32 v63, v63
  v_cvt_pk_bf16_f32 v228, v56, v57
  v_cvt_pk_bf16_f32 v229, v58, v59
  v_cvt_pk_bf16_f32 v230, v60, v61
  v_cvt_pk_bf16_f32 v231, v62, v63
  v_exp_f32 v64, v64
  v_exp_f32 v65, v65
  v_exp_f32 v66, v66
  v_exp_f32 v67, v67
  v_mfma_f32_32x32x16_bf16 v[176:191], v[108:111], v[228:231], v[176:191]
  v_exp_f32 v68, v68
  v_exp_f32 v69, v69
  v_exp_f32 v70, v70
  v_smfmac_f32_16x16x64_bf16 v[216:219], v[12:15], v[224:231], v11
  v_exp_f32 v71, v71
  v_cvt_pk_bf16_f32 v224, v64, v65
  v_cvt_pk_bf16_f32 v225, v66, v67
  v_cvt_pk_bf16_f32 v226, v68, v69
  v_cvt_pk_bf16_f32 v227, v70, v71
  v_exp_f32 v72, v72
  v_exp_f32 v73, v73
  v_exp_f32 v74, v74
  v_exp_f32 v75, v75
  v_mfma_f32_32x32x16_bf16 v[192:207], v[104:107], v[224:227], v[192:207]
  v_exp_f32 v76, v76
  v_exp_f32 v77, v77
  v_exp_f32 v78, v78
  v_exp_f32 v79, v79
  v_cvt_pk_bf16_f32 v228, v72, v73
  v_cvt_pk_bf16_f32 v229, v74, v75
  v_cvt_pk_bf16_f32 v230, v76, v77
  v_cvt_pk_bf16_f32 v231, v78, v79
  s_cmp_lg_u32 s39, 0
  s_cbranch_scc1 .fz_kernel_a_p1
  s_ff1_i32_b32 s33, s36
  s_bitset0_b32 s36, s33
  s_lshl_b32 s33, s33, 14
  s_add_u32 s30, s33, s35
  s_cbranch_scc1 .fz_kernel_pk27c
.fz_kernel_pk27:
  buffer_load_dwordx4 v[112:115], v3, s[4:7], s30 offen offset:0
  buffer_load_dwordx4 v[116:119], v3, s[4:7], s30 offen offset:1024
  buffer_load_dwordx4 v[120:123], v3, s[4:7], s30 offen offset:2048
  buffer_load_dwordx4 v[124:127], v3, s[4:7], s30 offen offset:3072
  buffer_load_dwordx4 v[128:131], v10, s[4:7], s30 offen offset:0
  buffer_load_dwordx4 v[132:135], v10, s[4:7], s30 offen offset:1024
  buffer_load_dwordx4 v[136:139], v10, s[4:7], s30 offen offset:2048
  buffer_load_dwordx4 v[140:143], v10, s[4:7], s30 offen offset:3072
.fz_kernel_a_p1:
  s_ff1_i32_b32 s33, s36
  s_bitset0_b32 s36, s33
  s_lshl_b32 s33, s33, 14
  s_add_u32 s30, s33, s35
  s_cbranch_scc1 .fz_kernel_pk28c
.fz_kernel_pk28:
  buffer_load_dwordx4 v[80:83], v3, s[4:7], s30 offen offset:0
  buffer_load_dwordx4 v[84:87], v3, s[4:7], s30 offen offset:1024
  buffer_load_dwordx4 v[88:91], v3, s[4:7], s30 offen offset:2048
  buffer_load_dwordx4 v[92:95], v3, s[4:7], s30 offen offset:3072
  buffer_load_dwordx4 v[96:99], v10, s[4:7], s30 offen offset:0
  s_waitcnt vmcnt(11)
  v_mfma_f32_32x32x16_bf16 v[48:63], v[112:115], v[16:19], 0
  v_mfma_f32_32x32x16_bf16 v[48:63], v[116:119], v[20:23], v[48:63]
  s_nop 9
  s_branch .fz_kernel_a_b2
.fz_kernel_a_e:
  s_mov_b32 s36, s33
  s_or_b32 s34, s34, s39
  s_ff1_i32_b32 s33, s36
  s_bitset0_b32 s36, s33
  s_lshl_b32 s33, s33, 14
  s_add_u32 s30, s33, s35
  v_mfma_f32_32x32x16_bf16 v[48:63], v[96:99], v[16:19], 0
  buffer_load_dwordx4 v[112:115], v3, s[4:7], s30 offen offset:0
  v_exp_f32 v64, v64
  v_exp_f32 v65, v65
  v_exp_f32 v66, v66
  v_exp_f32 v67, v67
  v_mfma_f32_32x32x16_bf16 v[176:191], v[92:95], v[228:231], v[176:191]
  buffer_load_dwordx4 v[116:119], v3, s[4:7], s30 offen offset:1024
  v_exp_f32 v68, v68
  v_exp_f32 v69, v69
  v_exp_f32 v70, v70
  v_smfmac_f32_16x16x64_bf16 v[216:219], v[12:15], v[224:231], v11
  buffer_load_dwordx4 v[120:123], v3, s[4:7], s30 offen offset:2048
  v_exp_f32 v71, v71
  v_mfma_f32_32x32x16_bf16 v[48:63], v[100:103], v[20:23], v[48:63]
  buffer_load_dwordx4 v[124:127], v3, s[4:7], s30 offen offset:3072
  v_cvt_pk_bf16_f32 v224, v64, v65
  v_cvt_pk_bf16_f32 v225, v66, v67
  v_cvt_pk_bf16_f32 v226, v68, v69
  v_cvt_pk_bf16_f32 v227, v70, v71
  v_exp_f32 v72, v72
  v_exp_f32 v73, v73
  v_exp_f32 v74, v74
  v_exp_f32 v75, v75
  v_mfma_f32_32x32x16_bf16 v[192:207], v[88:91], v[224:227], 0
  buffer_load_dwordx4 v[128:131], v10, s[4:7], s30 offen offset:0
  v_exp_f32 v76, v76
  v_exp_f32 v77, v77
  v_exp_f32 v78, v78
  v_exp_f32 v79, v79
  v_cvt_pk_bf16_f32 v228, v72, v73
  v_cvt_pk_bf16_f32 v229, v74, v75
  v_cvt_pk_bf16_f32 v230, v76, v77
  v_cvt_pk_bf16_f32 v231, v78, v79
  v_mfma_f32_32x32x16_bf16 v[64:79], v[96:99], v[24:27], 0
  buffer_load_dwordx4 v[132:135], v10, s[4:7], s30 offen offset:1024
  v_exp_f32 v48, v48
  v_exp_f32 v49, v49
  v_exp_f32 v50, v50
  v_exp_f32 v51, v51
  v_mfma_f32_32x32x16_bf16 v[192:207], v[92:95], v[228:231], v[192:207]
  buffer_load_dwordx4 v[136:139], v10, s[4:7], s30 offen offset:2048
  v_exp_f32 v52, v52
  v_exp_f32 v53, v53
  v_exp_f32 v54, v54
  v_smfmac_f32_16x16x64_bf16 v[220:223], v[12:15], v[224:231], v11
  buffer_load_dwordx4 v[140:143], v10, s[4:7], s30 offen offset:3072
  v_exp_f32 v55, v55
  v_mfma_f32_32x32x16_bf16 v[64:79], v[100:103], v[28:31], v[64:79]
  s_ff1_i32_b32 s33, s36
  v_cvt_pk_bf16_f32 v224, v48, v49
  v_cvt_pk_bf16_f32 v225, v50, v51
  v_cvt_pk_bf16_f32 v226, v52, v53
  v_cvt_pk_bf16_f32 v227, v54, v55
  v_exp_f32 v56, v56
  v_exp_f32 v57, v57
  v_exp_f32 v58, v58
  v_exp_f32 v59, v59
  v_mfma_f32_32x32x16_bf16 v[144:159], v[104:107], v[224:227], v[144:159]
  s_bitset0_b32 s36, s33
  v_exp_f32 v60, v60
  v_exp_f32 v61, v61
  v_exp_f32 v62, v62
  v_exp_f32 v63, v63
  v_cvt_pk_bf16_f32 v228, v56, v57
  v_cvt_pk_bf16_f32 v229, v58, v59
  v_cvt_pk_bf16_f32 v230, v60, v61
  v_cvt_pk_bf16_f32 v231, v62, v63
  v_mfma_f32_32x32x16_bf16 v[48:63], v[96:99], v[32:35], 0
  s_lshl_b32 s33, s33, 14
  v_exp_f32 v64, v64
  v_exp_f32 v65, v65
  v_exp_f32 v66, v66
  v_exp_f32 v67, v67
  v_mfma_f32_32x32x16_bf16 v[144:159], v[108:111], v[228:231], v[144:159]
  s_add_u32 s30, s33, s35
  v_exp_f32 v68, v68
  v_exp_f32 v69, v69
  v_exp_f32 v70, v70
  v_smfmac_f32_16x16x64_bf16 v[208:211], v[12:15], v[224:231], v11
  buffer_load_dwordx4 v[80:83], v3, s[4:7], s30 offen offset:0
  v_exp_f32 v71, v71
  v_mfma_f32_32x32x16_bf16 v[48:63], v[100:103], v[36:39], v[48:63]
  buffer_load_dwordx4 v[84:87], v3, s[4:7], s30 offen offset:1024
  v_cvt_pk_bf16_f32 v224, v64, v65
  v_cvt_pk_bf16_f32 v225, v66, v67
  v_cvt_pk_bf16_f32 v226, v68, v69
  v_cvt_pk_bf16_f32 v227, v70, v71
  v_exp_f32 v72, v72
  v_exp_f32 v73, v73
  v_exp_f32 v74, v74
  v_exp_f32 v75, v75
  v_mfma_f32_32x32x16_bf16 v[160:175], v[104:107], v[224:227], v[160:175]
  buffer_load_dwordx4 v[88:91], v3, s[4:7], s30 offen offset:2048
  v_exp_f32 v76, v76
  v_exp_f32 v77, v77
  v_exp_f32 v78, v78
  v_exp_f32 v79, v79
  v_cvt_pk_bf16_f32 v228, v72, v73
  v_cvt_pk_bf16_f32 v229, v74, v75
  v_cvt_pk_bf16_f32 v230, v76, v77
  v_cvt_pk_bf16_f32 v231, v78, v79
  v_mfma_f32_32x32x16_bf16 v[64:79], v[96:99], v[40:43], 0
  buffer_load_dwordx4 v[92:95], v3, s[4:7], s30 offen offset:3072
  v_exp_f32 v48, v48
  v_exp_f32 v49, v49
  v_exp_f32 v50, v50
  v_exp_f32 v51, v51
  v_mfma_f32_32x32x16_bf16 v[160:175], v[108:111], v[228:231], v[160:175]
  v_exp_f32 v52, v52
  v_exp_f32 v53, v53
  v_exp_f32 v54, v54
  v_smfmac_f32_16x16x64_bf16 v[212:215], v[12:15], v[224:231], v11
  v_exp_f32 v55, v55
  v_mfma_f32_32x32x16_bf16 v[64:79], v[100:103], v[44:47], v[64:79]
  v_cvt_pk_bf16_f32 v224, v48, v49
  v_cvt_pk_bf16_f32 v225, v50, v51
  v_cvt_pk_bf16_f32 v226, v52, v53
  v_cvt_pk_bf16_f32 v227, v54, v55
  v_exp_f32 v56, v56
  v_exp_f32 v57, v57
  v_exp_f32 v58, v58
  v_exp_f32 v59, v59
  v_mfma_f32_32x32x16_bf16 v[176:191], v[104:107], v[224:227], v[176:191]
  s_waitcnt vmcnt(10)
  v_exp_f32 v60, v60
  v_exp_f32 v61, v61
  v_exp_f32 v62, v62
  v_exp_f32 v63, v63
  v_cvt_pk_bf16_f32 v228, v56, v57
  v_cvt_pk_bf16_f32 v229, v58, v59
  v_cvt_pk_bf16_f32 v230, v60, v61
  v_cvt_pk_bf16_f32 v231, v62, v63
  v_mfma_f32_32x32x16_bf16 v[48:63], v[112:115], v[16:19], 0
  v_exp_f32 v64, v64
  v_exp_f32 v65, v65
  v_exp_f32 v66, v66
  v_exp_f32 v67, v67
  v_mfma_f32_32x32x16_bf16 v[176:191], v[108:111], v[228:231], v[176:191]
  buffer_load_dwordx4 v[96:99], v10, s[4:7], s30 offen offset:0
  v_exp_f32 v68, v68
  v_exp_f32 v69, v69
  v_exp_f32 v70, v70
  v_smfmac_f32_16x16x64_bf16 v[216:219], v[12:15], v[224:231], v11
  v_exp_f32 v71, v71
  v_mfma_f32_32x32x16_bf16 v[48:63], v[116:119], v[20:23], v[48:63]
  v_cvt_pk_bf16_f32 v224, v64, v65
  v_cvt_pk_bf16_f32 v225, v66, v67
  v_cvt_pk_bf16_f32 v226, v68, v69
  v_cvt_pk_bf16_f32 v227, v70, v71
  v_exp_f32 v72, v72
  v_exp_f32 v73, v73
  v_exp_f32 v74, v74
  v_exp_f32 v75, v75
  v_mfma_f32_32x32x16_bf16 v[192:207], v[104:107], v[224:227], v[192:207]
  v_exp_f32 v76, v76
  v_exp_f32 v77, v77
  v_exp_f32 v78, v78
  v_exp_f32 v79, v79
  v_cvt_pk_bf16_f32 v228, v72, v73
  v_cvt_pk_bf16_f32 v229, v74, v75
  v_cvt_pk_bf16_f32 v230, v76, v77
  v_cvt_pk_bf16_f32 v231, v78, v79
  s_branch .fz_kernel_a_b2
  .p2align 6
.fz_kernel_a_loop:
  v_mfma_f32_32x32x16_bf16 v[64:79], v[80:83], v[24:27], 0
  v_exp_f32 v48, v48
  v_exp_f32 v49, v49
  v_exp_f32 v50, v50
  v_exp_f32 v51, v51
  v_mfma_f32_32x32x16_bf16 v[192:207], v[140:143], v[228:231], v[192:207]
  v_exp_f32 v52, v52
  v_exp_f32 v53, v53
  v_exp_f32 v54, v54
  v_smfmac_f32_16x16x64_bf16 v[220:223], v[12:15], v[224:231], v11
  buffer_load_dwordx4 v[132:135], v10, s[4:7], s30 offen offset:1024
  v_exp_f32 v55, v55
  v_mfma_f32_32x32x16_bf16 v[64:79], v[84:87], v[28:31], v[64:79]
  s_waitcnt vmcnt(10)
  v_cvt_pk_bf16_f32 v224, v48, v49
  v_cvt_pk_bf16_f32 v225, v50, v51
  v_cvt_pk_bf16_f32 v226, v52, v53
  v_cvt_pk_bf16_f32 v227, v54, v55
  v_exp_f32 v56, v56
  v_exp_f32 v57, v57
  v_exp_f32 v58, v58
  v_exp_f32 v59, v59
  v_mfma_f32_32x32x16_bf16 v[144:159], v[88:91], v[224:227], v[144:159]
  v_exp_f32 v60, v60
  v_exp_f32 v61, v61
  v_exp_f32 v62, v62
  v_exp_f32 v63, v63
  v_cvt_pk_bf16_f32 v228, v56, v57
  v_cvt_pk_bf16_f32 v229, v58, v59
  v_cvt_pk_bf16_f32 v230, v60, v61
  v_cvt_pk_bf16_f32 v231, v62, v63
  v_mfma_f32_32x32x16_bf16 v[48:63], v[80:83], v[32:35], 0
  v_exp_f32 v64, v64
  v_exp_f32 v65, v65
  v_exp_f32 v66, v66
  v_exp_f32 v67, v67
  v_mfma_f32_32x32x16_bf16 v[144:159], v[92:95], v[228:231], v[144:159]
  v_exp_f32 v68, v68
  v_exp_f32 v69, v69
  v_exp_f32 v70, v70
  v_smfmac_f32_16x16x64_bf16 v[208:211], v[12:15], v[224:231], v11
  buffer_load_dwordx4 v[136:139], v10, s[4:7], s30 offen offset:2048
  v_exp_f32 v71, v71
  v_mfma_f32_32x32x16_bf16 v[48:63], v[84:87], v[36:39], v[48:63]
  s_ff1_i32_b32 s33, s36
  v_cvt_pk_bf16_f32 v224, v64, v65
  v_cvt_pk_bf16_f32 v225, v66, v67
  v_cvt_pk_bf16_f32 v226, v68, v69
  v_cvt_pk_bf16_f32 v227, v70, v71
  v_exp_f32 v72, v72
  v_exp_f32 v73, v73
  v_exp_f32 v74, v74
  v_exp_f32 v75, v75
  v_mfma_f32_32x32x16_bf16 v[160:175], v[88:91], v[224:227], v[160:175]
  s_bitset0_b32 s36, s33
  v_exp_f32 v76, v76
  v_exp_f32 v77, v77
  v_exp_f32 v78, v78
  v_exp_f32 v79, v79
  v_cvt_pk_bf16_f32 v228, v72, v73
  v_cvt_pk_bf16_f32 v229, v74, v75
  v_cvt_pk_bf16_f32 v230, v76, v77
  v_cvt_pk_bf16_f32 v231, v78, v79
  v_mfma_f32_32x32x16_bf16 v[64:79], v[80:83], v[40:43], 0
  s_lshl_b32 s33, s33, 14
  v_exp_f32 v48, v48
  v_exp_f32 v49, v49
  v_exp_f32 v50, v50
  v_exp_f32 v51, v51
  v_mfma_f32_32x32x16_bf16 v[160:175], v[92:95], v[228:231], v[160:175]
  v_exp_f32 v52, v52
  v_exp_f32 v53, v53
  v_exp_f32 v54, v54
  v_smfmac_f32_16x16x64_bf16 v[212:215], v[12:15], v[224:231], v11
  buffer_load_dwordx4 v[140:143], v10, s[4:7], s30 offen offset:3072
  v_exp_f32 v55, v55
  v_mfma_f32_32x32x16_bf16 v[64:79], v[84:87], v[44:47], v[64:79]
  s_add_u32 s30, s33, s35
  v_cvt_pk_bf16_f32 v224, v48, v49
  v_cvt_pk_bf16_f32 v225, v50, v51
  v_cvt_pk_bf16_f32 v226, v52, v53
  v_cvt_pk_bf16_f32 v227, v54, v55
  v_exp_f32 v56, v56
  v_exp_f32 v57, v57
  v_exp_f32 v58, v58
  v_exp_f32 v59, v59
  v_mfma_f32_32x32x16_bf16 v[176:191], v[88:91], v[224:227], v[176:191]
  s_waitcnt vmcnt(10)
  v_exp_f32 v60, v60
  v_exp_f32 v61, v61
  v_exp_f32 v62, v62
  v_exp_f32 v63, v63
  v_cvt_pk_bf16_f32 v228, v56, v57
  v_cvt_pk_bf16_f32 v229, v58, v59
  v_cvt_pk_bf16_f32 v230, v60, v61
  v_cvt_pk_bf16_f32 v231, v62, v63
  v_mfma_f32_32x32x16_bf16 v[48:63], v[96:99], v[16:19], 0
  s_cbranch_scc1 .fz_kernel_pk31c
.fz_kernel_pk31:
  v_exp_f32 v64, v64
  v_exp_f32 v65, v65
  v_exp_f32 v66, v66
  v_exp_f32 v67, v67
  v_mfma_f32_32x32x16_bf16 v[176:191], v[92:95], v[228:231], v[176:191]
  v_exp_f32 v68, v68
  v_exp_f32 v69, v69
  v_exp_f32 v70, v70
  v_smfmac_f32_16x16x64_bf16 v[216:219], v[12:15], v[224:231], v11
  buffer_load_dwordx4 v[80:83], v3, s[4:7], s30 offen offset:0
  v_exp_f32 v71, v71
  v_mfma_f32_32x32x16_bf16 v[48:63], v[100:103], v[20:23], v[48:63]
  v_cvt_pk_bf16_f32 v224, v64, v65
  v_cvt_pk_bf16_f32 v225, v66, v67
  v_cvt_pk_bf16_f32 v226, v68, v69
  v_cvt_pk_bf16_f32 v227, v70, v71
  v_exp_f32 v72, v72
  v_exp_f32 v73, v73
  v_exp_f32 v74, v74
  v_exp_f32 v75, v75
  v_mfma_f32_32x32x16_bf16 v[192:207], v[88:91], v[224:227], v[192:207]
  v_exp_f32 v76, v76
  v_exp_f32 v77, v77
  v_exp_f32 v78, v78
  v_exp_f32 v79, v79
  v_cvt_pk_bf16_f32 v228, v72, v73
  v_cvt_pk_bf16_f32 v229, v74, v75
  v_cvt_pk_bf16_f32 v230, v76, v77
  v_cvt_pk_bf16_f32 v231, v78, v79
  v_mfma_f32_32x32x16_bf16 v[64:79], v[96:99], v[24:27], 0
  v_exp_f32 v48, v48
  v_exp_f32 v49, v49
  v_exp_f32 v50, v50
  v_exp_f32 v51, v51
  v_mfma_f32_32x32x16_bf16 v[192:207], v[92:95], v[228:231], v[192:207]
  v_exp_f32 v52, v52
  v_exp_f32 v53, v53
  v_exp_f32 v54, v54
  v_smfmac_f32_16x16x64_bf16 v[220:223], v[12:15], v[224:231], v11
  buffer_load_dwordx4 v[84:87], v3, s[4:7], s30 offen offset:1024
  v_exp_f32 v55, v55
  v_mfma_f32_32x32x16_bf16 v[64:79], v[100:103], v[28:31], v[64:79]
  s_waitcnt vmcnt(10)
  v_cvt_pk_bf16_f32 v224, v48, v49
  v_cvt_pk_bf16_f32 v225, v50, v51
  v_cvt_pk_bf16_f32 v226, v52, v53
  v_cvt_pk_bf16_f32 v227, v54, v55
  v_exp_f32 v56, v56
  v_exp_f32 v57, v57
  v_exp_f32 v58, v58
  v_exp_f32 v59, v59
  v_mfma_f32_32x32x16_bf16 v[144:159], v[104:107], v[224:227], v[144:159]
  v_exp_f32 v60, v60
  v_exp_f32 v61, v61
  v_exp_f32 v62, v62
  v_exp_f32 v63, v63
  v_cvt_pk_bf16_f32 v228, v56, v57
  v_cvt_pk_bf16_f32 v229, v58, v59
  v_cvt_pk_bf16_f32 v230, v60, v61
  v_cvt_pk_bf16_f32 v231, v62, v63
  v_mfma_f32_32x32x16_bf16 v[48:63], v[96:99], v[32:35], 0
  v_exp_f32 v64, v64
  v_exp_f32 v65, v65
  v_exp_f32 v66, v66
  v_exp_f32 v67, v67
  v_mfma_f32_32x32x16_bf16 v[144:159], v[108:111], v[228:231], v[144:159]
  v_exp_f32 v68, v68
  v_exp_f32 v69, v69
  v_exp_f32 v70, v70
  v_smfmac_f32_16x16x64_bf16 v[208:211], v[12:15], v[224:231], v11
  buffer_load_dwordx4 v[88:91], v3, s[4:7], s30 offen offset:2048
  v_exp_f32 v71, v71
  v_mfma_f32_32x32x16_bf16 v[48:63], v[100:103], v[36:39], v[48:63]
  v_cvt_pk_bf16_f32 v224, v64, v65
  v_cvt_pk_bf16_f32 v225, v66, v67
  v_cvt_pk_bf16_f32 v226, v68, v69
  v_cvt_pk_bf16_f32 v227, v70, v71
  v_exp_f32 v72, v72
  v_exp_f32 v73, v73
  v_exp_f32 v74, v74
  v_exp_f32 v75, v75
  v_mfma_f32_32x32x16_bf16 v[160:175], v[104:107], v[224:227], v[160:175]
  v_exp_f32 v76, v76
  v_exp_f32 v77, v77
  v_exp_f32 v78, v78
  v_exp_f32 v79, v79
  v_cvt_pk_bf16_f32 v228, v72, v73
  v_cvt_pk_bf16_f32 v229, v74, v75
  v_cvt_pk_bf16_f32 v230, v76, v77
  v_cvt_pk_bf16_f32 v231, v78, v79
  v_mfma_f32_32x32x16_bf16 v[64:79], v[96:99], v[40:43], 0
  v_exp_f32 v48, v48
  v_exp_f32 v49, v49
  v_exp_f32 v50, v50
  v_exp_f32 v51, v51
  v_mfma_f32_32x32x16_bf16 v[160:175], v[108:111], v[228:231], v[160:175]
  v_exp_f32 v52, v52
  v_exp_f32 v53, v53
  v_exp_f32 v54, v54
  v_smfmac_f32_16x16x64_bf16 v[212:215], v[12:15], v[224:231], v11
  buffer_load_dwordx4 v[92:95], v3, s[4:7], s30 offen offset:3072
  v_exp_f32 v55, v55
  v_mfma_f32_32x32x16_bf16 v[64:79], v[100:103], v[44:47], v[64:79]
  v_cvt_pk_bf16_f32 v224, v48, v49
  v_cvt_pk_bf16_f32 v225, v50, v51
  v_cvt_pk_bf16_f32 v226, v52, v53
  v_cvt_pk_bf16_f32 v227, v54, v55
  v_exp_f32 v56, v56
  v_exp_f32 v57, v57
  v_exp_f32 v58, v58
  v_exp_f32 v59, v59
  v_mfma_f32_32x32x16_bf16 v[176:191], v[104:107], v[224:227], v[176:191]
  s_waitcnt vmcnt(10)
  v_exp_f32 v60, v60
  v_exp_f32 v61, v61
  v_exp_f32 v62, v62
  v_exp_f32 v63, v63
  v_cvt_pk_bf16_f32 v228, v56, v57
  v_cvt_pk_bf16_f32 v229, v58, v59
  v_cvt_pk_bf16_f32 v230, v60, v61
  v_cvt_pk_bf16_f32 v231, v62, v63
  v_mfma_f32_32x32x16_bf16 v[48:63], v[112:115], v[16:19], 0
  v_exp_f32 v64, v64
  v_exp_f32 v65, v65
  v_exp_f32 v66, v66
  v_exp_f32 v67, v67
  v_mfma_f32_32x32x16_bf16 v[176:191], v[108:111], v[228:231], v[176:191]
  v_exp_f32 v68, v68
  v_exp_f32 v69, v69
  v_exp_f32 v70, v70
  v_smfmac_f32_16x16x64_bf16 v[216:219], v[12:15], v[224:231], v11
  buffer_load_dwordx4 v[96:99], v10, s[4:7], s30 offen offset:0
  v_exp_f32 v71, v71
  v_mfma_f32_32x32x16_bf16 v[48:63], v[116:119], v[20:23], v[48:63]
  v_cvt_pk_bf16_f32 v224, v64, v65
  v_cvt_pk_bf16_f32 v225, v66, v67
  v_cvt_pk_bf16_f32 v226, v68, v69
  v_cvt_pk_bf16_f32 v227, v70, v71
  v_exp_f32 v72, v72
  v_exp_f32 v73, v73
  v_exp_f32 v74, v74
  v_exp_f32 v75, v75
  v_mfma_f32_32x32x16_bf16 v[192:207], v[104:107], v[224:227], v[192:207]
  v_exp_f32 v76, v76
  v_exp_f32 v77, v77
  v_exp_f32 v78, v78
  v_exp_f32 v79, v79
  v_cvt_pk_bf16_f32 v228, v72, v73
  v_cvt_pk_bf16_f32 v229, v74, v75
  v_cvt_pk_bf16_f32 v230, v76, v77
  v_cvt_pk_bf16_f32 v231, v78, v79
.fz_kernel_a_b2:
  v_mfma_f32_32x32x16_bf16 v[64:79], v[112:115], v[24:27], 0
  v_exp_f32 v48, v48
  v_exp_f32 v49, v49
  v_exp_f32 v50, v50
  v_exp_f32 v51, v51
  v_mfma_f32_32x32x16_bf16 v[192:207], v[108:111], v[228:231], v[192:207]
  v_exp_f32 v52, v52
  v_exp_f32 v53, v53
  v_exp_f32 v54, v54
  v_smfmac_f32_16x16x64_bf16 v[220:223], v[12:15], v[224:231], v11
  buffer_load_dwordx4 v[100:103], v10, s[4:7], s30 offen offset:1024
  v_exp_f32 v55, v55
  v_mfma_f32_32x32x16_bf16 v[64:79], v[116:119], v[28:31], v[64:79]
  s_waitcnt vmcnt(10)
  v_cvt_pk_bf16_f32 v224, v48, v49
  v_cvt_pk_bf16_f32 v225, v50, v51
  v_cvt_pk_bf16_f32 v226, v52, v53
  v_cvt_pk_bf16_f32 v227, v54, v55
  v_exp_f32 v56, v56
  v_exp_f32 v57, v57
  v_exp_f32 v58, v58
  v_exp_f32 v59, v59
  v_mfma_f32_32x32x16_bf16 v[144:159], v[120:123], v[224:227], v[144:159]
  v_exp_f32 v60, v60
  v_exp_f32 v61, v61
  v_exp_f32 v62, v62
  v_exp_f32 v63, v63
  v_cvt_pk_bf16_f32 v228, v56, v57
  v_cvt_pk_bf16_f32 v229, v58, v59
  v_cvt_pk_bf16_f32 v230, v60, v61
  v_cvt_pk_bf16_f32 v231, v62, v63
  v_mfma_f32_32x32x16_bf16 v[48:63], v[112:115], v[32:35], 0
  v_exp_f32 v64, v64
  v_exp_f32 v65, v65
  v_exp_f32 v66, v66
  v_exp_f32 v67, v67
  v_mfma_f32_32x32x16_bf16 v[144:159], v[124:127], v[228:231], v[144:159]
  v_exp_f32 v68, v68
  v_exp_f32 v69, v69
  v_exp_f32 v70, v70
  v_smfmac_f32_16x16x64_bf16 v[208:211], v[12:15], v[224:231], v11
  buffer_load_dwordx4 v[104:107], v10, s[4:7], s30 offen offset:2048
  v_exp_f32 v71, v71
  v_mfma_f32_32x32x16_bf16 v[48:63], v[116:119], v[36:39], v[48:63]
  s_ff1_i32_b32 s33, s36
  v_cvt_pk_bf16_f32 v224, v64, v65
  v_cvt_pk_bf16_f32 v225, v66, v67
  v_cvt_pk_bf16_f32 v226, v68, v69
  v_cvt_pk_bf16_f32 v227, v70, v71
  v_exp_f32 v72, v72
  v_exp_f32 v73, v73
  v_exp_f32 v74, v74
  v_exp_f32 v75, v75
  v_mfma_f32_32x32x16_bf16 v[160:175], v[120:123], v[224:227], v[160:175]
  s_bitset0_b32 s36, s33
  v_exp_f32 v76, v76
  v_exp_f32 v77, v77
  v_exp_f32 v78, v78
  v_exp_f32 v79, v79
  v_cvt_pk_bf16_f32 v228, v72, v73
  v_cvt_pk_bf16_f32 v229, v74, v75
  v_cvt_pk_bf16_f32 v230, v76, v77
  v_cvt_pk_bf16_f32 v231, v78, v79
  v_mfma_f32_32x32x16_bf16 v[64:79], v[112:115], v[40:43], 0
  s_lshl_b32 s33, s33, 14
  v_exp_f32 v48, v48
  v_exp_f32 v49, v49
  v_exp_f32 v50, v50
  v_exp_f32 v51, v51
  v_mfma_f32_32x32x16_bf16 v[160:175], v[124:127], v[228:231], v[160:175]
  v_exp_f32 v52, v52
  v_exp_f32 v53, v53
  v_exp_f32 v54, v54
  v_smfmac_f32_16x16x64_bf16 v[212:215], v[12:15], v[224:231], v11
  buffer_load_dwordx4 v[108:111], v10, s[4:7], s30 offen offset:3072
  v_exp_f32 v55, v55
  v_mfma_f32_32x32x16_bf16 v[64:79], v[116:119], v[44:47], v[64:79]
  s_add_u32 s30, s33, s35
  v_cvt_pk_bf16_f32 v224, v48, v49
  v_cvt_pk_bf16_f32 v225, v50, v51
  v_cvt_pk_bf16_f32 v226, v52, v53
  v_cvt_pk_bf16_f32 v227, v54, v55
  v_exp_f32 v56, v56
  v_exp_f32 v57, v57
  v_exp_f32 v58, v58
  v_exp_f32 v59, v59
  v_mfma_f32_32x32x16_bf16 v[176:191], v[120:123], v[224:227], v[176:191]
  s_waitcnt vmcnt(10)
  v_exp_f32 v60, v60
  v_exp_f32 v61, v61
  v_exp_f32 v62, v62
  v_exp_f32 v63, v63
  v_cvt_pk_bf16_f32 v228, v56, v57
  v_cvt_pk_bf16_f32 v229, v58, v59
  v_cvt_pk_bf16_f32 v230, v60, v61
  v_cvt_pk_bf16_f32 v231, v62, v63
  v_mfma_f32_32x32x16_bf16 v[48:63], v[128:131], v[16:19], 0
  s_cbranch_scc1 .fz_kernel_pk32c
.fz_kernel_pk32:
  v_exp_f32 v64, v64
  v_exp_f32 v65, v65
  v_exp_f32 v66, v66
  v_exp_f32 v67, v67
  v_mfma_f32_32x32x16_bf16 v[176:191], v[124:127], v[228:231], v[176:191]
  v_exp_f32 v68, v68
  v_exp_f32 v69, v69
  v_exp_f32 v70, v70
  v_smfmac_f32_16x16x64_bf16 v[216:219], v[12:15], v[224:231], v11
  buffer_load_dwordx4 v[112:115], v3, s[4:7], s30 offen offset:0
  v_exp_f32 v71, v71
  v_mfma_f32_32x32x16_bf16 v[48:63], v[132:135], v[20:23], v[48:63]
  v_cvt_pk_bf16_f32 v224, v64, v65
  v_cvt_pk_bf16_f32 v225, v66, v67
  v_cvt_pk_bf16_f32 v226, v68, v69
  v_cvt_pk_bf16_f32 v227, v70, v71
  v_exp_f32 v72, v72
  v_exp_f32 v73, v73
  v_exp_f32 v74, v74
  v_exp_f32 v75, v75
  v_mfma_f32_32x32x16_bf16 v[192:207], v[120:123], v[224:227], v[192:207]
  v_exp_f32 v76, v76
  v_exp_f32 v77, v77
  v_exp_f32 v78, v78
  v_exp_f32 v79, v79
  v_cvt_pk_bf16_f32 v228, v72, v73
  v_cvt_pk_bf16_f32 v229, v74, v75
  v_cvt_pk_bf16_f32 v230, v76, v77
  v_cvt_pk_bf16_f32 v231, v78, v79
  v_mfma_f32_32x32x16_bf16 v[64:79], v[128:131], v[24:27], 0
  v_exp_f32 v48, v48
  v_exp_f32 v49, v49
  v_exp_f32 v50, v50
  v_exp_f32 v51, v51
  v_mfma_f32_32x32x16_bf16 v[192:207], v[124:127], v[228:231], v[192:207]
  v_exp_f32 v52, v52
  v_exp_f32 v53, v53
  v_exp_f32 v54, v54
  v_smfmac_f32_16x16x64_bf16 v[220:223], v[12:15], v[224:231], v11
  buffer_load_dwordx4 v[116:119], v3, s[4:7], s30 offen offset:1024
  v_exp_f32 v55, v55
  v_mfma_f32_32x32x16_bf16 v[64:79], v[132:135], v[28:31], v[64:79]
  s_waitcnt vmcnt(10)
  v_cvt_pk_bf16_f32 v224, v48, v49
  v_cvt_pk_bf16_f32 v225, v50, v51
  v_cvt_pk_bf16_f32 v226, v52, v53
  v_cvt_pk_bf16_f32 v227, v54, v55
  v_exp_f32 v56, v56
  v_exp_f32 v57, v57
  v_exp_f32 v58, v58
  v_exp_f32 v59, v59
  v_mfma_f32_32x32x16_bf16 v[144:159], v[136:139], v[224:227], v[144:159]
  v_exp_f32 v60, v60
  v_exp_f32 v61, v61
  v_exp_f32 v62, v62
  v_exp_f32 v63, v63
  v_cvt_pk_bf16_f32 v228, v56, v57
  v_cvt_pk_bf16_f32 v229, v58, v59
  v_cvt_pk_bf16_f32 v230, v60, v61
  v_cvt_pk_bf16_f32 v231, v62, v63
  v_mfma_f32_32x32x16_bf16 v[48:63], v[128:131], v[32:35], 0
  v_exp_f32 v64, v64
  v_exp_f32 v65, v65
  v_exp_f32 v66, v66
  v_exp_f32 v67, v67
  v_mfma_f32_32x32x16_bf16 v[144:159], v[140:143], v[228:231], v[144:159]
  v_exp_f32 v68, v68
  v_exp_f32 v69, v69
  v_exp_f32 v70, v70
  v_smfmac_f32_16x16x64_bf16 v[208:211], v[12:15], v[224:231], v11
  buffer_load_dwordx4 v[120:123], v3, s[4:7], s30 offen offset:2048
  v_exp_f32 v71, v71
  v_mfma_f32_32x32x16_bf16 v[48:63], v[132:135], v[36:39], v[48:63]
  v_cvt_pk_bf16_f32 v224, v64, v65
  v_cvt_pk_bf16_f32 v225, v66, v67
  v_cvt_pk_bf16_f32 v226, v68, v69
  v_cvt_pk_bf16_f32 v227, v70, v71
  v_exp_f32 v72, v72
  v_exp_f32 v73, v73
  v_exp_f32 v74, v74
  v_exp_f32 v75, v75
  v_mfma_f32_32x32x16_bf16 v[160:175], v[136:139], v[224:227], v[160:175]
  v_exp_f32 v76, v76
  v_exp_f32 v77, v77
  v_exp_f32 v78, v78
  v_exp_f32 v79, v79
  v_cvt_pk_bf16_f32 v228, v72, v73
  v_cvt_pk_bf16_f32 v229, v74, v75
  v_cvt_pk_bf16_f32 v230, v76, v77
  v_cvt_pk_bf16_f32 v231, v78, v79
  v_mfma_f32_32x32x16_bf16 v[64:79], v[128:131], v[40:43], 0
  v_exp_f32 v48, v48
  v_exp_f32 v49, v49
  v_exp_f32 v50, v50
  v_exp_f32 v51, v51
  v_mfma_f32_32x32x16_bf16 v[160:175], v[140:143], v[228:231], v[160:175]
  v_exp_f32 v52, v52
  v_exp_f32 v53, v53
  v_exp_f32 v54, v54
  v_smfmac_f32_16x16x64_bf16 v[212:215], v[12:15], v[224:231], v11
  buffer_load_dwordx4 v[124:127], v3, s[4:7], s30 offen offset:3072
  v_exp_f32 v55, v55
  v_mfma_f32_32x32x16_bf16 v[64:79], v[132:135], v[44:47], v[64:79]
  v_cvt_pk_bf16_f32 v224, v48, v49
  v_cvt_pk_bf16_f32 v225, v50, v51
  v_cvt_pk_bf16_f32 v226, v52, v53
  v_cvt_pk_bf16_f32 v227, v54, v55
  v_exp_f32 v56, v56
  v_exp_f32 v57, v57
  v_exp_f32 v58, v58
  v_exp_f32 v59, v59
  v_mfma_f32_32x32x16_bf16 v[176:191], v[136:139], v[224:227], v[176:191]
  s_waitcnt vmcnt(10)
  v_exp_f32 v60, v60
  v_exp_f32 v61, v61
  v_exp_f32 v62, v62
  v_exp_f32 v63, v63
  v_cvt_pk_bf16_f32 v228, v56, v57
  v_cvt_pk_bf16_f32 v229, v58, v59
  v_cvt_pk_bf16_f32 v230, v60, v61
  v_cvt_pk_bf16_f32 v231, v62, v63
  v_mfma_f32_32x32x16_bf16 v[48:63], v[80:83], v[16:19], 0
  v_exp_f32 v64, v64
  v_exp_f32 v65, v65
  v_exp_f32 v66, v66
  v_exp_f32 v67, v67
  v_mfma_f32_32x32x16_bf16 v[176:191], v[140:143], v[228:231], v[176:191]
  v_exp_f32 v68, v68
  v_exp_f32 v69, v69
  v_exp_f32 v70, v70
  v_smfmac_f32_16x16x64_bf16 v[216:219], v[12:15], v[224:231], v11
  buffer_load_dwordx4 v[128:131], v10, s[4:7], s30 offen offset:0
  v_exp_f32 v71, v71
  v_mfma_f32_32x32x16_bf16 v[48:63], v[84:87], v[20:23], v[48:63]
  s_sub_u32 s32, s32, 1
  v_cvt_pk_bf16_f32 v224, v64, v65
  v_cvt_pk_bf16_f32 v225, v66, v67
  v_cvt_pk_bf16_f32 v226, v68, v69
  v_cvt_pk_bf16_f32 v227, v70, v71
  v_exp_f32 v72, v72
  v_exp_f32 v73, v73
  v_exp_f32 v74, v74
  v_exp_f32 v75, v75
  v_mfma_f32_32x32x16_bf16 v[192:207], v[136:139], v[224:227], v[192:207]
  s_cmp_lg_u32 s32, 0
  v_exp_f32 v76, v76
  v_exp_f32 v77, v77
  v_exp_f32 v78, v78
  v_exp_f32 v79, v79
  v_cvt_pk_bf16_f32 v228, v72, v73
  v_cvt_pk_bf16_f32 v229, v74, v75
  v_cvt_pk_bf16_f32 v230, v76, v77
  v_cvt_pk_bf16_f32 v231, v78, v79
  s_cbranch_scc1 .fz_kernel_a_loop
  v_cvt_pk_bf16_f32 v176, v176, v177
  v_cvt_pk_bf16_f32 v177, v178, v179
  v_mfma_f32_32x32x16_bf16 v[192:207], v[140:143], v[228:231], v[192:207]
  v_cvt_pk_bf16_f32 v178, v180, v181
  v_cvt_pk_bf16_f32 v179, v182, v183
  v_cvt_pk_bf16_f32 v180, v184, v185
  v_cvt_pk_bf16_f32 v181, v186, v187
  v_cvt_pk_bf16_f32 v182, v188, v189
  v_smfmac_f32_16x16x64_bf16 v[220:223], v[12:15], v[224:231], v11
  v_cvt_pk_bf16_f32 v183, v190, v191
  s_lshl_b32 s33, s16, 12
  s_add_u32 s33, s33, 131072
  v_add_u32 v36, s33, v3
  ds_write_b128 v36, v[176:179]
  ds_write_b128 v36, v[180:183] offset:1024
  s_and_b32 s39, s16, 1
  v_and_b32 v32, 16, v2
  v_cmp_ne_u32 s[34:35], 0, v32
  v_and_b32 v35, 31, v2
  v_lshlrev_b32 v35, 3, v35
  s_lshl_b32 s33, s16, 8
  s_add_u32 s33, s33, 147456
  v_add_u32 v37, s33, v35
  v_cvt_pk_bf16_f32 v192, v192, v193
  v_cvt_pk_bf16_f32 v193, v194, v195
  v_cvt_pk_bf16_f32 v194, v196, v197
  v_cvt_pk_bf16_f32 v195, v198, v199
  v_cvt_pk_bf16_f32 v196, v200, v201
  v_cvt_pk_bf16_f32 v197, v202, v203
  v_cvt_pk_bf16_f32 v198, v204, v205
  v_cvt_pk_bf16_f32 v199, v206, v207
  ds_write_b128 v36, v[192:195] offset:2048
  ds_write_b128 v36, v[196:199] offset:3072
  v_add_f32 v216, v216, v218
  v_add_f32 v217, v217, v219
  v_add_f32 v220, v220, v222
  v_add_f32 v221, v221, v223
  v_cndmask_b32 v38, v216, v217, s[34:35]
  v_cndmask_b32 v39, v220, v221, s[34:35]
  ds_write_b64 v37, v[38:39]
  v_add_f32 v208, v208, v210
  v_add_f32 v209, v209, v211
  v_add_f32 v212, v212, v214
  v_add_f32 v213, v213, v215
  v_cndmask_b32 v32, v208, v209, s[34:35]
  v_cndmask_b32 v33, v212, v213, s[34:35]
  v_xor_b32 v36, 8192, v36
  v_xor_b32 v37, 512, v37
  s_waitcnt vmcnt(0) lgkmcnt(0)
  s_barrier
  ds_read_b128 v[48:51], v36 offset:0
  ds_read_b128 v[52:55], v36 offset:1024
  ds_read_b128 v[56:59], v36 offset:2048
  ds_read_b128 v[60:63], v36 offset:3072
  ds_read_b64 v[38:39], v37
  v_mov_b32 v41, 8.673617379884035e-19
  v_mov_b32 v42, 1.152921504606847e+18
  s_and_b32 s32, s16, 2
  s_lshl2_add_u32 s31, s17, s32
  s_lshl_b32 s31, s31, 4
  s_add_u32 s31, s31, s18
  s_lshl1_add_u32 s31, s31, s39
  s_lshl_b32 s31, s31, 11
  s_add_u32 s28, s31, s64
  s_add_u32 s29, s28, 65536
  s_waitcnt lgkmcnt(4)
  v_mfma_f32_32x32x16_bf16 v[144:159], v[248:251], v[48:51], v[144:159]
  s_waitcnt lgkmcnt(3)
  v_mfma_f32_32x32x16_bf16 v[144:159], v[252:255], v[52:55], v[144:159]
  s_waitcnt lgkmcnt(2)
  v_mfma_f32_32x32x16_bf16 v[160:175], v[248:251], v[56:59], v[160:175]
  s_waitcnt lgkmcnt(1)
  v_mfma_f32_32x32x16_bf16 v[160:175], v[252:255], v[60:63], v[160:175]
  s_waitcnt lgkmcnt(0)
  v_add_f32 v32, v32, v38
  v_add_f32 v33, v33, v39
  s_mov_b32 s73, 0
.fz_kernel_a_fin:
  v_rcp_f32 v34, v32
  v_rcp_f32 v36, v33
  v_min_f32 v38, v32, v33
  v_max_f32 v39, v32, v33
  v_cmp_o_f32 s[36:37], v32, v33
  v_cmp_ge_f32 vcc, v38, v41
  s_and_b64 s[36:37], s[36:37], vcc
  v_cmp_le_f32 vcc, v39, v42
  s_and_b64 s[36:37], s[36:37], vcc
  v_pk_mul_f32 v[144:145], v[144:145], v[34:35] op_sel_hi:[1,0]
  v_pk_mul_f32 v[146:147], v[146:147], v[34:35] op_sel_hi:[1,0]
  v_pk_mul_f32 v[148:149], v[148:149], v[34:35] op_sel_hi:[1,0]
  v_pk_mul_f32 v[150:151], v[150:151], v[34:35] op_sel_hi:[1,0]
  v_cvt_pk_bf16_f32 v48, v144, v145
  v_cvt_pk_bf16_f32 v49, v146, v147
  v_cvt_pk_bf16_f32 v50, v148, v149
  v_cvt_pk_bf16_f32 v51, v150, v151
  buffer_store_dwordx4 v[48:51], v3, s[4:7], s28 offen offset:0 sc1
  v_pk_mul_f32 v[152:153], v[152:153], v[34:35] op_sel_hi:[1,0]
  v_pk_mul_f32 v[154:155], v[154:155], v[34:35] op_sel_hi:[1,0]
  v_pk_mul_f32 v[156:157], v[156:157], v[34:35] op_sel_hi:[1,0]
  v_pk_mul_f32 v[158:159], v[158:159], v[34:35] op_sel_hi:[1,0]
  v_cvt_pk_bf16_f32 v52, v152, v153
  v_cvt_pk_bf16_f32 v53, v154, v155
  v_cvt_pk_bf16_f32 v54, v156, v157
  v_cvt_pk_bf16_f32 v55, v158, v159
  buffer_store_dwordx4 v[52:55], v3, s[4:7], s28 offen offset:1024 sc1
  v_pk_mul_f32 v[160:161], v[160:161], v[36:37] op_sel_hi:[1,0]
  v_pk_mul_f32 v[162:163], v[162:163], v[36:37] op_sel_hi:[1,0]
  v_pk_mul_f32 v[164:165], v[164:165], v[36:37] op_sel_hi:[1,0]
  v_pk_mul_f32 v[166:167], v[166:167], v[36:37] op_sel_hi:[1,0]
  v_cvt_pk_bf16_f32 v56, v160, v161
  v_cvt_pk_bf16_f32 v57, v162, v163
  v_cvt_pk_bf16_f32 v58, v164, v165
  v_cvt_pk_bf16_f32 v59, v166, v167
  buffer_store_dwordx4 v[56:59], v3, s[4:7], s29 offen offset:0 sc1
  v_pk_mul_f32 v[168:169], v[168:169], v[36:37] op_sel_hi:[1,0]
  v_pk_mul_f32 v[170:171], v[170:171], v[36:37] op_sel_hi:[1,0]
  v_pk_mul_f32 v[172:173], v[172:173], v[36:37] op_sel_hi:[1,0]
  v_pk_mul_f32 v[174:175], v[174:175], v[36:37] op_sel_hi:[1,0]
  v_cvt_pk_bf16_f32 v60, v168, v169
  v_cvt_pk_bf16_f32 v61, v170, v171
  v_cvt_pk_bf16_f32 v62, v172, v173
  v_cvt_pk_bf16_f32 v63, v174, v175
  buffer_store_dwordx4 v[60:63], v3, s[4:7], s29 offen offset:1024 sc1
  ds_read_b32 v7, v6 offset:8
  v_pk_fma_f32 v[64:65], v[144:145], 0, 0 op_sel_hi:[1,0,0]
  v_pk_fma_f32 v[66:67], v[146:147], 0, 0 op_sel_hi:[1,0,0]
  v_pk_fma_f32 v[64:65], v[148:149], 0, v[64:65] op_sel_hi:[1,0,1]
  v_pk_fma_f32 v[66:67], v[150:151], 0, v[66:67] op_sel_hi:[1,0,1]
  v_pk_fma_f32 v[64:65], v[152:153], 0, v[64:65] op_sel_hi:[1,0,1]
  v_pk_fma_f32 v[66:67], v[154:155], 0, v[66:67] op_sel_hi:[1,0,1]
  v_pk_fma_f32 v[64:65], v[156:157], 0, v[64:65] op_sel_hi:[1,0,1]
  v_pk_fma_f32 v[66:67], v[158:159], 0, v[66:67] op_sel_hi:[1,0,1]
  v_pk_fma_f32 v[64:65], v[160:161], 0, v[64:65] op_sel_hi:[1,0,1]
  v_pk_fma_f32 v[66:67], v[162:163], 0, v[66:67] op_sel_hi:[1,0,1]
  v_pk_fma_f32 v[64:65], v[164:165], 0, v[64:65] op_sel_hi:[1,0,1]
  v_pk_fma_f32 v[66:67], v[166:167], 0, v[66:67] op_sel_hi:[1,0,1]
  v_pk_fma_f32 v[64:65], v[168:169], 0, v[64:65] op_sel_hi:[1,0,1]
  v_pk_fma_f32 v[66:67], v[170:171], 0, v[66:67] op_sel_hi:[1,0,1]
  v_pk_fma_f32 v[64:65], v[172:173], 0, v[64:65] op_sel_hi:[1,0,1]
  v_pk_fma_f32 v[66:67], v[174:175], 0, v[66:67] op_sel_hi:[1,0,1]
  v_pk_add_f32 v[64:65], v[64:65], v[66:67]
  v_cmp_o_f32 vcc, v64, v65
  s_and_b64 s[36:37], s[36:37], vcc
  s_cmp_eq_u64 s[36:37], -1
  s_cbranch_scc0 .fz_kernel_a_slow
.fz_kernel_a_ok:
  s_mov_b32 s8, s48
  s_mov_b32 s9, s49
  s_mov_b32 s10, 0x800
  s_mov_b32 s11, 0x00020000
  v_lshrrev_b32 v17, 5, v2
  v_lshlrev_b32 v19, 4, v17
  s_lshl_b32 s22, s18, 7
  s_lshl2_add_u32 s32, s17, s16
  s_lshl_b32 s35, s32, 16
  s_add_u32 s35, s35, s64
  s_mov_b32 s34, 0
  v_add_u32 v6, 8, v6
  buffer_load_dwordx4 v[48:51], v19, s[8:11], s22 offen offset:0
  buffer_load_dwordx4 v[52:55], v19, s[8:11], s22 offen offset:32
  buffer_load_dwordx4 v[56:59], v19, s[8:11], s22 offen offset:64
  buffer_load_dwordx4 v[60:63], v19, s[8:11], s22 offen offset:96
  s_waitcnt lgkmcnt(0)
  v_readfirstlane_b32 s36, v7
  s_bcnt1_i32_b32 s29, s36
  s_cmp_lt_u32 s29, 3
  s_cbranch_scc1 .fz_kernel_w_e0
  s_andn2_b32 s33, s36, s34
  s_cbranch_scc0 .fz_kernel_pk41c
.fz_kernel_pk41:
  s_ff1_i32_b32 s33, s33
  s_bitset1_b32 s34, s33
  s_lshl_b32 s20, s33, 13
  s_lshl_b32 s33, s33, 12
  s_add_u32 s30, s33, s35
  buffer_load_dwordx4 v[96:99], v3, s[4:7], s30 offen offset:0
  buffer_load_dwordx4 v[100:103], v3, s[4:7], s30 offen offset:1024
  buffer_load_dwordx4 v[104:107], v3, s[4:7], s30 offen offset:2048
  buffer_load_dwordx4 v[108:111], v3, s[4:7], s30 offen offset:3072
  s_andn2_b32 s33, s36, s34
  s_cbranch_scc0 .fz_kernel_pk42c
.fz_kernel_pk42:
  s_ff1_i32_b32 s33, s33
  s_bitset1_b32 s34, s33
  s_lshl_b32 s21, s33, 13
  s_lshl_b32 s33, s33, 12
  s_add_u32 s30, s33, s35
  buffer_load_dwordx4 v[112:115], v3, s[4:7], s30 offen offset:0
  buffer_load_dwordx4 v[116:119], v3, s[4:7], s30 offen offset:1024
  buffer_load_dwordx4 v[120:123], v3, s[4:7], s30 offen offset:2048
  buffer_load_dwordx4 v[124:127], v3, s[4:7], s30 offen offset:3072
  s_andn2_b32 s33, s36, s34
  s_cbranch_scc0 .fz_kernel_pk43c
.fz_kernel_pk43:
  s_ff1_i32_b32 s33, s33
  s_bitset1_b32 s34, s33
  s_lshl_b32 s22, s33, 13
  s_lshl_b32 s33, s33, 12
  s_add_u32 s30, s33, s35
  buffer_load_dwordx4 v[128:131], v3, s[4:7], s30 offen offset:0
  buffer_load_dwordx4 v[132:135], v3, s[4:7], s30 offen offset:1024
  buffer_load_dwordx4 v[136:139], v3, s[4:7], s30 offen offset:2048
  buffer_load_dwordx4 v[140:143], v3, s[4:7], s30 offen offset:3072
.fz_kernel_w_e0:
  v_and_b32 v18, 31, v2
  s_lshl_b32 s39, s17, 4
  s_add_u32 s39, s39, s18
  s_lshl_b32 s39, s39, 2
  s_add_u32 s39, s39, s16
  s_lshl_b32 s39, s39, 12
  v_and_b32 v16, 16, v2
  v_lshlrev_b32 v16, 7, v16
  v_lshl_add_u32 v16, v17, 8, v16
  v_and_b32 v1, 0xf0, v3
  v_add_u32 v16, v16, v1
  s_add_u32 s39, s39, s65
  s_lshl_b32 s31, s16, 5
  v_add_u32 v45, s31, v18
  v_lshlrev_b32 v11, 2, v45
  v_add_u32 v11, 155648, v11
  v_mov_b32 v44, 159952
  ds_read_b32 v40, v11 offset:6400
  ds_read_b32 v42, v11 offset:6912
  ds_read_b32 v46, v44 offset:8
  ds_read_b32 v44, v44
  v_mov_b32 v47, 0.32768
  v_add_u32 v45, 1, v45
  v_bfe_u32 v11, v2, 2, 2
  v_lshl_add_u32 v12, v17, 2, v11
  v_lshlrev_b32 v12, 7, v12
  v_lshrrev_b32 v13, 1, v11
  v_lshl_add_u32 v12, v13, 6, v12
  v_bfe_u32 v13, v2, 4, 1
  v_lshl_add_u32 v12, v13, 5, v12
  v_and_b32 v13, 1, v2
  v_lshl_add_u32 v12, v13, 4, v12
  v_bfe_u32 v13, v2, 1, 1
  v_lshl_add_u32 v14, v13, 3, v12
  v_xor_b32 v15, 64, v14
  s_waitcnt lgkmcnt(0)
  v_lshlrev_b32 v64, 16, v232
  v_and_b32 v65, 0xffff0000, v232
  v_lshlrev_b32 v66, 16, v233
  v_and_b32 v67, 0xffff0000, v233
  v_lshlrev_b32 v68, 16, v234
  v_and_b32 v69, 0xffff0000, v234
  v_lshlrev_b32 v70, 16, v235
  v_and_b32 v71, 0xffff0000, v235
  v_lshlrev_b32 v72, 16, v236
  v_and_b32 v73, 0xffff0000, v236
  v_lshlrev_b32 v74, 16, v237
  v_and_b32 v75, 0xffff0000, v237
  v_lshlrev_b32 v76, 16, v238
  v_and_b32 v77, 0xffff0000, v238
  v_lshlrev_b32 v78, 16, v239
  v_and_b32 v79, 0xffff0000, v239
  v_lshlrev_b32 v80, 16, v240
  v_and_b32 v81, 0xffff0000, v240
  v_lshlrev_b32 v82, 16, v241
  v_and_b32 v83, 0xffff0000, v241
  v_lshlrev_b32 v84, 16, v242
  v_and_b32 v85, 0xffff0000, v242
  v_lshlrev_b32 v86, 16, v243
  v_and_b32 v87, 0xffff0000, v243
  v_lshlrev_b32 v88, 16, v244
  v_and_b32 v89, 0xffff0000, v244
  v_lshlrev_b32 v90, 16, v245
  v_and_b32 v91, 0xffff0000, v245
  v_lshlrev_b32 v92, 16, v246
  v_and_b32 v93, 0xffff0000, v246
  v_lshlrev_b32 v94, 16, v247
  v_and_b32 v95, 0xffff0000, v247
  v_pk_fma_f32 v[64:65], v[64:65], v[40:41], v[42:43] op_sel_hi:[1,0,0]
  v_pk_fma_f32 v[66:67], v[66:67], v[40:41], v[42:43] op_sel_hi:[1,0,0]
  v_pk_fma_f32 v[68:69], v[68:69], v[40:41], v[42:43] op_sel_hi:[1,0,0]
  v_pk_fma_f32 v[70:71], v[70:71], v[40:41], v[42:43] op_sel_hi:[1,0,0]
  v_pk_fma_f32 v[72:73], v[72:73], v[40:41], v[42:43] op_sel_hi:[1,0,0]
  v_pk_fma_f32 v[74:75], v[74:75], v[40:41], v[42:43] op_sel_hi:[1,0,0]
  v_pk_fma_f32 v[76:77], v[76:77], v[40:41], v[42:43] op_sel_hi:[1,0,0]
  v_pk_fma_f32 v[78:79], v[78:79], v[40:41], v[42:43] op_sel_hi:[1,0,0]
  v_pk_fma_f32 v[80:81], v[80:81], v[40:41], v[42:43] op_sel_hi:[1,0,0]
  v_pk_fma_f32 v[82:83], v[82:83], v[40:41], v[42:43] op_sel_hi:[1,0,0]
  v_pk_fma_f32 v[84:85], v[84:85], v[40:41], v[42:43] op_sel_hi:[1,0,0]
  v_pk_fma_f32 v[86:87], v[86:87], v[40:41], v[42:43] op_sel_hi:[1,0,0]
  v_pk_fma_f32 v[88:89], v[88:89], v[40:41], v[42:43] op_sel_hi:[1,0,0]
  v_pk_fma_f32 v[90:91], v[90:91], v[40:41], v[42:43] op_sel_hi:[1,0,0]
  v_pk_fma_f32 v[92:93], v[92:93], v[40:41], v[42:43] op_sel_hi:[1,0,0]
  v_pk_fma_f32 v[94:95], v[94:95], v[40:41], v[42:43] op_sel_hi:[1,0,0]
  v_cmp_eq_u32 vcc, v44, v45
  s_cbranch_vccnz .fz_kernel_w_pt
.fz_kernel_w_pb:
  s_mov_b64 exec, 1
  s_cmp_lt_u32 s29, 3
  s_cbranch_scc1 .fz_kernel_w_e1
  s_waitcnt vmcnt(16)
  ds_add_u32 v6, v5 offset:0x100
  s_mov_b64 exec, -1
  s_branch .fz_kernel_w_e2
.fz_kernel_w_e1:
  s_waitcnt vmcnt(4)
  ds_add_u32 v6, v5 offset:0x100
  s_mov_b64 exec, -1
  s_andn2_b32 s33, s36, s34
  s_cbranch_scc0 .fz_kernel_pk44c
.fz_kernel_pk44:
  s_ff1_i32_b32 s33, s33
  s_bitset1_b32 s34, s33
  s_lshl_b32 s20, s33, 13
  s_lshl_b32 s33, s33, 12
  s_add_u32 s30, s33, s35
  buffer_load_dwordx4 v[96:99], v3, s[4:7], s30 offen offset:0
  buffer_load_dwordx4 v[100:103], v3, s[4:7], s30 offen offset:1024
  buffer_load_dwordx4 v[104:107], v3, s[4:7], s30 offen offset:2048
  buffer_load_dwordx4 v[108:111], v3, s[4:7], s30 offen offset:3072
  s_andn2_b32 s33, s36, s34
  s_cbranch_scc0 .fz_kernel_pk45c
.fz_kernel_pk45:
  s_ff1_i32_b32 s33, s33
  s_bitset1_b32 s34, s33
  s_lshl_b32 s21, s33, 13
  s_lshl_b32 s33, s33, 12
  s_add_u32 s30, s33, s35
  buffer_load_dwordx4 v[112:115], v3, s[4:7], s30 offen offset:0
  buffer_load_dwordx4 v[116:119], v3, s[4:7], s30 offen offset:1024
  buffer_load_dwordx4 v[120:123], v3, s[4:7], s30 offen offset:2048
  buffer_load_dwordx4 v[124:127], v3, s[4:7], s30 offen offset:3072
  s_andn2_b32 s33, s36, s34
  s_cbranch_scc0 .fz_kernel_pk46c
.fz_kernel_pk46:
  s_ff1_i32_b32 s33, s33
  s_bitset1_b32 s34, s33
  s_lshl_b32 s22, s33, 13
  s_lshl_b32 s33, s33, 12
  s_add_u32 s30, s33, s35
  buffer_load_dwordx4 v[128:131], v3, s[4:7], s30 offen offset:0
  buffer_load_dwordx4 v[132:135], v3, s[4:7], s30 offen offset:1024
  buffer_load_dwordx4 v[136:139], v3, s[4:7], s30 offen offset:2048
  buffer_load_dwordx4 v[140:143], v3, s[4:7], s30 offen offset:3072
.fz_kernel_w_e2:
  v_add_u32 v10, s20, v14
  v_add_u32 v11, s20, v15
  ds_read_b64_tr_b16 v[224:225], v10 offset:0
  ds_read_b64_tr_b16 v[226:227], v10 offset:1024
  ds_read_b64_tr_b16 v[228:229], v11 offset:0
  ds_read_b64_tr_b16 v[230:231], v11 offset:1024
  ds_read_b64_tr_b16 v[232:233], v10 offset:2048
  ds_read_b64_tr_b16 v[234:235], v10 offset:3072
  ds_read_b64_tr_b16 v[236:237], v11 offset:2048
  ds_read_b64_tr_b16 v[238:239], v11 offset:3072
  s_andn2_b32 s33, s36, s34
  s_cbranch_scc0 .fz_kernel_pk47c
.fz_kernel_pk47:
  s_ff1_i32_b32 s33, s33
  s_bitset1_b32 s34, s33
  s_lshl_b32 s23, s33, 13
  s_lshl_b32 s33, s33, 12
  s_add_u32 s30, s33, s35
  s_waitcnt vmcnt(11) lgkmcnt(6)
  v_mfma_f32_32x32x16_bf16 v[64:79], v[224:227], v[96:99], v[64:79]
  v_add_u32 v12, s21, v14
  v_add_u32 v13, s21, v15
  buffer_load_dwordx4 v[144:147], v3, s[4:7], s30 offen offset:0
  ds_read_b64_tr_b16 v[240:241], v10 offset:4096
  s_waitcnt lgkmcnt(5)
  v_mfma_f32_32x32x16_bf16 v[80:95], v[228:231], v[96:99], v[80:95]
  ds_read_b64_tr_b16 v[242:243], v10 offset:5120
  ds_read_b64_tr_b16 v[244:245], v11 offset:4096
  ds_read_b64_tr_b16 v[246:247], v11 offset:5120
  s_waitcnt vmcnt(11) lgkmcnt(6)
  v_mfma_f32_32x32x16_bf16 v[64:79], v[232:235], v[100:103], v[64:79]
  buffer_load_dwordx4 v[148:151], v3, s[4:7], s30 offen offset:1024
  ds_read_b64_tr_b16 v[248:249], v10 offset:6144
  s_waitcnt lgkmcnt(5)
  v_mfma_f32_32x32x16_bf16 v[80:95], v[236:239], v[100:103], v[80:95]
  ds_read_b64_tr_b16 v[250:251], v10 offset:7168
  ds_read_b64_tr_b16 v[252:253], v11 offset:6144
  ds_read_b64_tr_b16 v[254:255], v11 offset:7168
  s_waitcnt vmcnt(11) lgkmcnt(6)
  v_mfma_f32_32x32x16_bf16 v[64:79], v[240:243], v[104:107], v[64:79]
  buffer_load_dwordx4 v[152:155], v3, s[4:7], s30 offen offset:2048
  ds_read_b64_tr_b16 v[224:225], v12 offset:0
  s_waitcnt lgkmcnt(5)
  v_mfma_f32_32x32x16_bf16 v[80:95], v[244:247], v[104:107], v[80:95]
  ds_read_b64_tr_b16 v[226:227], v12 offset:1024
  ds_read_b64_tr_b16 v[228:229], v13 offset:0
  ds_read_b64_tr_b16 v[230:231], v13 offset:1024
  s_waitcnt vmcnt(11) lgkmcnt(6)
  v_mfma_f32_32x32x16_bf16 v[64:79], v[248:251], v[108:111], v[64:79]
  buffer_load_dwordx4 v[156:159], v3, s[4:7], s30 offen offset:3072
  ds_read_b64_tr_b16 v[232:233], v12 offset:2048
  s_waitcnt lgkmcnt(5)
  v_mfma_f32_32x32x16_bf16 v[80:95], v[252:255], v[108:111], v[80:95]
  ds_read_b64_tr_b16 v[234:235], v12 offset:3072
  ds_read_b64_tr_b16 v[236:237], v13 offset:2048
  ds_read_b64_tr_b16 v[238:239], v13 offset:3072
  s_andn2_b32 s33, s36, s34
  s_cbranch_scc0 .fz_kernel_pk48c
.fz_kernel_pk48:
  s_ff1_i32_b32 s33, s33
  s_bitset1_b32 s34, s33
  s_lshl_b32 s24, s33, 13
  s_lshl_b32 s33, s33, 12
  s_add_u32 s30, s33, s35
  s_waitcnt vmcnt(11) lgkmcnt(6)
  v_mfma_f32_32x32x16_bf16 v[64:79], v[224:227], v[112:115], v[64:79]
  v_add_u32 v10, s22, v14
  v_add_u32 v11, s22, v15
  buffer_load_dwordx4 v[160:163], v3, s[4:7], s30 offen offset:0
  ds_read_b64_tr_b16 v[240:241], v12 offset:4096
  s_waitcnt lgkmcnt(5)
  v_mfma_f32_32x32x16_bf16 v[80:95], v[228:231], v[112:115], v[80:95]
  ds_read_b64_tr_b16 v[242:243], v12 offset:5120
  ds_read_b64_tr_b16 v[244:245], v13 offset:4096
  ds_read_b64_tr_b16 v[246:247], v13 offset:5120
  s_waitcnt vmcnt(11) lgkmcnt(6)
  v_mfma_f32_32x32x16_bf16 v[64:79], v[232:235], v[116:119], v[64:79]
  buffer_load_dwordx4 v[164:167], v3, s[4:7], s30 offen offset:1024
  ds_read_b64_tr_b16 v[248:249], v12 offset:6144
  s_waitcnt lgkmcnt(5)
  v_mfma_f32_32x32x16_bf16 v[80:95], v[236:239], v[116:119], v[80:95]
  ds_read_b64_tr_b16 v[250:251], v12 offset:7168
  ds_read_b64_tr_b16 v[252:253], v13 offset:6144
  ds_read_b64_tr_b16 v[254:255], v13 offset:7168
  s_waitcnt vmcnt(11) lgkmcnt(6)
  v_mfma_f32_32x32x16_bf16 v[64:79], v[240:243], v[120:123], v[64:79]
  buffer_load_dwordx4 v[168:171], v3, s[4:7], s30 offen offset:2048
  ds_read_b64_tr_b16 v[224:225], v10 offset:0
  s_waitcnt lgkmcnt(5)
  v_mfma_f32_32x32x16_bf16 v[80:95], v[244:247], v[120:123], v[80:95]
  ds_read_b64_tr_b16 v[226:227], v10 offset:1024
  ds_read_b64_tr_b16 v[228:229], v11 offset:0
  ds_read_b64_tr_b16 v[230:231], v11 offset:1024
  s_waitcnt vmcnt(11) lgkmcnt(6)
  v_mfma_f32_32x32x16_bf16 v[64:79], v[248:251], v[124:127], v[64:79]
  buffer_load_dwordx4 v[172:175], v3, s[4:7], s30 offen offset:3072
  ds_read_b64_tr_b16 v[232:233], v10 offset:2048
  s_waitcnt lgkmcnt(5)
  v_mfma_f32_32x32x16_bf16 v[80:95], v[252:255], v[124:127], v[80:95]
  ds_read_b64_tr_b16 v[234:235], v10 offset:3072
  ds_read_b64_tr_b16 v[236:237], v11 offset:2048
  ds_read_b64_tr_b16 v[238:239], v11 offset:3072
  s_andn2_b32 s33, s36, s34
  s_cbranch_scc0 .fz_kernel_pk49c
.fz_kernel_pk49:
  s_ff1_i32_b32 s33, s33
  s_bitset1_b32 s34, s33
  s_lshl_b32 s25, s33, 13
  s_lshl_b32 s33, s33, 12
  s_add_u32 s30, s33, s35
  s_waitcnt vmcnt(11) lgkmcnt(6)
  v_mfma_f32_32x32x16_bf16 v[64:79], v[224:227], v[128:131], v[64:79]
  v_add_u32 v12, s23, v14
  v_add_u32 v13, s23, v15
  buffer_load_dwordx4 v[176:179], v3, s[4:7], s30 offen offset:0
  ds_read_b64_tr_b16 v[240:241], v10 offset:4096
  s_waitcnt lgkmcnt(5)
  v_mfma_f32_32x32x16_bf16 v[80:95], v[228:231], v[128:131], v[80:95]
  ds_read_b64_tr_b16 v[242:243], v10 offset:5120
  ds_read_b64_tr_b16 v[244:245], v11 offset:4096
  ds_read_b64_tr_b16 v[246:247], v11 offset:5120
  s_waitcnt vmcnt(11) lgkmcnt(6)
  v_mfma_f32_32x32x16_bf16 v[64:79], v[232:235], v[132:135], v[64:79]
  buffer_load_dwordx4 v[180:183], v3, s[4:7], s30 offen offset:1024
  ds_read_b64_tr_b16 v[248:249], v10 offset:6144
  s_waitcnt lgkmcnt(5)
  v_mfma_f32_32x32x16_bf16 v[80:95], v[236:239], v[132:135], v[80:95]
  ds_read_b64_tr_b16 v[250:251], v10 offset:7168
  ds_read_b64_tr_b16 v[252:253], v11 offset:6144
  ds_read_b64_tr_b16 v[254:255], v11 offset:7168
  s_waitcnt vmcnt(11) lgkmcnt(6)
  v_mfma_f32_32x32x16_bf16 v[64:79], v[240:243], v[136:139], v[64:79]
  buffer_load_dwordx4 v[184:187], v3, s[4:7], s30 offen offset:2048
  ds_read_b64_tr_b16 v[224:225], v12 offset:0
  s_waitcnt lgkmcnt(5)
  v_mfma_f32_32x32x16_bf16 v[80:95], v[244:247], v[136:139], v[80:95]
  ds_read_b64_tr_b16 v[226:227], v12 offset:1024
  ds_read_b64_tr_b16 v[228:229], v13 offset:0
  ds_read_b64_tr_b16 v[230:231], v13 offset:1024
  s_waitcnt vmcnt(11) lgkmcnt(6)
  v_mfma_f32_32x32x16_bf16 v[64:79], v[248:251], v[140:143], v[64:79]
  buffer_load_dwordx4 v[188:191], v3, s[4:7], s30 offen offset:3072
  ds_read_b64_tr_b16 v[232:233], v12 offset:2048
  s_waitcnt lgkmcnt(5)
  v_mfma_f32_32x32x16_bf16 v[80:95], v[252:255], v[140:143], v[80:95]
  ds_read_b64_tr_b16 v[234:235], v12 offset:3072
  ds_read_b64_tr_b16 v[236:237], v13 offset:2048
  ds_read_b64_tr_b16 v[238:239], v13 offset:3072
  s_andn2_b32 s33, s36, s34
  s_cbranch_scc0 .fz_kernel_pk50c
.fz_kernel_pk50:
  s_ff1_i32_b32 s33, s33
  s_bitset1_b32 s34, s33
  s_lshl_b32 s26, s33, 13
  s_lshl_b32 s33, s33, 12
  s_add_u32 s30, s33, s35
  s_waitcnt vmcnt(11) lgkmcnt(6)
  v_mfma_f32_32x32x16_bf16 v[64:79], v[224:227], v[144:147], v[64:79]
  v_add_u32 v10, s24, v14
  v_add_u32 v11, s24, v15
  buffer_load_dwordx4 v[192:195], v3, s[4:7], s30 offen offset:0
  ds_read_b64_tr_b16 v[240:241], v12 offset:4096
  s_waitcnt lgkmcnt(5)
  v_mfma_f32_32x32x16_bf16 v[80:95], v[228:231], v[144:147], v[80:95]
  ds_read_b64_tr_b16 v[242:243], v12 offset:5120
  ds_read_b64_tr_b16 v[244:245], v13 offset:4096
  ds_read_b64_tr_b16 v[246:247], v13 offset:5120
  s_waitcnt vmcnt(11) lgkmcnt(6)
  v_mfma_f32_32x32x16_bf16 v[64:79], v[232:235], v[148:151], v[64:79]
  buffer_load_dwordx4 v[196:199], v3, s[4:7], s30 offen offset:1024
  ds_read_b64_tr_b16 v[248:249], v12 offset:6144
  s_waitcnt lgkmcnt(5)
  v_mfma_f32_32x32x16_bf16 v[80:95], v[236:239], v[148:151], v[80:95]
  ds_read_b64_tr_b16 v[250:251], v12 offset:7168
  ds_read_b64_tr_b16 v[252:253], v13 offset:6144
  ds_read_b64_tr_b16 v[254:255], v13 offset:7168
  s_waitcnt vmcnt(11) lgkmcnt(6)
  v_mfma_f32_32x32x16_bf16 v[64:79], v[240:243], v[152:155], v[64:79]
  buffer_load_dwordx4 v[200:203], v3, s[4:7], s30 offen offset:2048
  ds_read_b64_tr_b16 v[224:225], v10 offset:0
  s_waitcnt lgkmcnt(5)
  v_mfma_f32_32x32x16_bf16 v[80:95], v[244:247], v[152:155], v[80:95]
  ds_read_b64_tr_b16 v[226:227], v10 offset:1024
  ds_read_b64_tr_b16 v[228:229], v11 offset:0
  ds_read_b64_tr_b16 v[230:231], v11 offset:1024
  s_waitcnt vmcnt(11) lgkmcnt(6)
  v_mfma_f32_32x32x16_bf16 v[64:79], v[248:251], v[156:159], v[64:79]
  buffer_load_dwordx4 v[204:207], v3, s[4:7], s30 offen offset:3072
  ds_read_b64_tr_b16 v[232:233], v10 offset:2048
  s_waitcnt lgkmcnt(5)
  v_mfma_f32_32x32x16_bf16 v[80:95], v[252:255], v[156:159], v[80:95]
  ds_read_b64_tr_b16 v[234:235], v10 offset:3072
  ds_read_b64_tr_b16 v[236:237], v11 offset:2048
  ds_read_b64_tr_b16 v[238:239], v11 offset:3072
  s_andn2_b32 s33, s36, s34
  s_cbranch_scc0 .fz_kernel_pk51c
.fz_kernel_pk51:
  s_ff1_i32_b32 s33, s33
  s_bitset1_b32 s34, s33
  s_lshl_b32 s27, s33, 13
  s_lshl_b32 s33, s33, 12
  s_add_u32 s30, s33, s35
  s_waitcnt vmcnt(11) lgkmcnt(6)
  v_mfma_f32_32x32x16_bf16 v[64:79], v[224:227], v[160:163], v[64:79]
  v_add_u32 v12, s25, v14
  v_add_u32 v13, s25, v15
  buffer_load_dwordx4 v[208:211], v3, s[4:7], s30 offen offset:0
  ds_read_b64_tr_b16 v[240:241], v10 offset:4096
  s_waitcnt lgkmcnt(5)
  v_mfma_f32_32x32x16_bf16 v[80:95], v[228:231], v[160:163], v[80:95]
  ds_read_b64_tr_b16 v[242:243], v10 offset:5120
  ds_read_b64_tr_b16 v[244:245], v11 offset:4096
  ds_read_b64_tr_b16 v[246:247], v11 offset:5120
  s_waitcnt vmcnt(11) lgkmcnt(6)
  v_mfma_f32_32x32x16_bf16 v[64:79], v[232:235], v[164:167], v[64:79]
  buffer_load_dwordx4 v[212:215], v3, s[4:7], s30 offen offset:1024
  ds_read_b64_tr_b16 v[248:249], v10 offset:6144
  s_waitcnt lgkmcnt(5)
  v_mfma_f32_32x32x16_bf16 v[80:95], v[236:239], v[164:167], v[80:95]
  ds_read_b64_tr_b16 v[250:251], v10 offset:7168
  ds_read_b64_tr_b16 v[252:253], v11 offset:6144
  ds_read_b64_tr_b16 v[254:255], v11 offset:7168
  s_waitcnt vmcnt(11) lgkmcnt(6)
  v_mfma_f32_32x32x16_bf16 v[64:79], v[240:243], v[168:171], v[64:79]
  buffer_load_dwordx4 v[216:219], v3, s[4:7], s30 offen offset:2048
  ds_read_b64_tr_b16 v[224:225], v12 offset:0
  s_waitcnt lgkmcnt(5)
  v_mfma_f32_32x32x16_bf16 v[80:95], v[244:247], v[168:171], v[80:95]
  ds_read_b64_tr_b16 v[226:227], v12 offset:1024
  ds_read_b64_tr_b16 v[228:229], v13 offset:0
  ds_read_b64_tr_b16 v[230:231], v13 offset:1024
  s_waitcnt vmcnt(11) lgkmcnt(6)
  v_mfma_f32_32x32x16_bf16 v[64:79], v[248:251], v[172:175], v[64:79]
  buffer_load_dwordx4 v[220:223], v3, s[4:7], s30 offen offset:3072
  ds_read_b64_tr_b16 v[232:233], v12 offset:2048
  s_waitcnt lgkmcnt(5)
  v_mfma_f32_32x32x16_bf16 v[80:95], v[252:255], v[172:175], v[80:95]
  ds_read_b64_tr_b16 v[234:235], v12 offset:3072
  ds_read_b64_tr_b16 v[236:237], v13 offset:2048
  ds_read_b64_tr_b16 v[238:239], v13 offset:3072
  s_andn2_b32 s33, s36, s34
  s_cbranch_scc0 .fz_kernel_pk52c
.fz_kernel_pk52:
  s_ff1_i32_b32 s33, s33
  s_bitset1_b32 s34, s33
  s_lshl_b32 s20, s33, 13
  s_lshl_b32 s33, s33, 12
  s_add_u32 s30, s33, s35
  s_waitcnt vmcnt(11) lgkmcnt(6)
  v_mfma_f32_32x32x16_bf16 v[64:79], v[224:227], v[176:179], v[64:79]
  v_add_u32 v10, s26, v14
  v_add_u32 v11, s26, v15
  buffer_load_dwordx4 v[96:99], v3, s[4:7], s30 offen offset:0
  ds_read_b64_tr_b16 v[240:241], v12 offset:4096
  s_waitcnt lgkmcnt(5)
  v_mfma_f32_32x32x16_bf16 v[80:95], v[228:231], v[176:179], v[80:95]
  ds_read_b64_tr_b16 v[242:243], v12 offset:5120
  ds_read_b64_tr_b16 v[244:245], v13 offset:4096
  ds_read_b64_tr_b16 v[246:247], v13 offset:5120
  s_waitcnt vmcnt(11) lgkmcnt(6)
  v_mfma_f32_32x32x16_bf16 v[64:79], v[232:235], v[180:183], v[64:79]
  buffer_load_dwordx4 v[100:103], v3, s[4:7], s30 offen offset:1024
  ds_read_b64_tr_b16 v[248:249], v12 offset:6144
  s_waitcnt lgkmcnt(5)
  v_mfma_f32_32x32x16_bf16 v[80:95], v[236:239], v[180:183], v[80:95]
  ds_read_b64_tr_b16 v[250:251], v12 offset:7168
  ds_read_b64_tr_b16 v[252:253], v13 offset:6144
  ds_read_b64_tr_b16 v[254:255], v13 offset:7168
  s_waitcnt vmcnt(11) lgkmcnt(6)
  v_mfma_f32_32x32x16_bf16 v[64:79], v[240:243], v[184:187], v[64:79]
  buffer_load_dwordx4 v[104:107], v3, s[4:7], s30 offen offset:2048
  ds_read_b64_tr_b16 v[224:225], v10 offset:0
  s_waitcnt lgkmcnt(5)
  v_mfma_f32_32x32x16_bf16 v[80:95], v[244:247], v[184:187], v[80:95]
  ds_read_b64_tr_b16 v[226:227], v10 offset:1024
  ds_read_b64_tr_b16 v[228:229], v11 offset:0
  ds_read_b64_tr_b16 v[230:231], v11 offset:1024
  s_waitcnt vmcnt(11) lgkmcnt(6)
  v_mfma_f32_32x32x16_bf16 v[64:79], v[248:251], v[188:191], v[64:79]
  buffer_load_dwordx4 v[108:111], v3, s[4:7], s30 offen offset:3072
  ds_read_b64_tr_b16 v[232:233], v10 offset:2048
  s_waitcnt lgkmcnt(5)
  v_mfma_f32_32x32x16_bf16 v[80:95], v[252:255], v[188:191], v[80:95]
  ds_read_b64_tr_b16 v[234:235], v10 offset:3072
  ds_read_b64_tr_b16 v[236:237], v11 offset:2048
  ds_read_b64_tr_b16 v[238:239], v11 offset:3072
  s_andn2_b32 s33, s36, s34
  s_cbranch_scc0 .fz_kernel_pk53c
.fz_kernel_pk53:
  s_ff1_i32_b32 s33, s33
  s_bitset1_b32 s34, s33
  s_lshl_b32 s21, s33, 13
  s_lshl_b32 s33, s33, 12
  s_add_u32 s30, s33, s35
  s_waitcnt vmcnt(11) lgkmcnt(6)
  v_mfma_f32_32x32x16_bf16 v[64:79], v[224:227], v[192:195], v[64:79]
  v_add_u32 v12, s27, v14
  v_add_u32 v13, s27, v15
  buffer_load_dwordx4 v[112:115], v3, s[4:7], s30 offen offset:0
  ds_read_b64_tr_b16 v[240:241], v10 offset:4096
  s_waitcnt lgkmcnt(5)
  v_mfma_f32_32x32x16_bf16 v[80:95], v[228:231], v[192:195], v[80:95]
  ds_read_b64_tr_b16 v[242:243], v10 offset:5120
  ds_read_b64_tr_b16 v[244:245], v11 offset:4096
  ds_read_b64_tr_b16 v[246:247], v11 offset:5120
  s_waitcnt vmcnt(11) lgkmcnt(6)
  v_mfma_f32_32x32x16_bf16 v[64:79], v[232:235], v[196:199], v[64:79]
  buffer_load_dwordx4 v[116:119], v3, s[4:7], s30 offen offset:1024
  ds_read_b64_tr_b16 v[248:249], v10 offset:6144
  s_waitcnt lgkmcnt(5)
  v_mfma_f32_32x32x16_bf16 v[80:95], v[236:239], v[196:199], v[80:95]
  ds_read_b64_tr_b16 v[250:251], v10 offset:7168
  ds_read_b64_tr_b16 v[252:253], v11 offset:6144
  ds_read_b64_tr_b16 v[254:255], v11 offset:7168
  s_waitcnt vmcnt(11) lgkmcnt(6)
  v_mfma_f32_32x32x16_bf16 v[64:79], v[240:243], v[200:203], v[64:79]
  buffer_load_dwordx4 v[120:123], v3, s[4:7], s30 offen offset:2048
  ds_read_b64_tr_b16 v[224:225], v12 offset:0
  s_waitcnt lgkmcnt(5)
  v_mfma_f32_32x32x16_bf16 v[80:95], v[244:247], v[200:203], v[80:95]
  ds_read_b64_tr_b16 v[226:227], v12 offset:1024
  ds_read_b64_tr_b16 v[228:229], v13 offset:0
  ds_read_b64_tr_b16 v[230:231], v13 offset:1024
  s_waitcnt vmcnt(11) lgkmcnt(6)
  v_mfma_f32_32x32x16_bf16 v[64:79], v[248:251], v[204:207], v[64:79]
  buffer_load_dwordx4 v[124:127], v3, s[4:7], s30 offen offset:3072
  ds_read_b64_tr_b16 v[232:233], v12 offset:2048
  s_waitcnt lgkmcnt(5)
  v_mfma_f32_32x32x16_bf16 v[80:95], v[252:255], v[204:207], v[80:95]
  ds_read_b64_tr_b16 v[234:235], v12 offset:3072
  ds_read_b64_tr_b16 v[236:237], v13 offset:2048
  ds_read_b64_tr_b16 v[238:239], v13 offset:3072
  s_andn2_b32 s33, s36, s34
  s_cbranch_scc0 .fz_kernel_pk54c
.fz_kernel_pk54:
  s_ff1_i32_b32 s33, s33
  s_bitset1_b32 s34, s33
  s_lshl_b32 s22, s33, 13
  s_lshl_b32 s33, s33, 12
  s_add_u32 s30, s33, s35
  s_waitcnt vmcnt(11) lgkmcnt(6)
  v_mfma_f32_32x32x16_bf16 v[64:79], v[224:227], v[208:211], v[64:79]
  v_add_u32 v10, s20, v14
  v_add_u32 v11, s20, v15
  buffer_load_dwordx4 v[128:131], v3, s[4:7], s30 offen offset:0
  ds_read_b64_tr_b16 v[240:241], v12 offset:4096
  s_waitcnt lgkmcnt(5)
  v_mfma_f32_32x32x16_bf16 v[80:95], v[228:231], v[208:211], v[80:95]
  ds_read_b64_tr_b16 v[242:243], v12 offset:5120
  ds_read_b64_tr_b16 v[244:245], v13 offset:4096
  ds_read_b64_tr_b16 v[246:247], v13 offset:5120
  s_waitcnt vmcnt(11) lgkmcnt(6)
  v_mfma_f32_32x32x16_bf16 v[64:79], v[232:235], v[212:215], v[64:79]
  buffer_load_dwordx4 v[132:135], v3, s[4:7], s30 offen offset:1024
  ds_read_b64_tr_b16 v[248:249], v12 offset:6144
  s_waitcnt lgkmcnt(5)
  v_mfma_f32_32x32x16_bf16 v[80:95], v[236:239], v[212:215], v[80:95]
  ds_read_b64_tr_b16 v[250:251], v12 offset:7168
  ds_read_b64_tr_b16 v[252:253], v13 offset:6144
  ds_read_b64_tr_b16 v[254:255], v13 offset:7168
  s_waitcnt vmcnt(11) lgkmcnt(6)
  v_mfma_f32_32x32x16_bf16 v[64:79], v[240:243], v[216:219], v[64:79]
  buffer_load_dwordx4 v[136:139], v3, s[4:7], s30 offen offset:2048
  ds_read_b64_tr_b16 v[224:225], v10 offset:0
  s_waitcnt lgkmcnt(5)
  v_mfma_f32_32x32x16_bf16 v[80:95], v[244:247], v[216:219], v[80:95]
  ds_read_b64_tr_b16 v[226:227], v10 offset:1024
  ds_read_b64_tr_b16 v[228:229], v11 offset:0
  ds_read_b64_tr_b16 v[230:231], v11 offset:1024
  s_waitcnt vmcnt(11) lgkmcnt(6)
  v_mfma_f32_32x32x16_bf16 v[64:79], v[248:251], v[220:223], v[64:79]
  buffer_load_dwordx4 v[140:143], v3, s[4:7], s30 offen offset:3072
  ds_read_b64_tr_b16 v[232:233], v10 offset:2048
  s_waitcnt lgkmcnt(5)
  v_mfma_f32_32x32x16_bf16 v[80:95], v[252:255], v[220:223], v[80:95]
  ds_read_b64_tr_b16 v[234:235], v10 offset:3072
  ds_read_b64_tr_b16 v[236:237], v11 offset:2048
  ds_read_b64_tr_b16 v[238:239], v11 offset:3072
  s_andn2_b32 s33, s36, s34
  s_cbranch_scc0 .fz_kernel_pk55c
.fz_kernel_pk55:
  s_ff1_i32_b32 s33, s33
  s_bitset1_b32 s34, s33
  s_lshl_b32 s23, s33, 13
  s_lshl_b32 s33, s33, 12
  s_add_u32 s30, s33, s35
  s_waitcnt vmcnt(11) lgkmcnt(6)
  v_mfma_f32_32x32x16_bf16 v[64:79], v[224:227], v[96:99], v[64:79]
  v_add_u32 v12, s21, v14
  v_add_u32 v13, s21, v15
  buffer_load_dwordx4 v[144:147], v3, s[4:7], s30 offen offset:0
  ds_read_b64_tr_b16 v[240:241], v10 offset:4096
  s_waitcnt lgkmcnt(5)
  v_mfma_f32_32x32x16_bf16 v[80:95], v[228:231], v[96:99], v[80:95]
  ds_read_b64_tr_b16 v[242:243], v10 offset:5120
  ds_read_b64_tr_b16 v[244:245], v11 offset:4096
  ds_read_b64_tr_b16 v[246:247], v11 offset:5120
  s_waitcnt vmcnt(11) lgkmcnt(6)
  v_mfma_f32_32x32x16_bf16 v[64:79], v[232:235], v[100:103], v[64:79]
  buffer_load_dwordx4 v[148:151], v3, s[4:7], s30 offen offset:1024
  ds_read_b64_tr_b16 v[248:249], v10 offset:6144
  s_waitcnt lgkmcnt(5)
  v_mfma_f32_32x32x16_bf16 v[80:95], v[236:239], v[100:103], v[80:95]
  ds_read_b64_tr_b16 v[250:251], v10 offset:7168
  ds_read_b64_tr_b16 v[252:253], v11 offset:6144
  ds_read_b64_tr_b16 v[254:255], v11 offset:7168
  s_waitcnt vmcnt(11) lgkmcnt(6)
  v_mfma_f32_32x32x16_bf16 v[64:79], v[240:243], v[104:107], v[64:79]
  buffer_load_dwordx4 v[152:155], v3, s[4:7], s30 offen offset:2048
  ds_read_b64_tr_b16 v[224:225], v12 offset:0
  s_waitcnt lgkmcnt(5)
  v_mfma_f32_32x32x16_bf16 v[80:95], v[244:247], v[104:107], v[80:95]
  ds_read_b64_tr_b16 v[226:227], v12 offset:1024
  ds_read_b64_tr_b16 v[228:229], v13 offset:0
  ds_read_b64_tr_b16 v[230:231], v13 offset:1024
  s_waitcnt vmcnt(11) lgkmcnt(6)
  v_mfma_f32_32x32x16_bf16 v[64:79], v[248:251], v[108:111], v[64:79]
  buffer_load_dwordx4 v[156:159], v3, s[4:7], s30 offen offset:3072
  ds_read_b64_tr_b16 v[232:233], v12 offset:2048
  s_waitcnt lgkmcnt(5)
  v_mfma_f32_32x32x16_bf16 v[80:95], v[252:255], v[108:111], v[80:95]
  ds_read_b64_tr_b16 v[234:235], v12 offset:3072
  ds_read_b64_tr_b16 v[236:237], v13 offset:2048
  ds_read_b64_tr_b16 v[238:239], v13 offset:3072
  s_andn2_b32 s33, s36, s34
  s_cbranch_scc0 .fz_kernel_pk56c
.fz_kernel_pk56:
  s_ff1_i32_b32 s33, s33
  s_bitset1_b32 s34, s33
  s_lshl_b32 s24, s33, 13
  s_lshl_b32 s33, s33, 12
  s_add_u32 s30, s33, s35
  s_waitcnt vmcnt(11) lgkmcnt(6)
  v_mfma_f32_32x32x16_bf16 v[64:79], v[224:227], v[112:115], v[64:79]
  v_add_u32 v10, s22, v14
  v_add_u32 v11, s22, v15
  buffer_load_dwordx4 v[160:163], v3, s[4:7], s30 offen offset:0
  ds_read_b64_tr_b16 v[240:241], v12 offset:4096
  s_waitcnt lgkmcnt(5)
  v_mfma_f32_32x32x16_bf16 v[80:95], v[228:231], v[112:115], v[80:95]
  ds_read_b64_tr_b16 v[242:243], v12 offset:5120
  ds_read_b64_tr_b16 v[244:245], v13 offset:4096
  ds_read_b64_tr_b16 v[246:247], v13 offset:5120
  s_waitcnt vmcnt(11) lgkmcnt(6)
  v_mfma_f32_32x32x16_bf16 v[64:79], v[232:235], v[116:119], v[64:79]
  buffer_load_dwordx4 v[164:167], v3, s[4:7], s30 offen offset:1024
  ds_read_b64_tr_b16 v[248:249], v12 offset:6144
  s_waitcnt lgkmcnt(5)
  v_mfma_f32_32x32x16_bf16 v[80:95], v[236:239], v[116:119], v[80:95]
  ds_read_b64_tr_b16 v[250:251], v12 offset:7168
  ds_read_b64_tr_b16 v[252:253], v13 offset:6144
  ds_read_b64_tr_b16 v[254:255], v13 offset:7168
  s_waitcnt vmcnt(11) lgkmcnt(6)
  v_mfma_f32_32x32x16_bf16 v[64:79], v[240:243], v[120:123], v[64:79]
  buffer_load_dwordx4 v[168:171], v3, s[4:7], s30 offen offset:2048
  ds_read_b64_tr_b16 v[224:225], v10 offset:0
  s_waitcnt lgkmcnt(5)
  v_mfma_f32_32x32x16_bf16 v[80:95], v[244:247], v[120:123], v[80:95]
  ds_read_b64_tr_b16 v[226:227], v10 offset:1024
  ds_read_b64_tr_b16 v[228:229], v11 offset:0
  ds_read_b64_tr_b16 v[230:231], v11 offset:1024
  s_waitcnt vmcnt(11) lgkmcnt(6)
  v_mfma_f32_32x32x16_bf16 v[64:79], v[248:251], v[124:127], v[64:79]
  buffer_load_dwordx4 v[172:175], v3, s[4:7], s30 offen offset:3072
  ds_read_b64_tr_b16 v[232:233], v10 offset:2048
  s_waitcnt lgkmcnt(5)
  v_mfma_f32_32x32x16_bf16 v[80:95], v[252:255], v[124:127], v[80:95]
  ds_read_b64_tr_b16 v[234:235], v10 offset:3072
  ds_read_b64_tr_b16 v[236:237], v11 offset:2048
  ds_read_b64_tr_b16 v[238:239], v11 offset:3072
  s_andn2_b32 s33, s36, s34
  s_cbranch_scc0 .fz_kernel_pk57c
.fz_kernel_pk57:
  s_ff1_i32_b32 s33, s33
  s_bitset1_b32 s34, s33
  s_lshl_b32 s25, s33, 13
  s_lshl_b32 s33, s33, 12
  s_add_u32 s30, s33, s35
  s_waitcnt vmcnt(11) lgkmcnt(6)
  v_mfma_f32_32x32x16_bf16 v[64:79], v[224:227], v[128:131], v[64:79]
  v_add_u32 v12, s23, v14
  v_add_u32 v13, s23, v15
  buffer_load_dwordx4 v[176:179], v3, s[4:7], s30 offen offset:0
  ds_read_b64_tr_b16 v[240:241], v10 offset:4096
  s_waitcnt lgkmcnt(5)
  v_mfma_f32_32x32x16_bf16 v[80:95], v[228:231], v[128:131], v[80:95]
  ds_read_b64_tr_b16 v[242:243], v10 offset:5120
  ds_read_b64_tr_b16 v[244:245], v11 offset:4096
  ds_read_b64_tr_b16 v[246:247], v11 offset:5120
  s_waitcnt vmcnt(11) lgkmcnt(6)
  v_mfma_f32_32x32x16_bf16 v[64:79], v[232:235], v[132:135], v[64:79]
  buffer_load_dwordx4 v[180:183], v3, s[4:7], s30 offen offset:1024
  ds_read_b64_tr_b16 v[248:249], v10 offset:6144
  s_waitcnt lgkmcnt(5)
  v_mfma_f32_32x32x16_bf16 v[80:95], v[236:239], v[132:135], v[80:95]
  ds_read_b64_tr_b16 v[250:251], v10 offset:7168
  ds_read_b64_tr_b16 v[252:253], v11 offset:6144
  ds_read_b64_tr_b16 v[254:255], v11 offset:7168
  s_waitcnt vmcnt(11) lgkmcnt(6)
  v_mfma_f32_32x32x16_bf16 v[64:79], v[240:243], v[136:139], v[64:79]
  buffer_load_dwordx4 v[184:187], v3, s[4:7], s30 offen offset:2048
  ds_read_b64_tr_b16 v[224:225], v12 offset:0
  s_waitcnt lgkmcnt(5)
  v_mfma_f32_32x32x16_bf16 v[80:95], v[244:247], v[136:139], v[80:95]
  ds_read_b64_tr_b16 v[226:227], v12 offset:1024
  ds_read_b64_tr_b16 v[228:229], v13 offset:0
  ds_read_b64_tr_b16 v[230:231], v13 offset:1024
  s_waitcnt vmcnt(11) lgkmcnt(6)
  v_mfma_f32_32x32x16_bf16 v[64:79], v[248:251], v[140:143], v[64:79]
  buffer_load_dwordx4 v[188:191], v3, s[4:7], s30 offen offset:3072
  ds_read_b64_tr_b16 v[232:233], v12 offset:2048
  s_waitcnt lgkmcnt(5)
  v_mfma_f32_32x32x16_bf16 v[80:95], v[252:255], v[140:143], v[80:95]
  ds_read_b64_tr_b16 v[234:235], v12 offset:3072
  ds_read_b64_tr_b16 v[236:237], v13 offset:2048
  ds_read_b64_tr_b16 v[238:239], v13 offset:3072
  s_andn2_b32 s33, s36, s34
  s_cbranch_scc0 .fz_kernel_pk58c
.fz_kernel_pk58:
  s_ff1_i32_b32 s33, s33
  s_bitset1_b32 s34, s33
  s_lshl_b32 s26, s33, 13
  s_lshl_b32 s33, s33, 12
  s_add_u32 s30, s33, s35
  s_waitcnt vmcnt(11) lgkmcnt(6)
  v_mfma_f32_32x32x16_bf16 v[64:79], v[224:227], v[144:147], v[64:79]
  v_add_u32 v10, s24, v14
  v_add_u32 v11, s24, v15
  buffer_load_dwordx4 v[192:195], v3, s[4:7], s30 offen offset:0
  ds_read_b64_tr_b16 v[240:241], v12 offset:4096
  s_waitcnt lgkmcnt(5)
  v_mfma_f32_32x32x16_bf16 v[80:95], v[228:231], v[144:147], v[80:95]
  ds_read_b64_tr_b16 v[242:243], v12 offset:5120
  ds_read_b64_tr_b16 v[244:245], v13 offset:4096
  ds_read_b64_tr_b16 v[246:247], v13 offset:5120
  s_waitcnt vmcnt(11) lgkmcnt(6)
  v_mfma_f32_32x32x16_bf16 v[64:79], v[232:235], v[148:151], v[64:79]
  buffer_load_dwordx4 v[196:199], v3, s[4:7], s30 offen offset:1024
  ds_read_b64_tr_b16 v[248:249], v12 offset:6144
  s_waitcnt lgkmcnt(5)
  v_mfma_f32_32x32x16_bf16 v[80:95], v[236:239], v[148:151], v[80:95]
  ds_read_b64_tr_b16 v[250:251], v12 offset:7168
  ds_read_b64_tr_b16 v[252:253], v13 offset:6144
  ds_read_b64_tr_b16 v[254:255], v13 offset:7168
  s_waitcnt vmcnt(11) lgkmcnt(6)
  v_mfma_f32_32x32x16_bf16 v[64:79], v[240:243], v[152:155], v[64:79]
  buffer_load_dwordx4 v[200:203], v3, s[4:7], s30 offen offset:2048
  ds_read_b64_tr_b16 v[224:225], v10 offset:0
  s_waitcnt lgkmcnt(5)
  v_mfma_f32_32x32x16_bf16 v[80:95], v[244:247], v[152:155], v[80:95]
  ds_read_b64_tr_b16 v[226:227], v10 offset:1024
  ds_read_b64_tr_b16 v[228:229], v11 offset:0
  ds_read_b64_tr_b16 v[230:231], v11 offset:1024
  s_waitcnt vmcnt(11) lgkmcnt(6)
  v_mfma_f32_32x32x16_bf16 v[64:79], v[248:251], v[156:159], v[64:79]
  buffer_load_dwordx4 v[204:207], v3, s[4:7], s30 offen offset:3072
  ds_read_b64_tr_b16 v[232:233], v10 offset:2048
  s_waitcnt lgkmcnt(5)
  v_mfma_f32_32x32x16_bf16 v[80:95], v[252:255], v[156:159], v[80:95]
  ds_read_b64_tr_b16 v[234:235], v10 offset:3072
  ds_read_b64_tr_b16 v[236:237], v11 offset:2048
  ds_read_b64_tr_b16 v[238:239], v11 offset:3072
  s_andn2_b32 s33, s36, s34
  s_cbranch_scc0 .fz_kernel_pk59c
.fz_kernel_pk59:
  s_ff1_i32_b32 s33, s33
  s_bitset1_b32 s34, s33
  s_lshl_b32 s27, s33, 13
  s_lshl_b32 s33, s33, 12
  s_add_u32 s30, s33, s35
  s_waitcnt vmcnt(11) lgkmcnt(6)
  v_mfma_f32_32x32x16_bf16 v[64:79], v[224:227], v[160:163], v[64:79]
  v_add_u32 v12, s25, v14
  v_add_u32 v13, s25, v15
  buffer_load_dwordx4 v[208:211], v3, s[4:7], s30 offen offset:0
  ds_read_b64_tr_b16 v[240:241], v10 offset:4096
  s_waitcnt lgkmcnt(5)
  v_mfma_f32_32x32x16_bf16 v[80:95], v[228:231], v[160:163], v[80:95]
  ds_read_b64_tr_b16 v[242:243], v10 offset:5120
  ds_read_b64_tr_b16 v[244:245], v11 offset:4096
  ds_read_b64_tr_b16 v[246:247], v11 offset:5120
  s_waitcnt vmcnt(11) lgkmcnt(6)
  v_mfma_f32_32x32x16_bf16 v[64:79], v[232:235], v[164:167], v[64:79]
  buffer_load_dwordx4 v[212:215], v3, s[4:7], s30 offen offset:1024
  ds_read_b64_tr_b16 v[248:249], v10 offset:6144
  s_waitcnt lgkmcnt(5)
  v_mfma_f32_32x32x16_bf16 v[80:95], v[236:239], v[164:167], v[80:95]
  ds_read_b64_tr_b16 v[250:251], v10 offset:7168
  ds_read_b64_tr_b16 v[252:253], v11 offset:6144
  ds_read_b64_tr_b16 v[254:255], v11 offset:7168
  s_waitcnt vmcnt(11) lgkmcnt(6)
  v_mfma_f32_32x32x16_bf16 v[64:79], v[240:243], v[168:171], v[64:79]
  buffer_load_dwordx4 v[216:219], v3, s[4:7], s30 offen offset:2048
  ds_read_b64_tr_b16 v[224:225], v12 offset:0
  s_waitcnt lgkmcnt(5)
  v_mfma_f32_32x32x16_bf16 v[80:95], v[244:247], v[168:171], v[80:95]
  ds_read_b64_tr_b16 v[226:227], v12 offset:1024
  ds_read_b64_tr_b16 v[228:229], v13 offset:0
  ds_read_b64_tr_b16 v[230:231], v13 offset:1024
  s_waitcnt vmcnt(11) lgkmcnt(6)
  v_mfma_f32_32x32x16_bf16 v[64:79], v[248:251], v[172:175], v[64:79]
  buffer_load_dwordx4 v[220:223], v3, s[4:7], s30 offen offset:3072
  ds_read_b64_tr_b16 v[232:233], v12 offset:2048
  s_waitcnt lgkmcnt(5)
  v_mfma_f32_32x32x16_bf16 v[80:95], v[252:255], v[172:175], v[80:95]
  ds_read_b64_tr_b16 v[234:235], v12 offset:3072
  ds_read_b64_tr_b16 v[236:237], v13 offset:2048
  ds_read_b64_tr_b16 v[238:239], v13 offset:3072
  s_waitcnt vmcnt(11) lgkmcnt(6)
  v_mfma_f32_32x32x16_bf16 v[64:79], v[224:227], v[176:179], v[64:79]
  v_add_u32 v10, s26, v14
  v_add_u32 v11, s26, v15
  ds_read_b64_tr_b16 v[240:241], v12 offset:4096
  s_waitcnt lgkmcnt(5)
  v_mfma_f32_32x32x16_bf16 v[80:95], v[228:231], v[176:179], v[80:95]
  ds_read_b64_tr_b16 v[242:243], v12 offset:5120
  ds_read_b64_tr_b16 v[244:245], v13 offset:4096
  ds_read_b64_tr_b16 v[246:247], v13 offset:5120
  s_waitcnt vmcnt(10) lgkmcnt(6)
  v_mfma_f32_32x32x16_bf16 v[64:79], v[232:235], v[180:183], v[64:79]
  ds_read_b64_tr_b16 v[248:249], v12 offset:6144
  s_waitcnt lgkmcnt(5)
  v_mfma_f32_32x32x16_bf16 v[80:95], v[236:239], v[180:183], v[80:95]
  ds_read_b64_tr_b16 v[250:251], v12 offset:7168
  ds_read_b64_tr_b16 v[252:253], v13 offset:6144
  ds_read_b64_tr_b16 v[254:255], v13 offset:7168
  s_waitcnt vmcnt(9) lgkmcnt(6)
  v_mfma_f32_32x32x16_bf16 v[64:79], v[240:243], v[184:187], v[64:79]
  ds_read_b64_tr_b16 v[224:225], v10 offset:0
  s_waitcnt lgkmcnt(5)
  v_mfma_f32_32x32x16_bf16 v[80:95], v[244:247], v[184:187], v[80:95]
  ds_read_b64_tr_b16 v[226:227], v10 offset:1024
  ds_read_b64_tr_b16 v[228:229], v11 offset:0
  ds_read_b64_tr_b16 v[230:231], v11 offset:1024
  s_waitcnt vmcnt(8) lgkmcnt(6)
  v_mfma_f32_32x32x16_bf16 v[64:79], v[248:251], v[188:191], v[64:79]
  ds_read_b64_tr_b16 v[232:233], v10 offset:2048
  s_waitcnt lgkmcnt(5)
  v_mfma_f32_32x32x16_bf16 v[80:95], v[252:255], v[188:191], v[80:95]
  ds_read_b64_tr_b16 v[234:235], v10 offset:3072
  ds_read_b64_tr_b16 v[236:237], v11 offset:2048
  ds_read_b64_tr_b16 v[238:239], v11 offset:3072
  s_waitcnt vmcnt(7) lgkmcnt(6)
  v_mfma_f32_32x32x16_bf16 v[64:79], v[224:227], v[192:195], v[64:79]
  v_add_u32 v12, s27, v14
  v_add_u32 v13, s27, v15
  ds_read_b64_tr_b16 v[240:241], v10 offset:4096
  s_waitcnt lgkmcnt(5)
  v_mfma_f32_32x32x16_bf16 v[80:95], v[228:231], v[192:195], v[80:95]
  ds_read_b64_tr_b16 v[242:243], v10 offset:5120
  ds_read_b64_tr_b16 v[244:245], v11 offset:4096
  ds_read_b64_tr_b16 v[246:247], v11 offset:5120
  s_waitcnt vmcnt(6) lgkmcnt(6)
  v_mfma_f32_32x32x16_bf16 v[64:79], v[232:235], v[196:199], v[64:79]
  ds_read_b64_tr_b16 v[248:249], v10 offset:6144
  s_waitcnt lgkmcnt(5)
  v_mfma_f32_32x32x16_bf16 v[80:95], v[236:239], v[196:199], v[80:95]
  ds_read_b64_tr_b16 v[250:251], v10 offset:7168
  ds_read_b64_tr_b16 v[252:253], v11 offset:6144
  ds_read_b64_tr_b16 v[254:255], v11 offset:7168
  s_waitcnt vmcnt(5) lgkmcnt(6)
  v_mfma_f32_32x32x16_bf16 v[64:79], v[240:243], v[200:203], v[64:79]
  ds_read_b64_tr_b16 v[224:225], v12 offset:0
  s_waitcnt lgkmcnt(5)
  v_mfma_f32_32x32x16_bf16 v[80:95], v[244:247], v[200:203], v[80:95]
  ds_read_b64_tr_b16 v[226:227], v12 offset:1024
  ds_read_b64_tr_b16 v[228:229], v13 offset:0
  ds_read_b64_tr_b16 v[230:231], v13 offset:1024
  s_waitcnt vmcnt(4) lgkmcnt(6)
  v_mfma_f32_32x32x16_bf16 v[64:79], v[248:251], v[204:207], v[64:79]
  ds_read_b64_tr_b16 v[232:233], v12 offset:2048
  s_waitcnt lgkmcnt(5)
  v_mfma_f32_32x32x16_bf16 v[80:95], v[252:255], v[204:207], v[80:95]
  ds_read_b64_tr_b16 v[234:235], v12 offset:3072
  ds_read_b64_tr_b16 v[236:237], v13 offset:2048
  ds_read_b64_tr_b16 v[238:239], v13 offset:3072
  s_waitcnt vmcnt(3) lgkmcnt(6)
  v_mfma_f32_32x32x16_bf16 v[64:79], v[224:227], v[208:211], v[64:79]
  ds_read_b64_tr_b16 v[240:241], v12 offset:4096
  s_waitcnt lgkmcnt(5)
  v_mfma_f32_32x32x16_bf16 v[80:95], v[228:231], v[208:211], v[80:95]
  ds_read_b64_tr_b16 v[242:243], v12 offset:5120
  ds_read_b64_tr_b16 v[244:245], v13 offset:4096
  ds_read_b64_tr_b16 v[246:247], v13 offset:5120
  s_waitcnt vmcnt(2) lgkmcnt(6)
  v_mfma_f32_32x32x16_bf16 v[64:79], v[232:235], v[212:215], v[64:79]
  ds_read_b64_tr_b16 v[248:249], v12 offset:6144
  s_waitcnt lgkmcnt(5)
  v_mfma_f32_32x32x16_bf16 v[80:95], v[236:239], v[212:215], v[80:95]
  ds_read_b64_tr_b16 v[250:251], v12 offset:7168
  ds_read_b64_tr_b16 v[252:253], v13 offset:6144
  ds_read_b64_tr_b16 v[254:255], v13 offset:7168
  s_waitcnt vmcnt(1) lgkmcnt(6)
  v_mfma_f32_32x32x16_bf16 v[64:79], v[240:243], v[216:219], v[64:79]
  s_waitcnt lgkmcnt(4)
  v_mfma_f32_32x32x16_bf16 v[80:95], v[244:247], v[216:219], v[80:95]
  s_waitcnt vmcnt(0) lgkmcnt(0)
  v_mfma_f32_32x32x16_bf16 v[64:79], v[248:251], v[220:223], v[64:79]
  v_mfma_f32_32x32x16_bf16 v[80:95], v[252:255], v[220:223], v[80:95]
  s_mov_b32 s36, 0x3f803f80
  v_mov_b32 v8, 0
  v_mov_b32 v9, 0
  v_mov_b32 v10, 0
  v_mov_b32 v11, 0
  v_mov_b32 v12, 0
  v_mov_b32 v13, 0
  v_lshlrev_b32 v19, 2, v18
  v_lshl_add_u32 v19, v17, 13, v19
  s_lshl_b32 s34, s32, 7
  s_add_u32 s34, s34, s66
  s_add_u32 s34, s34, 16384
  s_add_u32 s37, s34, 16384
  v_cvt_pk_bf16_f32 v20, v64, v65
  v_cvt_pk_bf16_f32 v21, v66, v67
  v_cvt_pk_bf16_f32 v22, v68, v69
  v_cvt_pk_bf16_f32 v23, v70, v71
  buffer_store_dwordx4 v[20:23], v16, s[4:7], s39 offen offset:0 sc1
  v_cvt_pk_bf16_f32 v24, v72, v73
  v_cvt_pk_bf16_f32 v25, v74, v75
  v_cvt_pk_bf16_f32 v26, v76, v77
  v_cvt_pk_bf16_f32 v27, v78, v79
  buffer_store_dwordx4 v[24:27], v16, s[4:7], s39 offen offset:512 sc1
  v_cvt_pk_bf16_f32 v28, v80, v81
  v_cvt_pk_bf16_f32 v29, v82, v83
  v_cvt_pk_bf16_f32 v30, v84, v85
  v_cvt_pk_bf16_f32 v31, v86, v87
  buffer_store_dwordx4 v[28:31], v16, s[4:7], s39 offen offset:1024 sc1
  v_cvt_pk_bf16_f32 v32, v88, v89
  v_cvt_pk_bf16_f32 v33, v90, v91
  v_cvt_pk_bf16_f32 v34, v92, v93
  v_cvt_pk_bf16_f32 v35, v94, v95
  buffer_store_dwordx4 v[32:35], v16, s[4:7], s39 offen offset:1536 sc1
  v_dot2c_f32_bf16 v8, s36, v20
  v_dot2c_f32_bf16 v9, v20, v20
  v_dot2c_f32_bf16 v10, v20, v48
  v_dot2c_f32_bf16 v11, s36, v21
  v_dot2c_f32_bf16 v12, v21, v21
  v_dot2c_f32_bf16 v13, v21, v49
  v_dot2c_f32_bf16 v8, s36, v22
  v_dot2c_f32_bf16 v9, v22, v22
  v_dot2c_f32_bf16 v10, v22, v50
  v_dot2c_f32_bf16 v11, s36, v23
  v_dot2c_f32_bf16 v12, v23, v23
  v_dot2c_f32_bf16 v13, v23, v51
  v_dot2c_f32_bf16 v8, s36, v24
  v_dot2c_f32_bf16 v9, v24, v24
  v_dot2c_f32_bf16 v10, v24, v52
  v_dot2c_f32_bf16 v11, s36, v25
  v_dot2c_f32_bf16 v12, v25, v25
  v_dot2c_f32_bf16 v13, v25, v53
  v_dot2c_f32_bf16 v8, s36, v26
  v_dot2c_f32_bf16 v9, v26, v26
  v_dot2c_f32_bf16 v10, v26, v54
  v_dot2c_f32_bf16 v11, s36, v27
  v_dot2c_f32_bf16 v12, v27, v27
  v_dot2c_f32_bf16 v13, v27, v55
  v_dot2c_f32_bf16 v8, s36, v28
  v_dot2c_f32_bf16 v9, v28, v28
  v_dot2c_f32_bf16 v10, v28, v56
  v_dot2c_f32_bf16 v11, s36, v29
  v_dot2c_f32_bf16 v12, v29, v29
  v_dot2c_f32_bf16 v13, v29, v57
  v_dot2c_f32_bf16 v8, s36, v30
  v_dot2c_f32_bf16 v9, v30, v30
  v_dot2c_f32_bf16 v10, v30, v58
  v_dot2c_f32_bf16 v11, s36, v31
  v_dot2c_f32_bf16 v12, v31, v31
  v_dot2c_f32_bf16 v13, v31, v59
  v_dot2c_f32_bf16 v8, s36, v32
  v_dot2c_f32_bf16 v9, v32, v32
  v_dot2c_f32_bf16 v10, v32, v60
  v_dot2c_f32_bf16 v11, s36, v33
  v_dot2c_f32_bf16 v12, v33, v33
  v_dot2c_f32_bf16 v13, v33, v61
  v_dot2c_f32_bf16 v8, s36, v34
  v_dot2c_f32_bf16 v9, v34, v34
  v_dot2c_f32_bf16 v10, v34, v62
  v_dot2c_f32_bf16 v11, s36, v35
  v_dot2c_f32_bf16 v12, v35, v35
  v_dot2c_f32_bf16 v13, v35, v63
  s_nop 0
  v_add_f32 v36, v8, v11
  v_add_f32 v37, v9, v12
  v_add_f32 v38, v10, v13
  v_fma_f32 v38, -v36, v46, v38
  v_fmac_f32 v47, 0x44800000, v37
  v_mov_b32 v39, v38
  s_nop 0
  v_permlane32_swap_b32 v36, v47
  v_permlane32_swap_b32 v38, v39
  v_add_f32 v36, v36, v47
  v_add_f32 v38, v38, v39
  buffer_atomic_add_f32 v36, v19, s[4:7], s34 offen sc1
  s_mov_b32 exec_hi, 0
  buffer_atomic_add_f32 v38, v19, s[4:7], s37 offen sc1
  s_mov_b64 exec, -1
  s_barrier
  v_add_u32 v1, 4, v6
  s_mov_b32 s72, s66
  s_mov_b32 s73, s65
  s_mov_b32 s74, s67
  s_mov_b32 s75, s62
  s_cmp_lg_u32 s62, 0
  s_cbranch_scc1 .fz_kernel_tail
  s_mov_b32 s62, 1
  s_mov_b32 s63, 0x2000000
  s_mov_b32 s64, 0x2800000
  s_mov_b32 s65, 0x1400000
  s_mov_b32 s66, 0x1c42000
  s_mov_b32 s67, 12
  s_mov_b32 s71, 159776
  v_mov_b32 v6, 159832
  s_branch .fz_kernel_q_cons2
.fz_kernel_tail:
  s_mov_b32 s28, s56
  s_mov_b32 s29, s57
  s_mov_b32 s30, 0x400000
  s_mov_b32 s31, 0x00020000
  v_lshlrev_b32 v37, 2, v45
  v_add_u32 v37, 155644, v37
  v_mov_b32 v36, 159952
  v_lshlrev_b32 v38, 11, v18
  v_lshl_add_u32 v38, v17, 4, v38
  s_lshl_b32 s32, s32, 16
  s_lshl_b32 s33, s18, 7
  s_add_u32 s32, s32, s33
  v_lshlrev_b32 v64, 16, v20
  v_and_b32 v65, 0xffff0000, v20
  v_lshlrev_b32 v66, 16, v21
  v_and_b32 v67, 0xffff0000, v21
  v_lshlrev_b32 v68, 16, v22
  v_and_b32 v69, 0xffff0000, v22
  v_lshlrev_b32 v70, 16, v23
  v_and_b32 v71, 0xffff0000, v23
  v_lshlrev_b32 v72, 16, v24
  v_and_b32 v73, 0xffff0000, v24
  v_lshlrev_b32 v74, 16, v25
  v_and_b32 v75, 0xffff0000, v25
  v_lshlrev_b32 v76, 16, v26
  v_and_b32 v77, 0xffff0000, v26
  v_lshlrev_b32 v78, 16, v27
  v_and_b32 v79, 0xffff0000, v27
  v_lshlrev_b32 v80, 16, v28
  v_and_b32 v81, 0xffff0000, v28
  v_lshlrev_b32 v82, 16, v29
  v_and_b32 v83, 0xffff0000, v29
  v_lshlrev_b32 v84, 16, v30
  v_and_b32 v85, 0xffff0000, v30
  v_lshlrev_b32 v86, 16, v31
  v_and_b32 v87, 0xffff0000, v31
  v_lshlrev_b32 v88, 16, v32
  v_and_b32 v89, 0xffff0000, v32
  v_lshlrev_b32 v90, 16, v33
  v_and_b32 v91, 0xffff0000, v33
  v_lshlrev_b32 v92, 16, v34
  v_and_b32 v93, 0xffff0000, v34
  v_lshlrev_b32 v94, 16, v35
  v_and_b32 v95, 0xffff0000, v35
  s_mov_b64 exec, 1
  s_waitcnt vmcnt(0)
  ds_add_u32 v1, v5 offset:0x100
  s_mov_b64 exec, -1
  s_barrier
  ds_read_b32 v40, v37 offset:6400
  ds_read_b32 v42, v37 offset:6912
  ds_read_b32 v36, v36
  s_waitcnt lgkmcnt(0)
  v_cmp_ne_u32 vcc, v36, v45
  s_mov_b64 exec, vcc
  v_pk_fma_f32 v[64:65], v[64:65], v[40:41], v[42:43] op_sel_hi:[1,0,0]
  v_pk_fma_f32 v[66:67], v[66:67], v[40:41], v[42:43] op_sel_hi:[1,0,0]
  v_pk_fma_f32 v[68:69], v[68:69], v[40:41], v[42:43] op_sel_hi:[1,0,0]
  v_pk_fma_f32 v[70:71], v[70:71], v[40:41], v[42:43] op_sel_hi:[1,0,0]
  v_cvt_pk_bf16_f32 v20, v64, v65
  v_cvt_pk_bf16_f32 v21, v66, v67
  v_cvt_pk_bf16_f32 v22, v68, v69
  v_cvt_pk_bf16_f32 v23, v70, v71
  buffer_store_dwordx4 v[20:23], v38, s[28:31], s32 offen offset:0
  v_pk_fma_f32 v[72:73], v[72:73], v[40:41], v[42:43] op_sel_hi:[1,0,0]
  v_pk_fma_f32 v[74:75], v[74:75], v[40:41], v[42:43] op_sel_hi:[1,0,0]
  v_pk_fma_f32 v[76:77], v[76:77], v[40:41], v[42:43] op_sel_hi:[1,0,0]
  v_pk_fma_f32 v[78:79], v[78:79], v[40:41], v[42:43] op_sel_hi:[1,0,0]
  v_cvt_pk_bf16_f32 v24, v72, v73
  v_cvt_pk_bf16_f32 v25, v74, v75
  v_cvt_pk_bf16_f32 v26, v76, v77
  v_cvt_pk_bf16_f32 v27, v78, v79
  buffer_store_dwordx4 v[24:27], v38, s[28:31], s32 offen offset:32
  v_pk_fma_f32 v[80:81], v[80:81], v[40:41], v[42:43] op_sel_hi:[1,0,0]
  v_pk_fma_f32 v[82:83], v[82:83], v[40:41], v[42:43] op_sel_hi:[1,0,0]
  v_pk_fma_f32 v[84:85], v[84:85], v[40:41], v[42:43] op_sel_hi:[1,0,0]
  v_pk_fma_f32 v[86:87], v[86:87], v[40:41], v[42:43] op_sel_hi:[1,0,0]
  v_cvt_pk_bf16_f32 v28, v80, v81
  v_cvt_pk_bf16_f32 v29, v82, v83
  v_cvt_pk_bf16_f32 v30, v84, v85
  v_cvt_pk_bf16_f32 v31, v86, v87
  buffer_store_dwordx4 v[28:31], v38, s[28:31], s32 offen offset:64
  v_pk_fma_f32 v[88:89], v[88:89], v[40:41], v[42:43] op_sel_hi:[1,0,0]
  v_pk_fma_f32 v[90:91], v[90:91], v[40:41], v[42:43] op_sel_hi:[1,0,0]
  v_pk_fma_f32 v[92:93], v[92:93], v[40:41], v[42:43] op_sel_hi:[1,0,0]
  v_pk_fma_f32 v[94:95], v[94:95], v[40:41], v[42:43] op_sel_hi:[1,0,0]
  v_cvt_pk_bf16_f32 v32, v88, v89
  v_cvt_pk_bf16_f32 v33, v90, v91
  v_cvt_pk_bf16_f32 v34, v92, v93
  v_cvt_pk_bf16_f32 v35, v94, v95
  buffer_store_dwordx4 v[32:35], v38, s[28:31], s32 offen offset:96
  s_mov_b64 exec, -1
  s_branch .fz_kernel_fin
.fz_kernel_chain:
  s_setprio 0
  s_bitcmp1_b32 s18, 0
  s_cselect_b32 s8, s52, s50
  s_cselect_b32 s9, s53, s51
  s_mov_b32 s10, 0x700000
  s_mov_b32 s11, 0x00020000
  s_lshl_b32 s12, s16, 8
  s_and_b32 s12, s12, 511
  s_and_b32 s31, s18, 2
  s_lshl_b32 s31, s31, 8
  s_add_u32 s12, s12, s31
  s_mul_i32 s12, s12, 7168
  s_lshl_b32 s31, s17, 2
  s_lshr_b32 s33, s18, 2
  s_add_u32 s31, s31, s33
  s_lshl_b32 s31, s31, 7
  s_add_u32 s12, s12, s31
  v_lshrrev_b32 v13, 3, v2
  v_mul_u32_u24 v13, 229376, v13
  v_and_b32 v11, 7, v2
  v_lshl_add_u32 v13, v11, 4, v13
  s_mov_b32 s24, s44
  s_mov_b32 s25, s45
  s_mov_b32 s26, 0x200000
  s_mov_b32 s27, 0x00020000
  v_lshrrev_b32 v8, 3, v2
  v_and_b32 v9, 7, v2
  v_bfe_u32 v10, v2, 4, 1
  v_lshlrev_b32 v10, 2, v10
  v_xor_b32 v9, v9, v10
  v_lshlrev_b32 v9, 4, v9
  v_lshl_add_u32 v10, v8, 11, v9
  s_mov_b32 s24, s54
  s_mov_b32 s25, s55
  s_mov_b32 s26, 0x700000
  s_mov_b32 s27, 0x00020000
  s_mov_b32 s36, 0x05040100
  s_mov_b32 s37, 0x07060302
  s_and_b32 s20, s16, 1
  s_lshl1_add_u32 s13, s17, s20
  s_lshl_b32 s13, s13, 18
  s_lshl_b32 s14, s18, 7
  s_add_u32 s13, s13, s14
  s_cmp_ge_u32 s17, 14
  s_cbranch_scc1 .fz_kernel_c_nl
  s_mov_b32 s38, 0
.fz_kernel_kw60:
  s_sleep 2
  ds_read_b32 v7, v6 offset:0
  s_add_u32 s38, s38, 1
  s_waitcnt lgkmcnt(0)
  v_readfirstlane_b32 s31, v7
  s_bcnt1_i32_b32 s31, s31
  s_cmp_ge_u32 s31, 16
  s_cbranch_scc1 .fz_kernel_kw60d
  s_cmp_lt_u32 s38, 1048576
  s_cbranch_scc1 .fz_kernel_kw60
.fz_kernel_kw60d:
  buffer_load_dwordx4 v[112:115], v13, s[8:11], s12 offen nt
  s_add_u32 s12, s12, 7168
  s_waitcnt vmcnt(2)
  buffer_load_dwordx4 v[116:119], v13, s[8:11], s12 offen nt
  s_add_u32 s12, s12, 7168
  s_waitcnt vmcnt(2)
  buffer_load_dwordx4 v[120:123], v13, s[8:11], s12 offen nt
  s_add_u32 s12, s12, 7168
  s_waitcnt vmcnt(2)
  buffer_load_dwordx4 v[124:127], v13, s[8:11], s12 offen nt
  s_add_u32 s12, s12, 7168
  s_waitcnt vmcnt(2)
  buffer_load_dwordx4 v[128:131], v13, s[8:11], s12 offen nt
  s_add_u32 s12, s12, 7168
  s_waitcnt vmcnt(2)
  buffer_load_dwordx4 v[132:135], v13, s[8:11], s12 offen nt
  s_add_u32 s12, s12, 7168
  s_waitcnt vmcnt(2)
  buffer_load_dwordx4 v[136:139], v13, s[8:11], s12 offen nt
  s_add_u32 s12, s12, 7168
  s_waitcnt vmcnt(2)
  buffer_load_dwordx4 v[140:143], v13, s[8:11], s12 offen nt
  s_add_u32 s12, s12, 7168
  s_waitcnt vmcnt(2)
  buffer_load_dwordx4 v[144:147], v13, s[8:11], s12 offen nt
  s_add_u32 s12, s12, 7168
  s_waitcnt vmcnt(2)
  buffer_load_dwordx4 v[148:151], v13, s[8:11], s12 offen nt
  s_add_u32 s12, s12, 7168
  s_waitcnt vmcnt(2)
  buffer_load_dwordx4 v[152:155], v13, s[8:11], s12 offen nt
  s_add_u32 s12, s12, 7168
  s_waitcnt vmcnt(2)
  buffer_load_dwordx4 v[156:159], v13, s[8:11], s12 offen nt
  s_add_u32 s12, s12, 7168
  s_waitcnt vmcnt(2)
  buffer_load_dwordx4 v[160:163], v13, s[8:11], s12 offen nt
  s_add_u32 s12, s12, 7168
  s_waitcnt vmcnt(2)
  buffer_load_dwordx4 v[164:167], v13, s[8:11], s12 offen nt
  s_add_u32 s12, s12, 7168
  s_waitcnt vmcnt(2)
  buffer_load_dwordx4 v[168:171], v13, s[8:11], s12 offen nt
  s_add_u32 s12, s12, 7168
  s_waitcnt vmcnt(2)
  buffer_load_dwordx4 v[172:175], v13, s[8:11], s12 offen nt
  s_add_u32 s12, s12, 7168
  s_waitcnt vmcnt(2)
  buffer_load_dwordx4 v[176:179], v13, s[8:11], s12 offen nt
  s_add_u32 s12, s12, 7168
  s_waitcnt vmcnt(2)
  buffer_load_dwordx4 v[180:183], v13, s[8:11], s12 offen nt
  s_add_u32 s12, s12, 7168
  s_waitcnt vmcnt(2)
  buffer_load_dwordx4 v[184:187], v13, s[8:11], s12 offen nt
  s_add_u32 s12, s12, 7168
  s_waitcnt vmcnt(2)
  buffer_load_dwordx4 v[188:191], v13, s[8:11], s12 offen nt
  s_add_u32 s12, s12, 7168
  s_waitcnt vmcnt(2)
  buffer_load_dwordx4 v[192:195], v13, s[8:11], s12 offen nt
  s_add_u32 s12, s12, 7168
  s_waitcnt vmcnt(2)
  buffer_load_dwordx4 v[196:199], v13, s[8:11], s12 offen nt
  s_add_u32 s12, s12, 7168
  s_waitcnt vmcnt(2)
  buffer_load_dwordx4 v[200:203], v13, s[8:11], s12 offen nt
  s_add_u32 s12, s12, 7168
  s_waitcnt vmcnt(2)
  buffer_load_dwordx4 v[204:207], v13, s[8:11], s12 offen nt
  s_add_u32 s12, s12, 7168
  s_waitcnt vmcnt(2)
  buffer_load_dwordx4 v[208:211], v13, s[8:11], s12 offen nt
  s_add_u32 s12, s12, 7168
  s_waitcnt vmcnt(2)
  buffer_load_dwordx4 v[212:215], v13, s[8:11], s12 offen nt
  s_add_u32 s12, s12, 7168
  s_waitcnt vmcnt(2)
  buffer_load_dwordx4 v[216:219], v13, s[8:11], s12 offen nt
  s_add_u32 s12, s12, 7168
  s_waitcnt vmcnt(2)
  buffer_load_dwordx4 v[220:223], v13, s[8:11], s12 offen nt
  s_add_u32 s12, s12, 7168
  s_waitcnt vmcnt(2)
  buffer_load_dwordx4 v[224:227], v13, s[8:11], s12 offen nt
  s_add_u32 s12, s12, 7168
  s_waitcnt vmcnt(2)
  buffer_load_dwordx4 v[228:231], v13, s[8:11], s12 offen nt
  s_add_u32 s12, s12, 7168
  s_waitcnt vmcnt(2)
  buffer_load_dwordx4 v[232:235], v13, s[8:11], s12 offen nt
  s_add_u32 s12, s12, 7168
  s_waitcnt vmcnt(2)
  buffer_load_dwordx4 v[236:239], v13, s[8:11], s12 offen nt
  s_add_u32 s12, s12, 7168
  s_waitcnt vmcnt(2)
  buffer_load_dwordx4 v[32:35], v10, s[24:27], s13 offen nt
  s_add_u32 s13, s13, 16384
  s_waitcnt vmcnt(2)
  buffer_load_dwordx4 v[36:39], v10, s[24:27], s13 offen nt
  s_add_u32 s13, s13, 16384
  s_waitcnt vmcnt(2)
  buffer_load_dwordx4 v[40:43], v10, s[24:27], s13 offen nt
  s_add_u32 s13, s13, 16384
  s_waitcnt vmcnt(2)
  buffer_load_dwordx4 v[44:47], v10, s[24:27], s13 offen nt
  s_add_u32 s13, s13, 16384
  s_waitcnt vmcnt(2)
  buffer_load_dwordx4 v[48:51], v10, s[24:27], s13 offen nt
  s_add_u32 s13, s13, 16384
  s_waitcnt vmcnt(2)
  buffer_load_dwordx4 v[52:55], v10, s[24:27], s13 offen nt
  s_add_u32 s13, s13, 16384
  s_waitcnt vmcnt(2)
  buffer_load_dwordx4 v[56:59], v10, s[24:27], s13 offen nt
  s_add_u32 s13, s13, 16384
  s_waitcnt vmcnt(2)
  buffer_load_dwordx4 v[60:63], v10, s[24:27], s13 offen nt
  s_add_u32 s13, s13, 16384
  s_waitcnt vmcnt(2)
  buffer_load_dwordx4 v[64:67], v10, s[24:27], s13 offen nt
  s_add_u32 s13, s13, 16384
  s_waitcnt vmcnt(2)
  buffer_load_dwordx4 v[68:71], v10, s[24:27], s13 offen nt
  s_add_u32 s13, s13, 16384
  s_waitcnt vmcnt(2)
  buffer_load_dwordx4 v[72:75], v10, s[24:27], s13 offen nt
  s_add_u32 s13, s13, 16384
  s_waitcnt vmcnt(2)
  buffer_load_dwordx4 v[76:79], v10, s[24:27], s13 offen nt
  s_add_u32 s13, s13, 16384
  s_waitcnt vmcnt(2)
  buffer_load_dwordx4 v[240:243], v10, s[24:27], s13 offen nt
  s_add_u32 s13, s13, 16384
  s_waitcnt vmcnt(2)
  buffer_load_dwordx4 v[244:247], v10, s[24:27], s13 offen nt
  s_add_u32 s13, s13, 16384
  s_waitcnt vmcnt(2)
  buffer_load_dwordx4 v[248:251], v10, s[24:27], s13 offen nt
  s_add_u32 s13, s13, 16384
  s_waitcnt vmcnt(2)
  buffer_load_dwordx4 v[252:255], v10, s[24:27], s13 offen nt
  s_add_u32 s13, s13, 16384
  s_waitcnt vmcnt(2)
  v_mov_b32 v16, 0x3f803f80
  v_mov_b32 v17, 0x3f803f80
  v_mov_b32 v18, 0x3f803f80
  v_mov_b32 v19, 0x3f803f80
  s_waitcnt vmcnt(0)
  s_barrier
  v_perm_b32 v80, v116, v112, s36
  v_perm_b32 v84, v116, v112, s37
  v_perm_b32 v88, v117, v113, s36
  v_perm_b32 v92, v117, v113, s37
  v_perm_b32 v96, v118, v114, s36
  v_perm_b32 v100, v118, v114, s37
  v_perm_b32 v104, v119, v115, s36
  v_perm_b32 v108, v119, v115, s37
  v_perm_b32 v81, v124, v120, s36
  v_perm_b32 v85, v124, v120, s37
  v_perm_b32 v89, v125, v121, s36
  v_perm_b32 v93, v125, v121, s37
  v_perm_b32 v97, v126, v122, s36
  v_perm_b32 v101, v126, v122, s37
  v_perm_b32 v105, v127, v123, s36
  v_perm_b32 v109, v127, v123, s37
  v_perm_b32 v82, v132, v128, s36
  v_perm_b32 v86, v132, v128, s37
  v_perm_b32 v90, v133, v129, s36
  v_perm_b32 v94, v133, v129, s37
  v_perm_b32 v98, v134, v130, s36
  v_perm_b32 v102, v134, v130, s37
  v_perm_b32 v106, v135, v131, s36
  v_perm_b32 v110, v135, v131, s37
  v_perm_b32 v83, v140, v136, s36
  v_perm_b32 v87, v140, v136, s37
  v_perm_b32 v91, v141, v137, s36
  v_perm_b32 v95, v141, v137, s37
  v_perm_b32 v99, v142, v138, s36
  v_perm_b32 v103, v142, v138, s37
  v_perm_b32 v107, v143, v139, s36
  v_perm_b32 v111, v143, v139, s37
  v_perm_b32 v112, v148, v144, s36
  v_perm_b32 v116, v148, v144, s37
  v_perm_b32 v120, v149, v145, s36
  v_perm_b32 v124, v149, v145, s37
  v_perm_b32 v128, v150, v146, s36
  v_perm_b32 v132, v150, v146, s37
  v_perm_b32 v136, v151, v147, s36
  v_perm_b32 v140, v151, v147, s37
  v_perm_b32 v113, v156, v152, s36
  v_perm_b32 v117, v156, v152, s37
  v_perm_b32 v121, v157, v153, s36
  v_perm_b32 v125, v157, v153, s37
  v_perm_b32 v129, v158, v154, s36
  v_perm_b32 v133, v158, v154, s37
  v_perm_b32 v137, v159, v155, s36
  v_perm_b32 v141, v159, v155, s37
  v_perm_b32 v114, v164, v160, s36
  v_perm_b32 v118, v164, v160, s37
  v_perm_b32 v122, v165, v161, s36
  v_perm_b32 v126, v165, v161, s37
  v_perm_b32 v130, v166, v162, s36
  v_perm_b32 v134, v166, v162, s37
  v_perm_b32 v138, v167, v163, s36
  v_perm_b32 v142, v167, v163, s37
  v_perm_b32 v115, v172, v168, s36
  v_perm_b32 v119, v172, v168, s37
  v_perm_b32 v123, v173, v169, s36
  v_perm_b32 v127, v173, v169, s37
  v_perm_b32 v131, v174, v170, s36
  v_perm_b32 v135, v174, v170, s37
  v_perm_b32 v139, v175, v171, s36
  v_perm_b32 v143, v175, v171, s37
  v_perm_b32 v144, v180, v176, s36
  v_perm_b32 v148, v180, v176, s37
  v_perm_b32 v152, v181, v177, s36
  v_perm_b32 v156, v181, v177, s37
  v_perm_b32 v160, v182, v178, s36
  v_perm_b32 v164, v182, v178, s37
  v_perm_b32 v168, v183, v179, s36
  v_perm_b32 v172, v183, v179, s37
  v_perm_b32 v145, v188, v184, s36
  v_perm_b32 v149, v188, v184, s37
  v_perm_b32 v153, v189, v185, s36
  v_perm_b32 v157, v189, v185, s37
  v_perm_b32 v161, v190, v186, s36
  v_perm_b32 v165, v190, v186, s37
  v_perm_b32 v169, v191, v187, s36
  v_perm_b32 v173, v191, v187, s37
  v_perm_b32 v146, v196, v192, s36
  v_perm_b32 v150, v196, v192, s37
  v_perm_b32 v154, v197, v193, s36
  v_perm_b32 v158, v197, v193, s37
  v_perm_b32 v162, v198, v194, s36
  v_perm_b32 v166, v198, v194, s37
  v_perm_b32 v170, v199, v195, s36
  v_perm_b32 v174, v199, v195, s37
  v_perm_b32 v147, v204, v200, s36
  v_perm_b32 v151, v204, v200, s37
  v_perm_b32 v155, v205, v201, s36
  v_perm_b32 v159, v205, v201, s37
  v_perm_b32 v163, v206, v202, s36
  v_perm_b32 v167, v206, v202, s37
  v_perm_b32 v171, v207, v203, s36
  v_perm_b32 v175, v207, v203, s37
  v_perm_b32 v176, v212, v208, s36
  v_perm_b32 v180, v212, v208, s37
  v_perm_b32 v184, v213, v209, s36
  v_perm_b32 v188, v213, v209, s37
  v_perm_b32 v192, v214, v210, s36
  v_perm_b32 v196, v214, v210, s37
  v_perm_b32 v200, v215, v211, s36
  v_perm_b32 v204, v215, v211, s37
  v_perm_b32 v177, v220, v216, s36
  v_perm_b32 v181, v220, v216, s37
  v_perm_b32 v185, v221, v217, s36
  v_perm_b32 v189, v221, v217, s37
  v_perm_b32 v193, v222, v218, s36
  v_perm_b32 v197, v222, v218, s37
  v_perm_b32 v201, v223, v219, s36
  v_perm_b32 v205, v223, v219, s37
  v_perm_b32 v178, v228, v224, s36
  v_perm_b32 v182, v228, v224, s37
  v_perm_b32 v186, v229, v225, s36
  v_perm_b32 v190, v229, v225, s37
  v_perm_b32 v194, v230, v226, s36
  v_perm_b32 v198, v230, v226, s37
  v_perm_b32 v202, v231, v227, s36
  v_perm_b32 v206, v231, v227, s37
  v_perm_b32 v179, v236, v232, s36
  v_perm_b32 v183, v236, v232, s37
  v_perm_b32 v187, v237, v233, s36
  v_perm_b32 v191, v237, v233, s37
  v_perm_b32 v195, v238, v234, s36
  v_perm_b32 v199, v238, v234, s37
  v_perm_b32 v203, v239, v235, s36
  v_perm_b32 v207, v239, v235, s37
  v_mfma_f32_16x16x32_bf16 v[208:211], v[16:19], v[80:83], 0
  v_mfma_f32_16x16x32_bf16 v[212:215], v[16:19], v[84:87], 0
  v_mfma_f32_16x16x32_bf16 v[216:219], v[16:19], v[88:91], 0
  v_mfma_f32_16x16x32_bf16 v[220:223], v[16:19], v[92:95], 0
  v_mfma_f32_16x16x32_bf16 v[224:227], v[16:19], v[96:99], 0
  v_mfma_f32_16x16x32_bf16 v[228:231], v[16:19], v[100:103], 0
  v_mfma_f32_16x16x32_bf16 v[232:235], v[16:19], v[104:107], 0
  v_mfma_f32_16x16x32_bf16 v[236:239], v[16:19], v[108:111], 0
  v_mfma_f32_16x16x32_bf16 v[208:211], v[16:19], v[112:115], v[208:211]
  v_mfma_f32_16x16x32_bf16 v[212:215], v[16:19], v[116:119], v[212:215]
  v_mfma_f32_16x16x32_bf16 v[216:219], v[16:19], v[120:123], v[216:219]
  v_mfma_f32_16x16x32_bf16 v[220:223], v[16:19], v[124:127], v[220:223]
  v_mfma_f32_16x16x32_bf16 v[224:227], v[16:19], v[128:131], v[224:227]
  v_mfma_f32_16x16x32_bf16 v[228:231], v[16:19], v[132:135], v[228:231]
  v_mfma_f32_16x16x32_bf16 v[232:235], v[16:19], v[136:139], v[232:235]
  v_mfma_f32_16x16x32_bf16 v[236:239], v[16:19], v[140:143], v[236:239]
  v_mfma_f32_16x16x32_bf16 v[208:211], v[16:19], v[144:147], v[208:211]
  v_mfma_f32_16x16x32_bf16 v[212:215], v[16:19], v[148:151], v[212:215]
  v_mfma_f32_16x16x32_bf16 v[216:219], v[16:19], v[152:155], v[216:219]
  v_mfma_f32_16x16x32_bf16 v[220:223], v[16:19], v[156:159], v[220:223]
  v_mfma_f32_16x16x32_bf16 v[224:227], v[16:19], v[160:163], v[224:227]
  v_mfma_f32_16x16x32_bf16 v[228:231], v[16:19], v[164:167], v[228:231]
  v_mfma_f32_16x16x32_bf16 v[232:235], v[16:19], v[168:171], v[232:235]
  v_mfma_f32_16x16x32_bf16 v[236:239], v[16:19], v[172:175], v[236:239]
  v_mfma_f32_16x16x32_bf16 v[208:211], v[16:19], v[176:179], v[208:211]
  v_mfma_f32_16x16x32_bf16 v[212:215], v[16:19], v[180:183], v[212:215]
  v_mfma_f32_16x16x32_bf16 v[216:219], v[16:19], v[184:187], v[216:219]
  v_mfma_f32_16x16x32_bf16 v[220:223], v[16:19], v[188:191], v[220:223]
  v_mfma_f32_16x16x32_bf16 v[224:227], v[16:19], v[192:195], v[224:227]
  v_mfma_f32_16x16x32_bf16 v[228:231], v[16:19], v[196:199], v[228:231]
  v_mfma_f32_16x16x32_bf16 v[232:235], v[16:19], v[200:203], v[232:235]
  v_mfma_f32_16x16x32_bf16 v[236:239], v[16:19], v[204:207], v[236:239]
  s_nop 0
  v_add_f32 v28, v209, v208 row_ror:8 row_mask:0xf bank_mask:0x3
  v_add_f32 v29, v213, v212 row_ror:8 row_mask:0xf bank_mask:0x3
  v_add_f32 v30, v217, v216 row_ror:8 row_mask:0xf bank_mask:0x3
  v_add_f32 v31, v221, v220 row_ror:8 row_mask:0xf bank_mask:0x3
  v_add_f32 v28, v224, v225 row_ror:8 row_mask:0xf bank_mask:0xc
  v_add_f32 v29, v228, v229 row_ror:8 row_mask:0xf bank_mask:0xc
  v_add_f32 v30, v232, v233 row_ror:8 row_mask:0xf bank_mask:0xc
  v_add_f32 v31, v236, v237 row_ror:8 row_mask:0xf bank_mask:0xc
  v_mul_f32 v28, 0.0009765625, v28
  v_mul_f32 v29, 0.0009765625, v29
  v_mul_f32 v30, 0.0009765625, v30
  v_mul_f32 v31, 0.0009765625, v31
.fz_kernel_c_np:
  v_mov_b32 v27, v6
  s_mov_b32 s72, s66
  s_mov_b32 s73, s65
  s_mov_b32 s74, s67
  s_mov_b32 s75, s62
  s_cmp_lg_u32 s62, 0
  s_cbranch_scc1 .fz_kernel_c_n2
  s_mov_b32 s62, 1
  s_mov_b32 s63, 0x2000000
  s_mov_b32 s64, 0x2800000
  s_mov_b32 s65, 0x1400000
  s_mov_b32 s66, 0x1c42000
  s_mov_b32 s67, 12
  s_mov_b32 s71, 159776
  v_mov_b32 v6, 159832
.fz_kernel_c_n2:
  s_lshr_b32 s21, s17, 3
  s_add_u32 s70, s18, s21
  s_lshl1_add_u32 s70, s17, s70
  s_and_b32 s70, s70, 15
  s_cmp_eq_u32 s75, 0
  s_cselect_b32 s3, 32, 0
  s_cselect_b32 s70, s70, s18
  s_and_b32 s20, s16, 1
  s_mov_b32 s34, 0x00030003
  s_mov_b32 s35, 0x00030003
  s_mov_b32 s71, 0
  s_lshl1_add_u32 s26, s17, s20
  v_lshrrev_b32 v8, 4, v2
  v_bfe_u32 v12, v2, 3, 1
  v_lshl_add_u32 v12, v12, 2, v8
  v_lshlrev_b32 v10, 7, v2
  s_lshl_b32 s25, s20, 1
  v_lshrrev_b32 v14, 4, v2
  v_bfe_u32 v15, v2, 2, 2
  v_lshl_add_u32 v16, v14, 3, v15
  v_lshlrev_b32 v16, 7, v16
  v_and_b32 v14, 1, v14
  v_lshrrev_b32 v15, 1, v15
  v_lshl_add_u32 v14, v14, 1, v15
  v_xor_b32 v14, s25, v14
  v_lshl_add_u32 v16, v14, 5, v16
  v_and_b32 v14, 3, v2
  v_lshl_add_u32 v16, v14, 3, v16
  v_add_u32 v7, 65536, v16
  v_xor_b32 v9, 32, v7
  s_add_u32 s21, s74, 0x1800008
  s_sub_u32 s22, s72, 32768
  v_mov_b32 v14, s21
  v_mov_b32 v15, s22
  v_cmp_gt_u32 vcc, 16, v2
  s_nop 1
  v_cndmask_b32 v14, v15, v14, vcc
  v_lshl_add_u32 v14, v2, 11, v14
  s_lshl_b32 s25, s17, 7
  s_lshl_b32 s22, 1, s18
  v_mov_b32 v15, s22
  v_lshlrev_b32 v16, 3, v2
  s_and_b32 s21, s2, 7
  s_lshl_b32 s21, s21, 11
  s_lshl_b32 s22, s20, 10
  s_add_u32 s21, s21, s22
  s_add_u32 s21, s21, s72
  s_lshl_b32 s22, s20, 12
  s_add_u32 s22, s22, s72
  s_add_u32 s22, s22, 16384
  s_add_u32 s23, s22, 8192
  s_add_u32 s24, s22, 16384
  v_and_b32 v17, 1, v8
  v_lshlrev_b32 v17, 13, v17
  v_lshrrev_b32 v18, 1, v8
  v_mul_u32_u24 v18, 320, v18
  v_add_u32 v17, v17, v18
  v_bfe_u32 v18, v2, 3, 1
  v_lshl_add_u32 v17, v18, 9, v17
  v_bfe_u32 v18, v2, 2, 1
  v_lshl_add_u32 v17, v18, 7, v17
  v_and_b32 v18, 3, v2
  v_lshl_add_u32 v17, v18, 3, v17
  s_lshl_b32 s27, s20, 14
  s_add_u32 s27, s27, 114688
  v_add_u32 v17, s27, v17
  v_xor_b32 v18, 64, v17
  v_and_b32 v19, 15, v2
  v_lshlrev_b32 v19, 6, v19
  v_lshl_add_u32 v19, v8, 4, v19
  v_and_b32 v20, 7, v2
  v_lshlrev_b32 v20, 5, v20
  v_and_b32 v21, 8, v2
  v_lshl_add_u32 v20, v21, 1, v20
  v_and_b32 v21, 31, v2
  v_lshlrev_b32 v21, 4, v21
  v_lshrrev_b32 v22, 5, v2
  v_lshl_add_u32 v21, v22, 11, v21
  v_mov_b32 v23, 0.0009765625
  v_mov_b32 v24, 9.5367431640625e-07
  v_mov_b32 v25, 1e-05
  v_add_u32 v26, 155648, v16
  s_lshl_b32 s14, s17, 9
  s_add_u32 s14, s14, s72
  s_add_u32 s14, s14, 16384
  s_add_u32 s15, s14, 8192
  v_add_u32 v13, s27, v3
  s_barrier
.fz_kernel_c_n3:
  s_mov_b32 s13, 0xffffff
  s_cmp_eq_u32 s20, 0
  s_cbranch_scc1 .fz_kernel_c_nf
  s_cmp_eq_u32 s75, 0
  s_cselect_b32 exec_lo, 0xffff, s13
  s_mov_b32 exec_hi, 0
  s_mov_b32 s38, 0
.fz_kernel_cw61:
  s_sleep 1
  ds_read_u8 v22, v27 offset:268
  s_add_u32 s38, s38, 1
  s_waitcnt lgkmcnt(0)
  v_cmp_gt_u32 vcc, 4, v22
  s_cbranch_vccz .fz_kernel_cw61d
  s_cmp_lt_u32 s38, 8388608
  s_cbranch_scc1 .fz_kernel_cw61
.fz_kernel_cw61d:
  buffer_atomic_or v15, v14, s[4:7], s25 offen sc1
  s_mov_b64 exec, -1
.fz_kernel_c_nf:
  ds_write_b128 v13, v[32:35] offset:0
  ds_write_b128 v13, v[36:39] offset:1024
  ds_write_b128 v13, v[40:43] offset:2048
  ds_write_b128 v13, v[44:47] offset:3072
  ds_write_b128 v13, v[48:51] offset:4096
  ds_write_b128 v13, v[52:55] offset:5120
  ds_write_b128 v13, v[56:59] offset:6144
  ds_write_b128 v13, v[60:63] offset:7168
  ds_write_b128 v13, v[64:67] offset:8192
  ds_write_b128 v13, v[68:71] offset:9216
  ds_write_b128 v13, v[72:75] offset:10240
  ds_write_b128 v13, v[76:79] offset:11264
  ds_write_b128 v13, v[240:243] offset:12288
  ds_write_b128 v13, v[244:247] offset:13312
  ds_write_b128 v13, v[248:251] offset:14336
  ds_write_b128 v13, v[252:255] offset:15360
  v_and_b32 v14, 1, v2
  v_lshlrev_b32 v14, 10, v14
  v_lshl_add_u32 v14, v8, 14, v14
  s_waitcnt lgkmcnt(0)
  s_cmp_lg_u32 s75, 0
  s_cbranch_scc1 .fz_kernel_c_nw
  s_mov_b32 s38, 0
.fz_kernel_cw62:
  s_sleep 1
  ds_read_u8 v27, v6 offset:272
  s_add_u32 s38, s38, 1
  s_waitcnt lgkmcnt(0)
  v_cmp_gt_u32 vcc, 2, v27
  s_cbranch_vccz .fz_kernel_cw62d
  s_cmp_lt_u32 s38, 8388608
  s_cbranch_scc1 .fz_kernel_cw62
.fz_kernel_cw62d:
  ds_read_b64_tr_b16 v[32:33], v7 offset:0
  ds_read_b64_tr_b16 v[34:35], v7 offset:512
  ds_read_b64_tr_b16 v[36:37], v9 offset:0
  ds_read_b64_tr_b16 v[38:39], v9 offset:512
  ds_read_b64_tr_b16 v[40:41], v7 offset:4096
  ds_read_b64_tr_b16 v[42:43], v7 offset:4608
  ds_read_b64_tr_b16 v[44:45], v9 offset:4096
  ds_read_b64_tr_b16 v[46:47], v9 offset:4608
  ds_read_b64_tr_b16 v[48:49], v7 offset:8192
  ds_read_b64_tr_b16 v[50:51], v7 offset:8704
  ds_read_b64_tr_b16 v[52:53], v9 offset:8192
  ds_read_b64_tr_b16 v[54:55], v9 offset:8704
  s_waitcnt lgkmcnt(0)
  ds_read_b64_tr_b16 v[56:57], v7 offset:12288
  ds_read_b64_tr_b16 v[58:59], v7 offset:12800
  ds_read_b64_tr_b16 v[60:61], v9 offset:12288
  ds_read_b64_tr_b16 v[62:63], v9 offset:12800
  ds_read_b64_tr_b16 v[64:65], v7 offset:16384
  ds_read_b64_tr_b16 v[66:67], v7 offset:16896
  ds_read_b64_tr_b16 v[68:69], v9 offset:16384
  ds_read_b64_tr_b16 v[70:71], v9 offset:16896
  ds_read_b64_tr_b16 v[72:73], v7 offset:20480
  ds_read_b64_tr_b16 v[74:75], v7 offset:20992
  ds_read_b64_tr_b16 v[76:77], v9 offset:20480
  ds_read_b64_tr_b16 v[78:79], v9 offset:20992
  s_waitcnt lgkmcnt(0)
  s_lshl_b32 s21, s18, 10
  s_add_u32 s21, s21, s72
  s_cmp_lg_u32 s20, 0
  s_cbranch_scc1 .fz_kernel_c_c2
  s_add_u32 s22, s19, s74
  s_add_u32 s23, s14, 16384
  s_mov_b64 exec, 1
  s_mov_b32 s38, 0
.fz_kernel_c_c0:
  buffer_load_dword v9, v4, s[4:7], s22 offen offset:8 sc1
  s_add_u32 s38, s38, 1
  s_waitcnt vmcnt(0)
  v_cmp_ne_u32 vcc, 0xffff, v9
  s_cbranch_vccz .fz_kernel_c_c1
  s_cmp_lt_u32 s38, 131072
  s_cbranch_scc1 .fz_kernel_c_c0
.fz_kernel_c_c1:
  s_mov_b64 exec, -1
  buffer_load_dwordx2 v[240:241], v16, s[4:7], s14 offen
  buffer_load_dwordx2 v[242:243], v16, s[4:7], s15 offen
  buffer_load_dwordx2 v[244:245], v16, s[4:7], s23 offen
  s_lshl_b32 s23, s17, 6
  s_add_u32 s23, s23, s21
  s_lshl_b32 s24, s17, 7
  s_add_u32 s24, s24, 1
  s_waitcnt vmcnt(0)
  v_fma_f32 v208, -v240, v240, v242
  v_fma_f32 v209, -v241, v241, v243
  v_rsq_f32 v208, abs(v208)
  v_rsq_f32 v209, abs(v209)
  v_mul_f32 v208, v208, v244
  v_mul_f32 v209, v209, v245
  v_and_b32 v208, -2, v208
  v_or_b32 v209, 1, v209
  v_cmp_gt_f32 vcc, v209, v208
  v_max_f32 v9, v208, v209
  s_nop 0
  v_cndmask_b32 v210, v240, v241, vcc
  v_max_f32 v7, v9, v9 row_ror:8 row_mask:0xf bank_mask:0xf
  v_cndmask_b32 v211, v242, v243, vcc
  s_nop 0
  v_max_f32 v7, v7, v7 row_ror:4 row_mask:0xf bank_mask:0xf
  s_nop 1
  v_max_f32 v7, v7, v7 row_ror:2 row_mask:0xf bank_mask:0xf
  s_nop 1
  v_max_f32 v7, v7, v7 row_ror:1 row_mask:0xf bank_mask:0xf
  s_nop 1
  v_max_f32 v7, v7, v7 row_bcast:15 row_mask:0xa bank_mask:0xf
  s_nop 1
  v_max_f32 v7, v7, v7 row_bcast:31 row_mask:0xc bank_mask:0xf
  v_and_b32 v209, 1, v9
  v_lshl_add_u32 v209, v2, 1, v209
  v_readlane_b32 s22, v7, 63
  v_add_u32 v209, s24, v209
  v_mov_b32 v208, v9
  v_cmp_eq_u32 vcc, s22, v9
  s_ff1_i32_b64 s22, vcc
  s_lshl_b64 exec, 1, s22
  buffer_store_dwordx4 v[208:211], v4, s[4:7], s23 offen sc1
  s_mov_b64 exec, -1
.fz_kernel_c_c2:
  s_cmp_lg_u32 s20, 0
  s_cbranch_scc1 .fz_kernel_c_c21
  s_call_b64 s[68:69], .fz_kernel_c_coef
  ds_write_b64 v26, v[248:249] offset:4608
  ds_write_b64 v26, v[250:251] offset:5120
  ds_write_b64 v26, v[252:253] offset:6400
  ds_write_b64 v26, v[254:255] offset:6912
.fz_kernel_c_c21:
  s_cmp_eq_u32 s3, 0
  s_cbranch_scc1 .fz_kernel_hb63
  s_barrier
  s_sub_u32 s3, s3, 1
.fz_kernel_hb63:
  s_cmp_eq_u32 s3, 0
  s_cbranch_scc1 .fz_kernel_hb64
  s_barrier
  s_sub_u32 s3, s3, 1
.fz_kernel_hb64:
  s_cmp_eq_u32 s3, 0
  s_cbranch_scc1 .fz_kernel_hb65
  s_barrier
  s_sub_u32 s3, s3, 1
.fz_kernel_hb65:
.fz_kernel_c_c3:
  v_lshlrev_b32 v22, 6, v2
  s_mov_b64 exec, 0xffff
  s_mov_b32 s38, 0
.fz_kernel_c_c4:
  buffer_load_dwordx4 v[224:227], v22, s[4:7], s21 offen sc1
  s_add_u32 s38, s38, 1
  s_mov_b32 s46, 0
  s_call_b64 s[0:1], .fz_kernel_hw
  s_waitcnt vmcnt(0)
  v_min_u32 v9, v225, v227
  v_max_f32 v7, v224, v224 row_ror:8 row_mask:0xf bank_mask:0xf
  v_cmp_eq_u32 vcc, 0, v9
  s_cbranch_vccz .fz_kernel_c_c5
  s_cmp_lt_u32 s38, 131072
  s_cbranch_scc1 .fz_kernel_c_c4
.fz_kernel_c_c5:
  s_waitcnt lgkmcnt(0)
  v_max_f32 v7, v7, v7 row_ror:4 row_mask:0xf bank_mask:0xf
  s_nop 1
  v_max_f32 v7, v7, v7 row_ror:2 row_mask:0xf bank_mask:0xf
  s_nop 1
  v_max_f32 v7, v7, v7 row_ror:1 row_mask:0xf bank_mask:0xf
  v_cmp_eq_u32 vcc, v7, v224
  s_or_b32 s22, vcc_lo, 0x8000
  s_ff1_i32_b32 s22, s22
  v_readlane_b32 s77, v225, s22
  v_readlane_b32 s27, v224, s22
  v_readlane_b32 s23, v226, s22
  v_readlane_b32 s24, v227, s22
  s_mov_b64 exec, -1
  v_mov_b32 v11, s23
  v_mov_b32 v15, s24
  s_branch .fz_kernel_c_idx
.fz_kernel_c_nw:
  s_mov_b64 exec, 0xff
  s_mov_b32 s38, 0
.fz_kernel_c_gm:
  buffer_load_dword v9, v10, s[4:7], s21 offen sc1
  s_add_u32 s38, s38, 1
  s_mov_b32 s46, 0
  s_call_b64 s[0:1], .fz_kernel_hw
  s_waitcnt vmcnt(0)
  v_cmp_ne_u32 vcc, 0xffff, v9
  s_cbranch_vccz .fz_kernel_c_gmd
  s_cmp_eq_u32 s3, 0
  s_cbranch_scc1 .fz_kernel_hb66
  s_barrier
  s_sub_u32 s3, s3, 1
.fz_kernel_hb66:
  s_cmp_lt_u32 s38, 131072
  s_cbranch_scc1 .fz_kernel_c_gm
.fz_kernel_c_gmd:
  s_mov_b64 exec, -1
  buffer_load_dwordx4 v[208:211], v3, s[4:7], s22 offen offset:0
  buffer_load_dwordx4 v[212:215], v3, s[4:7], s23 offen offset:0
  buffer_load_dwordx4 v[216:219], v3, s[4:7], s24 offen offset:0
  buffer_load_dwordx4 v[220:223], v3, s[4:7], s22 offen offset:1024
  buffer_load_dwordx4 v[224:227], v3, s[4:7], s23 offen offset:1024
  buffer_load_dwordx4 v[228:231], v3, s[4:7], s24 offen offset:1024
  buffer_load_dwordx4 v[232:235], v3, s[4:7], s22 offen offset:2048
  buffer_load_dwordx4 v[236:239], v3, s[4:7], s23 offen offset:2048
  buffer_load_dwordx4 v[240:243], v3, s[4:7], s24 offen offset:2048
  buffer_load_dwordx4 v[244:247], v3, s[4:7], s22 offen offset:3072
  buffer_load_dwordx4 v[248:251], v3, s[4:7], s23 offen offset:3072
  buffer_load_dwordx4 v[252:255], v3, s[4:7], s24 offen offset:3072
  s_lshl_b32 s21, s75, 4
  s_add_u32 s21, s21, 159968
  v_mov_b32 v10, s21
  s_lshl_b32 s22, s20, 3
  v_add_u32 v13, s22, v10
  s_mov_b32 s46, 6
  s_call_b64 s[0:1], .fz_kernel_hw
  s_waitcnt vmcnt(6)
  s_waitcnt vmcnt(10)
  v_fma_f32 v212, -v208, v208, v212
  v_fma_f32 v213, -v209, v209, v213
  v_fma_f32 v214, -v210, v210, v214
  v_fma_f32 v215, -v211, v211, v215
  s_cmp_eq_u32 s3, 0
  s_cbranch_scc1 .fz_kernel_hb74
  s_barrier
  s_sub_u32 s3, s3, 1
.fz_kernel_hb74:
  v_rsq_f32 v212, abs(v212)
  v_rsq_f32 v213, abs(v213)
  v_rsq_f32 v214, abs(v214)
  v_rsq_f32 v215, abs(v215)
  s_waitcnt vmcnt(9)
  v_mul_f32 v216, v216, v212
  v_mul_f32 v217, v217, v213
  v_mul_f32 v218, v218, v214
  v_mul_f32 v219, v219, v215
  v_and_or_b32 v216, v216, -16, 0
  v_and_or_b32 v217, v217, -16, 1
  v_and_or_b32 v218, v218, -16, 2
  v_and_or_b32 v219, v219, -16, 3
  v_max3_f32 v9, v216, v217, v218
  v_max_f32 v9, v9, v219
  s_waitcnt vmcnt(7)
  v_fma_f32 v224, -v220, v220, v224
  v_fma_f32 v225, -v221, v221, v225
  v_fma_f32 v226, -v222, v222, v226
  v_fma_f32 v227, -v223, v223, v227
  v_rsq_f32 v224, abs(v224)
  v_rsq_f32 v225, abs(v225)
  v_rsq_f32 v226, abs(v226)
  v_rsq_f32 v227, abs(v227)
  s_waitcnt vmcnt(6)
  v_mul_f32 v228, v228, v224
  v_mul_f32 v229, v229, v225
  v_mul_f32 v230, v230, v226
  v_mul_f32 v231, v231, v227
  s_cmp_eq_u32 s3, 0
  s_cbranch_scc1 .fz_kernel_hb75
  s_barrier
  s_sub_u32 s3, s3, 1
.fz_kernel_hb75:
  v_and_or_b32 v228, v228, -16, 4
  v_and_or_b32 v229, v229, -16, 5
  v_and_or_b32 v230, v230, -16, 6
  v_and_or_b32 v231, v231, -16, 7
  v_max3_f32 v9, v9, v228, v229
  v_max3_f32 v9, v9, v230, v231
  s_waitcnt vmcnt(4)
  v_fma_f32 v236, -v232, v232, v236
  v_fma_f32 v237, -v233, v233, v237
  v_fma_f32 v238, -v234, v234, v238
  v_fma_f32 v239, -v235, v235, v239
  v_rsq_f32 v236, abs(v236)
  v_rsq_f32 v237, abs(v237)
  v_rsq_f32 v238, abs(v238)
  v_rsq_f32 v239, abs(v239)
  s_waitcnt vmcnt(3)
  v_mul_f32 v240, v240, v236
  v_mul_f32 v241, v241, v237
  v_mul_f32 v242, v242, v238
  v_mul_f32 v243, v243, v239
  v_and_or_b32 v240, v240, -16, 8
  v_and_or_b32 v241, v241, -16, 9
  v_and_or_b32 v242, v242, -16, 10
  v_and_or_b32 v243, v243, -16, 11
  v_max3_f32 v9, v9, v240, v241
  v_max3_f32 v9, v9, v242, v243
  s_waitcnt vmcnt(1)
  v_fma_f32 v248, -v244, v244, v248
  v_fma_f32 v249, -v245, v245, v249
  v_fma_f32 v250, -v246, v246, v250
  v_fma_f32 v251, -v247, v247, v251
  v_rsq_f32 v248, abs(v248)
  s_cmp_eq_u32 s3, 0
  s_cbranch_scc1 .fz_kernel_hb76
  s_barrier
  s_sub_u32 s3, s3, 1
.fz_kernel_hb76:
  v_rsq_f32 v249, abs(v249)
  v_rsq_f32 v250, abs(v250)
  v_rsq_f32 v251, abs(v251)
  s_waitcnt vmcnt(0)
  v_mul_f32 v252, v252, v248
  v_mul_f32 v253, v253, v249
  v_mul_f32 v254, v254, v250
  v_mul_f32 v255, v255, v251
  v_and_or_b32 v252, v252, -16, 12
  v_and_or_b32 v253, v253, -16, 13
  v_and_or_b32 v254, v254, -16, 14
  v_and_or_b32 v255, v255, -16, 15
  v_max3_f32 v9, v9, v252, v253
  v_max3_f32 v9, v9, v254, v255
  s_nop 1
  v_max_f32 v7, v9, v9 row_ror:8 row_mask:0xf bank_mask:0xf
  s_nop 1
  v_max_f32 v7, v7, v7 row_ror:4 row_mask:0xf bank_mask:0xf
  s_nop 1
  v_max_f32 v7, v7, v7 row_ror:2 row_mask:0xf bank_mask:0xf
  s_nop 1
  v_max_f32 v7, v7, v7 row_ror:1 row_mask:0xf bank_mask:0xf
  s_nop 1
  v_max_f32 v7, v7, v7 row_bcast:15 row_mask:0xa bank_mask:0xf
  s_nop 1
  v_max_f32 v7, v7, v7 row_bcast:31 row_mask:0xc bank_mask:0xf
  s_nop 0
  v_readlane_b32 s21, v7, 63
  s_nop 1
  v_cmp_eq_u32 vcc, s21, v9
  s_ff1_i32_b64 s22, vcc
  s_lshl_b32 s22, s22, 2
  s_and_b32 s23, s21, 3
  s_add_u32 s22, s22, s23
  s_and_b32 s23, s21, 12
  s_lshl_b32 s23, s23, 6
  s_add_u32 s22, s22, s23
  s_and_b32 s22, s22, 1023
  s_lshl_b32 s23, s20, 10
  s_add_u32 s22, s22, s23
  s_add_u32 s22, s22, 1
  v_mov_b32 v224, s21
  v_mov_b32 v225, s22
  s_mov_b64 exec, 1
  ds_write_b64 v13, v[224:225]
  s_mov_b32 s38, 0
.fz_kernel_c_am:
  s_cmp_eq_u32 s3, 0
  s_cbranch_scc1 .fz_kernel_hb77
  s_barrier
  s_sub_u32 s3, s3, 1
.fz_kernel_hb77:
  ds_read_b128 v[224:227], v10
  s_add_u32 s38, s38, 1
  s_waitcnt lgkmcnt(0)
  v_min_u32 v9, v225, v227
  v_cmp_eq_u32 vcc, 0, v9
  s_cbranch_vccz .fz_kernel_c_amd
  s_cmp_eq_u32 s3, 0
  s_cbranch_scc1 .fz_kernel_hb67
  s_barrier
  s_sub_u32 s3, s3, 1
.fz_kernel_hb67:
  s_cmp_lt_u32 s38, 524288
  s_cbranch_scc1 .fz_kernel_c_am
.fz_kernel_c_amd:
  v_cmp_gt_f32 vcc, v226, v224
  s_nop 1
  v_cndmask_b32 v225, v225, v227, vcc
  v_cndmask_b32 v224, v224, v226, vcc
  v_readfirstlane_b32 s77, v225
  v_readfirstlane_b32 s27, v224
  s_mov_b64 exec, -1
  s_sub_u32 s21, s77, 1
  s_and_b32 s21, s21, 2047
  s_lshl_b32 s21, s21, 2
  s_add_u32 s21, s21, s72
  s_add_u32 s21, s21, 16384
  s_add_u32 s22, s21, 8192
  buffer_load_dword v11, v4, s[4:7], s21 offen
  buffer_load_dword v15, v4, s[4:7], s22 offen
.fz_kernel_c_idx:
  s_mov_b64 exec, s[34:35]
  s_sub_u32 s77, s77, 1
  s_and_b32 s77, s77, 2047
  s_lshr_b32 s78, s77, 7
  s_lshl_b32 s78, s78, 18
  s_and_b32 s21, s77, 0x70
  s_lshl_b32 s21, s21, 7
  s_add_u32 s78, s78, s21
  s_and_b32 s21, s77, 15
  s_lshl_b32 s21, s21, 4
  s_add_u32 s78, s78, s21
  s_add_u32 s78, s78, s73
  s_and_b32 s25, s18, 2
  s_add_u32 s25, s25, s20
  s_lshl_b32 s21, s25, 16
  s_add_u32 s21, s21, s78
  buffer_load_dwordx4 v[208:211], v14, s[4:7], s21 offen offset:0
  buffer_load_dwordx4 v[212:215], v14, s[4:7], s21 offen offset:256
  buffer_load_dwordx4 v[216:219], v14, s[4:7], s21 offen offset:512
  buffer_load_dwordx4 v[220:223], v14, s[4:7], s21 offen offset:768
  s_mov_b64 exec, -1
  s_lshr_b32 s21, s77, 7
  s_and_b32 s79, s77, 127
  s_add_u32 s79, s79, 1
  s_cmp_eq_u32 s21, s17
  s_cselect_b32 s79, s79, 0
  s_and_b32 s21, s18, 1
  s_lshl_b32 s21, s21, 2
  s_add_u32 s21, s21, s25
  s_lshl_b32 s21, s21, 9
  s_lshl_b32 s22, s17, 13
  s_add_u32 s21, s21, s22
  s_and_b32 s22, s18, 8
  s_lshl_b32 s22, s22, 9
  s_add_u32 s21, s21, s22
  s_and_b32 s22, s18, 4
  s_lshl_b32 s22, s22, 6
  s_add_u32 s21, s21, s22
  s_add_u32 s21, s21, s72
  s_add_u32 s21, s21, 40960
  s_cmp_eq_u32 s3, 0
  s_cbranch_scc1 .fz_kernel_hb78
  s_barrier
  s_sub_u32 s3, s3, 1
.fz_kernel_hb78:
  v_mov_b32 v1, -1477.3197218702985
  v_mul_f32 v1, s27, v1
  v_exp_f32 v1, v1
  s_nop 0
  v_add_f32 v1, 1.0, v1
  v_rcp_f32 v1, v1
  v_and_b32 v14, 8, v2
  v_lshlrev_b32 v14, 7, v14
  v_lshl_add_u32 v14, v8, 8, v14
  s_lshl_b32 s23, s70, 14
  s_add_u32 s23, s23, s78
  s_mov_b32 s46, 0
  s_call_b64 s[0:1], .fz_kernel_hw
  s_waitcnt vmcnt(0)
  s_cmp_ge_u32 s17, 14
  s_cbranch_scc1 .fz_kernel_c_ng
  s_setprio 2
  v_mfma_f32_16x16x32_bf16 v[224:227], v[208:211], v[80:83], 0
  v_mfma_f32_16x16x32_bf16 v[228:231], v[208:211], v[84:87], 0
  v_mfma_f32_16x16x32_bf16 v[232:235], v[208:211], v[88:91], 0
  v_mfma_f32_16x16x32_bf16 v[236:239], v[208:211], v[92:95], 0
  v_mfma_f32_16x16x32_bf16 v[240:243], v[208:211], v[96:99], 0
  v_mfma_f32_16x16x32_bf16 v[244:247], v[208:211], v[100:103], 0
  v_mfma_f32_16x16x32_bf16 v[248:251], v[208:211], v[104:107], 0
  v_mfma_f32_16x16x32_bf16 v[252:255], v[208:211], v[108:111], 0
  v_mfma_f32_16x16x32_bf16 v[224:227], v[212:215], v[112:115], v[224:227]
  v_mfma_f32_16x16x32_bf16 v[228:231], v[212:215], v[116:119], v[228:231]
  v_mfma_f32_16x16x32_bf16 v[232:235], v[212:215], v[120:123], v[232:235]
  v_mfma_f32_16x16x32_bf16 v[236:239], v[212:215], v[124:127], v[236:239]
  v_mfma_f32_16x16x32_bf16 v[240:243], v[212:215], v[128:131], v[240:243]
  v_mfma_f32_16x16x32_bf16 v[244:247], v[212:215], v[132:135], v[244:247]
  v_mfma_f32_16x16x32_bf16 v[248:251], v[212:215], v[136:139], v[248:251]
  v_mfma_f32_16x16x32_bf16 v[252:255], v[212:215], v[140:143], v[252:255]
  v_mfma_f32_16x16x32_bf16 v[224:227], v[216:219], v[144:147], v[224:227]
  v_mfma_f32_16x16x32_bf16 v[228:231], v[216:219], v[148:151], v[228:231]
  v_mfma_f32_16x16x32_bf16 v[232:235], v[216:219], v[152:155], v[232:235]
  v_mfma_f32_16x16x32_bf16 v[236:239], v[216:219], v[156:159], v[236:239]
  v_mfma_f32_16x16x32_bf16 v[240:243], v[216:219], v[160:163], v[240:243]
  v_mfma_f32_16x16x32_bf16 v[244:247], v[216:219], v[164:167], v[244:247]
  v_mfma_f32_16x16x32_bf16 v[248:251], v[216:219], v[168:171], v[248:251]
  v_mfma_f32_16x16x32_bf16 v[252:255], v[216:219], v[172:175], v[252:255]
  v_mfma_f32_16x16x32_bf16 v[224:227], v[220:223], v[176:179], v[224:227]
  v_mfma_f32_16x16x32_bf16 v[228:231], v[220:223], v[180:183], v[228:231]
  v_mfma_f32_16x16x32_bf16 v[232:235], v[220:223], v[184:187], v[232:235]
  v_mfma_f32_16x16x32_bf16 v[236:239], v[220:223], v[188:191], v[236:239]
  v_mfma_f32_16x16x32_bf16 v[240:243], v[220:223], v[192:195], v[240:243]
  v_mfma_f32_16x16x32_bf16 v[244:247], v[220:223], v[196:199], v[244:247]
  v_mfma_f32_16x16x32_bf16 v[248:251], v[220:223], v[200:203], v[248:251]
  v_mfma_f32_16x16x32_bf16 v[252:255], v[220:223], v[204:207], v[252:255]
  s_nop 0
  v_add_f32 v208, v225, v224 row_ror:8 row_mask:0xf bank_mask:0x3
  v_add_f32 v209, v229, v228 row_ror:8 row_mask:0xf bank_mask:0x3
  v_add_f32 v210, v233, v232 row_ror:8 row_mask:0xf bank_mask:0x3
  v_add_f32 v211, v237, v236 row_ror:8 row_mask:0xf bank_mask:0x3
  v_add_f32 v208, v240, v241 row_ror:8 row_mask:0xf bank_mask:0xc
  v_add_f32 v209, v244, v245 row_ror:8 row_mask:0xf bank_mask:0xc
  v_add_f32 v210, v248, v249 row_ror:8 row_mask:0xf bank_mask:0xc
  v_add_f32 v211, v252, v253 row_ror:8 row_mask:0xf bank_mask:0xc
  v_fma_f32 v208, -v11, v28, v208
  v_fma_f32 v209, -v11, v29, v209
  v_or_b32 v208, 1, v208
  v_fma_f32 v210, -v11, v30, v210
  v_fma_f32 v211, -v11, v31, v211
  v_or_b32 v210, 1, v210
  s_mov_b64 exec, 0xffff
  buffer_store_dwordx4 v[208:211], v20, s[4:7], s21 offen offset:0 sc1
  s_mov_b64 exec, -1
  s_setprio 0
  s_cmp_eq_u32 s3, 0
  s_cbranch_scc1 .fz_kernel_hb68
  s_barrier
  s_sub_u32 s3, s3, 1
.fz_kernel_hb68:
.fz_kernel_c_ng:
  s_cmp_eq_u32 s20, 0
  s_cbranch_scc1 .fz_kernel_c_ng1
  buffer_load_dwordx4 v[200:203], v14, s[4:7], s23 offen
  s_branch .fz_kernel_c_ng2
.fz_kernel_c_ng1:
  s_cmp_eq_u32 s75, 0
  s_cbranch_scc1 .fz_kernel_c_ng2
  buffer_load_dwordx2 v[240:241], v16, s[4:7], s14 offen
  buffer_load_dwordx2 v[242:243], v16, s[4:7], s15 offen
.fz_kernel_c_ng2:
  s_cmp_ge_u32 s17, 14
  s_cbranch_scc1 .fz_kernel_c_g1
  ds_read_b64_tr_b16 v[80:81], v17 offset:0
  ds_read_b64_tr_b16 v[82:83], v17 offset:1024
  ds_read_b64_tr_b16 v[84:85], v17 offset:32
  ds_read_b64_tr_b16 v[86:87], v17 offset:1056
  ds_read_b64_tr_b16 v[88:89], v18 offset:0
  ds_read_b64_tr_b16 v[90:91], v18 offset:1024
  ds_read_b64_tr_b16 v[92:93], v18 offset:32
  ds_read_b64_tr_b16 v[94:95], v18 offset:1056
  ds_read_b64_tr_b16 v[96:97], v17 offset:2048
  ds_read_b64_tr_b16 v[98:99], v17 offset:3072
  ds_read_b64_tr_b16 v[100:101], v17 offset:2080
  ds_read_b64_tr_b16 v[102:103], v17 offset:3104
  ds_read_b64_tr_b16 v[104:105], v18 offset:2048
  s_cmp_eq_u32 s3, 0
  s_cbranch_scc1 .fz_kernel_hb79
  s_barrier
  s_sub_u32 s3, s3, 1
.fz_kernel_hb79:
  ds_read_b64_tr_b16 v[106:107], v18 offset:3072
  ds_read_b64_tr_b16 v[108:109], v18 offset:2080
  ds_read_b64_tr_b16 v[110:111], v18 offset:3104
  s_waitcnt lgkmcnt(4)
  ds_read_b64_tr_b16 v[112:113], v17 offset:4096
  ds_read_b64_tr_b16 v[114:115], v17 offset:5120
  ds_read_b64_tr_b16 v[116:117], v17 offset:4128
  ds_read_b64_tr_b16 v[118:119], v17 offset:5152
  ds_read_b64_tr_b16 v[120:121], v18 offset:4096
  ds_read_b64_tr_b16 v[122:123], v18 offset:5120
  ds_read_b64_tr_b16 v[124:125], v18 offset:4128
  ds_read_b64_tr_b16 v[126:127], v18 offset:5152
  ds_read_b64_tr_b16 v[128:129], v17 offset:6144
  ds_read_b64_tr_b16 v[130:131], v17 offset:7168
  ds_read_b64_tr_b16 v[132:133], v17 offset:6176
  ds_read_b64_tr_b16 v[134:135], v17 offset:7200
  ds_read_b64_tr_b16 v[136:137], v18 offset:6144
  ds_read_b64_tr_b16 v[138:139], v18 offset:7168
  s_cmp_eq_u32 s3, 0
  s_cbranch_scc1 .fz_kernel_hb80
  s_barrier
  s_sub_u32 s3, s3, 1
.fz_kernel_hb80:
  ds_read_b64_tr_b16 v[140:141], v18 offset:6176
  ds_read_b64_tr_b16 v[142:143], v18 offset:7200
.fz_kernel_c_g1:
  v_fma_f32 v15, -v11, v11, v15
  v_rsq_f32 v15, abs(v15)
  s_nop 0
  v_mul_f32 v179, v11, v15
  v_mul_f32 v15, 0x44800000, v15
  v_sub_f32 v179, 0, v179
  v_add_f32 v178, 1.0, v15
  v_mul_f32 v177, -1.4426950408889634, v15
  v_mul_f32 v15, v15, v15
  v_mul_f32 v1, v1, v15
  s_cmp_eq_u32 s75, 0
  s_cbranch_scc1 .fz_kernel_c_d0
  s_cmp_lg_u32 s20, 0
  s_cbranch_scc1 .fz_kernel_c_t2
  s_waitcnt vmcnt(0)
  s_call_b64 s[68:69], .fz_kernel_c_coef
  v_mov_b32 v9, 159952
  v_mov_b32 v7, s79
  ds_write_b64 v26, v[252:253] offset:6400
  ds_write_b64 v26, v[254:255] offset:6912
  ds_write_b32 v9, v7
  s_waitcnt lgkmcnt(0)
.fz_kernel_c_t2:
  s_barrier
.fz_kernel_c_d0:
  s_cmp_ge_u32 s17, 14
  s_cbranch_scc1 .fz_kernel_c_nd
  s_lshl_b32 s21, s26, 12
  s_add_u32 s21, s21, s72
  s_add_u32 s21, s21, 40960
  s_mul_i32 s27, s18, 28
  s_add_u32 s27, s27, s26
  s_lshl_b32 s27, s27, 8
  s_add_u32 s27, s27, s72
  s_add_u32 s27, s27, 155648
  s_cmp_eq_u32 s3, 0
  s_cbranch_scc1 .fz_kernel_hb70
  s_barrier
  s_sub_u32 s3, s3, 1
.fz_kernel_hb70:
  buffer_load_dwordx4 v[144:147], v21, s[4:7], s21 offen offset:0 sc1
  buffer_load_dwordx4 v[148:151], v21, s[4:7], s21 offen offset:512 sc1
  buffer_load_dwordx4 v[152:155], v21, s[4:7], s21 offen offset:1024 sc1
  buffer_load_dwordx4 v[156:159], v21, s[4:7], s21 offen offset:1536 sc1
  s_mov_b32 s38, 0
.fz_kernel_c_gu:
  s_mov_b32 s46, 0
  s_call_b64 s[0:1], .fz_kernel_hw
  s_waitcnt vmcnt(0)
  v_min3_u32 v9, v144, v146, v148
  v_min3_u32 v9, v9, v150, v152
  v_min3_u32 v9, v9, v154, v156
  v_min_u32 v9, v9, v158
  v_cmp_eq_u32 vcc, 0, v9
  v_add_f32 v160, v144, v148
  v_add_f32 v161, v145, v149
  v_add_f32 v162, v146, v150
  v_add_f32 v163, v147, v151
  s_cbranch_vccnz .fz_kernel_c_gur
.fz_kernel_c_gud:
  v_add_f32 v152, v152, v156
  v_add_f32 v153, v153, v157
  v_add_f32 v154, v154, v158
  v_add_f32 v155, v155, v159
  v_add_f32 v144, v152, v160
  v_add_f32 v145, v153, v161
  v_add_f32 v146, v154, v162
  v_add_f32 v147, v155, v163
  s_nop 0
  v_permlane32_swap_b32 v144, v146
  v_permlane32_swap_b32 v145, v147
  v_mul_f32 v148, v144, v177
  v_mul_f32 v149, v145, v177
  v_exp_f32 v148, v148
  s_cmp_eq_u32 s3, 0
  s_cbranch_scc1 .fz_kernel_hb81
  s_barrier
  s_sub_u32 s3, s3, 1
.fz_kernel_hb81:
  v_exp_f32 v149, v149
  v_mul_f32 v144, v144, v146
  v_add_f32 v148, 1.0, v148
  v_add_f32 v149, 1.0, v149
  v_rcp_f32 v148, v148
  v_rcp_f32 v149, v149
  v_mul_f32 v145, v145, v147
  v_mul_f32 v144, v144, v148
  v_mul_f32 v145, v145, v149
  v_cvt_pk_bf16_f32 v144, v144, v145
  s_waitcnt lgkmcnt(0)
  s_setprio 2
  v_mov_b32 v160, v144 row_newbcast:0 row_mask:0xf bank_mask:0xf
  v_mov_b32 v161, v144 row_newbcast:1 row_mask:0xf bank_mask:0xf
  v_mov_b32 v162, v144 row_newbcast:2 row_mask:0xf bank_mask:0xf
  v_mov_b32 v163, v144 row_newbcast:3 row_mask:0xf bank_mask:0xf
  v_mov_b32 v164, v144 row_newbcast:4 row_mask:0xf bank_mask:0xf
  v_mov_b32 v165, v144 row_newbcast:5 row_mask:0xf bank_mask:0xf
  v_mov_b32 v166, v144 row_newbcast:6 row_mask:0xf bank_mask:0xf
  v_mov_b32 v167, v144 row_newbcast:7 row_mask:0xf bank_mask:0xf
  v_mfma_f32_16x16x32_bf16 v[208:211], v[80:83], v[160:163], 0
  v_mfma_f32_16x16x32_bf16 v[212:215], v[84:87], v[160:163], 0
  v_mfma_f32_16x16x32_bf16 v[216:219], v[88:91], v[160:163], 0
  v_mfma_f32_16x16x32_bf16 v[220:223], v[92:95], v[160:163], 0
  v_mov_b32 v168, v144 row_newbcast:8 row_mask:0xf bank_mask:0xf
  v_mov_b32 v169, v144 row_newbcast:9 row_mask:0xf bank_mask:0xf
  v_mov_b32 v170, v144 row_newbcast:10 row_mask:0xf bank_mask:0xf
  v_mov_b32 v171, v144 row_newbcast:11 row_mask:0xf bank_mask:0xf
  v_mfma_f32_16x16x32_bf16 v[208:211], v[96:99], v[164:167], v[208:211]
  v_mfma_f32_16x16x32_bf16 v[212:215], v[100:103], v[164:167], v[212:215]
  v_mfma_f32_16x16x32_bf16 v[216:219], v[104:107], v[164:167], v[216:219]
  v_mfma_f32_16x16x32_bf16 v[220:223], v[108:111], v[164:167], v[220:223]
  v_mov_b32 v172, v144 row_newbcast:12 row_mask:0xf bank_mask:0xf
  v_mov_b32 v173, v144 row_newbcast:13 row_mask:0xf bank_mask:0xf
  v_mov_b32 v174, v144 row_newbcast:14 row_mask:0xf bank_mask:0xf
  v_mov_b32 v175, v144 row_newbcast:15 row_mask:0xf bank_mask:0xf
  v_mfma_f32_16x16x32_bf16 v[208:211], v[112:115], v[168:171], v[208:211]
  v_mfma_f32_16x16x32_bf16 v[212:215], v[116:119], v[168:171], v[212:215]
  v_mfma_f32_16x16x32_bf16 v[216:219], v[120:123], v[168:171], v[216:219]
  v_mfma_f32_16x16x32_bf16 v[220:223], v[124:127], v[168:171], v[220:223]
  v_mfma_f32_16x16x32_bf16 v[208:211], v[128:131], v[172:175], v[208:211]
  v_mfma_f32_16x16x32_bf16 v[212:215], v[132:135], v[172:175], v[212:215]
  v_mfma_f32_16x16x32_bf16 v[216:219], v[136:139], v[172:175], v[216:219]
  v_mfma_f32_16x16x32_bf16 v[220:223], v[140:143], v[172:175], v[220:223]
  s_mov_b32 exec_lo, 0x20002
  s_mov_b32 exec_hi, 0x20002
  s_nop 3
  v_mov_b32 v208, v212
  v_mov_b32 v209, v213
  v_mov_b32 v210, v214
  v_mov_b32 v211, v215
  s_mov_b32 exec_lo, 0x40004
  s_mov_b32 exec_hi, 0x40004
  v_mov_b32 v208, v216
  v_mov_b32 v209, v217
  v_mov_b32 v210, v218
  v_mov_b32 v211, v219
  s_mov_b32 exec_lo, 0x80008
  s_mov_b32 exec_hi, 0x80008
  v_mov_b32 v208, v220
  v_mov_b32 v209, v221
  v_mov_b32 v210, v222
  v_mov_b32 v211, v223
  s_mov_b32 exec_lo, 0xf000f
  s_mov_b32 exec_hi, 0xf000f
  v_or_b32 v208, 1, v208
  v_or_b32 v210, 1, v210
  buffer_store_dwordx4 v[208:211], v19, s[4:7], s27 offen sc1
  s_mov_b64 exec, -1
  s_setprio 0
.fz_kernel_c_nd:
  s_cmp_eq_u32 s75, 0
  s_cbranch_scc1 .fz_kernel_c_m0
  s_lshl_b32 s21, s17, 1
  s_add_u32 s21, s21, s20
  s_cmp_lg_u32 s21, 31
  s_cbranch_scc1 .fz_kernel_fin
  s_branch .fz_kernel_c_pp
.fz_kernel_c_m0:
  s_cmp_eq_u32 s79, 0
  s_cselect_b32 s21, 2, 0
  s_add_u32 s3, s3, s21
.fz_kernel_c_pp:
  s_cmp_eq_u32 s3, 0
  s_cbranch_scc1 .fz_kernel_hb82
  s_barrier
  s_sub_u32 s3, s3, 1
.fz_kernel_hb82:
  v_and_b32 v10, 7, v2
  v_lshlrev_b32 v10, 8, v10
  v_lshl_add_u32 v10, v12, 5, v10
  s_mul_i32 s21, s70, 7168
  s_add_u32 s21, s21, s72
  s_add_u32 s21, s21, 155648
  s_add_u32 s22, s21, 4096
  s_mov_b32 s24, 0x0f0f0f0f
  s_mov_b32 s25, 0x0f0f0f0f
  s_lshl_b32 s27, s18, 4
  s_add_u32 s27, s27, s17
  s_lshl_b32 s27, s27, 10
  s_add_u32 s27, s27, 0x1c84000
  v_mov_b32 v168, 1
  v_mov_b32 v169, 1
  v_mov_b32 v170, 1
  v_mov_b32 v171, 1
  v_mov_b32 v172, 1
  v_mov_b32 v173, 1
  v_mov_b32 v174, 1
  v_mov_b32 v175, 1
  s_cmp_eq_u32 s3, 0
  s_cbranch_scc1 .fz_kernel_hb71
  s_barrier
  s_sub_u32 s3, s3, 1
.fz_kernel_hb71:
  s_cmp_eq_u32 s3, 0
  s_cbranch_scc1 .fz_kernel_hb72
  s_barrier
  s_sub_u32 s3, s3, 1
.fz_kernel_hb72:
  buffer_load_dwordx4 v[144:147], v10, s[4:7], s21 offen offset:0 sc1
  buffer_load_dwordx4 v[148:151], v10, s[4:7], s21 offen offset:16 sc1
  buffer_load_dwordx4 v[152:155], v10, s[4:7], s21 offen offset:2048 sc1
  buffer_load_dwordx4 v[156:159], v10, s[4:7], s21 offen offset:2064 sc1
  buffer_load_dwordx4 v[160:163], v10, s[4:7], s22 offen offset:0 sc1
  buffer_load_dwordx4 v[164:167], v10, s[4:7], s22 offen offset:16 sc1
  s_mov_b64 exec, s[24:25]
  buffer_load_dwordx4 v[168:171], v10, s[4:7], s22 offen offset:2048 sc1
  buffer_load_dwordx4 v[172:175], v10, s[4:7], s22 offen offset:2064 sc1
  s_mov_b64 exec, -1
  s_mov_b32 s38, 0
  s_cmp_eq_u32 s20, 0
  s_cbranch_scc1 .fz_kernel_c_pu
  s_waitcnt vmcnt(8)
  v_lshlrev_b32 v184, 16, v200
  v_and_b32 v185, 0xffff0000, v200
  v_lshlrev_b32 v186, 16, v201
  v_and_b32 v187, 0xffff0000, v201
  v_lshlrev_b32 v188, 16, v202
  v_and_b32 v189, 0xffff0000, v202
  v_lshlrev_b32 v190, 16, v203
  v_and_b32 v191, 0xffff0000, v203
  v_fma_f32 v184, v184, v178, v179
  v_fma_f32 v185, v185, v178, v179
  v_fma_f32 v186, v186, v178, v179
  v_fma_f32 v187, v187, v178, v179
  v_fma_f32 v188, v188, v178, v179
  v_fma_f32 v189, v189, v178, v179
  v_fma_f32 v190, v190, v178, v179
  v_fma_f32 v191, v191, v178, v179
.fz_kernel_c_pu:
  s_mov_b32 s46, 0
  s_call_b64 s[0:1], .fz_kernel_hw
  s_waitcnt vmcnt(0)
  s_cmp_eq_u32 s3, 0
  s_cbranch_scc1 .fz_kernel_hb83
  s_barrier
  s_sub_u32 s3, s3, 1
.fz_kernel_hb83:
  v_min3_u32 v9, v144, v146, v148
  v_min3_u32 v9, v9, v150, v152
  v_min3_u32 v9, v9, v154, v156
  v_min3_u32 v9, v9, v158, v160
  v_min3_u32 v9, v9, v162, v164
  v_min3_u32 v9, v9, v166, v168
  v_min3_u32 v9, v9, v170, v172
  v_min_u32 v9, v9, v174
  v_cmp_eq_u32 vcc, 0, v9
  v_add_f32 v236, v144, v152
  v_add_f32 v237, v145, v153
  v_add_f32 v238, v146, v154
  v_add_f32 v239, v147, v155
  s_cbranch_vccnz .fz_kernel_c_pur
.fz_kernel_c_pud:
  v_add_f32 v240, v148, v156
  v_add_f32 v241, v149, v157
  v_add_f32 v242, v150, v158
  v_add_f32 v243, v151, v159
  v_add_f32 v160, v160, v168
  v_add_f32 v161, v161, v169
  v_add_f32 v162, v162, v170
  v_add_f32 v163, v163, v171
  v_add_f32 v164, v164, v172
  v_add_f32 v165, v165, v173
  v_add_f32 v166, v166, v174
  v_add_f32 v167, v167, v175
  v_add_f32 v144, v236, v160
  v_add_f32 v145, v237, v161
  v_add_f32 v146, v238, v162
  v_add_f32 v147, v239, v163
  v_add_f32 v148, v240, v164
  v_add_f32 v149, v241, v165
  v_add_f32 v150, v242, v166
  v_add_f32 v151, v243, v167
  v_add_f32 v144, v144, v144 quad_perm:[1,0,3,2] row_mask:0xf bank_mask:0xf
  v_add_f32 v145, v145, v145 quad_perm:[1,0,3,2] row_mask:0xf bank_mask:0xf
  s_cmp_eq_u32 s3, 0
  s_cbranch_scc1 .fz_kernel_hb84
  s_barrier
  s_sub_u32 s3, s3, 1
.fz_kernel_hb84:
  v_add_f32 v146, v146, v146 quad_perm:[1,0,3,2] row_mask:0xf bank_mask:0xf
  v_add_f32 v147, v147, v147 quad_perm:[1,0,3,2] row_mask:0xf bank_mask:0xf
  v_add_f32 v148, v148, v148 quad_perm:[1,0,3,2] row_mask:0xf bank_mask:0xf
  v_add_f32 v149, v149, v149 quad_perm:[1,0,3,2] row_mask:0xf bank_mask:0xf
  v_add_f32 v150, v150, v150 quad_perm:[1,0,3,2] row_mask:0xf bank_mask:0xf
  v_add_f32 v151, v151, v151 quad_perm:[1,0,3,2] row_mask:0xf bank_mask:0xf
  v_add_f32 v144, v144, v144 quad_perm:[2,3,0,1] row_mask:0xf bank_mask:0xf
  v_add_f32 v145, v145, v145 quad_perm:[2,3,0,1] row_mask:0xf bank_mask:0xf
  v_add_f32 v146, v146, v146 quad_perm:[2,3,0,1] row_mask:0xf bank_mask:0xf
  v_add_f32 v147, v147, v147 quad_perm:[2,3,0,1] row_mask:0xf bank_mask:0xf
  v_add_f32 v148, v148, v148 quad_perm:[2,3,0,1] row_mask:0xf bank_mask:0xf
  v_add_f32 v149, v149, v149 quad_perm:[2,3,0,1] row_mask:0xf bank_mask:0xf
  v_add_f32 v150, v150, v150 quad_perm:[2,3,0,1] row_mask:0xf bank_mask:0xf
  v_add_f32 v151, v151, v151 quad_perm:[2,3,0,1] row_mask:0xf bank_mask:0xf
  v_add_f32 v144, v144, v144 row_half_mirror row_mask:0xf bank_mask:0xf
  v_add_f32 v145, v145, v145 row_half_mirror row_mask:0xf bank_mask:0xf
  v_add_f32 v146, v146, v146 row_half_mirror row_mask:0xf bank_mask:0xf
  v_add_f32 v147, v147, v147 row_half_mirror row_mask:0xf bank_mask:0xf
  v_add_f32 v148, v148, v148 row_half_mirror row_mask:0xf bank_mask:0xf
  v_add_f32 v149, v149, v149 row_half_mirror row_mask:0xf bank_mask:0xf
  v_add_f32 v150, v150, v150 row_half_mirror row_mask:0xf bank_mask:0xf
  v_add_f32 v151, v151, v151 row_half_mirror row_mask:0xf bank_mask:0xf
  v_mul_f32 v144, v144, v1
  v_mul_f32 v145, v145, v1
  v_mul_f32 v146, v146, v1
  v_mul_f32 v147, v147, v1
  v_mul_f32 v148, v148, v1
  v_mul_f32 v149, v149, v1
  v_mul_f32 v150, v150, v1
  v_mul_f32 v151, v151, v1
  v_cvt_pk_bf16_f32 v180, v144, v145
  v_cvt_pk_bf16_f32 v181, v146, v147
  v_cvt_pk_bf16_f32 v182, v148, v149
  v_cvt_pk_bf16_f32 v183, v150, v151
  s_or_b32 s21, s75, s71
  s_cbranch_scc1 .fz_kernel_c_w7
  s_mul_i32 s21, s20, 384
  s_add_u32 s21, s21, s27
  s_setprio 2
  v_mfma_f32_16x16x32_bf16 v[208:211], v[180:183], v[32:35], 0
  v_mov_b32 v232, v180 row_ror:8 row_mask:0xf bank_mask:0xf
  v_mfma_f32_16x16x32_bf16 v[212:215], v[180:183], v[36:39], 0
  v_mov_b32 v233, v181 row_ror:8 row_mask:0xf bank_mask:0xf
  v_mfma_f32_16x16x32_bf16 v[216:219], v[180:183], v[40:43], 0
  v_mov_b32 v234, v182 row_ror:8 row_mask:0xf bank_mask:0xf
  v_mfma_f32_16x16x32_bf16 v[220:223], v[180:183], v[44:47], 0
  v_mov_b32 v235, v183 row_ror:8 row_mask:0xf bank_mask:0xf
  v_mfma_f32_16x16x32_bf16 v[224:227], v[180:183], v[48:51], 0
  v_mfma_f32_16x16x32_bf16 v[228:231], v[180:183], v[52:55], 0
  v_mfma_f32_16x16x32_bf16 v[208:211], v[232:235], v[56:59], v[208:211]
  v_mfma_f32_16x16x32_bf16 v[212:215], v[232:235], v[60:63], v[212:215]
  v_mfma_f32_16x16x32_bf16 v[216:219], v[232:235], v[64:67], v[216:219]
  v_mfma_f32_16x16x32_bf16 v[220:223], v[232:235], v[68:71], v[220:223]
  v_mfma_f32_16x16x32_bf16 v[224:227], v[232:235], v[72:75], v[224:227]
  v_mfma_f32_16x16x32_bf16 v[228:231], v[232:235], v[76:79], v[228:231]
  s_nop 2
  v_or_b32 v208, 1, v208
  v_mov_b32 v209, v212
  v_or_b32 v210, 1, v216
  v_mov_b32 v211, v220
  s_mov_b64 exec, 0xffff
  buffer_store_dwordx4 v[208:211], v3, s[4:7], s21 offen offset:0 sc1
  v_or_b32 v224, 1, v224
  v_mov_b32 v225, v228
  buffer_store_dwordx2 v[224:225], v16, s[4:7], s21 offen offset:256 sc1
  s_mov_b64 exec, -1
  s_setprio 0
  s_cmp_lg_u32 s20, 0
  s_cbranch_scc1 .fz_kernel_c_w7
  s_cmp_eq_u32 s79, 0
  s_cbranch_scc1 .fz_kernel_c_no2
  s_cmp_eq_u32 s3, 0
  s_cbranch_scc1 .fz_kernel_hb85
  s_barrier
  s_sub_u32 s3, s3, 1
.fz_kernel_hb85:
  v_add_u32 v13, 155648, v3
  s_lshl_b32 s21, s18, 14
  s_add_u32 s21, s21, 0x1c84000
  s_add_u32 s22, s21, 4096
  s_add_u32 s23, s21, 8192
  s_add_u32 s24, s21, 12288
  v_rcp_f32 v144, v178
  v_lshlrev_b32 v146, 1, v2
  v_sub_u32 v146, s79, v146
  v_cmp_eq_u32 s[28:29], 1, v146
  v_cmp_eq_u32 s[30:31], 2, v146
  s_nop 0
  v_cndmask_b32 v148, 0, v144, s[28:29]
  v_cndmask_b32 v149, 0, v144, s[30:31]
  s_bfm_b64 exec, 49, 0
  s_mov_b32 s38, 0
.fz_kernel_c_pd:
  buffer_load_dwordx4 v[80:83], v3, s[4:7], s21 offen offset:0 sc1
  buffer_load_dwordx4 v[84:87], v3, s[4:7], s21 offen offset:1024 sc1
  buffer_load_dwordx4 v[88:91], v3, s[4:7], s21 offen offset:2048 sc1
  buffer_load_dwordx4 v[92:95], v3, s[4:7], s21 offen offset:3072 sc1
  buffer_load_dwordx4 v[96:99], v3, s[4:7], s22 offen offset:0 sc1
  buffer_load_dwordx4 v[100:103], v3, s[4:7], s22 offen offset:1024 sc1
  buffer_load_dwordx4 v[104:107], v3, s[4:7], s22 offen offset:2048 sc1
  buffer_load_dwordx4 v[108:111], v3, s[4:7], s22 offen offset:3072 sc1
  buffer_load_dwordx4 v[112:115], v3, s[4:7], s23 offen offset:0 sc1
  buffer_load_dwordx4 v[116:119], v3, s[4:7], s23 offen offset:1024 sc1
  buffer_load_dwordx4 v[120:123], v3, s[4:7], s23 offen offset:2048 sc1
  s_cmp_eq_u32 s3, 0
  s_cbranch_scc1 .fz_kernel_hb86
  s_barrier
  s_sub_u32 s3, s3, 1
.fz_kernel_hb86:
  buffer_load_dwordx4 v[124:127], v3, s[4:7], s23 offen offset:3072 sc1
  buffer_load_dwordx4 v[128:131], v3, s[4:7], s24 offen offset:0 sc1
  buffer_load_dwordx4 v[132:135], v3, s[4:7], s24 offen offset:1024 sc1
  buffer_load_dwordx4 v[136:139], v3, s[4:7], s24 offen offset:2048 sc1
  buffer_load_dwordx4 v[140:143], v3, s[4:7], s24 offen offset:3072 sc1
  s_add_u32 s38, s38, 1
  s_mov_b32 s46, 0
  s_call_b64 s[0:1], .fz_kernel_hw
  s_waitcnt vmcnt(0)
  v_min3_u32 v9, v80, v82, v84
  v_min3_u32 v9, v9, v86, v88
  v_min3_u32 v9, v9, v90, v92
  v_min3_u32 v9, v9, v94, v96
  v_min3_u32 v9, v9, v98, v100
  v_min3_u32 v9, v9, v102, v104
  v_min3_u32 v9, v9, v106, v108
  v_min3_u32 v9, v9, v110, v112
  v_min3_u32 v9, v9, v114, v116
  v_min3_u32 v9, v9, v118, v120
  v_min3_u32 v9, v9, v122, v124
  v_min3_u32 v9, v9, v126, v128
  v_min3_u32 v9, v9, v130, v132
  v_min3_u32 v9, v9, v134, v136
  v_min3_u32 v9, v9, v138, v140
  v_min_u32 v9, v9, v142
  v_cmp_eq_u32 vcc, 0, v9
  s_cbranch_vccz .fz_kernel_c_pdd
  s_cmp_lt_u32 s38, 131072
  s_cbranch_scc1 .fz_kernel_c_pd
.fz_kernel_c_pdd:
  v_add_f32 v80, v80, v112
  v_add_f32 v81, v81, v113
  v_add_f32 v82, v82, v114
  v_add_f32 v83, v83, v115
  v_add_f32 v84, v84, v116
  s_cmp_eq_u32 s3, 0
  s_cbranch_scc1 .fz_kernel_hb87
  s_barrier
  s_sub_u32 s3, s3, 1
.fz_kernel_hb87:
  v_add_f32 v85, v85, v117
  v_add_f32 v86, v86, v118
  v_add_f32 v87, v87, v119
  v_add_f32 v88, v88, v120
  v_add_f32 v89, v89, v121
  v_add_f32 v90, v90, v122
  v_add_f32 v91, v91, v123
  v_add_f32 v92, v92, v124
  v_add_f32 v93, v93, v125
  v_add_f32 v94, v94, v126
  v_add_f32 v95, v95, v127
  v_add_f32 v96, v96, v128
  v_add_f32 v97, v97, v129
  v_add_f32 v98, v98, v130
  v_add_f32 v99, v99, v131
  v_add_f32 v100, v100, v132
  v_add_f32 v101, v101, v133
  v_add_f32 v102, v102, v134
  v_add_f32 v103, v103, v135
  v_add_f32 v104, v104, v136
  v_add_f32 v105, v105, v137
  v_add_f32 v106, v106, v138
  v_add_f32 v107, v107, v139
  v_add_f32 v108, v108, v140
  v_add_f32 v109, v109, v141
  v_add_f32 v110, v110, v142
  v_add_f32 v111, v111, v143
  v_add_f32 v80, v80, v96
  v_add_f32 v81, v81, v97
  v_add_f32 v82, v82, v98
  v_add_f32 v83, v83, v99
  v_add_f32 v84, v84, v100
  v_add_f32 v85, v85, v101
  v_add_f32 v86, v86, v102
  v_add_f32 v87, v87, v103
  v_add_f32 v88, v88, v104
  s_cmp_eq_u32 s3, 0
  s_cbranch_scc1 .fz_kernel_hb88
  s_barrier
  s_sub_u32 s3, s3, 1
.fz_kernel_hb88:
  v_add_f32 v89, v89, v105
  v_add_f32 v90, v90, v106
  v_add_f32 v91, v91, v107
  v_add_f32 v92, v92, v108
  v_add_f32 v93, v93, v109
  v_add_f32 v94, v94, v110
  v_add_f32 v95, v95, v111
  v_add_f32 v80, v80, v88
  v_add_f32 v81, v81, v89
  v_add_f32 v82, v82, v90
  v_add_f32 v83, v83, v91
  v_add_f32 v84, v84, v92
  v_add_f32 v85, v85, v93
  v_add_f32 v86, v86, v94
  v_add_f32 v87, v87, v95
  v_add_f32 v80, v80, v84
  v_add_f32 v81, v81, v85
  v_add_f32 v82, v82, v86
  v_add_f32 v83, v83, v87
  s_mov_b64 exec, -1
  v_readlane_b32 s21, v80, 48
  v_readlane_b32 s22, v82, 48
  s_nop 0
  v_mul_f32 v144, s21, v23
  v_fma_f32 v145, s22, v23, v25
  v_fma_f32 v145, -v144, v144, v145
  v_rsq_f32 v145, abs(v145)
  v_sub_f32 v144, v179, v144
  v_mul_f32 v146, v145, v178
  v_mul_f32 v147, v145, v144
  s_lshl_b32 s21, s79, 2
  s_add_u32 s21, s21, 155644
  v_mov_b32 v9, s21
  ds_write_b32 v9, v146 offset:4608
  ds_write_b32 v9, v147 offset:5120
  s_cmp_eq_u32 s3, 0
  s_cbranch_scc1 .fz_kernel_hb89
  s_barrier
  s_sub_u32 s3, s3, 1
.fz_kernel_hb89:
  v_mov_b32 v9, 159952
  v_mov_b32 v7, s79
  ds_write_b32 v9, v7
  ds_write_b64 v26, v[148:149] offset:512
  s_mov_b32 exec_hi, 0xffff
  ds_write_b128 v13, v[80:83] offset:1536
  s_mov_b64 exec, -1
  s_waitcnt lgkmcnt(0)
  s_add_u32 s3, s3, 2
.fz_kernel_c_no2:
  s_branch .fz_kernel_q_he
.fz_kernel_c_w7:
  v_lshlrev_b32 v144, 16, v180
  v_and_b32 v145, 0xffff0000, v180
  v_lshlrev_b32 v146, 16, v181
  v_and_b32 v147, 0xffff0000, v181
  v_lshlrev_b32 v148, 16, v182
  v_and_b32 v149, 0xffff0000, v182
  v_lshlrev_b32 v150, 16, v183
  v_and_b32 v151, 0xffff0000, v183
  s_cmp_lg_u32 s71, 0
  s_cbranch_scc1 .fz_kernel_c_eu
  v_add_f32 v184, v184, v144
  v_add_f32 v185, v185, v145
  v_add_f32 v186, v186, v146
  v_add_f32 v187, v187, v147
  v_add_f32 v188, v188, v148
  v_add_f32 v189, v189, v149
  v_add_f32 v190, v190, v150
  v_add_f32 v191, v191, v151
  s_cmp_lg_u32 s75, 0
  s_cbranch_scc1 .fz_kernel_c_t3
  v_mul_f32 v152, v184, v184
  v_add_f32 v154, v184, v185
  v_fmac_f32 v152, v185, v185
  v_fmac_f32 v152, v186, v186
  v_add_f32 v154, v154, v186
  v_fmac_f32 v152, v187, v187
  v_add_f32 v154, v154, v187
  s_cmp_eq_u32 s3, 0
  s_cbranch_scc1 .fz_kernel_hb90
  s_barrier
  s_sub_u32 s3, s3, 1
.fz_kernel_hb90:
  v_fmac_f32 v152, v188, v188
  v_add_f32 v154, v154, v188
  v_fmac_f32 v152, v189, v189
  v_add_f32 v154, v154, v189
  v_fmac_f32 v152, v190, v190
  v_add_f32 v154, v154, v190
  v_fmac_f32 v152, v191, v191
  v_add_f32 v154, v154, v191
  v_lshrrev_b32 v9, 5, v2
  v_lshlrev_b32 v9, 3, v9
  v_permlane32_swap_b32 v154, v152
  v_add_f32 v154, v154, v152
  s_nop 1
  v_add_f32 v154, v154, v154 row_ror:8 row_mask:0xf bank_mask:0xf
  s_nop 1
  v_add_f32 v154, v154, v154 row_bcast:15 row_mask:0xa bank_mask:0xf
  v_or_b32 v154, 1, v154
  s_mov_b32 exec_lo, 0x10000
  s_mov_b32 exec_hi, 0x10000
  buffer_store_dword v154, v9, s[4:7], s27 offen offset:768 sc1
  s_mov_b64 exec, -1
  s_cmp_eq_u32 s79, 0
  s_cbranch_scc1 .fz_kernel_q_he
  s_add_u32 s3, s3, 2
  s_mov_b32 s71, 1
  s_mov_b32 s70, s18
  s_branch .fz_kernel_c_pp
.fz_kernel_c_eu:
  v_lshlrev_b32 v9, 5, v12
  v_add_u32 v9, 155648, v9
  s_mov_b32 exec_lo, 0x01010101
  s_mov_b32 exec_hi, 0x01010101
  ds_write_b128 v9, v[144:147] offset:7424
  ds_write_b128 v9, v[148:151] offset:7440
  s_mov_b64 exec, -1
  s_waitcnt lgkmcnt(0)
  s_branch .fz_kernel_q_he
.fz_kernel_c_t3:
  s_mov_b32 s28, s56
  s_mov_b32 s29, s57
  s_mov_b32 s30, 0x400000
  s_mov_b32 s31, 0x00020000
  v_cvt_pk_bf16_f32 v144, v184, v185
  v_cvt_pk_bf16_f32 v145, v186, v187
  v_cvt_pk_bf16_f32 v146, v188, v189
  v_cvt_pk_bf16_f32 v147, v190, v191
  s_cmp_eq_u32 s3, 0
  s_cbranch_scc1 .fz_kernel_hb91
  s_barrier
  s_sub_u32 s3, s3, 1
.fz_kernel_hb91:
  v_lshlrev_b32 v9, 4, v12
  s_lshl_b32 s21, s77, 11
  s_lshl_b32 s22, s18, 7
  s_add_u32 s21, s21, s22
  s_mov_b32 exec_lo, 0x01010101
  s_mov_b32 exec_hi, 0x01010101
  buffer_store_dwordx4 v[144:147], v9, s[28:31], s21 offen
  s_mov_b64 exec, -1
.fz_kernel_fin:
.fz_kernel_end:
  s_endpgm
.fz_kernel_pick:
  s_mov_b32 s33, 1
  s_cmp_eq_u32 s34, 0xffff
  s_cselect_b32 s35, 0x40000000, s35
  s_cbranch_scc1 .fz_kernel_pick_ret
  s_mov_b32 s38, 0
.fz_kernel_pick_l:
  ds_read_b32 v7, v6
  s_add_u32 s38, s38, 1
  s_waitcnt lgkmcnt(0)
  v_readfirstlane_b32 s36, v7
  s_andn2_b32 s33, s36, s34
  s_cbranch_scc1 .fz_kernel_pick_ret
  s_cmp_lt_u32 s38, 1048576
  s_cbranch_scc1 .fz_kernel_pick_l
  s_mov_b32 s36, 0xffff
  s_andn2_b32 s33, s36, s34
.fz_kernel_pick_ret:
  s_nop 4
  s_setpc_b64 s[68:69]
.fz_kernel_hw:
  s_mov_b32 s47, 0
.fz_kernel_hwl:
  s_getreg_b32 s100, hwreg(HW_REG_IB_STS)
  s_bfe_u32 s101, s100, 0x20016
  s_and_b32 s100, s100, 15
  s_lshl4_add_u32 s100, s101, s100
  s_cmp_le_u32 s100, s46
  s_cbranch_scc1 .fz_kernel_hwr
  s_sub_u32 s47, s47, 1
  s_cbranch_scc0 .fz_kernel_hwl
  s_cmp_eq_u32 s3, 0
  s_cbranch_scc1 .fz_kernel_hwr
  s_cmp_eq_u32 s3, 32
  s_cbranch_scc1 .fz_kernel_hwp
.fz_kernel_hwb:
  s_barrier
  s_sub_u32 s3, s3, 1
  s_mov_b32 s47, 2
  s_branch .fz_kernel_hwl
.fz_kernel_hwr:
  s_setpc_b64 s[0:1]
  .fz_kernel_hwp:
  ds_read_b32 v27, v6 offset:0x110
  s_mov_b32 s47, 0
  s_waitcnt lgkmcnt(0)
  v_readfirstlane_b32 s100, v27
  s_cmp_ge_u32 s100, 0x200
  s_cbranch_scc1 .fz_kernel_hwb
  s_branch .fz_kernel_hwl
.fz_kernel_q_cons2:
  s_setprio 0
  s_lshr_b32 s26, s16, 1
  s_lshl_b32 s28, s26, 13
  v_add_u32 v8, s28, v3
  v_add_u32 v9, 1024, v8
  v_mov_b32 v232, v20
  v_mov_b32 v233, v21
  v_mov_b32 v234, v22
  v_mov_b32 v235, v23
  v_mov_b32 v236, v24
  v_mov_b32 v237, v25
  v_mov_b32 v238, v26
  v_mov_b32 v239, v27
  v_mov_b32 v240, v28
  v_mov_b32 v241, v29
  v_mov_b32 v242, v30
  v_mov_b32 v243, v31
  v_mov_b32 v244, v32
  v_mov_b32 v245, v33
  v_mov_b32 v246, v34
  v_mov_b32 v247, v35
  s_branch .fz_kernel_q_cs
.fz_kernel_q_patch:
  s_mul_i32 s31, s27, 384
  s_add_u32 s31, s31, 155648
  v_and_b32 v73, 48, v2
  v_lshlrev_b32 v73, 2, v73
  v_add_u32 v73, s31, v73
  v_and_b32 v75, 15, v2
  v_lshlrev_b32 v75, 3, v75
  v_add_u32 v75, s31, v75
  ds_read_b32 v72, v14 offset:512
  ds_read_b32 v74, v14 offset:576
  ds_read_b32 v76, v14 offset:640
  ds_read_b32 v78, v14 offset:704
  ds_read_b128 v[80:83], v73 offset:1536
  ds_read_b128 v[84:87], v73 offset:1552
  ds_read_b128 v[88:91], v73 offset:1568
  ds_read_b128 v[92:95], v73 offset:1584
  s_waitcnt lgkmcnt(0)
  v_fmac_f32 v160, v82, v72
  v_fmac_f32 v161, v86, v72
  v_fmac_f32 v162, v90, v72
  v_fmac_f32 v163, v94, v72
  v_fmac_f32 v164, v82, v74
  v_fmac_f32 v165, v86, v74
  v_fmac_f32 v166, v90, v74
  v_fmac_f32 v167, v94, v74
  v_fmac_f32 v168, v82, v76
  v_fmac_f32 v169, v86, v76
  v_fmac_f32 v170, v90, v76
  v_fmac_f32 v171, v94, v76
  v_fmac_f32 v172, v82, v78
  v_fmac_f32 v173, v86, v78
  v_fmac_f32 v174, v90, v78
  v_fmac_f32 v175, v94, v78
  v_fmac_f32 v176, v83, v72
  v_fmac_f32 v177, v87, v72
  v_fmac_f32 v178, v91, v72
  v_fmac_f32 v179, v95, v72
  v_fmac_f32 v180, v83, v74
  v_fmac_f32 v181, v87, v74
  v_fmac_f32 v182, v91, v74
  v_fmac_f32 v183, v95, v74
  v_fmac_f32 v184, v83, v76
  v_fmac_f32 v185, v87, v76
  v_fmac_f32 v186, v91, v76
  v_fmac_f32 v187, v95, v76
  v_fmac_f32 v188, v83, v78
  v_fmac_f32 v189, v87, v78
  v_fmac_f32 v190, v91, v78
  v_fmac_f32 v191, v95, v78
  v_fmac_f32 v128, v80, v72
  v_fmac_f32 v129, v84, v72
  v_fmac_f32 v130, v88, v72
  v_fmac_f32 v131, v92, v72
  v_fmac_f32 v132, v80, v74
  v_fmac_f32 v133, v84, v74
  v_fmac_f32 v134, v88, v74
  v_fmac_f32 v135, v92, v74
  v_fmac_f32 v136, v80, v76
  v_fmac_f32 v137, v84, v76
  v_fmac_f32 v138, v88, v76
  v_fmac_f32 v139, v92, v76
  v_fmac_f32 v140, v80, v78
  v_fmac_f32 v141, v84, v78
  v_fmac_f32 v142, v88, v78
  v_fmac_f32 v143, v92, v78
  v_fmac_f32 v144, v81, v72
  v_fmac_f32 v145, v85, v72
  v_fmac_f32 v146, v89, v72
  v_fmac_f32 v147, v93, v72
  v_fmac_f32 v148, v81, v74
  v_fmac_f32 v149, v85, v74
  v_fmac_f32 v150, v89, v74
  v_fmac_f32 v151, v93, v74
  v_fmac_f32 v152, v81, v76
  v_fmac_f32 v153, v85, v76
  v_fmac_f32 v154, v89, v76
  v_fmac_f32 v155, v93, v76
  v_fmac_f32 v156, v81, v78
  v_fmac_f32 v157, v85, v78
  v_fmac_f32 v158, v89, v78
  v_fmac_f32 v159, v93, v78
  ds_read_b128 v[80:83], v15 offset:512
  ds_read_b128 v[84:87], v15 offset:576
  ds_read_b128 v[88:91], v15 offset:640
  ds_read_b128 v[92:95], v15 offset:704
  ds_read_b64 v[72:73], v75 offset:1792
  s_waitcnt lgkmcnt(0)
  v_fmac_f32 v192, v80, v72
  v_fmac_f32 v193, v81, v72
  v_fmac_f32 v194, v82, v72
  v_fmac_f32 v195, v83, v72
  v_fmac_f32 v196, v84, v72
  v_fmac_f32 v197, v85, v72
  v_fmac_f32 v198, v86, v72
  v_fmac_f32 v199, v87, v72
  v_fmac_f32 v200, v88, v72
  v_fmac_f32 v201, v89, v72
  v_fmac_f32 v202, v90, v72
  v_fmac_f32 v203, v91, v72
  v_fmac_f32 v204, v92, v72
  v_fmac_f32 v205, v93, v72
  v_fmac_f32 v206, v94, v72
  v_fmac_f32 v207, v95, v72
  v_fmac_f32 v208, v80, v73
  v_fmac_f32 v209, v81, v73
  v_fmac_f32 v210, v82, v73
  v_fmac_f32 v211, v83, v73
  v_fmac_f32 v212, v84, v73
  v_fmac_f32 v213, v85, v73
  v_fmac_f32 v214, v86, v73
  v_fmac_f32 v215, v87, v73
  v_fmac_f32 v216, v88, v73
  v_fmac_f32 v217, v89, v73
  v_fmac_f32 v218, v90, v73
  v_fmac_f32 v219, v91, v73
  v_fmac_f32 v220, v92, v73
  v_fmac_f32 v221, v93, v73
  v_fmac_f32 v222, v94, v73
  v_fmac_f32 v223, v95, v73
  s_branch .fz_kernel_q_pback
.fz_kernel_q_prod2:
  s_mov_b64 s[8:9], s[4:5]
  s_mov_b64 s[10:11], s[6:7]
  s_lshl_b32 s35, s17, 6
  s_and_b32 s31, s16, 1
  s_add_u32 s35, s35, s31
  s_lshl_b32 s35, s35, 12
  s_add_u32 s35, s35, s73
  s_lshr_b32 s33, s17, 3
  s_add_u32 s29, s18, s33
  s_lshl1_add_u32 s29, s17, s29
  s_and_b32 s29, s29, 15
  s_mov_b32 s22, 16384
  s_mov_b32 s23, 8192
  s_mov_b32 s36, 0
  s_add_u32 s37, s19, s74
  s_add_u32 s37, s37, 8
  v_mov_b32 v40, v3
  v_mov_b32 v41, v3
  v_mov_b32 v42, v3
  v_mov_b32 v43, v3
  s_branch .fz_kernel_q_pc
.fz_kernel_xok1w:
  s_call_b64 s[68:69], .fz_kernel_q_xw
  s_branch .fz_kernel_xok1
.fz_kernel_xok2w:
  s_call_b64 s[68:69], .fz_kernel_q_xw
  s_branch .fz_kernel_xok2
.fz_kernel_q_xw:
  s_mov_b64 exec, 1
  s_mov_b32 s38, 0
.fz_kernel_q_xwl:
  buffer_load_dword v11, v4, s[4:7], s37 offen sc1
  s_add_u32 s38, s38, 1
  s_waitcnt vmcnt(0)
  v_readfirstlane_b32 s36, v11
  s_bitcmp1_b32 s36, s24
  s_cbranch_scc1 .fz_kernel_q_xwd
  s_cmp_lt_u32 s38, 131072
  s_cbranch_scc1 .fz_kernel_q_xwl
  s_mov_b32 s36, -1
.fz_kernel_q_xwd:
  s_mov_b64 exec, -1
  s_nop 4
  s_setpc_b64 s[68:69]
.fz_kernel_xok3w:
  s_call_b64 s[68:69], .fz_kernel_q_xw
  s_branch .fz_kernel_xok3
.fz_kernel_lz20a:
  v_lshlrev_b32 v16, 3, v2
  buffer_atomic_and_x2 v[12:13], v16, s[4:7], s36 offen offset:0 sc1
  buffer_atomic_and_x2 v[12:13], v16, s[4:7], s36 offen offset:512 sc1
  buffer_atomic_and_x2 v[12:13], v16, s[4:7], s36 offen offset:1024 sc1
  buffer_atomic_and_x2 v[12:13], v16, s[4:7], s36 offen offset:1536 sc1
  buffer_atomic_and_x2 v[12:13], v16, s[4:7], s36 offen offset:2048 sc1
  buffer_atomic_and_x2 v[12:13], v16, s[4:7], s36 offen offset:2560 sc1
  buffer_atomic_and_x2 v[12:13], v16, s[4:7], s36 offen offset:3072 sc1
  buffer_atomic_and_x2 v[12:13], v16, s[4:7], s36 offen offset:3584 sc1
  s_branch .fz_kernel_lz20
.fz_kernel_a_pick:
  s_cmp_eq_u32 s34, 0xffff
  s_cbranch_scc1 .fz_kernel_a_picke
  s_mov_b32 s38, 0
.fz_kernel_a_pickl:
  ds_read_b32 v7, v6
  s_add_u32 s38, s38, 1
  s_waitcnt lgkmcnt(0)
  v_readfirstlane_b32 s33, v7
  s_cmp_lt_u32 s38, 1048576
  s_cselect_b32 s33, s33, 0xffff
  s_andn2_b32 s36, s33, s34
  s_cbranch_scc0 .fz_kernel_a_pickl
  s_or_b32 s34, s34, s33
  s_ff1_i32_b32 s33, s36
  s_bitset0_b32 s36, s33
  s_lshl_b32 s33, s33, 14
  s_add_u32 s30, s33, s35
  s_setpc_b64 s[68:69]
.fz_kernel_a_picke:
  s_mov_b32 s30, 0x40000000
  ds_write_b32 v6, v5 offset:0x104
  s_setpc_b64 s[68:69]
.fz_kernel_pk26c:
  s_call_b64 s[68:69], .fz_kernel_a_pick
  s_branch .fz_kernel_pk26
.fz_kernel_pk27c:
  s_call_b64 s[68:69], .fz_kernel_a_pick
  s_branch .fz_kernel_pk27
.fz_kernel_pk28c:
  s_call_b64 s[68:69], .fz_kernel_a_pick
  s_branch .fz_kernel_pk28
.fz_kernel_pk31c:
  s_call_b64 s[68:69], .fz_kernel_a_pick
  s_branch .fz_kernel_pk31
.fz_kernel_pk32c:
  s_call_b64 s[68:69], .fz_kernel_a_pick
  s_branch .fz_kernel_pk32
.fz_kernel_a_slow:
  s_cmp_lg_u32 s73, 0
  s_cbranch_scc1 .fz_kernel_a_ok
  s_mov_b32 s73, 1
  s_call_b64 s[68:69], .fz_kernel_a_sl
  v_mov_b32 v32, v33
  v_mov_b32 v176, v144
  v_mov_b32 v177, v145
  v_mov_b32 v178, v146
  v_mov_b32 v179, v147
  v_mov_b32 v180, v148
  v_mov_b32 v181, v149
  v_mov_b32 v182, v150
  v_mov_b32 v183, v151
  v_mov_b32 v184, v152
  v_mov_b32 v185, v153
  v_mov_b32 v186, v154
  v_mov_b32 v187, v155
  v_mov_b32 v188, v156
  v_mov_b32 v189, v157
  v_mov_b32 v190, v158
  v_mov_b32 v191, v159
  v_mov_b32 v16, v24
  v_mov_b32 v17, v25
  v_mov_b32 v18, v26
  v_mov_b32 v19, v27
  v_mov_b32 v20, v28
  v_mov_b32 v21, v29
  v_mov_b32 v22, v30
  v_mov_b32 v23, v31
  s_call_b64 s[68:69], .fz_kernel_a_sl
  v_mov_b32 v160, v144
  v_mov_b32 v144, v176
  v_mov_b32 v161, v145
  v_mov_b32 v145, v177
  v_mov_b32 v162, v146
  v_mov_b32 v146, v178
  v_mov_b32 v163, v147
  v_mov_b32 v147, v179
  v_mov_b32 v164, v148
  v_mov_b32 v148, v180
  v_mov_b32 v165, v149
  v_mov_b32 v149, v181
  v_mov_b32 v166, v150
  v_mov_b32 v150, v182
  v_mov_b32 v167, v151
  v_mov_b32 v151, v183
  v_mov_b32 v168, v152
  v_mov_b32 v152, v184
  v_mov_b32 v169, v153
  v_mov_b32 v153, v185
  v_mov_b32 v170, v154
  v_mov_b32 v154, v186
  v_mov_b32 v171, v155
  v_mov_b32 v155, v187
  v_mov_b32 v172, v156
  v_mov_b32 v156, v188
  v_mov_b32 v173, v157
  v_mov_b32 v157, v189
  v_mov_b32 v174, v158
  v_mov_b32 v158, v190
  v_mov_b32 v175, v159
  v_mov_b32 v159, v191
  s_branch .fz_kernel_a_fin
.fz_kernel_a_sl:
  s_waitcnt vmcnt(0)
  s_lshl_b32 s36, s18, 1
  s_add_u32 s36, s36, s39
  s_lshl_b32 s36, s36, 18
  s_add_u32 s36, s36, s63
  s_mov_b32 s30, s36
  s_mov_b32 s33, 64
  v_mov_b32 v36, 0xff800000
.fz_kernel_a_s1:
  buffer_load_dwordx4 v[80:83], v3, s[4:7], s30 offen offset:0
  buffer_load_dwordx4 v[84:87], v3, s[4:7], s30 offen offset:1024
  s_waitcnt vmcnt(0)
  v_mfma_f32_32x32x16_bf16 v[48:63], v[80:83], v[16:19], 0
  v_mfma_f32_32x32x16_bf16 v[48:63], v[84:87], v[20:23], v[48:63]
  s_nop 11
  v_max3_f32 v36, v36, v48, v49
  v_max3_f32 v36, v36, v50, v51
  v_max3_f32 v36, v36, v52, v53
  v_max3_f32 v36, v36, v54, v55
  v_max3_f32 v36, v36, v56, v57
  v_max3_f32 v36, v36, v58, v59
  v_max3_f32 v36, v36, v60, v61
  v_max3_f32 v36, v36, v62, v63
  s_add_u32 s30, s30, 4096
  s_sub_u32 s33, s33, 1
  s_cmp_lg_u32 s33, 0
  s_cbranch_scc1 .fz_kernel_a_s1
  v_mov_b32 v35, v36
  s_nop 1
  v_permlane32_swap_b32 v35, v36
  v_max_f32 v36, v36, v35
  v_sub_f32 v36, 0, v36
  v_mov_b32 v64, v36
  v_mov_b32 v144, 0
  v_mov_b32 v65, v36
  v_mov_b32 v145, 0
  v_mov_b32 v66, v36
  v_mov_b32 v146, 0
  v_mov_b32 v67, v36
  v_mov_b32 v147, 0
  v_mov_b32 v68, v36
  v_mov_b32 v148, 0
  v_mov_b32 v69, v36
  v_mov_b32 v149, 0
  v_mov_b32 v70, v36
  v_mov_b32 v150, 0
  v_mov_b32 v71, v36
  v_mov_b32 v151, 0
  v_mov_b32 v72, v36
  v_mov_b32 v152, 0
  v_mov_b32 v73, v36
  v_mov_b32 v153, 0
  v_mov_b32 v74, v36
  v_mov_b32 v154, 0
  v_mov_b32 v75, v36
  v_mov_b32 v155, 0
  v_mov_b32 v76, v36
  v_mov_b32 v156, 0
  v_mov_b32 v77, v36
  v_mov_b32 v157, 0
  v_mov_b32 v78, v36
  v_mov_b32 v158, 0
  v_mov_b32 v79, v36
  v_mov_b32 v159, 0
  v_mov_b32 v208, 0
  v_mov_b32 v209, 0
  v_mov_b32 v210, 0
  v_mov_b32 v211, 0
  s_mov_b32 s30, s36
  s_mov_b32 s33, 64
.fz_kernel_a_s2:
  buffer_load_dwordx4 v[80:83], v3, s[4:7], s30 offen offset:0
  buffer_load_dwordx4 v[84:87], v3, s[4:7], s30 offen offset:1024
  buffer_load_dwordx4 v[88:91], v3, s[4:7], s30 offen offset:2048
  buffer_load_dwordx4 v[92:95], v3, s[4:7], s30 offen offset:3072
  s_waitcnt vmcnt(0)
  v_mfma_f32_32x32x16_bf16 v[48:63], v[80:83], v[16:19], v[64:79]
  v_mfma_f32_32x32x16_bf16 v[48:63], v[84:87], v[20:23], v[48:63]
  s_nop 11
  v_exp_f32 v48, v48
  v_exp_f32 v49, v49
  v_exp_f32 v50, v50
  v_exp_f32 v51, v51
  v_exp_f32 v52, v52
  v_exp_f32 v53, v53
  v_exp_f32 v54, v54
  v_exp_f32 v55, v55
  v_exp_f32 v56, v56
  v_exp_f32 v57, v57
  v_exp_f32 v58, v58
  v_exp_f32 v59, v59
  v_exp_f32 v60, v60
  v_exp_f32 v61, v61
  v_exp_f32 v62, v62
  v_exp_f32 v63, v63
  v_cvt_pk_bf16_f32 v224, v48, v49
  v_cvt_pk_bf16_f32 v225, v50, v51
  v_cvt_pk_bf16_f32 v226, v52, v53
  v_cvt_pk_bf16_f32 v227, v54, v55
  v_cvt_pk_bf16_f32 v228, v56, v57
  v_cvt_pk_bf16_f32 v229, v58, v59
  v_cvt_pk_bf16_f32 v230, v60, v61
  v_cvt_pk_bf16_f32 v231, v62, v63
  v_mfma_f32_32x32x16_bf16 v[144:159], v[88:91], v[224:227], v[144:159]
  s_nop 0
  v_mfma_f32_32x32x16_bf16 v[144:159], v[92:95], v[228:231], v[144:159]
  v_smfmac_f32_16x16x64_bf16 v[208:211], v[12:15], v[224:231], v11
  s_add_u32 s30, s30, 4096
  s_sub_u32 s33, s33, 1
  s_cmp_lg_u32 s33, 0
  s_cbranch_scc1 .fz_kernel_a_s2
  s_nop 7
  v_add_f32 v208, v208, v210
  v_add_f32 v209, v209, v211
  v_cndmask_b32 v33, v208, v209, s[34:35]
  s_nop 7
  s_setpc_b64 s[68:69]
.fz_kernel_serv:
  s_setprio 3
  s_mov_b32 s24, s44
  s_mov_b32 s25, s45
  s_mov_b32 s26, 0x200000
  s_mov_b32 s27, 0x00020000
  v_lshrrev_b32 v8, 3, v2
  v_and_b32 v9, 7, v2
  v_bfe_u32 v10, v2, 4, 1
  v_lshlrev_b32 v10, 2, v10
  v_xor_b32 v9, v9, v10
  v_lshlrev_b32 v9, 4, v9
  v_lshl_add_u32 v10, v8, 11, v9
  s_cmp_eq_u32 s16, 5
  s_cbranch_scc1 .fz_kernel_sv1
  s_barrier
  v_lshlrev_b32 v7, 7, v2
  s_lshl_b32 s31, s18, 11
  s_lshl_b32 s33, 1, s17
  s_add_u32 s31, s31, s67
  s_add_u32 s31, s31, 0x1800000
  v_mov_b32 v8, s33
  s_mov_b64 exec, 0xffff
  s_mov_b32 s38, 0
.fz_kernel_cw33:
  s_sleep 1
  ds_read_u8 v9, v6 offset:256
  s_add_u32 s38, s38, 1
  s_waitcnt lgkmcnt(0)
  v_cmp_gt_u32 vcc, 4, v9
  s_cbranch_vccz .fz_kernel_cw33d
  s_cmp_lt_u32 s38, 8388608
  s_cbranch_scc1 .fz_kernel_cw33
.fz_kernel_cw33d:
  buffer_atomic_or v8, v7, s[4:7], s31 offen sc1
  s_mov_b64 exec, -1
  s_setprio 0
  s_mov_b32 s38, 0
.fz_kernel_kw34:
  s_sleep 2
  ds_read_b32 v7, v6 offset:0
  s_add_u32 s38, s38, 1
  s_waitcnt lgkmcnt(0)
  v_readfirstlane_b32 s31, v7
  s_bcnt1_i32_b32 s31, s31
  s_cmp_ge_u32 s31, 16
  s_cbranch_scc1 .fz_kernel_kw34d
  s_cmp_lt_u32 s38, 1048576
  s_cbranch_scc1 .fz_kernel_kw34
.fz_kernel_kw34d:
  s_branch .fz_kernel_sv2
.fz_kernel_sv1:
  s_add_u32 s37, s19, s67
  s_mov_b64 exec, 1
  buffer_load_dword v7, v4, s[4:7], s37 offen sc1
  s_waitcnt vmcnt(0)
  ds_or_b32 v6, v7
  buffer_load_dword v9, v4, s[4:7], s37 offen sc1
  s_barrier
  s_waitcnt vmcnt(0)
  ds_or_b32 v6, v9
  s_add_u32 s37, s19, s67
  s_mov_b64 exec, 1
  s_mov_b32 s38, 0
.fz_kernel_po35:
  buffer_load_dword v7, v4, s[4:7], s37 offen offset:0 sc1
  s_add_u32 s38, s38, 1
  s_waitcnt vmcnt(0)
  ds_or_b32 v6, v7 offset:0
  v_cmp_ne_u32 vcc, 0xffff, v7
  s_cbranch_vccz .fz_kernel_po35d
  s_cmp_lt_u32 s38, 131072
  s_cbranch_scc1 .fz_kernel_po35
.fz_kernel_po35d:
  s_mov_b64 exec, -1
  s_setprio 0
  s_mov_b32 s38, 0
.fz_kernel_kw36:
  s_sleep 2
  ds_read_b32 v7, v6 offset:0
  s_add_u32 s38, s38, 1
  s_waitcnt lgkmcnt(0)
  v_readfirstlane_b32 s31, v7
  s_bcnt1_i32_b32 s31, s31
  s_cmp_ge_u32 s31, 16
  s_cbranch_scc1 .fz_kernel_kw36d
  s_cmp_lt_u32 s38, 1048576
  s_cbranch_scc1 .fz_kernel_kw36
.fz_kernel_kw36d:
.fz_kernel_sv2:
  s_and_b32 s30, s16, 1
  s_lshl_b32 s30, s30, 16
  s_add_u32 s32, s30, 65536
  s_lshl_b32 s31, s18, 7
  v_add_u32 v10, s31, v10
.fz_kernel_sv3:
  s_mov_b32 m0, s30
  s_lshl_b32 s31, s30, 4
  s_add_u32 s30, s30, 1024
  buffer_load_dwordx4 v10, s[24:27], s31 offen  lds
  s_cmp_lg_u32 s30, s32
  s_waitcnt vmcnt(3)
  s_cbranch_scc1 .fz_kernel_sv3
  s_cmp_lg_u32 s62, 0
  s_cbranch_scc1 .fz_kernel_wt37
  s_mov_b32 s12, s42
  s_mov_b32 s13, s43
  s_mov_b32 s14, 0x600000
  s_mov_b32 s15, 0x00020000
  s_and_b32 s30, s16, 1
  s_lshl1_add_u32 s30, s17, s30
  s_and_b32 s30, s30, 15
  s_mul_i32 s30, s30, 393216
  s_lshl_b32 s31, s18, 7
  s_add_u32 s30, s30, s31
  v_mul_u32_u24 v11, 6144, v2
  buffer_load_dword v1, v11, s[12:15], s30 offen
  s_add_u32 s30, s30, 2048
  s_waitcnt vmcnt(0)
  buffer_load_dword v1, v11, s[12:15], s30 offen
  s_add_u32 s30, s30, 2048
  s_waitcnt vmcnt(0)
  buffer_load_dword v1, v11, s[12:15], s30 offen
  s_add_u32 s30, s30, 2048
  s_waitcnt vmcnt(0)
.fz_kernel_wt37:
  s_cmp_lg_u32 s16, 4
  s_cbranch_scc1 .fz_kernel_ct38e
  s_getpc_b64 s[0:1]
.fz_kernel_ct38:
  s_sub_u32 s0, s0, .fz_kernel_ct38-fz_kernel
  s_subb_u32 s1, s1, 0
  s_lshr_b32 s31, s2, 3
  s_mulk_i32 s31, 0x500
  v_lshl_add_u32 v1, v2, 7, s31
  v_min_u32 v1, .fz_kernel_last-fz_kernel, v1
  s_mov_b64 exec, 0x3ff
  global_load_dword v1, v1, s[0:1]
  s_mov_b64 exec, -1
.fz_kernel_ct38e:
  s_waitcnt vmcnt(0)
  s_cmp_lg_u32 s16, 5
  s_cbranch_scc1 .fz_kernel_sv35
  s_mov_b64 exec, 1
  s_mov_b32 s38, 0
.fz_kernel_sv34:
  s_sleep 4
  buffer_load_dword v7, v4, s[4:7], s37 offen offset:4 sc1
  ds_read_b32 v8, v6 offset:0x104
  s_add_u32 s38, s38, 1
  s_waitcnt vmcnt(0) lgkmcnt(0)
  ds_or_b32 v6, v7 offset:8
  v_cmp_ne_u32 vcc, 0, v8
  s_cbranch_vccnz .fz_kernel_sv35
  s_cmp_lt_u32 s38, 131072
  s_cbranch_scc1 .fz_kernel_sv34
.fz_kernel_sv35:
  s_mov_b64 exec, -1
  s_setprio 3
  s_barrier
  s_cmp_eq_u32 s16, 5
  s_cbranch_scc1 .fz_kernel_sv4
  v_lshlrev_b32 v7, 11, v2
  s_lshl_b32 s31, s17, 7
  s_lshl_b32 s33, 1, s18
  s_add_u32 s31, s31, s67
  s_add_u32 s31, s31, 0x1800004
  v_mov_b32 v8, s33
  s_mov_b64 exec, 0xffff
  s_mov_b32 s38, 0
.fz_kernel_cw39:
  s_sleep 1
  ds_read_u8 v9, v6 offset:264
  s_add_u32 s38, s38, 1
  s_waitcnt lgkmcnt(0)
  v_cmp_gt_u32 vcc, 4, v9
  s_cbranch_vccz .fz_kernel_cw39d
  s_cmp_lt_u32 s38, 8388608
  s_cbranch_scc1 .fz_kernel_cw39
.fz_kernel_cw39d:
  buffer_atomic_or v8, v7, s[4:7], s31 offen sc1
  s_mov_b64 exec, -1
  s_mov_b64 exec, 1
  ds_or_b32 v6, v8 offset:8
  s_mov_b64 exec, -1
  s_branch .fz_kernel_sv5
.fz_kernel_sv4:
  s_add_u32 s37, s19, s67
  s_mov_b64 exec, 1
  s_mov_b32 s38, 0
.fz_kernel_po40:
  buffer_load_dword v7, v4, s[4:7], s37 offen offset:4 sc1
  s_add_u32 s38, s38, 1
  s_waitcnt vmcnt(0)
  ds_or_b32 v6, v7 offset:8
  v_cmp_ne_u32 vcc, 0xffff, v7
  s_cbranch_vccz .fz_kernel_po40d
  s_cmp_lt_u32 s38, 131072
  s_cbranch_scc1 .fz_kernel_po40
.fz_kernel_po40d:
  s_mov_b64 exec, -1
.fz_kernel_sv5:
  s_mov_b32 s72, s66
  s_mov_b32 s73, s65
  s_mov_b32 s74, s67
  s_mov_b32 s75, s62
  s_cmp_lg_u32 s62, 0
  s_cbranch_scc1 .fz_kernel_w_lt
  s_mov_b32 s62, 1
  s_mov_b32 s63, 0x2000000
  s_mov_b32 s64, 0x2800000
  s_mov_b32 s65, 0x1400000
  s_mov_b32 s66, 0x1c42000
  s_mov_b32 s67, 12
  s_mov_b32 s71, 159776
  v_mov_b32 v6, 159832
  s_branch .fz_kernel_q_prod2
.fz_kernel_w_lt:
  s_barrier
  s_barrier
  s_branch .fz_kernel_fin
.fz_kernel_pk41c:
  s_call_b64 s[68:69], .fz_kernel_pick
  s_branch .fz_kernel_pk41
.fz_kernel_pk42c:
  s_call_b64 s[68:69], .fz_kernel_pick
  s_branch .fz_kernel_pk42
.fz_kernel_pk43c:
  s_call_b64 s[68:69], .fz_kernel_pick
  s_branch .fz_kernel_pk43
.fz_kernel_w_pt:
  v_lshlrev_b32 v44, 5, v17
  v_add_u32 v44, 155648, v44
  s_mov_b64 exec, vcc
  ds_read_b128 v[232:235], v44 offset:7424
  ds_read_b128 v[236:239], v44 offset:7440
  ds_read_b128 v[240:243], v44 offset:7488
  ds_read_b128 v[244:247], v44 offset:7504
  s_waitcnt lgkmcnt(0)
  v_pk_add_f32 v[64:65], v[64:65], v[232:233]
  v_pk_add_f32 v[66:67], v[66:67], v[234:235]
  v_pk_add_f32 v[68:69], v[68:69], v[236:237]
  v_pk_add_f32 v[70:71], v[70:71], v[238:239]
  v_pk_add_f32 v[72:73], v[72:73], v[240:241]
  v_pk_add_f32 v[74:75], v[74:75], v[242:243]
  v_pk_add_f32 v[76:77], v[76:77], v[244:245]
  v_pk_add_f32 v[78:79], v[78:79], v[246:247]
  ds_read_b128 v[232:235], v44 offset:7552
  ds_read_b128 v[236:239], v44 offset:7568
  ds_read_b128 v[240:243], v44 offset:7616
  ds_read_b128 v[244:247], v44 offset:7632
  s_waitcnt lgkmcnt(0)
  v_pk_add_f32 v[80:81], v[80:81], v[232:233]
  v_pk_add_f32 v[82:83], v[82:83], v[234:235]
  v_pk_add_f32 v[84:85], v[84:85], v[236:237]
  v_pk_add_f32 v[86:87], v[86:87], v[238:239]
  v_pk_add_f32 v[88:89], v[88:89], v[240:241]
  v_pk_add_f32 v[90:91], v[90:91], v[242:243]
  v_pk_add_f32 v[92:93], v[92:93], v[244:245]
  v_pk_add_f32 v[94:95], v[94:95], v[246:247]
  s_mov_b64 exec, -1
  s_branch .fz_kernel_w_pb
.fz_kernel_pk44c:
  s_call_b64 s[68:69], .fz_kernel_pick
  s_branch .fz_kernel_pk44
.fz_kernel_pk45c:
  s_call_b64 s[68:69], .fz_kernel_pick
  s_branch .fz_kernel_pk45
.fz_kernel_pk46c:
  s_call_b64 s[68:69], .fz_kernel_pick
  s_branch .fz_kernel_pk46
.fz_kernel_pk47c:
  s_call_b64 s[68:69], .fz_kernel_pick
  s_branch .fz_kernel_pk47
.fz_kernel_pk48c:
  s_call_b64 s[68:69], .fz_kernel_pick
  s_branch .fz_kernel_pk48
.fz_kernel_pk49c:
  s_call_b64 s[68:69], .fz_kernel_pick
  s_branch .fz_kernel_pk49
.fz_kernel_pk50c:
  s_call_b64 s[68:69], .fz_kernel_pick
  s_branch .fz_kernel_pk50
.fz_kernel_pk51c:
  s_call_b64 s[68:69], .fz_kernel_pick
  s_branch .fz_kernel_pk51
.fz_kernel_pk52c:
  s_call_b64 s[68:69], .fz_kernel_pick
  s_branch .fz_kernel_pk52
.fz_kernel_pk53c:
  s_call_b64 s[68:69], .fz_kernel_pick
  s_branch .fz_kernel_pk53
.fz_kernel_pk54c:
  s_call_b64 s[68:69], .fz_kernel_pick
  s_branch .fz_kernel_pk54
.fz_kernel_pk55c:
  s_call_b64 s[68:69], .fz_kernel_pick
  s_branch .fz_kernel_pk55
.fz_kernel_pk56c:
  s_call_b64 s[68:69], .fz_kernel_pick
  s_branch .fz_kernel_pk56
.fz_kernel_pk57c:
  s_call_b64 s[68:69], .fz_kernel_pick
  s_branch .fz_kernel_pk57
.fz_kernel_pk58c:
  s_call_b64 s[68:69], .fz_kernel_pick
  s_branch .fz_kernel_pk58
.fz_kernel_pk59c:
  s_call_b64 s[68:69], .fz_kernel_pick
  s_branch .fz_kernel_pk59
.fz_kernel_c_nl:
  s_barrier
  s_branch .fz_kernel_c_np
.fz_kernel_c_coef:
  v_fma_f32 v242, -v240, v240, v242
  v_fma_f32 v243, -v241, v241, v243
  v_rsq_f32 v248, abs(v242)
  v_rsq_f32 v249, abs(v243)
  v_mul_f32 v254, v240, v248
  v_sub_f32 v254, 0, v254
  v_mov_b32 v252, 1.0
  v_fmac_f32 v252, 0x44800000, v248
  v_fma_f32 v242, v242, v24, -v25
  v_max_f32 v242, 0, v242
  v_mul_f32 v248, v252, v252
  v_fma_f32 v248, v248, v242, v25
  v_rsq_f32 v248, v248
  v_mul_f32 v240, v23, v240
  v_mul_f32 v248, v248, v252
  v_mul_f32 v250, v248, v240
  v_sub_f32 v250, 0, v250
  v_mul_f32 v255, v241, v249
  v_sub_f32 v255, 0, v255
  v_mov_b32 v253, 1.0
  v_fmac_f32 v253, 0x44800000, v249
  s_cmp_eq_u32 s3, 0
  s_cbranch_scc1 .fz_kernel_hb69
  s_barrier
  s_sub_u32 s3, s3, 1
.fz_kernel_hb69:
  v_fma_f32 v243, v243, v24, -v25
  v_max_f32 v243, 0, v243
  v_mul_f32 v249, v253, v253
  v_fma_f32 v249, v249, v243, v25
  v_rsq_f32 v249, v249
  v_mul_f32 v241, v23, v241
  v_mul_f32 v249, v249, v253
  v_mul_f32 v251, v249, v241
  v_sub_f32 v251, 0, v251
  s_setpc_b64 s[68:69]
.fz_kernel_c_gur:
  v_min_u32 v9, v144, v146
  v_cmp_eq_u32 s[8:9], 0, v9
  v_min_u32 v9, v148, v150
  v_cmp_eq_u32 s[10:11], 0, v9
  v_min_u32 v9, v152, v154
  v_cmp_eq_u32 s[12:13], 0, v9
  v_min_u32 v9, v156, v158
  v_cmp_eq_u32 s[14:15], 0, v9
  s_add_u32 s38, s38, 1
  s_cmp_ge_u32 s38, 131072
  s_cbranch_scc1 .fz_kernel_c_gud
  s_or_b64 exec, s[8:9], 1
  buffer_load_dwordx4 v[144:147], v21, s[4:7], s21 offen offset:0 sc1
  s_or_b64 exec, s[10:11], 1
  buffer_load_dwordx4 v[148:151], v21, s[4:7], s21 offen offset:512 sc1
  s_or_b64 exec, s[12:13], 1
  buffer_load_dwordx4 v[152:155], v21, s[4:7], s21 offen offset:1024 sc1
  s_or_b64 exec, s[14:15], 1
  buffer_load_dwordx4 v[156:159], v21, s[4:7], s21 offen offset:1536 sc1
  s_mov_b64 exec, -1
  s_branch .fz_kernel_c_gu
.fz_kernel_c_pur:
  v_min3_u32 v9, v144, v146, v148
  v_min_u32 v9, v9, v150
  v_cmp_eq_u32 s[8:9], 0, v9
  v_min3_u32 v9, v152, v154, v156
  v_min_u32 v9, v9, v158
  v_cmp_eq_u32 s[10:11], 0, v9
  v_min3_u32 v9, v160, v162, v164
  v_min_u32 v9, v9, v166
  v_cmp_eq_u32 s[12:13], 0, v9
  v_min3_u32 v9, v168, v170, v172
  v_min_u32 v9, v9, v174
  v_cmp_eq_u32 s[14:15], 0, v9
  s_cmp_eq_u32 s3, 0
  s_cbranch_scc1 .fz_kernel_hb73
  s_barrier
  s_sub_u32 s3, s3, 1
.fz_kernel_hb73:
  s_add_u32 s38, s38, 1
  s_cmp_ge_u32 s38, 131072
  s_cbranch_scc1 .fz_kernel_c_pud
  s_or_b64 exec, s[8:9], 1
  buffer_load_dwordx4 v[144:147], v10, s[4:7], s21 offen offset:0 sc1
  buffer_load_dwordx4 v[148:151], v10, s[4:7], s21 offen offset:16 sc1
  s_or_b64 exec, s[10:11], 1
  buffer_load_dwordx4 v[152:155], v10, s[4:7], s21 offen offset:2048 sc1
  buffer_load_dwordx4 v[156:159], v10, s[4:7], s21 offen offset:2064 sc1
  s_or_b64 exec, s[12:13], 1
  buffer_load_dwordx4 v[160:163], v10, s[4:7], s22 offen offset:0 sc1
  buffer_load_dwordx4 v[164:167], v10, s[4:7], s22 offen offset:16 sc1
  s_or_b64 exec, s[14:15], 1
  buffer_load_dwordx4 v[168:171], v10, s[4:7], s22 offen offset:2048 sc1
  buffer_load_dwordx4 v[172:175], v10, s[4:7], s22 offen offset:2064 sc1
  s_mov_b64 exec, -1
  s_branch .fz_kernel_c_pu
.fz_kernel_last:
  s_endpgm

.section .rodata,"a"
.p2align 6
.amdhsa_kernel fz_kernel
  .amdhsa_next_free_vgpr 256
  .amdhsa_next_free_sgpr 102
  .amdhsa_accum_offset 256
  .amdhsa_group_segment_fixed_size 0
  .amdhsa_kernarg_size 88
  .amdhsa_user_sgpr_count 2
  .amdhsa_user_sgpr_kernarg_segment_ptr 1
  .amdhsa_system_sgpr_workgroup_id_x 1
.end_amdhsa_kernel
```

```asm
; @launch kernel=fz_kernel grid=(256,1,1) block=(512,1,1) lds=163840
.amdgcn_target "amdgcn-amd-amdhsa--gfx950"
.text
.globl fz_kernel
.p2align 8
.type fz_kernel,@function
fz_kernel:
  s_cmp_ge_u32 s2, 256
  s_cbranch_scc1 .fz_kernel_end
  s_load_dwordx2 s[8:9], s[0:1], 0
  s_load_dwordx2 s[12:13], s[0:1], 8
  s_load_dwordx2 s[4:5], s[0:1], 80
  s_load_dwordx16 s[40:55], s[0:1], 0
  s_load_dwordx4 s[56:59], s[0:1], 64
  v_lshrrev_b32 v1, 6, v0
  v_and_b32 v2, 63, v0
  v_readfirstlane_b32 s16, v1
  s_and_b32 s21, s2, 7
  s_lshr_b32 s22, s2, 3
  s_and_b32 s23, s21, 3
  s_lshl_b32 s23, s23, 2
  s_and_b32 s24, s22, 3
  s_add_u32 s18, s23, s24
  s_lshr_b32 s24, s21, 2
  s_lshl_b32 s24, s24, 3
  s_lshr_b32 s25, s22, 2
  s_add_u32 s17, s24, s25
  s_lshl_b32 s19, s18, 4
  s_add_u32 s19, s19, s17
  s_lshl_b32 s19, s19, 7
  s_add_u32 s19, s19, 0x1800000
  v_lshlrev_b32 v3, 4, v2
  v_mov_b32 v4, 0
  v_mov_b32 v5, 1
  s_mov_b32 s6, 0x2c00000
  s_mov_b32 s7, 0x00020000
  s_mov_b32 s62, 0
  s_mov_b32 s63, 0x400000
  s_mov_b32 s64, 0xc00000
  s_mov_b32 s65, 0x1000000
  s_mov_b32 s66, 0x1c00000
  s_mov_b32 s67, 0
  s_mov_b32 s71, 159744
  v_mov_b32 v6, 159808
  s_cmp_lt_u32 s16, 4
  s_cbranch_scc1 .fz_kernel_q_cons1
  s_cmp_ge_u32 s16, 6
  s_cbranch_scc1 .fz_kernel_q_help1
  s_mov_b32 s10, 0x400000
  s_mov_b32 s11, 0x00020000
  v_lshrrev_b32 v20, 3, v2
  v_and_b32 v21, 7, v2
  v_lshrrev_b32 v22, 4, v2
  v_xor_b32 v23, v21, v22
  v_lshlrev_b32 v23, 4, v23
  v_lshl_add_u32 v24, v20, 11, v23
  v_xor_b32 v25, 64, v24
  s_lshl_b32 s35, s17, 2
  s_and_b32 s31, s16, 1
  s_add_u32 s35, s35, s31
  s_lshl_b32 s35, s35, 16
  s_and_b32 s29, s18, 12
  s_lshr_b32 s33, s17, 3
  s_lshl1_add_u32 s29, s33, s29
  s_lshl2_add_u32 s29, s17, s29
  s_and_b32 s29, s29, 15
  s_mov_b32 s22, 128
  s_mov_b32 s23, 131072
  s_mov_b32 s36, -1
  v_add_u32 v40, 0, v24
  v_add_u32 v41, 15360, v25
  v_add_u32 v42, 30720, v24
  v_add_u32 v43, 46080, v25
.fz_kernel_q_pc:
  s_mov_b32 s14, 0x600000
  s_mov_b32 s15, 0x00020000
  v_lshrrev_b32 v28, 3, v2
  v_and_b32 v29, 7, v2
  v_bfe_u32 v30, v2, 4, 1
  v_lshlrev_b32 v30, 1, v30
  v_xor_b32 v31, v29, v30
  v_lshlrev_b32 v31, 4, v31
  v_mul_u32_u24 v28, 6144, v28
  v_add_u32 v28, v28, v31
  v_xor_b32 v29, 64, v28
  s_lshl_b32 s32, s18, 7
  s_add_u32 s39, s32, 6291456
  s_mul_i32 s33, s29, 393216
  s_add_u32 s33, s33, s32
  s_lshl_b32 s29, s29, 1
  s_mul_i32 s25, s31, 6144
  s_add_u32 s25, s25, 65536
  s_mov_b32 s30, s25
  s_add_u32 s26, s25, 49152
  s_lshl_b32 s21, s31, 12
  s_cmp_eq_u32 s31, 0
  s_mov_b32 s24, 100352
  s_cselect_b32 s24, 0, s24
  v_add_u32 v32, s24, v28
  s_mov_b32 s24, 148480
  s_cselect_b32 s24, 48128, s24
  v_add_u32 v33, s24, v29
  s_mov_b32 s24, 2048
  s_cselect_b32 s24, 96256, s24
  v_add_u32 v34, s24, v28
  s_mov_b32 s24, 50176
  s_cselect_b32 s24, 144384, s24
  v_add_u32 v35, s24, v29
  s_mov_b32 s24, 102400
  s_cselect_b32 s24, 2048, s24
  v_add_u32 v36, s24, v28
  s_mov_b32 s24, 150528
  s_cselect_b32 s24, 50176, s24
  v_add_u32 v37, s24, v29
  s_cmp_lg_u32 s62, 0
  s_cbranch_scc1 .fz_kernel_q_st2
  s_waitcnt lgkmcnt(0)
  s_mov_b32 s34, 32
  s_call_b64 s[0:1], .fz_kernel_q_ix
  s_call_b64 s[0:1], .fz_kernel_q_iu
  s_call_b64 s[0:1], .fz_kernel_q_iu
  s_call_b64 s[0:1], .fz_kernel_q_iu
  s_waitcnt vmcnt(20)
  s_barrier
  s_call_b64 s[0:1], .fz_kernel_q_iu
  s_waitcnt vmcnt(24)
  s_barrier
  s_call_b64 s[0:1], .fz_kernel_q_iu
  s_branch .fz_kernel_q_pl
.fz_kernel_q_ix:
  s_bfe_u32 s24, s29, 0x40001
  s_mul_i32 s20, s24, s22
  s_bitcmp1_b32 s29, 0
  s_cselect_b32 s31, s23, 0
  s_add_u32 s20, s20, s35
  s_add_u32 s20, s20, s31
  s_bitcmp1_b32 s36, s24
  s_cbranch_scc0 .fz_kernel_xok1w
.fz_kernel_xok1:
  s_mov_b32 m0, s21
  s_add_u32 s21, s21, 8192
  s_and_b32 s21, s21, 0xffff
  s_add_u32 s29, s29, 1
  buffer_load_dwordx4 v40, s[8:11], s20 offen offset:0 lds
  buffer_load_dwordx4 v41, s[8:11], s20 offen offset:1024 lds
  buffer_load_dwordx4 v42, s[8:11], s20 offen offset:2048 lds
  buffer_load_dwordx4 v43, s[8:11], s20 offen offset:3072 lds
  s_setpc_b64 s[0:1]
.fz_kernel_q_iu:
  s_mov_b32 m0, s30
  s_add_u32 s30, s30, 12288
  buffer_load_dwordx4 v32, s[12:15], s33 offen offset:0 lds
  s_bfe_u32 s24, s29, 0x40001
  buffer_load_dwordx4 v33, s[12:15], s33 offen offset:1024 lds
  s_mul_i32 s20, s24, s22
  buffer_load_dwordx4 v34, s[12:15], s33 offen offset:2048 lds
  s_bitcmp1_b32 s29, 0
  s_cselect_b32 s31, s23, 0
  buffer_load_dwordx4 v35, s[12:15], s33 offen offset:3072 lds
  s_add_u32 m0, m0, 4096
  s_add_u32 s20, s20, s35
  buffer_load_dwordx4 v36, s[12:15], s33 offen offset:0 lds
  s_add_u32 s20, s20, s31
  buffer_load_dwordx4 v37, s[12:15], s33 offen offset:1024 lds
  s_bitcmp1_b32 s36, s24
  s_cbranch_scc0 .fz_kernel_xok2w
.fz_kernel_xok2:
  s_mov_b32 m0, s21
  s_add_u32 s21, s21, 8192
  s_and_b32 s21, s21, 0xffff
  s_add_u32 s29, s29, 1
  buffer_load_dwordx4 v40, s[8:11], s20 offen offset:0 lds
  s_add_u32 s33, s33, 196608
  s_cmp_eq_u32 s33, s39
  s_cselect_b32 s33, s32, s33
  buffer_load_dwordx4 v41, s[8:11], s20 offen offset:1024 lds
  s_cmp_eq_u32 s30, s26
  s_cselect_b32 s30, s25, s30
  buffer_load_dwordx4 v42, s[8:11], s20 offen offset:2048 lds
  s_sub_u32 s34, s34, 1
  s_cmp_lg_u32 s34, 0
  buffer_load_dwordx4 v43, s[8:11], s20 offen offset:3072 lds
  s_setpc_b64 s[0:1]
.fz_kernel_q_iw:
  s_mov_b32 m0, s30
  s_add_u32 s30, s30, 12288
  buffer_load_dwordx4 v32, s[12:15], s33 offen offset:0 lds
  s_nop 0
  buffer_load_dwordx4 v33, s[12:15], s33 offen offset:1024 lds
  s_nop 0
  buffer_load_dwordx4 v34, s[12:15], s33 offen offset:2048 lds
  s_nop 0
  buffer_load_dwordx4 v35, s[12:15], s33 offen offset:3072 lds
  s_add_u32 m0, m0, 4096
  s_nop 0
  buffer_load_dwordx4 v36, s[12:15], s33 offen offset:0 lds
  buffer_load_dwordx4 v37, s[12:15], s33 offen offset:1024 lds
  s_add_u32 s33, s33, 196608
  s_cmp_eq_u32 s33, s39
  s_cselect_b32 s33, s32, s33
  s_cmp_eq_u32 s30, s26
  s_cselect_b32 s30, s25, s30
  s_sub_u32 s34, s34, 1
  s_cmp_lg_u32 s34, 0
  s_setpc_b64 s[0:1]
.fz_kernel_q_st2:
  s_mov_b32 s34, 32
  s_waitcnt vmcnt(0)
  s_barrier
  s_call_b64 s[0:1], .fz_kernel_q_iw
  s_call_b64 s[0:1], .fz_kernel_q_iw
  s_call_b64 s[0:1], .fz_kernel_q_iw
  s_call_b64 s[0:1], .fz_kernel_q_iw
  s_call_b64 s[0:1], .fz_kernel_q_ix
  s_call_b64 s[0:1], .fz_kernel_q_ix
  s_mov_b64 exec, 1
  s_waitcnt vmcnt(20)
  ds_add_u32 v6, v5 offset:0x110
  s_mov_b64 exec, -1
  v_mov_b32 v12, 0x100
  s_call_b64 s[0:1], .fz_kernel_q_ix
  s_call_b64 s[0:1], .fz_kernel_q_ix
  s_waitcnt vmcnt(8)
  s_mov_b64 exec, 1
  ds_add_u32 v6, v12 offset:0x110
  s_mov_b64 exec, -1
  s_barrier
  s_waitcnt vmcnt(8)
  s_barrier
  s_call_b64 s[0:1], .fz_kernel_q_ix
  s_call_b64 s[0:1], .fz_kernel_q_iu
  s_waitcnt vmcnt(14)
  s_barrier
  s_call_b64 s[0:1], .fz_kernel_q_iu
  s_waitcnt vmcnt(20)
  s_barrier
  s_call_b64 s[0:1], .fz_kernel_q_iu
.fz_kernel_q_pl:
  s_waitcnt vmcnt(20)
  s_barrier
  s_mov_b32 m0, s30
  s_add_u32 s30, s30, 12288
  buffer_load_dwordx4 v32, s[12:15], s33 offen offset:0 lds
  s_bfe_u32 s24, s29, 0x40001
  buffer_load_dwordx4 v33, s[12:15], s33 offen offset:1024 lds
  s_mul_i32 s20, s24, s22
  buffer_load_dwordx4 v34, s[12:15], s33 offen offset:2048 lds
  s_bitcmp1_b32 s29, 0
  s_cselect_b32 s31, s23, 0
  buffer_load_dwordx4 v35, s[12:15], s33 offen offset:3072 lds
  s_add_u32 m0, m0, 4096
  s_add_u32 s20, s20, s35
  buffer_load_dwordx4 v36, s[12:15], s33 offen offset:0 lds
  s_add_u32 s20, s20, s31
  buffer_load_dwordx4 v37, s[12:15], s33 offen offset:1024 lds
  s_bitcmp1_b32 s36, s24
  s_cbranch_scc0 .fz_kernel_xok3w
.fz_kernel_xok3:
  s_mov_b32 m0, s21
  s_add_u32 s21, s21, 8192
  s_and_b32 s21, s21, 0xffff
  s_add_u32 s29, s29, 1
  buffer_load_dwordx4 v40, s[8:11], s20 offen offset:0 lds
  s_add_u32 s33, s33, 196608
  s_cmp_eq_u32 s33, s39
  s_cselect_b32 s33, s32, s33
  buffer_load_dwordx4 v41, s[8:11], s20 offen offset:1024 lds
  s_cmp_eq_u32 s30, s26
  s_cselect_b32 s30, s25, s30
  buffer_load_dwordx4 v42, s[8:11], s20 offen offset:2048 lds
  s_sub_u32 s34, s34, 1
  s_cmp_lg_u32 s34, 0
  buffer_load_dwordx4 v43, s[8:11], s20 offen offset:3072 lds
  s_cbranch_scc1 .fz_kernel_q_pl
  s_waitcnt vmcnt(20)
  s_barrier
  s_waitcnt vmcnt(10)
  s_barrier
  s_waitcnt vmcnt(0)
  s_barrier
  s_barrier
  s_branch .fz_kernel_serv
.fz_kernel_q_cons1:
  s_waitcnt lgkmcnt(0)
  s_mov_b32 s12, s42
  s_mov_b32 s13, s43
  s_mov_b32 s14, 0x600000
  s_mov_b32 s15, 0x00020000
  s_and_b32 s20, s18, 4
  s_add_u32 s20, s20, s16
  s_cmp_ge_u32 s20, 3
  s_cbranch_scc1 .fz_kernel_q_nsp
  s_and_b32 s20, s17, 7
  s_and_b32 s21, s18, 3
  s_lshl2_add_u32 s20, s20, s21
  s_mul_i32 s20, s20, 196608
  s_or_b32 s21, s18, 3
  s_lshl4_add_u32 s21, s16, s21
  s_lshl_b32 s21, s21, 7
  s_add_u32 s20, s20, s21
  v_mul_u32_u24 v20, 6144, v2
  s_mov_b32 exec_hi, 0
  buffer_load_dword v231, v20, s[12:15], s20 offen
  s_mov_b32 exec_hi, -1
.fz_kernel_q_nsp:
  v_lshlrev_b32 v20, 2, v0
  v_add_u32 v20, 159744, v20
  s_cmp_ge_u32 s16, 2
  s_cbranch_scc1 .fz_kernel_q_nz
  ds_write_b32 v20, v4
.fz_kernel_q_nz:
  s_lshr_b32 s26, s16, 1
  s_lshl_b32 s28, s26, 13
  v_and_b32 v20, 15, v2
  v_lshrrev_b32 v21, 4, v2
  v_bfe_u32 v22, v2, 1, 3
  v_xor_b32 v22, v22, v21
  v_lshlrev_b32 v20, 7, v20
  v_lshl_add_u32 v20, v22, 4, v20
  v_add_u32 v8, s28, v20
  v_xor_b32 v9, 64, v8
.fz_kernel_q_cs:
  s_and_b32 s27, s16, 1
  s_lshl_b32 s28, s27, 1
  v_lshrrev_b32 v14, 4, v2
  v_bfe_u32 v15, v2, 2, 2
  v_lshl_add_u32 v16, v14, 3, v15
  v_lshlrev_b32 v16, 7, v16
  v_and_b32 v14, 1, v14
  v_lshrrev_b32 v15, 1, v15
  v_lshl_add_u32 v14, v14, 1, v15
  v_xor_b32 v14, s28, v14
  v_lshl_add_u32 v16, v14, 5, v16
  v_and_b32 v14, 3, v2
  v_lshl_add_u32 v16, v14, 3, v16
  v_add_u32 v12, 65536, v16
  v_xor_b32 v13, 32, v12
  v_mov_b32 v10, v12
  v_mov_b32 v11, v13
  s_mov_b32 s29, 16
  s_mov_b32 s30, 0
  v_mov_b32 v128, 0
  v_mov_b32 v129, 0
  v_mov_b32 v130, 0
  v_mov_b32 v131, 0
  v_mov_b32 v132, 0
  v_mov_b32 v133, 0
  v_mov_b32 v134, 0
  v_mov_b32 v135, 0
  v_mov_b32 v136, 0
  v_mov_b32 v137, 0
  v_mov_b32 v138, 0
  v_mov_b32 v139, 0
  v_mov_b32 v140, 0
  v_mov_b32 v141, 0
  v_mov_b32 v142, 0
  v_mov_b32 v143, 0
  v_mov_b32 v144, 0
  v_mov_b32 v145, 0
  v_mov_b32 v146, 0
  v_mov_b32 v147, 0
  v_mov_b32 v148, 0
  v_mov_b32 v149, 0
  v_mov_b32 v150, 0
  v_mov_b32 v151, 0
  v_mov_b32 v152, 0
  v_mov_b32 v153, 0
  v_mov_b32 v154, 0
  v_mov_b32 v155, 0
  v_mov_b32 v156, 0
  v_mov_b32 v157, 0
  v_mov_b32 v158, 0
  v_mov_b32 v159, 0
  v_mov_b32 v160, 0
  v_mov_b32 v161, 0
  v_mov_b32 v162, 0
  v_mov_b32 v163, 0
  v_mov_b32 v164, 0
  v_mov_b32 v165, 0
  v_mov_b32 v166, 0
  v_mov_b32 v167, 0
  v_mov_b32 v168, 0
  v_mov_b32 v169, 0
  v_mov_b32 v170, 0
  v_mov_b32 v171, 0
  v_mov_b32 v172, 0
  v_mov_b32 v173, 0
  v_mov_b32 v174, 0
  v_mov_b32 v175, 0
  s_cmp_eq_u32 s62, 0
  s_cbranch_scc1 .fz_kernel_q_i1
  s_mov_b64 exec, 1
  s_waitcnt vmcnt(0)
  ds_add_u32 v1, v5 offset:0x100
  s_mov_b64 exec, -1
.fz_kernel_q_i1:
  v_mov_b32 v176, 0
  v_mov_b32 v177, 0
  v_mov_b32 v178, 0
  v_mov_b32 v179, 0
  v_mov_b32 v180, 0
  v_mov_b32 v181, 0
  v_mov_b32 v182, 0
  v_mov_b32 v183, 0
  v_mov_b32 v184, 0
  v_mov_b32 v185, 0
  v_mov_b32 v186, 0
  v_mov_b32 v187, 0
  v_mov_b32 v188, 0
  v_mov_b32 v189, 0
  v_mov_b32 v190, 0
  v_mov_b32 v191, 0
  v_mov_b32 v192, 0
  v_mov_b32 v193, 0
  v_mov_b32 v194, 0
  v_mov_b32 v195, 0
  v_mov_b32 v196, 0
  v_mov_b32 v197, 0
  v_mov_b32 v198, 0
  v_mov_b32 v199, 0
  v_mov_b32 v200, 0
  v_mov_b32 v201, 0
  v_mov_b32 v202, 0
  v_mov_b32 v203, 0
  v_mov_b32 v204, 0
  v_mov_b32 v205, 0
  v_mov_b32 v206, 0
  v_mov_b32 v207, 0
  v_mov_b32 v208, 0
  v_mov_b32 v209, 0
  v_mov_b32 v210, 0
  v_mov_b32 v211, 0
  v_mov_b32 v212, 0
  v_mov_b32 v213, 0
  v_mov_b32 v214, 0
  v_mov_b32 v215, 0
  v_mov_b32 v216, 0
  v_mov_b32 v217, 0
  v_mov_b32 v218, 0
  v_mov_b32 v219, 0
  v_mov_b32 v220, 0
  v_mov_b32 v221, 0
  v_mov_b32 v222, 0
  v_mov_b32 v223, 0
  v_and_b32 v14, 1, v2
  v_lshlrev_b32 v14, 4, v14
  v_mov_b32 v15, 0x3f80
  v_lshlrev_b32 v14, v14, v15
  v_mov_b32 v248, 0
  v_mov_b32 v249, 0
  v_mov_b32 v250, 0
  v_mov_b32 v251, 0
  v_mov_b32 v252, 0
  v_mov_b32 v253, 0
  v_mov_b32 v254, 0
  v_mov_b32 v255, 0
  s_mov_b32 exec_lo, 0x3
  s_mov_b32 exec_hi, 0x30
  v_mov_b32 v248, v14
  s_mov_b32 exec_lo, 0xc
  s_mov_b32 exec_hi, 0xc0
  v_mov_b32 v249, v14
  s_mov_b32 exec_lo, 0x300
  s_mov_b32 exec_hi, 0x3000
  v_mov_b32 v250, v14
  s_mov_b32 exec_lo, 0xc00
  s_mov_b32 exec_hi, 0xc000
  v_mov_b32 v251, v14
  s_mov_b32 exec_lo, 0x30000
  s_mov_b32 exec_hi, 0x300000
  v_mov_b32 v252, v14
  s_mov_b32 exec_lo, 0xc0000
  s_mov_b32 exec_hi, 0xc00000
  v_mov_b32 v253, v14
  s_mov_b32 exec_lo, 0x3000000
  s_mov_b32 exec_hi, 0x30000000
  v_mov_b32 v254, v14
  s_mov_b32 exec_lo, 0xc000000
  s_mov_b32 exec_hi, 0xc0000000
  v_mov_b32 v255, v14
  s_mov_b64 exec, -1
  s_mov_b32 s12, s40
  s_mov_b32 s13, s41
  s_mov_b32 s14, 0x400000
  s_mov_b32 s15, 0x00020000
  v_lshrrev_b32 v14, 5, v2
  v_and_b32 v15, 31, v2
  v_lshlrev_b32 v14, 4, v14
  v_lshl_add_u32 v15, v15, 11, v14
  s_lshl2_add_u32 s23, s17, s16
  s_lshl_b32 s23, s23, 16
  s_lshl_b32 s22, s18, 7
  s_add_u32 s23, s22, s23
  s_waitcnt lgkmcnt(0)
  s_barrier
  ds_read_b64_tr_b16 v[56:57], v10 offset:4096
  ds_read_b64_tr_b16 v[58:59], v10 offset:4608
  ds_read_b128 v[32:35], v8 offset:0
  ds_read_b128 v[36:39], v8 offset:2048
  ds_read_b128 v[40:43], v8 offset:4096
  ds_read_b128 v[44:47], v8 offset:6144
  ds_read_b64_tr_b16 v[60:61], v11 offset:4096
  ds_read_b64_tr_b16 v[62:63], v11 offset:4608
  ds_read_b64_tr_b16 v[64:65], v10 offset:8192
  ds_read_b64_tr_b16 v[66:67], v10 offset:8704
  ds_read_b64_tr_b16 v[68:69], v11 offset:8192
  ds_read_b64_tr_b16 v[70:71], v11 offset:8704
  ds_read_b64_tr_b16 v[48:49], v10 offset:0
  ds_read_b64_tr_b16 v[50:51], v10 offset:512
  ds_read_b64_tr_b16 v[52:53], v11 offset:0
  ds_read_b64_tr_b16 v[54:55], v11 offset:512
  s_add_u32 s30, s30, 12288
  s_cmp_eq_u32 s30, 49152
  s_cselect_b32 s30, 0, s30
  v_add_u32 v8, 0x4000, v8
  v_add_u32 v10, s30, v12
  v_add_u32 v11, s30, v13
  v_and_b32 v8, 0xffff, v8
  s_waitcnt lgkmcnt(0)
  s_branch .fz_kernel_q_l0
  .p2align 6
.fz_kernel_q_loop:
  v_mfma_f32_16x16x32_bf16 v[148:151], v[52:55], v[36:39], v[148:151]
  v_mfma_f32_16x16x32_bf16 v[152:155], v[52:55], v[40:43], v[152:155]
  s_waitcnt lgkmcnt(0)
  v_mfma_f32_16x16x32_bf16 v[156:159], v[52:55], v[44:47], v[156:159]
  s_barrier
  v_mfma_f32_16x16x32_bf16 v[160:163], v[96:99], v[72:75], v[160:163]
  ds_read_b64_tr_b16 v[56:57], v10 offset:4096
  v_mfma_f32_16x16x32_bf16 v[164:167], v[96:99], v[76:79], v[164:167]
  ds_read_b64_tr_b16 v[58:59], v10 offset:4608
  v_mfma_f32_16x16x32_bf16 v[168:171], v[96:99], v[80:83], v[168:171]
  ds_read_b128 v[32:35], v8 offset:0
  v_mfma_f32_16x16x32_bf16 v[172:175], v[96:99], v[84:87], v[172:175]
  ds_read_b128 v[36:39], v8 offset:2048
  v_mfma_f32_16x16x32_bf16 v[176:179], v[100:103], v[72:75], v[176:179]
  ds_read_b128 v[40:43], v8 offset:4096
  v_mfma_f32_16x16x32_bf16 v[180:183], v[100:103], v[76:79], v[180:183]
  ds_read_b128 v[44:47], v8 offset:6144
  v_mfma_f32_16x16x32_bf16 v[184:187], v[100:103], v[80:83], v[184:187]
  ds_read_b64_tr_b16 v[60:61], v11 offset:4096
  v_mfma_f32_16x16x32_bf16 v[188:191], v[100:103], v[84:87], v[188:191]
  ds_read_b64_tr_b16 v[62:63], v11 offset:4608
  v_mfma_f32_16x16x32_bf16 v[192:195], v[72:75], v[104:107], v[192:195]
  ds_read_b64_tr_b16 v[64:65], v10 offset:8192
  s_add_u32 s30, s30, 12288
  v_mfma_f32_16x16x32_bf16 v[196:199], v[76:79], v[104:107], v[196:199]
  ds_read_b64_tr_b16 v[66:67], v10 offset:8704
  s_cmp_eq_u32 s30, 49152
  v_mfma_f32_16x16x32_bf16 v[200:203], v[80:83], v[104:107], v[200:203]
  ds_read_b64_tr_b16 v[68:69], v11 offset:8192
  s_cselect_b32 s30, 0, s30
  v_mfma_f32_16x16x32_bf16 v[204:207], v[84:87], v[104:107], v[204:207]
  ds_read_b64_tr_b16 v[70:71], v11 offset:8704
  v_mfma_f32_16x16x32_bf16 v[208:211], v[72:75], v[108:111], v[208:211]
  ds_read_b64_tr_b16 v[48:49], v10 offset:0
  v_mfma_f32_16x16x32_bf16 v[212:215], v[76:79], v[108:111], v[212:215]
  ds_read_b64_tr_b16 v[50:51], v10 offset:512
  v_mfma_f32_16x16x32_bf16 v[216:219], v[80:83], v[108:111], v[216:219]
  ds_read_b64_tr_b16 v[52:53], v11 offset:0
  v_mfma_f32_16x16x32_bf16 v[220:223], v[84:87], v[108:111], v[220:223]
  ds_read_b64_tr_b16 v[54:55], v11 offset:512
  v_mfma_f32_16x16x32_bf16 v[128:131], v[88:91], v[72:75], v[128:131]
  v_add_u32 v8, 0x4000, v8
  v_mfma_f32_16x16x32_bf16 v[132:135], v[88:91], v[76:79], v[132:135]
  v_add_u32 v10, s30, v12
  v_mfma_f32_16x16x32_bf16 v[136:139], v[88:91], v[80:83], v[136:139]
  v_add_u32 v11, s30, v13
  v_mfma_f32_16x16x32_bf16 v[140:143], v[88:91], v[84:87], v[140:143]
  v_and_b32 v8, 0xffff, v8
  v_mfma_f32_16x16x32_bf16 v[144:147], v[92:95], v[72:75], v[144:147]
  v_mfma_f32_16x16x32_bf16 v[148:151], v[92:95], v[76:79], v[148:151]
  v_mfma_f32_16x16x32_bf16 v[152:155], v[92:95], v[80:83], v[152:155]
  s_waitcnt lgkmcnt(0)
  v_mfma_f32_16x16x32_bf16 v[156:159], v[92:95], v[84:87], v[156:159]
.fz_kernel_q_l0:
  s_barrier
  v_mfma_f32_16x16x32_bf16 v[160:163], v[56:59], v[32:35], v[160:163]
  ds_read_b64_tr_b16 v[96:97], v10 offset:4096
  v_mfma_f32_16x16x32_bf16 v[164:167], v[56:59], v[36:39], v[164:167]
  ds_read_b64_tr_b16 v[98:99], v10 offset:4608
  v_mfma_f32_16x16x32_bf16 v[168:171], v[56:59], v[40:43], v[168:171]
  ds_read_b128 v[72:75], v9 offset:0
  v_mfma_f32_16x16x32_bf16 v[172:175], v[56:59], v[44:47], v[172:175]
  ds_read_b128 v[76:79], v9 offset:2048
  v_mfma_f32_16x16x32_bf16 v[176:179], v[60:63], v[32:35], v[176:179]
  ds_read_b128 v[80:83], v9 offset:4096
  v_mfma_f32_16x16x32_bf16 v[180:183], v[60:63], v[36:39], v[180:183]
  ds_read_b128 v[84:87], v9 offset:6144
  v_mfma_f32_16x16x32_bf16 v[184:187], v[60:63], v[40:43], v[184:187]
  ds_read_b64_tr_b16 v[100:101], v11 offset:4096
  v_mfma_f32_16x16x32_bf16 v[188:191], v[60:63], v[44:47], v[188:191]
  ds_read_b64_tr_b16 v[102:103], v11 offset:4608
  v_mfma_f32_16x16x32_bf16 v[192:195], v[32:35], v[64:67], v[192:195]
  ds_read_b64_tr_b16 v[104:105], v10 offset:8192
  s_add_u32 s30, s30, 12288
  v_mfma_f32_16x16x32_bf16 v[196:199], v[36:39], v[64:67], v[196:199]
  ds_read_b64_tr_b16 v[106:107], v10 offset:8704
  s_cmp_eq_u32 s30, 49152
  v_mfma_f32_16x16x32_bf16 v[200:203], v[40:43], v[64:67], v[200:203]
  ds_read_b64_tr_b16 v[108:109], v11 offset:8192
  s_cselect_b32 s30, 0, s30
  v_mfma_f32_16x16x32_bf16 v[204:207], v[44:47], v[64:67], v[204:207]
  ds_read_b64_tr_b16 v[110:111], v11 offset:8704
  s_sub_u32 s29, s29, 1
  v_mfma_f32_16x16x32_bf16 v[208:211], v[32:35], v[68:71], v[208:211]
  ds_read_b64_tr_b16 v[88:89], v10 offset:0
  s_cmp_lg_u32 s29, 0
  v_mfma_f32_16x16x32_bf16 v[212:215], v[36:39], v[68:71], v[212:215]
  ds_read_b64_tr_b16 v[90:91], v10 offset:512
  v_mfma_f32_16x16x32_bf16 v[216:219], v[40:43], v[68:71], v[216:219]
  ds_read_b64_tr_b16 v[92:93], v11 offset:0
  v_mfma_f32_16x16x32_bf16 v[220:223], v[44:47], v[68:71], v[220:223]
  ds_read_b64_tr_b16 v[94:95], v11 offset:512
  v_mfma_f32_16x16x32_bf16 v[128:131], v[48:51], v[32:35], v[128:131]
  v_add_u32 v9, 0x4000, v9
  v_mfma_f32_16x16x32_bf16 v[132:135], v[48:51], v[36:39], v[132:135]
  v_add_u32 v10, s30, v12
  v_mfma_f32_16x16x32_bf16 v[136:139], v[48:51], v[40:43], v[136:139]
  v_add_u32 v11, s30, v13
  v_mfma_f32_16x16x32_bf16 v[140:143], v[48:51], v[44:47], v[140:143]
  v_and_b32 v9, 0xffff, v9
  v_mfma_f32_16x16x32_bf16 v[144:147], v[52:55], v[32:35], v[144:147]
  s_cbranch_scc1 .fz_kernel_q_loop
  v_mfma_f32_16x16x32_bf16 v[148:151], v[52:55], v[36:39], v[148:151]
  v_mfma_f32_16x16x32_bf16 v[152:155], v[52:55], v[40:43], v[152:155]
  s_waitcnt lgkmcnt(0)
  v_mfma_f32_16x16x32_bf16 v[156:159], v[52:55], v[44:47], v[156:159]
  s_cmp_lg_u32 s62, 0
  s_cbranch_scc1 .fz_kernel_q_nr
  buffer_load_dwordx4 v[232:235], v15, s[12:15], s23 offen offset:0
  buffer_load_dwordx4 v[236:239], v15, s[12:15], s23 offen offset:32
  buffer_load_dwordx4 v[240:243], v15, s[12:15], s23 offen offset:64
  buffer_load_dwordx4 v[244:247], v15, s[12:15], s23 offen offset:96
.fz_kernel_q_nr:
  s_barrier
  v_mfma_f32_16x16x32_bf16 v[160:163], v[96:99], v[72:75], v[160:163]
  s_lshl_b32 s31, s26, 8
  s_add_u32 s31, s31, 155648
  v_and_b32 v14, 15, v2
  v_and_b32 v15, 48, v2
  v_mfma_f32_16x16x32_bf16 v[164:167], v[96:99], v[76:79], v[164:167]
  s_lshl_b32 s33, s27, 7
  s_add_u32 s33, s33, 155648
  v_lshlrev_b32 v14, 2, v14
  v_mov_b32 v1, 159952
  v_mfma_f32_16x16x32_bf16 v[168:171], v[96:99], v[80:83], v[168:171]
  v_add_u32 v29, s33, v14
  v_add_u32 v14, s31, v14
  v_mfma_f32_16x16x32_bf16 v[172:175], v[96:99], v[84:87], v[172:175]
  v_add_u32 v28, s33, v15
  v_add_u32 v15, s31, v15
  v_mfma_f32_16x16x32_bf16 v[176:179], v[100:103], v[72:75], v[176:179]
  ds_read_b32 v1, v1
  v_add_u32 v64, 4608, v14
  v_mfma_f32_16x16x32_bf16 v[180:183], v[100:103], v[76:79], v[180:183]
  ds_read_b128 v[120:123], v28 offset:5888
  v_mfma_f32_16x16x32_bf16 v[184:187], v[100:103], v[80:83], v[184:187]
  ds_read_b128 v[124:127], v28 offset:5952
  v_mfma_f32_16x16x32_bf16 v[188:191], v[100:103], v[84:87], v[188:191]
  ds_read2_b32 v[224:225], v64 offset0:0 offset1:128
  v_mfma_f32_16x16x32_bf16 v[192:195], v[72:75], v[104:107], v[192:195]
  ds_read2_b32 v[226:227], v64 offset0:16 offset1:144
  v_mfma_f32_16x16x32_bf16 v[196:199], v[76:79], v[104:107], v[196:199]
  ds_read2_b32 v[228:229], v64 offset0:32 offset1:160
  v_mfma_f32_16x16x32_bf16 v[200:203], v[80:83], v[104:107], v[200:203]
  ds_read2_b32 v[230:231], v64 offset0:48 offset1:176
  v_mfma_f32_16x16x32_bf16 v[204:207], v[84:87], v[104:107], v[204:207]
  ds_read_b32 v24, v29 offset:6144
  v_mfma_f32_16x16x32_bf16 v[208:211], v[72:75], v[108:111], v[208:211]
  ds_read_b32 v26, v29 offset:6208
  v_mfma_f32_16x16x32_bf16 v[212:215], v[76:79], v[108:111], v[212:215]
  ds_read_b128 v[32:35], v15 offset:4608
  ds_read_b128 v[48:51], v15 offset:5120
  v_mfma_f32_16x16x32_bf16 v[216:219], v[80:83], v[108:111], v[216:219]
  ds_read_b128 v[36:39], v15 offset:4672
  ds_read_b128 v[52:55], v15 offset:5184
  v_mfma_f32_16x16x32_bf16 v[220:223], v[84:87], v[108:111], v[220:223]
  ds_read_b128 v[40:43], v15 offset:4736
  ds_read_b128 v[56:59], v15 offset:5248
  v_mfma_f32_16x16x32_bf16 v[128:131], v[88:91], v[72:75], v[128:131]
  ds_read_b128 v[44:47], v15 offset:4800
  ds_read_b128 v[60:63], v15 offset:5312
  v_mfma_f32_16x16x32_bf16 v[132:135], v[88:91], v[76:79], v[132:135]
  ds_read_b128 v[112:115], v28 offset:5632
  ds_read_b128 v[116:119], v28 offset:5696
  v_mfma_f32_16x16x32_bf16 v[136:139], v[88:91], v[80:83], v[136:139]
  s_lshl1_add_u32 s34, s18, s27
  s_lshl4_add_u32 s34, s34, s17
  s_lshl1_add_u32 s34, s34, s26
  v_mfma_f32_16x16x32_bf16 v[140:143], v[88:91], v[84:87], v[140:143]
  s_lshl_b32 s36, s34, 13
  s_add_u32 s36, s36, s63
  s_add_u32 s37, s36, 4096
  v_mfma_f32_16x16x32_bf16 v[144:147], v[92:95], v[72:75], v[144:147]
  s_lshl_b32 s34, s16, 12
  s_add_u32 s34, s34, 131072
  v_add_u32 v9, s34, v3
  v_mfma_f32_16x16x32_bf16 v[148:151], v[92:95], v[76:79], v[148:151]
  v_xor_b32 v8, 8192, v9
  v_mfma_f32_16x16x32_bf16 v[152:155], v[92:95], v[80:83], v[152:155]
  v_mfma_f32_16x16x32_bf16 v[156:159], v[92:95], v[84:87], v[156:159]
  s_waitcnt lgkmcnt(12)
  v_add_u32 v1, -1, v1
  v_lshrrev_b32 v1, 6, v1
  v_cmp_eq_u32 vcc, s26, v1
  s_cbranch_vccnz .fz_kernel_q_patch
.fz_kernel_q_pback:
  v_pk_mul_f32 v[64:65], v[120:121], v[224:225] op_sel:[0,1] op_sel_hi:[1,1]
  v_pk_fma_f32 v[160:161], v[160:161], v[224:225], v[64:65] op_sel_hi:[1,0,1]
  v_pk_mul_f32 v[66:67], v[122:123], v[224:225] op_sel:[0,1] op_sel_hi:[1,1]
  v_pk_fma_f32 v[162:163], v[162:163], v[224:225], v[66:67] op_sel_hi:[1,0,1]
  v_pk_mul_f32 v[68:69], v[124:125], v[224:225] op_sel:[0,1] op_sel_hi:[1,1]
  v_pk_fma_f32 v[176:177], v[176:177], v[224:225], v[68:69] op_sel_hi:[1,0,1]
  v_pk_mul_f32 v[70:71], v[126:127], v[224:225] op_sel:[0,1] op_sel_hi:[1,1]
  v_pk_fma_f32 v[178:179], v[178:179], v[224:225], v[70:71] op_sel_hi:[1,0,1]
  v_cvt_pk_bf16_f32 v80, v160, v161
  v_cvt_pk_bf16_f32 v81, v162, v163
  v_cvt_pk_bf16_f32 v82, v176, v177
  v_cvt_pk_bf16_f32 v83, v178, v179
  v_pk_mul_f32 v[64:65], v[120:121], v[226:227] op_sel:[0,1] op_sel_hi:[1,1]
  v_pk_fma_f32 v[164:165], v[164:165], v[226:227], v[64:65] op_sel_hi:[1,0,1]
  v_pk_mul_f32 v[66:67], v[122:123], v[226:227] op_sel:[0,1] op_sel_hi:[1,1]
  v_pk_fma_f32 v[166:167], v[166:167], v[226:227], v[66:67] op_sel_hi:[1,0,1]
  v_pk_mul_f32 v[68:69], v[124:125], v[226:227] op_sel:[0,1] op_sel_hi:[1,1]
  v_pk_fma_f32 v[180:181], v[180:181], v[226:227], v[68:69] op_sel_hi:[1,0,1]
  v_pk_mul_f32 v[70:71], v[126:127], v[226:227] op_sel:[0,1] op_sel_hi:[1,1]
  v_pk_fma_f32 v[182:183], v[182:183], v[226:227], v[70:71] op_sel_hi:[1,0,1]
  v_cvt_pk_bf16_f32 v84, v164, v165
  v_cvt_pk_bf16_f32 v85, v166, v167
  v_cvt_pk_bf16_f32 v86, v180, v181
  v_cvt_pk_bf16_f32 v87, v182, v183
  v_permlane16_swap_b32 v80, v84
  v_permlane16_swap_b32 v81, v85
  v_permlane16_swap_b32 v82, v86
  v_permlane16_swap_b32 v83, v87
  buffer_store_dwordx4 v[80:83], v3, s[4:7], s36 offen offset:0 sc1
  buffer_store_dwordx4 v[84:87], v3, s[4:7], s36 offen offset:1024 sc1
  v_pk_mul_f32 v[64:65], v[120:121], v[228:229] op_sel:[0,1] op_sel_hi:[1,1]
  v_pk_fma_f32 v[168:169], v[168:169], v[228:229], v[64:65] op_sel_hi:[1,0,1]
  v_pk_mul_f32 v[66:67], v[122:123], v[228:229] op_sel:[0,1] op_sel_hi:[1,1]
  v_pk_fma_f32 v[170:171], v[170:171], v[228:229], v[66:67] op_sel_hi:[1,0,1]
  v_pk_mul_f32 v[68:69], v[124:125], v[228:229] op_sel:[0,1] op_sel_hi:[1,1]
  v_pk_fma_f32 v[184:185], v[184:185], v[228:229], v[68:69] op_sel_hi:[1,0,1]
  v_pk_mul_f32 v[70:71], v[126:127], v[228:229] op_sel:[0,1] op_sel_hi:[1,1]
  v_pk_fma_f32 v[186:187], v[186:187], v[228:229], v[70:71] op_sel_hi:[1,0,1]
  v_cvt_pk_bf16_f32 v96, v168, v169
  v_cvt_pk_bf16_f32 v97, v170, v171
  v_cvt_pk_bf16_f32 v98, v184, v185
  v_cvt_pk_bf16_f32 v99, v186, v187
  v_pk_mul_f32 v[64:65], v[120:121], v[230:231] op_sel:[0,1] op_sel_hi:[1,1]
  v_pk_fma_f32 v[172:173], v[172:173], v[230:231], v[64:65] op_sel_hi:[1,0,1]
  v_pk_mul_f32 v[66:67], v[122:123], v[230:231] op_sel:[0,1] op_sel_hi:[1,1]
  v_pk_fma_f32 v[174:175], v[174:175], v[230:231], v[66:67] op_sel_hi:[1,0,1]
  v_pk_mul_f32 v[68:69], v[124:125], v[230:231] op_sel:[0,1] op_sel_hi:[1,1]
  v_pk_fma_f32 v[188:189], v[188:189], v[230:231], v[68:69] op_sel_hi:[1,0,1]
  v_pk_mul_f32 v[70:71], v[126:127], v[230:231] op_sel:[0,1] op_sel_hi:[1,1]
  v_pk_fma_f32 v[190:191], v[190:191], v[230:231], v[70:71] op_sel_hi:[1,0,1]
  v_cvt_pk_bf16_f32 v100, v172, v173
  v_cvt_pk_bf16_f32 v101, v174, v175
  v_cvt_pk_bf16_f32 v102, v188, v189
  v_cvt_pk_bf16_f32 v103, v190, v191
  v_permlane16_swap_b32 v96, v100
  v_permlane16_swap_b32 v97, v101
  v_permlane16_swap_b32 v98, v102
  v_permlane16_swap_b32 v99, v103
  buffer_store_dwordx4 v[96:99], v3, s[4:7], s37 offen offset:0 sc1
  buffer_store_dwordx4 v[100:103], v3, s[4:7], s37 offen offset:1024 sc1
  s_waitcnt lgkmcnt(0)
  v_pk_mul_f32 v[64:65], v[48:49], v[24:25] op_sel_hi:[1,0]
  v_pk_fma_f32 v[192:193], v[192:193], v[32:33], v[64:65]
  v_pk_mul_f32 v[66:67], v[50:51], v[24:25] op_sel_hi:[1,0]
  v_pk_fma_f32 v[194:195], v[194:195], v[34:35], v[66:67]
  v_pk_mul_f32 v[68:69], v[48:49], v[26:27] op_sel_hi:[1,0]
  v_pk_fma_f32 v[208:209], v[208:209], v[32:33], v[68:69]
  v_pk_mul_f32 v[70:71], v[50:51], v[26:27] op_sel_hi:[1,0]
  v_pk_fma_f32 v[210:211], v[210:211], v[34:35], v[70:71]
  v_cvt_pk_bf16_f32 v88, v192, v193
  v_cvt_pk_bf16_f32 v90, v208, v209
  v_cvt_pk_bf16_f32 v89, v194, v195
  v_cvt_pk_bf16_f32 v91, v210, v211
  v_pk_mul_f32 v[64:65], v[52:53], v[24:25] op_sel_hi:[1,0]
  v_pk_fma_f32 v[196:197], v[196:197], v[36:37], v[64:65]
  v_pk_mul_f32 v[66:67], v[54:55], v[24:25] op_sel_hi:[1,0]
  v_pk_fma_f32 v[198:199], v[198:199], v[38:39], v[66:67]
  v_pk_mul_f32 v[68:69], v[52:53], v[26:27] op_sel_hi:[1,0]
  v_pk_fma_f32 v[212:213], v[212:213], v[36:37], v[68:69]
  v_pk_mul_f32 v[70:71], v[54:55], v[26:27] op_sel_hi:[1,0]
  v_pk_fma_f32 v[214:215], v[214:215], v[38:39], v[70:71]
  v_cvt_pk_bf16_f32 v92, v196, v197
  v_cvt_pk_bf16_f32 v94, v212, v213
  v_cvt_pk_bf16_f32 v93, v198, v199
  v_cvt_pk_bf16_f32 v95, v214, v215
  v_permlane16_swap_b32 v88, v90
  v_permlane16_swap_b32 v89, v91
  v_permlane16_swap_b32 v92, v94
  v_permlane16_swap_b32 v93, v95
  v_permlane32_swap_b32 v88, v90
  v_permlane32_swap_b32 v89, v91
  v_permlane32_swap_b32 v92, v94
  v_permlane32_swap_b32 v93, v95
  buffer_store_dwordx4 v[88:91], v3, s[4:7], s36 offen offset:2048 sc1
  buffer_store_dwordx4 v[92:95], v3, s[4:7], s36 offen offset:3072 sc1
  v_pk_mul_f32 v[64:65], v[56:57], v[24:25] op_sel_hi:[1,0]
  v_pk_fma_f32 v[200:201], v[200:201], v[40:41], v[64:65]
  v_pk_mul_f32 v[66:67], v[58:59], v[24:25] op_sel_hi:[1,0]
  v_pk_fma_f32 v[202:203], v[202:203], v[42:43], v[66:67]
  v_pk_mul_f32 v[68:69], v[56:57], v[26:27] op_sel_hi:[1,0]
  v_pk_fma_f32 v[216:217], v[216:217], v[40:41], v[68:69]
  v_pk_mul_f32 v[70:71], v[58:59], v[26:27] op_sel_hi:[1,0]
  v_pk_fma_f32 v[218:219], v[218:219], v[42:43], v[70:71]
  v_cvt_pk_bf16_f32 v104, v200, v201
  v_cvt_pk_bf16_f32 v106, v216, v217
  v_cvt_pk_bf16_f32 v105, v202, v203
  v_cvt_pk_bf16_f32 v107, v218, v219
  v_pk_mul_f32 v[64:65], v[60:61], v[24:25] op_sel_hi:[1,0]
  v_pk_fma_f32 v[204:205], v[204:205], v[44:45], v[64:65]
  v_pk_mul_f32 v[66:67], v[62:63], v[24:25] op_sel_hi:[1,0]
  v_pk_fma_f32 v[206:207], v[206:207], v[46:47], v[66:67]
  v_pk_mul_f32 v[68:69], v[60:61], v[26:27] op_sel_hi:[1,0]
  v_pk_fma_f32 v[220:221], v[220:221], v[44:45], v[68:69]
  v_pk_mul_f32 v[70:71], v[62:63], v[26:27] op_sel_hi:[1,0]
  v_pk_fma_f32 v[222:223], v[222:223], v[46:47], v[70:71]
  v_cvt_pk_bf16_f32 v108, v204, v205
  v_cvt_pk_bf16_f32 v110, v220, v221
  v_cvt_pk_bf16_f32 v109, v206, v207
  v_cvt_pk_bf16_f32 v111, v222, v223
  v_permlane16_swap_b32 v104, v106
  v_permlane16_swap_b32 v105, v107
  v_permlane16_swap_b32 v108, v110
  v_permlane16_swap_b32 v109, v111
  v_permlane32_swap_b32 v104, v106
  v_permlane32_swap_b32 v105, v107
  v_permlane32_swap_b32 v108, v110
  v_permlane32_swap_b32 v109, v111
  buffer_store_dwordx4 v[104:107], v3, s[4:7], s37 offen offset:2048 sc1
  buffer_store_dwordx4 v[108:111], v3, s[4:7], s37 offen offset:3072 sc1
  v_mul_f32 v224, 0.25503486164919736, v224
  v_mul_f32 v225, 0.25503486164919736, v225
  v_mul_f32 v226, 0.25503486164919736, v226
  v_mul_f32 v227, 0.25503486164919736, v227
  v_mul_f32 v228, 0.25503486164919736, v228
  v_mul_f32 v229, 0.25503486164919736, v229
  v_mul_f32 v230, 0.25503486164919736, v230
  v_mul_f32 v231, 0.25503486164919736, v231
  v_pk_mul_f32 v[64:65], v[112:113], v[224:225] op_sel:[0,1] op_sel_hi:[1,1]
  v_pk_fma_f32 v[128:129], v[128:129], v[224:225], v[64:65] op_sel_hi:[1,0,1]
  v_pk_mul_f32 v[66:67], v[114:115], v[224:225] op_sel:[0,1] op_sel_hi:[1,1]
  v_pk_fma_f32 v[130:131], v[130:131], v[224:225], v[66:67] op_sel_hi:[1,0,1]
  v_pk_mul_f32 v[68:69], v[116:117], v[224:225] op_sel:[0,1] op_sel_hi:[1,1]
  v_pk_fma_f32 v[144:145], v[144:145], v[224:225], v[68:69] op_sel_hi:[1,0,1]
  v_pk_mul_f32 v[70:71], v[118:119], v[224:225] op_sel:[0,1] op_sel_hi:[1,1]
  v_pk_fma_f32 v[146:147], v[146:147], v[224:225], v[70:71] op_sel_hi:[1,0,1]
  v_cvt_pk_bf16_f32 v16, v128, v129
  v_cvt_pk_bf16_f32 v17, v130, v131
  v_cvt_pk_bf16_f32 v18, v144, v145
  v_cvt_pk_bf16_f32 v19, v146, v147
  v_pk_mul_f32 v[64:65], v[112:113], v[226:227] op_sel:[0,1] op_sel_hi:[1,1]
  v_pk_fma_f32 v[132:133], v[132:133], v[226:227], v[64:65] op_sel_hi:[1,0,1]
  v_pk_mul_f32 v[66:67], v[114:115], v[226:227] op_sel:[0,1] op_sel_hi:[1,1]
  v_pk_fma_f32 v[134:135], v[134:135], v[226:227], v[66:67] op_sel_hi:[1,0,1]
  v_pk_mul_f32 v[68:69], v[116:117], v[226:227] op_sel:[0,1] op_sel_hi:[1,1]
  v_pk_fma_f32 v[148:149], v[148:149], v[226:227], v[68:69] op_sel_hi:[1,0,1]
  v_pk_mul_f32 v[70:71], v[118:119], v[226:227] op_sel:[0,1] op_sel_hi:[1,1]
  v_pk_fma_f32 v[150:151], v[150:151], v[226:227], v[70:71] op_sel_hi:[1,0,1]
  v_cvt_pk_bf16_f32 v20, v132, v133
  v_cvt_pk_bf16_f32 v21, v134, v135
  v_cvt_pk_bf16_f32 v22, v148, v149
  v_cvt_pk_bf16_f32 v23, v150, v151
  v_permlane16_swap_b32 v16, v20
  v_permlane16_swap_b32 v17, v21
  v_permlane16_swap_b32 v18, v22
  v_permlane16_swap_b32 v19, v23
  ds_write_b128 v8, v[16:19] offset:0
  ds_write_b128 v8, v[20:23] offset:1024
  v_pk_mul_f32 v[64:65], v[112:113], v[228:229] op_sel:[0,1] op_sel_hi:[1,1]
  v_pk_fma_f32 v[136:137], v[136:137], v[228:229], v[64:65] op_sel_hi:[1,0,1]
  v_pk_mul_f32 v[66:67], v[114:115], v[228:229] op_sel:[0,1] op_sel_hi:[1,1]
  v_pk_fma_f32 v[138:139], v[138:139], v[228:229], v[66:67] op_sel_hi:[1,0,1]
  v_pk_mul_f32 v[68:69], v[116:117], v[228:229] op_sel:[0,1] op_sel_hi:[1,1]
  v_pk_fma_f32 v[152:153], v[152:153], v[228:229], v[68:69] op_sel_hi:[1,0,1]
  v_pk_mul_f32 v[70:71], v[118:119], v[228:229] op_sel:[0,1] op_sel_hi:[1,1]
  v_pk_fma_f32 v[154:155], v[154:155], v[228:229], v[70:71] op_sel_hi:[1,0,1]
  v_cvt_pk_bf16_f32 v24, v136, v137
  v_cvt_pk_bf16_f32 v25, v138, v139
  v_cvt_pk_bf16_f32 v26, v152, v153
  v_cvt_pk_bf16_f32 v27, v154, v155
  v_pk_mul_f32 v[64:65], v[112:113], v[230:231] op_sel:[0,1] op_sel_hi:[1,1]
  v_pk_fma_f32 v[140:141], v[140:141], v[230:231], v[64:65] op_sel_hi:[1,0,1]
  v_pk_mul_f32 v[66:67], v[114:115], v[230:231] op_sel:[0,1] op_sel_hi:[1,1]
  v_pk_fma_f32 v[142:143], v[142:143], v[230:231], v[66:67] op_sel_hi:[1,0,1]
  v_pk_mul_f32 v[68:69], v[116:117], v[230:231] op_sel:[0,1] op_sel_hi:[1,1]
  v_pk_fma_f32 v[156:157], v[156:157], v[230:231], v[68:69] op_sel_hi:[1,0,1]
  v_pk_mul_f32 v[70:71], v[118:119], v[230:231] op_sel:[0,1] op_sel_hi:[1,1]
  v_pk_fma_f32 v[158:159], v[158:159], v[230:231], v[70:71] op_sel_hi:[1,0,1]
  v_cvt_pk_bf16_f32 v28, v140, v141
  v_cvt_pk_bf16_f32 v29, v142, v143
  v_cvt_pk_bf16_f32 v30, v156, v157
  v_cvt_pk_bf16_f32 v31, v158, v159
  v_permlane16_swap_b32 v24, v28
  v_permlane16_swap_b32 v25, v29
  v_permlane16_swap_b32 v26, v30
  v_permlane16_swap_b32 v27, v31
  ds_write_b128 v8, v[24:27] offset:2048
  ds_write_b128 v8, v[28:31] offset:3072
  s_branch .fz_kernel_att
.fz_kernel_q_help1:
  s_waitcnt lgkmcnt(0)
  s_mov_b32 s3, 32
  s_cmp_eq_u32 s16, 7
  s_cbranch_scc1 .fz_kernel_q_h7
  s_getpc_b64 s[0:1]
.fz_kernel_ct4:
  s_sub_u32 s0, s0, .fz_kernel_ct4-fz_kernel
  s_subb_u32 s1, s1, 0
  s_lshr_b32 s31, s2, 3
  s_mulk_i32 s31, 0x500
  v_lshl_add_u32 v1, v2, 7, s31
  v_min_u32 v1, .fz_kernel_last-fz_kernel, v1
  s_mov_b64 exec, 0x3ff
  global_load_dword v1, v1, s[0:1]
  s_mov_b64 exec, -1
.fz_kernel_ct4e:
  s_mov_b32 s12, s58
  s_mov_b32 s13, s59
  s_mov_b32 s14, 0x100
  s_mov_b32 s15, 0x00020000
  s_mov_b32 s30, 0
  s_and_b32 s31, s18, 3
  s_sub_u32 s31, s31, s30
  s_and_b32 s30, s31, 3
  s_lshl_b32 s30, s30, 14
  v_and_b32 v20, 15, v2
  v_lshrrev_b32 v21, 4, v2
  v_bfe_u32 v22, v2, 1, 3
  v_xor_b32 v22, v22, v21
  v_lshlrev_b32 v21, 7, v20
  v_lshl_add_u32 v21, v22, 4, v21
  v_add_u32 v21, s30, v21
  v_xor_b32 v22, 64, v21
  v_lshlrev_b32 v20, 3, v20
  s_lshl_b32 s30, s17, 10
  s_add_u32 s30, s30, 0x1808000
  s_mov_b32 exec_lo, 0x00f0000f
  s_mov_b32 exec_hi, 0xf0000f00
  v_add_u32 v20, 4, v20
  s_mov_b64 exec, -1
  v_mov_b32 v24, 0x3f803f80
  v_mov_b32 v25, v24
  v_mov_b32 v26, v24
  v_mov_b32 v27, v24
  s_lshl_b32 s31, s31, 1
  s_sub_u32 s31, 31, s31
  s_mov_b32 s20, s48
  s_mov_b32 s21, s49
  s_mov_b32 s22, 0x800
  s_mov_b32 s23, 0x00020000
  v_lshlrev_b32 v40, 5, v2
  buffer_load_dwordx4 v[44:47], v40, s[20:23], 0 offen
  buffer_load_dwordx4 v[48:51], v40, s[20:23], 0 offen offset:16
  v_mov_b32 v40, 0
  s_waitcnt vmcnt(0)
  v_lshlrev_b32 v41, 16, v44
  v_and_b32 v42, 0xffff0000, v44
  v_add_f32 v40, v40, v41
  v_add_f32 v40, v40, v42
  v_lshlrev_b32 v41, 16, v45
  v_and_b32 v42, 0xffff0000, v45
  v_add_f32 v40, v40, v41
  v_add_f32 v40, v40, v42
  v_lshlrev_b32 v41, 16, v46
  v_and_b32 v42, 0xffff0000, v46
  v_add_f32 v40, v40, v41
  v_add_f32 v40, v40, v42
  v_lshlrev_b32 v41, 16, v47
  v_and_b32 v42, 0xffff0000, v47
  v_add_f32 v40, v40, v41
  v_add_f32 v40, v40, v42
  v_lshlrev_b32 v41, 16, v48
  v_and_b32 v42, 0xffff0000, v48
  v_add_f32 v40, v40, v41
  v_add_f32 v40, v40, v42
  v_lshlrev_b32 v41, 16, v49
  v_and_b32 v42, 0xffff0000, v49
  v_add_f32 v40, v40, v41
  v_add_f32 v40, v40, v42
  v_lshlrev_b32 v41, 16, v50
  v_and_b32 v42, 0xffff0000, v50
  v_add_f32 v40, v40, v41
  v_add_f32 v40, v40, v42
  v_lshlrev_b32 v41, 16, v51
  v_and_b32 v42, 0xffff0000, v51
  v_add_f32 v40, v40, v41
  v_add_f32 v40, v40, v42
  s_nop 1
  v_add_f32 v40, v40, v40 quad_perm:[1,0,3,2] row_mask:0xf bank_mask:0xf
  s_nop 1
  v_add_f32 v40, v40, v40 quad_perm:[2,3,0,1] row_mask:0xf bank_mask:0xf
  s_nop 1
  v_add_f32 v40, v40, v40 row_half_mirror row_mask:0xf bank_mask:0xf
  s_nop 1
  v_add_f32 v40, v40, v40 row_mirror row_mask:0xf bank_mask:0xf
  s_nop 0
  v_readlane_b32 s20, v40, 16
  v_readlane_b32 s21, v40, 32
  v_readlane_b32 s22, v40, 48
  v_add_f32 v40, s20, v40
  v_add_f32 v40, s21, v40
  v_add_f32 v40, s22, v40
  v_mul_f32 v40, 0x3a800000, v40
  s_nop 0
  v_readfirstlane_b32 s76, v40
.fz_kernel_xs5:
  s_barrier
  s_sub_u32 s3, s3, 1
  s_cmp_lg_u32 s3, s31
  s_cbranch_scc1 .fz_kernel_xs5
  ds_read_b128 v[64:67], v21 offset:0
  ds_read_b128 v[72:75], v21 offset:2048
  ds_read_b128 v[80:83], v21 offset:4096
  ds_read_b128 v[88:91], v21 offset:6144
  ds_read_b128 v[96:99], v21 offset:8192
  ds_read_b128 v[104:107], v21 offset:10240
  ds_read_b128 v[112:115], v21 offset:12288
  ds_read_b128 v[120:123], v21 offset:14336
  ds_read_b128 v[68:71], v22 offset:0
  ds_read_b128 v[76:79], v22 offset:2048
  ds_read_b128 v[84:87], v22 offset:4096
  ds_read_b128 v[92:95], v22 offset:6144
  ds_read_b128 v[100:103], v22 offset:8192
  ds_read_b128 v[108:111], v22 offset:10240
  ds_read_b128 v[116:119], v22 offset:12288
  ds_read_b128 v[124:127], v22 offset:14336
  s_waitcnt lgkmcnt(0)
  s_cmp_eq_u32 s3, 0
  s_cbranch_scc1 .fz_kernel_hb6
  s_barrier
  s_sub_u32 s3, s3, 1
.fz_kernel_hb6:
  s_setprio 2
  v_mfma_f32_16x16x32_bf16 v[128:131], v[24:27], v[64:67], 0
  v_mfma_f32_16x16x32_bf16 v[160:163], v[64:67], v[64:67], 0
  v_mfma_f32_16x16x32_bf16 v[132:135], v[24:27], v[72:75], 0
  v_mfma_f32_16x16x32_bf16 v[164:167], v[72:75], v[72:75], 0
  v_mfma_f32_16x16x32_bf16 v[136:139], v[24:27], v[80:83], 0
  v_mfma_f32_16x16x32_bf16 v[168:171], v[80:83], v[80:83], 0
  v_mfma_f32_16x16x32_bf16 v[140:143], v[24:27], v[88:91], 0
  v_mfma_f32_16x16x32_bf16 v[172:175], v[88:91], v[88:91], 0
  v_mfma_f32_16x16x32_bf16 v[144:147], v[24:27], v[96:99], 0
  v_mfma_f32_16x16x32_bf16 v[176:179], v[96:99], v[96:99], 0
  v_mfma_f32_16x16x32_bf16 v[148:151], v[24:27], v[104:107], 0
  v_mfma_f32_16x16x32_bf16 v[180:183], v[104:107], v[104:107], 0
  v_mfma_f32_16x16x32_bf16 v[152:155], v[24:27], v[112:115], 0
  v_mfma_f32_16x16x32_bf16 v[184:187], v[112:115], v[112:115], 0
  v_mfma_f32_16x16x32_bf16 v[156:159], v[24:27], v[120:123], 0
  v_mfma_f32_16x16x32_bf16 v[188:191], v[120:123], v[120:123], 0
  v_mfma_f32_16x16x32_bf16 v[128:131], v[24:27], v[68:71], v[128:131]
  v_mfma_f32_16x16x32_bf16 v[160:163], v[68:71], v[68:71], v[160:163]
  v_mfma_f32_16x16x32_bf16 v[132:135], v[24:27], v[76:79], v[132:135]
  v_mfma_f32_16x16x32_bf16 v[164:167], v[76:79], v[76:79], v[164:167]
  v_mfma_f32_16x16x32_bf16 v[136:139], v[24:27], v[84:87], v[136:139]
  v_mfma_f32_16x16x32_bf16 v[168:171], v[84:87], v[84:87], v[168:171]
  v_mfma_f32_16x16x32_bf16 v[140:143], v[24:27], v[92:95], v[140:143]
  v_mfma_f32_16x16x32_bf16 v[172:175], v[92:95], v[92:95], v[172:175]
  v_mfma_f32_16x16x32_bf16 v[144:147], v[24:27], v[100:103], v[144:147]
  v_mfma_f32_16x16x32_bf16 v[176:179], v[100:103], v[100:103], v[176:179]
  v_mfma_f32_16x16x32_bf16 v[148:151], v[24:27], v[108:111], v[148:151]
  v_mfma_f32_16x16x32_bf16 v[180:183], v[108:111], v[108:111], v[180:183]
  v_mfma_f32_16x16x32_bf16 v[152:155], v[24:27], v[116:119], v[152:155]
  v_mfma_f32_16x16x32_bf16 v[184:187], v[116:119], v[116:119], v[184:187]
  v_mfma_f32_16x16x32_bf16 v[156:159], v[24:27], v[124:127], v[156:159]
  v_mfma_f32_16x16x32_bf16 v[188:191], v[124:127], v[124:127], v[188:191]
  s_setprio 0
  s_cmp_eq_u32 s3, 0
  s_cbranch_scc1 .fz_kernel_hb7
  s_barrier
  s_sub_u32 s3, s3, 1
.fz_kernel_hb7:
  s_mov_b32 exec_lo, 0x100001
  s_mov_b32 exec_hi, 0x10000100
  buffer_load_dword v9, v4, s[12:15], 0 offen sc1
  v_mov_b32 v128, v160
  v_mov_b32 v132, v164
  v_mov_b32 v136, v168
  v_mov_b32 v140, v172
  v_mov_b32 v144, v176
  v_mov_b32 v148, v180
  v_mov_b32 v152, v184
  v_mov_b32 v156, v188
  s_mov_b32 exec_lo, 0x200002
  s_mov_b32 exec_hi, 0x20000200
  v_mov_b32 v128, v161
  v_mov_b32 v132, v165
  v_mov_b32 v136, v169
  v_mov_b32 v140, v173
  v_mov_b32 v144, v177
  v_mov_b32 v148, v181
  v_mov_b32 v152, v185
  v_mov_b32 v156, v189
  s_mov_b32 exec_lo, 0x400004
  s_mov_b32 exec_hi, 0x40000400
  v_mov_b32 v128, v162
  v_mov_b32 v132, v166
  v_mov_b32 v136, v170
  v_mov_b32 v140, v174
  v_mov_b32 v144, v178
  v_mov_b32 v148, v182
  v_mov_b32 v152, v186
  v_mov_b32 v156, v190
  s_mov_b32 exec_lo, 0x800008
  s_mov_b32 exec_hi, 0x80000800
  v_mov_b32 v128, v163
  v_mov_b32 v132, v167
  v_mov_b32 v136, v171
  v_mov_b32 v140, v175
  v_mov_b32 v144, v179
  v_mov_b32 v148, v183
  v_mov_b32 v152, v187
  v_mov_b32 v156, v191
  s_mov_b64 exec, 1
  s_mov_b32 s38, 0
.fz_kernel_pw8:
  s_mov_b32 s46, 0
  s_call_b64 s[0:1], .fz_kernel_hw
  s_waitcnt vmcnt(0)
  v_readfirstlane_b32 s31, v9
  s_cmp_eq_u32 s31, 64
  s_cbranch_scc1 .fz_kernel_pw8d
  s_cmp_eq_u32 s3, 0
  s_cbranch_scc1 .fz_kernel_hb9
  s_barrier
  s_sub_u32 s3, s3, 1
.fz_kernel_hb9:
  s_cmp_eq_u32 s3, 0
  s_cbranch_scc1 .fz_kernel_hb10
  s_barrier
  s_sub_u32 s3, s3, 1
.fz_kernel_hb10:
  buffer_load_dword v9, v4, s[12:15], 0 offen sc1
  s_add_u32 s38, s38, 1
  s_cmp_lt_u32 s38, 131072
  s_cbranch_scc1 .fz_kernel_pw8
  s_waitcnt vmcnt(0)
.fz_kernel_pw8d:
  s_mov_b64 exec, -1
  s_mov_b32 exec_lo, 0x00fff00f
  s_mov_b32 exec_hi, 0xff000ff0
  buffer_atomic_add_f32 v128, v20, s[4:7], s30 offen offset:0 sc1
  buffer_atomic_add_f32 v132, v20, s[4:7], s30 offen offset:128 sc1
  buffer_atomic_add_f32 v136, v20, s[4:7], s30 offen offset:256 sc1
  buffer_atomic_add_f32 v140, v20, s[4:7], s30 offen offset:384 sc1
  buffer_atomic_add_f32 v144, v20, s[4:7], s30 offen offset:512 sc1
  buffer_atomic_add_f32 v148, v20, s[4:7], s30 offen offset:640 sc1
  buffer_atomic_add_f32 v152, v20, s[4:7], s30 offen offset:768 sc1
  buffer_atomic_add_f32 v156, v20, s[4:7], s30 offen offset:896 sc1
  s_mov_b64 exec, -1
  s_mov_b32 s46, 0
  s_call_b64 s[0:1], .fz_kernel_hw
  s_waitcnt vmcnt(0)
  v_lshlrev_b32 v7, 11, v2
  s_lshl_b32 s31, s17, 7
  s_lshl_b32 s33, 1, s18
  s_add_u32 s31, s31, s67
  s_add_u32 s31, s31, 0x1800018
  v_mov_b32 v8, s33
  s_mov_b64 exec, 0xffff
  buffer_atomic_or v8, v7, s[4:7], s31 offen sc1
  s_mov_b64 exec, -1
  s_add_u32 s37, s19, 24
.fz_kernel_f111:
  s_cmp_le_u32 s3, 8
  s_cbranch_scc1 .fz_kernel_f111d
  s_barrier
  s_sub_u32 s3, s3, 1
  s_branch .fz_kernel_f111
.fz_kernel_f111d:
  s_mov_b64 exec, 1
  buffer_load_dword v9, v4, s[4:7], s37 offen sc1
  s_mov_b64 exec, 1
  s_mov_b32 s38, 0
.fz_kernel_pw12:
  s_mov_b32 s46, 0
  s_call_b64 s[0:1], .fz_kernel_hw
  s_waitcnt vmcnt(0)
  v_readfirstlane_b32 s31, v9
  s_cmp_eq_u32 s31, 65535
  s_cbranch_scc1 .fz_kernel_pw12d
  s_cmp_eq_u32 s3, 0
  s_cbranch_scc1 .fz_kernel_hb13
  s_barrier
  s_sub_u32 s3, s3, 1
.fz_kernel_hb13:
  s_cmp_eq_u32 s3, 0
  s_cbranch_scc1 .fz_kernel_hb14
  s_barrier
  s_sub_u32 s3, s3, 1
.fz_kernel_hb14:
  buffer_load_dword v9, v4, s[4:7], s37 offen sc1
  s_add_u32 s38, s38, 1
  s_cmp_lt_u32 s38, 131072
  s_cbranch_scc1 .fz_kernel_pw12
  s_waitcnt vmcnt(0)
.fz_kernel_pw12d:
  s_mov_b64 exec, -1
  buffer_load_dwordx4 v[64:67], v3, s[4:7], s30 offen sc1
  s_mov_b32 s46, 0
  s_call_b64 s[0:1], .fz_kernel_hw
  s_waitcnt vmcnt(0)
  v_mov_b32 v26, 0.0009765625
  v_mul_f32 v20, v26, v64
  v_mul_f32 v27, v20, v20
  v_fma_f32 v22, v65, v26, -v27
  v_max_f32 v22, 0, v22
  v_add_f32 v22, 1e-05, v22
  v_rsq_f32 v22, v22
  s_nop 0
  v_mul_f32 v20, v20, v22
  v_sub_f32 v20, 0, v20
  v_mul_f32 v21, v26, v66
  v_mul_f32 v27, v21, v21
  v_fma_f32 v23, v67, v26, -v27
  v_max_f32 v23, 0, v23
  v_add_f32 v23, 1e-05, v23
  v_rsq_f32 v23, v23
  s_nop 0
  v_mul_f32 v21, v21, v23
  v_sub_f32 v21, 0, v21
  v_lshlrev_b32 v24, 3, v2
  v_add_u32 v24, 155648, v24
  ds_write_b64 v24, v[22:23] offset:4608
  ds_write_b64 v24, v[20:21] offset:5120
  v_mov_b32 v20, 1.0
  v_mov_b32 v21, 1.0
  v_mov_b32 v22, 0
  v_mov_b32 v23, 0
  ds_write_b64 v24, v[20:21] offset:6400
  ds_write_b64 v24, v[22:23] offset:6912
  v_mov_b32 v24, 159952
  v_mov_b32 v25, s76
  ds_write_b32 v24, v25 offset:8
  s_waitcnt lgkmcnt(0)
.fz_kernel_q_hw2:
  s_add_u32 s3, s3, 2
.fz_kernel_q_he:
  s_cmp_eq_u32 s3, 0
  s_cbranch_scc1 .fz_kernel_chain
  s_barrier
  s_sub_u32 s3, s3, 1
  s_branch .fz_kernel_q_he
.fz_kernel_q_h7:
  s_mov_b32 s8, s58
  s_mov_b32 s9, s59
  s_mov_b32 s10, 0x100
  s_mov_b32 s11, 0x00020000
  v_mov_b32 v12, 0
  v_mov_b32 v13, 0
  v_mov_b32 v14, 0
  v_mov_b32 v15, 0
  s_cmp_ge_u32 s2, 64
  s_cbranch_scc1 .fz_kernel_q_nzero
  s_lshl_b32 s36, s2, 10
  s_add_u32 s36, s36, 0x1800000
  buffer_store_dwordx4 v[12:15], v3, s[4:7], s36 offen sc1
.fz_kernel_q_nzero:
  v_and_b32 v21, 7, v2
  v_and_b32 v20, 16, v2
  v_lshlrev_b32 v20, 1, v20
  v_xor_b32 v20, v20, v3
  s_bfe_u32 s33, s17, 0x10002
  s_lshl_b32 s33, s33, 1
  s_and_b32 s31, s33, 3
  s_mul_i32 s31, s31, 12288
  s_add_u32 s31, s31, 65536
  v_add_u32 v16, s31, v20
  v_xor_b32 v17, 64, v16
  s_add_u32 s31, s31, 12288
  v_add_u32 v18, s31, v20
  v_xor_b32 v19, 64, v18
  s_sub_u32 s33, 31, s33
  v_lshlrev_b32 v21, 5, v21
  v_and_b32 v22, 24, v2
  v_add_u32 v21, v22, v21
  v_lshrrev_b32 v22, 5, v2
  v_lshl_add_u32 v21, v22, 2, v21
  s_lshl_b32 s30, s18, 10
  s_add_u32 s30, s30, 0x180c000
  v_and_b32 v22, 1, v2
  v_lshlrev_b32 v22, 4, v22
  v_mov_b32 v23, 0x3f80
  v_lshlrev_b32 v22, v22, v23
  v_mov_b32 v24, 0
  v_mov_b32 v25, 0
  v_mov_b32 v26, 0
  v_mov_b32 v27, 0
  s_mov_b32 exec_lo, 0x3030303
  s_mov_b32 exec_hi, 0x3030303
  v_mov_b32 v24, v22
  s_mov_b32 exec_lo, 0xc0c0c0c
  s_mov_b32 exec_hi, 0xc0c0c0c
  v_mov_b32 v25, v22
  s_mov_b32 exec_lo, 0x30303030
  s_mov_b32 exec_hi, 0x30303030
  v_mov_b32 v26, v22
  s_mov_b32 exec_lo, 0xc0c0c0c0
  s_mov_b32 exec_hi, 0xc0c0c0c0
  v_mov_b32 v27, v22
  s_mov_b64 exec, -1
  s_cmp_ge_u32 s2, 64
  s_cbranch_scc1 .fz_kernel_nz2
  s_mov_b64 exec, 1
  s_waitcnt vmcnt(0)
  buffer_atomic_add v5, v4, s[8:11], 0 offen sc1
  s_mov_b64 exec, -1
.fz_kernel_nz2:
  s_barrier
  s_sub_u32 s3, s3, 1
  s_cmp_lg_u32 s3, s33
  s_cbranch_scc1 .fz_kernel_nz2
  ds_read_b128 v[64:67], v16 offset:0
  ds_read_b128 v[68:71], v16 offset:4096
  ds_read_b128 v[72:75], v16 offset:8192
  ds_read_b128 v[76:79], v17 offset:1024
  ds_read_b128 v[80:83], v17 offset:5120
  ds_read_b128 v[84:87], v17 offset:9216
  ds_read_b128 v[88:91], v16 offset:2048
  ds_read_b128 v[92:95], v16 offset:6144
  ds_read_b128 v[96:99], v16 offset:10240
  ds_read_b128 v[100:103], v17 offset:3072
  ds_read_b128 v[104:107], v17 offset:7168
  ds_read_b128 v[108:111], v17 offset:11264
  s_waitcnt lgkmcnt(0)
  s_cmp_eq_u32 s3, 0
  s_cbranch_scc1 .fz_kernel_hb15
  s_barrier
  s_sub_u32 s3, s3, 1
.fz_kernel_hb15:
  ds_read_b128 v[112:115], v18 offset:0
  ds_read_b128 v[116:119], v18 offset:4096
  ds_read_b128 v[120:123], v18 offset:8192
  ds_read_b128 v[124:127], v19 offset:1024
  ds_read_b128 v[128:131], v19 offset:5120
  ds_read_b128 v[132:135], v19 offset:9216
  ds_read_b128 v[136:139], v18 offset:2048
  ds_read_b128 v[140:143], v18 offset:6144
  ds_read_b128 v[144:147], v18 offset:10240
  ds_read_b128 v[148:151], v19 offset:3072
  ds_read_b128 v[152:155], v19 offset:7168
  ds_read_b128 v[156:159], v19 offset:11264
  s_waitcnt lgkmcnt(0)
  s_cmp_eq_u32 s3, 0
  s_cbranch_scc1 .fz_kernel_hb16
  s_barrier
  s_sub_u32 s3, s3, 1
.fz_kernel_hb16:
  s_setprio 2
  v_mfma_f32_16x16x32_bf16 v[160:163], v[24:27], v[64:67], 0
  v_mfma_f32_16x16x32_bf16 v[164:167], v[24:27], v[68:71], 0
  v_mfma_f32_16x16x32_bf16 v[168:171], v[24:27], v[72:75], 0
  v_mfma_f32_16x16x32_bf16 v[160:163], v[24:27], v[76:79], v[160:163]
  v_mfma_f32_16x16x32_bf16 v[164:167], v[24:27], v[80:83], v[164:167]
  v_mfma_f32_16x16x32_bf16 v[168:171], v[24:27], v[84:87], v[168:171]
  v_mfma_f32_16x16x32_bf16 v[160:163], v[24:27], v[88:91], v[160:163]
  v_mfma_f32_16x16x32_bf16 v[164:167], v[24:27], v[92:95], v[164:167]
  v_mfma_f32_16x16x32_bf16 v[168:171], v[24:27], v[96:99], v[168:171]
  v_mfma_f32_16x16x32_bf16 v[160:163], v[24:27], v[100:103], v[160:163]
  v_mfma_f32_16x16x32_bf16 v[164:167], v[24:27], v[104:107], v[164:167]
  v_mfma_f32_16x16x32_bf16 v[168:171], v[24:27], v[108:111], v[168:171]
  v_mfma_f32_16x16x32_bf16 v[160:163], v[24:27], v[112:115], v[160:163]
  v_mfma_f32_16x16x32_bf16 v[164:167], v[24:27], v[116:119], v[164:167]
  v_mfma_f32_16x16x32_bf16 v[168:171], v[24:27], v[120:123], v[168:171]
  v_mfma_f32_16x16x32_bf16 v[160:163], v[24:27], v[124:127], v[160:163]
  v_mfma_f32_16x16x32_bf16 v[164:167], v[24:27], v[128:131], v[164:167]
  v_mfma_f32_16x16x32_bf16 v[168:171], v[24:27], v[132:135], v[168:171]
  v_mfma_f32_16x16x32_bf16 v[160:163], v[24:27], v[136:139], v[160:163]
  v_mfma_f32_16x16x32_bf16 v[164:167], v[24:27], v[140:143], v[164:167]
  v_mfma_f32_16x16x32_bf16 v[168:171], v[24:27], v[144:147], v[168:171]
  v_mfma_f32_16x16x32_bf16 v[160:163], v[24:27], v[148:151], v[160:163]
  v_mfma_f32_16x16x32_bf16 v[164:167], v[24:27], v[152:155], v[164:167]
  v_mfma_f32_16x16x32_bf16 v[168:171], v[24:27], v[156:159], v[168:171]
  s_setprio 0
  s_mov_b64 exec, 1
  buffer_load_dword v9, v4, s[8:11], 0 offen sc1
  s_mov_b64 exec, -1
  s_nop 1
  v_add_f32 v160, v160, v160 row_ror:8 row_mask:0xf bank_mask:0xf
  v_add_f32 v161, v161, v161 row_ror:8 row_mask:0xf bank_mask:0xf
  v_add_f32 v162, v162, v162 row_ror:8 row_mask:0xf bank_mask:0xf
  v_add_f32 v163, v163, v163 row_ror:8 row_mask:0xf bank_mask:0xf
  v_add_f32 v164, v164, v164 row_ror:8 row_mask:0xf bank_mask:0xf
  v_add_f32 v165, v165, v165 row_ror:8 row_mask:0xf bank_mask:0xf
  v_add_f32 v166, v166, v166 row_ror:8 row_mask:0xf bank_mask:0xf
  v_add_f32 v167, v167, v167 row_ror:8 row_mask:0xf bank_mask:0xf
  v_add_f32 v168, v168, v168 row_ror:8 row_mask:0xf bank_mask:0xf
  v_add_f32 v169, v169, v169 row_ror:8 row_mask:0xf bank_mask:0xf
  v_add_f32 v170, v170, v170 row_ror:8 row_mask:0xf bank_mask:0xf
  v_add_f32 v171, v171, v171 row_ror:8 row_mask:0xf bank_mask:0xf
  s_mov_b32 exec_lo, 0x0
  s_mov_b32 exec_hi, 0xff00ff
  v_mov_b32 v160, v161
  v_mov_b32 v164, v165
  v_mov_b32 v168, v169
  s_mov_b32 exec_lo, 0xff00ff00
  s_mov_b32 exec_hi, 0x0
  v_mov_b32 v160, v162
  v_mov_b32 v164, v166
  v_mov_b32 v168, v170
  s_mov_b32 exec_lo, 0x0
  s_mov_b32 exec_hi, 0xff00ff00
  v_mov_b32 v160, v163
  v_mov_b32 v164, v167
  v_mov_b32 v168, v171
  s_mov_b64 exec, 1
  s_mov_b32 s38, 0
.fz_kernel_pw17:
  s_mov_b32 s46, 0
  s_call_b64 s[0:1], .fz_kernel_hw
  s_waitcnt vmcnt(0)
  v_readfirstlane_b32 s31, v9
  s_cmp_eq_u32 s31, 64
  s_cbranch_scc1 .fz_kernel_pw17d
  s_cmp_eq_u32 s3, 0
  s_cbranch_scc1 .fz_kernel_hb18
  s_barrier
  s_sub_u32 s3, s3, 1
.fz_kernel_hb18:
  s_cmp_eq_u32 s3, 0
  s_cbranch_scc1 .fz_kernel_hb19
  s_barrier
  s_sub_u32 s3, s3, 1
.fz_kernel_hb19:
  buffer_load_dword v9, v4, s[8:11], 0 offen sc1
  s_add_u32 s38, s38, 1
  s_cmp_lt_u32 s38, 131072
  s_cbranch_scc1 .fz_kernel_pw17
  s_waitcnt vmcnt(0)
.fz_kernel_pw17d:
  s_mov_b64 exec, -1
  buffer_atomic_add_f32 v160, v21, s[4:7], s30 offen offset:0 sc1
  buffer_atomic_add_f32 v164, v21, s[4:7], s30 offen offset:256 sc1
  buffer_atomic_add_f32 v168, v21, s[4:7], s30 offen offset:512 sc1
  s_mov_b32 s46, 0
  s_call_b64 s[0:1], .fz_kernel_hw
  s_waitcnt vmcnt(0)
  v_lshlrev_b32 v7, 7, v2
  s_lshl_b32 s31, s18, 11
  s_lshl_b32 s33, 1, s17
  s_add_u32 s31, s31, s67
  s_add_u32 s31, s31, 0x180001c
  v_mov_b32 v8, s33
  s_mov_b64 exec, 0xffff
  buffer_atomic_or v8, v7, s[4:7], s31 offen sc1
  s_mov_b64 exec, -1
  s_cmp_ge_u32 s2, 196
  s_cbranch_scc1 .fz_kernel_lz20
  s_lshl_b32 s36, s2, 12
  s_add_u32 s36, s36, 0x1c00000
  s_sub_u32 s31, s2, 66
  s_min_u32 s31, s31, s2
  s_sub_u32 s31, s31, 4
  s_cmp_lt_u32 s31, 6
  s_cbranch_scc1 .fz_kernel_lz20a
  buffer_store_dwordx4 v[12:15], v3, s[4:7], s36 offen sc1
  buffer_store_dwordx4 v[12:15], v3, s[4:7], s36 offen offset:1024 sc1
  buffer_store_dwordx4 v[12:15], v3, s[4:7], s36 offen offset:2048 sc1
  buffer_store_dwordx4 v[12:15], v3, s[4:7], s36 offen offset:3072 sc1
.fz_kernel_lz20:
  s_add_u32 s37, s19, 28
.fz_kernel_f121:
  s_cmp_le_u32 s3, 8
  s_cbranch_scc1 .fz_kernel_f121d
  s_barrier
  s_sub_u32 s3, s3, 1
  s_branch .fz_kernel_f121
.fz_kernel_f121d:
  s_mov_b64 exec, 1
  buffer_load_dword v9, v4, s[4:7], s37 offen sc1
  s_mov_b64 exec, 1
  s_mov_b32 s38, 0
.fz_kernel_pw22:
  s_mov_b32 s46, 0
  s_call_b64 s[0:1], .fz_kernel_hw
  s_waitcnt vmcnt(0)
  v_readfirstlane_b32 s31, v9
  s_cmp_eq_u32 s31, 65535
  s_cbranch_scc1 .fz_kernel_pw22d
  s_cmp_eq_u32 s3, 0
  s_cbranch_scc1 .fz_kernel_hb23
  s_barrier
  s_sub_u32 s3, s3, 1
.fz_kernel_hb23:
  s_cmp_eq_u32 s3, 0
  s_cbranch_scc1 .fz_kernel_hb24
  s_barrier
  s_sub_u32 s3, s3, 1
.fz_kernel_hb24:
  buffer_load_dword v9, v4, s[4:7], s37 offen sc1
  s_add_u32 s38, s38, 1
  s_cmp_lt_u32 s38, 131072
  s_cbranch_scc1 .fz_kernel_pw22
  s_waitcnt vmcnt(0)
.fz_kernel_pw22d:
  s_mov_b64 exec, -1
  buffer_load_dwordx4 v[64:67], v3, s[4:7], s30 offen sc1
  s_mov_b32 s46, 0
  s_call_b64 s[0:1], .fz_kernel_hw
  s_waitcnt vmcnt(0)
  v_add_u32 v24, 155648, v3
  s_mov_b32 exec_hi, 0xffff
  ds_write_b128 v24, v[64:67] offset:5632
  s_mov_b64 exec, -1
  s_waitcnt lgkmcnt(0)
  s_getpc_b64 s[0:1]
.fz_kernel_ct25:
  s_sub_u32 s0, s0, .fz_kernel_ct25-fz_kernel
  s_subb_u32 s1, s1, 0
  s_lshr_b32 s31, s2, 3
  s_mulk_i32 s31, 0x500
  v_lshl_add_u32 v1, v2, 7, s31
  v_min_u32 v1, .fz_kernel_last-fz_kernel, v1
  s_mov_b64 exec, 0x3ff
  global_load_dword v1, v1, s[0:1]
  s_mov_b64 exec, -1
.fz_kernel_ct25e:
  s_branch .fz_kernel_q_hw2
.fz_kernel_att:
  s_setprio 1
  s_and_b32 s39, s16, 1
  s_lshr_b32 s32, s16, 1
  s_lshl1_add_u32 s35, s18, s39
  s_lshl_b32 s35, s35, 5
  s_add_u32 s35, s35, s32
  s_lshl_b32 s35, s35, 13
  s_add_u32 s35, s35, s63
  s_lshl_b32 s34, 1, s17
  s_mov_b32 s36, 0
  v_add_u32 v10, 4096, v3
  v_mfma_f32_32x32x16_bf16 v[48:63], v[80:83], v[16:19], 0
  v_mfma_f32_32x32x16_bf16 v[48:63], v[84:87], v[20:23], v[48:63]
  v_mov_b32 v1, 0x3f803f80
  v_mov_b32 v11, 0x4444
  v_mov_b32 v12, v1
  v_mov_b32 v14, 0
  s_mov_b32 exec_lo, 0xaaaaaaaa
  s_mov_b32 exec_hi, 0xaaaaaaaa
  v_mov_b32 v12, 0
  v_mov_b32 v14, v1
  s_mov_b32 exec_lo, 0xcccccccc
  s_mov_b32 exec_hi, 0xcccccccc
  v_mov_b32 v11, 0xeeee
  s_mov_b64 exec, -1
  v_mov_b32 v13, v12
  v_mov_b32 v15, v14
  s_lshl_b32 s31, s16, 8
  s_add_u32 s31, s31, 147456
  v_and_b32 v1, 31, v2
  v_lshl_add_u32 v1, v1, 3, s31
  s_mov_b32 s26, 0xffff0000
  s_mov_b32 s27, 0xffff0000
  s_mov_b32 s24, 0x21800000
  s_mov_b32 s25, 0x5d800000
  s_andn2_b32 s31, 2, s16
  s_lshl2_add_u32 s31, s17, s31
  s_lshl4_add_u32 s31, s31, s18
  s_lshl1_add_u32 s31, s31, s39
  s_lshl_b32 s31, s31, 11
  s_add_u32 s28, s31, s64
  s_add_u32 s29, s28, 65536
  s_mov_b32 s73, 0
  v_mov_b32 v208, 0
  v_mov_b32 v209, 0
  v_mov_b32 v210, 0
  v_mov_b32 v211, 0
  v_mov_b32 v212, 0
  v_mov_b32 v213, 0
  v_mov_b32 v214, 0
  v_mov_b32 v215, 0
  v_mov_b32 v216, 0
  v_mov_b32 v217, 0
  v_mov_b32 v218, 0
  v_mov_b32 v219, 0
  v_mov_b32 v220, 0
  v_mov_b32 v221, 0
  v_mov_b32 v222, 0
  v_mov_b32 v223, 0
  s_mov_b32 s32, 8
  s_waitcnt lgkmcnt(0)
  s_barrier
  ds_read_b128 v[32:35], v9 offset:0
  ds_read_b128 v[36:39], v9 offset:1024
  ds_read_b128 v[40:43], v9 offset:2048
  ds_read_b128 v[44:47], v9 offset:3072
  v_mfma_f32_32x32x16_bf16 v[64:79], v[80:83], v[24:27], 0
  v_exp_f32 v48, v48
  v_exp_f32 v49, v49
  v_exp_f32 v50, v50
  v_exp_f32 v51, v51
  v_exp_f32 v52, v52
  v_exp_f32 v53, v53
  v_exp_f32 v54, v54
  v_exp_f32 v55, v55
  v_mfma_f32_32x32x16_bf16 v[64:79], v[84:87], v[28:31], v[64:79]
  v_cvt_pk_bf16_f32 v224, v48, v49
  v_cvt_pk_bf16_f32 v225, v50, v51
  v_cvt_pk_bf16_f32 v226, v52, v53
  v_cvt_pk_bf16_f32 v227, v54, v55
  v_exp_f32 v56, v56
  v_exp_f32 v57, v57
  v_exp_f32 v58, v58
  v_exp_f32 v59, v59
  v_mfma_f32_32x32x16_bf16 v[144:159], v[88:91], v[224:227], 0
  v_exp_f32 v60, v60
  v_exp_f32 v61, v61
  v_exp_f32 v62, v62
  v_exp_f32 v63, v63
  v_cvt_pk_bf16_f32 v228, v56, v57
  v_cvt_pk_bf16_f32 v229, v58, v59
  v_cvt_pk_bf16_f32 v230, v60, v61
  v_cvt_pk_bf16_f32 v231, v62, v63
  s_waitcnt lgkmcnt(0)
  v_mfma_f32_32x32x16_bf16 v[48:63], v[80:83], v[32:35], 0
  v_exp_f32 v64, v64
  v_exp_f32 v65, v65
  v_exp_f32 v66, v66
  v_exp_f32 v67, v67
  v_mfma_f32_32x32x16_bf16 v[144:159], v[92:95], v[228:231], v[144:159]
  v_exp_f32 v68, v68
  v_exp_f32 v69, v69
  v_exp_f32 v70, v70
  v_smfmac_f32_16x16x64_bf16 v[208:211], v[12:15], v[224:231], v11
  v_exp_f32 v71, v71
  v_mfma_f32_32x32x16_bf16 v[48:63], v[84:87], v[36:39], v[48:63]
  v_cvt_pk_bf16_f32 v224, v64, v65
  v_cvt_pk_bf16_f32 v225, v66, v67
  v_cvt_pk_bf16_f32 v226, v68, v69
  v_cvt_pk_bf16_f32 v227, v70, v71
  v_exp_f32 v72, v72
  v_exp_f32 v73, v73
  v_exp_f32 v74, v74
  v_exp_f32 v75, v75
  v_mfma_f32_32x32x16_bf16 v[160:175], v[88:91], v[224:227], 0
  v_exp_f32 v76, v76
  v_exp_f32 v77, v77
  v_exp_f32 v78, v78
  v_exp_f32 v79, v79
  v_cvt_pk_bf16_f32 v228, v72, v73
  v_cvt_pk_bf16_f32 v229, v74, v75
  v_cvt_pk_bf16_f32 v230, v76, v77
  v_cvt_pk_bf16_f32 v231, v78, v79
  s_mov_b64 exec, 1
  s_waitcnt vmcnt(0)
  ds_add_u32 v6, v5 offset:0x100
  s_mov_b64 exec, -1
  v_mfma_f32_32x32x16_bf16 v[64:79], v[80:83], v[40:43], 0
  v_exp_f32 v48, v48
  v_exp_f32 v49, v49
  v_exp_f32 v50, v50
  v_exp_f32 v51, v51
  v_mfma_f32_32x32x16_bf16 v[160:175], v[92:95], v[228:231], v[160:175]
  v_exp_f32 v52, v52
  v_exp_f32 v53, v53
  v_exp_f32 v54, v54
  v_smfmac_f32_16x16x64_bf16 v[212:215], v[12:15], v[224:231], v11
  v_exp_f32 v55, v55
  v_mfma_f32_32x32x16_bf16 v[64:79], v[84:87], v[44:47], v[64:79]
  v_cvt_pk_bf16_f32 v224, v48, v49
  v_cvt_pk_bf16_f32 v225, v50, v51
  v_cvt_pk_bf16_f32 v226, v52, v53
  v_cvt_pk_bf16_f32 v227, v54, v55
  v_exp_f32 v56, v56
  v_exp_f32 v57, v57
  v_exp_f32 v58, v58
  v_exp_f32 v59, v59
  v_mfma_f32_32x32x16_bf16 v[176:191], v[88:91], v[224:227], 0
  ds_read_b32 v7, v6
  v_exp_f32 v60, v60
  v_exp_f32 v61, v61
  v_exp_f32 v62, v62
  v_exp_f32 v63, v63
  v_cvt_pk_bf16_f32 v228, v56, v57
  v_cvt_pk_bf16_f32 v229, v58, v59
  v_cvt_pk_bf16_f32 v230, v60, v61
  v_cvt_pk_bf16_f32 v231, v62, v63
  s_waitcnt lgkmcnt(0)
  v_readfirstlane_b32 s39, v7
  s_andn2_b32 s33, s39, s34
  s_bcnt1_i32_b32 s31, s33
  s_cmp_ge_u32 s31, 2
  s_cbranch_scc1 .fz_kernel_a_e
  v_mfma_f32_32x32x16_bf16 v[48:63], v[96:99], v[16:19], 0
  v_exp_f32 v64, v64
  v_exp_f32 v65, v65
  v_exp_f32 v66, v66
  v_exp_f32 v67, v67
  v_mfma_f32_32x32x16_bf16 v[176:191], v[92:95], v[228:231], v[176:191]
  v_exp_f32 v68, v68
  v_exp_f32 v69, v69
  v_exp_f32 v70, v70
  v_smfmac_f32_16x16x64_bf16 v[216:219], v[12:15], v[224:231], v11
  v_exp_f32 v71, v71
  v_mfma_f32_32x32x16_bf16 v[48:63], v[100:103], v[20:23], v[48:63]
  v_cvt_pk_bf16_f32 v224, v64, v65
  v_cvt_pk_bf16_f32 v225, v66, v67
  v_cvt_pk_bf16_f32 v226, v68, v69
  v_cvt_pk_bf16_f32 v227, v70, v71
  v_exp_f32 v72, v72
  v_exp_f32 v73, v73
  v_exp_f32 v74, v74
  v_exp_f32 v75, v75
  v_mfma_f32_32x32x16_bf16 v[192:207], v[88:91], v[224:227], 0
  v_exp_f32 v76, v76
  v_exp_f32 v77, v77
  v_exp_f32 v78, v78
  v_exp_f32 v79, v79
  v_cvt_pk_bf16_f32 v228, v72, v73
  v_cvt_pk_bf16_f32 v229, v74, v75
  v_cvt_pk_bf16_f32 v230, v76, v77
  v_cvt_pk_bf16_f32 v231, v78, v79
  v_mfma_f32_32x32x16_bf16 v[64:79], v[96:99], v[24:27], 0
  v_exp_f32 v48, v48
  v_exp_f32 v49, v49
  v_exp_f32 v50, v50
  v_exp_f32 v51, v51
  v_mfma_f32_32x32x16_bf16 v[192:207], v[92:95], v[228:231], v[192:207]
  v_exp_f32 v52, v52
  v_exp_f32 v53, v53
  v_exp_f32 v54, v54
  v_smfmac_f32_16x16x64_bf16 v[220:223], v[12:15], v[224:231], v11
  v_exp_f32 v55, v55
  v_mfma_f32_32x32x16_bf16 v[64:79], v[100:103], v[28:31], v[64:79]
  v_cvt_pk_bf16_f32 v224, v48, v49
  v_cvt_pk_bf16_f32 v225, v50, v51
  v_cvt_pk_bf16_f32 v226, v52, v53
  v_cvt_pk_bf16_f32 v227, v54, v55
  v_exp_f32 v56, v56
  v_exp_f32 v57, v57
  v_exp_f32 v58, v58
  v_exp_f32 v59, v59
  v_mfma_f32_32x32x16_bf16 v[144:159], v[104:107], v[224:227], v[144:159]
  v_exp_f32 v60, v60
  v_exp_f32 v61, v61
  v_exp_f32 v62, v62
  v_exp_f32 v63, v63
  v_cvt_pk_bf16_f32 v228, v56, v57
  v_cvt_pk_bf16_f32 v229, v58, v59
  v_cvt_pk_bf16_f32 v230, v60, v61
  v_cvt_pk_bf16_f32 v231, v62, v63
  v_mfma_f32_32x32x16_bf16 v[48:63], v[96:99], v[32:35], 0
  v_exp_f32 v64, v64
  v_exp_f32 v65, v65
  v_exp_f32 v66, v66
  v_exp_f32 v67, v67
  v_mfma_f32_32x32x16_bf16 v[144:159], v[108:111], v[228:231], v[144:159]
  v_exp_f32 v68, v68
  v_exp_f32 v69, v69
  v_exp_f32 v70, v70
  v_smfmac_f32_16x16x64_bf16 v[208:211], v[12:15], v[224:231], v11
  v_exp_f32 v71, v71
  v_mfma_f32_32x32x16_bf16 v[48:63], v[100:103], v[36:39], v[48:63]
  v_cvt_pk_bf16_f32 v224, v64, v65
  v_cvt_pk_bf16_f32 v225, v66, v67
  v_cvt_pk_bf16_f32 v226, v68, v69
  v_cvt_pk_bf16_f32 v227, v70, v71
  v_exp_f32 v72, v72
  v_exp_f32 v73, v73
  v_exp_f32 v74, v74
  v_exp_f32 v75, v75
  v_mfma_f32_32x32x16_bf16 v[160:175], v[104:107], v[224:227], v[160:175]
  ds_read_b32 v7, v6
  v_exp_f32 v76, v76
  v_exp_f32 v77, v77
  v_exp_f32 v78, v78
  v_exp_f32 v79, v79
  v_cvt_pk_bf16_f32 v228, v72, v73
  v_cvt_pk_bf16_f32 v229, v74, v75
  v_cvt_pk_bf16_f32 v230, v76, v77
  v_cvt_pk_bf16_f32 v231, v78, v79
  s_waitcnt lgkmcnt(0)
  v_readfirstlane_b32 s39, v7
  s_andn2_b32 s39, s39, s34
  s_cbranch_scc0 .fz_kernel_a_p0
  s_ff1_i32_b32 s33, s36
  s_bitset0_b32 s36, s33
  s_lshl_b32 s33, s33, 14
  s_add_u32 s30, s33, s35
  s_cbranch_scc1 .fz_kernel_pk26c
.fz_kernel_pk26:
  buffer_load_dwordx4 v[112:115], v3, s[4:7], s30 offen offset:0
  buffer_load_dwordx4 v[116:119], v3, s[4:7], s30 offen offset:1024
  buffer_load_dwordx4 v[120:123], v3, s[4:7], s30 offen offset:2048
  buffer_load_dwordx4 v[124:127], v3, s[4:7], s30 offen offset:3072
  buffer_load_dwordx4 v[128:131], v10, s[4:7], s30 offen offset:0
  buffer_load_dwordx4 v[132:135], v10, s[4:7], s30 offen offset:1024
  buffer_load_dwordx4 v[136:139], v10, s[4:7], s30 offen offset:2048
  buffer_load_dwordx4 v[140:143], v10, s[4:7], s30 offen offset:3072
.fz_kernel_a_p0:
  v_mfma_f32_32x32x16_bf16 v[64:79], v[96:99], v[40:43], 0
  v_exp_f32 v48, v48
  v_exp_f32 v49, v49
  v_exp_f32 v50, v50
  v_exp_f32 v51, v51
  v_mfma_f32_32x32x16_bf16 v[160:175], v[108:111], v[228:231], v[160:175]
  v_exp_f32 v52, v52
  v_exp_f32 v53, v53
  v_exp_f32 v54, v54
  v_smfmac_f32_16x16x64_bf16 v[212:215], v[12:15], v[224:231], v11
  v_exp_f32 v55, v55
  v_mfma_f32_32x32x16_bf16 v[64:79], v[100:103], v[44:47], v[64:79]
  v_cvt_pk_bf16_f32 v224, v48, v49
  v_cvt_pk_bf16_f32 v225, v50, v51
  v_cvt_pk_bf16_f32 v226, v52, v53
  v_cvt_pk_bf16_f32 v227, v54, v55
  v_exp_f32 v56, v56
  v_exp_f32 v57, v57
  v_exp_f32 v58, v58
  v_exp_f32 v59, v59
  v_mfma_f32_32x32x16_bf16 v[176:191], v[104:107], v[224:227], v[176:191]
  v_exp_f32 v60, v60
  v_exp_f32 v61, v61
  v_exp_f32 v62, v62
  v_exp_f32 v63, v63
  v_cvt_pk_bf16_f32 v228, v56, v57
  v_cvt_pk_bf16_f32 v229, v58, v59
  v_cvt_pk_bf16_f32 v230, v60, v61
  v_cvt_pk_bf16_f32 v231, v62, v63
  v_exp_f32 v64, v64
  v_exp_f32 v65, v65
  v_exp_f32 v66, v66
  v_exp_f32 v67, v67
  v_mfma_f32_32x32x16_bf16 v[176:191], v[108:111], v[228:231], v[176:191]
  v_exp_f32 v68, v68
  v_exp_f32 v69, v69
  v_exp_f32 v70, v70
  v_smfmac_f32_16x16x64_bf16 v[216:219], v[12:15], v[224:231], v11
  v_exp_f32 v71, v71
  v_cvt_pk_bf16_f32 v224, v64, v65
  v_cvt_pk_bf16_f32 v225, v66, v67
  v_cvt_pk_bf16_f32 v226, v68, v69
  v_cvt_pk_bf16_f32 v227, v70, v71
  v_exp_f32 v72, v72
  v_exp_f32 v73, v73
  v_exp_f32 v74, v74
  v_exp_f32 v75, v75
  v_mfma_f32_32x32x16_bf16 v[192:207], v[104:107], v[224:227], v[192:207]
  v_exp_f32 v76, v76
  v_exp_f32 v77, v77
  v_exp_f32 v78, v78
  v_exp_f32 v79, v79
  v_cvt_pk_bf16_f32 v228, v72, v73
  v_cvt_pk_bf16_f32 v229, v74, v75
  v_cvt_pk_bf16_f32 v230, v76, v77
  v_cvt_pk_bf16_f32 v231, v78, v79
  s_cmp_lg_u32 s39, 0
  s_cbranch_scc1 .fz_kernel_a_p1
  s_ff1_i32_b32 s33, s36
  s_bitset0_b32 s36, s33
  s_lshl_b32 s33, s33, 14
  s_add_u32 s30, s33, s35
  s_cbranch_scc1 .fz_kernel_pk27c
.fz_kernel_pk27:
  buffer_load_dwordx4 v[112:115], v3, s[4:7], s30 offen offset:0
  buffer_load_dwordx4 v[116:119], v3, s[4:7], s30 offen offset:1024
  buffer_load_dwordx4 v[120:123], v3, s[4:7], s30 offen offset:2048
  buffer_load_dwordx4 v[124:127], v3, s[4:7], s30 offen offset:3072
  buffer_load_dwordx4 v[128:131], v10, s[4:7], s30 offen offset:0
  buffer_load_dwordx4 v[132:135], v10, s[4:7], s30 offen offset:1024
  buffer_load_dwordx4 v[136:139], v10, s[4:7], s30 offen offset:2048
  buffer_load_dwordx4 v[140:143], v10, s[4:7], s30 offen offset:3072
.fz_kernel_a_p1:
  s_ff1_i32_b32 s33, s36
  s_bitset0_b32 s36, s33
  s_lshl_b32 s33, s33, 14
  s_add_u32 s30, s33, s35
  s_cbranch_scc1 .fz_kernel_pk28c
.fz_kernel_pk28:
  buffer_load_dwordx4 v[80:83], v3, s[4:7], s30 offen offset:0
  buffer_load_dwordx4 v[84:87], v3, s[4:7], s30 offen offset:1024
  buffer_load_dwordx4 v[88:91], v3, s[4:7], s30 offen offset:2048
  buffer_load_dwordx4 v[92:95], v3, s[4:7], s30 offen offset:3072
  buffer_load_dwordx4 v[96:99], v10, s[4:7], s30 offen offset:0
  s_waitcnt vmcnt(11)
  v_mfma_f32_32x32x16_bf16 v[48:63], v[112:115], v[16:19], 0
  v_mfma_f32_32x32x16_bf16 v[48:63], v[116:119], v[20:23], v[48:63]
  s_nop 9
  s_branch .fz_kernel_a_b2
.fz_kernel_a_e:
  s_mov_b32 s36, s33
  s_or_b32 s34, s34, s39
  s_ff1_i32_b32 s33, s36
  s_bitset0_b32 s36, s33
  s_lshl_b32 s33, s33, 14
  s_add_u32 s30, s33, s35
  v_mfma_f32_32x32x16_bf16 v[48:63], v[96:99], v[16:19], 0
  buffer_load_dwordx4 v[112:115], v3, s[4:7], s30 offen offset:0
  v_exp_f32 v64, v64
  v_exp_f32 v65, v65
  v_exp_f32 v66, v66
  v_exp_f32 v67, v67
  v_mfma_f32_32x32x16_bf16 v[176:191], v[92:95], v[228:231], v[176:191]
  buffer_load_dwordx4 v[116:119], v3, s[4:7], s30 offen offset:1024
  v_exp_f32 v68, v68
  v_exp_f32 v69, v69
  v_exp_f32 v70, v70
  v_smfmac_f32_16x16x64_bf16 v[216:219], v[12:15], v[224:231], v11
  buffer_load_dwordx4 v[120:123], v3, s[4:7], s30 offen offset:2048
  v_exp_f32 v71, v71
  v_mfma_f32_32x32x16_bf16 v[48:63], v[100:103], v[20:23], v[48:63]
  buffer_load_dwordx4 v[124:127], v3, s[4:7], s30 offen offset:3072
  v_cvt_pk_bf16_f32 v224, v64, v65
  v_cvt_pk_bf16_f32 v225, v66, v67
  v_cvt_pk_bf16_f32 v226, v68, v69
  v_cvt_pk_bf16_f32 v227, v70, v71
  v_exp_f32 v72, v72
  v_exp_f32 v73, v73
  v_exp_f32 v74, v74
  v_exp_f32 v75, v75
  v_mfma_f32_32x32x16_bf16 v[192:207], v[88:91], v[224:227], 0
  buffer_load_dwordx4 v[128:131], v10, s[4:7], s30 offen offset:0
  v_exp_f32 v76, v76
  v_exp_f32 v77, v77
  v_exp_f32 v78, v78
  v_exp_f32 v79, v79
  v_cvt_pk_bf16_f32 v228, v72, v73
  v_cvt_pk_bf16_f32 v229, v74, v75
  v_cvt_pk_bf16_f32 v230, v76, v77
  v_cvt_pk_bf16_f32 v231, v78, v79
  v_mfma_f32_32x32x16_bf16 v[64:79], v[96:99], v[24:27], 0
  buffer_load_dwordx4 v[132:135], v10, s[4:7], s30 offen offset:1024
  v_exp_f32 v48, v48
  v_exp_f32 v49, v49
  v_exp_f32 v50, v50
  v_exp_f32 v51, v51
  v_mfma_f32_32x32x16_bf16 v[192:207], v[92:95], v[228:231], v[192:207]
  buffer_load_dwordx4 v[136:139], v10, s[4:7], s30 offen offset:2048
  v_exp_f32 v52, v52
  v_exp_f32 v53, v53
  v_exp_f32 v54, v54
  v_smfmac_f32_16x16x64_bf16 v[220:223], v[12:15], v[224:231], v11
  buffer_load_dwordx4 v[140:143], v10, s[4:7], s30 offen offset:3072
  v_exp_f32 v55, v55
  v_mfma_f32_32x32x16_bf16 v[64:79], v[100:103], v[28:31], v[64:79]
  s_ff1_i32_b32 s33, s36
  v_cvt_pk_bf16_f32 v224, v48, v49
  v_cvt_pk_bf16_f32 v225, v50, v51
  v_cvt_pk_bf16_f32 v226, v52, v53
  v_cvt_pk_bf16_f32 v227, v54, v55
  v_exp_f32 v56, v56
  v_exp_f32 v57, v57
  v_exp_f32 v58, v58
  v_exp_f32 v59, v59
  v_mfma_f32_32x32x16_bf16 v[144:159], v[104:107], v[224:227], v[144:159]
  s_bitset0_b32 s36, s33
  v_exp_f32 v60, v60
  v_exp_f32 v61, v61
  v_exp_f32 v62, v62
  v_exp_f32 v63, v63
  v_cvt_pk_bf16_f32 v228, v56, v57
  v_cvt_pk_bf16_f32 v229, v58, v59
  v_cvt_pk_bf16_f32 v230, v60, v61
  v_cvt_pk_bf16_f32 v231, v62, v63
  v_mfma_f32_32x32x16_bf16 v[48:63], v[96:99], v[32:35], 0
  s_lshl_b32 s33, s33, 14
  v_exp_f32 v64, v64
  v_exp_f32 v65, v65
  v_exp_f32 v66, v66
  v_exp_f32 v67, v67
  v_mfma_f32_32x32x16_bf16 v[144:159], v[108:111], v[228:231], v[144:159]
  s_add_u32 s30, s33, s35
  v_exp_f32 v68, v68
  v_exp_f32 v69, v69
  v_exp_f32 v70, v70
  v_smfmac_f32_16x16x64_bf16 v[208:211], v[12:15], v[224:231], v11
  buffer_load_dwordx4 v[80:83], v3, s[4:7], s30 offen offset:0
  v_exp_f32 v71, v71
  v_mfma_f32_32x32x16_bf16 v[48:63], v[100:103], v[36:39], v[48:63]
  buffer_load_dwordx4 v[84:87], v3, s[4:7], s30 offen offset:1024
  v_cvt_pk_bf16_f32 v224, v64, v65
  v_cvt_pk_bf16_f32 v225, v66, v67
  v_cvt_pk_bf16_f32 v226, v68, v69
  v_cvt_pk_bf16_f32 v227, v70, v71
  v_exp_f32 v72, v72
  v_exp_f32 v73, v73
  v_exp_f32 v74, v74
  v_exp_f32 v75, v75
  v_mfma_f32_32x32x16_bf16 v[160:175], v[104:107], v[224:227], v[160:175]
  buffer_load_dwordx4 v[88:91], v3, s[4:7], s30 offen offset:2048
  v_exp_f32 v76, v76
  v_exp_f32 v77, v77
  v_exp_f32 v78, v78
  v_exp_f32 v79, v79
  v_cvt_pk_bf16_f32 v228, v72, v73
  v_cvt_pk_bf16_f32 v229, v74, v75
  v_cvt_pk_bf16_f32 v230, v76, v77
  v_cvt_pk_bf16_f32 v231, v78, v79
  v_mfma_f32_32x32x16_bf16 v[64:79], v[96:99], v[40:43], 0
  buffer_load_dwordx4 v[92:95], v3, s[4:7], s30 offen offset:3072
  v_exp_f32 v48, v48
  v_exp_f32 v49, v49
  v_exp_f32 v50, v50
  v_exp_f32 v51, v51
  v_mfma_f32_32x32x16_bf16 v[160:175], v[108:111], v[228:231], v[160:175]
  v_exp_f32 v52, v52
  v_exp_f32 v53, v53
  v_exp_f32 v54, v54
  v_smfmac_f32_16x16x64_bf16 v[212:215], v[12:15], v[224:231], v11
  v_exp_f32 v55, v55
  v_mfma_f32_32x32x16_bf16 v[64:79], v[100:103], v[44:47], v[64:79]
  v_cvt_pk_bf16_f32 v224, v48, v49
  v_cvt_pk_bf16_f32 v225, v50, v51
  v_cvt_pk_bf16_f32 v226, v52, v53
  v_cvt_pk_bf16_f32 v227, v54, v55
  v_exp_f32 v56, v56
  v_exp_f32 v57, v57
  v_exp_f32 v58, v58
  v_exp_f32 v59, v59
  v_mfma_f32_32x32x16_bf16 v[176:191], v[104:107], v[224:227], v[176:191]
  s_waitcnt vmcnt(10)
  v_exp_f32 v60, v60
  v_exp_f32 v61, v61
  v_exp_f32 v62, v62
  v_exp_f32 v63, v63
  v_cvt_pk_bf16_f32 v228, v56, v57
  v_cvt_pk_bf16_f32 v229, v58, v59
  v_cvt_pk_bf16_f32 v230, v60, v61
  v_cvt_pk_bf16_f32 v231, v62, v63
  v_mfma_f32_32x32x16_bf16 v[48:63], v[112:115], v[16:19], 0
  v_exp_f32 v64, v64
  v_exp_f32 v65, v65
  v_exp_f32 v66, v66
  v_exp_f32 v67, v67
  v_mfma_f32_32x32x16_bf16 v[176:191], v[108:111], v[228:231], v[176:191]
  buffer_load_dwordx4 v[96:99], v10, s[4:7], s30 offen offset:0
  v_exp_f32 v68, v68
  v_exp_f32 v69, v69
  v_exp_f32 v70, v70
  v_smfmac_f32_16x16x64_bf16 v[216:219], v[12:15], v[224:231], v11
  v_exp_f32 v71, v71
  v_mfma_f32_32x32x16_bf16 v[48:63], v[116:119], v[20:23], v[48:63]
  v_cvt_pk_bf16_f32 v224, v64, v65
  v_cvt_pk_bf16_f32 v225, v66, v67
  v_cvt_pk_bf16_f32 v226, v68, v69
  v_cvt_pk_bf16_f32 v227, v70, v71
  v_exp_f32 v72, v72
  v_exp_f32 v73, v73
  v_exp_f32 v74, v74
  v_exp_f32 v75, v75
  v_mfma_f32_32x32x16_bf16 v[192:207], v[104:107], v[224:227], v[192:207]
  v_exp_f32 v76, v76
  v_exp_f32 v77, v77
  v_exp_f32 v78, v78
  v_exp_f32 v79, v79
  v_cvt_pk_bf16_f32 v228, v72, v73
  v_cvt_pk_bf16_f32 v229, v74, v75
  v_cvt_pk_bf16_f32 v230, v76, v77
  v_cvt_pk_bf16_f32 v231, v78, v79
  s_branch .fz_kernel_a_b2
  .p2align 6
.fz_kernel_a_loop:
  v_mfma_f32_32x32x16_bf16 v[64:79], v[80:83], v[24:27], 0
  v_exp_f32 v48, v48
  v_exp_f32 v49, v49
  v_exp_f32 v50, v50
  v_exp_f32 v51, v51
  v_mfma_f32_32x32x16_bf16 v[192:207], v[140:143], v[228:231], v[192:207]
  v_exp_f32 v52, v52
  v_exp_f32 v53, v53
  v_exp_f32 v54, v54
  v_smfmac_f32_16x16x64_bf16 v[220:223], v[12:15], v[224:231], v11
  buffer_load_dwordx4 v[132:135], v10, s[4:7], s30 offen offset:1024
  v_exp_f32 v55, v55
  v_mfma_f32_32x32x16_bf16 v[64:79], v[84:87], v[28:31], v[64:79]
  s_waitcnt vmcnt(10)
  v_cvt_pk_bf16_f32 v224, v48, v49
  v_cvt_pk_bf16_f32 v225, v50, v51
  v_cvt_pk_bf16_f32 v226, v52, v53
  v_cvt_pk_bf16_f32 v227, v54, v55
  v_exp_f32 v56, v56
  v_exp_f32 v57, v57
  v_exp_f32 v58, v58
  v_exp_f32 v59, v59
  v_mfma_f32_32x32x16_bf16 v[144:159], v[88:91], v[224:227], v[144:159]
  v_exp_f32 v60, v60
  v_exp_f32 v61, v61
  v_exp_f32 v62, v62
  v_exp_f32 v63, v63
  v_cvt_pk_bf16_f32 v228, v56, v57
  v_cvt_pk_bf16_f32 v229, v58, v59
  v_cvt_pk_bf16_f32 v230, v60, v61
  v_cvt_pk_bf16_f32 v231, v62, v63
  v_mfma_f32_32x32x16_bf16 v[48:63], v[80:83], v[32:35], 0
  v_exp_f32 v64, v64
  v_exp_f32 v65, v65
  v_exp_f32 v66, v66
  v_exp_f32 v67, v67
  v_mfma_f32_32x32x16_bf16 v[144:159], v[92:95], v[228:231], v[144:159]
  v_exp_f32 v68, v68
  v_exp_f32 v69, v69
  v_exp_f32 v70, v70
  v_smfmac_f32_16x16x64_bf16 v[208:211], v[12:15], v[224:231], v11
  buffer_load_dwordx4 v[136:139], v10, s[4:7], s30 offen offset:2048
  v_exp_f32 v71, v71
  v_mfma_f32_32x32x16_bf16 v[48:63], v[84:87], v[36:39], v[48:63]
  s_ff1_i32_b32 s33, s36
  v_cvt_pk_bf16_f32 v224, v64, v65
  v_cvt_pk_bf16_f32 v225, v66, v67
  v_cvt_pk_bf16_f32 v226, v68, v69
  v_cvt_pk_bf16_f32 v227, v70, v71
  v_exp_f32 v72, v72
  v_exp_f32 v73, v73
  v_exp_f32 v74, v74
  v_exp_f32 v75, v75
  v_mfma_f32_32x32x16_bf16 v[160:175], v[88:91], v[224:227], v[160:175]
  s_bitset0_b32 s36, s33
  v_exp_f32 v76, v76
  v_exp_f32 v77, v77
  v_exp_f32 v78, v78
  v_exp_f32 v79, v79
  v_cvt_pk_bf16_f32 v228, v72, v73
  v_cvt_pk_bf16_f32 v229, v74, v75
  v_cvt_pk_bf16_f32 v230, v76, v77
  v_cvt_pk_bf16_f32 v231, v78, v79
  v_mfma_f32_32x32x16_bf16 v[64:79], v[80:83], v[40:43], 0
  s_lshl_b32 s33, s33, 14
  v_exp_f32 v48, v48
  v_exp_f32 v49, v49
  v_exp_f32 v50, v50
  v_exp_f32 v51, v51
  v_mfma_f32_32x32x16_bf16 v[160:175], v[92:95], v[228:231], v[160:175]
  v_exp_f32 v52, v52
  v_exp_f32 v53, v53
  v_exp_f32 v54, v54
  v_smfmac_f32_16x16x64_bf16 v[212:215], v[12:15], v[224:231], v11
  buffer_load_dwordx4 v[140:143], v10, s[4:7], s30 offen offset:3072
  v_exp_f32 v55, v55
  v_mfma_f32_32x32x16_bf16 v[64:79], v[84:87], v[44:47], v[64:79]
  s_add_u32 s30, s33, s35
  v_cvt_pk_bf16_f32 v224, v48, v49
  v_cvt_pk_bf16_f32 v225, v50, v51
  v_cvt_pk_bf16_f32 v226, v52, v53
  v_cvt_pk_bf16_f32 v227, v54, v55
  v_exp_f32 v56, v56
  v_exp_f32 v57, v57
  v_exp_f32 v58, v58
  v_exp_f32 v59, v59
  v_mfma_f32_32x32x16_bf16 v[176:191], v[88:91], v[224:227], v[176:191]
  s_waitcnt vmcnt(10)
  v_exp_f32 v60, v60
  v_exp_f32 v61, v61
  v_exp_f32 v62, v62
  v_exp_f32 v63, v63
  v_cvt_pk_bf16_f32 v228, v56, v57
  v_cvt_pk_bf16_f32 v229, v58, v59
  v_cvt_pk_bf16_f32 v230, v60, v61
  v_cvt_pk_bf16_f32 v231, v62, v63
  v_mfma_f32_32x32x16_bf16 v[48:63], v[96:99], v[16:19], 0
  s_cbranch_scc1 .fz_kernel_pk31c
.fz_kernel_pk31:
  v_exp_f32 v64, v64
  v_exp_f32 v65, v65
  v_exp_f32 v66, v66
  v_exp_f32 v67, v67
  v_mfma_f32_32x32x16_bf16 v[176:191], v[92:95], v[228:231], v[176:191]
  v_exp_f32 v68, v68
  v_exp_f32 v69, v69
  v_exp_f32 v70, v70
  v_smfmac_f32_16x16x64_bf16 v[216:219], v[12:15], v[224:231], v11
  buffer_load_dwordx4 v[80:83], v3, s[4:7], s30 offen offset:0
  v_exp_f32 v71, v71
  v_mfma_f32_32x32x16_bf16 v[48:63], v[100:103], v[20:23], v[48:63]
  v_cvt_pk_bf16_f32 v224, v64, v65
  v_cvt_pk_bf16_f32 v225, v66, v67
  v_cvt_pk_bf16_f32 v226, v68, v69
  v_cvt_pk_bf16_f32 v227, v70, v71
  v_exp_f32 v72, v72
  v_exp_f32 v73, v73
  v_exp_f32 v74, v74
  v_exp_f32 v75, v75
  v_mfma_f32_32x32x16_bf16 v[192:207], v[88:91], v[224:227], v[192:207]
  v_exp_f32 v76, v76
  v_exp_f32 v77, v77
  v_exp_f32 v78, v78
  v_exp_f32 v79, v79
  v_cvt_pk_bf16_f32 v228, v72, v73
  v_cvt_pk_bf16_f32 v229, v74, v75
  v_cvt_pk_bf16_f32 v230, v76, v77
  v_cvt_pk_bf16_f32 v231, v78, v79
  v_mfma_f32_32x32x16_bf16 v[64:79], v[96:99], v[24:27], 0
  v_exp_f32 v48, v48
  v_exp_f32 v49, v49
  v_exp_f32 v50, v50
  v_exp_f32 v51, v51
  v_mfma_f32_32x32x16_bf16 v[192:207], v[92:95], v[228:231], v[192:207]
  v_exp_f32 v52, v52
  v_exp_f32 v53, v53
  v_exp_f32 v54, v54
  v_smfmac_f32_16x16x64_bf16 v[220:223], v[12:15], v[224:231], v11
  buffer_load_dwordx4 v[84:87], v3, s[4:7], s30 offen offset:1024
  v_exp_f32 v55, v55
  v_mfma_f32_32x32x16_bf16 v[64:79], v[100:103], v[28:31], v[64:79]
  s_waitcnt vmcnt(10)
  v_cvt_pk_bf16_f32 v224, v48, v49
  v_cvt_pk_bf16_f32 v225, v50, v51
  v_cvt_pk_bf16_f32 v226, v52, v53
  v_cvt_pk_bf16_f32 v227, v54, v55
  v_exp_f32 v56, v56
  v_exp_f32 v57, v57
  v_exp_f32 v58, v58
  v_exp_f32 v59, v59
  v_mfma_f32_32x32x16_bf16 v[144:159], v[104:107], v[224:227], v[144:159]
  v_exp_f32 v60, v60
  v_exp_f32 v61, v61
  v_exp_f32 v62, v62
  v_exp_f32 v63, v63
  v_cvt_pk_bf16_f32 v228, v56, v57
  v_cvt_pk_bf16_f32 v229, v58, v59
  v_cvt_pk_bf16_f32 v230, v60, v61
  v_cvt_pk_bf16_f32 v231, v62, v63
  v_mfma_f32_32x32x16_bf16 v[48:63], v[96:99], v[32:35], 0
  v_exp_f32 v64, v64
  v_exp_f32 v65, v65
  v_exp_f32 v66, v66
  v_exp_f32 v67, v67
  v_mfma_f32_32x32x16_bf16 v[144:159], v[108:111], v[228:231], v[144:159]
  v_exp_f32 v68, v68
  v_exp_f32 v69, v69
  v_exp_f32 v70, v70
  v_smfmac_f32_16x16x64_bf16 v[208:211], v[12:15], v[224:231], v11
  buffer_load_dwordx4 v[88:91], v3, s[4:7], s30 offen offset:2048
  v_exp_f32 v71, v71
  v_mfma_f32_32x32x16_bf16 v[48:63], v[100:103], v[36:39], v[48:63]
  v_cvt_pk_bf16_f32 v224, v64, v65
  v_cvt_pk_bf16_f32 v225, v66, v67
  v_cvt_pk_bf16_f32 v226, v68, v69
  v_cvt_pk_bf16_f32 v227, v70, v71
  v_exp_f32 v72, v72
  v_exp_f32 v73, v73
  v_exp_f32 v74, v74
  v_exp_f32 v75, v75
  v_mfma_f32_32x32x16_bf16 v[160:175], v[104:107], v[224:227], v[160:175]
  v_exp_f32 v76, v76
  v_exp_f32 v77, v77
  v_exp_f32 v78, v78
  v_exp_f32 v79, v79
  v_cvt_pk_bf16_f32 v228, v72, v73
  v_cvt_pk_bf16_f32 v229, v74, v75
  v_cvt_pk_bf16_f32 v230, v76, v77
  v_cvt_pk_bf16_f32 v231, v78, v79
  v_mfma_f32_32x32x16_bf16 v[64:79], v[96:99], v[40:43], 0
  v_exp_f32 v48, v48
  v_exp_f32 v49, v49
  v_exp_f32 v50, v50
  v_exp_f32 v51, v51
  v_mfma_f32_32x32x16_bf16 v[160:175], v[108:111], v[228:231], v[160:175]
  v_exp_f32 v52, v52
  v_exp_f32 v53, v53
  v_exp_f32 v54, v54
  v_smfmac_f32_16x16x64_bf16 v[212:215], v[12:15], v[224:231], v11
  buffer_load_dwordx4 v[92:95], v3, s[4:7], s30 offen offset:3072
  v_exp_f32 v55, v55
  v_mfma_f32_32x32x16_bf16 v[64:79], v[100:103], v[44:47], v[64:79]
  v_cvt_pk_bf16_f32 v224, v48, v49
  v_cvt_pk_bf16_f32 v225, v50, v51
  v_cvt_pk_bf16_f32 v226, v52, v53
  v_cvt_pk_bf16_f32 v227, v54, v55
  v_exp_f32 v56, v56
  v_exp_f32 v57, v57
  v_exp_f32 v58, v58
  v_exp_f32 v59, v59
  v_mfma_f32_32x32x16_bf16 v[176:191], v[104:107], v[224:227], v[176:191]
  s_waitcnt vmcnt(10)
  v_exp_f32 v60, v60
  v_exp_f32 v61, v61
  v_exp_f32 v62, v62
  v_exp_f32 v63, v63
  v_cvt_pk_bf16_f32 v228, v56, v57
  v_cvt_pk_bf16_f32 v229, v58, v59
  v_cvt_pk_bf16_f32 v230, v60, v61
  v_cvt_pk_bf16_f32 v231, v62, v63
  v_mfma_f32_32x32x16_bf16 v[48:63], v[112:115], v[16:19], 0
  v_exp_f32 v64, v64
  v_exp_f32 v65, v65
  v_exp_f32 v66, v66
  v_exp_f32 v67, v67
  v_mfma_f32_32x32x16_bf16 v[176:191], v[108:111], v[228:231], v[176:191]
  v_exp_f32 v68, v68
  v_exp_f32 v69, v69
  v_exp_f32 v70, v70
  v_smfmac_f32_16x16x64_bf16 v[216:219], v[12:15], v[224:231], v11
  buffer_load_dwordx4 v[96:99], v10, s[4:7], s30 offen offset:0
  v_exp_f32 v71, v71
  v_mfma_f32_32x32x16_bf16 v[48:63], v[116:119], v[20:23], v[48:63]
  v_cvt_pk_bf16_f32 v224, v64, v65
  v_cvt_pk_bf16_f32 v225, v66, v67
  v_cvt_pk_bf16_f32 v226, v68, v69
  v_cvt_pk_bf16_f32 v227, v70, v71
  v_exp_f32 v72, v72
  v_exp_f32 v73, v73
  v_exp_f32 v74, v74
  v_exp_f32 v75, v75
  v_mfma_f32_32x32x16_bf16 v[192:207], v[104:107], v[224:227], v[192:207]
  v_exp_f32 v76, v76
  v_exp_f32 v77, v77
  v_exp_f32 v78, v78
  v_exp_f32 v79, v79
  v_cvt_pk_bf16_f32 v228, v72, v73
  v_cvt_pk_bf16_f32 v229, v74, v75
  v_cvt_pk_bf16_f32 v230, v76, v77
  v_cvt_pk_bf16_f32 v231, v78, v79
.fz_kernel_a_b2:
  v_mfma_f32_32x32x16_bf16 v[64:79], v[112:115], v[24:27], 0
  v_exp_f32 v48, v48
  v_exp_f32 v49, v49
  v_exp_f32 v50, v50
  v_exp_f32 v51, v51
  v_mfma_f32_32x32x16_bf16 v[192:207], v[108:111], v[228:231], v[192:207]
  v_exp_f32 v52, v52
  v_exp_f32 v53, v53
  v_exp_f32 v54, v54
  v_smfmac_f32_16x16x64_bf16 v[220:223], v[12:15], v[224:231], v11
  buffer_load_dwordx4 v[100:103], v10, s[4:7], s30 offen offset:1024
  v_exp_f32 v55, v55
  v_mfma_f32_32x32x16_bf16 v[64:79], v[116:119], v[28:31], v[64:79]
  s_waitcnt vmcnt(10)
  v_cvt_pk_bf16_f32 v224, v48, v49
  v_cvt_pk_bf16_f32 v225, v50, v51
  v_cvt_pk_bf16_f32 v226, v52, v53
  v_cvt_pk_bf16_f32 v227, v54, v55
  v_exp_f32 v56, v56
  v_exp_f32 v57, v57
  v_exp_f32 v58, v58
  v_exp_f32 v59, v59
  v_mfma_f32_32x32x16_bf16 v[144:159], v[120:123], v[224:227], v[144:159]
  v_exp_f32 v60, v60
  v_exp_f32 v61, v61
  v_exp_f32 v62, v62
  v_exp_f32 v63, v63
  v_cvt_pk_bf16_f32 v228, v56, v57
  v_cvt_pk_bf16_f32 v229, v58, v59
  v_cvt_pk_bf16_f32 v230, v60, v61
  v_cvt_pk_bf16_f32 v231, v62, v63
  v_mfma_f32_32x32x16_bf16 v[48:63], v[112:115], v[32:35], 0
  v_exp_f32 v64, v64
  v_exp_f32 v65, v65
  v_exp_f32 v66, v66
  v_exp_f32 v67, v67
  v_mfma_f32_32x32x16_bf16 v[144:159], v[124:127], v[228:231], v[144:159]
  v_exp_f32 v68, v68
  v_exp_f32 v69, v69
  v_exp_f32 v70, v70
  v_smfmac_f32_16x16x64_bf16 v[208:211], v[12:15], v[224:231], v11
  buffer_load_dwordx4 v[104:107], v10, s[4:7], s30 offen offset:2048
  v_exp_f32 v71, v71
  v_mfma_f32_32x32x16_bf16 v[48:63], v[116:119], v[36:39], v[48:63]
  s_ff1_i32_b32 s33, s36
  v_cvt_pk_bf16_f32 v224, v64, v65
  v_cvt_pk_bf16_f32 v225, v66, v67
  v_cvt_pk_bf16_f32 v226, v68, v69
  v_cvt_pk_bf16_f32 v227, v70, v71
  v_exp_f32 v72, v72
  v_exp_f32 v73, v73
  v_exp_f32 v74, v74
  v_exp_f32 v75, v75
  v_mfma_f32_32x32x16_bf16 v[160:175], v[120:123], v[224:227], v[160:175]
  s_bitset0_b32 s36, s33
  v_exp_f32 v76, v76
  v_exp_f32 v77, v77
  v_exp_f32 v78, v78
  v_exp_f32 v79, v79
  v_cvt_pk_bf16_f32 v228, v72, v73
  v_cvt_pk_bf16_f32 v229, v74, v75
  v_cvt_pk_bf16_f32 v230, v76, v77
  v_cvt_pk_bf16_f32 v231, v78, v79
  v_mfma_f32_32x32x16_bf16 v[64:79], v[112:115], v[40:43], 0
  s_lshl_b32 s33, s33, 14
  v_exp_f32 v48, v48
  v_exp_f32 v49, v49
  v_exp_f32 v50, v50
  v_exp_f32 v51, v51
  v_mfma_f32_32x32x16_bf16 v[160:175], v[124:127], v[228:231], v[160:175]
  v_exp_f32 v52, v52
  v_exp_f32 v53, v53
  v_exp_f32 v54, v54
  v_smfmac_f32_16x16x64_bf16 v[212:215], v[12:15], v[224:231], v11
  buffer_load_dwordx4 v[108:111], v10, s[4:7], s30 offen offset:3072
  v_exp_f32 v55, v55
  v_mfma_f32_32x32x16_bf16 v[64:79], v[116:119], v[44:47], v[64:79]
  s_add_u32 s30, s33, s35
  v_cvt_pk_bf16_f32 v224, v48, v49
  v_cvt_pk_bf16_f32 v225, v50, v51
  v_cvt_pk_bf16_f32 v226, v52, v53
  v_cvt_pk_bf16_f32 v227, v54, v55
  v_exp_f32 v56, v56
  v_exp_f32 v57, v57
  v_exp_f32 v58, v58
  v_exp_f32 v59, v59
  v_mfma_f32_32x32x16_bf16 v[176:191], v[120:123], v[224:227], v[176:191]
  s_waitcnt vmcnt(10)
  v_exp_f32 v60, v60
  v_exp_f32 v61, v61
  v_exp_f32 v62, v62
  v_exp_f32 v63, v63
  v_cvt_pk_bf16_f32 v228, v56, v57
  v_cvt_pk_bf16_f32 v229, v58, v59
  v_cvt_pk_bf16_f32 v230, v60, v61
  v_cvt_pk_bf16_f32 v231, v62, v63
  v_mfma_f32_32x32x16_bf16 v[48:63], v[128:131], v[16:19], 0
  s_cbranch_scc1 .fz_kernel_pk32c
.fz_kernel_pk32:
  v_exp_f32 v64, v64
  v_exp_f32 v65, v65
  v_exp_f32 v66, v66
  v_exp_f32 v67, v67
  v_mfma_f32_32x32x16_bf16 v[176:191], v[124:127], v[228:231], v[176:191]
  v_exp_f32 v68, v68
  v_exp_f32 v69, v69
  v_exp_f32 v70, v70
  v_smfmac_f32_16x16x64_bf16 v[216:219], v[12:15], v[224:231], v11
  buffer_load_dwordx4 v[112:115], v3, s[4:7], s30 offen offset:0
  v_exp_f32 v71, v71
  v_mfma_f32_32x32x16_bf16 v[48:63], v[132:135], v[20:23], v[48:63]
  v_cvt_pk_bf16_f32 v224, v64, v65
  v_cvt_pk_bf16_f32 v225, v66, v67
  v_cvt_pk_bf16_f32 v226, v68, v69
  v_cvt_pk_bf16_f32 v227, v70, v71
  v_exp_f32 v72, v72
  v_exp_f32 v73, v73
  v_exp_f32 v74, v74
  v_exp_f32 v75, v75
  v_mfma_f32_32x32x16_bf16 v[192:207], v[120:123], v[224:227], v[192:207]
  v_exp_f32 v76, v76
  v_exp_f32 v77, v77
  v_exp_f32 v78, v78
  v_exp_f32 v79, v79
  v_cvt_pk_bf16_f32 v228, v72, v73
  v_cvt_pk_bf16_f32 v229, v74, v75
  v_cvt_pk_bf16_f32 v230, v76, v77
  v_cvt_pk_bf16_f32 v231, v78, v79
  v_mfma_f32_32x32x16_bf16 v[64:79], v[128:131], v[24:27], 0
  v_exp_f32 v48, v48
  v_exp_f32 v49, v49
  v_exp_f32 v50, v50
  v_exp_f32 v51, v51
  v_mfma_f32_32x32x16_bf16 v[192:207], v[124:127], v[228:231], v[192:207]
  v_exp_f32 v52, v52
  v_exp_f32 v53, v53
  v_exp_f32 v54, v54
  v_smfmac_f32_16x16x64_bf16 v[220:223], v[12:15], v[224:231], v11
  buffer_load_dwordx4 v[116:119], v3, s[4:7], s30 offen offset:1024
  v_exp_f32 v55, v55
  v_mfma_f32_32x32x16_bf16 v[64:79], v[132:135], v[28:31], v[64:79]
  s_waitcnt vmcnt(10)
  v_cvt_pk_bf16_f32 v224, v48, v49
  v_cvt_pk_bf16_f32 v225, v50, v51
  v_cvt_pk_bf16_f32 v226, v52, v53
  v_cvt_pk_bf16_f32 v227, v54, v55
  v_exp_f32 v56, v56
  v_exp_f32 v57, v57
  v_exp_f32 v58, v58
  v_exp_f32 v59, v59
  v_mfma_f32_32x32x16_bf16 v[144:159], v[136:139], v[224:227], v[144:159]
  v_exp_f32 v60, v60
  v_exp_f32 v61, v61
  v_exp_f32 v62, v62
  v_exp_f32 v63, v63
  v_cvt_pk_bf16_f32 v228, v56, v57
  v_cvt_pk_bf16_f32 v229, v58, v59
  v_cvt_pk_bf16_f32 v230, v60, v61
  v_cvt_pk_bf16_f32 v231, v62, v63
  v_mfma_f32_32x32x16_bf16 v[48:63], v[128:131], v[32:35], 0
  s_sub_u32 s32, s32, 1
  v_exp_f32 v64, v64
  v_exp_f32 v65, v65
  v_exp_f32 v66, v66
  v_exp_f32 v67, v67
  v_mfma_f32_32x32x16_bf16 v[144:159], v[140:143], v[228:231], v[144:159]
  s_cmp_eq_u32 s32, 0
  v_exp_f32 v68, v68
  v_exp_f32 v69, v69
  v_exp_f32 v70, v70
  v_smfmac_f32_16x16x64_bf16 v[208:211], v[12:15], v[224:231], v11
  buffer_load_dwordx4 v[120:123], v3, s[4:7], s30 offen offset:2048
  v_exp_f32 v71, v71
  v_mfma_f32_32x32x16_bf16 v[48:63], v[132:135], v[36:39], v[48:63]
  v_cvt_pk_bf16_f32 v224, v64, v65
  v_cvt_pk_bf16_f32 v225, v66, v67
  v_cvt_pk_bf16_f32 v226, v68, v69
  v_cvt_pk_bf16_f32 v227, v70, v71
  v_exp_f32 v72, v72
  v_exp_f32 v73, v73
  v_exp_f32 v74, v74
  v_exp_f32 v75, v75
  v_mfma_f32_32x32x16_bf16 v[160:175], v[136:139], v[224:227], v[160:175]
  v_exp_f32 v76, v76
  v_exp_f32 v77, v77
  v_exp_f32 v78, v78
  v_exp_f32 v79, v79
  v_cvt_pk_bf16_f32 v228, v72, v73
  v_cvt_pk_bf16_f32 v229, v74, v75
  v_cvt_pk_bf16_f32 v230, v76, v77
  v_cvt_pk_bf16_f32 v231, v78, v79
  s_cbranch_scc1 .fz_kernel_a_x
  v_mfma_f32_32x32x16_bf16 v[64:79], v[128:131], v[40:43], 0
  v_exp_f32 v48, v48
  v_exp_f32 v49, v49
  v_exp_f32 v50, v50
  v_exp_f32 v51, v51
  v_mfma_f32_32x32x16_bf16 v[160:175], v[140:143], v[228:231], v[160:175]
  v_exp_f32 v52, v52
  v_exp_f32 v53, v53
  v_exp_f32 v54, v54
  v_smfmac_f32_16x16x64_bf16 v[212:215], v[12:15], v[224:231], v11
  buffer_load_dwordx4 v[124:127], v3, s[4:7], s30 offen offset:3072
  v_exp_f32 v55, v55
  v_mfma_f32_32x32x16_bf16 v[64:79], v[132:135], v[44:47], v[64:79]
  v_cvt_pk_bf16_f32 v224, v48, v49
  v_cvt_pk_bf16_f32 v225, v50, v51
  v_cvt_pk_bf16_f32 v226, v52, v53
  v_cvt_pk_bf16_f32 v227, v54, v55
  v_exp_f32 v56, v56
  v_exp_f32 v57, v57
  v_exp_f32 v58, v58
  v_exp_f32 v59, v59
  v_mfma_f32_32x32x16_bf16 v[176:191], v[136:139], v[224:227], v[176:191]
  s_waitcnt vmcnt(10)
  v_exp_f32 v60, v60
  v_exp_f32 v61, v61
  v_exp_f32 v62, v62
  v_exp_f32 v63, v63
  v_cvt_pk_bf16_f32 v228, v56, v57
  v_cvt_pk_bf16_f32 v229, v58, v59
  v_cvt_pk_bf16_f32 v230, v60, v61
  v_cvt_pk_bf16_f32 v231, v62, v63
  v_mfma_f32_32x32x16_bf16 v[48:63], v[80:83], v[16:19], 0
  v_exp_f32 v64, v64
  v_exp_f32 v65, v65
  v_exp_f32 v66, v66
  v_exp_f32 v67, v67
  v_mfma_f32_32x32x16_bf16 v[176:191], v[140:143], v[228:231], v[176:191]
  v_exp_f32 v68, v68
  v_exp_f32 v69, v69
  v_exp_f32 v70, v70
  v_smfmac_f32_16x16x64_bf16 v[216:219], v[12:15], v[224:231], v11
  buffer_load_dwordx4 v[128:131], v10, s[4:7], s30 offen offset:0
  v_exp_f32 v71, v71
  v_mfma_f32_32x32x16_bf16 v[48:63], v[84:87], v[20:23], v[48:63]
  v_cvt_pk_bf16_f32 v224, v64, v65
  v_cvt_pk_bf16_f32 v225, v66, v67
  v_cvt_pk_bf16_f32 v226, v68, v69
  v_cvt_pk_bf16_f32 v227, v70, v71
  v_exp_f32 v72, v72
  v_exp_f32 v73, v73
  v_exp_f32 v74, v74
  v_exp_f32 v75, v75
  v_mfma_f32_32x32x16_bf16 v[192:207], v[136:139], v[224:227], v[192:207]
  v_exp_f32 v76, v76
  v_exp_f32 v77, v77
  v_exp_f32 v78, v78
  v_exp_f32 v79, v79
  v_cvt_pk_bf16_f32 v228, v72, v73
  v_cvt_pk_bf16_f32 v229, v74, v75
  v_cvt_pk_bf16_f32 v230, v76, v77
  v_cvt_pk_bf16_f32 v231, v78, v79
  s_branch .fz_kernel_a_loop
.fz_kernel_a_x:
  v_cvt_pk_bf16_f32 v144, v144, v145
  v_cvt_pk_bf16_f32 v145, v146, v147
  v_cvt_pk_bf16_f32 v146, v148, v149
  v_cvt_pk_bf16_f32 v147, v150, v151
  ds_write_b128 v9, v[144:147] offset:0
  v_cvt_pk_bf16_f32 v148, v152, v153
  v_cvt_pk_bf16_f32 v149, v154, v155
  v_cvt_pk_bf16_f32 v150, v156, v157
  v_cvt_pk_bf16_f32 v151, v158, v159
  ds_write_b128 v9, v[148:151] offset:1024
  v_add_f32 v208, v208, v210
  v_add_f32 v209, v209, v211
  v_cndmask_b32 v30, v208, v209, s[26:27]
  v_mfma_f32_32x32x16_bf16 v[64:79], v[128:131], v[40:43], 0
  v_exp_f32 v48, v48
  v_exp_f32 v49, v49
  v_exp_f32 v50, v50
  v_exp_f32 v51, v51
  v_mfma_f32_32x32x16_bf16 v[160:175], v[140:143], v[228:231], v[160:175]
  v_exp_f32 v52, v52
  v_exp_f32 v53, v53
  v_exp_f32 v54, v54
  v_smfmac_f32_16x16x64_bf16 v[212:215], v[12:15], v[224:231], v11
  v_exp_f32 v55, v55
  v_mfma_f32_32x32x16_bf16 v[64:79], v[132:135], v[44:47], v[64:79]
  v_cvt_pk_bf16_f32 v224, v48, v49
  v_cvt_pk_bf16_f32 v225, v50, v51
  v_cvt_pk_bf16_f32 v226, v52, v53
  v_cvt_pk_bf16_f32 v227, v54, v55
  v_exp_f32 v56, v56
  v_exp_f32 v57, v57
  v_exp_f32 v58, v58
  v_exp_f32 v59, v59
  v_mfma_f32_32x32x16_bf16 v[176:191], v[136:139], v[224:227], v[176:191]
  v_exp_f32 v60, v60
  v_exp_f32 v61, v61
  v_exp_f32 v62, v62
  v_exp_f32 v63, v63
  v_cvt_pk_bf16_f32 v228, v56, v57
  v_cvt_pk_bf16_f32 v229, v58, v59
  v_cvt_pk_bf16_f32 v230, v60, v61
  v_cvt_pk_bf16_f32 v231, v62, v63
  v_cvt_pk_bf16_f32 v160, v160, v161
  v_cvt_pk_bf16_f32 v161, v162, v163
  v_cvt_pk_bf16_f32 v162, v164, v165
  v_cvt_pk_bf16_f32 v163, v166, v167
  ds_write_b128 v9, v[160:163] offset:2048
  v_cvt_pk_bf16_f32 v164, v168, v169
  v_cvt_pk_bf16_f32 v165, v170, v171
  v_cvt_pk_bf16_f32 v166, v172, v173
  v_cvt_pk_bf16_f32 v167, v174, v175
  ds_write_b128 v9, v[164:167] offset:3072
  v_add_f32 v212, v212, v214
  v_add_f32 v213, v213, v215
  v_cndmask_b32 v31, v212, v213, s[26:27]
  ds_write_b64 v1, v[30:31]
  v_xor_b32 v1, 512, v1
  v_exp_f32 v64, v64
  v_exp_f32 v65, v65
  v_exp_f32 v66, v66
  v_exp_f32 v67, v67
  v_mfma_f32_32x32x16_bf16 v[176:191], v[140:143], v[228:231], v[176:191]
  v_exp_f32 v68, v68
  v_exp_f32 v69, v69
  v_exp_f32 v70, v70
  v_smfmac_f32_16x16x64_bf16 v[216:219], v[12:15], v[224:231], v11
  s_waitcnt vmcnt(0) lgkmcnt(0)
  s_barrier
  ds_read_b128 v[48:51], v8 offset:0
  ds_read_b128 v[52:55], v8 offset:1024
  ds_read_b128 v[56:59], v8 offset:2048
  ds_read_b128 v[60:63], v8 offset:3072
  ds_read_b64 v[30:31], v1
  v_exp_f32 v71, v71
  v_cvt_pk_bf16_f32 v224, v64, v65
  v_cvt_pk_bf16_f32 v225, v66, v67
  v_cvt_pk_bf16_f32 v226, v68, v69
  v_cvt_pk_bf16_f32 v227, v70, v71
  v_exp_f32 v72, v72
  v_exp_f32 v73, v73
  s_waitcnt lgkmcnt(3)
  v_mfma_f32_32x32x16_bf16 v[176:191], v[248:251], v[48:51], v[176:191]
  v_exp_f32 v74, v74
  v_exp_f32 v75, v75
  v_mfma_f32_32x32x16_bf16 v[192:207], v[136:139], v[224:227], v[192:207]
  v_exp_f32 v76, v76
  v_exp_f32 v77, v77
  s_waitcnt lgkmcnt(0)
  v_mfma_f32_32x32x16_bf16 v[176:191], v[252:255], v[52:55], v[176:191]
  v_exp_f32 v78, v78
  v_exp_f32 v79, v79
  v_mfma_f32_32x32x16_bf16 v[192:207], v[248:251], v[56:59], v[192:207]
  v_cvt_pk_bf16_f32 v228, v72, v73
  v_cvt_pk_bf16_f32 v229, v74, v75
  v_cvt_pk_bf16_f32 v230, v76, v77
  v_cvt_pk_bf16_f32 v231, v78, v79
  v_mfma_f32_32x32x16_bf16 v[192:207], v[252:255], v[60:63], v[192:207]
  v_add_f32 v216, v216, v218
  v_add_f32 v217, v217, v219
  v_cndmask_b32 v24, v216, v217, s[26:27]
  v_add_f32 v24, v24, v30
  s_mov_b64 s[36:37], -1
  v_smfmac_f32_16x16x64_bf16 v[220:223], v[12:15], v[224:231], v11
  v_mfma_f32_32x32x16_bf16 v[192:207], v[140:143], v[228:231], v[192:207]
  v_rcp_f32 v26, v24
  v_cmp_le_f32 vcc, s24, v24
  s_and_b64 s[36:37], s[36:37], vcc
  v_cmp_ge_f32 vcc, s25, v24
  s_and_b64 s[36:37], s[36:37], vcc
  v_pk_mul_f32 v[176:177], v[176:177], v[26:27] op_sel_hi:[1,0]
  v_pk_mul_f32 v[178:179], v[178:179], v[26:27] op_sel_hi:[1,0]
  v_pk_mul_f32 v[180:181], v[180:181], v[26:27] op_sel_hi:[1,0]
  v_pk_mul_f32 v[182:183], v[182:183], v[26:27] op_sel_hi:[1,0]
  v_cvt_pk_bf16_f32 v48, v176, v177
  v_cvt_pk_bf16_f32 v49, v178, v179
  v_cvt_pk_bf16_f32 v50, v180, v181
  v_cvt_pk_bf16_f32 v51, v182, v183
  buffer_store_dwordx4 v[48:51], v3, s[4:7], s28 offen offset:0 sc1
  v_pk_mul_f32 v[184:185], v[184:185], v[26:27] op_sel_hi:[1,0]
  v_pk_mul_f32 v[186:187], v[186:187], v[26:27] op_sel_hi:[1,0]
  v_pk_mul_f32 v[188:189], v[188:189], v[26:27] op_sel_hi:[1,0]
  v_pk_mul_f32 v[190:191], v[190:191], v[26:27] op_sel_hi:[1,0]
  v_cvt_pk_bf16_f32 v52, v184, v185
  v_cvt_pk_bf16_f32 v53, v186, v187
  v_cvt_pk_bf16_f32 v54, v188, v189
  v_cvt_pk_bf16_f32 v55, v190, v191
  buffer_store_dwordx4 v[52:55], v3, s[4:7], s28 offen offset:1024 sc1
  v_add_f32 v220, v220, v222
  v_add_f32 v221, v221, v223
  v_cndmask_b32 v25, v220, v221, s[26:27]
  v_add_f32 v25, v25, v31
.fz_kernel_a_fin:
  v_rcp_f32 v28, v25
  v_cmp_le_f32 vcc, s24, v25
  s_and_b64 s[36:37], s[36:37], vcc
  v_cmp_ge_f32 vcc, s25, v25
  s_and_b64 s[36:37], s[36:37], vcc
  v_pk_mul_f32 v[192:193], v[192:193], v[28:29] op_sel_hi:[1,0]
  v_pk_mul_f32 v[194:195], v[194:195], v[28:29] op_sel_hi:[1,0]
  v_pk_mul_f32 v[196:197], v[196:197], v[28:29] op_sel_hi:[1,0]
  v_pk_mul_f32 v[198:199], v[198:199], v[28:29] op_sel_hi:[1,0]
  v_cvt_pk_bf16_f32 v56, v192, v193
  v_cvt_pk_bf16_f32 v57, v194, v195
  v_cvt_pk_bf16_f32 v58, v196, v197
  v_cvt_pk_bf16_f32 v59, v198, v199
  buffer_store_dwordx4 v[56:59], v3, s[4:7], s29 offen offset:0 sc1
  v_pk_mul_f32 v[200:201], v[200:201], v[28:29] op_sel_hi:[1,0]
  v_pk_mul_f32 v[202:203], v[202:203], v[28:29] op_sel_hi:[1,0]
  v_pk_mul_f32 v[204:205], v[204:205], v[28:29] op_sel_hi:[1,0]
  v_pk_mul_f32 v[206:207], v[206:207], v[28:29] op_sel_hi:[1,0]
  v_cvt_pk_bf16_f32 v60, v200, v201
  v_cvt_pk_bf16_f32 v61, v202, v203
  v_cvt_pk_bf16_f32 v62, v204, v205
  v_cvt_pk_bf16_f32 v63, v206, v207
  buffer_store_dwordx4 v[60:63], v3, s[4:7], s29 offen offset:1024 sc1
  ds_read_b32 v7, v6 offset:8
  v_pk_fma_f32 v[64:65], v[176:177], 0, 0 op_sel_hi:[1,0,0]
  v_pk_fma_f32 v[66:67], v[178:179], 0, 0 op_sel_hi:[1,0,0]
  v_pk_fma_f32 v[64:65], v[180:181], 0, v[64:65] op_sel_hi:[1,0,1]
  v_pk_fma_f32 v[66:67], v[182:183], 0, v[66:67] op_sel_hi:[1,0,1]
  v_pk_fma_f32 v[64:65], v[184:185], 0, v[64:65] op_sel_hi:[1,0,1]
  v_pk_fma_f32 v[66:67], v[186:187], 0, v[66:67] op_sel_hi:[1,0,1]
  v_pk_fma_f32 v[64:65], v[188:189], 0, v[64:65] op_sel_hi:[1,0,1]
  v_pk_fma_f32 v[66:67], v[190:191], 0, v[66:67] op_sel_hi:[1,0,1]
  v_pk_fma_f32 v[64:65], v[192:193], 0, v[64:65] op_sel_hi:[1,0,1]
  v_pk_fma_f32 v[66:67], v[194:195], 0, v[66:67] op_sel_hi:[1,0,1]
  v_pk_fma_f32 v[64:65], v[196:197], 0, v[64:65] op_sel_hi:[1,0,1]
  v_pk_fma_f32 v[66:67], v[198:199], 0, v[66:67] op_sel_hi:[1,0,1]
  v_pk_fma_f32 v[64:65], v[200:201], 0, v[64:65] op_sel_hi:[1,0,1]
  v_pk_fma_f32 v[66:67], v[202:203], 0, v[66:67] op_sel_hi:[1,0,1]
  v_pk_fma_f32 v[64:65], v[204:205], 0, v[64:65] op_sel_hi:[1,0,1]
  v_pk_fma_f32 v[66:67], v[206:207], 0, v[66:67] op_sel_hi:[1,0,1]
  v_pk_add_f32 v[64:65], v[64:65], v[66:67]
  v_cmp_o_f32 vcc, v64, v65
  s_and_b64 s[36:37], s[36:37], vcc
  s_cmp_eq_u64 s[36:37], -1
  s_cbranch_scc0 .fz_kernel_a_slow
.fz_kernel_a_ok:
  s_mov_b32 s8, s48
  s_mov_b32 s9, s49
  s_mov_b32 s10, 0x800
  s_mov_b32 s11, 0x00020000
  v_lshrrev_b32 v17, 5, v2
  v_lshlrev_b32 v19, 4, v17
  s_lshl_b32 s22, s18, 7
  s_lshl2_add_u32 s32, s17, s16
  s_lshl_b32 s35, s32, 16
  s_add_u32 s35, s35, s64
  s_mov_b32 s34, 0
  v_add_u32 v6, 8, v6
  buffer_load_dwordx4 v[48:51], v19, s[8:11], s22 offen offset:0
  buffer_load_dwordx4 v[52:55], v19, s[8:11], s22 offen offset:32
  buffer_load_dwordx4 v[56:59], v19, s[8:11], s22 offen offset:64
  buffer_load_dwordx4 v[60:63], v19, s[8:11], s22 offen offset:96
  s_waitcnt lgkmcnt(0)
  v_readfirstlane_b32 s36, v7
  s_bcnt1_i32_b32 s29, s36
  s_cmp_lt_u32 s29, 3
  s_cbranch_scc1 .fz_kernel_w_e0
  s_andn2_b32 s33, s36, s34
  s_cbranch_scc0 .fz_kernel_pk41c
.fz_kernel_pk41:
  s_ff1_i32_b32 s33, s33
  s_bitset1_b32 s34, s33
  s_lshl_b32 s20, s33, 13
  s_lshl_b32 s33, s33, 12
  s_add_u32 s30, s33, s35
  buffer_load_dwordx4 v[96:99], v3, s[4:7], s30 offen offset:0
  buffer_load_dwordx4 v[100:103], v3, s[4:7], s30 offen offset:1024
  buffer_load_dwordx4 v[104:107], v3, s[4:7], s30 offen offset:2048
  buffer_load_dwordx4 v[108:111], v3, s[4:7], s30 offen offset:3072
  s_andn2_b32 s33, s36, s34
  s_cbranch_scc0 .fz_kernel_pk42c
.fz_kernel_pk42:
  s_ff1_i32_b32 s33, s33
  s_bitset1_b32 s34, s33
  s_lshl_b32 s21, s33, 13
  s_lshl_b32 s33, s33, 12
  s_add_u32 s30, s33, s35
  buffer_load_dwordx4 v[112:115], v3, s[4:7], s30 offen offset:0
  buffer_load_dwordx4 v[116:119], v3, s[4:7], s30 offen offset:1024
  buffer_load_dwordx4 v[120:123], v3, s[4:7], s30 offen offset:2048
  buffer_load_dwordx4 v[124:127], v3, s[4:7], s30 offen offset:3072
  s_andn2_b32 s33, s36, s34
  s_cbranch_scc0 .fz_kernel_pk43c
.fz_kernel_pk43:
  s_ff1_i32_b32 s33, s33
  s_bitset1_b32 s34, s33
  s_lshl_b32 s22, s33, 13
  s_lshl_b32 s33, s33, 12
  s_add_u32 s30, s33, s35
  buffer_load_dwordx4 v[128:131], v3, s[4:7], s30 offen offset:0
  buffer_load_dwordx4 v[132:135], v3, s[4:7], s30 offen offset:1024
  buffer_load_dwordx4 v[136:139], v3, s[4:7], s30 offen offset:2048
  buffer_load_dwordx4 v[140:143], v3, s[4:7], s30 offen offset:3072
.fz_kernel_w_e0:
  v_and_b32 v18, 31, v2
  s_lshl_b32 s39, s17, 4
  s_add_u32 s39, s39, s18
  s_lshl_b32 s39, s39, 2
  s_add_u32 s39, s39, s16
  s_lshl_b32 s39, s39, 12
  v_and_b32 v16, 16, v2
  v_lshlrev_b32 v16, 7, v16
  v_lshl_add_u32 v16, v17, 8, v16
  v_and_b32 v1, 0xf0, v3
  v_add_u32 v16, v16, v1
  s_add_u32 s39, s39, s65
  s_lshl_b32 s31, s16, 5
  v_add_u32 v45, s31, v18
  v_lshlrev_b32 v11, 2, v45
  v_add_u32 v11, 155648, v11
  v_mov_b32 v44, 159952
  ds_read_b32 v40, v11 offset:6400
  ds_read_b32 v42, v11 offset:6912
  ds_read_b32 v46, v44 offset:8
  ds_read_b32 v44, v44
  v_mov_b32 v47, 0.32768
  v_add_u32 v45, 1, v45
  v_bfe_u32 v11, v2, 2, 2
  v_lshl_add_u32 v12, v17, 2, v11
  v_lshlrev_b32 v12, 7, v12
  v_lshrrev_b32 v13, 1, v11
  v_lshl_add_u32 v12, v13, 6, v12
  v_bfe_u32 v13, v2, 4, 1
  v_lshl_add_u32 v12, v13, 5, v12
  v_and_b32 v13, 1, v2
  v_lshl_add_u32 v12, v13, 4, v12
  v_bfe_u32 v13, v2, 1, 1
  v_lshl_add_u32 v14, v13, 3, v12
  v_xor_b32 v15, 64, v14
  s_mov_b64 exec, 1
  s_cmp_lt_u32 s29, 3
  s_cbranch_scc1 .fz_kernel_w_e1
  s_waitcnt vmcnt(16)
  s_branch .fz_kernel_w_e3
.fz_kernel_w_e1:
  s_waitcnt vmcnt(4)
.fz_kernel_w_e3:
  ds_add_u32 v6, v5 offset:0x100
  s_mov_b64 exec, -1
  v_lshlrev_b32 v64, 16, v232
  v_and_b32 v65, 0xffff0000, v232
  v_lshlrev_b32 v66, 16, v233
  v_and_b32 v67, 0xffff0000, v233
  v_lshlrev_b32 v68, 16, v234
  v_and_b32 v69, 0xffff0000, v234
  v_lshlrev_b32 v70, 16, v235
  v_and_b32 v71, 0xffff0000, v235
  v_lshlrev_b32 v72, 16, v236
  v_and_b32 v73, 0xffff0000, v236
  v_lshlrev_b32 v74, 16, v237
  v_and_b32 v75, 0xffff0000, v237
  v_lshlrev_b32 v76, 16, v238
  v_and_b32 v77, 0xffff0000, v238
  v_lshlrev_b32 v78, 16, v239
  v_and_b32 v79, 0xffff0000, v239
  v_lshlrev_b32 v80, 16, v240
  v_and_b32 v81, 0xffff0000, v240
  v_lshlrev_b32 v82, 16, v241
  v_and_b32 v83, 0xffff0000, v241
  v_lshlrev_b32 v84, 16, v242
  v_and_b32 v85, 0xffff0000, v242
  v_lshlrev_b32 v86, 16, v243
  v_and_b32 v87, 0xffff0000, v243
  v_lshlrev_b32 v88, 16, v244
  v_and_b32 v89, 0xffff0000, v244
  v_lshlrev_b32 v90, 16, v245
  v_and_b32 v91, 0xffff0000, v245
  v_lshlrev_b32 v92, 16, v246
  v_and_b32 v93, 0xffff0000, v246
  v_lshlrev_b32 v94, 16, v247
  v_and_b32 v95, 0xffff0000, v247
  s_waitcnt lgkmcnt(0)
  v_pk_fma_f32 v[64:65], v[64:65], v[40:41], v[42:43] op_sel_hi:[1,0,0]
  v_pk_fma_f32 v[66:67], v[66:67], v[40:41], v[42:43] op_sel_hi:[1,0,0]
  v_pk_fma_f32 v[68:69], v[68:69], v[40:41], v[42:43] op_sel_hi:[1,0,0]
  v_pk_fma_f32 v[70:71], v[70:71], v[40:41], v[42:43] op_sel_hi:[1,0,0]
  v_pk_fma_f32 v[72:73], v[72:73], v[40:41], v[42:43] op_sel_hi:[1,0,0]
  v_pk_fma_f32 v[74:75], v[74:75], v[40:41], v[42:43] op_sel_hi:[1,0,0]
  v_pk_fma_f32 v[76:77], v[76:77], v[40:41], v[42:43] op_sel_hi:[1,0,0]
  v_pk_fma_f32 v[78:79], v[78:79], v[40:41], v[42:43] op_sel_hi:[1,0,0]
  v_pk_fma_f32 v[80:81], v[80:81], v[40:41], v[42:43] op_sel_hi:[1,0,0]
  v_pk_fma_f32 v[82:83], v[82:83], v[40:41], v[42:43] op_sel_hi:[1,0,0]
  v_pk_fma_f32 v[84:85], v[84:85], v[40:41], v[42:43] op_sel_hi:[1,0,0]
  v_pk_fma_f32 v[86:87], v[86:87], v[40:41], v[42:43] op_sel_hi:[1,0,0]
  v_pk_fma_f32 v[88:89], v[88:89], v[40:41], v[42:43] op_sel_hi:[1,0,0]
  v_pk_fma_f32 v[90:91], v[90:91], v[40:41], v[42:43] op_sel_hi:[1,0,0]
  v_pk_fma_f32 v[92:93], v[92:93], v[40:41], v[42:43] op_sel_hi:[1,0,0]
  v_pk_fma_f32 v[94:95], v[94:95], v[40:41], v[42:43] op_sel_hi:[1,0,0]
  v_cmp_eq_u32 vcc, v44, v45
  s_cbranch_vccnz .fz_kernel_w_pt
.fz_kernel_w_pb:
  s_cmp_ge_u32 s29, 3
  s_cbranch_scc1 .fz_kernel_w_e2
  s_andn2_b32 s33, s36, s34
  s_cbranch_scc0 .fz_kernel_pk44c
.fz_kernel_pk44:
  s_ff1_i32_b32 s33, s33
  s_bitset1_b32 s34, s33
  s_lshl_b32 s20, s33, 13
  s_lshl_b32 s33, s33, 12
  s_add_u32 s30, s33, s35
  buffer_load_dwordx4 v[96:99], v3, s[4:7], s30 offen offset:0
  buffer_load_dwordx4 v[100:103], v3, s[4:7], s30 offen offset:1024
  buffer_load_dwordx4 v[104:107], v3, s[4:7], s30 offen offset:2048
  buffer_load_dwordx4 v[108:111], v3, s[4:7], s30 offen offset:3072
  s_andn2_b32 s33, s36, s34
  s_cbranch_scc0 .fz_kernel_pk45c
.fz_kernel_pk45:
  s_ff1_i32_b32 s33, s33
  s_bitset1_b32 s34, s33
  s_lshl_b32 s21, s33, 13
  s_lshl_b32 s33, s33, 12
  s_add_u32 s30, s33, s35
  buffer_load_dwordx4 v[112:115], v3, s[4:7], s30 offen offset:0
  buffer_load_dwordx4 v[116:119], v3, s[4:7], s30 offen offset:1024
  buffer_load_dwordx4 v[120:123], v3, s[4:7], s30 offen offset:2048
  buffer_load_dwordx4 v[124:127], v3, s[4:7], s30 offen offset:3072
  s_andn2_b32 s33, s36, s34
  s_cbranch_scc0 .fz_kernel_pk46c
.fz_kernel_pk46:
  s_ff1_i32_b32 s33, s33
  s_bitset1_b32 s34, s33
  s_lshl_b32 s22, s33, 13
  s_lshl_b32 s33, s33, 12
  s_add_u32 s30, s33, s35
  buffer_load_dwordx4 v[128:131], v3, s[4:7], s30 offen offset:0
  buffer_load_dwordx4 v[132:135], v3, s[4:7], s30 offen offset:1024
  buffer_load_dwordx4 v[136:139], v3, s[4:7], s30 offen offset:2048
  buffer_load_dwordx4 v[140:143], v3, s[4:7], s30 offen offset:3072
.fz_kernel_w_e2:
  v_add_u32 v10, s20, v14
  v_add_u32 v11, s20, v15
  ds_read_b64_tr_b16 v[224:225], v10 offset:0
  ds_read_b64_tr_b16 v[226:227], v10 offset:1024
  ds_read_b64_tr_b16 v[228:229], v11 offset:0
  ds_read_b64_tr_b16 v[230:231], v11 offset:1024
  ds_read_b64_tr_b16 v[232:233], v10 offset:2048
  ds_read_b64_tr_b16 v[234:235], v10 offset:3072
  ds_read_b64_tr_b16 v[236:237], v11 offset:2048
  ds_read_b64_tr_b16 v[238:239], v11 offset:3072
  s_andn2_b32 s33, s36, s34
  s_cbranch_scc0 .fz_kernel_pk47c
.fz_kernel_pk47:
  s_ff1_i32_b32 s33, s33
  s_bitset1_b32 s34, s33
  s_lshl_b32 s23, s33, 13
  s_lshl_b32 s33, s33, 12
  s_add_u32 s30, s33, s35
  s_waitcnt vmcnt(11) lgkmcnt(6)
  v_mfma_f32_32x32x16_bf16 v[64:79], v[224:227], v[96:99], v[64:79]
  v_add_u32 v12, s21, v14
  v_add_u32 v13, s21, v15
  buffer_load_dwordx4 v[144:147], v3, s[4:7], s30 offen offset:0
  ds_read_b64_tr_b16 v[240:241], v10 offset:4096
  s_waitcnt lgkmcnt(5)
  v_mfma_f32_32x32x16_bf16 v[80:95], v[228:231], v[96:99], v[80:95]
  ds_read_b64_tr_b16 v[242:243], v10 offset:5120
  ds_read_b64_tr_b16 v[244:245], v11 offset:4096
  ds_read_b64_tr_b16 v[246:247], v11 offset:5120
  s_waitcnt vmcnt(11) lgkmcnt(6)
  v_mfma_f32_32x32x16_bf16 v[64:79], v[232:235], v[100:103], v[64:79]
  buffer_load_dwordx4 v[148:151], v3, s[4:7], s30 offen offset:1024
  ds_read_b64_tr_b16 v[248:249], v10 offset:6144
  s_waitcnt lgkmcnt(5)
  v_mfma_f32_32x32x16_bf16 v[80:95], v[236:239], v[100:103], v[80:95]
  ds_read_b64_tr_b16 v[250:251], v10 offset:7168
  ds_read_b64_tr_b16 v[252:253], v11 offset:6144
  ds_read_b64_tr_b16 v[254:255], v11 offset:7168
  s_waitcnt vmcnt(11) lgkmcnt(6)
  v_mfma_f32_32x32x16_bf16 v[64:79], v[240:243], v[104:107], v[64:79]
  buffer_load_dwordx4 v[152:155], v3, s[4:7], s30 offen offset:2048
  ds_read_b64_tr_b16 v[224:225], v12 offset:0
  s_waitcnt lgkmcnt(5)
  v_mfma_f32_32x32x16_bf16 v[80:95], v[244:247], v[104:107], v[80:95]
  ds_read_b64_tr_b16 v[226:227], v12 offset:1024
  ds_read_b64_tr_b16 v[228:229], v13 offset:0
  ds_read_b64_tr_b16 v[230:231], v13 offset:1024
  s_waitcnt vmcnt(11) lgkmcnt(6)
  v_mfma_f32_32x32x16_bf16 v[64:79], v[248:251], v[108:111], v[64:79]
  buffer_load_dwordx4 v[156:159], v3, s[4:7], s30 offen offset:3072
  ds_read_b64_tr_b16 v[232:233], v12 offset:2048
  s_waitcnt lgkmcnt(5)
  v_mfma_f32_32x32x16_bf16 v[80:95], v[252:255], v[108:111], v[80:95]
  ds_read_b64_tr_b16 v[234:235], v12 offset:3072
  ds_read_b64_tr_b16 v[236:237], v13 offset:2048
  ds_read_b64_tr_b16 v[238:239], v13 offset:3072
  s_andn2_b32 s33, s36, s34
  s_cbranch_scc0 .fz_kernel_pk48c
.fz_kernel_pk48:
  s_ff1_i32_b32 s33, s33
  s_bitset1_b32 s34, s33
  s_lshl_b32 s24, s33, 13
  s_lshl_b32 s33, s33, 12
  s_add_u32 s30, s33, s35
  s_waitcnt vmcnt(11) lgkmcnt(6)
  v_mfma_f32_32x32x16_bf16 v[64:79], v[224:227], v[112:115], v[64:79]
  v_add_u32 v10, s22, v14
  v_add_u32 v11, s22, v15
  buffer_load_dwordx4 v[160:163], v3, s[4:7], s30 offen offset:0
  ds_read_b64_tr_b16 v[240:241], v12 offset:4096
  s_waitcnt lgkmcnt(5)
  v_mfma_f32_32x32x16_bf16 v[80:95], v[228:231], v[112:115], v[80:95]
  ds_read_b64_tr_b16 v[242:243], v12 offset:5120
  ds_read_b64_tr_b16 v[244:245], v13 offset:4096
  ds_read_b64_tr_b16 v[246:247], v13 offset:5120
  s_waitcnt vmcnt(11) lgkmcnt(6)
  v_mfma_f32_32x32x16_bf16 v[64:79], v[232:235], v[116:119], v[64:79]
  buffer_load_dwordx4 v[164:167], v3, s[4:7], s30 offen offset:1024
  ds_read_b64_tr_b16 v[248:249], v12 offset:6144
  s_waitcnt lgkmcnt(5)
  v_mfma_f32_32x32x16_bf16 v[80:95], v[236:239], v[116:119], v[80:95]
  ds_read_b64_tr_b16 v[250:251], v12 offset:7168
  ds_read_b64_tr_b16 v[252:253], v13 offset:6144
  ds_read_b64_tr_b16 v[254:255], v13 offset:7168
  s_waitcnt vmcnt(11) lgkmcnt(6)
  v_mfma_f32_32x32x16_bf16 v[64:79], v[240:243], v[120:123], v[64:79]
  buffer_load_dwordx4 v[168:171], v3, s[4:7], s30 offen offset:2048
  ds_read_b64_tr_b16 v[224:225], v10 offset:0
  s_waitcnt lgkmcnt(5)
  v_mfma_f32_32x32x16_bf16 v[80:95], v[244:247], v[120:123], v[80:95]
  ds_read_b64_tr_b16 v[226:227], v10 offset:1024
  ds_read_b64_tr_b16 v[228:229], v11 offset:0
  ds_read_b64_tr_b16 v[230:231], v11 offset:1024
  s_waitcnt vmcnt(11) lgkmcnt(6)
  v_mfma_f32_32x32x16_bf16 v[64:79], v[248:251], v[124:127], v[64:79]
  buffer_load_dwordx4 v[172:175], v3, s[4:7], s30 offen offset:3072
  ds_read_b64_tr_b16 v[232:233], v10 offset:2048
  s_waitcnt lgkmcnt(5)
  v_mfma_f32_32x32x16_bf16 v[80:95], v[252:255], v[124:127], v[80:95]
  ds_read_b64_tr_b16 v[234:235], v10 offset:3072
  ds_read_b64_tr_b16 v[236:237], v11 offset:2048
  ds_read_b64_tr_b16 v[238:239], v11 offset:3072
  s_andn2_b32 s33, s36, s34
  s_cbranch_scc0 .fz_kernel_pk49c
.fz_kernel_pk49:
  s_ff1_i32_b32 s33, s33
  s_bitset1_b32 s34, s33
  s_lshl_b32 s25, s33, 13
  s_lshl_b32 s33, s33, 12
  s_add_u32 s30, s33, s35
  s_waitcnt vmcnt(11) lgkmcnt(6)
  v_mfma_f32_32x32x16_bf16 v[64:79], v[224:227], v[128:131], v[64:79]
  v_add_u32 v12, s23, v14
  v_add_u32 v13, s23, v15
  buffer_load_dwordx4 v[176:179], v3, s[4:7], s30 offen offset:0
  ds_read_b64_tr_b16 v[240:241], v10 offset:4096
  s_waitcnt lgkmcnt(5)
  v_mfma_f32_32x32x16_bf16 v[80:95], v[228:231], v[128:131], v[80:95]
  ds_read_b64_tr_b16 v[242:243], v10 offset:5120
  ds_read_b64_tr_b16 v[244:245], v11 offset:4096
  ds_read_b64_tr_b16 v[246:247], v11 offset:5120
  s_waitcnt vmcnt(11) lgkmcnt(6)
  v_mfma_f32_32x32x16_bf16 v[64:79], v[232:235], v[132:135], v[64:79]
  buffer_load_dwordx4 v[180:183], v3, s[4:7], s30 offen offset:1024
  ds_read_b64_tr_b16 v[248:249], v10 offset:6144
  s_waitcnt lgkmcnt(5)
  v_mfma_f32_32x32x16_bf16 v[80:95], v[236:239], v[132:135], v[80:95]
  ds_read_b64_tr_b16 v[250:251], v10 offset:7168
  ds_read_b64_tr_b16 v[252:253], v11 offset:6144
  ds_read_b64_tr_b16 v[254:255], v11 offset:7168
  s_waitcnt vmcnt(11) lgkmcnt(6)
  v_mfma_f32_32x32x16_bf16 v[64:79], v[240:243], v[136:139], v[64:79]
  buffer_load_dwordx4 v[184:187], v3, s[4:7], s30 offen offset:2048
  ds_read_b64_tr_b16 v[224:225], v12 offset:0
  s_waitcnt lgkmcnt(5)
  v_mfma_f32_32x32x16_bf16 v[80:95], v[244:247], v[136:139], v[80:95]
  ds_read_b64_tr_b16 v[226:227], v12 offset:1024
  ds_read_b64_tr_b16 v[228:229], v13 offset:0
  ds_read_b64_tr_b16 v[230:231], v13 offset:1024
  s_waitcnt vmcnt(11) lgkmcnt(6)
  v_mfma_f32_32x32x16_bf16 v[64:79], v[248:251], v[140:143], v[64:79]
  buffer_load_dwordx4 v[188:191], v3, s[4:7], s30 offen offset:3072
  ds_read_b64_tr_b16 v[232:233], v12 offset:2048
  s_waitcnt lgkmcnt(5)
  v_mfma_f32_32x32x16_bf16 v[80:95], v[252:255], v[140:143], v[80:95]
  ds_read_b64_tr_b16 v[234:235], v12 offset:3072
  ds_read_b64_tr_b16 v[236:237], v13 offset:2048
  ds_read_b64_tr_b16 v[238:239], v13 offset:3072
  s_andn2_b32 s33, s36, s34
  s_cbranch_scc0 .fz_kernel_pk50c
.fz_kernel_pk50:
  s_ff1_i32_b32 s33, s33
  s_bitset1_b32 s34, s33
  s_lshl_b32 s26, s33, 13
  s_lshl_b32 s33, s33, 12
  s_add_u32 s30, s33, s35
  s_waitcnt vmcnt(11) lgkmcnt(6)
  v_mfma_f32_32x32x16_bf16 v[64:79], v[224:227], v[144:147], v[64:79]
  v_add_u32 v10, s24, v14
  v_add_u32 v11, s24, v15
  buffer_load_dwordx4 v[192:195], v3, s[4:7], s30 offen offset:0
  ds_read_b64_tr_b16 v[240:241], v12 offset:4096
  s_waitcnt lgkmcnt(5)
  v_mfma_f32_32x32x16_bf16 v[80:95], v[228:231], v[144:147], v[80:95]
  ds_read_b64_tr_b16 v[242:243], v12 offset:5120
  ds_read_b64_tr_b16 v[244:245], v13 offset:4096
  ds_read_b64_tr_b16 v[246:247], v13 offset:5120
  s_waitcnt vmcnt(11) lgkmcnt(6)
  v_mfma_f32_32x32x16_bf16 v[64:79], v[232:235], v[148:151], v[64:79]
  buffer_load_dwordx4 v[196:199], v3, s[4:7], s30 offen offset:1024
  ds_read_b64_tr_b16 v[248:249], v12 offset:6144
  s_waitcnt lgkmcnt(5)
  v_mfma_f32_32x32x16_bf16 v[80:95], v[236:239], v[148:151], v[80:95]
  ds_read_b64_tr_b16 v[250:251], v12 offset:7168
  ds_read_b64_tr_b16 v[252:253], v13 offset:6144
  ds_read_b64_tr_b16 v[254:255], v13 offset:7168
  s_waitcnt vmcnt(11) lgkmcnt(6)
  v_mfma_f32_32x32x16_bf16 v[64:79], v[240:243], v[152:155], v[64:79]
  buffer_load_dwordx4 v[200:203], v3, s[4:7], s30 offen offset:2048
  ds_read_b64_tr_b16 v[224:225], v10 offset:0
  s_waitcnt lgkmcnt(5)
  v_mfma_f32_32x32x16_bf16 v[80:95], v[244:247], v[152:155], v[80:95]
  ds_read_b64_tr_b16 v[226:227], v10 offset:1024
  ds_read_b64_tr_b16 v[228:229], v11 offset:0
  ds_read_b64_tr_b16 v[230:231], v11 offset:1024
  s_waitcnt vmcnt(11) lgkmcnt(6)
  v_mfma_f32_32x32x16_bf16 v[64:79], v[248:251], v[156:159], v[64:79]
  buffer_load_dwordx4 v[204:207], v3, s[4:7], s30 offen offset:3072
  ds_read_b64_tr_b16 v[232:233], v10 offset:2048
  s_waitcnt lgkmcnt(5)
  v_mfma_f32_32x32x16_bf16 v[80:95], v[252:255], v[156:159], v[80:95]
  ds_read_b64_tr_b16 v[234:235], v10 offset:3072
  ds_read_b64_tr_b16 v[236:237], v11 offset:2048
  ds_read_b64_tr_b16 v[238:239], v11 offset:3072
  s_andn2_b32 s33, s36, s34
  s_cbranch_scc0 .fz_kernel_pk51c
.fz_kernel_pk51:
  s_ff1_i32_b32 s33, s33
  s_bitset1_b32 s34, s33
  s_lshl_b32 s27, s33, 13
  s_lshl_b32 s33, s33, 12
  s_add_u32 s30, s33, s35
  s_waitcnt vmcnt(11) lgkmcnt(6)
  v_mfma_f32_32x32x16_bf16 v[64:79], v[224:227], v[160:163], v[64:79]
  v_add_u32 v12, s25, v14
  v_add_u32 v13, s25, v15
  buffer_load_dwordx4 v[208:211], v3, s[4:7], s30 offen offset:0
  ds_read_b64_tr_b16 v[240:241], v10 offset:4096
  s_waitcnt lgkmcnt(5)
  v_mfma_f32_32x32x16_bf16 v[80:95], v[228:231], v[160:163], v[80:95]
  ds_read_b64_tr_b16 v[242:243], v10 offset:5120
  ds_read_b64_tr_b16 v[244:245], v11 offset:4096
  ds_read_b64_tr_b16 v[246:247], v11 offset:5120
  s_waitcnt vmcnt(11) lgkmcnt(6)
  v_mfma_f32_32x32x16_bf16 v[64:79], v[232:235], v[164:167], v[64:79]
  buffer_load_dwordx4 v[212:215], v3, s[4:7], s30 offen offset:1024
  ds_read_b64_tr_b16 v[248:249], v10 offset:6144
  s_waitcnt lgkmcnt(5)
  v_mfma_f32_32x32x16_bf16 v[80:95], v[236:239], v[164:167], v[80:95]
  ds_read_b64_tr_b16 v[250:251], v10 offset:7168
  ds_read_b64_tr_b16 v[252:253], v11 offset:6144
  ds_read_b64_tr_b16 v[254:255], v11 offset:7168
  s_waitcnt vmcnt(11) lgkmcnt(6)
  v_mfma_f32_32x32x16_bf16 v[64:79], v[240:243], v[168:171], v[64:79]
  buffer_load_dwordx4 v[216:219], v3, s[4:7], s30 offen offset:2048
  ds_read_b64_tr_b16 v[224:225], v12 offset:0
  s_waitcnt lgkmcnt(5)
  v_mfma_f32_32x32x16_bf16 v[80:95], v[244:247], v[168:171], v[80:95]
  ds_read_b64_tr_b16 v[226:227], v12 offset:1024
  ds_read_b64_tr_b16 v[228:229], v13 offset:0
  ds_read_b64_tr_b16 v[230:231], v13 offset:1024
  s_waitcnt vmcnt(11) lgkmcnt(6)
  v_mfma_f32_32x32x16_bf16 v[64:79], v[248:251], v[172:175], v[64:79]
  buffer_load_dwordx4 v[220:223], v3, s[4:7], s30 offen offset:3072
  ds_read_b64_tr_b16 v[232:233], v12 offset:2048
  s_waitcnt lgkmcnt(5)
  v_mfma_f32_32x32x16_bf16 v[80:95], v[252:255], v[172:175], v[80:95]
  ds_read_b64_tr_b16 v[234:235], v12 offset:3072
  ds_read_b64_tr_b16 v[236:237], v13 offset:2048
  ds_read_b64_tr_b16 v[238:239], v13 offset:3072
  s_andn2_b32 s33, s36, s34
  s_cbranch_scc0 .fz_kernel_pk52c
.fz_kernel_pk52:
  s_ff1_i32_b32 s33, s33
  s_bitset1_b32 s34, s33
  s_lshl_b32 s20, s33, 13
  s_lshl_b32 s33, s33, 12
  s_add_u32 s30, s33, s35
  s_waitcnt vmcnt(11) lgkmcnt(6)
  v_mfma_f32_32x32x16_bf16 v[64:79], v[224:227], v[176:179], v[64:79]
  v_add_u32 v10, s26, v14
  v_add_u32 v11, s26, v15
  buffer_load_dwordx4 v[96:99], v3, s[4:7], s30 offen offset:0
  ds_read_b64_tr_b16 v[240:241], v12 offset:4096
  s_waitcnt lgkmcnt(5)
  v_mfma_f32_32x32x16_bf16 v[80:95], v[228:231], v[176:179], v[80:95]
  ds_read_b64_tr_b16 v[242:243], v12 offset:5120
  ds_read_b64_tr_b16 v[244:245], v13 offset:4096
  ds_read_b64_tr_b16 v[246:247], v13 offset:5120
  s_waitcnt vmcnt(11) lgkmcnt(6)
  v_mfma_f32_32x32x16_bf16 v[64:79], v[232:235], v[180:183], v[64:79]
  buffer_load_dwordx4 v[100:103], v3, s[4:7], s30 offen offset:1024
  ds_read_b64_tr_b16 v[248:249], v12 offset:6144
  s_waitcnt lgkmcnt(5)
  v_mfma_f32_32x32x16_bf16 v[80:95], v[236:239], v[180:183], v[80:95]
  ds_read_b64_tr_b16 v[250:251], v12 offset:7168
  ds_read_b64_tr_b16 v[252:253], v13 offset:6144
  ds_read_b64_tr_b16 v[254:255], v13 offset:7168
  s_waitcnt vmcnt(11) lgkmcnt(6)
  v_mfma_f32_32x32x16_bf16 v[64:79], v[240:243], v[184:187], v[64:79]
  buffer_load_dwordx4 v[104:107], v3, s[4:7], s30 offen offset:2048
  ds_read_b64_tr_b16 v[224:225], v10 offset:0
  s_waitcnt lgkmcnt(5)
  v_mfma_f32_32x32x16_bf16 v[80:95], v[244:247], v[184:187], v[80:95]
  ds_read_b64_tr_b16 v[226:227], v10 offset:1024
  ds_read_b64_tr_b16 v[228:229], v11 offset:0
  ds_read_b64_tr_b16 v[230:231], v11 offset:1024
  s_waitcnt vmcnt(11) lgkmcnt(6)
  v_mfma_f32_32x32x16_bf16 v[64:79], v[248:251], v[188:191], v[64:79]
  buffer_load_dwordx4 v[108:111], v3, s[4:7], s30 offen offset:3072
  ds_read_b64_tr_b16 v[232:233], v10 offset:2048
  s_waitcnt lgkmcnt(5)
  v_mfma_f32_32x32x16_bf16 v[80:95], v[252:255], v[188:191], v[80:95]
  ds_read_b64_tr_b16 v[234:235], v10 offset:3072
  ds_read_b64_tr_b16 v[236:237], v11 offset:2048
  ds_read_b64_tr_b16 v[238:239], v11 offset:3072
  s_andn2_b32 s33, s36, s34
  s_cbranch_scc0 .fz_kernel_pk53c
.fz_kernel_pk53:
  s_ff1_i32_b32 s33, s33
  s_bitset1_b32 s34, s33
  s_lshl_b32 s21, s33, 13
  s_lshl_b32 s33, s33, 12
  s_add_u32 s30, s33, s35
  s_waitcnt vmcnt(11) lgkmcnt(6)
  v_mfma_f32_32x32x16_bf16 v[64:79], v[224:227], v[192:195], v[64:79]
  v_add_u32 v12, s27, v14
  v_add_u32 v13, s27, v15
  buffer_load_dwordx4 v[112:115], v3, s[4:7], s30 offen offset:0
  ds_read_b64_tr_b16 v[240:241], v10 offset:4096
  s_waitcnt lgkmcnt(5)
  v_mfma_f32_32x32x16_bf16 v[80:95], v[228:231], v[192:195], v[80:95]
  ds_read_b64_tr_b16 v[242:243], v10 offset:5120
  ds_read_b64_tr_b16 v[244:245], v11 offset:4096
  ds_read_b64_tr_b16 v[246:247], v11 offset:5120
  s_waitcnt vmcnt(11) lgkmcnt(6)
  v_mfma_f32_32x32x16_bf16 v[64:79], v[232:235], v[196:199], v[64:79]
  buffer_load_dwordx4 v[116:119], v3, s[4:7], s30 offen offset:1024
  ds_read_b64_tr_b16 v[248:249], v10 offset:6144
  s_waitcnt lgkmcnt(5)
  v_mfma_f32_32x32x16_bf16 v[80:95], v[236:239], v[196:199], v[80:95]
  ds_read_b64_tr_b16 v[250:251], v10 offset:7168
  ds_read_b64_tr_b16 v[252:253], v11 offset:6144
  ds_read_b64_tr_b16 v[254:255], v11 offset:7168
  s_waitcnt vmcnt(11) lgkmcnt(6)
  v_mfma_f32_32x32x16_bf16 v[64:79], v[240:243], v[200:203], v[64:79]
  buffer_load_dwordx4 v[120:123], v3, s[4:7], s30 offen offset:2048
  ds_read_b64_tr_b16 v[224:225], v12 offset:0
  s_waitcnt lgkmcnt(5)
  v_mfma_f32_32x32x16_bf16 v[80:95], v[244:247], v[200:203], v[80:95]
  ds_read_b64_tr_b16 v[226:227], v12 offset:1024
  ds_read_b64_tr_b16 v[228:229], v13 offset:0
  ds_read_b64_tr_b16 v[230:231], v13 offset:1024
  s_waitcnt vmcnt(11) lgkmcnt(6)
  v_mfma_f32_32x32x16_bf16 v[64:79], v[248:251], v[204:207], v[64:79]
  buffer_load_dwordx4 v[124:127], v3, s[4:7], s30 offen offset:3072
  ds_read_b64_tr_b16 v[232:233], v12 offset:2048
  s_waitcnt lgkmcnt(5)
  v_mfma_f32_32x32x16_bf16 v[80:95], v[252:255], v[204:207], v[80:95]
  ds_read_b64_tr_b16 v[234:235], v12 offset:3072
  ds_read_b64_tr_b16 v[236:237], v13 offset:2048
  ds_read_b64_tr_b16 v[238:239], v13 offset:3072
  s_andn2_b32 s33, s36, s34
  s_cbranch_scc0 .fz_kernel_pk54c
.fz_kernel_pk54:
  s_ff1_i32_b32 s33, s33
  s_bitset1_b32 s34, s33
  s_lshl_b32 s22, s33, 13
  s_lshl_b32 s33, s33, 12
  s_add_u32 s30, s33, s35
  s_waitcnt vmcnt(11) lgkmcnt(6)
  v_mfma_f32_32x32x16_bf16 v[64:79], v[224:227], v[208:211], v[64:79]
  v_add_u32 v10, s20, v14
  v_add_u32 v11, s20, v15
  buffer_load_dwordx4 v[128:131], v3, s[4:7], s30 offen offset:0
  ds_read_b64_tr_b16 v[240:241], v12 offset:4096
  s_waitcnt lgkmcnt(5)
  v_mfma_f32_32x32x16_bf16 v[80:95], v[228:231], v[208:211], v[80:95]
  ds_read_b64_tr_b16 v[242:243], v12 offset:5120
  ds_read_b64_tr_b16 v[244:245], v13 offset:4096
  ds_read_b64_tr_b16 v[246:247], v13 offset:5120
  s_waitcnt vmcnt(11) lgkmcnt(6)
  v_mfma_f32_32x32x16_bf16 v[64:79], v[232:235], v[212:215], v[64:79]
  buffer_load_dwordx4 v[132:135], v3, s[4:7], s30 offen offset:1024
  ds_read_b64_tr_b16 v[248:249], v12 offset:6144
  s_waitcnt lgkmcnt(5)
  v_mfma_f32_32x32x16_bf16 v[80:95], v[236:239], v[212:215], v[80:95]
  ds_read_b64_tr_b16 v[250:251], v12 offset:7168
  ds_read_b64_tr_b16 v[252:253], v13 offset:6144
  ds_read_b64_tr_b16 v[254:255], v13 offset:7168
  s_waitcnt vmcnt(11) lgkmcnt(6)
  v_mfma_f32_32x32x16_bf16 v[64:79], v[240:243], v[216:219], v[64:79]
  buffer_load_dwordx4 v[136:139], v3, s[4:7], s30 offen offset:2048
  ds_read_b64_tr_b16 v[224:225], v10 offset:0
  s_waitcnt lgkmcnt(5)
  v_mfma_f32_32x32x16_bf16 v[80:95], v[244:247], v[216:219], v[80:95]
  ds_read_b64_tr_b16 v[226:227], v10 offset:1024
  ds_read_b64_tr_b16 v[228:229], v11 offset:0
  ds_read_b64_tr_b16 v[230:231], v11 offset:1024
  s_waitcnt vmcnt(11) lgkmcnt(6)
  v_mfma_f32_32x32x16_bf16 v[64:79], v[248:251], v[220:223], v[64:79]
  buffer_load_dwordx4 v[140:143], v3, s[4:7], s30 offen offset:3072
  ds_read_b64_tr_b16 v[232:233], v10 offset:2048
  s_waitcnt lgkmcnt(5)
  v_mfma_f32_32x32x16_bf16 v[80:95], v[252:255], v[220:223], v[80:95]
  ds_read_b64_tr_b16 v[234:235], v10 offset:3072
  ds_read_b64_tr_b16 v[236:237], v11 offset:2048
  ds_read_b64_tr_b16 v[238:239], v11 offset:3072
  s_andn2_b32 s33, s36, s34
  s_cbranch_scc0 .fz_kernel_pk55c
.fz_kernel_pk55:
  s_ff1_i32_b32 s33, s33
  s_bitset1_b32 s34, s33
  s_lshl_b32 s23, s33, 13
  s_lshl_b32 s33, s33, 12
  s_add_u32 s30, s33, s35
  s_waitcnt vmcnt(11) lgkmcnt(6)
  v_mfma_f32_32x32x16_bf16 v[64:79], v[224:227], v[96:99], v[64:79]
  v_add_u32 v12, s21, v14
  v_add_u32 v13, s21, v15
  buffer_load_dwordx4 v[144:147], v3, s[4:7], s30 offen offset:0
  ds_read_b64_tr_b16 v[240:241], v10 offset:4096
  s_waitcnt lgkmcnt(5)
  v_mfma_f32_32x32x16_bf16 v[80:95], v[228:231], v[96:99], v[80:95]
  ds_read_b64_tr_b16 v[242:243], v10 offset:5120
  ds_read_b64_tr_b16 v[244:245], v11 offset:4096
  ds_read_b64_tr_b16 v[246:247], v11 offset:5120
  s_waitcnt vmcnt(11) lgkmcnt(6)
  v_mfma_f32_32x32x16_bf16 v[64:79], v[232:235], v[100:103], v[64:79]
  buffer_load_dwordx4 v[148:151], v3, s[4:7], s30 offen offset:1024
  ds_read_b64_tr_b16 v[248:249], v10 offset:6144
  s_waitcnt lgkmcnt(5)
  v_mfma_f32_32x32x16_bf16 v[80:95], v[236:239], v[100:103], v[80:95]
  ds_read_b64_tr_b16 v[250:251], v10 offset:7168
  ds_read_b64_tr_b16 v[252:253], v11 offset:6144
  ds_read_b64_tr_b16 v[254:255], v11 offset:7168
  s_waitcnt vmcnt(11) lgkmcnt(6)
  v_mfma_f32_32x32x16_bf16 v[64:79], v[240:243], v[104:107], v[64:79]
  buffer_load_dwordx4 v[152:155], v3, s[4:7], s30 offen offset:2048
  ds_read_b64_tr_b16 v[224:225], v12 offset:0
  s_waitcnt lgkmcnt(5)
  v_mfma_f32_32x32x16_bf16 v[80:95], v[244:247], v[104:107], v[80:95]
  ds_read_b64_tr_b16 v[226:227], v12 offset:1024
  ds_read_b64_tr_b16 v[228:229], v13 offset:0
  ds_read_b64_tr_b16 v[230:231], v13 offset:1024
  s_waitcnt vmcnt(11) lgkmcnt(6)
  v_mfma_f32_32x32x16_bf16 v[64:79], v[248:251], v[108:111], v[64:79]
  buffer_load_dwordx4 v[156:159], v3, s[4:7], s30 offen offset:3072
  ds_read_b64_tr_b16 v[232:233], v12 offset:2048
  s_waitcnt lgkmcnt(5)
  v_mfma_f32_32x32x16_bf16 v[80:95], v[252:255], v[108:111], v[80:95]
  ds_read_b64_tr_b16 v[234:235], v12 offset:3072
  ds_read_b64_tr_b16 v[236:237], v13 offset:2048
  ds_read_b64_tr_b16 v[238:239], v13 offset:3072
  s_andn2_b32 s33, s36, s34
  s_cbranch_scc0 .fz_kernel_pk56c
.fz_kernel_pk56:
  s_ff1_i32_b32 s33, s33
  s_bitset1_b32 s34, s33
  s_lshl_b32 s24, s33, 13
  s_lshl_b32 s33, s33, 12
  s_add_u32 s30, s33, s35
  s_waitcnt vmcnt(11) lgkmcnt(6)
  v_mfma_f32_32x32x16_bf16 v[64:79], v[224:227], v[112:115], v[64:79]
  v_add_u32 v10, s22, v14
  v_add_u32 v11, s22, v15
  buffer_load_dwordx4 v[160:163], v3, s[4:7], s30 offen offset:0
  ds_read_b64_tr_b16 v[240:241], v12 offset:4096
  s_waitcnt lgkmcnt(5)
  v_mfma_f32_32x32x16_bf16 v[80:95], v[228:231], v[112:115], v[80:95]
  ds_read_b64_tr_b16 v[242:243], v12 offset:5120
  ds_read_b64_tr_b16 v[244:245], v13 offset:4096
  ds_read_b64_tr_b16 v[246:247], v13 offset:5120
  s_waitcnt vmcnt(11) lgkmcnt(6)
  v_mfma_f32_32x32x16_bf16 v[64:79], v[232:235], v[116:119], v[64:79]
  buffer_load_dwordx4 v[164:167], v3, s[4:7], s30 offen offset:1024
  ds_read_b64_tr_b16 v[248:249], v12 offset:6144
  s_waitcnt lgkmcnt(5)
  v_mfma_f32_32x32x16_bf16 v[80:95], v[236:239], v[116:119], v[80:95]
  ds_read_b64_tr_b16 v[250:251], v12 offset:7168
  ds_read_b64_tr_b16 v[252:253], v13 offset:6144
  ds_read_b64_tr_b16 v[254:255], v13 offset:7168
  s_waitcnt vmcnt(11) lgkmcnt(6)
  v_mfma_f32_32x32x16_bf16 v[64:79], v[240:243], v[120:123], v[64:79]
  buffer_load_dwordx4 v[168:171], v3, s[4:7], s30 offen offset:2048
  ds_read_b64_tr_b16 v[224:225], v10 offset:0
  s_waitcnt lgkmcnt(5)
  v_mfma_f32_32x32x16_bf16 v[80:95], v[244:247], v[120:123], v[80:95]
  ds_read_b64_tr_b16 v[226:227], v10 offset:1024
  ds_read_b64_tr_b16 v[228:229], v11 offset:0
  ds_read_b64_tr_b16 v[230:231], v11 offset:1024
  s_waitcnt vmcnt(11) lgkmcnt(6)
  v_mfma_f32_32x32x16_bf16 v[64:79], v[248:251], v[124:127], v[64:79]
  buffer_load_dwordx4 v[172:175], v3, s[4:7], s30 offen offset:3072
  ds_read_b64_tr_b16 v[232:233], v10 offset:2048
  s_waitcnt lgkmcnt(5)
  v_mfma_f32_32x32x16_bf16 v[80:95], v[252:255], v[124:127], v[80:95]
  ds_read_b64_tr_b16 v[234:235], v10 offset:3072
  ds_read_b64_tr_b16 v[236:237], v11 offset:2048
  ds_read_b64_tr_b16 v[238:239], v11 offset:3072
  s_andn2_b32 s33, s36, s34
  s_cbranch_scc0 .fz_kernel_pk57c
.fz_kernel_pk57:
  s_ff1_i32_b32 s33, s33
  s_bitset1_b32 s34, s33
  s_lshl_b32 s25, s33, 13
  s_lshl_b32 s33, s33, 12
  s_add_u32 s30, s33, s35
  s_waitcnt vmcnt(11) lgkmcnt(6)
  v_mfma_f32_32x32x16_bf16 v[64:79], v[224:227], v[128:131], v[64:79]
  v_add_u32 v12, s23, v14
  v_add_u32 v13, s23, v15
  buffer_load_dwordx4 v[176:179], v3, s[4:7], s30 offen offset:0
  ds_read_b64_tr_b16 v[240:241], v10 offset:4096
  s_waitcnt lgkmcnt(5)
  v_mfma_f32_32x32x16_bf16 v[80:95], v[228:231], v[128:131], v[80:95]
  ds_read_b64_tr_b16 v[242:243], v10 offset:5120
  ds_read_b64_tr_b16 v[244:245], v11 offset:4096
  ds_read_b64_tr_b16 v[246:247], v11 offset:5120
  s_waitcnt vmcnt(11) lgkmcnt(6)
  v_mfma_f32_32x32x16_bf16 v[64:79], v[232:235], v[132:135], v[64:79]
  buffer_load_dwordx4 v[180:183], v3, s[4:7], s30 offen offset:1024
  ds_read_b64_tr_b16 v[248:249], v10 offset:6144
  s_waitcnt lgkmcnt(5)
  v_mfma_f32_32x32x16_bf16 v[80:95], v[236:239], v[132:135], v[80:95]
  ds_read_b64_tr_b16 v[250:251], v10 offset:7168
  ds_read_b64_tr_b16 v[252:253], v11 offset:6144
  ds_read_b64_tr_b16 v[254:255], v11 offset:7168
  s_waitcnt vmcnt(11) lgkmcnt(6)
  v_mfma_f32_32x32x16_bf16 v[64:79], v[240:243], v[136:139], v[64:79]
  buffer_load_dwordx4 v[184:187], v3, s[4:7], s30 offen offset:2048
  ds_read_b64_tr_b16 v[224:225], v12 offset:0
  s_waitcnt lgkmcnt(5)
  v_mfma_f32_32x32x16_bf16 v[80:95], v[244:247], v[136:139], v[80:95]
  ds_read_b64_tr_b16 v[226:227], v12 offset:1024
  ds_read_b64_tr_b16 v[228:229], v13 offset:0
  ds_read_b64_tr_b16 v[230:231], v13 offset:1024
  s_waitcnt vmcnt(11) lgkmcnt(6)
  v_mfma_f32_32x32x16_bf16 v[64:79], v[248:251], v[140:143], v[64:79]
  buffer_load_dwordx4 v[188:191], v3, s[4:7], s30 offen offset:3072
  ds_read_b64_tr_b16 v[232:233], v12 offset:2048
  s_waitcnt lgkmcnt(5)
  v_mfma_f32_32x32x16_bf16 v[80:95], v[252:255], v[140:143], v[80:95]
  ds_read_b64_tr_b16 v[234:235], v12 offset:3072
  ds_read_b64_tr_b16 v[236:237], v13 offset:2048
  ds_read_b64_tr_b16 v[238:239], v13 offset:3072
  s_andn2_b32 s33, s36, s34
  s_cbranch_scc0 .fz_kernel_pk58c
.fz_kernel_pk58:
  s_ff1_i32_b32 s33, s33
  s_bitset1_b32 s34, s33
  s_lshl_b32 s26, s33, 13
  s_lshl_b32 s33, s33, 12
  s_add_u32 s30, s33, s35
  s_waitcnt vmcnt(11) lgkmcnt(6)
  v_mfma_f32_32x32x16_bf16 v[64:79], v[224:227], v[144:147], v[64:79]
  v_add_u32 v10, s24, v14
  v_add_u32 v11, s24, v15
  buffer_load_dwordx4 v[192:195], v3, s[4:7], s30 offen offset:0
  ds_read_b64_tr_b16 v[240:241], v12 offset:4096
  s_waitcnt lgkmcnt(5)
  v_mfma_f32_32x32x16_bf16 v[80:95], v[228:231], v[144:147], v[80:95]
  ds_read_b64_tr_b16 v[242:243], v12 offset:5120
  ds_read_b64_tr_b16 v[244:245], v13 offset:4096
  ds_read_b64_tr_b16 v[246:247], v13 offset:5120
  s_waitcnt vmcnt(11) lgkmcnt(6)
  v_mfma_f32_32x32x16_bf16 v[64:79], v[232:235], v[148:151], v[64:79]
  buffer_load_dwordx4 v[196:199], v3, s[4:7], s30 offen offset:1024
  ds_read_b64_tr_b16 v[248:249], v12 offset:6144
  s_waitcnt lgkmcnt(5)
  v_mfma_f32_32x32x16_bf16 v[80:95], v[236:239], v[148:151], v[80:95]
  ds_read_b64_tr_b16 v[250:251], v12 offset:7168
  ds_read_b64_tr_b16 v[252:253], v13 offset:6144
  ds_read_b64_tr_b16 v[254:255], v13 offset:7168
  s_waitcnt vmcnt(11) lgkmcnt(6)
  v_mfma_f32_32x32x16_bf16 v[64:79], v[240:243], v[152:155], v[64:79]
  buffer_load_dwordx4 v[200:203], v3, s[4:7], s30 offen offset:2048
  ds_read_b64_tr_b16 v[224:225], v10 offset:0
  s_waitcnt lgkmcnt(5)
  v_mfma_f32_32x32x16_bf16 v[80:95], v[244:247], v[152:155], v[80:95]
  ds_read_b64_tr_b16 v[226:227], v10 offset:1024
  ds_read_b64_tr_b16 v[228:229], v11 offset:0
  ds_read_b64_tr_b16 v[230:231], v11 offset:1024
  s_waitcnt vmcnt(11) lgkmcnt(6)
  v_mfma_f32_32x32x16_bf16 v[64:79], v[248:251], v[156:159], v[64:79]
  buffer_load_dwordx4 v[204:207], v3, s[4:7], s30 offen offset:3072
  ds_read_b64_tr_b16 v[232:233], v10 offset:2048
  s_waitcnt lgkmcnt(5)
  v_mfma_f32_32x32x16_bf16 v[80:95], v[252:255], v[156:159], v[80:95]
  ds_read_b64_tr_b16 v[234:235], v10 offset:3072
  ds_read_b64_tr_b16 v[236:237], v11 offset:2048
  ds_read_b64_tr_b16 v[238:239], v11 offset:3072
  s_andn2_b32 s33, s36, s34
  s_cbranch_scc0 .fz_kernel_pk59c
.fz_kernel_pk59:
  s_ff1_i32_b32 s33, s33
  s_bitset1_b32 s34, s33
  s_lshl_b32 s27, s33, 13
  s_lshl_b32 s33, s33, 12
  s_add_u32 s30, s33, s35
  s_waitcnt vmcnt(11) lgkmcnt(6)
  v_mfma_f32_32x32x16_bf16 v[64:79], v[224:227], v[160:163], v[64:79]
  v_add_u32 v12, s25, v14
  v_add_u32 v13, s25, v15
  buffer_load_dwordx4 v[208:211], v3, s[4:7], s30 offen offset:0
  ds_read_b64_tr_b16 v[240:241], v10 offset:4096
  s_waitcnt lgkmcnt(5)
  v_mfma_f32_32x32x16_bf16 v[80:95], v[228:231], v[160:163], v[80:95]
  ds_read_b64_tr_b16 v[242:243], v10 offset:5120
  ds_read_b64_tr_b16 v[244:245], v11 offset:4096
  ds_read_b64_tr_b16 v[246:247], v11 offset:5120
  s_waitcnt vmcnt(11) lgkmcnt(6)
  v_mfma_f32_32x32x16_bf16 v[64:79], v[232:235], v[164:167], v[64:79]
  buffer_load_dwordx4 v[212:215], v3, s[4:7], s30 offen offset:1024
  ds_read_b64_tr_b16 v[248:249], v10 offset:6144
  s_waitcnt lgkmcnt(5)
  v_mfma_f32_32x32x16_bf16 v[80:95], v[236:239], v[164:167], v[80:95]
  ds_read_b64_tr_b16 v[250:251], v10 offset:7168
  ds_read_b64_tr_b16 v[252:253], v11 offset:6144
  ds_read_b64_tr_b16 v[254:255], v11 offset:7168
  s_waitcnt vmcnt(11) lgkmcnt(6)
  v_mfma_f32_32x32x16_bf16 v[64:79], v[240:243], v[168:171], v[64:79]
  buffer_load_dwordx4 v[216:219], v3, s[4:7], s30 offen offset:2048
  ds_read_b64_tr_b16 v[224:225], v12 offset:0
  s_waitcnt lgkmcnt(5)
  v_mfma_f32_32x32x16_bf16 v[80:95], v[244:247], v[168:171], v[80:95]
  ds_read_b64_tr_b16 v[226:227], v12 offset:1024
  ds_read_b64_tr_b16 v[228:229], v13 offset:0
  ds_read_b64_tr_b16 v[230:231], v13 offset:1024
  s_waitcnt vmcnt(11) lgkmcnt(6)
  v_mfma_f32_32x32x16_bf16 v[64:79], v[248:251], v[172:175], v[64:79]
  buffer_load_dwordx4 v[220:223], v3, s[4:7], s30 offen offset:3072
  ds_read_b64_tr_b16 v[232:233], v12 offset:2048
  s_waitcnt lgkmcnt(5)
  v_mfma_f32_32x32x16_bf16 v[80:95], v[252:255], v[172:175], v[80:95]
  ds_read_b64_tr_b16 v[234:235], v12 offset:3072
  ds_read_b64_tr_b16 v[236:237], v13 offset:2048
  ds_read_b64_tr_b16 v[238:239], v13 offset:3072
  s_waitcnt vmcnt(11) lgkmcnt(6)
  v_mfma_f32_32x32x16_bf16 v[64:79], v[224:227], v[176:179], v[64:79]
  v_add_u32 v10, s26, v14
  v_add_u32 v11, s26, v15
  ds_read_b64_tr_b16 v[240:241], v12 offset:4096
  s_waitcnt lgkmcnt(5)
  v_mfma_f32_32x32x16_bf16 v[80:95], v[228:231], v[176:179], v[80:95]
  ds_read_b64_tr_b16 v[242:243], v12 offset:5120
  ds_read_b64_tr_b16 v[244:245], v13 offset:4096
  ds_read_b64_tr_b16 v[246:247], v13 offset:5120
  s_waitcnt vmcnt(10) lgkmcnt(6)
  v_mfma_f32_32x32x16_bf16 v[64:79], v[232:235], v[180:183], v[64:79]
  ds_read_b64_tr_b16 v[248:249], v12 offset:6144
  s_waitcnt lgkmcnt(5)
  v_mfma_f32_32x32x16_bf16 v[80:95], v[236:239], v[180:183], v[80:95]
  ds_read_b64_tr_b16 v[250:251], v12 offset:7168
  ds_read_b64_tr_b16 v[252:253], v13 offset:6144
  ds_read_b64_tr_b16 v[254:255], v13 offset:7168
  s_waitcnt vmcnt(9) lgkmcnt(6)
  v_mfma_f32_32x32x16_bf16 v[64:79], v[240:243], v[184:187], v[64:79]
  ds_read_b64_tr_b16 v[224:225], v10 offset:0
  s_waitcnt lgkmcnt(5)
  v_mfma_f32_32x32x16_bf16 v[80:95], v[244:247], v[184:187], v[80:95]
  ds_read_b64_tr_b16 v[226:227], v10 offset:1024
  ds_read_b64_tr_b16 v[228:229], v11 offset:0
  ds_read_b64_tr_b16 v[230:231], v11 offset:1024
  s_waitcnt vmcnt(8) lgkmcnt(6)
  v_mfma_f32_32x32x16_bf16 v[64:79], v[248:251], v[188:191], v[64:79]
  ds_read_b64_tr_b16 v[232:233], v10 offset:2048
  s_waitcnt lgkmcnt(5)
  v_mfma_f32_32x32x16_bf16 v[80:95], v[252:255], v[188:191], v[80:95]
  ds_read_b64_tr_b16 v[234:235], v10 offset:3072
  ds_read_b64_tr_b16 v[236:237], v11 offset:2048
  ds_read_b64_tr_b16 v[238:239], v11 offset:3072
  s_waitcnt vmcnt(7) lgkmcnt(6)
  v_mfma_f32_32x32x16_bf16 v[64:79], v[224:227], v[192:195], v[64:79]
  v_add_u32 v12, s27, v14
  v_add_u32 v13, s27, v15
  ds_read_b64_tr_b16 v[240:241], v10 offset:4096
  s_waitcnt lgkmcnt(5)
  v_mfma_f32_32x32x16_bf16 v[80:95], v[228:231], v[192:195], v[80:95]
  ds_read_b64_tr_b16 v[242:243], v10 offset:5120
  ds_read_b64_tr_b16 v[244:245], v11 offset:4096
  ds_read_b64_tr_b16 v[246:247], v11 offset:5120
  s_waitcnt vmcnt(6) lgkmcnt(6)
  v_mfma_f32_32x32x16_bf16 v[64:79], v[232:235], v[196:199], v[64:79]
  ds_read_b64_tr_b16 v[248:249], v10 offset:6144
  s_waitcnt lgkmcnt(5)
  v_mfma_f32_32x32x16_bf16 v[80:95], v[236:239], v[196:199], v[80:95]
  ds_read_b64_tr_b16 v[250:251], v10 offset:7168
  ds_read_b64_tr_b16 v[252:253], v11 offset:6144
  ds_read_b64_tr_b16 v[254:255], v11 offset:7168
  s_waitcnt vmcnt(5) lgkmcnt(6)
  v_mfma_f32_32x32x16_bf16 v[64:79], v[240:243], v[200:203], v[64:79]
  ds_read_b64_tr_b16 v[224:225], v12 offset:0
  s_waitcnt lgkmcnt(5)
  v_mfma_f32_32x32x16_bf16 v[80:95], v[244:247], v[200:203], v[80:95]
  ds_read_b64_tr_b16 v[226:227], v12 offset:1024
  ds_read_b64_tr_b16 v[228:229], v13 offset:0
  ds_read_b64_tr_b16 v[230:231], v13 offset:1024
  s_waitcnt vmcnt(4) lgkmcnt(6)
  v_mfma_f32_32x32x16_bf16 v[64:79], v[248:251], v[204:207], v[64:79]
  ds_read_b64_tr_b16 v[232:233], v12 offset:2048
  s_waitcnt lgkmcnt(5)
  v_mfma_f32_32x32x16_bf16 v[80:95], v[252:255], v[204:207], v[80:95]
  ds_read_b64_tr_b16 v[234:235], v12 offset:3072
  ds_read_b64_tr_b16 v[236:237], v13 offset:2048
  ds_read_b64_tr_b16 v[238:239], v13 offset:3072
  s_waitcnt vmcnt(3) lgkmcnt(6)
  v_mfma_f32_32x32x16_bf16 v[64:79], v[224:227], v[208:211], v[64:79]
  ds_read_b64_tr_b16 v[240:241], v12 offset:4096
  s_waitcnt lgkmcnt(5)
  v_mfma_f32_32x32x16_bf16 v[80:95], v[228:231], v[208:211], v[80:95]
  ds_read_b64_tr_b16 v[242:243], v12 offset:5120
  ds_read_b64_tr_b16 v[244:245], v13 offset:4096
  ds_read_b64_tr_b16 v[246:247], v13 offset:5120
  s_waitcnt vmcnt(2) lgkmcnt(6)
  v_mfma_f32_32x32x16_bf16 v[64:79], v[232:235], v[212:215], v[64:79]
  ds_read_b64_tr_b16 v[248:249], v12 offset:6144
  s_waitcnt lgkmcnt(5)
  v_mfma_f32_32x32x16_bf16 v[80:95], v[236:239], v[212:215], v[80:95]
  ds_read_b64_tr_b16 v[250:251], v12 offset:7168
  ds_read_b64_tr_b16 v[252:253], v13 offset:6144
  ds_read_b64_tr_b16 v[254:255], v13 offset:7168
  s_waitcnt vmcnt(1) lgkmcnt(6)
  v_mfma_f32_32x32x16_bf16 v[64:79], v[240:243], v[216:219], v[64:79]
  s_waitcnt lgkmcnt(4)
  v_mfma_f32_32x32x16_bf16 v[80:95], v[244:247], v[216:219], v[80:95]
  s_waitcnt vmcnt(0) lgkmcnt(0)
  v_mfma_f32_32x32x16_bf16 v[64:79], v[248:251], v[220:223], v[64:79]
  v_mfma_f32_32x32x16_bf16 v[80:95], v[252:255], v[220:223], v[80:95]
  s_mov_b32 s36, 0x3f803f80
  v_mov_b32 v8, 0
  v_mov_b32 v9, 0
  v_mov_b32 v10, 0
  v_mov_b32 v11, 0
  v_mov_b32 v12, 0
  v_mov_b32 v13, 0
  v_lshlrev_b32 v19, 2, v18
  v_lshl_add_u32 v19, v17, 13, v19
  s_lshl_b32 s34, s32, 7
  s_add_u32 s34, s34, s66
  s_add_u32 s34, s34, 16384
  s_add_u32 s37, s34, 16384
  v_cvt_pk_bf16_f32 v20, v64, v65
  v_cvt_pk_bf16_f32 v21, v66, v67
  v_cvt_pk_bf16_f32 v22, v68, v69
  v_cvt_pk_bf16_f32 v23, v70, v71
  buffer_store_dwordx4 v[20:23], v16, s[4:7], s39 offen offset:0 sc1
  v_cvt_pk_bf16_f32 v24, v72, v73
  v_cvt_pk_bf16_f32 v25, v74, v75
  v_cvt_pk_bf16_f32 v26, v76, v77
  v_cvt_pk_bf16_f32 v27, v78, v79
  buffer_store_dwordx4 v[24:27], v16, s[4:7], s39 offen offset:512 sc1
  v_cvt_pk_bf16_f32 v28, v80, v81
  v_cvt_pk_bf16_f32 v29, v82, v83
  v_cvt_pk_bf16_f32 v30, v84, v85
  v_cvt_pk_bf16_f32 v31, v86, v87
  buffer_store_dwordx4 v[28:31], v16, s[4:7], s39 offen offset:1024 sc1
  v_cvt_pk_bf16_f32 v32, v88, v89
  v_cvt_pk_bf16_f32 v33, v90, v91
  v_cvt_pk_bf16_f32 v34, v92, v93
  v_cvt_pk_bf16_f32 v35, v94, v95
  buffer_store_dwordx4 v[32:35], v16, s[4:7], s39 offen offset:1536 sc1
  v_dot2c_f32_bf16 v8, s36, v20
  v_dot2c_f32_bf16 v9, v20, v20
  v_dot2c_f32_bf16 v10, v20, v48
  v_dot2c_f32_bf16 v11, s36, v21
  v_dot2c_f32_bf16 v12, v21, v21
  v_dot2c_f32_bf16 v13, v21, v49
  v_dot2c_f32_bf16 v8, s36, v22
  v_dot2c_f32_bf16 v9, v22, v22
  v_dot2c_f32_bf16 v10, v22, v50
  v_dot2c_f32_bf16 v11, s36, v23
  v_dot2c_f32_bf16 v12, v23, v23
  v_dot2c_f32_bf16 v13, v23, v51
  v_dot2c_f32_bf16 v8, s36, v24
  v_dot2c_f32_bf16 v9, v24, v24
  v_dot2c_f32_bf16 v10, v24, v52
  v_dot2c_f32_bf16 v11, s36, v25
  v_dot2c_f32_bf16 v12, v25, v25
  v_dot2c_f32_bf16 v13, v25, v53
  v_dot2c_f32_bf16 v8, s36, v26
  v_dot2c_f32_bf16 v9, v26, v26
  v_dot2c_f32_bf16 v10, v26, v54
  v_dot2c_f32_bf16 v11, s36, v27
  v_dot2c_f32_bf16 v12, v27, v27
  v_dot2c_f32_bf16 v13, v27, v55
  v_dot2c_f32_bf16 v8, s36, v28
  v_dot2c_f32_bf16 v9, v28, v28
  v_dot2c_f32_bf16 v10, v28, v56
  v_dot2c_f32_bf16 v11, s36, v29
  v_dot2c_f32_bf16 v12, v29, v29
  v_dot2c_f32_bf16 v13, v29, v57
  v_dot2c_f32_bf16 v8, s36, v30
  v_dot2c_f32_bf16 v9, v30, v30
  v_dot2c_f32_bf16 v10, v30, v58
  v_dot2c_f32_bf16 v11, s36, v31
  v_dot2c_f32_bf16 v12, v31, v31
  v_dot2c_f32_bf16 v13, v31, v59
  v_dot2c_f32_bf16 v8, s36, v32
  v_dot2c_f32_bf16 v9, v32, v32
  v_dot2c_f32_bf16 v10, v32, v60
  v_dot2c_f32_bf16 v11, s36, v33
  v_dot2c_f32_bf16 v12, v33, v33
  v_dot2c_f32_bf16 v13, v33, v61
  v_dot2c_f32_bf16 v8, s36, v34
  v_dot2c_f32_bf16 v9, v34, v34
  v_dot2c_f32_bf16 v10, v34, v62
  v_dot2c_f32_bf16 v11, s36, v35
  v_dot2c_f32_bf16 v12, v35, v35
  v_dot2c_f32_bf16 v13, v35, v63
  s_nop 0
  v_add_f32 v36, v8, v11
  v_add_f32 v37, v9, v12
  v_add_f32 v38, v10, v13
  v_fma_f32 v38, -v36, v46, v38
  v_fmac_f32 v47, 0x44800000, v37
  v_mov_b32 v39, v38
  s_nop 0
  v_permlane32_swap_b32 v36, v47
  v_permlane32_swap_b32 v38, v39
  v_add_f32 v36, v36, v47
  v_add_f32 v38, v38, v39
  buffer_atomic_add_f32 v36, v19, s[4:7], s34 offen sc1
  s_mov_b32 exec_hi, 0
  buffer_atomic_add_f32 v38, v19, s[4:7], s37 offen sc1
  s_mov_b64 exec, -1
  s_barrier
  v_add_u32 v1, 4, v6
  s_mov_b32 s72, s66
  s_mov_b32 s73, s65
  s_mov_b32 s74, s67
  s_mov_b32 s75, s62
  s_cmp_lg_u32 s62, 0
  s_cbranch_scc1 .fz_kernel_tail
  s_mov_b32 s62, 1
  s_mov_b32 s63, 0x2000000
  s_mov_b32 s64, 0x2800000
  s_mov_b32 s65, 0x1400000
  s_mov_b32 s66, 0x1c42000
  s_mov_b32 s67, 12
  s_mov_b32 s71, 159776
  v_mov_b32 v6, 159832
  s_branch .fz_kernel_q_cons2
.fz_kernel_tail:
  s_mov_b32 s28, s56
  s_mov_b32 s29, s57
  s_mov_b32 s30, 0x400000
  s_mov_b32 s31, 0x00020000
  v_lshlrev_b32 v37, 2, v45
  v_add_u32 v37, 155644, v37
  v_mov_b32 v36, 159952
  v_lshlrev_b32 v38, 11, v18
  v_lshl_add_u32 v38, v17, 4, v38
  s_lshl_b32 s32, s32, 16
  s_lshl_b32 s33, s18, 7
  s_add_u32 s32, s32, s33
  v_lshlrev_b32 v64, 16, v20
  v_and_b32 v65, 0xffff0000, v20
  v_lshlrev_b32 v66, 16, v21
  v_and_b32 v67, 0xffff0000, v21
  v_lshlrev_b32 v68, 16, v22
  v_and_b32 v69, 0xffff0000, v22
  v_lshlrev_b32 v70, 16, v23
  v_and_b32 v71, 0xffff0000, v23
  v_lshlrev_b32 v72, 16, v24
  v_and_b32 v73, 0xffff0000, v24
  v_lshlrev_b32 v74, 16, v25
  v_and_b32 v75, 0xffff0000, v25
  v_lshlrev_b32 v76, 16, v26
  v_and_b32 v77, 0xffff0000, v26
  v_lshlrev_b32 v78, 16, v27
  v_and_b32 v79, 0xffff0000, v27
  v_lshlrev_b32 v80, 16, v28
  v_and_b32 v81, 0xffff0000, v28
  v_lshlrev_b32 v82, 16, v29
  v_and_b32 v83, 0xffff0000, v29
  v_lshlrev_b32 v84, 16, v30
  v_and_b32 v85, 0xffff0000, v30
  v_lshlrev_b32 v86, 16, v31
  v_and_b32 v87, 0xffff0000, v31
  v_lshlrev_b32 v88, 16, v32
  v_and_b32 v89, 0xffff0000, v32
  v_lshlrev_b32 v90, 16, v33
  v_and_b32 v91, 0xffff0000, v33
  v_lshlrev_b32 v92, 16, v34
  v_and_b32 v93, 0xffff0000, v34
  v_lshlrev_b32 v94, 16, v35
  v_and_b32 v95, 0xffff0000, v35
  s_mov_b64 exec, 1
  s_waitcnt vmcnt(0)
  ds_add_u32 v1, v5 offset:0x100
  s_mov_b64 exec, -1
  s_barrier
  ds_read_b32 v40, v37 offset:6400
  ds_read_b32 v42, v37 offset:6912
  ds_read_b32 v36, v36
  s_waitcnt lgkmcnt(0)
  v_cmp_ne_u32 vcc, v36, v45
  s_mov_b64 exec, vcc
  v_pk_fma_f32 v[64:65], v[64:65], v[40:41], v[42:43] op_sel_hi:[1,0,0]
  v_pk_fma_f32 v[66:67], v[66:67], v[40:41], v[42:43] op_sel_hi:[1,0,0]
  v_pk_fma_f32 v[68:69], v[68:69], v[40:41], v[42:43] op_sel_hi:[1,0,0]
  v_pk_fma_f32 v[70:71], v[70:71], v[40:41], v[42:43] op_sel_hi:[1,0,0]
  v_cvt_pk_bf16_f32 v20, v64, v65
  v_cvt_pk_bf16_f32 v21, v66, v67
  v_cvt_pk_bf16_f32 v22, v68, v69
  v_cvt_pk_bf16_f32 v23, v70, v71
  buffer_store_dwordx4 v[20:23], v38, s[28:31], s32 offen offset:0
  v_pk_fma_f32 v[72:73], v[72:73], v[40:41], v[42:43] op_sel_hi:[1,0,0]
  v_pk_fma_f32 v[74:75], v[74:75], v[40:41], v[42:43] op_sel_hi:[1,0,0]
  v_pk_fma_f32 v[76:77], v[76:77], v[40:41], v[42:43] op_sel_hi:[1,0,0]
  v_pk_fma_f32 v[78:79], v[78:79], v[40:41], v[42:43] op_sel_hi:[1,0,0]
  v_cvt_pk_bf16_f32 v24, v72, v73
  v_cvt_pk_bf16_f32 v25, v74, v75
  v_cvt_pk_bf16_f32 v26, v76, v77
  v_cvt_pk_bf16_f32 v27, v78, v79
  buffer_store_dwordx4 v[24:27], v38, s[28:31], s32 offen offset:32
  v_pk_fma_f32 v[80:81], v[80:81], v[40:41], v[42:43] op_sel_hi:[1,0,0]
  v_pk_fma_f32 v[82:83], v[82:83], v[40:41], v[42:43] op_sel_hi:[1,0,0]
  v_pk_fma_f32 v[84:85], v[84:85], v[40:41], v[42:43] op_sel_hi:[1,0,0]
  v_pk_fma_f32 v[86:87], v[86:87], v[40:41], v[42:43] op_sel_hi:[1,0,0]
  v_cvt_pk_bf16_f32 v28, v80, v81
  v_cvt_pk_bf16_f32 v29, v82, v83
  v_cvt_pk_bf16_f32 v30, v84, v85
  v_cvt_pk_bf16_f32 v31, v86, v87
  buffer_store_dwordx4 v[28:31], v38, s[28:31], s32 offen offset:64
  v_pk_fma_f32 v[88:89], v[88:89], v[40:41], v[42:43] op_sel_hi:[1,0,0]
  v_pk_fma_f32 v[90:91], v[90:91], v[40:41], v[42:43] op_sel_hi:[1,0,0]
  v_pk_fma_f32 v[92:93], v[92:93], v[40:41], v[42:43] op_sel_hi:[1,0,0]
  v_pk_fma_f32 v[94:95], v[94:95], v[40:41], v[42:43] op_sel_hi:[1,0,0]
  v_cvt_pk_bf16_f32 v32, v88, v89
  v_cvt_pk_bf16_f32 v33, v90, v91
  v_cvt_pk_bf16_f32 v34, v92, v93
  v_cvt_pk_bf16_f32 v35, v94, v95
  buffer_store_dwordx4 v[32:35], v38, s[28:31], s32 offen offset:96
  s_mov_b64 exec, -1
  s_branch .fz_kernel_fin
.fz_kernel_chain:
  s_setprio 0
  s_bitcmp1_b32 s18, 0
  s_cselect_b32 s8, s52, s50
  s_cselect_b32 s9, s53, s51
  s_mov_b32 s10, 0x700000
  s_mov_b32 s11, 0x00020000
  s_lshl_b32 s12, s16, 8
  s_and_b32 s12, s12, 511
  s_and_b32 s31, s18, 2
  s_lshl_b32 s31, s31, 8
  s_add_u32 s12, s12, s31
  s_mul_i32 s12, s12, 7168
  s_lshl_b32 s31, s17, 2
  s_lshr_b32 s33, s18, 2
  s_add_u32 s31, s31, s33
  s_lshl_b32 s31, s31, 7
  s_add_u32 s12, s12, s31
  v_lshrrev_b32 v13, 3, v2
  v_mul_u32_u24 v13, 229376, v13
  v_and_b32 v11, 7, v2
  v_lshl_add_u32 v13, v11, 4, v13
  s_mov_b32 s24, s44
  s_mov_b32 s25, s45
  s_mov_b32 s26, 0x200000
  s_mov_b32 s27, 0x00020000
  v_lshrrev_b32 v8, 3, v2
  v_and_b32 v9, 7, v2
  v_bfe_u32 v10, v2, 4, 1
  v_lshlrev_b32 v10, 2, v10
  v_xor_b32 v9, v9, v10
  v_lshlrev_b32 v9, 4, v9
  v_lshl_add_u32 v10, v8, 11, v9
  s_mov_b32 s24, s54
  s_mov_b32 s25, s55
  s_mov_b32 s26, 0x700000
  s_mov_b32 s27, 0x00020000
  s_mov_b32 s36, 0x05040100
  s_mov_b32 s37, 0x07060302
  s_and_b32 s20, s16, 1
  s_lshl1_add_u32 s13, s17, s20
  s_lshl_b32 s13, s13, 18
  s_lshl_b32 s14, s18, 7
  s_add_u32 s13, s13, s14
  s_cmp_ge_u32 s17, 14
  s_cbranch_scc1 .fz_kernel_c_nl
  s_mov_b32 s38, 0
.fz_kernel_kw60:
  s_sleep 2
  ds_read_b32 v7, v6 offset:0
  s_add_u32 s38, s38, 1
  s_waitcnt lgkmcnt(0)
  v_readfirstlane_b32 s31, v7
  s_bcnt1_i32_b32 s31, s31
  s_cmp_ge_u32 s31, 16
  s_cbranch_scc1 .fz_kernel_kw60d
  s_cmp_lt_u32 s38, 1048576
  s_cbranch_scc1 .fz_kernel_kw60
.fz_kernel_kw60d:
  buffer_load_dwordx4 v[112:115], v13, s[8:11], s12 offen nt
  s_add_u32 s12, s12, 7168
  s_waitcnt vmcnt(2)
  buffer_load_dwordx4 v[116:119], v13, s[8:11], s12 offen nt
  s_add_u32 s12, s12, 7168
  s_waitcnt vmcnt(2)
  buffer_load_dwordx4 v[120:123], v13, s[8:11], s12 offen nt
  s_add_u32 s12, s12, 7168
  s_waitcnt vmcnt(2)
  buffer_load_dwordx4 v[124:127], v13, s[8:11], s12 offen nt
  s_add_u32 s12, s12, 7168
  s_waitcnt vmcnt(2)
  buffer_load_dwordx4 v[128:131], v13, s[8:11], s12 offen nt
  s_add_u32 s12, s12, 7168
  s_waitcnt vmcnt(2)
  buffer_load_dwordx4 v[132:135], v13, s[8:11], s12 offen nt
  s_add_u32 s12, s12, 7168
  s_waitcnt vmcnt(2)
  buffer_load_dwordx4 v[136:139], v13, s[8:11], s12 offen nt
  s_add_u32 s12, s12, 7168
  s_waitcnt vmcnt(2)
  buffer_load_dwordx4 v[140:143], v13, s[8:11], s12 offen nt
  s_add_u32 s12, s12, 7168
  s_waitcnt vmcnt(2)
  buffer_load_dwordx4 v[144:147], v13, s[8:11], s12 offen nt
  s_add_u32 s12, s12, 7168
  s_waitcnt vmcnt(2)
  buffer_load_dwordx4 v[148:151], v13, s[8:11], s12 offen nt
  s_add_u32 s12, s12, 7168
  s_waitcnt vmcnt(2)
  buffer_load_dwordx4 v[152:155], v13, s[8:11], s12 offen nt
  s_add_u32 s12, s12, 7168
  s_waitcnt vmcnt(2)
  buffer_load_dwordx4 v[156:159], v13, s[8:11], s12 offen nt
  s_add_u32 s12, s12, 7168
  s_waitcnt vmcnt(2)
  buffer_load_dwordx4 v[160:163], v13, s[8:11], s12 offen nt
  s_add_u32 s12, s12, 7168
  s_waitcnt vmcnt(2)
  buffer_load_dwordx4 v[164:167], v13, s[8:11], s12 offen nt
  s_add_u32 s12, s12, 7168
  s_waitcnt vmcnt(2)
  buffer_load_dwordx4 v[168:171], v13, s[8:11], s12 offen nt
  s_add_u32 s12, s12, 7168
  s_waitcnt vmcnt(2)
  buffer_load_dwordx4 v[172:175], v13, s[8:11], s12 offen nt
  s_add_u32 s12, s12, 7168
  s_waitcnt vmcnt(2)
  buffer_load_dwordx4 v[176:179], v13, s[8:11], s12 offen nt
  s_add_u32 s12, s12, 7168
  s_waitcnt vmcnt(2)
  buffer_load_dwordx4 v[180:183], v13, s[8:11], s12 offen nt
  s_add_u32 s12, s12, 7168
  s_waitcnt vmcnt(2)
  buffer_load_dwordx4 v[184:187], v13, s[8:11], s12 offen nt
  s_add_u32 s12, s12, 7168
  s_waitcnt vmcnt(2)
  buffer_load_dwordx4 v[188:191], v13, s[8:11], s12 offen nt
  s_add_u32 s12, s12, 7168
  s_waitcnt vmcnt(2)
  buffer_load_dwordx4 v[192:195], v13, s[8:11], s12 offen nt
  s_add_u32 s12, s12, 7168
  s_waitcnt vmcnt(2)
  buffer_load_dwordx4 v[196:199], v13, s[8:11], s12 offen nt
  s_add_u32 s12, s12, 7168
  s_waitcnt vmcnt(2)
  buffer_load_dwordx4 v[200:203], v13, s[8:11], s12 offen nt
  s_add_u32 s12, s12, 7168
  s_waitcnt vmcnt(2)
  buffer_load_dwordx4 v[204:207], v13, s[8:11], s12 offen nt
  s_add_u32 s12, s12, 7168
  s_waitcnt vmcnt(2)
  buffer_load_dwordx4 v[208:211], v13, s[8:11], s12 offen nt
  s_add_u32 s12, s12, 7168
  s_waitcnt vmcnt(2)
  buffer_load_dwordx4 v[212:215], v13, s[8:11], s12 offen nt
  s_add_u32 s12, s12, 7168
  s_waitcnt vmcnt(2)
  buffer_load_dwordx4 v[216:219], v13, s[8:11], s12 offen nt
  s_add_u32 s12, s12, 7168
  s_waitcnt vmcnt(2)
  buffer_load_dwordx4 v[220:223], v13, s[8:11], s12 offen nt
  s_add_u32 s12, s12, 7168
  s_waitcnt vmcnt(2)
  buffer_load_dwordx4 v[224:227], v13, s[8:11], s12 offen nt
  s_add_u32 s12, s12, 7168
  s_waitcnt vmcnt(2)
  buffer_load_dwordx4 v[228:231], v13, s[8:11], s12 offen nt
  s_add_u32 s12, s12, 7168
  s_waitcnt vmcnt(2)
  buffer_load_dwordx4 v[232:235], v13, s[8:11], s12 offen nt
  s_add_u32 s12, s12, 7168
  s_waitcnt vmcnt(2)
  buffer_load_dwordx4 v[236:239], v13, s[8:11], s12 offen nt
  s_add_u32 s12, s12, 7168
  s_waitcnt vmcnt(2)
  buffer_load_dwordx4 v[32:35], v10, s[24:27], s13 offen nt
  s_add_u32 s13, s13, 16384
  s_waitcnt vmcnt(2)
  buffer_load_dwordx4 v[36:39], v10, s[24:27], s13 offen nt
  s_add_u32 s13, s13, 16384
  s_waitcnt vmcnt(2)
  buffer_load_dwordx4 v[40:43], v10, s[24:27], s13 offen nt
  s_add_u32 s13, s13, 16384
  s_waitcnt vmcnt(2)
  buffer_load_dwordx4 v[44:47], v10, s[24:27], s13 offen nt
  s_add_u32 s13, s13, 16384
  s_waitcnt vmcnt(2)
  buffer_load_dwordx4 v[48:51], v10, s[24:27], s13 offen nt
  s_add_u32 s13, s13, 16384
  s_waitcnt vmcnt(2)
  buffer_load_dwordx4 v[52:55], v10, s[24:27], s13 offen nt
  s_add_u32 s13, s13, 16384
  s_waitcnt vmcnt(2)
  buffer_load_dwordx4 v[56:59], v10, s[24:27], s13 offen nt
  s_add_u32 s13, s13, 16384
  s_waitcnt vmcnt(2)
  buffer_load_dwordx4 v[60:63], v10, s[24:27], s13 offen nt
  s_add_u32 s13, s13, 16384
  s_waitcnt vmcnt(2)
  buffer_load_dwordx4 v[64:67], v10, s[24:27], s13 offen nt
  s_add_u32 s13, s13, 16384
  s_waitcnt vmcnt(2)
  buffer_load_dwordx4 v[68:71], v10, s[24:27], s13 offen nt
  s_add_u32 s13, s13, 16384
  s_waitcnt vmcnt(2)
  buffer_load_dwordx4 v[72:75], v10, s[24:27], s13 offen nt
  s_add_u32 s13, s13, 16384
  s_waitcnt vmcnt(2)
  buffer_load_dwordx4 v[76:79], v10, s[24:27], s13 offen nt
  s_add_u32 s13, s13, 16384
  s_waitcnt vmcnt(2)
  buffer_load_dwordx4 v[240:243], v10, s[24:27], s13 offen nt
  s_add_u32 s13, s13, 16384
  s_waitcnt vmcnt(2)
  buffer_load_dwordx4 v[244:247], v10, s[24:27], s13 offen nt
  s_add_u32 s13, s13, 16384
  s_waitcnt vmcnt(2)
  buffer_load_dwordx4 v[248:251], v10, s[24:27], s13 offen nt
  s_add_u32 s13, s13, 16384
  s_waitcnt vmcnt(2)
  buffer_load_dwordx4 v[252:255], v10, s[24:27], s13 offen nt
  s_add_u32 s13, s13, 16384
  s_waitcnt vmcnt(2)
  v_mov_b32 v16, 0x3f803f80
  v_mov_b32 v17, 0x3f803f80
  v_mov_b32 v18, 0x3f803f80
  v_mov_b32 v19, 0x3f803f80
  s_waitcnt vmcnt(0)
  s_barrier
  v_perm_b32 v80, v116, v112, s36
  v_perm_b32 v84, v116, v112, s37
  v_perm_b32 v88, v117, v113, s36
  v_perm_b32 v92, v117, v113, s37
  v_perm_b32 v96, v118, v114, s36
  v_perm_b32 v100, v118, v114, s37
  v_perm_b32 v104, v119, v115, s36
  v_perm_b32 v108, v119, v115, s37
  v_perm_b32 v81, v124, v120, s36
  v_perm_b32 v85, v124, v120, s37
  v_perm_b32 v89, v125, v121, s36
  v_perm_b32 v93, v125, v121, s37
  v_perm_b32 v97, v126, v122, s36
  v_perm_b32 v101, v126, v122, s37
  v_perm_b32 v105, v127, v123, s36
  v_perm_b32 v109, v127, v123, s37
  v_perm_b32 v82, v132, v128, s36
  v_perm_b32 v86, v132, v128, s37
  v_perm_b32 v90, v133, v129, s36
  v_perm_b32 v94, v133, v129, s37
  v_perm_b32 v98, v134, v130, s36
  v_perm_b32 v102, v134, v130, s37
  v_perm_b32 v106, v135, v131, s36
  v_perm_b32 v110, v135, v131, s37
  v_perm_b32 v83, v140, v136, s36
  v_perm_b32 v87, v140, v136, s37
  v_perm_b32 v91, v141, v137, s36
  v_perm_b32 v95, v141, v137, s37
  v_perm_b32 v99, v142, v138, s36
  v_perm_b32 v103, v142, v138, s37
  v_perm_b32 v107, v143, v139, s36
  v_perm_b32 v111, v143, v139, s37
  v_perm_b32 v112, v148, v144, s36
  v_perm_b32 v116, v148, v144, s37
  v_perm_b32 v120, v149, v145, s36
  v_perm_b32 v124, v149, v145, s37
  v_perm_b32 v128, v150, v146, s36
  v_perm_b32 v132, v150, v146, s37
  v_perm_b32 v136, v151, v147, s36
  v_perm_b32 v140, v151, v147, s37
  v_perm_b32 v113, v156, v152, s36
  v_perm_b32 v117, v156, v152, s37
  v_perm_b32 v121, v157, v153, s36
  v_perm_b32 v125, v157, v153, s37
  v_perm_b32 v129, v158, v154, s36
  v_perm_b32 v133, v158, v154, s37
  v_perm_b32 v137, v159, v155, s36
  v_perm_b32 v141, v159, v155, s37
  v_perm_b32 v114, v164, v160, s36
  v_perm_b32 v118, v164, v160, s37
  v_perm_b32 v122, v165, v161, s36
  v_perm_b32 v126, v165, v161, s37
  v_perm_b32 v130, v166, v162, s36
  v_perm_b32 v134, v166, v162, s37
  v_perm_b32 v138, v167, v163, s36
  v_perm_b32 v142, v167, v163, s37
  v_perm_b32 v115, v172, v168, s36
  v_perm_b32 v119, v172, v168, s37
  v_perm_b32 v123, v173, v169, s36
  v_perm_b32 v127, v173, v169, s37
  v_perm_b32 v131, v174, v170, s36
  v_perm_b32 v135, v174, v170, s37
  v_perm_b32 v139, v175, v171, s36
  v_perm_b32 v143, v175, v171, s37
  v_perm_b32 v144, v180, v176, s36
  v_perm_b32 v148, v180, v176, s37
  v_perm_b32 v152, v181, v177, s36
  v_perm_b32 v156, v181, v177, s37
  v_perm_b32 v160, v182, v178, s36
  v_perm_b32 v164, v182, v178, s37
  v_perm_b32 v168, v183, v179, s36
  v_perm_b32 v172, v183, v179, s37
  v_perm_b32 v145, v188, v184, s36
  v_perm_b32 v149, v188, v184, s37
  v_perm_b32 v153, v189, v185, s36
  v_perm_b32 v157, v189, v185, s37
  v_perm_b32 v161, v190, v186, s36
  v_perm_b32 v165, v190, v186, s37
  v_perm_b32 v169, v191, v187, s36
  v_perm_b32 v173, v191, v187, s37
  v_perm_b32 v146, v196, v192, s36
  v_perm_b32 v150, v196, v192, s37
  v_perm_b32 v154, v197, v193, s36
  v_perm_b32 v158, v197, v193, s37
  v_perm_b32 v162, v198, v194, s36
  v_perm_b32 v166, v198, v194, s37
  v_perm_b32 v170, v199, v195, s36
  v_perm_b32 v174, v199, v195, s37
  v_perm_b32 v147, v204, v200, s36
  v_perm_b32 v151, v204, v200, s37
  v_perm_b32 v155, v205, v201, s36
  v_perm_b32 v159, v205, v201, s37
  v_perm_b32 v163, v206, v202, s36
  v_perm_b32 v167, v206, v202, s37
  v_perm_b32 v171, v207, v203, s36
  v_perm_b32 v175, v207, v203, s37
  v_perm_b32 v176, v212, v208, s36
  v_perm_b32 v180, v212, v208, s37
  v_perm_b32 v184, v213, v209, s36
  v_perm_b32 v188, v213, v209, s37
  v_perm_b32 v192, v214, v210, s36
  v_perm_b32 v196, v214, v210, s37
  v_perm_b32 v200, v215, v211, s36
  v_perm_b32 v204, v215, v211, s37
  v_perm_b32 v177, v220, v216, s36
  v_perm_b32 v181, v220, v216, s37
  v_perm_b32 v185, v221, v217, s36
  v_perm_b32 v189, v221, v217, s37
  v_perm_b32 v193, v222, v218, s36
  v_perm_b32 v197, v222, v218, s37
  v_perm_b32 v201, v223, v219, s36
  v_perm_b32 v205, v223, v219, s37
  v_perm_b32 v178, v228, v224, s36
  v_perm_b32 v182, v228, v224, s37
  v_perm_b32 v186, v229, v225, s36
  v_perm_b32 v190, v229, v225, s37
  v_perm_b32 v194, v230, v226, s36
  v_perm_b32 v198, v230, v226, s37
  v_perm_b32 v202, v231, v227, s36
  v_perm_b32 v206, v231, v227, s37
  v_perm_b32 v179, v236, v232, s36
  v_perm_b32 v183, v236, v232, s37
  v_perm_b32 v187, v237, v233, s36
  v_perm_b32 v191, v237, v233, s37
  v_perm_b32 v195, v238, v234, s36
  v_perm_b32 v199, v238, v234, s37
  v_perm_b32 v203, v239, v235, s36
  v_perm_b32 v207, v239, v235, s37
  v_mfma_f32_16x16x32_bf16 v[208:211], v[16:19], v[80:83], 0
  v_mfma_f32_16x16x32_bf16 v[212:215], v[16:19], v[84:87], 0
  v_mfma_f32_16x16x32_bf16 v[216:219], v[16:19], v[88:91], 0
  v_mfma_f32_16x16x32_bf16 v[220:223], v[16:19], v[92:95], 0
  v_mfma_f32_16x16x32_bf16 v[224:227], v[16:19], v[96:99], 0
  v_mfma_f32_16x16x32_bf16 v[228:231], v[16:19], v[100:103], 0
  v_mfma_f32_16x16x32_bf16 v[232:235], v[16:19], v[104:107], 0
  v_mfma_f32_16x16x32_bf16 v[236:239], v[16:19], v[108:111], 0
  v_mfma_f32_16x16x32_bf16 v[208:211], v[16:19], v[112:115], v[208:211]
  v_mfma_f32_16x16x32_bf16 v[212:215], v[16:19], v[116:119], v[212:215]
  v_mfma_f32_16x16x32_bf16 v[216:219], v[16:19], v[120:123], v[216:219]
  v_mfma_f32_16x16x32_bf16 v[220:223], v[16:19], v[124:127], v[220:223]
  v_mfma_f32_16x16x32_bf16 v[224:227], v[16:19], v[128:131], v[224:227]
  v_mfma_f32_16x16x32_bf16 v[228:231], v[16:19], v[132:135], v[228:231]
  v_mfma_f32_16x16x32_bf16 v[232:235], v[16:19], v[136:139], v[232:235]
  v_mfma_f32_16x16x32_bf16 v[236:239], v[16:19], v[140:143], v[236:239]
  v_mfma_f32_16x16x32_bf16 v[208:211], v[16:19], v[144:147], v[208:211]
  v_mfma_f32_16x16x32_bf16 v[212:215], v[16:19], v[148:151], v[212:215]
  v_mfma_f32_16x16x32_bf16 v[216:219], v[16:19], v[152:155], v[216:219]
  v_mfma_f32_16x16x32_bf16 v[220:223], v[16:19], v[156:159], v[220:223]
  v_mfma_f32_16x16x32_bf16 v[224:227], v[16:19], v[160:163], v[224:227]
  v_mfma_f32_16x16x32_bf16 v[228:231], v[16:19], v[164:167], v[228:231]
  v_mfma_f32_16x16x32_bf16 v[232:235], v[16:19], v[168:171], v[232:235]
  v_mfma_f32_16x16x32_bf16 v[236:239], v[16:19], v[172:175], v[236:239]
  v_mfma_f32_16x16x32_bf16 v[208:211], v[16:19], v[176:179], v[208:211]
  v_mfma_f32_16x16x32_bf16 v[212:215], v[16:19], v[180:183], v[212:215]
  v_mfma_f32_16x16x32_bf16 v[216:219], v[16:19], v[184:187], v[216:219]
  v_mfma_f32_16x16x32_bf16 v[220:223], v[16:19], v[188:191], v[220:223]
  v_mfma_f32_16x16x32_bf16 v[224:227], v[16:19], v[192:195], v[224:227]
  v_mfma_f32_16x16x32_bf16 v[228:231], v[16:19], v[196:199], v[228:231]
  v_mfma_f32_16x16x32_bf16 v[232:235], v[16:19], v[200:203], v[232:235]
  v_mfma_f32_16x16x32_bf16 v[236:239], v[16:19], v[204:207], v[236:239]
  s_nop 0
  v_add_f32 v28, v209, v208 row_ror:8 row_mask:0xf bank_mask:0x3
  v_add_f32 v29, v213, v212 row_ror:8 row_mask:0xf bank_mask:0x3
  v_add_f32 v30, v217, v216 row_ror:8 row_mask:0xf bank_mask:0x3
  v_add_f32 v31, v221, v220 row_ror:8 row_mask:0xf bank_mask:0x3
  v_add_f32 v28, v224, v225 row_ror:8 row_mask:0xf bank_mask:0xc
  v_add_f32 v29, v228, v229 row_ror:8 row_mask:0xf bank_mask:0xc
  v_add_f32 v30, v232, v233 row_ror:8 row_mask:0xf bank_mask:0xc
  v_add_f32 v31, v236, v237 row_ror:8 row_mask:0xf bank_mask:0xc
  v_mul_f32 v28, 0.0009765625, v28
  v_mul_f32 v29, 0.0009765625, v29
  v_mul_f32 v30, 0.0009765625, v30
  v_mul_f32 v31, 0.0009765625, v31
.fz_kernel_c_np:
  v_mov_b32 v27, v6
  s_mov_b32 s72, s66
  s_mov_b32 s73, s65
  s_mov_b32 s74, s67
  s_mov_b32 s75, s62
  s_cmp_lg_u32 s62, 0
  s_cbranch_scc1 .fz_kernel_c_n2
  s_mov_b32 s62, 1
  s_mov_b32 s63, 0x2000000
  s_mov_b32 s64, 0x2800000
  s_mov_b32 s65, 0x1400000
  s_mov_b32 s66, 0x1c42000
  s_mov_b32 s67, 12
  s_mov_b32 s71, 159776
  v_mov_b32 v6, 159832
.fz_kernel_c_n2:
  s_lshr_b32 s21, s17, 3
  s_add_u32 s70, s18, s21
  s_lshl1_add_u32 s70, s17, s70
  s_and_b32 s70, s70, 15
  s_cmp_eq_u32 s75, 0
  s_cselect_b32 s3, 32, 0
  s_cselect_b32 s70, s70, s18
  s_and_b32 s20, s16, 1
  s_mov_b32 s34, 0x00030003
  s_mov_b32 s35, 0x00030003
  s_mov_b32 s71, 0
  s_lshl1_add_u32 s26, s17, s20
  v_lshrrev_b32 v8, 4, v2
  v_bfe_u32 v12, v2, 3, 1
  v_lshl_add_u32 v12, v12, 2, v8
  v_lshlrev_b32 v10, 7, v2
  s_lshl_b32 s25, s20, 1
  v_lshrrev_b32 v14, 4, v2
  v_bfe_u32 v15, v2, 2, 2
  v_lshl_add_u32 v16, v14, 3, v15
  v_lshlrev_b32 v16, 7, v16
  v_and_b32 v14, 1, v14
  v_lshrrev_b32 v15, 1, v15
  v_lshl_add_u32 v14, v14, 1, v15
  v_xor_b32 v14, s25, v14
  v_lshl_add_u32 v16, v14, 5, v16
  v_and_b32 v14, 3, v2
  v_lshl_add_u32 v16, v14, 3, v16
  v_add_u32 v7, 65536, v16
  v_xor_b32 v9, 32, v7
  s_add_u32 s21, s74, 0x1800008
  s_sub_u32 s22, s72, 32768
  v_mov_b32 v14, s21
  v_mov_b32 v15, s22
  v_cmp_gt_u32 vcc, 16, v2
  s_nop 1
  v_cndmask_b32 v14, v15, v14, vcc
  v_lshl_add_u32 v14, v2, 11, v14
  s_lshl_b32 s25, s17, 7
  s_lshl_b32 s22, 1, s18
  v_mov_b32 v15, s22
  v_lshlrev_b32 v16, 3, v2
  s_and_b32 s21, s2, 7
  s_lshl_b32 s21, s21, 11
  s_lshl_b32 s22, s20, 10
  s_add_u32 s21, s21, s22
  s_add_u32 s21, s21, s72
  s_lshl_b32 s22, s20, 12
  s_add_u32 s22, s22, s72
  s_add_u32 s22, s22, 16384
  s_add_u32 s23, s22, 8192
  s_add_u32 s24, s22, 16384
  v_and_b32 v17, 1, v8
  v_lshlrev_b32 v17, 13, v17
  v_lshrrev_b32 v18, 1, v8
  v_mul_u32_u24 v18, 320, v18
  v_add_u32 v17, v17, v18
  v_bfe_u32 v18, v2, 3, 1
  v_lshl_add_u32 v17, v18, 9, v17
  v_bfe_u32 v18, v2, 2, 1
  v_lshl_add_u32 v17, v18, 7, v17
  v_and_b32 v18, 3, v2
  v_lshl_add_u32 v17, v18, 3, v17
  s_lshl_b32 s27, s20, 14
  s_add_u32 s27, s27, 114688
  v_add_u32 v17, s27, v17
  v_xor_b32 v18, 64, v17
  v_and_b32 v19, 15, v2
  v_lshlrev_b32 v19, 6, v19
  v_lshl_add_u32 v19, v8, 4, v19
  v_and_b32 v20, 7, v2
  v_lshlrev_b32 v20, 5, v20
  v_and_b32 v21, 8, v2
  v_lshl_add_u32 v20, v21, 1, v20
  v_and_b32 v21, 31, v2
  v_lshlrev_b32 v21, 4, v21
  v_lshrrev_b32 v22, 5, v2
  v_lshl_add_u32 v21, v22, 11, v21
  v_mov_b32 v23, 0.0009765625
  v_mov_b32 v24, 9.5367431640625e-07
  v_mov_b32 v25, 1e-05
  v_add_u32 v26, 155648, v16
  s_lshl_b32 s14, s17, 9
  s_add_u32 s14, s14, s72
  s_add_u32 s14, s14, 16384
  s_add_u32 s15, s14, 8192
  v_add_u32 v13, s27, v3
  s_barrier
.fz_kernel_c_n3:
  s_mov_b32 s13, 0xffffff
  s_cmp_eq_u32 s20, 0
  s_cbranch_scc1 .fz_kernel_c_nf
  s_cmp_eq_u32 s75, 0
  s_cselect_b32 exec_lo, 0xffff, s13
  s_mov_b32 exec_hi, 0
  s_mov_b32 s38, 0
.fz_kernel_cw61:
  s_sleep 1
  ds_read_u8 v22, v27 offset:268
  s_add_u32 s38, s38, 1
  s_waitcnt lgkmcnt(0)
  v_cmp_gt_u32 vcc, 4, v22
  s_cbranch_vccz .fz_kernel_cw61d
  s_cmp_lt_u32 s38, 8388608
  s_cbranch_scc1 .fz_kernel_cw61
.fz_kernel_cw61d:
  buffer_atomic_or v15, v14, s[4:7], s25 offen sc1
  s_mov_b64 exec, -1
.fz_kernel_c_nf:
  s_add_u32 s13, s19, s74
  s_mov_b64 exec, 1
  buffer_load_dword v11, v4, s[4:7], s13 offen offset:8 sc1
  s_mov_b64 exec, -1
  ds_write_b128 v13, v[32:35] offset:0
  ds_write_b128 v13, v[36:39] offset:1024
  ds_write_b128 v13, v[40:43] offset:2048
  ds_write_b128 v13, v[44:47] offset:3072
  ds_write_b128 v13, v[48:51] offset:4096
  ds_write_b128 v13, v[52:55] offset:5120
  ds_write_b128 v13, v[56:59] offset:6144
  ds_write_b128 v13, v[60:63] offset:7168
  ds_write_b128 v13, v[64:67] offset:8192
  ds_write_b128 v13, v[68:71] offset:9216
  ds_write_b128 v13, v[72:75] offset:10240
  ds_write_b128 v13, v[76:79] offset:11264
  ds_write_b128 v13, v[240:243] offset:12288
  ds_write_b128 v13, v[244:247] offset:13312
  ds_write_b128 v13, v[248:251] offset:14336
  ds_write_b128 v13, v[252:255] offset:15360
  v_and_b32 v14, 1, v2
  v_lshlrev_b32 v14, 10, v14
  v_lshl_add_u32 v14, v8, 14, v14
  s_waitcnt lgkmcnt(0)
  s_cmp_lg_u32 s75, 0
  s_cbranch_scc1 .fz_kernel_c_nw
  v_mov_b32 v13, v9
  s_lshl_b32 s21, s18, 10
  s_add_u32 s21, s21, s72
  s_cmp_lg_u32 s20, 0
  s_cbranch_scc1 .fz_kernel_c_c7
  s_add_u32 s22, s19, s74
  s_add_u32 s23, s14, 16384
  s_mov_b64 exec, 1
  s_mov_b32 s38, 0
  s_branch .fz_kernel_c_c00
.fz_kernel_c_c0:
  buffer_load_dword v11, v4, s[4:7], s22 offen offset:8 sc1
.fz_kernel_c_c00:
  s_add_u32 s38, s38, 1
  s_waitcnt vmcnt(0)
  ds_or_b32 v6, v11 offset:0x114
  v_or_b32 v11, v11, v15
  v_cmp_ne_u32 vcc, 0xffff, v11
  s_cbranch_vccz .fz_kernel_c_c1
  s_cmp_lt_u32 s38, 131072
  s_cbranch_scc1 .fz_kernel_c_c0
.fz_kernel_c_c1:
  s_mov_b32 s38, 0
.fz_kernel_cw62:
  s_sleep 1
  ds_read_u8 v22, v27 offset:268
  s_add_u32 s38, s38, 1
  s_waitcnt lgkmcnt(0)
  v_cmp_gt_u32 vcc, 4, v22
  s_cbranch_vccz .fz_kernel_cw62d
  s_cmp_lt_u32 s38, 8388608
  s_cbranch_scc1 .fz_kernel_cw62
.fz_kernel_cw62d:
  ds_or_b32 v6, v11 offset:0x114
  s_mov_b64 exec, -1
  buffer_load_dwordx2 v[240:241], v16, s[4:7], s14 offen
  buffer_load_dwordx2 v[242:243], v16, s[4:7], s15 offen
  buffer_load_dwordx2 v[244:245], v16, s[4:7], s23 offen
  s_lshl_b32 s23, s17, 6
  s_add_u32 s23, s23, s21
  s_lshl_b32 s24, s17, 7
  s_add_u32 s24, s24, 1
  s_mov_b32 s38, 0
.fz_kernel_cw63:
  s_sleep 1
  ds_read_u8 v22, v6 offset:272
  s_add_u32 s38, s38, 1
  s_waitcnt lgkmcnt(0)
  v_cmp_gt_u32 vcc, 2, v22
  s_cbranch_vccz .fz_kernel_cw63d
  s_cmp_lt_u32 s38, 8388608
  s_cbranch_scc1 .fz_kernel_cw63
.fz_kernel_cw63d:
  ds_read_b64_tr_b16 v[32:33], v7 offset:0
  ds_read_b64_tr_b16 v[34:35], v7 offset:512
  ds_read_b64_tr_b16 v[36:37], v13 offset:0
  ds_read_b64_tr_b16 v[38:39], v13 offset:512
  ds_read_b64_tr_b16 v[40:41], v7 offset:4096
  ds_read_b64_tr_b16 v[42:43], v7 offset:4608
  ds_read_b64_tr_b16 v[44:45], v13 offset:4096
  ds_read_b64_tr_b16 v[46:47], v13 offset:4608
  ds_read_b64_tr_b16 v[48:49], v7 offset:8192
  ds_read_b64_tr_b16 v[50:51], v7 offset:8704
  ds_read_b64_tr_b16 v[52:53], v13 offset:8192
  ds_read_b64_tr_b16 v[54:55], v13 offset:8704
  s_waitcnt lgkmcnt(0)
  ds_read_b64_tr_b16 v[56:57], v7 offset:12288
  ds_read_b64_tr_b16 v[58:59], v7 offset:12800
  ds_read_b64_tr_b16 v[60:61], v13 offset:12288
  ds_read_b64_tr_b16 v[62:63], v13 offset:12800
  ds_read_b64_tr_b16 v[64:65], v7 offset:16384
  ds_read_b64_tr_b16 v[66:67], v7 offset:16896
  ds_read_b64_tr_b16 v[68:69], v13 offset:16384
  ds_read_b64_tr_b16 v[70:71], v13 offset:16896
  ds_read_b64_tr_b16 v[72:73], v7 offset:20480
  ds_read_b64_tr_b16 v[74:75], v7 offset:20992
  ds_read_b64_tr_b16 v[76:77], v13 offset:20480
  ds_read_b64_tr_b16 v[78:79], v13 offset:20992
  s_waitcnt lgkmcnt(0)
  s_waitcnt vmcnt(0)
  v_fma_f32 v208, -v240, v240, v242
  v_fma_f32 v209, -v241, v241, v243
  v_rsq_f32 v208, abs(v208)
  v_rsq_f32 v209, abs(v209)
  v_mul_f32 v208, v208, v244
  v_mul_f32 v209, v209, v245
  v_and_b32 v208, -2, v208
  v_or_b32 v209, 1, v209
  v_cmp_gt_f32 vcc, v209, v208
  v_max_f32 v9, v208, v209
  s_nop 0
  v_cndmask_b32 v210, v240, v241, vcc
  v_max_f32 v7, v9, v9 row_ror:8 row_mask:0xf bank_mask:0xf
  v_cndmask_b32 v211, v242, v243, vcc
  s_nop 0
  v_max_f32 v7, v7, v7 row_ror:4 row_mask:0xf bank_mask:0xf
  s_nop 1
  v_max_f32 v7, v7, v7 row_ror:2 row_mask:0xf bank_mask:0xf
  s_nop 1
  v_max_f32 v7, v7, v7 row_ror:1 row_mask:0xf bank_mask:0xf
  s_nop 1
  v_max_f32 v7, v7, v7 row_bcast:15 row_mask:0xa bank_mask:0xf
  s_nop 1
  v_max_f32 v7, v7, v7 row_bcast:31 row_mask:0xc bank_mask:0xf
  v_and_b32 v209, 1, v9
  v_lshl_add_u32 v209, v2, 1, v209
  v_readlane_b32 s22, v7, 63
  v_add_u32 v209, s24, v209
  v_mov_b32 v208, v9
  v_cmp_eq_u32 vcc, s22, v9
  s_ff1_i32_b64 s22, vcc
  s_lshl_b64 exec, 1, s22
  buffer_store_dwordx4 v[208:211], v4, s[4:7], s23 offen sc1
  s_mov_b64 exec, -1
.fz_kernel_c_c2:
  s_cmp_lg_u32 s20, 0
  s_cbranch_scc1 .fz_kernel_c_c21
  s_call_b64 s[68:69], .fz_kernel_c_coef
  ds_write_b64 v26, v[248:249] offset:4608
  ds_write_b64 v26, v[250:251] offset:5120
  ds_write_b64 v26, v[252:253] offset:6400
  ds_write_b64 v26, v[254:255] offset:6912
.fz_kernel_c_c21:
  s_cmp_eq_u32 s3, 0
  s_cbranch_scc1 .fz_kernel_hb65
  s_barrier
  s_sub_u32 s3, s3, 1
.fz_kernel_hb65:
  s_cmp_eq_u32 s3, 0
  s_cbranch_scc1 .fz_kernel_hb66
  s_barrier
  s_sub_u32 s3, s3, 1
.fz_kernel_hb66:
  s_cmp_eq_u32 s3, 0
  s_cbranch_scc1 .fz_kernel_hb67
  s_barrier
  s_sub_u32 s3, s3, 1
.fz_kernel_hb67:
.fz_kernel_c_c3:
  v_lshlrev_b32 v22, 6, v2
  s_mov_b64 exec, 0xffff
  s_mov_b32 s38, 0
.fz_kernel_c_c4:
  buffer_load_dwordx4 v[224:227], v22, s[4:7], s21 offen sc1
  s_add_u32 s38, s38, 1
  s_mov_b32 s46, 0
  s_call_b64 s[0:1], .fz_kernel_hw
  s_waitcnt vmcnt(0)
  v_min_u32 v9, v225, v227
  v_max_f32 v7, v224, v224 row_ror:8 row_mask:0xf bank_mask:0xf
  v_cmp_eq_u32 vcc, 0, v9
  s_cbranch_vccz .fz_kernel_c_c5
  s_cmp_lt_u32 s38, 131072
  s_cbranch_scc1 .fz_kernel_c_c4
.fz_kernel_c_c5:
  s_waitcnt lgkmcnt(0)
  v_max_f32 v7, v7, v7 row_ror:4 row_mask:0xf bank_mask:0xf
  s_nop 1
  v_max_f32 v7, v7, v7 row_ror:2 row_mask:0xf bank_mask:0xf
  s_nop 1
  v_max_f32 v7, v7, v7 row_ror:1 row_mask:0xf bank_mask:0xf
  v_cmp_eq_u32 vcc, v7, v224
  s_or_b32 s22, vcc_lo, 0x8000
  s_ff1_i32_b32 s22, s22
  v_readlane_b32 s77, v225, s22
  v_readlane_b32 s27, v224, s22
  v_readlane_b32 s23, v226, s22
  v_readlane_b32 s24, v227, s22
  s_mov_b64 exec, -1
  v_mov_b32 v11, s23
  v_mov_b32 v15, s24
  s_branch .fz_kernel_c_idx
.fz_kernel_c_nw:
  s_mov_b64 exec, 0xff
  s_mov_b32 s38, 0
.fz_kernel_c_gm:
  buffer_load_dword v9, v10, s[4:7], s21 offen sc1
  s_add_u32 s38, s38, 1
  s_mov_b32 s46, 0
  s_call_b64 s[0:1], .fz_kernel_hw
  s_waitcnt vmcnt(0)
  v_cmp_ne_u32 vcc, 0xffff, v9
  s_cbranch_vccz .fz_kernel_c_gmd
  s_cmp_eq_u32 s3, 0
  s_cbranch_scc1 .fz_kernel_hb68
  s_barrier
  s_sub_u32 s3, s3, 1
.fz_kernel_hb68:
  s_cmp_lt_u32 s38, 131072
  s_cbranch_scc1 .fz_kernel_c_gm
.fz_kernel_c_gmd:
  s_mov_b64 exec, -1
  buffer_load_dwordx4 v[208:211], v3, s[4:7], s22 offen offset:0
  buffer_load_dwordx4 v[212:215], v3, s[4:7], s23 offen offset:0
  buffer_load_dwordx4 v[216:219], v3, s[4:7], s24 offen offset:0
  buffer_load_dwordx4 v[220:223], v3, s[4:7], s22 offen offset:1024
  buffer_load_dwordx4 v[224:227], v3, s[4:7], s23 offen offset:1024
  buffer_load_dwordx4 v[228:231], v3, s[4:7], s24 offen offset:1024
  buffer_load_dwordx4 v[232:235], v3, s[4:7], s22 offen offset:2048
  buffer_load_dwordx4 v[236:239], v3, s[4:7], s23 offen offset:2048
  buffer_load_dwordx4 v[240:243], v3, s[4:7], s24 offen offset:2048
  buffer_load_dwordx4 v[244:247], v3, s[4:7], s22 offen offset:3072
  buffer_load_dwordx4 v[248:251], v3, s[4:7], s23 offen offset:3072
  buffer_load_dwordx4 v[252:255], v3, s[4:7], s24 offen offset:3072
  s_lshl_b32 s21, s75, 4
  s_add_u32 s21, s21, 159968
  v_mov_b32 v10, s21
  s_lshl_b32 s22, s20, 3
  v_add_u32 v13, s22, v10
  s_mov_b32 s46, 6
  s_call_b64 s[0:1], .fz_kernel_hw
  s_waitcnt vmcnt(6)
  s_waitcnt vmcnt(10)
  v_fma_f32 v212, -v208, v208, v212
  v_fma_f32 v213, -v209, v209, v213
  v_fma_f32 v214, -v210, v210, v214
  v_fma_f32 v215, -v211, v211, v215
  s_cmp_eq_u32 s3, 0
  s_cbranch_scc1 .fz_kernel_hb76
  s_barrier
  s_sub_u32 s3, s3, 1
.fz_kernel_hb76:
  v_rsq_f32 v212, abs(v212)
  v_rsq_f32 v213, abs(v213)
  v_rsq_f32 v214, abs(v214)
  v_rsq_f32 v215, abs(v215)
  s_waitcnt vmcnt(9)
  v_mul_f32 v216, v216, v212
  v_mul_f32 v217, v217, v213
  v_mul_f32 v218, v218, v214
  v_mul_f32 v219, v219, v215
  v_and_or_b32 v216, v216, -16, 0
  v_and_or_b32 v217, v217, -16, 1
  v_and_or_b32 v218, v218, -16, 2
  v_and_or_b32 v219, v219, -16, 3
  v_max3_f32 v9, v216, v217, v218
  v_max_f32 v9, v9, v219
  s_waitcnt vmcnt(7)
  v_fma_f32 v224, -v220, v220, v224
  v_fma_f32 v225, -v221, v221, v225
  v_fma_f32 v226, -v222, v222, v226
  v_fma_f32 v227, -v223, v223, v227
  v_rsq_f32 v224, abs(v224)
  v_rsq_f32 v225, abs(v225)
  v_rsq_f32 v226, abs(v226)
  v_rsq_f32 v227, abs(v227)
  s_waitcnt vmcnt(6)
  v_mul_f32 v228, v228, v224
  v_mul_f32 v229, v229, v225
  v_mul_f32 v230, v230, v226
  v_mul_f32 v231, v231, v227
  s_cmp_eq_u32 s3, 0
  s_cbranch_scc1 .fz_kernel_hb77
  s_barrier
  s_sub_u32 s3, s3, 1
.fz_kernel_hb77:
  v_and_or_b32 v228, v228, -16, 4
  v_and_or_b32 v229, v229, -16, 5
  v_and_or_b32 v230, v230, -16, 6
  v_and_or_b32 v231, v231, -16, 7
  v_max3_f32 v9, v9, v228, v229
  v_max3_f32 v9, v9, v230, v231
  s_waitcnt vmcnt(4)
  v_fma_f32 v236, -v232, v232, v236
  v_fma_f32 v237, -v233, v233, v237
  v_fma_f32 v238, -v234, v234, v238
  v_fma_f32 v239, -v235, v235, v239
  v_rsq_f32 v236, abs(v236)
  v_rsq_f32 v237, abs(v237)
  v_rsq_f32 v238, abs(v238)
  v_rsq_f32 v239, abs(v239)
  s_waitcnt vmcnt(3)
  v_mul_f32 v240, v240, v236
  v_mul_f32 v241, v241, v237
  v_mul_f32 v242, v242, v238
  v_mul_f32 v243, v243, v239
  v_and_or_b32 v240, v240, -16, 8
  v_and_or_b32 v241, v241, -16, 9
  v_and_or_b32 v242, v242, -16, 10
  v_and_or_b32 v243, v243, -16, 11
  v_max3_f32 v9, v9, v240, v241
  v_max3_f32 v9, v9, v242, v243
  s_waitcnt vmcnt(1)
  v_fma_f32 v248, -v244, v244, v248
  v_fma_f32 v249, -v245, v245, v249
  v_fma_f32 v250, -v246, v246, v250
  v_fma_f32 v251, -v247, v247, v251
  v_rsq_f32 v248, abs(v248)
  s_cmp_eq_u32 s3, 0
  s_cbranch_scc1 .fz_kernel_hb78
  s_barrier
  s_sub_u32 s3, s3, 1
.fz_kernel_hb78:
  v_rsq_f32 v249, abs(v249)
  v_rsq_f32 v250, abs(v250)
  v_rsq_f32 v251, abs(v251)
  s_waitcnt vmcnt(0)
  v_mul_f32 v252, v252, v248
  v_mul_f32 v253, v253, v249
  v_mul_f32 v254, v254, v250
  v_mul_f32 v255, v255, v251
  v_and_or_b32 v252, v252, -16, 12
  v_and_or_b32 v253, v253, -16, 13
  v_and_or_b32 v254, v254, -16, 14
  v_and_or_b32 v255, v255, -16, 15
  v_max3_f32 v9, v9, v252, v253
  v_max3_f32 v9, v9, v254, v255
  s_nop 1
  v_max_f32 v7, v9, v9 row_ror:8 row_mask:0xf bank_mask:0xf
  s_nop 1
  v_max_f32 v7, v7, v7 row_ror:4 row_mask:0xf bank_mask:0xf
  s_nop 1
  v_max_f32 v7, v7, v7 row_ror:2 row_mask:0xf bank_mask:0xf
  s_nop 1
  v_max_f32 v7, v7, v7 row_ror:1 row_mask:0xf bank_mask:0xf
  s_nop 1
  v_max_f32 v7, v7, v7 row_bcast:15 row_mask:0xa bank_mask:0xf
  s_nop 1
  v_max_f32 v7, v7, v7 row_bcast:31 row_mask:0xc bank_mask:0xf
  s_nop 0
  v_readlane_b32 s21, v7, 63
  s_nop 1
  v_cmp_eq_u32 vcc, s21, v9
  s_ff1_i32_b64 s22, vcc
  s_lshl_b32 s22, s22, 2
  s_and_b32 s23, s21, 3
  s_add_u32 s22, s22, s23
  s_and_b32 s23, s21, 12
  s_lshl_b32 s23, s23, 6
  s_add_u32 s22, s22, s23
  s_and_b32 s22, s22, 1023
  s_lshl_b32 s23, s20, 10
  s_add_u32 s22, s22, s23
  s_add_u32 s22, s22, 1
  v_mov_b32 v224, s21
  v_mov_b32 v225, s22
  s_mov_b64 exec, 1
  ds_write_b64 v13, v[224:225]
  s_mov_b32 s38, 0
.fz_kernel_c_am:
  s_cmp_eq_u32 s3, 0
  s_cbranch_scc1 .fz_kernel_hb79
  s_barrier
  s_sub_u32 s3, s3, 1
.fz_kernel_hb79:
  ds_read_b128 v[224:227], v10
  s_add_u32 s38, s38, 1
  s_waitcnt lgkmcnt(0)
  v_min_u32 v9, v225, v227
  v_cmp_eq_u32 vcc, 0, v9
  s_cbranch_vccz .fz_kernel_c_amd
  s_cmp_eq_u32 s3, 0
  s_cbranch_scc1 .fz_kernel_hb69
  s_barrier
  s_sub_u32 s3, s3, 1
.fz_kernel_hb69:
  s_cmp_lt_u32 s38, 524288
  s_cbranch_scc1 .fz_kernel_c_am
.fz_kernel_c_amd:
  v_cmp_gt_f32 vcc, v226, v224
  s_nop 1
  v_cndmask_b32 v225, v225, v227, vcc
  v_cndmask_b32 v224, v224, v226, vcc
  v_readfirstlane_b32 s77, v225
  v_readfirstlane_b32 s27, v224
  s_mov_b64 exec, -1
  s_sub_u32 s21, s77, 1
  s_and_b32 s21, s21, 2047
  s_lshl_b32 s21, s21, 2
  s_add_u32 s21, s21, s72
  s_add_u32 s21, s21, 16384
  s_add_u32 s22, s21, 8192
  buffer_load_dword v11, v4, s[4:7], s21 offen
  buffer_load_dword v15, v4, s[4:7], s22 offen
.fz_kernel_c_idx:
  s_mov_b64 exec, s[34:35]
  s_sub_u32 s77, s77, 1
  s_and_b32 s77, s77, 2047
  s_lshr_b32 s78, s77, 7
  s_lshl_b32 s78, s78, 18
  s_and_b32 s21, s77, 0x70
  s_lshl_b32 s21, s21, 7
  s_add_u32 s78, s78, s21
  s_and_b32 s21, s77, 15
  s_lshl_b32 s21, s21, 4
  s_add_u32 s78, s78, s21
  s_add_u32 s78, s78, s73
  s_and_b32 s25, s18, 2
  s_add_u32 s25, s25, s20
  s_lshl_b32 s21, s25, 16
  s_add_u32 s21, s21, s78
  buffer_load_dwordx4 v[208:211], v14, s[4:7], s21 offen offset:0
  buffer_load_dwordx4 v[212:215], v14, s[4:7], s21 offen offset:256
  buffer_load_dwordx4 v[216:219], v14, s[4:7], s21 offen offset:512
  buffer_load_dwordx4 v[220:223], v14, s[4:7], s21 offen offset:768
  s_mov_b64 exec, -1
  s_lshr_b32 s21, s77, 7
  s_and_b32 s79, s77, 127
  s_add_u32 s79, s79, 1
  s_cmp_eq_u32 s21, s17
  s_cselect_b32 s79, s79, 0
  s_and_b32 s21, s18, 1
  s_lshl_b32 s21, s21, 2
  s_add_u32 s21, s21, s25
  s_lshl_b32 s21, s21, 9
  s_lshl_b32 s22, s17, 13
  s_add_u32 s21, s21, s22
  s_and_b32 s22, s18, 8
  s_lshl_b32 s22, s22, 9
  s_add_u32 s21, s21, s22
  s_and_b32 s22, s18, 4
  s_lshl_b32 s22, s22, 6
  s_add_u32 s21, s21, s22
  s_add_u32 s21, s21, s72
  s_add_u32 s21, s21, 40960
  s_cmp_eq_u32 s3, 0
  s_cbranch_scc1 .fz_kernel_hb80
  s_barrier
  s_sub_u32 s3, s3, 1
.fz_kernel_hb80:
  v_mov_b32 v1, -1477.3197218702985
  v_mul_f32 v1, s27, v1
  v_exp_f32 v1, v1
  s_nop 0
  v_add_f32 v1, 1.0, v1
  v_rcp_f32 v1, v1
  v_and_b32 v14, 8, v2
  v_lshlrev_b32 v14, 7, v14
  v_lshl_add_u32 v14, v8, 8, v14
  s_lshl_b32 s23, s70, 14
  s_add_u32 s23, s23, s78
  s_mov_b32 s46, 0
  s_call_b64 s[0:1], .fz_kernel_hw
  s_waitcnt vmcnt(0)
  s_cmp_ge_u32 s17, 14
  s_cbranch_scc1 .fz_kernel_c_ng
  s_setprio 2
  v_mfma_f32_16x16x32_bf16 v[224:227], v[208:211], v[80:83], 0
  v_mfma_f32_16x16x32_bf16 v[228:231], v[208:211], v[84:87], 0
  v_mfma_f32_16x16x32_bf16 v[232:235], v[208:211], v[88:91], 0
  v_mfma_f32_16x16x32_bf16 v[236:239], v[208:211], v[92:95], 0
  v_mfma_f32_16x16x32_bf16 v[240:243], v[208:211], v[96:99], 0
  v_mfma_f32_16x16x32_bf16 v[244:247], v[208:211], v[100:103], 0
  v_mfma_f32_16x16x32_bf16 v[248:251], v[208:211], v[104:107], 0
  v_mfma_f32_16x16x32_bf16 v[252:255], v[208:211], v[108:111], 0
  v_mfma_f32_16x16x32_bf16 v[224:227], v[212:215], v[112:115], v[224:227]
  v_mfma_f32_16x16x32_bf16 v[228:231], v[212:215], v[116:119], v[228:231]
  v_mfma_f32_16x16x32_bf16 v[232:235], v[212:215], v[120:123], v[232:235]
  v_mfma_f32_16x16x32_bf16 v[236:239], v[212:215], v[124:127], v[236:239]
  v_mfma_f32_16x16x32_bf16 v[240:243], v[212:215], v[128:131], v[240:243]
  v_mfma_f32_16x16x32_bf16 v[244:247], v[212:215], v[132:135], v[244:247]
  v_mfma_f32_16x16x32_bf16 v[248:251], v[212:215], v[136:139], v[248:251]
  v_mfma_f32_16x16x32_bf16 v[252:255], v[212:215], v[140:143], v[252:255]
  v_mfma_f32_16x16x32_bf16 v[224:227], v[216:219], v[144:147], v[224:227]
  v_mfma_f32_16x16x32_bf16 v[228:231], v[216:219], v[148:151], v[228:231]
  v_mfma_f32_16x16x32_bf16 v[232:235], v[216:219], v[152:155], v[232:235]
  v_mfma_f32_16x16x32_bf16 v[236:239], v[216:219], v[156:159], v[236:239]
  v_mfma_f32_16x16x32_bf16 v[240:243], v[216:219], v[160:163], v[240:243]
  v_mfma_f32_16x16x32_bf16 v[244:247], v[216:219], v[164:167], v[244:247]
  v_mfma_f32_16x16x32_bf16 v[248:251], v[216:219], v[168:171], v[248:251]
  v_mfma_f32_16x16x32_bf16 v[252:255], v[216:219], v[172:175], v[252:255]
  v_mfma_f32_16x16x32_bf16 v[224:227], v[220:223], v[176:179], v[224:227]
  v_mfma_f32_16x16x32_bf16 v[228:231], v[220:223], v[180:183], v[228:231]
  v_mfma_f32_16x16x32_bf16 v[232:235], v[220:223], v[184:187], v[232:235]
  v_mfma_f32_16x16x32_bf16 v[236:239], v[220:223], v[188:191], v[236:239]
  v_mfma_f32_16x16x32_bf16 v[240:243], v[220:223], v[192:195], v[240:243]
  v_mfma_f32_16x16x32_bf16 v[244:247], v[220:223], v[196:199], v[244:247]
  v_mfma_f32_16x16x32_bf16 v[248:251], v[220:223], v[200:203], v[248:251]
  v_mfma_f32_16x16x32_bf16 v[252:255], v[220:223], v[204:207], v[252:255]
  s_nop 0
  v_add_f32 v208, v225, v224 row_ror:8 row_mask:0xf bank_mask:0x3
  v_add_f32 v209, v229, v228 row_ror:8 row_mask:0xf bank_mask:0x3
  v_add_f32 v210, v233, v232 row_ror:8 row_mask:0xf bank_mask:0x3
  v_add_f32 v211, v237, v236 row_ror:8 row_mask:0xf bank_mask:0x3
  v_add_f32 v208, v240, v241 row_ror:8 row_mask:0xf bank_mask:0xc
  v_add_f32 v209, v244, v245 row_ror:8 row_mask:0xf bank_mask:0xc
  v_add_f32 v210, v248, v249 row_ror:8 row_mask:0xf bank_mask:0xc
  v_add_f32 v211, v252, v253 row_ror:8 row_mask:0xf bank_mask:0xc
  v_fma_f32 v208, -v11, v28, v208
  v_fma_f32 v209, -v11, v29, v209
  v_or_b32 v208, 1, v208
  v_fma_f32 v210, -v11, v30, v210
  v_fma_f32 v211, -v11, v31, v211
  v_or_b32 v210, 1, v210
  s_mov_b64 exec, 0xffff
  buffer_store_dwordx4 v[208:211], v20, s[4:7], s21 offen offset:0 sc1
  s_mov_b64 exec, -1
  s_setprio 0
  s_cmp_eq_u32 s3, 0
  s_cbranch_scc1 .fz_kernel_hb70
  s_barrier
  s_sub_u32 s3, s3, 1
.fz_kernel_hb70:
.fz_kernel_c_ng:
  s_cmp_eq_u32 s20, 0
  s_cbranch_scc1 .fz_kernel_c_ng1
  buffer_load_dwordx4 v[200:203], v14, s[4:7], s23 offen
  s_branch .fz_kernel_c_ng2
.fz_kernel_c_ng1:
  s_cmp_eq_u32 s75, 0
  s_cbranch_scc1 .fz_kernel_c_ng2
  buffer_load_dwordx2 v[240:241], v16, s[4:7], s14 offen
  buffer_load_dwordx2 v[242:243], v16, s[4:7], s15 offen
.fz_kernel_c_ng2:
  s_cmp_ge_u32 s17, 14
  s_cbranch_scc1 .fz_kernel_c_g1
  ds_read_b64_tr_b16 v[80:81], v17 offset:0
  ds_read_b64_tr_b16 v[82:83], v17 offset:1024
  ds_read_b64_tr_b16 v[84:85], v17 offset:32
  ds_read_b64_tr_b16 v[86:87], v17 offset:1056
  ds_read_b64_tr_b16 v[88:89], v18 offset:0
  ds_read_b64_tr_b16 v[90:91], v18 offset:1024
  ds_read_b64_tr_b16 v[92:93], v18 offset:32
  ds_read_b64_tr_b16 v[94:95], v18 offset:1056
  ds_read_b64_tr_b16 v[96:97], v17 offset:2048
  ds_read_b64_tr_b16 v[98:99], v17 offset:3072
  ds_read_b64_tr_b16 v[100:101], v17 offset:2080
  ds_read_b64_tr_b16 v[102:103], v17 offset:3104
  ds_read_b64_tr_b16 v[104:105], v18 offset:2048
  s_cmp_eq_u32 s3, 0
  s_cbranch_scc1 .fz_kernel_hb81
  s_barrier
  s_sub_u32 s3, s3, 1
.fz_kernel_hb81:
  ds_read_b64_tr_b16 v[106:107], v18 offset:3072
  ds_read_b64_tr_b16 v[108:109], v18 offset:2080
  ds_read_b64_tr_b16 v[110:111], v18 offset:3104
  s_waitcnt lgkmcnt(4)
  ds_read_b64_tr_b16 v[112:113], v17 offset:4096
  ds_read_b64_tr_b16 v[114:115], v17 offset:5120
  ds_read_b64_tr_b16 v[116:117], v17 offset:4128
  ds_read_b64_tr_b16 v[118:119], v17 offset:5152
  ds_read_b64_tr_b16 v[120:121], v18 offset:4096
  ds_read_b64_tr_b16 v[122:123], v18 offset:5120
  ds_read_b64_tr_b16 v[124:125], v18 offset:4128
  ds_read_b64_tr_b16 v[126:127], v18 offset:5152
  ds_read_b64_tr_b16 v[128:129], v17 offset:6144
  ds_read_b64_tr_b16 v[130:131], v17 offset:7168
  ds_read_b64_tr_b16 v[132:133], v17 offset:6176
  ds_read_b64_tr_b16 v[134:135], v17 offset:7200
  ds_read_b64_tr_b16 v[136:137], v18 offset:6144
  ds_read_b64_tr_b16 v[138:139], v18 offset:7168
  s_cmp_eq_u32 s3, 0
  s_cbranch_scc1 .fz_kernel_hb82
  s_barrier
  s_sub_u32 s3, s3, 1
.fz_kernel_hb82:
  ds_read_b64_tr_b16 v[140:141], v18 offset:6176
  ds_read_b64_tr_b16 v[142:143], v18 offset:7200
.fz_kernel_c_g1:
  v_fma_f32 v15, -v11, v11, v15
  v_rsq_f32 v15, abs(v15)
  s_nop 0
  v_mul_f32 v179, v11, v15
  v_mul_f32 v15, 0x44800000, v15
  v_sub_f32 v179, 0, v179
  v_add_f32 v178, 1.0, v15
  v_mul_f32 v177, -1.4426950408889634, v15
  v_mul_f32 v15, v15, v15
  v_mul_f32 v1, v1, v15
  s_cmp_eq_u32 s75, 0
  s_cbranch_scc1 .fz_kernel_c_d0
  s_cmp_lg_u32 s20, 0
  s_cbranch_scc1 .fz_kernel_c_t2
  s_waitcnt vmcnt(0)
  s_call_b64 s[68:69], .fz_kernel_c_coef
  v_mov_b32 v9, 159952
  v_mov_b32 v7, s79
  ds_write_b64 v26, v[252:253] offset:6400
  ds_write_b64 v26, v[254:255] offset:6912
  ds_write_b32 v9, v7
  s_waitcnt lgkmcnt(0)
.fz_kernel_c_t2:
  s_barrier
.fz_kernel_c_d0:
  s_cmp_ge_u32 s17, 14
  s_cbranch_scc1 .fz_kernel_c_nd
  s_lshl_b32 s21, s26, 12
  s_add_u32 s21, s21, s72
  s_add_u32 s21, s21, 40960
  s_mul_i32 s27, s18, 28
  s_add_u32 s27, s27, s26
  s_lshl_b32 s27, s27, 8
  s_add_u32 s27, s27, s72
  s_add_u32 s27, s27, 155648
  s_cmp_eq_u32 s3, 0
  s_cbranch_scc1 .fz_kernel_hb72
  s_barrier
  s_sub_u32 s3, s3, 1
.fz_kernel_hb72:
  buffer_load_dwordx4 v[144:147], v21, s[4:7], s21 offen offset:0 sc1
  buffer_load_dwordx4 v[148:151], v21, s[4:7], s21 offen offset:512 sc1
  buffer_load_dwordx4 v[152:155], v21, s[4:7], s21 offen offset:1024 sc1
  buffer_load_dwordx4 v[156:159], v21, s[4:7], s21 offen offset:1536 sc1
  s_mov_b32 s38, 0
.fz_kernel_c_gu:
  s_mov_b32 s46, 0
  s_call_b64 s[0:1], .fz_kernel_hw
  s_waitcnt vmcnt(0)
  v_min3_u32 v9, v144, v146, v148
  v_min3_u32 v9, v9, v150, v152
  v_min3_u32 v9, v9, v154, v156
  v_min_u32 v9, v9, v158
  v_cmp_eq_u32 vcc, 0, v9
  v_add_f32 v160, v144, v148
  v_add_f32 v161, v145, v149
  v_add_f32 v162, v146, v150
  v_add_f32 v163, v147, v151
  s_cbranch_vccnz .fz_kernel_c_gur
.fz_kernel_c_gud:
  v_add_f32 v152, v152, v156
  v_add_f32 v153, v153, v157
  v_add_f32 v154, v154, v158
  v_add_f32 v155, v155, v159
  v_add_f32 v144, v152, v160
  v_add_f32 v145, v153, v161
  v_add_f32 v146, v154, v162
  v_add_f32 v147, v155, v163
  s_nop 0
  v_permlane32_swap_b32 v144, v146
  v_permlane32_swap_b32 v145, v147
  v_mul_f32 v148, v144, v177
  v_mul_f32 v149, v145, v177
  v_exp_f32 v148, v148
  s_cmp_eq_u32 s3, 0
  s_cbranch_scc1 .fz_kernel_hb83
  s_barrier
  s_sub_u32 s3, s3, 1
.fz_kernel_hb83:
  v_exp_f32 v149, v149
  v_mul_f32 v144, v144, v146
  v_add_f32 v148, 1.0, v148
  v_add_f32 v149, 1.0, v149
  v_rcp_f32 v148, v148
  v_rcp_f32 v149, v149
  v_mul_f32 v145, v145, v147
  v_mul_f32 v144, v144, v148
  v_mul_f32 v145, v145, v149
  v_cvt_pk_bf16_f32 v144, v144, v145
  s_waitcnt lgkmcnt(0)
  s_setprio 2
  v_mov_b32 v160, v144 row_newbcast:0 row_mask:0xf bank_mask:0xf
  v_mov_b32 v161, v144 row_newbcast:1 row_mask:0xf bank_mask:0xf
  v_mov_b32 v162, v144 row_newbcast:2 row_mask:0xf bank_mask:0xf
  v_mov_b32 v163, v144 row_newbcast:3 row_mask:0xf bank_mask:0xf
  v_mov_b32 v164, v144 row_newbcast:4 row_mask:0xf bank_mask:0xf
  v_mov_b32 v165, v144 row_newbcast:5 row_mask:0xf bank_mask:0xf
  v_mov_b32 v166, v144 row_newbcast:6 row_mask:0xf bank_mask:0xf
  v_mov_b32 v167, v144 row_newbcast:7 row_mask:0xf bank_mask:0xf
  v_mfma_f32_16x16x32_bf16 v[208:211], v[80:83], v[160:163], 0
  v_mfma_f32_16x16x32_bf16 v[212:215], v[84:87], v[160:163], 0
  v_mfma_f32_16x16x32_bf16 v[216:219], v[88:91], v[160:163], 0
  v_mfma_f32_16x16x32_bf16 v[220:223], v[92:95], v[160:163], 0
  v_mov_b32 v168, v144 row_newbcast:8 row_mask:0xf bank_mask:0xf
  v_mov_b32 v169, v144 row_newbcast:9 row_mask:0xf bank_mask:0xf
  v_mov_b32 v170, v144 row_newbcast:10 row_mask:0xf bank_mask:0xf
  v_mov_b32 v171, v144 row_newbcast:11 row_mask:0xf bank_mask:0xf
  v_mfma_f32_16x16x32_bf16 v[208:211], v[96:99], v[164:167], v[208:211]
  v_mfma_f32_16x16x32_bf16 v[212:215], v[100:103], v[164:167], v[212:215]
  v_mfma_f32_16x16x32_bf16 v[216:219], v[104:107], v[164:167], v[216:219]
  v_mfma_f32_16x16x32_bf16 v[220:223], v[108:111], v[164:167], v[220:223]
  v_mov_b32 v172, v144 row_newbcast:12 row_mask:0xf bank_mask:0xf
  v_mov_b32 v173, v144 row_newbcast:13 row_mask:0xf bank_mask:0xf
  v_mov_b32 v174, v144 row_newbcast:14 row_mask:0xf bank_mask:0xf
  v_mov_b32 v175, v144 row_newbcast:15 row_mask:0xf bank_mask:0xf
  v_mfma_f32_16x16x32_bf16 v[208:211], v[112:115], v[168:171], v[208:211]
  v_mfma_f32_16x16x32_bf16 v[212:215], v[116:119], v[168:171], v[212:215]
  v_mfma_f32_16x16x32_bf16 v[216:219], v[120:123], v[168:171], v[216:219]
  v_mfma_f32_16x16x32_bf16 v[220:223], v[124:127], v[168:171], v[220:223]
  v_mfma_f32_16x16x32_bf16 v[208:211], v[128:131], v[172:175], v[208:211]
  v_mfma_f32_16x16x32_bf16 v[212:215], v[132:135], v[172:175], v[212:215]
  v_mfma_f32_16x16x32_bf16 v[216:219], v[136:139], v[172:175], v[216:219]
  v_mfma_f32_16x16x32_bf16 v[220:223], v[140:143], v[172:175], v[220:223]
  s_mov_b32 exec_lo, 0x20002
  s_mov_b32 exec_hi, 0x20002
  s_nop 3
  v_mov_b32 v208, v212
  v_mov_b32 v209, v213
  v_mov_b32 v210, v214
  v_mov_b32 v211, v215
  s_mov_b32 exec_lo, 0x40004
  s_mov_b32 exec_hi, 0x40004
  v_mov_b32 v208, v216
  v_mov_b32 v209, v217
  v_mov_b32 v210, v218
  v_mov_b32 v211, v219
  s_mov_b32 exec_lo, 0x80008
  s_mov_b32 exec_hi, 0x80008
  v_mov_b32 v208, v220
  v_mov_b32 v209, v221
  v_mov_b32 v210, v222
  v_mov_b32 v211, v223
  s_mov_b32 exec_lo, 0xf000f
  s_mov_b32 exec_hi, 0xf000f
  v_or_b32 v208, 1, v208
  v_or_b32 v210, 1, v210
  buffer_store_dwordx4 v[208:211], v19, s[4:7], s27 offen sc1
  s_mov_b64 exec, -1
  s_setprio 0
.fz_kernel_c_nd:
  s_cmp_eq_u32 s75, 0
  s_cbranch_scc1 .fz_kernel_c_m0
  s_lshl_b32 s21, s17, 1
  s_add_u32 s21, s21, s20
  s_cmp_lg_u32 s21, 31
  s_cbranch_scc1 .fz_kernel_fin
  s_branch .fz_kernel_c_pp
.fz_kernel_c_m0:
  s_cmp_eq_u32 s79, 0
  s_cselect_b32 s21, 2, 0
  s_add_u32 s3, s3, s21
.fz_kernel_c_pp:
  s_cmp_eq_u32 s3, 0
  s_cbranch_scc1 .fz_kernel_hb84
  s_barrier
  s_sub_u32 s3, s3, 1
.fz_kernel_hb84:
  v_and_b32 v10, 7, v2
  v_lshlrev_b32 v10, 8, v10
  v_lshl_add_u32 v10, v12, 5, v10
  s_mul_i32 s21, s70, 7168
  s_add_u32 s21, s21, s72
  s_add_u32 s21, s21, 155648
  s_add_u32 s22, s21, 4096
  s_mov_b32 s24, 0x0f0f0f0f
  s_mov_b32 s25, 0x0f0f0f0f
  s_lshl_b32 s27, s18, 4
  s_add_u32 s27, s27, s17
  s_lshl_b32 s27, s27, 10
  s_add_u32 s27, s27, 0x1c84000
  v_mov_b32 v168, 1
  v_mov_b32 v169, 1
  v_mov_b32 v170, 1
  v_mov_b32 v171, 1
  v_mov_b32 v172, 1
  v_mov_b32 v173, 1
  v_mov_b32 v174, 1
  v_mov_b32 v175, 1
  s_cmp_eq_u32 s3, 0
  s_cbranch_scc1 .fz_kernel_hb73
  s_barrier
  s_sub_u32 s3, s3, 1
.fz_kernel_hb73:
  s_cmp_eq_u32 s3, 0
  s_cbranch_scc1 .fz_kernel_hb74
  s_barrier
  s_sub_u32 s3, s3, 1
.fz_kernel_hb74:
  buffer_load_dwordx4 v[144:147], v10, s[4:7], s21 offen offset:0 sc1
  buffer_load_dwordx4 v[148:151], v10, s[4:7], s21 offen offset:16 sc1
  buffer_load_dwordx4 v[152:155], v10, s[4:7], s21 offen offset:2048 sc1
  buffer_load_dwordx4 v[156:159], v10, s[4:7], s21 offen offset:2064 sc1
  buffer_load_dwordx4 v[160:163], v10, s[4:7], s22 offen offset:0 sc1
  buffer_load_dwordx4 v[164:167], v10, s[4:7], s22 offen offset:16 sc1
  s_mov_b64 exec, s[24:25]
  buffer_load_dwordx4 v[168:171], v10, s[4:7], s22 offen offset:2048 sc1
  buffer_load_dwordx4 v[172:175], v10, s[4:7], s22 offen offset:2064 sc1
  s_mov_b64 exec, -1
  s_mov_b32 s38, 0
  s_cmp_eq_u32 s20, 0
  s_cbranch_scc1 .fz_kernel_c_pu
  s_waitcnt vmcnt(8)
  v_lshlrev_b32 v184, 16, v200
  v_and_b32 v185, 0xffff0000, v200
  v_lshlrev_b32 v186, 16, v201
  v_and_b32 v187, 0xffff0000, v201
  v_lshlrev_b32 v188, 16, v202
  v_and_b32 v189, 0xffff0000, v202
  v_lshlrev_b32 v190, 16, v203
  v_and_b32 v191, 0xffff0000, v203
  v_fma_f32 v184, v184, v178, v179
  v_fma_f32 v185, v185, v178, v179
  v_fma_f32 v186, v186, v178, v179
  v_fma_f32 v187, v187, v178, v179
  v_fma_f32 v188, v188, v178, v179
  v_fma_f32 v189, v189, v178, v179
  v_fma_f32 v190, v190, v178, v179
  v_fma_f32 v191, v191, v178, v179
.fz_kernel_c_pu:
  s_mov_b32 s46, 0
  s_call_b64 s[0:1], .fz_kernel_hw
  s_waitcnt vmcnt(0)
  s_cmp_eq_u32 s3, 0
  s_cbranch_scc1 .fz_kernel_hb85
  s_barrier
  s_sub_u32 s3, s3, 1
.fz_kernel_hb85:
  v_min3_u32 v9, v144, v146, v148
  v_min3_u32 v9, v9, v150, v152
  v_min3_u32 v9, v9, v154, v156
  v_min3_u32 v9, v9, v158, v160
  v_min3_u32 v9, v9, v162, v164
  v_min3_u32 v9, v9, v166, v168
  v_min3_u32 v9, v9, v170, v172
  v_min_u32 v9, v9, v174
  v_cmp_eq_u32 vcc, 0, v9
  v_add_f32 v236, v144, v152
  v_add_f32 v237, v145, v153
  v_add_f32 v238, v146, v154
  v_add_f32 v239, v147, v155
  s_cbranch_vccnz .fz_kernel_c_pur
.fz_kernel_c_pud:
  v_add_f32 v240, v148, v156
  v_add_f32 v241, v149, v157
  v_add_f32 v242, v150, v158
  v_add_f32 v243, v151, v159
  v_add_f32 v160, v160, v168
  v_add_f32 v161, v161, v169
  v_add_f32 v162, v162, v170
  v_add_f32 v163, v163, v171
  v_add_f32 v164, v164, v172
  v_add_f32 v165, v165, v173
  v_add_f32 v166, v166, v174
  v_add_f32 v167, v167, v175
  v_add_f32 v144, v236, v160
  v_add_f32 v145, v237, v161
  v_add_f32 v146, v238, v162
  v_add_f32 v147, v239, v163
  v_add_f32 v148, v240, v164
  v_add_f32 v149, v241, v165
  v_add_f32 v150, v242, v166
  v_add_f32 v151, v243, v167
  v_add_f32 v144, v144, v144 quad_perm:[1,0,3,2] row_mask:0xf bank_mask:0xf
  v_add_f32 v145, v145, v145 quad_perm:[1,0,3,2] row_mask:0xf bank_mask:0xf
  s_cmp_eq_u32 s3, 0
  s_cbranch_scc1 .fz_kernel_hb86
  s_barrier
  s_sub_u32 s3, s3, 1
.fz_kernel_hb86:
  v_add_f32 v146, v146, v146 quad_perm:[1,0,3,2] row_mask:0xf bank_mask:0xf
  v_add_f32 v147, v147, v147 quad_perm:[1,0,3,2] row_mask:0xf bank_mask:0xf
  v_add_f32 v148, v148, v148 quad_perm:[1,0,3,2] row_mask:0xf bank_mask:0xf
  v_add_f32 v149, v149, v149 quad_perm:[1,0,3,2] row_mask:0xf bank_mask:0xf
  v_add_f32 v150, v150, v150 quad_perm:[1,0,3,2] row_mask:0xf bank_mask:0xf
  v_add_f32 v151, v151, v151 quad_perm:[1,0,3,2] row_mask:0xf bank_mask:0xf
  v_add_f32 v144, v144, v144 quad_perm:[2,3,0,1] row_mask:0xf bank_mask:0xf
  v_add_f32 v145, v145, v145 quad_perm:[2,3,0,1] row_mask:0xf bank_mask:0xf
  v_add_f32 v146, v146, v146 quad_perm:[2,3,0,1] row_mask:0xf bank_mask:0xf
  v_add_f32 v147, v147, v147 quad_perm:[2,3,0,1] row_mask:0xf bank_mask:0xf
  v_add_f32 v148, v148, v148 quad_perm:[2,3,0,1] row_mask:0xf bank_mask:0xf
  v_add_f32 v149, v149, v149 quad_perm:[2,3,0,1] row_mask:0xf bank_mask:0xf
  v_add_f32 v150, v150, v150 quad_perm:[2,3,0,1] row_mask:0xf bank_mask:0xf
  v_add_f32 v151, v151, v151 quad_perm:[2,3,0,1] row_mask:0xf bank_mask:0xf
  v_add_f32 v144, v144, v144 row_half_mirror row_mask:0xf bank_mask:0xf
  v_add_f32 v145, v145, v145 row_half_mirror row_mask:0xf bank_mask:0xf
  v_add_f32 v146, v146, v146 row_half_mirror row_mask:0xf bank_mask:0xf
  v_add_f32 v147, v147, v147 row_half_mirror row_mask:0xf bank_mask:0xf
  v_add_f32 v148, v148, v148 row_half_mirror row_mask:0xf bank_mask:0xf
  v_add_f32 v149, v149, v149 row_half_mirror row_mask:0xf bank_mask:0xf
  v_add_f32 v150, v150, v150 row_half_mirror row_mask:0xf bank_mask:0xf
  v_add_f32 v151, v151, v151 row_half_mirror row_mask:0xf bank_mask:0xf
  v_mul_f32 v144, v144, v1
  v_mul_f32 v145, v145, v1
  v_mul_f32 v146, v146, v1
  v_mul_f32 v147, v147, v1
  v_mul_f32 v148, v148, v1
  v_mul_f32 v149, v149, v1
  v_mul_f32 v150, v150, v1
  v_mul_f32 v151, v151, v1
  v_cvt_pk_bf16_f32 v180, v144, v145
  v_cvt_pk_bf16_f32 v181, v146, v147
  v_cvt_pk_bf16_f32 v182, v148, v149
  v_cvt_pk_bf16_f32 v183, v150, v151
  s_or_b32 s21, s75, s71
  s_cbranch_scc1 .fz_kernel_c_w7
  s_mul_i32 s21, s20, 384
  s_add_u32 s21, s21, s27
  s_setprio 2
  v_mfma_f32_16x16x32_bf16 v[208:211], v[180:183], v[32:35], 0
  v_mov_b32 v232, v180 row_ror:8 row_mask:0xf bank_mask:0xf
  v_mfma_f32_16x16x32_bf16 v[212:215], v[180:183], v[36:39], 0
  v_mov_b32 v233, v181 row_ror:8 row_mask:0xf bank_mask:0xf
  v_mfma_f32_16x16x32_bf16 v[216:219], v[180:183], v[40:43], 0
  v_mov_b32 v234, v182 row_ror:8 row_mask:0xf bank_mask:0xf
  v_mfma_f32_16x16x32_bf16 v[220:223], v[180:183], v[44:47], 0
  v_mov_b32 v235, v183 row_ror:8 row_mask:0xf bank_mask:0xf
  v_mfma_f32_16x16x32_bf16 v[224:227], v[180:183], v[48:51], 0
  v_mfma_f32_16x16x32_bf16 v[228:231], v[180:183], v[52:55], 0
  v_mfma_f32_16x16x32_bf16 v[208:211], v[232:235], v[56:59], v[208:211]
  v_mfma_f32_16x16x32_bf16 v[212:215], v[232:235], v[60:63], v[212:215]
  v_mfma_f32_16x16x32_bf16 v[216:219], v[232:235], v[64:67], v[216:219]
  v_mfma_f32_16x16x32_bf16 v[220:223], v[232:235], v[68:71], v[220:223]
  v_mfma_f32_16x16x32_bf16 v[224:227], v[232:235], v[72:75], v[224:227]
  v_mfma_f32_16x16x32_bf16 v[228:231], v[232:235], v[76:79], v[228:231]
  s_nop 2
  v_or_b32 v208, 1, v208
  v_mov_b32 v209, v212
  v_or_b32 v210, 1, v216
  v_mov_b32 v211, v220
  s_mov_b64 exec, 0xffff
  buffer_store_dwordx4 v[208:211], v3, s[4:7], s21 offen offset:0 sc1
  v_or_b32 v224, 1, v224
  v_mov_b32 v225, v228
  buffer_store_dwordx2 v[224:225], v16, s[4:7], s21 offen offset:256 sc1
  s_mov_b64 exec, -1
  s_setprio 0
  s_cmp_lg_u32 s20, 0
  s_cbranch_scc1 .fz_kernel_c_w7
  s_cmp_eq_u32 s79, 0
  s_cbranch_scc1 .fz_kernel_c_no2
  s_cmp_eq_u32 s3, 0
  s_cbranch_scc1 .fz_kernel_hb87
  s_barrier
  s_sub_u32 s3, s3, 1
.fz_kernel_hb87:
  v_add_u32 v13, 155648, v3
  s_lshl_b32 s21, s18, 14
  s_add_u32 s21, s21, 0x1c84000
  s_add_u32 s22, s21, 4096
  s_add_u32 s23, s21, 8192
  s_add_u32 s24, s21, 12288
  v_rcp_f32 v144, v178
  v_lshlrev_b32 v146, 1, v2
  v_sub_u32 v146, s79, v146
  v_cmp_eq_u32 s[28:29], 1, v146
  v_cmp_eq_u32 s[30:31], 2, v146
  s_nop 0
  v_cndmask_b32 v148, 0, v144, s[28:29]
  v_cndmask_b32 v149, 0, v144, s[30:31]
  s_bfm_b64 exec, 49, 0
  s_mov_b32 s38, 0
.fz_kernel_c_pd:
  buffer_load_dwordx4 v[80:83], v3, s[4:7], s21 offen offset:0 sc1
  buffer_load_dwordx4 v[84:87], v3, s[4:7], s21 offen offset:1024 sc1
  buffer_load_dwordx4 v[88:91], v3, s[4:7], s21 offen offset:2048 sc1
  buffer_load_dwordx4 v[92:95], v3, s[4:7], s21 offen offset:3072 sc1
  buffer_load_dwordx4 v[96:99], v3, s[4:7], s22 offen offset:0 sc1
  buffer_load_dwordx4 v[100:103], v3, s[4:7], s22 offen offset:1024 sc1
  buffer_load_dwordx4 v[104:107], v3, s[4:7], s22 offen offset:2048 sc1
  buffer_load_dwordx4 v[108:111], v3, s[4:7], s22 offen offset:3072 sc1
  buffer_load_dwordx4 v[112:115], v3, s[4:7], s23 offen offset:0 sc1
  buffer_load_dwordx4 v[116:119], v3, s[4:7], s23 offen offset:1024 sc1
  buffer_load_dwordx4 v[120:123], v3, s[4:7], s23 offen offset:2048 sc1
  s_cmp_eq_u32 s3, 0
  s_cbranch_scc1 .fz_kernel_hb88
  s_barrier
  s_sub_u32 s3, s3, 1
.fz_kernel_hb88:
  buffer_load_dwordx4 v[124:127], v3, s[4:7], s23 offen offset:3072 sc1
  buffer_load_dwordx4 v[128:131], v3, s[4:7], s24 offen offset:0 sc1
  buffer_load_dwordx4 v[132:135], v3, s[4:7], s24 offen offset:1024 sc1
  buffer_load_dwordx4 v[136:139], v3, s[4:7], s24 offen offset:2048 sc1
  buffer_load_dwordx4 v[140:143], v3, s[4:7], s24 offen offset:3072 sc1
  s_add_u32 s38, s38, 1
  s_mov_b32 s46, 0
  s_call_b64 s[0:1], .fz_kernel_hw
  s_waitcnt vmcnt(0)
  v_min3_u32 v9, v80, v82, v84
  v_min3_u32 v9, v9, v86, v88
  v_min3_u32 v9, v9, v90, v92
  v_min3_u32 v9, v9, v94, v96
  v_min3_u32 v9, v9, v98, v100
  v_min3_u32 v9, v9, v102, v104
  v_min3_u32 v9, v9, v106, v108
  v_min3_u32 v9, v9, v110, v112
  v_min3_u32 v9, v9, v114, v116
  v_min3_u32 v9, v9, v118, v120
  v_min3_u32 v9, v9, v122, v124
  v_min3_u32 v9, v9, v126, v128
  v_min3_u32 v9, v9, v130, v132
  v_min3_u32 v9, v9, v134, v136
  v_min3_u32 v9, v9, v138, v140
  v_min_u32 v9, v9, v142
  v_cmp_eq_u32 vcc, 0, v9
  s_cbranch_vccz .fz_kernel_c_pdd
  s_cmp_lt_u32 s38, 131072
  s_cbranch_scc1 .fz_kernel_c_pd
.fz_kernel_c_pdd:
  v_add_f32 v80, v80, v112
  v_add_f32 v81, v81, v113
  v_add_f32 v82, v82, v114
  v_add_f32 v83, v83, v115
  v_add_f32 v84, v84, v116
  s_cmp_eq_u32 s3, 0
  s_cbranch_scc1 .fz_kernel_hb89
  s_barrier
  s_sub_u32 s3, s3, 1
.fz_kernel_hb89:
  v_add_f32 v85, v85, v117
  v_add_f32 v86, v86, v118
  v_add_f32 v87, v87, v119
  v_add_f32 v88, v88, v120
  v_add_f32 v89, v89, v121
  v_add_f32 v90, v90, v122
  v_add_f32 v91, v91, v123
  v_add_f32 v92, v92, v124
  v_add_f32 v93, v93, v125
  v_add_f32 v94, v94, v126
  v_add_f32 v95, v95, v127
  v_add_f32 v96, v96, v128
  v_add_f32 v97, v97, v129
  v_add_f32 v98, v98, v130
  v_add_f32 v99, v99, v131
  v_add_f32 v100, v100, v132
  v_add_f32 v101, v101, v133
  v_add_f32 v102, v102, v134
  v_add_f32 v103, v103, v135
  v_add_f32 v104, v104, v136
  v_add_f32 v105, v105, v137
  v_add_f32 v106, v106, v138
  v_add_f32 v107, v107, v139
  v_add_f32 v108, v108, v140
  v_add_f32 v109, v109, v141
  v_add_f32 v110, v110, v142
  v_add_f32 v111, v111, v143
  v_add_f32 v80, v80, v96
  v_add_f32 v81, v81, v97
  v_add_f32 v82, v82, v98
  v_add_f32 v83, v83, v99
  v_add_f32 v84, v84, v100
  v_add_f32 v85, v85, v101
  v_add_f32 v86, v86, v102
  v_add_f32 v87, v87, v103
  v_add_f32 v88, v88, v104
  s_cmp_eq_u32 s3, 0
  s_cbranch_scc1 .fz_kernel_hb90
  s_barrier
  s_sub_u32 s3, s3, 1
.fz_kernel_hb90:
  v_add_f32 v89, v89, v105
  v_add_f32 v90, v90, v106
  v_add_f32 v91, v91, v107
  v_add_f32 v92, v92, v108
  v_add_f32 v93, v93, v109
  v_add_f32 v94, v94, v110
  v_add_f32 v95, v95, v111
  v_add_f32 v80, v80, v88
  v_add_f32 v81, v81, v89
  v_add_f32 v82, v82, v90
  v_add_f32 v83, v83, v91
  v_add_f32 v84, v84, v92
  v_add_f32 v85, v85, v93
  v_add_f32 v86, v86, v94
  v_add_f32 v87, v87, v95
  v_add_f32 v80, v80, v84
  v_add_f32 v81, v81, v85
  v_add_f32 v82, v82, v86
  v_add_f32 v83, v83, v87
  s_mov_b64 exec, -1
  v_readlane_b32 s21, v80, 48
  v_readlane_b32 s22, v82, 48
  s_nop 0
  v_mul_f32 v144, s21, v23
  v_fma_f32 v145, s22, v23, v25
  v_fma_f32 v145, -v144, v144, v145
  v_rsq_f32 v145, abs(v145)
  v_sub_f32 v144, v179, v144
  v_mul_f32 v146, v145, v178
  v_mul_f32 v147, v145, v144
  s_lshl_b32 s21, s79, 2
  s_add_u32 s21, s21, 155644
  v_mov_b32 v9, s21
  ds_write_b32 v9, v146 offset:4608
  ds_write_b32 v9, v147 offset:5120
  s_cmp_eq_u32 s3, 0
  s_cbranch_scc1 .fz_kernel_hb91
  s_barrier
  s_sub_u32 s3, s3, 1
.fz_kernel_hb91:
  v_mov_b32 v9, 159952
  v_mov_b32 v7, s79
  ds_write_b32 v9, v7
  ds_write_b64 v26, v[148:149] offset:512
  s_mov_b32 exec_hi, 0xffff
  ds_write_b128 v13, v[80:83] offset:1536
  s_mov_b64 exec, -1
  s_waitcnt lgkmcnt(0)
  s_add_u32 s3, s3, 2
.fz_kernel_c_no2:
  s_branch .fz_kernel_q_he
.fz_kernel_c_w7:
  v_lshlrev_b32 v144, 16, v180
  v_and_b32 v145, 0xffff0000, v180
  v_lshlrev_b32 v146, 16, v181
  v_and_b32 v147, 0xffff0000, v181
  v_lshlrev_b32 v148, 16, v182
  v_and_b32 v149, 0xffff0000, v182
  v_lshlrev_b32 v150, 16, v183
  v_and_b32 v151, 0xffff0000, v183
  s_cmp_lg_u32 s71, 0
  s_cbranch_scc1 .fz_kernel_c_eu
  v_add_f32 v184, v184, v144
  v_add_f32 v185, v185, v145
  v_add_f32 v186, v186, v146
  v_add_f32 v187, v187, v147
  v_add_f32 v188, v188, v148
  v_add_f32 v189, v189, v149
  v_add_f32 v190, v190, v150
  v_add_f32 v191, v191, v151
  s_cmp_lg_u32 s75, 0
  s_cbranch_scc1 .fz_kernel_c_t3
  v_mul_f32 v152, v184, v184
  v_add_f32 v154, v184, v185
  v_fmac_f32 v152, v185, v185
  v_fmac_f32 v152, v186, v186
  v_add_f32 v154, v154, v186
  v_fmac_f32 v152, v187, v187
  v_add_f32 v154, v154, v187
  s_cmp_eq_u32 s3, 0
  s_cbranch_scc1 .fz_kernel_hb92
  s_barrier
  s_sub_u32 s3, s3, 1
.fz_kernel_hb92:
  v_fmac_f32 v152, v188, v188
  v_add_f32 v154, v154, v188
  v_fmac_f32 v152, v189, v189
  v_add_f32 v154, v154, v189
  v_fmac_f32 v152, v190, v190
  v_add_f32 v154, v154, v190
  v_fmac_f32 v152, v191, v191
  v_add_f32 v154, v154, v191
  v_lshrrev_b32 v9, 5, v2
  v_lshlrev_b32 v9, 3, v9
  v_permlane32_swap_b32 v154, v152
  v_add_f32 v154, v154, v152
  s_nop 1
  v_add_f32 v154, v154, v154 row_ror:8 row_mask:0xf bank_mask:0xf
  s_nop 1
  v_add_f32 v154, v154, v154 row_bcast:15 row_mask:0xa bank_mask:0xf
  v_or_b32 v154, 1, v154
  s_mov_b32 exec_lo, 0x10000
  s_mov_b32 exec_hi, 0x10000
  buffer_store_dword v154, v9, s[4:7], s27 offen offset:768 sc1
  s_mov_b64 exec, -1
  s_cmp_eq_u32 s79, 0
  s_cbranch_scc1 .fz_kernel_q_he
  s_add_u32 s3, s3, 2
  s_mov_b32 s71, 1
  s_mov_b32 s70, s18
  s_branch .fz_kernel_c_pp
.fz_kernel_c_eu:
  v_lshlrev_b32 v9, 5, v12
  v_add_u32 v9, 155648, v9
  s_mov_b32 exec_lo, 0x01010101
  s_mov_b32 exec_hi, 0x01010101
  ds_write_b128 v9, v[144:147] offset:7424
  ds_write_b128 v9, v[148:151] offset:7440
  s_mov_b64 exec, -1
  s_waitcnt lgkmcnt(0)
  s_branch .fz_kernel_q_he
.fz_kernel_c_t3:
  s_mov_b32 s28, s56
  s_mov_b32 s29, s57
  s_mov_b32 s30, 0x400000
  s_mov_b32 s31, 0x00020000
  v_cvt_pk_bf16_f32 v144, v184, v185
  v_cvt_pk_bf16_f32 v145, v186, v187
  v_cvt_pk_bf16_f32 v146, v188, v189
  v_cvt_pk_bf16_f32 v147, v190, v191
  s_cmp_eq_u32 s3, 0
  s_cbranch_scc1 .fz_kernel_hb93
  s_barrier
  s_sub_u32 s3, s3, 1
.fz_kernel_hb93:
  v_lshlrev_b32 v9, 4, v12
  s_lshl_b32 s21, s77, 11
  s_lshl_b32 s22, s18, 7
  s_add_u32 s21, s21, s22
  s_mov_b32 exec_lo, 0x01010101
  s_mov_b32 exec_hi, 0x01010101
  buffer_store_dwordx4 v[144:147], v9, s[28:31], s21 offen
  s_mov_b64 exec, -1
.fz_kernel_fin:
.fz_kernel_end:
  s_endpgm
.fz_kernel_pick:
  s_mov_b32 s33, 1
  s_cmp_eq_u32 s34, 0xffff
  s_cselect_b32 s35, 0x40000000, s35
  s_cbranch_scc1 .fz_kernel_pick_ret
  s_mov_b32 s38, 0
.fz_kernel_pick_l:
  ds_read_b32 v7, v6
  s_add_u32 s38, s38, 1
  s_waitcnt lgkmcnt(0)
  v_readfirstlane_b32 s36, v7
  s_andn2_b32 s33, s36, s34
  s_cbranch_scc1 .fz_kernel_pick_ret
  s_cmp_lt_u32 s38, 1048576
  s_cbranch_scc1 .fz_kernel_pick_l
  s_mov_b32 s36, 0xffff
  s_andn2_b32 s33, s36, s34
.fz_kernel_pick_ret:
  s_nop 4
  s_setpc_b64 s[68:69]
.fz_kernel_hw:
  s_mov_b32 s47, 0
.fz_kernel_hwl:
  s_getreg_b32 s100, hwreg(HW_REG_IB_STS)
  s_bfe_u32 s101, s100, 0x20016
  s_and_b32 s100, s100, 15
  s_lshl4_add_u32 s100, s101, s100
  s_cmp_le_u32 s100, s46
  s_cbranch_scc1 .fz_kernel_hwr
  s_sub_u32 s47, s47, 1
  s_cbranch_scc0 .fz_kernel_hwl
  s_cmp_eq_u32 s3, 0
  s_cbranch_scc1 .fz_kernel_hwr
  s_cmp_eq_u32 s3, 32
  s_cbranch_scc1 .fz_kernel_hwp
.fz_kernel_hwb:
  s_barrier
  s_sub_u32 s3, s3, 1
  s_mov_b32 s47, 2
  s_branch .fz_kernel_hwl
.fz_kernel_hwr:
  s_setpc_b64 s[0:1]
  .fz_kernel_hwp:
  ds_read_b32 v27, v6 offset:0x110
  s_mov_b32 s47, 0
  s_waitcnt lgkmcnt(0)
  v_readfirstlane_b32 s100, v27
  s_cmp_ge_u32 s100, 0x200
  s_cbranch_scc1 .fz_kernel_hwb
  s_branch .fz_kernel_hwl
.fz_kernel_q_cons2:
  s_setprio 0
  s_lshr_b32 s26, s16, 1
  s_lshl_b32 s28, s26, 13
  v_add_u32 v8, s28, v3
  v_add_u32 v9, 1024, v8
  v_mov_b32 v232, v20
  v_mov_b32 v233, v21
  v_mov_b32 v234, v22
  v_mov_b32 v235, v23
  v_mov_b32 v236, v24
  v_mov_b32 v237, v25
  v_mov_b32 v238, v26
  v_mov_b32 v239, v27
  v_mov_b32 v240, v28
  v_mov_b32 v241, v29
  v_mov_b32 v242, v30
  v_mov_b32 v243, v31
  v_mov_b32 v244, v32
  v_mov_b32 v245, v33
  v_mov_b32 v246, v34
  v_mov_b32 v247, v35
  s_branch .fz_kernel_q_cs
.fz_kernel_q_patch:
  s_mul_i32 s31, s27, 384
  s_add_u32 s31, s31, 155648
  v_and_b32 v73, 48, v2
  v_lshlrev_b32 v73, 2, v73
  v_add_u32 v73, s31, v73
  v_and_b32 v75, 15, v2
  v_lshlrev_b32 v75, 3, v75
  v_add_u32 v75, s31, v75
  ds_read_b32 v72, v14 offset:512
  ds_read_b32 v74, v14 offset:576
  ds_read_b32 v76, v14 offset:640
  ds_read_b32 v78, v14 offset:704
  ds_read_b128 v[80:83], v73 offset:1536
  ds_read_b128 v[84:87], v73 offset:1552
  ds_read_b128 v[88:91], v73 offset:1568
  ds_read_b128 v[92:95], v73 offset:1584
  s_waitcnt lgkmcnt(0)
  v_fmac_f32 v160, v82, v72
  v_fmac_f32 v161, v86, v72
  v_fmac_f32 v162, v90, v72
  v_fmac_f32 v163, v94, v72
  v_fmac_f32 v164, v82, v74
  v_fmac_f32 v165, v86, v74
  v_fmac_f32 v166, v90, v74
  v_fmac_f32 v167, v94, v74
  v_fmac_f32 v168, v82, v76
  v_fmac_f32 v169, v86, v76
  v_fmac_f32 v170, v90, v76
  v_fmac_f32 v171, v94, v76
  v_fmac_f32 v172, v82, v78
  v_fmac_f32 v173, v86, v78
  v_fmac_f32 v174, v90, v78
  v_fmac_f32 v175, v94, v78
  v_fmac_f32 v176, v83, v72
  v_fmac_f32 v177, v87, v72
  v_fmac_f32 v178, v91, v72
  v_fmac_f32 v179, v95, v72
  v_fmac_f32 v180, v83, v74
  v_fmac_f32 v181, v87, v74
  v_fmac_f32 v182, v91, v74
  v_fmac_f32 v183, v95, v74
  v_fmac_f32 v184, v83, v76
  v_fmac_f32 v185, v87, v76
  v_fmac_f32 v186, v91, v76
  v_fmac_f32 v187, v95, v76
  v_fmac_f32 v188, v83, v78
  v_fmac_f32 v189, v87, v78
  v_fmac_f32 v190, v91, v78
  v_fmac_f32 v191, v95, v78
  v_fmac_f32 v128, v80, v72
  v_fmac_f32 v129, v84, v72
  v_fmac_f32 v130, v88, v72
  v_fmac_f32 v131, v92, v72
  v_fmac_f32 v132, v80, v74
  v_fmac_f32 v133, v84, v74
  v_fmac_f32 v134, v88, v74
  v_fmac_f32 v135, v92, v74
  v_fmac_f32 v136, v80, v76
  v_fmac_f32 v137, v84, v76
  v_fmac_f32 v138, v88, v76
  v_fmac_f32 v139, v92, v76
  v_fmac_f32 v140, v80, v78
  v_fmac_f32 v141, v84, v78
  v_fmac_f32 v142, v88, v78
  v_fmac_f32 v143, v92, v78
  v_fmac_f32 v144, v81, v72
  v_fmac_f32 v145, v85, v72
  v_fmac_f32 v146, v89, v72
  v_fmac_f32 v147, v93, v72
  v_fmac_f32 v148, v81, v74
  v_fmac_f32 v149, v85, v74
  v_fmac_f32 v150, v89, v74
  v_fmac_f32 v151, v93, v74
  v_fmac_f32 v152, v81, v76
  v_fmac_f32 v153, v85, v76
  v_fmac_f32 v154, v89, v76
  v_fmac_f32 v155, v93, v76
  v_fmac_f32 v156, v81, v78
  v_fmac_f32 v157, v85, v78
  v_fmac_f32 v158, v89, v78
  v_fmac_f32 v159, v93, v78
  ds_read_b128 v[80:83], v15 offset:512
  ds_read_b128 v[84:87], v15 offset:576
  ds_read_b128 v[88:91], v15 offset:640
  ds_read_b128 v[92:95], v15 offset:704
  ds_read_b64 v[72:73], v75 offset:1792
  s_waitcnt lgkmcnt(0)
  v_fmac_f32 v192, v80, v72
  v_fmac_f32 v193, v81, v72
  v_fmac_f32 v194, v82, v72
  v_fmac_f32 v195, v83, v72
  v_fmac_f32 v196, v84, v72
  v_fmac_f32 v197, v85, v72
  v_fmac_f32 v198, v86, v72
  v_fmac_f32 v199, v87, v72
  v_fmac_f32 v200, v88, v72
  v_fmac_f32 v201, v89, v72
  v_fmac_f32 v202, v90, v72
  v_fmac_f32 v203, v91, v72
  v_fmac_f32 v204, v92, v72
  v_fmac_f32 v205, v93, v72
  v_fmac_f32 v206, v94, v72
  v_fmac_f32 v207, v95, v72
  v_fmac_f32 v208, v80, v73
  v_fmac_f32 v209, v81, v73
  v_fmac_f32 v210, v82, v73
  v_fmac_f32 v211, v83, v73
  v_fmac_f32 v212, v84, v73
  v_fmac_f32 v213, v85, v73
  v_fmac_f32 v214, v86, v73
  v_fmac_f32 v215, v87, v73
  v_fmac_f32 v216, v88, v73
  v_fmac_f32 v217, v89, v73
  v_fmac_f32 v218, v90, v73
  v_fmac_f32 v219, v91, v73
  v_fmac_f32 v220, v92, v73
  v_fmac_f32 v221, v93, v73
  v_fmac_f32 v222, v94, v73
  v_fmac_f32 v223, v95, v73
  s_branch .fz_kernel_q_pback
.fz_kernel_q_prod2:
  s_mov_b64 s[8:9], s[4:5]
  s_mov_b64 s[10:11], s[6:7]
  s_mov_b64 s[12:13], s[42:43]
  s_lshl_b32 s35, s17, 6
  s_and_b32 s31, s16, 1
  s_add_u32 s35, s35, s31
  s_lshl_b32 s35, s35, 12
  s_add_u32 s35, s35, s73
  s_lshr_b32 s33, s17, 3
  s_add_u32 s29, s18, s33
  s_lshl1_add_u32 s29, s17, s29
  s_and_b32 s29, s29, 15
  s_mov_b32 s22, 16384
  s_mov_b32 s23, 8192
  s_mov_b32 s36, 0
  s_add_u32 s37, s19, s74
  s_add_u32 s37, s37, 8
  v_mov_b32 v40, v3
  v_mov_b32 v41, v3
  v_mov_b32 v42, v3
  v_mov_b32 v43, v3
  s_branch .fz_kernel_q_pc
.fz_kernel_xok1w:
  s_call_b64 s[68:69], .fz_kernel_q_xw
  s_branch .fz_kernel_xok1
.fz_kernel_xok2w:
  s_call_b64 s[68:69], .fz_kernel_q_xw
  s_branch .fz_kernel_xok2
.fz_kernel_q_xw:
  s_mov_b64 exec, 1
  s_mov_b32 s38, 0
.fz_kernel_q_xwl:
  ds_read_b32 v11, v6 offset:0x114
  s_add_u32 s38, s38, 1
  s_waitcnt lgkmcnt(0)
  v_readfirstlane_b32 s36, v11
  s_bitcmp1_b32 s36, s24
  s_cbranch_scc1 .fz_kernel_q_xwd
  s_cmp_lt_u32 s38, 1048576
  s_cbranch_scc1 .fz_kernel_q_xwl
  s_mov_b32 s36, -1
.fz_kernel_q_xwd:
  s_mov_b64 exec, -1
  s_nop 4
  s_setpc_b64 s[68:69]
.fz_kernel_xok3w:
  s_call_b64 s[68:69], .fz_kernel_q_xw
  s_branch .fz_kernel_xok3
.fz_kernel_lz20a:
  v_lshlrev_b32 v16, 3, v2
  buffer_atomic_and_x2 v[12:13], v16, s[4:7], s36 offen offset:0 sc1
  buffer_atomic_and_x2 v[12:13], v16, s[4:7], s36 offen offset:512 sc1
  buffer_atomic_and_x2 v[12:13], v16, s[4:7], s36 offen offset:1024 sc1
  buffer_atomic_and_x2 v[12:13], v16, s[4:7], s36 offen offset:1536 sc1
  buffer_atomic_and_x2 v[12:13], v16, s[4:7], s36 offen offset:2048 sc1
  buffer_atomic_and_x2 v[12:13], v16, s[4:7], s36 offen offset:2560 sc1
  buffer_atomic_and_x2 v[12:13], v16, s[4:7], s36 offen offset:3072 sc1
  buffer_atomic_and_x2 v[12:13], v16, s[4:7], s36 offen offset:3584 sc1
  s_branch .fz_kernel_lz20
.fz_kernel_a_pick:
  s_cmp_eq_u32 s34, 0xffff
  s_cbranch_scc1 .fz_kernel_a_picke
  s_mov_b32 s38, 0
.fz_kernel_a_pickl:
  ds_read_b32 v7, v6
  s_add_u32 s38, s38, 1
  s_waitcnt lgkmcnt(0)
  v_readfirstlane_b32 s33, v7
  s_cmp_lt_u32 s38, 1048576
  s_cselect_b32 s33, s33, 0xffff
  s_andn2_b32 s36, s33, s34
  s_cbranch_scc0 .fz_kernel_a_pickl
  s_or_b32 s34, s34, s33
  s_ff1_i32_b32 s33, s36
  s_bitset0_b32 s36, s33
  s_lshl_b32 s33, s33, 14
  s_add_u32 s30, s33, s35
  s_setpc_b64 s[68:69]
.fz_kernel_a_picke:
  s_mov_b32 s30, 0x40000000
  ds_write_b32 v6, v5 offset:0x104
  s_setpc_b64 s[68:69]
.fz_kernel_pk26c:
  s_call_b64 s[68:69], .fz_kernel_a_pick
  s_branch .fz_kernel_pk26
.fz_kernel_pk27c:
  s_call_b64 s[68:69], .fz_kernel_a_pick
  s_branch .fz_kernel_pk27
.fz_kernel_pk28c:
  s_call_b64 s[68:69], .fz_kernel_a_pick
  s_branch .fz_kernel_pk28
.fz_kernel_pk31c:
  s_call_b64 s[68:69], .fz_kernel_a_pick
  s_branch .fz_kernel_pk31
.fz_kernel_pk32c:
  s_call_b64 s[68:69], .fz_kernel_a_pick
  s_branch .fz_kernel_pk32
.fz_kernel_a_slow:
  s_cmp_lg_u32 s73, 0
  s_cbranch_scc1 .fz_kernel_a_ok
  s_mov_b32 s73, 1
  s_and_b32 s39, s16, 1
  v_mov_b32 v16, v32
  v_mov_b32 v17, v33
  v_mov_b32 v18, v34
  v_mov_b32 v19, v35
  v_mov_b32 v20, v36
  v_mov_b32 v21, v37
  v_mov_b32 v22, v38
  v_mov_b32 v23, v39
  s_call_b64 s[68:69], .fz_kernel_a_sl
  v_mov_b32 v176, v144
  v_mov_b32 v177, v145
  v_mov_b32 v178, v146
  v_mov_b32 v179, v147
  v_mov_b32 v180, v148
  v_mov_b32 v181, v149
  v_mov_b32 v182, v150
  v_mov_b32 v183, v151
  v_mov_b32 v184, v152
  v_mov_b32 v185, v153
  v_mov_b32 v186, v154
  v_mov_b32 v187, v155
  v_mov_b32 v188, v156
  v_mov_b32 v189, v157
  v_mov_b32 v190, v158
  v_mov_b32 v191, v159
  v_mov_b32 v24, v25
  v_mov_b32 v16, v40
  v_mov_b32 v17, v41
  v_mov_b32 v18, v42
  v_mov_b32 v19, v43
  v_mov_b32 v20, v44
  v_mov_b32 v21, v45
  v_mov_b32 v22, v46
  v_mov_b32 v23, v47
  s_call_b64 s[68:69], .fz_kernel_a_sl
  v_mov_b32 v192, v144
  v_mov_b32 v193, v145
  v_mov_b32 v194, v146
  v_mov_b32 v195, v147
  v_mov_b32 v196, v148
  v_mov_b32 v197, v149
  v_mov_b32 v198, v150
  v_mov_b32 v199, v151
  v_mov_b32 v200, v152
  v_mov_b32 v201, v153
  v_mov_b32 v202, v154
  v_mov_b32 v203, v155
  v_mov_b32 v204, v156
  v_mov_b32 v205, v157
  v_mov_b32 v206, v158
  v_mov_b32 v207, v159
  v_rcp_f32 v26, v24
  v_cmp_le_f32 vcc, s24, v24
  s_and_b64 s[36:37], s[36:37], vcc
  v_cmp_ge_f32 vcc, s25, v24
  s_and_b64 s[36:37], s[36:37], vcc
  v_pk_mul_f32 v[176:177], v[176:177], v[26:27] op_sel_hi:[1,0]
  v_pk_mul_f32 v[178:179], v[178:179], v[26:27] op_sel_hi:[1,0]
  v_pk_mul_f32 v[180:181], v[180:181], v[26:27] op_sel_hi:[1,0]
  v_pk_mul_f32 v[182:183], v[182:183], v[26:27] op_sel_hi:[1,0]
  v_cvt_pk_bf16_f32 v48, v176, v177
  v_cvt_pk_bf16_f32 v49, v178, v179
  v_cvt_pk_bf16_f32 v50, v180, v181
  v_cvt_pk_bf16_f32 v51, v182, v183
  buffer_store_dwordx4 v[48:51], v3, s[4:7], s28 offen offset:0 sc1
  v_pk_mul_f32 v[184:185], v[184:185], v[26:27] op_sel_hi:[1,0]
  v_pk_mul_f32 v[186:187], v[186:187], v[26:27] op_sel_hi:[1,0]
  v_pk_mul_f32 v[188:189], v[188:189], v[26:27] op_sel_hi:[1,0]
  v_pk_mul_f32 v[190:191], v[190:191], v[26:27] op_sel_hi:[1,0]
  v_cvt_pk_bf16_f32 v52, v184, v185
  v_cvt_pk_bf16_f32 v53, v186, v187
  v_cvt_pk_bf16_f32 v54, v188, v189
  v_cvt_pk_bf16_f32 v55, v190, v191
  buffer_store_dwordx4 v[52:55], v3, s[4:7], s28 offen offset:1024 sc1
  s_branch .fz_kernel_a_fin
.fz_kernel_a_sl:
  s_waitcnt vmcnt(0)
  s_lshl_b32 s23, s18, 1
  s_add_u32 s23, s23, s39
  s_lshl_b32 s23, s23, 18
  s_add_u32 s23, s23, s63
  s_mov_b32 s30, s23
  s_mov_b32 s33, 64
  v_mov_b32 v27, 0xff800000
.fz_kernel_a_s1:
  buffer_load_dwordx4 v[80:83], v3, s[4:7], s30 offen offset:0
  buffer_load_dwordx4 v[84:87], v3, s[4:7], s30 offen offset:1024
  s_waitcnt vmcnt(0)
  v_mfma_f32_32x32x16_bf16 v[48:63], v[80:83], v[16:19], 0
  v_mfma_f32_32x32x16_bf16 v[48:63], v[84:87], v[20:23], v[48:63]
  s_nop 11
  v_max3_f32 v27, v27, v48, v49
  v_max3_f32 v27, v27, v50, v51
  v_max3_f32 v27, v27, v52, v53
  v_max3_f32 v27, v27, v54, v55
  v_max3_f32 v27, v27, v56, v57
  v_max3_f32 v27, v27, v58, v59
  v_max3_f32 v27, v27, v60, v61
  v_max3_f32 v27, v27, v62, v63
  s_add_u32 s30, s30, 4096
  s_sub_u32 s33, s33, 1
  s_cmp_lg_u32 s33, 0
  s_cbranch_scc1 .fz_kernel_a_s1
  v_mov_b32 v29, v27
  s_nop 1
  v_permlane32_swap_b32 v29, v27
  v_max_f32 v27, v27, v29
  v_sub_f32 v27, 0, v27
  v_mov_b32 v64, v27
  v_mov_b32 v144, 0
  v_mov_b32 v65, v27
  v_mov_b32 v145, 0
  v_mov_b32 v66, v27
  v_mov_b32 v146, 0
  v_mov_b32 v67, v27
  v_mov_b32 v147, 0
  v_mov_b32 v68, v27
  v_mov_b32 v148, 0
  v_mov_b32 v69, v27
  v_mov_b32 v149, 0
  v_mov_b32 v70, v27
  v_mov_b32 v150, 0
  v_mov_b32 v71, v27
  v_mov_b32 v151, 0
  v_mov_b32 v72, v27
  v_mov_b32 v152, 0
  v_mov_b32 v73, v27
  v_mov_b32 v153, 0
  v_mov_b32 v74, v27
  v_mov_b32 v154, 0
  v_mov_b32 v75, v27
  v_mov_b32 v155, 0
  v_mov_b32 v76, v27
  v_mov_b32 v156, 0
  v_mov_b32 v77, v27
  v_mov_b32 v157, 0
  v_mov_b32 v78, v27
  v_mov_b32 v158, 0
  v_mov_b32 v79, v27
  v_mov_b32 v159, 0
  v_mov_b32 v208, 0
  v_mov_b32 v209, 0
  v_mov_b32 v210, 0
  v_mov_b32 v211, 0
  s_mov_b32 s30, s23
  s_mov_b32 s33, 64
.fz_kernel_a_s2:
  buffer_load_dwordx4 v[80:83], v3, s[4:7], s30 offen offset:0
  buffer_load_dwordx4 v[84:87], v3, s[4:7], s30 offen offset:1024
  buffer_load_dwordx4 v[88:91], v3, s[4:7], s30 offen offset:2048
  buffer_load_dwordx4 v[92:95], v3, s[4:7], s30 offen offset:3072
  s_waitcnt vmcnt(0)
  v_mfma_f32_32x32x16_bf16 v[48:63], v[80:83], v[16:19], v[64:79]
  v_mfma_f32_32x32x16_bf16 v[48:63], v[84:87], v[20:23], v[48:63]
  s_nop 11
  v_exp_f32 v48, v48
  v_exp_f32 v49, v49
  v_exp_f32 v50, v50
  v_exp_f32 v51, v51
  v_exp_f32 v52, v52
  v_exp_f32 v53, v53
  v_exp_f32 v54, v54
  v_exp_f32 v55, v55
  v_exp_f32 v56, v56
  v_exp_f32 v57, v57
  v_exp_f32 v58, v58
  v_exp_f32 v59, v59
  v_exp_f32 v60, v60
  v_exp_f32 v61, v61
  v_exp_f32 v62, v62
  v_exp_f32 v63, v63
  v_cvt_pk_bf16_f32 v224, v48, v49
  v_cvt_pk_bf16_f32 v225, v50, v51
  v_cvt_pk_bf16_f32 v226, v52, v53
  v_cvt_pk_bf16_f32 v227, v54, v55
  v_cvt_pk_bf16_f32 v228, v56, v57
  v_cvt_pk_bf16_f32 v229, v58, v59
  v_cvt_pk_bf16_f32 v230, v60, v61
  v_cvt_pk_bf16_f32 v231, v62, v63
  v_mfma_f32_32x32x16_bf16 v[144:159], v[88:91], v[224:227], v[144:159]
  s_nop 0
  v_mfma_f32_32x32x16_bf16 v[144:159], v[92:95], v[228:231], v[144:159]
  v_smfmac_f32_16x16x64_bf16 v[208:211], v[12:15], v[224:231], v11
  s_add_u32 s30, s30, 4096
  s_sub_u32 s33, s33, 1
  s_cmp_lg_u32 s33, 0
  s_cbranch_scc1 .fz_kernel_a_s2
  s_nop 7
  v_add_f32 v208, v208, v210
  v_add_f32 v209, v209, v211
  v_cndmask_b32 v25, v208, v209, s[26:27]
  s_nop 7
  s_setpc_b64 s[68:69]
.fz_kernel_serv:
  s_setprio 3
  s_mov_b32 s24, s44
  s_mov_b32 s25, s45
  s_mov_b32 s26, 0x200000
  s_mov_b32 s27, 0x00020000
  v_lshrrev_b32 v8, 3, v2
  v_and_b32 v9, 7, v2
  v_bfe_u32 v10, v2, 4, 1
  v_lshlrev_b32 v10, 2, v10
  v_xor_b32 v9, v9, v10
  v_lshlrev_b32 v9, 4, v9
  v_lshl_add_u32 v10, v8, 11, v9
  s_cmp_eq_u32 s16, 5
  s_cbranch_scc1 .fz_kernel_sv1
  s_barrier
  v_lshlrev_b32 v7, 7, v2
  s_lshl_b32 s31, s18, 11
  s_lshl_b32 s33, 1, s17
  s_add_u32 s31, s31, s67
  s_add_u32 s31, s31, 0x1800000
  v_mov_b32 v8, s33
  s_mov_b64 exec, 0xffff
  s_mov_b32 s38, 0
.fz_kernel_cw33:
  s_sleep 1
  ds_read_u8 v9, v6 offset:256
  s_add_u32 s38, s38, 1
  s_waitcnt lgkmcnt(0)
  v_cmp_gt_u32 vcc, 4, v9
  s_cbranch_vccz .fz_kernel_cw33d
  s_cmp_lt_u32 s38, 8388608
  s_cbranch_scc1 .fz_kernel_cw33
.fz_kernel_cw33d:
  buffer_atomic_or v8, v7, s[4:7], s31 offen sc1
  s_mov_b64 exec, -1
  s_setprio 0
  s_mov_b32 s38, 0
.fz_kernel_kw34:
  s_sleep 2
  ds_read_b32 v7, v6 offset:0
  s_add_u32 s38, s38, 1
  s_waitcnt lgkmcnt(0)
  v_readfirstlane_b32 s31, v7
  s_bcnt1_i32_b32 s31, s31
  s_cmp_ge_u32 s31, 16
  s_cbranch_scc1 .fz_kernel_kw34d
  s_cmp_lt_u32 s38, 1048576
  s_cbranch_scc1 .fz_kernel_kw34
.fz_kernel_kw34d:
  s_branch .fz_kernel_sv2
.fz_kernel_sv1:
  s_add_u32 s37, s19, s67
  s_mov_b64 exec, 1
  buffer_load_dword v7, v4, s[4:7], s37 offen sc1
  s_waitcnt vmcnt(0)
  ds_or_b32 v6, v7
  buffer_load_dword v9, v4, s[4:7], s37 offen sc1
  s_barrier
  s_waitcnt vmcnt(0)
  ds_or_b32 v6, v9
  s_add_u32 s37, s19, s67
  s_mov_b64 exec, 1
  s_mov_b32 s38, 0
.fz_kernel_po35:
  buffer_load_dword v7, v4, s[4:7], s37 offen offset:0 sc1
  s_add_u32 s38, s38, 1
  s_waitcnt vmcnt(0)
  ds_or_b32 v6, v7 offset:0
  v_cmp_ne_u32 vcc, 0xffff, v7
  s_cbranch_vccz .fz_kernel_po35d
  s_cmp_lt_u32 s38, 131072
  s_cbranch_scc1 .fz_kernel_po35
.fz_kernel_po35d:
  s_mov_b64 exec, -1
  s_setprio 0
  s_mov_b32 s38, 0
.fz_kernel_kw36:
  s_sleep 2
  ds_read_b32 v7, v6 offset:0
  s_add_u32 s38, s38, 1
  s_waitcnt lgkmcnt(0)
  v_readfirstlane_b32 s31, v7
  s_bcnt1_i32_b32 s31, s31
  s_cmp_ge_u32 s31, 16
  s_cbranch_scc1 .fz_kernel_kw36d
  s_cmp_lt_u32 s38, 1048576
  s_cbranch_scc1 .fz_kernel_kw36
.fz_kernel_kw36d:
.fz_kernel_sv2:
  s_and_b32 s30, s16, 1
  s_lshl_b32 s30, s30, 16
  s_add_u32 s32, s30, 65536
  s_lshl_b32 s31, s18, 7
  v_add_u32 v10, s31, v10
.fz_kernel_sv3:
  s_mov_b32 m0, s30
  s_lshl_b32 s31, s30, 4
  s_add_u32 s30, s30, 1024
  buffer_load_dwordx4 v10, s[24:27], s31 offen  lds
  s_cmp_lg_u32 s30, s32
  s_waitcnt vmcnt(3)
  s_cbranch_scc1 .fz_kernel_sv3
  s_cmp_lg_u32 s62, 0
  s_cbranch_scc1 .fz_kernel_wt37
  s_mov_b32 s12, s42
  s_mov_b32 s13, s43
  s_mov_b32 s14, 0x600000
  s_mov_b32 s15, 0x00020000
  s_and_b32 s30, s16, 1
  s_lshl1_add_u32 s30, s17, s30
  s_and_b32 s30, s30, 15
  s_mul_i32 s30, s30, 393216
  s_lshl_b32 s31, s18, 7
  s_add_u32 s30, s30, s31
  v_mul_u32_u24 v11, 6144, v2
  buffer_load_dword v1, v11, s[12:15], s30 offen
  s_add_u32 s30, s30, 2048
  s_waitcnt vmcnt(0)
  buffer_load_dword v1, v11, s[12:15], s30 offen
  s_add_u32 s30, s30, 2048
  s_waitcnt vmcnt(0)
  buffer_load_dword v1, v11, s[12:15], s30 offen
  s_add_u32 s30, s30, 2048
  s_waitcnt vmcnt(0)
.fz_kernel_wt37:
  s_cmp_lg_u32 s16, 4
  s_cbranch_scc1 .fz_kernel_ct38e
  s_getpc_b64 s[0:1]
.fz_kernel_ct38:
  s_sub_u32 s0, s0, .fz_kernel_ct38-fz_kernel
  s_subb_u32 s1, s1, 0
  s_lshr_b32 s31, s2, 3
  s_mulk_i32 s31, 0x500
  v_lshl_add_u32 v1, v2, 7, s31
  v_min_u32 v1, .fz_kernel_last-fz_kernel, v1
  s_mov_b64 exec, 0x3ff
  global_load_dword v1, v1, s[0:1]
  s_mov_b64 exec, -1
.fz_kernel_ct38e:
  s_waitcnt vmcnt(0)
  s_cmp_lg_u32 s16, 5
  s_cbranch_scc1 .fz_kernel_sv35
  s_mov_b64 exec, 1
  s_mov_b32 s38, 0
.fz_kernel_sv34:
  s_sleep 4
  buffer_load_dword v7, v4, s[4:7], s37 offen offset:4 sc1
  ds_read_b32 v8, v6 offset:0x104
  s_add_u32 s38, s38, 1
  s_waitcnt vmcnt(0) lgkmcnt(0)
  ds_or_b32 v6, v7 offset:8
  v_cmp_ne_u32 vcc, 0, v8
  s_cbranch_vccnz .fz_kernel_sv35
  s_cmp_lt_u32 s38, 131072
  s_cbranch_scc1 .fz_kernel_sv34
.fz_kernel_sv35:
  s_mov_b64 exec, -1
  s_setprio 3
  s_barrier
  s_cmp_eq_u32 s16, 5
  s_cbranch_scc1 .fz_kernel_sv4
  v_lshlrev_b32 v7, 11, v2
  s_lshl_b32 s31, s17, 7
  s_lshl_b32 s33, 1, s18
  s_add_u32 s31, s31, s67
  s_add_u32 s31, s31, 0x1800004
  v_mov_b32 v8, s33
  s_mov_b64 exec, 0xffff
  s_mov_b32 s38, 0
.fz_kernel_cw39:
  s_sleep 1
  ds_read_u8 v9, v6 offset:264
  s_add_u32 s38, s38, 1
  s_waitcnt lgkmcnt(0)
  v_cmp_gt_u32 vcc, 4, v9
  s_cbranch_vccz .fz_kernel_cw39d
  s_cmp_lt_u32 s38, 8388608
  s_cbranch_scc1 .fz_kernel_cw39
.fz_kernel_cw39d:
  buffer_atomic_or v8, v7, s[4:7], s31 offen sc1
  s_mov_b64 exec, -1
  s_mov_b64 exec, 1
  ds_or_b32 v6, v8 offset:8
  s_mov_b64 exec, -1
  s_branch .fz_kernel_sv5
.fz_kernel_sv4:
  s_add_u32 s37, s19, s67
  s_mov_b64 exec, 1
  s_mov_b32 s38, 0
.fz_kernel_po40:
  buffer_load_dword v7, v4, s[4:7], s37 offen offset:4 sc1
  s_add_u32 s38, s38, 1
  s_waitcnt vmcnt(0)
  ds_or_b32 v6, v7 offset:8
  v_cmp_ne_u32 vcc, 0xffff, v7
  s_cbranch_vccz .fz_kernel_po40d
  s_cmp_lt_u32 s38, 131072
  s_cbranch_scc1 .fz_kernel_po40
.fz_kernel_po40d:
  s_mov_b64 exec, -1
.fz_kernel_sv5:
  s_mov_b32 s72, s66
  s_mov_b32 s73, s65
  s_mov_b32 s74, s67
  s_mov_b32 s75, s62
  s_cmp_lg_u32 s62, 0
  s_cbranch_scc1 .fz_kernel_w_lt
  s_mov_b32 s62, 1
  s_mov_b32 s63, 0x2000000
  s_mov_b32 s64, 0x2800000
  s_mov_b32 s65, 0x1400000
  s_mov_b32 s66, 0x1c42000
  s_mov_b32 s67, 12
  s_mov_b32 s71, 159776
  v_mov_b32 v6, 159832
  s_branch .fz_kernel_q_prod2
.fz_kernel_w_lt:
  s_barrier
  s_barrier
  s_branch .fz_kernel_fin
.fz_kernel_pk41c:
  s_call_b64 s[68:69], .fz_kernel_pick
  s_branch .fz_kernel_pk41
.fz_kernel_pk42c:
  s_call_b64 s[68:69], .fz_kernel_pick
  s_branch .fz_kernel_pk42
.fz_kernel_pk43c:
  s_call_b64 s[68:69], .fz_kernel_pick
  s_branch .fz_kernel_pk43
.fz_kernel_w_pt:
  v_lshlrev_b32 v44, 5, v17
  v_add_u32 v44, 155648, v44
  s_mov_b64 exec, vcc
  ds_read_b128 v[232:235], v44 offset:7424
  ds_read_b128 v[236:239], v44 offset:7440
  ds_read_b128 v[240:243], v44 offset:7488
  ds_read_b128 v[244:247], v44 offset:7504
  s_waitcnt lgkmcnt(0)
  v_pk_add_f32 v[64:65], v[64:65], v[232:233]
  v_pk_add_f32 v[66:67], v[66:67], v[234:235]
  v_pk_add_f32 v[68:69], v[68:69], v[236:237]
  v_pk_add_f32 v[70:71], v[70:71], v[238:239]
  v_pk_add_f32 v[72:73], v[72:73], v[240:241]
  v_pk_add_f32 v[74:75], v[74:75], v[242:243]
  v_pk_add_f32 v[76:77], v[76:77], v[244:245]
  v_pk_add_f32 v[78:79], v[78:79], v[246:247]
  ds_read_b128 v[232:235], v44 offset:7552
  ds_read_b128 v[236:239], v44 offset:7568
  ds_read_b128 v[240:243], v44 offset:7616
  ds_read_b128 v[244:247], v44 offset:7632
  s_waitcnt lgkmcnt(0)
  v_pk_add_f32 v[80:81], v[80:81], v[232:233]
  v_pk_add_f32 v[82:83], v[82:83], v[234:235]
  v_pk_add_f32 v[84:85], v[84:85], v[236:237]
  v_pk_add_f32 v[86:87], v[86:87], v[238:239]
  v_pk_add_f32 v[88:89], v[88:89], v[240:241]
  v_pk_add_f32 v[90:91], v[90:91], v[242:243]
  v_pk_add_f32 v[92:93], v[92:93], v[244:245]
  v_pk_add_f32 v[94:95], v[94:95], v[246:247]
  s_mov_b64 exec, -1
  s_branch .fz_kernel_w_pb
.fz_kernel_pk44c:
  s_call_b64 s[68:69], .fz_kernel_pick
  s_branch .fz_kernel_pk44
.fz_kernel_pk45c:
  s_call_b64 s[68:69], .fz_kernel_pick
  s_branch .fz_kernel_pk45
.fz_kernel_pk46c:
  s_call_b64 s[68:69], .fz_kernel_pick
  s_branch .fz_kernel_pk46
.fz_kernel_pk47c:
  s_call_b64 s[68:69], .fz_kernel_pick
  s_branch .fz_kernel_pk47
.fz_kernel_pk48c:
  s_call_b64 s[68:69], .fz_kernel_pick
  s_branch .fz_kernel_pk48
.fz_kernel_pk49c:
  s_call_b64 s[68:69], .fz_kernel_pick
  s_branch .fz_kernel_pk49
.fz_kernel_pk50c:
  s_call_b64 s[68:69], .fz_kernel_pick
  s_branch .fz_kernel_pk50
.fz_kernel_pk51c:
  s_call_b64 s[68:69], .fz_kernel_pick
  s_branch .fz_kernel_pk51
.fz_kernel_pk52c:
  s_call_b64 s[68:69], .fz_kernel_pick
  s_branch .fz_kernel_pk52
.fz_kernel_pk53c:
  s_call_b64 s[68:69], .fz_kernel_pick
  s_branch .fz_kernel_pk53
.fz_kernel_pk54c:
  s_call_b64 s[68:69], .fz_kernel_pick
  s_branch .fz_kernel_pk54
.fz_kernel_pk55c:
  s_call_b64 s[68:69], .fz_kernel_pick
  s_branch .fz_kernel_pk55
.fz_kernel_pk56c:
  s_call_b64 s[68:69], .fz_kernel_pick
  s_branch .fz_kernel_pk56
.fz_kernel_pk57c:
  s_call_b64 s[68:69], .fz_kernel_pick
  s_branch .fz_kernel_pk57
.fz_kernel_pk58c:
  s_call_b64 s[68:69], .fz_kernel_pick
  s_branch .fz_kernel_pk58
.fz_kernel_pk59c:
  s_call_b64 s[68:69], .fz_kernel_pick
  s_branch .fz_kernel_pk59
.fz_kernel_c_nl:
  s_barrier
  s_branch .fz_kernel_c_np
.fz_kernel_c_c7:
  s_mov_b32 s38, 0
.fz_kernel_cw64:
  s_sleep 1
  ds_read_u8 v22, v6 offset:272
  s_add_u32 s38, s38, 1
  s_waitcnt lgkmcnt(0)
  v_cmp_gt_u32 vcc, 2, v22
  s_cbranch_vccz .fz_kernel_cw64d
  s_cmp_lt_u32 s38, 8388608
  s_cbranch_scc1 .fz_kernel_cw64
.fz_kernel_cw64d:
  ds_read_b64_tr_b16 v[32:33], v7 offset:0
  ds_read_b64_tr_b16 v[34:35], v7 offset:512
  ds_read_b64_tr_b16 v[36:37], v13 offset:0
  ds_read_b64_tr_b16 v[38:39], v13 offset:512
  ds_read_b64_tr_b16 v[40:41], v7 offset:4096
  ds_read_b64_tr_b16 v[42:43], v7 offset:4608
  ds_read_b64_tr_b16 v[44:45], v13 offset:4096
  ds_read_b64_tr_b16 v[46:47], v13 offset:4608
  ds_read_b64_tr_b16 v[48:49], v7 offset:8192
  ds_read_b64_tr_b16 v[50:51], v7 offset:8704
  ds_read_b64_tr_b16 v[52:53], v13 offset:8192
  ds_read_b64_tr_b16 v[54:55], v13 offset:8704
  s_waitcnt lgkmcnt(0)
  ds_read_b64_tr_b16 v[56:57], v7 offset:12288
  ds_read_b64_tr_b16 v[58:59], v7 offset:12800
  ds_read_b64_tr_b16 v[60:61], v13 offset:12288
  ds_read_b64_tr_b16 v[62:63], v13 offset:12800
  ds_read_b64_tr_b16 v[64:65], v7 offset:16384
  ds_read_b64_tr_b16 v[66:67], v7 offset:16896
  ds_read_b64_tr_b16 v[68:69], v13 offset:16384
  ds_read_b64_tr_b16 v[70:71], v13 offset:16896
  ds_read_b64_tr_b16 v[72:73], v7 offset:20480
  ds_read_b64_tr_b16 v[74:75], v7 offset:20992
  ds_read_b64_tr_b16 v[76:77], v13 offset:20480
  ds_read_b64_tr_b16 v[78:79], v13 offset:20992
  s_waitcnt lgkmcnt(0)
  s_branch .fz_kernel_c_c2
.fz_kernel_c_coef:
  v_fma_f32 v242, -v240, v240, v242
  v_fma_f32 v243, -v241, v241, v243
  v_rsq_f32 v248, abs(v242)
  v_rsq_f32 v249, abs(v243)
  v_mul_f32 v254, v240, v248
  v_sub_f32 v254, 0, v254
  v_mov_b32 v252, 1.0
  v_fmac_f32 v252, 0x44800000, v248
  v_fma_f32 v242, v242, v24, -v25
  v_max_f32 v242, 0, v242
  v_mul_f32 v248, v252, v252
  v_fma_f32 v248, v248, v242, v25
  v_rsq_f32 v248, v248
  v_mul_f32 v240, v23, v240
  v_mul_f32 v248, v248, v252
  v_mul_f32 v250, v248, v240
  v_sub_f32 v250, 0, v250
  v_mul_f32 v255, v241, v249
  v_sub_f32 v255, 0, v255
  v_mov_b32 v253, 1.0
  v_fmac_f32 v253, 0x44800000, v249
  s_cmp_eq_u32 s3, 0
  s_cbranch_scc1 .fz_kernel_hb71
  s_barrier
  s_sub_u32 s3, s3, 1
.fz_kernel_hb71:
  v_fma_f32 v243, v243, v24, -v25
  v_max_f32 v243, 0, v243
  v_mul_f32 v249, v253, v253
  v_fma_f32 v249, v249, v243, v25
  v_rsq_f32 v249, v249
  v_mul_f32 v241, v23, v241
  v_mul_f32 v249, v249, v253
  v_mul_f32 v251, v249, v241
  v_sub_f32 v251, 0, v251
  s_setpc_b64 s[68:69]
.fz_kernel_c_gur:
  v_min_u32 v9, v144, v146
  v_cmp_eq_u32 s[8:9], 0, v9
  v_min_u32 v9, v148, v150
  v_cmp_eq_u32 s[10:11], 0, v9
  v_min_u32 v9, v152, v154
  v_cmp_eq_u32 s[12:13], 0, v9
  v_min_u32 v9, v156, v158
  v_cmp_eq_u32 s[14:15], 0, v9
  s_add_u32 s38, s38, 1
  s_cmp_ge_u32 s38, 131072
  s_cbranch_scc1 .fz_kernel_c_gud
  s_or_b64 exec, s[8:9], 1
  buffer_load_dwordx4 v[144:147], v21, s[4:7], s21 offen offset:0 sc1
  s_or_b64 exec, s[10:11], 1
  buffer_load_dwordx4 v[148:151], v21, s[4:7], s21 offen offset:512 sc1
  s_or_b64 exec, s[12:13], 1
  buffer_load_dwordx4 v[152:155], v21, s[4:7], s21 offen offset:1024 sc1
  s_or_b64 exec, s[14:15], 1
  buffer_load_dwordx4 v[156:159], v21, s[4:7], s21 offen offset:1536 sc1
  s_mov_b64 exec, -1
  s_branch .fz_kernel_c_gu
.fz_kernel_c_pur:
  v_min3_u32 v9, v144, v146, v148
  v_min_u32 v9, v9, v150
  v_cmp_eq_u32 s[8:9], 0, v9
  v_min3_u32 v9, v152, v154, v156
  v_min_u32 v9, v9, v158
  v_cmp_eq_u32 s[10:11], 0, v9
  v_min3_u32 v9, v160, v162, v164
  v_min_u32 v9, v9, v166
  v_cmp_eq_u32 s[12:13], 0, v9
  v_min3_u32 v9, v168, v170, v172
  v_min_u32 v9, v9, v174
  v_cmp_eq_u32 s[14:15], 0, v9
  s_cmp_eq_u32 s3, 0
  s_cbranch_scc1 .fz_kernel_hb75
  s_barrier
  s_sub_u32 s3, s3, 1
.fz_kernel_hb75:
  s_add_u32 s38, s38, 1
  s_cmp_ge_u32 s38, 131072
  s_cbranch_scc1 .fz_kernel_c_pud
  s_or_b64 exec, s[8:9], 1
  buffer_load_dwordx4 v[144:147], v10, s[4:7], s21 offen offset:0 sc1
  buffer_load_dwordx4 v[148:151], v10, s[4:7], s21 offen offset:16 sc1
  s_or_b64 exec, s[10:11], 1
  buffer_load_dwordx4 v[152:155], v10, s[4:7], s21 offen offset:2048 sc1
  buffer_load_dwordx4 v[156:159], v10, s[4:7], s21 offen offset:2064 sc1
  s_or_b64 exec, s[12:13], 1
  buffer_load_dwordx4 v[160:163], v10, s[4:7], s22 offen offset:0 sc1
  buffer_load_dwordx4 v[164:167], v10, s[4:7], s22 offen offset:16 sc1
  s_or_b64 exec, s[14:15], 1
  buffer_load_dwordx4 v[168:171], v10, s[4:7], s22 offen offset:2048 sc1
  buffer_load_dwordx4 v[172:175], v10, s[4:7], s22 offen offset:2064 sc1
  s_mov_b64 exec, -1
  s_branch .fz_kernel_c_pu
.fz_kernel_last:
  s_endpgm

.section .rodata,"a"
.p2align 6
.amdhsa_kernel fz_kernel
  .amdhsa_next_free_vgpr 256
  .amdhsa_next_free_sgpr 102
  .amdhsa_accum_offset 256
  .amdhsa_group_segment_fixed_size 0
  .amdhsa_kernarg_size 88
  .amdhsa_user_sgpr_count 2
  .amdhsa_user_sgpr_kernarg_segment_ptr 1
  .amdhsa_system_sgpr_workgroup_id_x 1
.end_amdhsa_kernel
```

```asm
; @launch kernel=fz_kernel grid=(256,1,1) block=(512,1,1) lds=163840
.amdgcn_target "amdgcn-amd-amdhsa--gfx950"
.text
.globl fz_kernel
.p2align 8
.type fz_kernel,@function
fz_kernel:
  s_cmp_ge_u32 s2, 256
  s_cbranch_scc1 .fz_kernel_end
  s_load_dwordx2 s[8:9], s[0:1], 0
  s_load_dwordx2 s[12:13], s[0:1], 8
  s_load_dwordx2 s[4:5], s[0:1], 80
  s_load_dwordx16 s[40:55], s[0:1], 0
  s_load_dwordx4 s[56:59], s[0:1], 64
  v_lshrrev_b32 v1, 6, v0
  v_and_b32 v2, 63, v0
  v_readfirstlane_b32 s16, v1
  s_and_b32 s21, s2, 7
  s_lshr_b32 s22, s2, 3
  s_and_b32 s23, s21, 3
  s_lshl_b32 s23, s23, 2
  s_and_b32 s24, s22, 3
  s_add_u32 s18, s23, s24
  s_lshr_b32 s24, s21, 2
  s_lshl_b32 s24, s24, 3
  s_lshr_b32 s25, s22, 2
  s_add_u32 s17, s24, s25
  s_lshl_b32 s19, s18, 4
  s_add_u32 s19, s19, s17
  s_lshl_b32 s19, s19, 7
  s_add_u32 s19, s19, 0x1800000
  v_lshlrev_b32 v3, 4, v2
  v_mov_b32 v4, 0
  v_mov_b32 v5, 1
  s_mov_b32 s6, 0x2c00000
  s_mov_b32 s7, 0x00020000
  s_mov_b32 s62, 0
  s_mov_b32 s63, 0x400000
  s_mov_b32 s64, 0xc00000
  s_mov_b32 s65, 0x1000000
  s_mov_b32 s66, 0x1c00000
  s_mov_b32 s67, 0
  s_mov_b32 s71, 159744
  v_mov_b32 v6, 159808
  s_cmp_lt_u32 s16, 4
  s_cbranch_scc1 .fz_kernel_q_cons1
  s_cmp_ge_u32 s16, 6
  s_cbranch_scc1 .fz_kernel_q_help1
  s_mov_b32 s10, 0x400000
  s_mov_b32 s11, 0x00020000
  v_lshrrev_b32 v20, 3, v2
  v_and_b32 v21, 7, v2
  v_lshrrev_b32 v22, 4, v2
  v_xor_b32 v23, v21, v22
  v_lshlrev_b32 v23, 4, v23
  v_lshl_add_u32 v24, v20, 11, v23
  v_xor_b32 v25, 64, v24
  s_lshl_b32 s35, s17, 2
  s_and_b32 s31, s16, 1
  s_add_u32 s35, s35, s31
  s_lshl_b32 s35, s35, 16
  s_and_b32 s29, s18, 12
  s_lshr_b32 s33, s17, 3
  s_lshl1_add_u32 s29, s33, s29
  s_lshl2_add_u32 s29, s17, s29
  s_and_b32 s29, s29, 15
  s_mov_b32 s22, 128
  s_mov_b32 s23, 131072
  s_mov_b32 s36, -1
  v_add_u32 v40, 0, v24
  v_add_u32 v41, 15360, v25
  v_add_u32 v42, 30720, v24
  v_add_u32 v43, 46080, v25
.fz_kernel_q_pc:
  s_mov_b32 s14, 0x600000
  s_mov_b32 s15, 0x00020000
  v_lshrrev_b32 v28, 3, v2
  v_and_b32 v29, 7, v2
  v_bfe_u32 v30, v2, 4, 1
  v_lshlrev_b32 v30, 1, v30
  v_xor_b32 v31, v29, v30
  v_lshlrev_b32 v31, 4, v31
  v_mul_u32_u24 v28, 6144, v28
  v_add_u32 v28, v28, v31
  v_xor_b32 v29, 64, v28
  s_lshl_b32 s32, s18, 7
  s_add_u32 s39, s32, 6291456
  s_mul_i32 s33, s29, 393216
  s_add_u32 s33, s33, s32
  s_lshl_b32 s29, s29, 1
  s_mul_i32 s25, s31, 6144
  s_add_u32 s25, s25, 65536
  s_mov_b32 s30, s25
  s_add_u32 s26, s25, 49152
  s_lshl_b32 s21, s31, 12
  s_cmp_eq_u32 s31, 0
  s_mov_b32 s24, 100352
  s_cselect_b32 s24, 0, s24
  v_add_u32 v32, s24, v28
  s_mov_b32 s24, 148480
  s_cselect_b32 s24, 48128, s24
  v_add_u32 v33, s24, v29
  s_mov_b32 s24, 2048
  s_cselect_b32 s24, 96256, s24
  v_add_u32 v34, s24, v28
  s_mov_b32 s24, 50176
  s_cselect_b32 s24, 144384, s24
  v_add_u32 v35, s24, v29
  s_mov_b32 s24, 102400
  s_cselect_b32 s24, 2048, s24
  v_add_u32 v36, s24, v28
  s_mov_b32 s24, 150528
  s_cselect_b32 s24, 50176, s24
  v_add_u32 v37, s24, v29
  s_cmp_lg_u32 s62, 0
  s_cbranch_scc1 .fz_kernel_q_st2
  s_waitcnt lgkmcnt(0)
  s_mov_b32 s34, 32
  s_call_b64 s[0:1], .fz_kernel_q_ix
  s_call_b64 s[0:1], .fz_kernel_q_iu
  s_call_b64 s[0:1], .fz_kernel_q_iu
  s_call_b64 s[0:1], .fz_kernel_q_iu
  s_waitcnt vmcnt(20)
  s_barrier
  s_call_b64 s[0:1], .fz_kernel_q_iu
  s_waitcnt vmcnt(24)
  s_barrier
  s_call_b64 s[0:1], .fz_kernel_q_iu
  s_branch .fz_kernel_q_pl
.fz_kernel_q_ix:
  s_bfe_u32 s24, s29, 0x40001
  s_mul_i32 s20, s24, s22
  s_bitcmp1_b32 s29, 0
  s_cselect_b32 s31, s23, 0
  s_add_u32 s20, s20, s35
  s_add_u32 s20, s20, s31
  s_bitcmp1_b32 s36, s24
  s_cbranch_scc0 .fz_kernel_xok1w
.fz_kernel_xok1:
  s_mov_b32 m0, s21
  s_add_u32 s21, s21, 8192
  s_and_b32 s21, s21, 0xffff
  s_add_u32 s29, s29, 1
  buffer_load_dwordx4 v40, s[8:11], s20 offen offset:0 lds
  buffer_load_dwordx4 v41, s[8:11], s20 offen offset:1024 lds
  buffer_load_dwordx4 v42, s[8:11], s20 offen offset:2048 lds
  buffer_load_dwordx4 v43, s[8:11], s20 offen offset:3072 lds
  s_setpc_b64 s[0:1]
.fz_kernel_q_iu:
  s_mov_b32 m0, s30
  s_add_u32 s30, s30, 12288
  buffer_load_dwordx4 v32, s[12:15], s33 offen offset:0 lds
  s_bfe_u32 s24, s29, 0x40001
  buffer_load_dwordx4 v33, s[12:15], s33 offen offset:1024 lds
  s_mul_i32 s20, s24, s22
  buffer_load_dwordx4 v34, s[12:15], s33 offen offset:2048 lds
  s_bitcmp1_b32 s29, 0
  s_cselect_b32 s31, s23, 0
  buffer_load_dwordx4 v35, s[12:15], s33 offen offset:3072 lds
  s_add_u32 m0, m0, 4096
  s_add_u32 s20, s20, s35
  buffer_load_dwordx4 v36, s[12:15], s33 offen offset:0 lds
  s_add_u32 s20, s20, s31
  buffer_load_dwordx4 v37, s[12:15], s33 offen offset:1024 lds
  s_bitcmp1_b32 s36, s24
  s_cbranch_scc0 .fz_kernel_xok2w
.fz_kernel_xok2:
  s_mov_b32 m0, s21
  s_add_u32 s21, s21, 8192
  s_and_b32 s21, s21, 0xffff
  s_add_u32 s29, s29, 1
  buffer_load_dwordx4 v40, s[8:11], s20 offen offset:0 lds
  s_add_u32 s33, s33, 196608
  s_cmp_eq_u32 s33, s39
  s_cselect_b32 s33, s32, s33
  buffer_load_dwordx4 v41, s[8:11], s20 offen offset:1024 lds
  s_cmp_eq_u32 s30, s26
  s_cselect_b32 s30, s25, s30
  buffer_load_dwordx4 v42, s[8:11], s20 offen offset:2048 lds
  s_sub_u32 s34, s34, 1
  s_cmp_lg_u32 s34, 0
  buffer_load_dwordx4 v43, s[8:11], s20 offen offset:3072 lds
  s_setpc_b64 s[0:1]
.fz_kernel_q_iw:
  s_mov_b32 m0, s30
  s_add_u32 s30, s30, 12288
  buffer_load_dwordx4 v32, s[12:15], s33 offen offset:0 lds
  s_nop 0
  buffer_load_dwordx4 v33, s[12:15], s33 offen offset:1024 lds
  s_nop 0
  buffer_load_dwordx4 v34, s[12:15], s33 offen offset:2048 lds
  s_nop 0
  buffer_load_dwordx4 v35, s[12:15], s33 offen offset:3072 lds
  s_add_u32 m0, m0, 4096
  s_nop 0
  buffer_load_dwordx4 v36, s[12:15], s33 offen offset:0 lds
  buffer_load_dwordx4 v37, s[12:15], s33 offen offset:1024 lds
  s_add_u32 s33, s33, 196608
  s_cmp_eq_u32 s33, s39
  s_cselect_b32 s33, s32, s33
  s_cmp_eq_u32 s30, s26
  s_cselect_b32 s30, s25, s30
  s_sub_u32 s34, s34, 1
  s_cmp_lg_u32 s34, 0
  s_setpc_b64 s[0:1]
.fz_kernel_q_st2:
  s_mov_b32 s34, 32
  s_waitcnt vmcnt(0)
  s_barrier
  s_call_b64 s[0:1], .fz_kernel_q_iw
  s_call_b64 s[0:1], .fz_kernel_q_iw
  s_call_b64 s[0:1], .fz_kernel_q_iw
  s_call_b64 s[0:1], .fz_kernel_q_iw
  s_call_b64 s[0:1], .fz_kernel_q_ix
  s_call_b64 s[0:1], .fz_kernel_q_ix
  s_mov_b64 exec, 1
  s_waitcnt vmcnt(20)
  ds_add_u32 v6, v5 offset:0x110
  s_mov_b64 exec, -1
  v_mov_b32 v12, 0x100
  s_call_b64 s[0:1], .fz_kernel_q_ix
  s_call_b64 s[0:1], .fz_kernel_q_ix
  s_waitcnt vmcnt(8)
  s_mov_b64 exec, 1
  ds_add_u32 v6, v12 offset:0x110
  s_mov_b64 exec, -1
  s_barrier
  s_waitcnt vmcnt(8)
  s_barrier
  s_call_b64 s[0:1], .fz_kernel_q_ix
  s_call_b64 s[0:1], .fz_kernel_q_iu
  s_waitcnt vmcnt(14)
  s_barrier
  s_call_b64 s[0:1], .fz_kernel_q_iu
  s_waitcnt vmcnt(20)
  s_barrier
  s_call_b64 s[0:1], .fz_kernel_q_iu
.fz_kernel_q_pl:
  s_waitcnt vmcnt(20)
  s_barrier
  s_mov_b32 m0, s30
  s_add_u32 s30, s30, 12288
  buffer_load_dwordx4 v32, s[12:15], s33 offen offset:0 lds
  s_bfe_u32 s24, s29, 0x40001
  buffer_load_dwordx4 v33, s[12:15], s33 offen offset:1024 lds
  s_mul_i32 s20, s24, s22
  buffer_load_dwordx4 v34, s[12:15], s33 offen offset:2048 lds
  s_bitcmp1_b32 s29, 0
  s_cselect_b32 s31, s23, 0
  buffer_load_dwordx4 v35, s[12:15], s33 offen offset:3072 lds
  s_add_u32 m0, m0, 4096
  s_add_u32 s20, s20, s35
  buffer_load_dwordx4 v36, s[12:15], s33 offen offset:0 lds
  s_add_u32 s20, s20, s31
  buffer_load_dwordx4 v37, s[12:15], s33 offen offset:1024 lds
  s_bitcmp1_b32 s36, s24
  s_cbranch_scc0 .fz_kernel_xok3w
.fz_kernel_xok3:
  s_mov_b32 m0, s21
  s_add_u32 s21, s21, 8192
  s_and_b32 s21, s21, 0xffff
  s_add_u32 s29, s29, 1
  buffer_load_dwordx4 v40, s[8:11], s20 offen offset:0 lds
  s_add_u32 s33, s33, 196608
  s_cmp_eq_u32 s33, s39
  s_cselect_b32 s33, s32, s33
  buffer_load_dwordx4 v41, s[8:11], s20 offen offset:1024 lds
  s_cmp_eq_u32 s30, s26
  s_cselect_b32 s30, s25, s30
  buffer_load_dwordx4 v42, s[8:11], s20 offen offset:2048 lds
  s_sub_u32 s34, s34, 1
  s_cmp_lg_u32 s34, 0
  buffer_load_dwordx4 v43, s[8:11], s20 offen offset:3072 lds
  s_cbranch_scc1 .fz_kernel_q_pl
  s_waitcnt vmcnt(20)
  s_barrier
  s_waitcnt vmcnt(10)
  s_barrier
  s_waitcnt vmcnt(0)
  s_barrier
  s_barrier
  s_branch .fz_kernel_serv
.fz_kernel_q_cons1:
  s_waitcnt lgkmcnt(0)
  s_mov_b32 s12, s42
  s_mov_b32 s13, s43
  s_mov_b32 s14, 0x600000
  s_mov_b32 s15, 0x00020000
  s_and_b32 s20, s18, 4
  s_add_u32 s20, s20, s16
  s_cmp_ge_u32 s20, 3
  s_cbranch_scc1 .fz_kernel_q_nsp
  s_and_b32 s20, s17, 7
  s_and_b32 s21, s18, 3
  s_lshl2_add_u32 s20, s20, s21
  s_mul_i32 s20, s20, 196608
  s_or_b32 s21, s18, 3
  s_lshl4_add_u32 s21, s16, s21
  s_lshl_b32 s21, s21, 7
  s_add_u32 s20, s20, s21
  v_mul_u32_u24 v20, 6144, v2
  s_mov_b32 exec_hi, 0
  buffer_load_dword v231, v20, s[12:15], s20 offen
  s_mov_b32 exec_hi, -1
.fz_kernel_q_nsp:
  v_lshlrev_b32 v20, 2, v0
  v_add_u32 v20, 159744, v20
  s_cmp_ge_u32 s16, 2
  s_cbranch_scc1 .fz_kernel_q_nz
  ds_write_b32 v20, v4
.fz_kernel_q_nz:
  s_lshr_b32 s26, s16, 1
  s_lshl_b32 s28, s26, 13
  v_and_b32 v20, 15, v2
  v_lshrrev_b32 v21, 4, v2
  v_bfe_u32 v22, v2, 1, 3
  v_xor_b32 v22, v22, v21
  v_lshlrev_b32 v20, 7, v20
  v_lshl_add_u32 v20, v22, 4, v20
  v_add_u32 v8, s28, v20
  v_xor_b32 v9, 64, v8
.fz_kernel_q_cs:
  s_and_b32 s27, s16, 1
  s_lshl_b32 s28, s27, 1
  v_lshrrev_b32 v14, 4, v2
  v_bfe_u32 v15, v2, 2, 2
  v_lshl_add_u32 v16, v14, 3, v15
  v_lshlrev_b32 v16, 7, v16
  v_and_b32 v14, 1, v14
  v_lshrrev_b32 v15, 1, v15
  v_lshl_add_u32 v14, v14, 1, v15
  v_xor_b32 v14, s28, v14
  v_lshl_add_u32 v16, v14, 5, v16
  v_and_b32 v14, 3, v2
  v_lshl_add_u32 v16, v14, 3, v16
  v_add_u32 v12, 65536, v16
  v_xor_b32 v13, 32, v12
  v_mov_b32 v10, v12
  v_mov_b32 v11, v13
  s_mov_b32 s29, 16
  s_mov_b32 s30, 0
  v_mov_b32 v128, 0
  v_mov_b32 v129, 0
  v_mov_b32 v130, 0
  v_mov_b32 v131, 0
  v_mov_b32 v132, 0
  v_mov_b32 v133, 0
  v_mov_b32 v134, 0
  v_mov_b32 v135, 0
  v_mov_b32 v136, 0
  v_mov_b32 v137, 0
  v_mov_b32 v138, 0
  v_mov_b32 v139, 0
  v_mov_b32 v140, 0
  v_mov_b32 v141, 0
  v_mov_b32 v142, 0
  v_mov_b32 v143, 0
  v_mov_b32 v144, 0
  v_mov_b32 v145, 0
  v_mov_b32 v146, 0
  v_mov_b32 v147, 0
  v_mov_b32 v148, 0
  v_mov_b32 v149, 0
  v_mov_b32 v150, 0
  v_mov_b32 v151, 0
  v_mov_b32 v152, 0
  v_mov_b32 v153, 0
  v_mov_b32 v154, 0
  v_mov_b32 v155, 0
  v_mov_b32 v156, 0
  v_mov_b32 v157, 0
  v_mov_b32 v158, 0
  v_mov_b32 v159, 0
  v_mov_b32 v160, 0
  v_mov_b32 v161, 0
  v_mov_b32 v162, 0
  v_mov_b32 v163, 0
  v_mov_b32 v164, 0
  v_mov_b32 v165, 0
  v_mov_b32 v166, 0
  v_mov_b32 v167, 0
  v_mov_b32 v168, 0
  v_mov_b32 v169, 0
  v_mov_b32 v170, 0
  v_mov_b32 v171, 0
  v_mov_b32 v172, 0
  v_mov_b32 v173, 0
  v_mov_b32 v174, 0
  v_mov_b32 v175, 0
  s_cmp_eq_u32 s62, 0
  s_cbranch_scc1 .fz_kernel_q_i1
  s_mov_b64 exec, 1
  s_waitcnt vmcnt(0)
  ds_add_u32 v1, v5 offset:0x100
  s_mov_b64 exec, -1
.fz_kernel_q_i1:
  v_mov_b32 v176, 0
  v_mov_b32 v177, 0
  v_mov_b32 v178, 0
  v_mov_b32 v179, 0
  v_mov_b32 v180, 0
  v_mov_b32 v181, 0
  v_mov_b32 v182, 0
  v_mov_b32 v183, 0
  v_mov_b32 v184, 0
  v_mov_b32 v185, 0
  v_mov_b32 v186, 0
  v_mov_b32 v187, 0
  v_mov_b32 v188, 0
  v_mov_b32 v189, 0
  v_mov_b32 v190, 0
  v_mov_b32 v191, 0
  v_mov_b32 v192, 0
  v_mov_b32 v193, 0
  v_mov_b32 v194, 0
  v_mov_b32 v195, 0
  v_mov_b32 v196, 0
  v_mov_b32 v197, 0
  v_mov_b32 v198, 0
  v_mov_b32 v199, 0
  v_mov_b32 v200, 0
  v_mov_b32 v201, 0
  v_mov_b32 v202, 0
  v_mov_b32 v203, 0
  v_mov_b32 v204, 0
  v_mov_b32 v205, 0
  v_mov_b32 v206, 0
  v_mov_b32 v207, 0
  v_mov_b32 v208, 0
  v_mov_b32 v209, 0
  v_mov_b32 v210, 0
  v_mov_b32 v211, 0
  v_mov_b32 v212, 0
  v_mov_b32 v213, 0
  v_mov_b32 v214, 0
  v_mov_b32 v215, 0
  v_mov_b32 v216, 0
  v_mov_b32 v217, 0
  v_mov_b32 v218, 0
  v_mov_b32 v219, 0
  v_mov_b32 v220, 0
  v_mov_b32 v221, 0
  v_mov_b32 v222, 0
  v_mov_b32 v223, 0
  v_and_b32 v14, 1, v2
  v_lshlrev_b32 v14, 4, v14
  v_mov_b32 v15, 0x3f80
  v_lshlrev_b32 v14, v14, v15
  v_mov_b32 v248, 0
  v_mov_b32 v249, 0
  v_mov_b32 v250, 0
  v_mov_b32 v251, 0
  v_mov_b32 v252, 0
  v_mov_b32 v253, 0
  v_mov_b32 v254, 0
  v_mov_b32 v255, 0
  s_mov_b32 exec_lo, 0x3
  s_mov_b32 exec_hi, 0x30
  v_mov_b32 v248, v14
  s_mov_b32 exec_lo, 0xc
  s_mov_b32 exec_hi, 0xc0
  v_mov_b32 v249, v14
  s_mov_b32 exec_lo, 0x300
  s_mov_b32 exec_hi, 0x3000
  v_mov_b32 v250, v14
  s_mov_b32 exec_lo, 0xc00
  s_mov_b32 exec_hi, 0xc000
  v_mov_b32 v251, v14
  s_mov_b32 exec_lo, 0x30000
  s_mov_b32 exec_hi, 0x300000
  v_mov_b32 v252, v14
  s_mov_b32 exec_lo, 0xc0000
  s_mov_b32 exec_hi, 0xc00000
  v_mov_b32 v253, v14
  s_mov_b32 exec_lo, 0x3000000
  s_mov_b32 exec_hi, 0x30000000
  v_mov_b32 v254, v14
  s_mov_b32 exec_lo, 0xc000000
  s_mov_b32 exec_hi, 0xc0000000
  v_mov_b32 v255, v14
  s_mov_b64 exec, -1
  s_mov_b32 s12, s40
  s_mov_b32 s13, s41
  s_mov_b32 s14, 0x400000
  s_mov_b32 s15, 0x00020000
  v_lshrrev_b32 v14, 5, v2
  v_and_b32 v15, 31, v2
  v_lshlrev_b32 v14, 4, v14
  v_lshl_add_u32 v15, v15, 11, v14
  s_lshl2_add_u32 s23, s17, s16
  s_lshl_b32 s23, s23, 16
  s_lshl_b32 s22, s18, 7
  s_add_u32 s23, s22, s23
  s_waitcnt lgkmcnt(0)
  s_barrier
  ds_read_b64_tr_b16 v[56:57], v10 offset:4096
  ds_read_b64_tr_b16 v[58:59], v10 offset:4608
  ds_read_b128 v[32:35], v8 offset:0
  ds_read_b128 v[36:39], v8 offset:2048
  ds_read_b128 v[40:43], v8 offset:4096
  ds_read_b128 v[44:47], v8 offset:6144
  ds_read_b64_tr_b16 v[60:61], v11 offset:4096
  ds_read_b64_tr_b16 v[62:63], v11 offset:4608
  ds_read_b64_tr_b16 v[64:65], v10 offset:8192
  ds_read_b64_tr_b16 v[66:67], v10 offset:8704
  ds_read_b64_tr_b16 v[68:69], v11 offset:8192
  ds_read_b64_tr_b16 v[70:71], v11 offset:8704
  ds_read_b64_tr_b16 v[48:49], v10 offset:0
  ds_read_b64_tr_b16 v[50:51], v10 offset:512
  ds_read_b64_tr_b16 v[52:53], v11 offset:0
  ds_read_b64_tr_b16 v[54:55], v11 offset:512
  s_add_u32 s30, s30, 12288
  s_cmp_eq_u32 s30, 49152
  s_cselect_b32 s30, 0, s30
  v_add_u32 v8, 0x4000, v8
  v_add_u32 v10, s30, v12
  v_add_u32 v11, s30, v13
  v_and_b32 v8, 0xffff, v8
  s_waitcnt lgkmcnt(0)
  s_branch .fz_kernel_q_l0
  .p2align 6
.fz_kernel_q_loop:
  v_mfma_f32_16x16x32_bf16 v[148:151], v[52:55], v[36:39], v[148:151]
  v_mfma_f32_16x16x32_bf16 v[152:155], v[52:55], v[40:43], v[152:155]
  s_waitcnt lgkmcnt(0)
  v_mfma_f32_16x16x32_bf16 v[156:159], v[52:55], v[44:47], v[156:159]
  s_barrier
  v_mfma_f32_16x16x32_bf16 v[160:163], v[96:99], v[72:75], v[160:163]
  ds_read_b64_tr_b16 v[56:57], v10 offset:4096
  v_mfma_f32_16x16x32_bf16 v[164:167], v[96:99], v[76:79], v[164:167]
  ds_read_b64_tr_b16 v[58:59], v10 offset:4608
  v_mfma_f32_16x16x32_bf16 v[168:171], v[96:99], v[80:83], v[168:171]
  ds_read_b128 v[32:35], v8 offset:0
  v_mfma_f32_16x16x32_bf16 v[172:175], v[96:99], v[84:87], v[172:175]
  ds_read_b128 v[36:39], v8 offset:2048
  v_mfma_f32_16x16x32_bf16 v[176:179], v[100:103], v[72:75], v[176:179]
  ds_read_b128 v[40:43], v8 offset:4096
  v_mfma_f32_16x16x32_bf16 v[180:183], v[100:103], v[76:79], v[180:183]
  ds_read_b128 v[44:47], v8 offset:6144
  v_mfma_f32_16x16x32_bf16 v[184:187], v[100:103], v[80:83], v[184:187]
  ds_read_b64_tr_b16 v[60:61], v11 offset:4096
  v_mfma_f32_16x16x32_bf16 v[188:191], v[100:103], v[84:87], v[188:191]
  ds_read_b64_tr_b16 v[62:63], v11 offset:4608
  v_mfma_f32_16x16x32_bf16 v[192:195], v[72:75], v[104:107], v[192:195]
  ds_read_b64_tr_b16 v[64:65], v10 offset:8192
  s_add_u32 s30, s30, 12288
  v_mfma_f32_16x16x32_bf16 v[196:199], v[76:79], v[104:107], v[196:199]
  ds_read_b64_tr_b16 v[66:67], v10 offset:8704
  s_cmp_eq_u32 s30, 49152
  v_mfma_f32_16x16x32_bf16 v[200:203], v[80:83], v[104:107], v[200:203]
  ds_read_b64_tr_b16 v[68:69], v11 offset:8192
  s_cselect_b32 s30, 0, s30
  v_mfma_f32_16x16x32_bf16 v[204:207], v[84:87], v[104:107], v[204:207]
  ds_read_b64_tr_b16 v[70:71], v11 offset:8704
  v_mfma_f32_16x16x32_bf16 v[208:211], v[72:75], v[108:111], v[208:211]
  ds_read_b64_tr_b16 v[48:49], v10 offset:0
  v_mfma_f32_16x16x32_bf16 v[212:215], v[76:79], v[108:111], v[212:215]
  ds_read_b64_tr_b16 v[50:51], v10 offset:512
  v_mfma_f32_16x16x32_bf16 v[216:219], v[80:83], v[108:111], v[216:219]
  ds_read_b64_tr_b16 v[52:53], v11 offset:0
  v_mfma_f32_16x16x32_bf16 v[220:223], v[84:87], v[108:111], v[220:223]
  ds_read_b64_tr_b16 v[54:55], v11 offset:512
  v_mfma_f32_16x16x32_bf16 v[128:131], v[88:91], v[72:75], v[128:131]
  v_add_u32 v8, 0x4000, v8
  v_mfma_f32_16x16x32_bf16 v[132:135], v[88:91], v[76:79], v[132:135]
  v_add_u32 v10, s30, v12
  v_mfma_f32_16x16x32_bf16 v[136:139], v[88:91], v[80:83], v[136:139]
  v_add_u32 v11, s30, v13
  v_mfma_f32_16x16x32_bf16 v[140:143], v[88:91], v[84:87], v[140:143]
  v_and_b32 v8, 0xffff, v8
  v_mfma_f32_16x16x32_bf16 v[144:147], v[92:95], v[72:75], v[144:147]
  v_mfma_f32_16x16x32_bf16 v[148:151], v[92:95], v[76:79], v[148:151]
  v_mfma_f32_16x16x32_bf16 v[152:155], v[92:95], v[80:83], v[152:155]
  s_waitcnt lgkmcnt(0)
  v_mfma_f32_16x16x32_bf16 v[156:159], v[92:95], v[84:87], v[156:159]
.fz_kernel_q_l0:
  s_barrier
  v_mfma_f32_16x16x32_bf16 v[160:163], v[56:59], v[32:35], v[160:163]
  ds_read_b64_tr_b16 v[96:97], v10 offset:4096
  v_mfma_f32_16x16x32_bf16 v[164:167], v[56:59], v[36:39], v[164:167]
  ds_read_b64_tr_b16 v[98:99], v10 offset:4608
  v_mfma_f32_16x16x32_bf16 v[168:171], v[56:59], v[40:43], v[168:171]
  ds_read_b128 v[72:75], v9 offset:0
  v_mfma_f32_16x16x32_bf16 v[172:175], v[56:59], v[44:47], v[172:175]
  ds_read_b128 v[76:79], v9 offset:2048
  v_mfma_f32_16x16x32_bf16 v[176:179], v[60:63], v[32:35], v[176:179]
  ds_read_b128 v[80:83], v9 offset:4096
  v_mfma_f32_16x16x32_bf16 v[180:183], v[60:63], v[36:39], v[180:183]
  ds_read_b128 v[84:87], v9 offset:6144
  v_mfma_f32_16x16x32_bf16 v[184:187], v[60:63], v[40:43], v[184:187]
  ds_read_b64_tr_b16 v[100:101], v11 offset:4096
  v_mfma_f32_16x16x32_bf16 v[188:191], v[60:63], v[44:47], v[188:191]
  ds_read_b64_tr_b16 v[102:103], v11 offset:4608
  v_mfma_f32_16x16x32_bf16 v[192:195], v[32:35], v[64:67], v[192:195]
  ds_read_b64_tr_b16 v[104:105], v10 offset:8192
  s_add_u32 s30, s30, 12288
  v_mfma_f32_16x16x32_bf16 v[196:199], v[36:39], v[64:67], v[196:199]
  ds_read_b64_tr_b16 v[106:107], v10 offset:8704
  s_cmp_eq_u32 s30, 49152
  v_mfma_f32_16x16x32_bf16 v[200:203], v[40:43], v[64:67], v[200:203]
  ds_read_b64_tr_b16 v[108:109], v11 offset:8192
  s_cselect_b32 s30, 0, s30
  v_mfma_f32_16x16x32_bf16 v[204:207], v[44:47], v[64:67], v[204:207]
  ds_read_b64_tr_b16 v[110:111], v11 offset:8704
  s_sub_u32 s29, s29, 1
  v_mfma_f32_16x16x32_bf16 v[208:211], v[32:35], v[68:71], v[208:211]
  ds_read_b64_tr_b16 v[88:89], v10 offset:0
  s_cmp_lg_u32 s29, 0
  v_mfma_f32_16x16x32_bf16 v[212:215], v[36:39], v[68:71], v[212:215]
  ds_read_b64_tr_b16 v[90:91], v10 offset:512
  v_mfma_f32_16x16x32_bf16 v[216:219], v[40:43], v[68:71], v[216:219]
  ds_read_b64_tr_b16 v[92:93], v11 offset:0
  v_mfma_f32_16x16x32_bf16 v[220:223], v[44:47], v[68:71], v[220:223]
  ds_read_b64_tr_b16 v[94:95], v11 offset:512
  v_mfma_f32_16x16x32_bf16 v[128:131], v[48:51], v[32:35], v[128:131]
  v_add_u32 v9, 0x4000, v9
  v_mfma_f32_16x16x32_bf16 v[132:135], v[48:51], v[36:39], v[132:135]
  v_add_u32 v10, s30, v12
  v_mfma_f32_16x16x32_bf16 v[136:139], v[48:51], v[40:43], v[136:139]
  v_add_u32 v11, s30, v13
  v_mfma_f32_16x16x32_bf16 v[140:143], v[48:51], v[44:47], v[140:143]
  v_and_b32 v9, 0xffff, v9
  v_mfma_f32_16x16x32_bf16 v[144:147], v[52:55], v[32:35], v[144:147]
  s_cbranch_scc1 .fz_kernel_q_loop
  v_mfma_f32_16x16x32_bf16 v[148:151], v[52:55], v[36:39], v[148:151]
  v_mfma_f32_16x16x32_bf16 v[152:155], v[52:55], v[40:43], v[152:155]
  s_waitcnt lgkmcnt(0)
  v_mfma_f32_16x16x32_bf16 v[156:159], v[52:55], v[44:47], v[156:159]
  s_cmp_lg_u32 s62, 0
  s_cbranch_scc1 .fz_kernel_q_nr
  buffer_load_dwordx4 v[232:235], v15, s[12:15], s23 offen offset:0
  buffer_load_dwordx4 v[236:239], v15, s[12:15], s23 offen offset:32
  buffer_load_dwordx4 v[240:243], v15, s[12:15], s23 offen offset:64
  buffer_load_dwordx4 v[244:247], v15, s[12:15], s23 offen offset:96
.fz_kernel_q_nr:
  s_barrier
  v_mfma_f32_16x16x32_bf16 v[160:163], v[96:99], v[72:75], v[160:163]
  s_lshl_b32 s31, s26, 8
  s_add_u32 s31, s31, 155648
  v_and_b32 v14, 15, v2
  v_and_b32 v15, 48, v2
  v_mfma_f32_16x16x32_bf16 v[164:167], v[96:99], v[76:79], v[164:167]
  s_lshl_b32 s33, s27, 7
  s_add_u32 s33, s33, 155648
  v_lshlrev_b32 v14, 2, v14
  v_mov_b32 v1, 159952
  v_mfma_f32_16x16x32_bf16 v[168:171], v[96:99], v[80:83], v[168:171]
  v_add_u32 v29, s33, v14
  v_add_u32 v14, s31, v14
  v_mfma_f32_16x16x32_bf16 v[172:175], v[96:99], v[84:87], v[172:175]
  v_add_u32 v28, s33, v15
  v_add_u32 v15, s31, v15
  v_mfma_f32_16x16x32_bf16 v[176:179], v[100:103], v[72:75], v[176:179]
  ds_read_b32 v1, v1
  v_add_u32 v64, 4608, v14
  v_mfma_f32_16x16x32_bf16 v[180:183], v[100:103], v[76:79], v[180:183]
  ds_read_b128 v[120:123], v28 offset:5888
  v_mfma_f32_16x16x32_bf16 v[184:187], v[100:103], v[80:83], v[184:187]
  ds_read_b128 v[124:127], v28 offset:5952
  v_mfma_f32_16x16x32_bf16 v[188:191], v[100:103], v[84:87], v[188:191]
  ds_read2_b32 v[224:225], v64 offset0:0 offset1:128
  v_mfma_f32_16x16x32_bf16 v[192:195], v[72:75], v[104:107], v[192:195]
  ds_read2_b32 v[226:227], v64 offset0:16 offset1:144
  v_mfma_f32_16x16x32_bf16 v[196:199], v[76:79], v[104:107], v[196:199]
  ds_read2_b32 v[228:229], v64 offset0:32 offset1:160
  v_mfma_f32_16x16x32_bf16 v[200:203], v[80:83], v[104:107], v[200:203]
  ds_read2_b32 v[230:231], v64 offset0:48 offset1:176
  v_mfma_f32_16x16x32_bf16 v[204:207], v[84:87], v[104:107], v[204:207]
  ds_read_b32 v24, v29 offset:6144
  v_mfma_f32_16x16x32_bf16 v[208:211], v[72:75], v[108:111], v[208:211]
  ds_read_b32 v26, v29 offset:6208
  v_mfma_f32_16x16x32_bf16 v[212:215], v[76:79], v[108:111], v[212:215]
  ds_read_b128 v[32:35], v15 offset:4608
  ds_read_b128 v[48:51], v15 offset:5120
  v_mfma_f32_16x16x32_bf16 v[216:219], v[80:83], v[108:111], v[216:219]
  ds_read_b128 v[36:39], v15 offset:4672
  ds_read_b128 v[52:55], v15 offset:5184
  v_mfma_f32_16x16x32_bf16 v[220:223], v[84:87], v[108:111], v[220:223]
  ds_read_b128 v[40:43], v15 offset:4736
  ds_read_b128 v[56:59], v15 offset:5248
  v_mfma_f32_16x16x32_bf16 v[128:131], v[88:91], v[72:75], v[128:131]
  ds_read_b128 v[44:47], v15 offset:4800
  ds_read_b128 v[60:63], v15 offset:5312
  v_mfma_f32_16x16x32_bf16 v[132:135], v[88:91], v[76:79], v[132:135]
  ds_read_b128 v[112:115], v28 offset:5632
  ds_read_b128 v[116:119], v28 offset:5696
  v_mfma_f32_16x16x32_bf16 v[136:139], v[88:91], v[80:83], v[136:139]
  s_lshl1_add_u32 s34, s18, s27
  s_lshl4_add_u32 s34, s34, s17
  s_lshl1_add_u32 s34, s34, s26
  v_mfma_f32_16x16x32_bf16 v[140:143], v[88:91], v[84:87], v[140:143]
  s_lshl_b32 s36, s34, 13
  s_add_u32 s36, s36, s63
  s_add_u32 s37, s36, 4096
  v_mfma_f32_16x16x32_bf16 v[144:147], v[92:95], v[72:75], v[144:147]
  s_lshl_b32 s34, s16, 12
  s_add_u32 s34, s34, 131072
  v_add_u32 v9, s34, v3
  v_mfma_f32_16x16x32_bf16 v[148:151], v[92:95], v[76:79], v[148:151]
  v_xor_b32 v8, 8192, v9
  v_mfma_f32_16x16x32_bf16 v[152:155], v[92:95], v[80:83], v[152:155]
  v_mfma_f32_16x16x32_bf16 v[156:159], v[92:95], v[84:87], v[156:159]
  s_waitcnt lgkmcnt(12)
  v_add_u32 v1, -1, v1
  v_lshrrev_b32 v1, 6, v1
  v_cmp_eq_u32 vcc, s26, v1
  s_cbranch_vccnz .fz_kernel_q_patch
.fz_kernel_q_pback:
  v_pk_mul_f32 v[64:65], v[120:121], v[224:225] op_sel:[0,1] op_sel_hi:[1,1]
  v_pk_fma_f32 v[160:161], v[160:161], v[224:225], v[64:65] op_sel_hi:[1,0,1]
  v_pk_mul_f32 v[66:67], v[122:123], v[224:225] op_sel:[0,1] op_sel_hi:[1,1]
  v_pk_fma_f32 v[162:163], v[162:163], v[224:225], v[66:67] op_sel_hi:[1,0,1]
  v_pk_mul_f32 v[68:69], v[124:125], v[224:225] op_sel:[0,1] op_sel_hi:[1,1]
  v_pk_fma_f32 v[176:177], v[176:177], v[224:225], v[68:69] op_sel_hi:[1,0,1]
  v_pk_mul_f32 v[70:71], v[126:127], v[224:225] op_sel:[0,1] op_sel_hi:[1,1]
  v_pk_fma_f32 v[178:179], v[178:179], v[224:225], v[70:71] op_sel_hi:[1,0,1]
  v_cvt_pk_bf16_f32 v80, v160, v161
  v_cvt_pk_bf16_f32 v81, v162, v163
  v_cvt_pk_bf16_f32 v82, v176, v177
  v_cvt_pk_bf16_f32 v83, v178, v179
  v_pk_mul_f32 v[64:65], v[120:121], v[226:227] op_sel:[0,1] op_sel_hi:[1,1]
  v_pk_fma_f32 v[164:165], v[164:165], v[226:227], v[64:65] op_sel_hi:[1,0,1]
  v_pk_mul_f32 v[66:67], v[122:123], v[226:227] op_sel:[0,1] op_sel_hi:[1,1]
  v_pk_fma_f32 v[166:167], v[166:167], v[226:227], v[66:67] op_sel_hi:[1,0,1]
  v_pk_mul_f32 v[68:69], v[124:125], v[226:227] op_sel:[0,1] op_sel_hi:[1,1]
  v_pk_fma_f32 v[180:181], v[180:181], v[226:227], v[68:69] op_sel_hi:[1,0,1]
  v_pk_mul_f32 v[70:71], v[126:127], v[226:227] op_sel:[0,1] op_sel_hi:[1,1]
  v_pk_fma_f32 v[182:183], v[182:183], v[226:227], v[70:71] op_sel_hi:[1,0,1]
  v_cvt_pk_bf16_f32 v84, v164, v165
  v_cvt_pk_bf16_f32 v85, v166, v167
  v_cvt_pk_bf16_f32 v86, v180, v181
  v_cvt_pk_bf16_f32 v87, v182, v183
  v_permlane16_swap_b32 v80, v84
  v_permlane16_swap_b32 v81, v85
  v_permlane16_swap_b32 v82, v86
  v_permlane16_swap_b32 v83, v87
  buffer_store_dwordx4 v[80:83], v3, s[4:7], s36 offen offset:0 sc1
  buffer_store_dwordx4 v[84:87], v3, s[4:7], s36 offen offset:1024 sc1
  v_pk_mul_f32 v[64:65], v[120:121], v[228:229] op_sel:[0,1] op_sel_hi:[1,1]
  v_pk_fma_f32 v[168:169], v[168:169], v[228:229], v[64:65] op_sel_hi:[1,0,1]
  v_pk_mul_f32 v[66:67], v[122:123], v[228:229] op_sel:[0,1] op_sel_hi:[1,1]
  v_pk_fma_f32 v[170:171], v[170:171], v[228:229], v[66:67] op_sel_hi:[1,0,1]
  v_pk_mul_f32 v[68:69], v[124:125], v[228:229] op_sel:[0,1] op_sel_hi:[1,1]
  v_pk_fma_f32 v[184:185], v[184:185], v[228:229], v[68:69] op_sel_hi:[1,0,1]
  v_pk_mul_f32 v[70:71], v[126:127], v[228:229] op_sel:[0,1] op_sel_hi:[1,1]
  v_pk_fma_f32 v[186:187], v[186:187], v[228:229], v[70:71] op_sel_hi:[1,0,1]
  v_cvt_pk_bf16_f32 v96, v168, v169
  v_cvt_pk_bf16_f32 v97, v170, v171
  v_cvt_pk_bf16_f32 v98, v184, v185
  v_cvt_pk_bf16_f32 v99, v186, v187
  v_pk_mul_f32 v[64:65], v[120:121], v[230:231] op_sel:[0,1] op_sel_hi:[1,1]
  v_pk_fma_f32 v[172:173], v[172:173], v[230:231], v[64:65] op_sel_hi:[1,0,1]
  v_pk_mul_f32 v[66:67], v[122:123], v[230:231] op_sel:[0,1] op_sel_hi:[1,1]
  v_pk_fma_f32 v[174:175], v[174:175], v[230:231], v[66:67] op_sel_hi:[1,0,1]
  v_pk_mul_f32 v[68:69], v[124:125], v[230:231] op_sel:[0,1] op_sel_hi:[1,1]
  v_pk_fma_f32 v[188:189], v[188:189], v[230:231], v[68:69] op_sel_hi:[1,0,1]
  v_pk_mul_f32 v[70:71], v[126:127], v[230:231] op_sel:[0,1] op_sel_hi:[1,1]
  v_pk_fma_f32 v[190:191], v[190:191], v[230:231], v[70:71] op_sel_hi:[1,0,1]
  v_cvt_pk_bf16_f32 v100, v172, v173
  v_cvt_pk_bf16_f32 v101, v174, v175
  v_cvt_pk_bf16_f32 v102, v188, v189
  v_cvt_pk_bf16_f32 v103, v190, v191
  v_permlane16_swap_b32 v96, v100
  v_permlane16_swap_b32 v97, v101
  v_permlane16_swap_b32 v98, v102
  v_permlane16_swap_b32 v99, v103
  buffer_store_dwordx4 v[96:99], v3, s[4:7], s37 offen offset:0 sc1
  buffer_store_dwordx4 v[100:103], v3, s[4:7], s37 offen offset:1024 sc1
  s_waitcnt lgkmcnt(0)
  v_pk_mul_f32 v[64:65], v[48:49], v[24:25] op_sel_hi:[1,0]
  v_pk_fma_f32 v[192:193], v[192:193], v[32:33], v[64:65]
  v_pk_mul_f32 v[66:67], v[50:51], v[24:25] op_sel_hi:[1,0]
  v_pk_fma_f32 v[194:195], v[194:195], v[34:35], v[66:67]
  v_pk_mul_f32 v[68:69], v[48:49], v[26:27] op_sel_hi:[1,0]
  v_pk_fma_f32 v[208:209], v[208:209], v[32:33], v[68:69]
  v_pk_mul_f32 v[70:71], v[50:51], v[26:27] op_sel_hi:[1,0]
  v_pk_fma_f32 v[210:211], v[210:211], v[34:35], v[70:71]
  v_cvt_pk_bf16_f32 v88, v192, v193
  v_cvt_pk_bf16_f32 v90, v208, v209
  v_cvt_pk_bf16_f32 v89, v194, v195
  v_cvt_pk_bf16_f32 v91, v210, v211
  v_pk_mul_f32 v[64:65], v[52:53], v[24:25] op_sel_hi:[1,0]
  v_pk_fma_f32 v[196:197], v[196:197], v[36:37], v[64:65]
  v_pk_mul_f32 v[66:67], v[54:55], v[24:25] op_sel_hi:[1,0]
  v_pk_fma_f32 v[198:199], v[198:199], v[38:39], v[66:67]
  v_pk_mul_f32 v[68:69], v[52:53], v[26:27] op_sel_hi:[1,0]
  v_pk_fma_f32 v[212:213], v[212:213], v[36:37], v[68:69]
  v_pk_mul_f32 v[70:71], v[54:55], v[26:27] op_sel_hi:[1,0]
  v_pk_fma_f32 v[214:215], v[214:215], v[38:39], v[70:71]
  v_cvt_pk_bf16_f32 v92, v196, v197
  v_cvt_pk_bf16_f32 v94, v212, v213
  v_cvt_pk_bf16_f32 v93, v198, v199
  v_cvt_pk_bf16_f32 v95, v214, v215
  v_permlane16_swap_b32 v88, v90
  v_permlane16_swap_b32 v89, v91
  v_permlane16_swap_b32 v92, v94
  v_permlane16_swap_b32 v93, v95
  v_permlane32_swap_b32 v88, v90
  v_permlane32_swap_b32 v89, v91
  v_permlane32_swap_b32 v92, v94
  v_permlane32_swap_b32 v93, v95
  buffer_store_dwordx4 v[88:91], v3, s[4:7], s36 offen offset:2048 sc1
  buffer_store_dwordx4 v[92:95], v3, s[4:7], s36 offen offset:3072 sc1
  v_pk_mul_f32 v[64:65], v[56:57], v[24:25] op_sel_hi:[1,0]
  v_pk_fma_f32 v[200:201], v[200:201], v[40:41], v[64:65]
  v_pk_mul_f32 v[66:67], v[58:59], v[24:25] op_sel_hi:[1,0]
  v_pk_fma_f32 v[202:203], v[202:203], v[42:43], v[66:67]
  v_pk_mul_f32 v[68:69], v[56:57], v[26:27] op_sel_hi:[1,0]
  v_pk_fma_f32 v[216:217], v[216:217], v[40:41], v[68:69]
  v_pk_mul_f32 v[70:71], v[58:59], v[26:27] op_sel_hi:[1,0]
  v_pk_fma_f32 v[218:219], v[218:219], v[42:43], v[70:71]
  v_cvt_pk_bf16_f32 v104, v200, v201
  v_cvt_pk_bf16_f32 v106, v216, v217
  v_cvt_pk_bf16_f32 v105, v202, v203
  v_cvt_pk_bf16_f32 v107, v218, v219
  v_pk_mul_f32 v[64:65], v[60:61], v[24:25] op_sel_hi:[1,0]
  v_pk_fma_f32 v[204:205], v[204:205], v[44:45], v[64:65]
  v_pk_mul_f32 v[66:67], v[62:63], v[24:25] op_sel_hi:[1,0]
  v_pk_fma_f32 v[206:207], v[206:207], v[46:47], v[66:67]
  v_pk_mul_f32 v[68:69], v[60:61], v[26:27] op_sel_hi:[1,0]
  v_pk_fma_f32 v[220:221], v[220:221], v[44:45], v[68:69]
  v_pk_mul_f32 v[70:71], v[62:63], v[26:27] op_sel_hi:[1,0]
  v_pk_fma_f32 v[222:223], v[222:223], v[46:47], v[70:71]
  v_cvt_pk_bf16_f32 v108, v204, v205
  v_cvt_pk_bf16_f32 v110, v220, v221
  v_cvt_pk_bf16_f32 v109, v206, v207
  v_cvt_pk_bf16_f32 v111, v222, v223
  v_permlane16_swap_b32 v104, v106
  v_permlane16_swap_b32 v105, v107
  v_permlane16_swap_b32 v108, v110
  v_permlane16_swap_b32 v109, v111
  v_permlane32_swap_b32 v104, v106
  v_permlane32_swap_b32 v105, v107
  v_permlane32_swap_b32 v108, v110
  v_permlane32_swap_b32 v109, v111
  buffer_store_dwordx4 v[104:107], v3, s[4:7], s37 offen offset:2048 sc1
  buffer_store_dwordx4 v[108:111], v3, s[4:7], s37 offen offset:3072 sc1
  v_mul_f32 v224, 0.25503486164919736, v224
  v_mul_f32 v225, 0.25503486164919736, v225
  v_mul_f32 v226, 0.25503486164919736, v226
  v_mul_f32 v227, 0.25503486164919736, v227
  v_mul_f32 v228, 0.25503486164919736, v228
  v_mul_f32 v229, 0.25503486164919736, v229
  v_mul_f32 v230, 0.25503486164919736, v230
  v_mul_f32 v231, 0.25503486164919736, v231
  v_pk_mul_f32 v[64:65], v[112:113], v[224:225] op_sel:[0,1] op_sel_hi:[1,1]
  v_pk_fma_f32 v[128:129], v[128:129], v[224:225], v[64:65] op_sel_hi:[1,0,1]
  v_pk_mul_f32 v[66:67], v[114:115], v[224:225] op_sel:[0,1] op_sel_hi:[1,1]
  v_pk_fma_f32 v[130:131], v[130:131], v[224:225], v[66:67] op_sel_hi:[1,0,1]
  v_pk_mul_f32 v[68:69], v[116:117], v[224:225] op_sel:[0,1] op_sel_hi:[1,1]
  v_pk_fma_f32 v[144:145], v[144:145], v[224:225], v[68:69] op_sel_hi:[1,0,1]
  v_pk_mul_f32 v[70:71], v[118:119], v[224:225] op_sel:[0,1] op_sel_hi:[1,1]
  v_pk_fma_f32 v[146:147], v[146:147], v[224:225], v[70:71] op_sel_hi:[1,0,1]
  v_cvt_pk_bf16_f32 v16, v128, v129
  v_cvt_pk_bf16_f32 v17, v130, v131
  v_cvt_pk_bf16_f32 v18, v144, v145
  v_cvt_pk_bf16_f32 v19, v146, v147
  v_pk_mul_f32 v[64:65], v[112:113], v[226:227] op_sel:[0,1] op_sel_hi:[1,1]
  v_pk_fma_f32 v[132:133], v[132:133], v[226:227], v[64:65] op_sel_hi:[1,0,1]
  v_pk_mul_f32 v[66:67], v[114:115], v[226:227] op_sel:[0,1] op_sel_hi:[1,1]
  v_pk_fma_f32 v[134:135], v[134:135], v[226:227], v[66:67] op_sel_hi:[1,0,1]
  v_pk_mul_f32 v[68:69], v[116:117], v[226:227] op_sel:[0,1] op_sel_hi:[1,1]
  v_pk_fma_f32 v[148:149], v[148:149], v[226:227], v[68:69] op_sel_hi:[1,0,1]
  v_pk_mul_f32 v[70:71], v[118:119], v[226:227] op_sel:[0,1] op_sel_hi:[1,1]
  v_pk_fma_f32 v[150:151], v[150:151], v[226:227], v[70:71] op_sel_hi:[1,0,1]
  v_cvt_pk_bf16_f32 v20, v132, v133
  v_cvt_pk_bf16_f32 v21, v134, v135
  v_cvt_pk_bf16_f32 v22, v148, v149
  v_cvt_pk_bf16_f32 v23, v150, v151
  v_permlane16_swap_b32 v16, v20
  v_permlane16_swap_b32 v17, v21
  v_permlane16_swap_b32 v18, v22
  v_permlane16_swap_b32 v19, v23
  ds_write_b128 v8, v[16:19] offset:0
  ds_write_b128 v8, v[20:23] offset:1024
  v_pk_mul_f32 v[64:65], v[112:113], v[228:229] op_sel:[0,1] op_sel_hi:[1,1]
  v_pk_fma_f32 v[136:137], v[136:137], v[228:229], v[64:65] op_sel_hi:[1,0,1]
  v_pk_mul_f32 v[66:67], v[114:115], v[228:229] op_sel:[0,1] op_sel_hi:[1,1]
  v_pk_fma_f32 v[138:139], v[138:139], v[228:229], v[66:67] op_sel_hi:[1,0,1]
  v_pk_mul_f32 v[68:69], v[116:117], v[228:229] op_sel:[0,1] op_sel_hi:[1,1]
  v_pk_fma_f32 v[152:153], v[152:153], v[228:229], v[68:69] op_sel_hi:[1,0,1]
  v_pk_mul_f32 v[70:71], v[118:119], v[228:229] op_sel:[0,1] op_sel_hi:[1,1]
  v_pk_fma_f32 v[154:155], v[154:155], v[228:229], v[70:71] op_sel_hi:[1,0,1]
  v_cvt_pk_bf16_f32 v24, v136, v137
  v_cvt_pk_bf16_f32 v25, v138, v139
  v_cvt_pk_bf16_f32 v26, v152, v153
  v_cvt_pk_bf16_f32 v27, v154, v155
  v_pk_mul_f32 v[64:65], v[112:113], v[230:231] op_sel:[0,1] op_sel_hi:[1,1]
  v_pk_fma_f32 v[140:141], v[140:141], v[230:231], v[64:65] op_sel_hi:[1,0,1]
  v_pk_mul_f32 v[66:67], v[114:115], v[230:231] op_sel:[0,1] op_sel_hi:[1,1]
  v_pk_fma_f32 v[142:143], v[142:143], v[230:231], v[66:67] op_sel_hi:[1,0,1]
  v_pk_mul_f32 v[68:69], v[116:117], v[230:231] op_sel:[0,1] op_sel_hi:[1,1]
  v_pk_fma_f32 v[156:157], v[156:157], v[230:231], v[68:69] op_sel_hi:[1,0,1]
  v_pk_mul_f32 v[70:71], v[118:119], v[230:231] op_sel:[0,1] op_sel_hi:[1,1]
  v_pk_fma_f32 v[158:159], v[158:159], v[230:231], v[70:71] op_sel_hi:[1,0,1]
  v_cvt_pk_bf16_f32 v28, v140, v141
  v_cvt_pk_bf16_f32 v29, v142, v143
  v_cvt_pk_bf16_f32 v30, v156, v157
  v_cvt_pk_bf16_f32 v31, v158, v159
  v_permlane16_swap_b32 v24, v28
  v_permlane16_swap_b32 v25, v29
  v_permlane16_swap_b32 v26, v30
  v_permlane16_swap_b32 v27, v31
  ds_write_b128 v8, v[24:27] offset:2048
  ds_write_b128 v8, v[28:31] offset:3072
  s_branch .fz_kernel_att
.fz_kernel_q_help1:
  s_waitcnt lgkmcnt(0)
  s_mov_b32 s3, 32
  s_cmp_eq_u32 s16, 7
  s_cbranch_scc1 .fz_kernel_q_h7
  s_getpc_b64 s[0:1]
.fz_kernel_ct4:
  s_sub_u32 s0, s0, .fz_kernel_ct4-fz_kernel
  s_subb_u32 s1, s1, 0
  s_lshr_b32 s31, s2, 3
  s_mulk_i32 s31, 0x500
  v_lshl_add_u32 v1, v2, 7, s31
  v_min_u32 v1, .fz_kernel_last-fz_kernel, v1
  s_mov_b64 exec, 0x3ff
  global_load_dword v1, v1, s[0:1]
  s_mov_b64 exec, -1
.fz_kernel_ct4e:
  s_mov_b32 s12, s58
  s_mov_b32 s13, s59
  s_mov_b32 s14, 0x100
  s_mov_b32 s15, 0x00020000
  s_mov_b32 s30, 0
  s_and_b32 s31, s18, 3
  s_sub_u32 s31, s31, s30
  s_and_b32 s30, s31, 3
  s_lshl_b32 s30, s30, 14
  v_and_b32 v20, 15, v2
  v_lshrrev_b32 v21, 4, v2
  v_bfe_u32 v22, v2, 1, 3
  v_xor_b32 v22, v22, v21
  v_lshlrev_b32 v21, 7, v20
  v_lshl_add_u32 v21, v22, 4, v21
  v_add_u32 v21, s30, v21
  v_xor_b32 v22, 64, v21
  v_lshlrev_b32 v20, 3, v20
  s_lshl_b32 s30, s17, 10
  s_add_u32 s30, s30, 0x1808000
  s_mov_b32 exec_lo, 0x00f0000f
  s_mov_b32 exec_hi, 0xf0000f00
  v_add_u32 v20, 4, v20
  s_mov_b64 exec, -1
  v_mov_b32 v24, 0x3f803f80
  v_mov_b32 v25, v24
  v_mov_b32 v26, v24
  v_mov_b32 v27, v24
  s_lshl_b32 s31, s31, 1
  s_sub_u32 s31, 31, s31
  s_mov_b32 s20, s48
  s_mov_b32 s21, s49
  s_mov_b32 s22, 0x800
  s_mov_b32 s23, 0x00020000
  v_lshlrev_b32 v40, 5, v2
  buffer_load_dwordx4 v[44:47], v40, s[20:23], 0 offen
  buffer_load_dwordx4 v[48:51], v40, s[20:23], 0 offen offset:16
  v_mov_b32 v40, 0
  s_waitcnt vmcnt(0)
  v_lshlrev_b32 v41, 16, v44
  v_and_b32 v42, 0xffff0000, v44
  v_add_f32 v40, v40, v41
  v_add_f32 v40, v40, v42
  v_lshlrev_b32 v41, 16, v45
  v_and_b32 v42, 0xffff0000, v45
  v_add_f32 v40, v40, v41
  v_add_f32 v40, v40, v42
  v_lshlrev_b32 v41, 16, v46
  v_and_b32 v42, 0xffff0000, v46
  v_add_f32 v40, v40, v41
  v_add_f32 v40, v40, v42
  v_lshlrev_b32 v41, 16, v47
  v_and_b32 v42, 0xffff0000, v47
  v_add_f32 v40, v40, v41
  v_add_f32 v40, v40, v42
  v_lshlrev_b32 v41, 16, v48
  v_and_b32 v42, 0xffff0000, v48
  v_add_f32 v40, v40, v41
  v_add_f32 v40, v40, v42
  v_lshlrev_b32 v41, 16, v49
  v_and_b32 v42, 0xffff0000, v49
  v_add_f32 v40, v40, v41
  v_add_f32 v40, v40, v42
  v_lshlrev_b32 v41, 16, v50
  v_and_b32 v42, 0xffff0000, v50
  v_add_f32 v40, v40, v41
  v_add_f32 v40, v40, v42
  v_lshlrev_b32 v41, 16, v51
  v_and_b32 v42, 0xffff0000, v51
  v_add_f32 v40, v40, v41
  v_add_f32 v40, v40, v42
  s_nop 1
  v_add_f32 v40, v40, v40 quad_perm:[1,0,3,2] row_mask:0xf bank_mask:0xf
  s_nop 1
  v_add_f32 v40, v40, v40 quad_perm:[2,3,0,1] row_mask:0xf bank_mask:0xf
  s_nop 1
  v_add_f32 v40, v40, v40 row_half_mirror row_mask:0xf bank_mask:0xf
  s_nop 1
  v_add_f32 v40, v40, v40 row_mirror row_mask:0xf bank_mask:0xf
  s_nop 0
  v_readlane_b32 s20, v40, 16
  v_readlane_b32 s21, v40, 32
  v_readlane_b32 s22, v40, 48
  v_add_f32 v40, s20, v40
  v_add_f32 v40, s21, v40
  v_add_f32 v40, s22, v40
  v_mul_f32 v40, 0x3a800000, v40
  s_nop 0
  v_readfirstlane_b32 s76, v40
.fz_kernel_xs5:
  s_barrier
  s_sub_u32 s3, s3, 1
  s_cmp_lg_u32 s3, s31
  s_cbranch_scc1 .fz_kernel_xs5
  ds_read_b128 v[64:67], v21 offset:0
  ds_read_b128 v[72:75], v21 offset:2048
  ds_read_b128 v[80:83], v21 offset:4096
  ds_read_b128 v[88:91], v21 offset:6144
  ds_read_b128 v[96:99], v21 offset:8192
  ds_read_b128 v[104:107], v21 offset:10240
  ds_read_b128 v[112:115], v21 offset:12288
  ds_read_b128 v[120:123], v21 offset:14336
  ds_read_b128 v[68:71], v22 offset:0
  ds_read_b128 v[76:79], v22 offset:2048
  ds_read_b128 v[84:87], v22 offset:4096
  ds_read_b128 v[92:95], v22 offset:6144
  ds_read_b128 v[100:103], v22 offset:8192
  ds_read_b128 v[108:111], v22 offset:10240
  ds_read_b128 v[116:119], v22 offset:12288
  ds_read_b128 v[124:127], v22 offset:14336
  s_waitcnt lgkmcnt(0)
  s_cmp_eq_u32 s3, 0
  s_cbranch_scc1 .fz_kernel_hb6
  s_barrier
  s_sub_u32 s3, s3, 1
.fz_kernel_hb6:
  s_setprio 2
  v_mfma_f32_16x16x32_bf16 v[128:131], v[24:27], v[64:67], 0
  v_mfma_f32_16x16x32_bf16 v[160:163], v[64:67], v[64:67], 0
  v_mfma_f32_16x16x32_bf16 v[132:135], v[24:27], v[72:75], 0
  v_mfma_f32_16x16x32_bf16 v[164:167], v[72:75], v[72:75], 0
  v_mfma_f32_16x16x32_bf16 v[136:139], v[24:27], v[80:83], 0
  v_mfma_f32_16x16x32_bf16 v[168:171], v[80:83], v[80:83], 0
  v_mfma_f32_16x16x32_bf16 v[140:143], v[24:27], v[88:91], 0
  v_mfma_f32_16x16x32_bf16 v[172:175], v[88:91], v[88:91], 0
  v_mfma_f32_16x16x32_bf16 v[144:147], v[24:27], v[96:99], 0
  v_mfma_f32_16x16x32_bf16 v[176:179], v[96:99], v[96:99], 0
  v_mfma_f32_16x16x32_bf16 v[148:151], v[24:27], v[104:107], 0
  v_mfma_f32_16x16x32_bf16 v[180:183], v[104:107], v[104:107], 0
  v_mfma_f32_16x16x32_bf16 v[152:155], v[24:27], v[112:115], 0
  v_mfma_f32_16x16x32_bf16 v[184:187], v[112:115], v[112:115], 0
  v_mfma_f32_16x16x32_bf16 v[156:159], v[24:27], v[120:123], 0
  v_mfma_f32_16x16x32_bf16 v[188:191], v[120:123], v[120:123], 0
  v_mfma_f32_16x16x32_bf16 v[128:131], v[24:27], v[68:71], v[128:131]
  v_mfma_f32_16x16x32_bf16 v[160:163], v[68:71], v[68:71], v[160:163]
  v_mfma_f32_16x16x32_bf16 v[132:135], v[24:27], v[76:79], v[132:135]
  v_mfma_f32_16x16x32_bf16 v[164:167], v[76:79], v[76:79], v[164:167]
  v_mfma_f32_16x16x32_bf16 v[136:139], v[24:27], v[84:87], v[136:139]
  v_mfma_f32_16x16x32_bf16 v[168:171], v[84:87], v[84:87], v[168:171]
  v_mfma_f32_16x16x32_bf16 v[140:143], v[24:27], v[92:95], v[140:143]
  v_mfma_f32_16x16x32_bf16 v[172:175], v[92:95], v[92:95], v[172:175]
  v_mfma_f32_16x16x32_bf16 v[144:147], v[24:27], v[100:103], v[144:147]
  v_mfma_f32_16x16x32_bf16 v[176:179], v[100:103], v[100:103], v[176:179]
  v_mfma_f32_16x16x32_bf16 v[148:151], v[24:27], v[108:111], v[148:151]
  v_mfma_f32_16x16x32_bf16 v[180:183], v[108:111], v[108:111], v[180:183]
  v_mfma_f32_16x16x32_bf16 v[152:155], v[24:27], v[116:119], v[152:155]
  v_mfma_f32_16x16x32_bf16 v[184:187], v[116:119], v[116:119], v[184:187]
  v_mfma_f32_16x16x32_bf16 v[156:159], v[24:27], v[124:127], v[156:159]
  v_mfma_f32_16x16x32_bf16 v[188:191], v[124:127], v[124:127], v[188:191]
  s_setprio 0
  s_cmp_eq_u32 s3, 0
  s_cbranch_scc1 .fz_kernel_hb7
  s_barrier
  s_sub_u32 s3, s3, 1
.fz_kernel_hb7:
  s_mov_b32 exec_lo, 0x100001
  s_mov_b32 exec_hi, 0x10000100
  buffer_load_dword v9, v4, s[12:15], 0 offen sc1
  v_mov_b32 v128, v160
  v_mov_b32 v132, v164
  v_mov_b32 v136, v168
  v_mov_b32 v140, v172
  v_mov_b32 v144, v176
  v_mov_b32 v148, v180
  v_mov_b32 v152, v184
  v_mov_b32 v156, v188
  s_mov_b32 exec_lo, 0x200002
  s_mov_b32 exec_hi, 0x20000200
  v_mov_b32 v128, v161
  v_mov_b32 v132, v165
  v_mov_b32 v136, v169
  v_mov_b32 v140, v173
  v_mov_b32 v144, v177
  v_mov_b32 v148, v181
  v_mov_b32 v152, v185
  v_mov_b32 v156, v189
  s_mov_b32 exec_lo, 0x400004
  s_mov_b32 exec_hi, 0x40000400
  v_mov_b32 v128, v162
  v_mov_b32 v132, v166
  v_mov_b32 v136, v170
  v_mov_b32 v140, v174
  v_mov_b32 v144, v178
  v_mov_b32 v148, v182
  v_mov_b32 v152, v186
  v_mov_b32 v156, v190
  s_mov_b32 exec_lo, 0x800008
  s_mov_b32 exec_hi, 0x80000800
  v_mov_b32 v128, v163
  v_mov_b32 v132, v167
  v_mov_b32 v136, v171
  v_mov_b32 v140, v175
  v_mov_b32 v144, v179
  v_mov_b32 v148, v183
  v_mov_b32 v152, v187
  v_mov_b32 v156, v191
  s_mov_b64 exec, 1
  s_mov_b32 s38, 0
.fz_kernel_pw8:
  s_mov_b32 s46, 0
  s_call_b64 s[0:1], .fz_kernel_hw
  s_waitcnt vmcnt(0)
  v_readfirstlane_b32 s31, v9
  s_cmp_eq_u32 s31, 64
  s_cbranch_scc1 .fz_kernel_pw8d
  s_cmp_eq_u32 s3, 0
  s_cbranch_scc1 .fz_kernel_hb9
  s_barrier
  s_sub_u32 s3, s3, 1
.fz_kernel_hb9:
  s_cmp_eq_u32 s3, 0
  s_cbranch_scc1 .fz_kernel_hb10
  s_barrier
  s_sub_u32 s3, s3, 1
.fz_kernel_hb10:
  buffer_load_dword v9, v4, s[12:15], 0 offen sc1
  s_add_u32 s38, s38, 1
  s_cmp_lt_u32 s38, 131072
  s_cbranch_scc1 .fz_kernel_pw8
  s_waitcnt vmcnt(0)
.fz_kernel_pw8d:
  s_mov_b64 exec, -1
  s_mov_b32 exec_lo, 0x00fff00f
  s_mov_b32 exec_hi, 0xff000ff0
  buffer_atomic_add_f32 v128, v20, s[4:7], s30 offen offset:0 sc1
  buffer_atomic_add_f32 v132, v20, s[4:7], s30 offen offset:128 sc1
  buffer_atomic_add_f32 v136, v20, s[4:7], s30 offen offset:256 sc1
  buffer_atomic_add_f32 v140, v20, s[4:7], s30 offen offset:384 sc1
  buffer_atomic_add_f32 v144, v20, s[4:7], s30 offen offset:512 sc1
  buffer_atomic_add_f32 v148, v20, s[4:7], s30 offen offset:640 sc1
  buffer_atomic_add_f32 v152, v20, s[4:7], s30 offen offset:768 sc1
  buffer_atomic_add_f32 v156, v20, s[4:7], s30 offen offset:896 sc1
  s_mov_b64 exec, -1
  s_mov_b32 s46, 0
  s_call_b64 s[0:1], .fz_kernel_hw
  s_waitcnt vmcnt(0)
  v_lshlrev_b32 v7, 11, v2
  s_lshl_b32 s31, s17, 7
  s_lshl_b32 s33, 1, s18
  s_add_u32 s31, s31, s67
  s_add_u32 s31, s31, 0x1800018
  v_mov_b32 v8, s33
  s_mov_b64 exec, 0xffff
  buffer_atomic_or v8, v7, s[4:7], s31 offen sc1
  s_mov_b64 exec, -1
  s_add_u32 s37, s19, 24
.fz_kernel_f111:
  s_cmp_le_u32 s3, 8
  s_cbranch_scc1 .fz_kernel_f111d
  s_barrier
  s_sub_u32 s3, s3, 1
  s_branch .fz_kernel_f111
.fz_kernel_f111d:
  s_mov_b64 exec, 1
  buffer_load_dword v9, v4, s[4:7], s37 offen sc1
  s_mov_b64 exec, 1
  s_mov_b32 s38, 0
.fz_kernel_pw12:
  s_mov_b32 s46, 0
  s_call_b64 s[0:1], .fz_kernel_hw
  s_waitcnt vmcnt(0)
  v_readfirstlane_b32 s31, v9
  s_cmp_eq_u32 s31, 65535
  s_cbranch_scc1 .fz_kernel_pw12d
  s_cmp_eq_u32 s3, 0
  s_cbranch_scc1 .fz_kernel_hb13
  s_barrier
  s_sub_u32 s3, s3, 1
.fz_kernel_hb13:
  s_cmp_eq_u32 s3, 0
  s_cbranch_scc1 .fz_kernel_hb14
  s_barrier
  s_sub_u32 s3, s3, 1
.fz_kernel_hb14:
  buffer_load_dword v9, v4, s[4:7], s37 offen sc1
  s_add_u32 s38, s38, 1
  s_cmp_lt_u32 s38, 131072
  s_cbranch_scc1 .fz_kernel_pw12
  s_waitcnt vmcnt(0)
.fz_kernel_pw12d:
  s_mov_b64 exec, -1
  buffer_load_dwordx4 v[64:67], v3, s[4:7], s30 offen sc1
  s_mov_b32 s46, 0
  s_call_b64 s[0:1], .fz_kernel_hw
  s_waitcnt vmcnt(0)
  v_mov_b32 v26, 0.0009765625
  v_mul_f32 v20, v26, v64
  v_mul_f32 v27, v20, v20
  v_fma_f32 v22, v65, v26, -v27
  v_max_f32 v22, 0, v22
  v_add_f32 v22, 1e-05, v22
  v_rsq_f32 v22, v22
  s_nop 0
  v_mul_f32 v20, v20, v22
  v_sub_f32 v20, 0, v20
  v_mul_f32 v21, v26, v66
  v_mul_f32 v27, v21, v21
  v_fma_f32 v23, v67, v26, -v27
  v_max_f32 v23, 0, v23
  v_add_f32 v23, 1e-05, v23
  v_rsq_f32 v23, v23
  s_nop 0
  v_mul_f32 v21, v21, v23
  v_sub_f32 v21, 0, v21
  v_lshlrev_b32 v24, 3, v2
  v_add_u32 v24, 155648, v24
  ds_write_b64 v24, v[22:23] offset:4608
  ds_write_b64 v24, v[20:21] offset:5120
  v_mov_b32 v20, 1.0
  v_mov_b32 v21, 1.0
  v_mov_b32 v22, 0
  v_mov_b32 v23, 0
  ds_write_b64 v24, v[20:21] offset:6400
  ds_write_b64 v24, v[22:23] offset:6912
  v_mov_b32 v24, 159952
  v_mov_b32 v25, s76
  ds_write_b32 v24, v25 offset:8
  s_waitcnt lgkmcnt(0)
.fz_kernel_q_hw2:
  s_add_u32 s3, s3, 2
.fz_kernel_q_he:
  s_cmp_eq_u32 s3, 0
  s_cbranch_scc1 .fz_kernel_chain
  s_barrier
  s_sub_u32 s3, s3, 1
  s_branch .fz_kernel_q_he
.fz_kernel_q_h7:
  s_mov_b32 s8, s58
  s_mov_b32 s9, s59
  s_mov_b32 s10, 0x100
  s_mov_b32 s11, 0x00020000
  v_mov_b32 v12, 0
  v_mov_b32 v13, 0
  v_mov_b32 v14, 0
  v_mov_b32 v15, 0
  s_cmp_ge_u32 s2, 64
  s_cbranch_scc1 .fz_kernel_q_nzero
  s_lshl_b32 s36, s2, 10
  s_add_u32 s36, s36, 0x1800000
  buffer_store_dwordx4 v[12:15], v3, s[4:7], s36 offen sc1
.fz_kernel_q_nzero:
  v_and_b32 v21, 7, v2
  v_and_b32 v20, 16, v2
  v_lshlrev_b32 v20, 1, v20
  v_xor_b32 v20, v20, v3
  s_bfe_u32 s33, s17, 0x10002
  s_lshl_b32 s33, s33, 1
  s_and_b32 s31, s33, 3
  s_mul_i32 s31, s31, 12288
  s_add_u32 s31, s31, 65536
  v_add_u32 v16, s31, v20
  v_xor_b32 v17, 64, v16
  s_add_u32 s31, s31, 12288
  v_add_u32 v18, s31, v20
  v_xor_b32 v19, 64, v18
  s_sub_u32 s33, 31, s33
  v_lshlrev_b32 v21, 5, v21
  v_and_b32 v22, 24, v2
  v_add_u32 v21, v22, v21
  v_lshrrev_b32 v22, 5, v2
  v_lshl_add_u32 v21, v22, 2, v21
  s_lshl_b32 s30, s18, 10
  s_add_u32 s30, s30, 0x180c000
  v_and_b32 v22, 1, v2
  v_lshlrev_b32 v22, 4, v22
  v_mov_b32 v23, 0x3f80
  v_lshlrev_b32 v22, v22, v23
  v_mov_b32 v24, 0
  v_mov_b32 v25, 0
  v_mov_b32 v26, 0
  v_mov_b32 v27, 0
  s_mov_b32 exec_lo, 0x3030303
  s_mov_b32 exec_hi, 0x3030303
  v_mov_b32 v24, v22
  s_mov_b32 exec_lo, 0xc0c0c0c
  s_mov_b32 exec_hi, 0xc0c0c0c
  v_mov_b32 v25, v22
  s_mov_b32 exec_lo, 0x30303030
  s_mov_b32 exec_hi, 0x30303030
  v_mov_b32 v26, v22
  s_mov_b32 exec_lo, 0xc0c0c0c0
  s_mov_b32 exec_hi, 0xc0c0c0c0
  v_mov_b32 v27, v22
  s_mov_b64 exec, -1
  s_cmp_ge_u32 s2, 64
  s_cbranch_scc1 .fz_kernel_nz2
  s_mov_b64 exec, 1
  s_waitcnt vmcnt(0)
  buffer_atomic_add v5, v4, s[8:11], 0 offen sc1
  s_mov_b64 exec, -1
.fz_kernel_nz2:
  s_barrier
  s_sub_u32 s3, s3, 1
  s_cmp_lg_u32 s3, s33
  s_cbranch_scc1 .fz_kernel_nz2
  ds_read_b128 v[64:67], v16 offset:0
  ds_read_b128 v[68:71], v16 offset:4096
  ds_read_b128 v[72:75], v16 offset:8192
  ds_read_b128 v[76:79], v17 offset:1024
  ds_read_b128 v[80:83], v17 offset:5120
  ds_read_b128 v[84:87], v17 offset:9216
  ds_read_b128 v[88:91], v16 offset:2048
  ds_read_b128 v[92:95], v16 offset:6144
  ds_read_b128 v[96:99], v16 offset:10240
  ds_read_b128 v[100:103], v17 offset:3072
  ds_read_b128 v[104:107], v17 offset:7168
  ds_read_b128 v[108:111], v17 offset:11264
  s_waitcnt lgkmcnt(0)
  s_cmp_eq_u32 s3, 0
  s_cbranch_scc1 .fz_kernel_hb15
  s_barrier
  s_sub_u32 s3, s3, 1
.fz_kernel_hb15:
  ds_read_b128 v[112:115], v18 offset:0
  ds_read_b128 v[116:119], v18 offset:4096
  ds_read_b128 v[120:123], v18 offset:8192
  ds_read_b128 v[124:127], v19 offset:1024
  ds_read_b128 v[128:131], v19 offset:5120
  ds_read_b128 v[132:135], v19 offset:9216
  ds_read_b128 v[136:139], v18 offset:2048
  ds_read_b128 v[140:143], v18 offset:6144
  ds_read_b128 v[144:147], v18 offset:10240
  ds_read_b128 v[148:151], v19 offset:3072
  ds_read_b128 v[152:155], v19 offset:7168
  ds_read_b128 v[156:159], v19 offset:11264
  s_waitcnt lgkmcnt(0)
  s_cmp_eq_u32 s3, 0
  s_cbranch_scc1 .fz_kernel_hb16
  s_barrier
  s_sub_u32 s3, s3, 1
.fz_kernel_hb16:
  s_setprio 2
  v_mfma_f32_16x16x32_bf16 v[160:163], v[24:27], v[64:67], 0
  v_mfma_f32_16x16x32_bf16 v[164:167], v[24:27], v[68:71], 0
  v_mfma_f32_16x16x32_bf16 v[168:171], v[24:27], v[72:75], 0
  v_mfma_f32_16x16x32_bf16 v[160:163], v[24:27], v[76:79], v[160:163]
  v_mfma_f32_16x16x32_bf16 v[164:167], v[24:27], v[80:83], v[164:167]
  v_mfma_f32_16x16x32_bf16 v[168:171], v[24:27], v[84:87], v[168:171]
  v_mfma_f32_16x16x32_bf16 v[160:163], v[24:27], v[88:91], v[160:163]
  v_mfma_f32_16x16x32_bf16 v[164:167], v[24:27], v[92:95], v[164:167]
  v_mfma_f32_16x16x32_bf16 v[168:171], v[24:27], v[96:99], v[168:171]
  v_mfma_f32_16x16x32_bf16 v[160:163], v[24:27], v[100:103], v[160:163]
  v_mfma_f32_16x16x32_bf16 v[164:167], v[24:27], v[104:107], v[164:167]
  v_mfma_f32_16x16x32_bf16 v[168:171], v[24:27], v[108:111], v[168:171]
  v_mfma_f32_16x16x32_bf16 v[160:163], v[24:27], v[112:115], v[160:163]
  v_mfma_f32_16x16x32_bf16 v[164:167], v[24:27], v[116:119], v[164:167]
  v_mfma_f32_16x16x32_bf16 v[168:171], v[24:27], v[120:123], v[168:171]
  v_mfma_f32_16x16x32_bf16 v[160:163], v[24:27], v[124:127], v[160:163]
  v_mfma_f32_16x16x32_bf16 v[164:167], v[24:27], v[128:131], v[164:167]
  v_mfma_f32_16x16x32_bf16 v[168:171], v[24:27], v[132:135], v[168:171]
  v_mfma_f32_16x16x32_bf16 v[160:163], v[24:27], v[136:139], v[160:163]
  v_mfma_f32_16x16x32_bf16 v[164:167], v[24:27], v[140:143], v[164:167]
  v_mfma_f32_16x16x32_bf16 v[168:171], v[24:27], v[144:147], v[168:171]
  v_mfma_f32_16x16x32_bf16 v[160:163], v[24:27], v[148:151], v[160:163]
  v_mfma_f32_16x16x32_bf16 v[164:167], v[24:27], v[152:155], v[164:167]
  v_mfma_f32_16x16x32_bf16 v[168:171], v[24:27], v[156:159], v[168:171]
  s_setprio 0
  s_mov_b64 exec, 1
  buffer_load_dword v9, v4, s[8:11], 0 offen sc1
  s_mov_b64 exec, -1
  s_nop 1
  v_add_f32 v160, v160, v160 row_ror:8 row_mask:0xf bank_mask:0xf
  v_add_f32 v161, v161, v161 row_ror:8 row_mask:0xf bank_mask:0xf
  v_add_f32 v162, v162, v162 row_ror:8 row_mask:0xf bank_mask:0xf
  v_add_f32 v163, v163, v163 row_ror:8 row_mask:0xf bank_mask:0xf
  v_add_f32 v164, v164, v164 row_ror:8 row_mask:0xf bank_mask:0xf
  v_add_f32 v165, v165, v165 row_ror:8 row_mask:0xf bank_mask:0xf
  v_add_f32 v166, v166, v166 row_ror:8 row_mask:0xf bank_mask:0xf
  v_add_f32 v167, v167, v167 row_ror:8 row_mask:0xf bank_mask:0xf
  v_add_f32 v168, v168, v168 row_ror:8 row_mask:0xf bank_mask:0xf
  v_add_f32 v169, v169, v169 row_ror:8 row_mask:0xf bank_mask:0xf
  v_add_f32 v170, v170, v170 row_ror:8 row_mask:0xf bank_mask:0xf
  v_add_f32 v171, v171, v171 row_ror:8 row_mask:0xf bank_mask:0xf
  s_mov_b32 exec_lo, 0x0
  s_mov_b32 exec_hi, 0xff00ff
  v_mov_b32 v160, v161
  v_mov_b32 v164, v165
  v_mov_b32 v168, v169
  s_mov_b32 exec_lo, 0xff00ff00
  s_mov_b32 exec_hi, 0x0
  v_mov_b32 v160, v162
  v_mov_b32 v164, v166
  v_mov_b32 v168, v170
  s_mov_b32 exec_lo, 0x0
  s_mov_b32 exec_hi, 0xff00ff00
  v_mov_b32 v160, v163
  v_mov_b32 v164, v167
  v_mov_b32 v168, v171
  s_mov_b64 exec, 1
  s_mov_b32 s38, 0
.fz_kernel_pw17:
  s_mov_b32 s46, 0
  s_call_b64 s[0:1], .fz_kernel_hw
  s_waitcnt vmcnt(0)
  v_readfirstlane_b32 s31, v9
  s_cmp_eq_u32 s31, 64
  s_cbranch_scc1 .fz_kernel_pw17d
  s_cmp_eq_u32 s3, 0
  s_cbranch_scc1 .fz_kernel_hb18
  s_barrier
  s_sub_u32 s3, s3, 1
.fz_kernel_hb18:
  s_cmp_eq_u32 s3, 0
  s_cbranch_scc1 .fz_kernel_hb19
  s_barrier
  s_sub_u32 s3, s3, 1
.fz_kernel_hb19:
  buffer_load_dword v9, v4, s[8:11], 0 offen sc1
  s_add_u32 s38, s38, 1
  s_cmp_lt_u32 s38, 131072
  s_cbranch_scc1 .fz_kernel_pw17
  s_waitcnt vmcnt(0)
.fz_kernel_pw17d:
  s_mov_b64 exec, -1
  buffer_atomic_add_f32 v160, v21, s[4:7], s30 offen offset:0 sc1
  buffer_atomic_add_f32 v164, v21, s[4:7], s30 offen offset:256 sc1
  buffer_atomic_add_f32 v168, v21, s[4:7], s30 offen offset:512 sc1
  s_mov_b32 s46, 0
  s_call_b64 s[0:1], .fz_kernel_hw
  s_waitcnt vmcnt(0)
  v_lshlrev_b32 v7, 7, v2
  s_lshl_b32 s31, s18, 11
  s_lshl_b32 s33, 1, s17
  s_add_u32 s31, s31, s67
  s_add_u32 s31, s31, 0x180001c
  v_mov_b32 v8, s33
  s_mov_b64 exec, 0xffff
  buffer_atomic_or v8, v7, s[4:7], s31 offen sc1
  s_mov_b64 exec, -1
  s_cmp_ge_u32 s2, 196
  s_cbranch_scc1 .fz_kernel_lz20
  s_lshl_b32 s36, s2, 12
  s_add_u32 s36, s36, 0x1c00000
  s_sub_u32 s31, s2, 66
  s_min_u32 s31, s31, s2
  s_sub_u32 s31, s31, 4
  s_cmp_lt_u32 s31, 6
  s_cbranch_scc1 .fz_kernel_lz20a
  buffer_store_dwordx4 v[12:15], v3, s[4:7], s36 offen sc1
  buffer_store_dwordx4 v[12:15], v3, s[4:7], s36 offen offset:1024 sc1
  buffer_store_dwordx4 v[12:15], v3, s[4:7], s36 offen offset:2048 sc1
  buffer_store_dwordx4 v[12:15], v3, s[4:7], s36 offen offset:3072 sc1
.fz_kernel_lz20:
  s_add_u32 s37, s19, 28
.fz_kernel_f121:
  s_cmp_le_u32 s3, 8
  s_cbranch_scc1 .fz_kernel_f121d
  s_barrier
  s_sub_u32 s3, s3, 1
  s_branch .fz_kernel_f121
.fz_kernel_f121d:
  s_mov_b64 exec, 1
  buffer_load_dword v9, v4, s[4:7], s37 offen sc1
  s_mov_b64 exec, 1
  s_mov_b32 s38, 0
.fz_kernel_pw22:
  s_mov_b32 s46, 0
  s_call_b64 s[0:1], .fz_kernel_hw
  s_waitcnt vmcnt(0)
  v_readfirstlane_b32 s31, v9
  s_cmp_eq_u32 s31, 65535
  s_cbranch_scc1 .fz_kernel_pw22d
  s_cmp_eq_u32 s3, 0
  s_cbranch_scc1 .fz_kernel_hb23
  s_barrier
  s_sub_u32 s3, s3, 1
.fz_kernel_hb23:
  s_cmp_eq_u32 s3, 0
  s_cbranch_scc1 .fz_kernel_hb24
  s_barrier
  s_sub_u32 s3, s3, 1
.fz_kernel_hb24:
  buffer_load_dword v9, v4, s[4:7], s37 offen sc1
  s_add_u32 s38, s38, 1
  s_cmp_lt_u32 s38, 131072
  s_cbranch_scc1 .fz_kernel_pw22
  s_waitcnt vmcnt(0)
.fz_kernel_pw22d:
  s_mov_b64 exec, -1
  buffer_load_dwordx4 v[64:67], v3, s[4:7], s30 offen sc1
  s_mov_b32 s46, 0
  s_call_b64 s[0:1], .fz_kernel_hw
  s_waitcnt vmcnt(0)
  v_add_u32 v24, 155648, v3
  s_mov_b32 exec_hi, 0xffff
  ds_write_b128 v24, v[64:67] offset:5632
  s_mov_b64 exec, -1
  s_waitcnt lgkmcnt(0)
  s_getpc_b64 s[0:1]
.fz_kernel_ct25:
  s_sub_u32 s0, s0, .fz_kernel_ct25-fz_kernel
  s_subb_u32 s1, s1, 0
  s_lshr_b32 s31, s2, 3
  s_mulk_i32 s31, 0x500
  v_lshl_add_u32 v1, v2, 7, s31
  v_min_u32 v1, .fz_kernel_last-fz_kernel, v1
  s_mov_b64 exec, 0x3ff
  global_load_dword v1, v1, s[0:1]
  s_mov_b64 exec, -1
.fz_kernel_ct25e:
  s_branch .fz_kernel_q_hw2
.fz_kernel_att:
  s_setprio 1
  s_and_b32 s39, s16, 1
  s_lshr_b32 s32, s16, 1
  s_lshl1_add_u32 s35, s18, s39
  s_lshl_b32 s35, s35, 5
  s_add_u32 s35, s35, s32
  s_lshl_b32 s35, s35, 13
  s_add_u32 s35, s35, s63
  s_lshl_b32 s34, 1, s17
  s_mov_b32 s36, 0
  v_add_u32 v10, 4096, v3
  v_mfma_f32_32x32x16_bf16 v[48:63], v[80:83], v[16:19], 0
  v_mfma_f32_32x32x16_bf16 v[48:63], v[84:87], v[20:23], v[48:63]
  v_mov_b32 v1, 0x3f803f80
  v_mov_b32 v11, 0x4444
  v_mov_b32 v12, v1
  v_mov_b32 v14, 0
  s_mov_b32 exec_lo, 0xaaaaaaaa
  s_mov_b32 exec_hi, 0xaaaaaaaa
  v_mov_b32 v12, 0
  v_mov_b32 v14, v1
  s_mov_b32 exec_lo, 0xcccccccc
  s_mov_b32 exec_hi, 0xcccccccc
  v_mov_b32 v11, 0xeeee
  s_mov_b64 exec, -1
  v_mov_b32 v13, v12
  v_mov_b32 v15, v14
  s_lshl_b32 s31, s16, 8
  s_add_u32 s31, s31, 147456
  v_and_b32 v1, 31, v2
  v_lshl_add_u32 v1, v1, 3, s31
  s_mov_b32 s26, 0xffff0000
  s_mov_b32 s27, 0xffff0000
  s_mov_b32 s24, 0x21800000
  s_mov_b32 s25, 0x5d800000
  s_andn2_b32 s31, 2, s16
  s_lshl2_add_u32 s31, s17, s31
  s_lshl4_add_u32 s31, s31, s18
  s_lshl1_add_u32 s31, s31, s39
  s_lshl_b32 s31, s31, 11
  s_add_u32 s28, s31, s64
  s_add_u32 s29, s28, 65536
  s_mov_b32 s73, 0
  v_mov_b32 v208, 0
  v_mov_b32 v209, 0
  v_mov_b32 v210, 0
  v_mov_b32 v211, 0
  v_mov_b32 v212, 0
  v_mov_b32 v213, 0
  v_mov_b32 v214, 0
  v_mov_b32 v215, 0
  v_mov_b32 v216, 0
  v_mov_b32 v217, 0
  v_mov_b32 v218, 0
  v_mov_b32 v219, 0
  v_mov_b32 v220, 0
  v_mov_b32 v221, 0
  v_mov_b32 v222, 0
  v_mov_b32 v223, 0
  s_mov_b32 s32, 8
  s_waitcnt lgkmcnt(0)
  s_barrier
  ds_read_b128 v[32:35], v9 offset:0
  ds_read_b128 v[36:39], v9 offset:1024
  ds_read_b128 v[40:43], v9 offset:2048
  ds_read_b128 v[44:47], v9 offset:3072
  v_mfma_f32_32x32x16_bf16 v[64:79], v[80:83], v[24:27], 0
  v_exp_f32 v48, v48
  v_exp_f32 v49, v49
  v_exp_f32 v50, v50
  v_exp_f32 v51, v51
  v_exp_f32 v52, v52
  v_exp_f32 v53, v53
  v_exp_f32 v54, v54
  v_exp_f32 v55, v55
  v_mfma_f32_32x32x16_bf16 v[64:79], v[84:87], v[28:31], v[64:79]
  v_cvt_pk_bf16_f32 v224, v48, v49
  v_cvt_pk_bf16_f32 v225, v50, v51
  v_cvt_pk_bf16_f32 v226, v52, v53
  v_cvt_pk_bf16_f32 v227, v54, v55
  v_exp_f32 v56, v56
  v_exp_f32 v57, v57
  v_exp_f32 v58, v58
  v_exp_f32 v59, v59
  v_mfma_f32_32x32x16_bf16 v[144:159], v[88:91], v[224:227], 0
  v_exp_f32 v60, v60
  v_exp_f32 v61, v61
  v_exp_f32 v62, v62
  v_exp_f32 v63, v63
  v_cvt_pk_bf16_f32 v228, v56, v57
  v_cvt_pk_bf16_f32 v229, v58, v59
  v_cvt_pk_bf16_f32 v230, v60, v61
  v_cvt_pk_bf16_f32 v231, v62, v63
  s_waitcnt lgkmcnt(0)
  v_mfma_f32_32x32x16_bf16 v[48:63], v[80:83], v[32:35], 0
  v_exp_f32 v64, v64
  v_exp_f32 v65, v65
  v_exp_f32 v66, v66
  v_exp_f32 v67, v67
  v_mfma_f32_32x32x16_bf16 v[144:159], v[92:95], v[228:231], v[144:159]
  v_exp_f32 v68, v68
  v_exp_f32 v69, v69
  v_exp_f32 v70, v70
  v_smfmac_f32_16x16x64_bf16 v[208:211], v[12:15], v[224:231], v11
  v_exp_f32 v71, v71
  v_mfma_f32_32x32x16_bf16 v[48:63], v[84:87], v[36:39], v[48:63]
  v_cvt_pk_bf16_f32 v224, v64, v65
  v_cvt_pk_bf16_f32 v225, v66, v67
  v_cvt_pk_bf16_f32 v226, v68, v69
  v_cvt_pk_bf16_f32 v227, v70, v71
  v_exp_f32 v72, v72
  v_exp_f32 v73, v73
  v_exp_f32 v74, v74
  v_exp_f32 v75, v75
  v_mfma_f32_32x32x16_bf16 v[160:175], v[88:91], v[224:227], 0
  v_exp_f32 v76, v76
  v_exp_f32 v77, v77
  v_exp_f32 v78, v78
  v_exp_f32 v79, v79
  v_cvt_pk_bf16_f32 v228, v72, v73
  v_cvt_pk_bf16_f32 v229, v74, v75
  v_cvt_pk_bf16_f32 v230, v76, v77
  v_cvt_pk_bf16_f32 v231, v78, v79
  s_mov_b64 exec, 1
  s_waitcnt vmcnt(0)
  ds_add_u32 v6, v5 offset:0x100
  s_mov_b64 exec, -1
  v_mfma_f32_32x32x16_bf16 v[64:79], v[80:83], v[40:43], 0
  v_exp_f32 v48, v48
  v_exp_f32 v49, v49
  v_exp_f32 v50, v50
  v_exp_f32 v51, v51
  v_mfma_f32_32x32x16_bf16 v[160:175], v[92:95], v[228:231], v[160:175]
  v_exp_f32 v52, v52
  v_exp_f32 v53, v53
  v_exp_f32 v54, v54
  v_smfmac_f32_16x16x64_bf16 v[212:215], v[12:15], v[224:231], v11
  v_exp_f32 v55, v55
  v_mfma_f32_32x32x16_bf16 v[64:79], v[84:87], v[44:47], v[64:79]
  v_cvt_pk_bf16_f32 v224, v48, v49
  v_cvt_pk_bf16_f32 v225, v50, v51
  v_cvt_pk_bf16_f32 v226, v52, v53
  v_cvt_pk_bf16_f32 v227, v54, v55
  v_exp_f32 v56, v56
  v_exp_f32 v57, v57
  v_exp_f32 v58, v58
  v_exp_f32 v59, v59
  v_mfma_f32_32x32x16_bf16 v[176:191], v[88:91], v[224:227], 0
  ds_read_b32 v7, v6
  v_exp_f32 v60, v60
  v_exp_f32 v61, v61
  v_exp_f32 v62, v62
  v_exp_f32 v63, v63
  v_cvt_pk_bf16_f32 v228, v56, v57
  v_cvt_pk_bf16_f32 v229, v58, v59
  v_cvt_pk_bf16_f32 v230, v60, v61
  v_cvt_pk_bf16_f32 v231, v62, v63
  s_waitcnt lgkmcnt(0)
  v_readfirstlane_b32 s39, v7
  s_andn2_b32 s33, s39, s34
  s_bcnt1_i32_b32 s31, s33
  s_cmp_ge_u32 s31, 2
  s_cbranch_scc1 .fz_kernel_a_e
  v_mfma_f32_32x32x16_bf16 v[48:63], v[96:99], v[16:19], 0
  v_exp_f32 v64, v64
  v_exp_f32 v65, v65
  v_exp_f32 v66, v66
  v_exp_f32 v67, v67
  v_mfma_f32_32x32x16_bf16 v[176:191], v[92:95], v[228:231], v[176:191]
  v_exp_f32 v68, v68
  v_exp_f32 v69, v69
  v_exp_f32 v70, v70
  v_smfmac_f32_16x16x64_bf16 v[216:219], v[12:15], v[224:231], v11
  v_exp_f32 v71, v71
  v_mfma_f32_32x32x16_bf16 v[48:63], v[100:103], v[20:23], v[48:63]
  v_cvt_pk_bf16_f32 v224, v64, v65
  v_cvt_pk_bf16_f32 v225, v66, v67
  v_cvt_pk_bf16_f32 v226, v68, v69
  v_cvt_pk_bf16_f32 v227, v70, v71
  v_exp_f32 v72, v72
  v_exp_f32 v73, v73
  v_exp_f32 v74, v74
  v_exp_f32 v75, v75
  v_mfma_f32_32x32x16_bf16 v[192:207], v[88:91], v[224:227], 0
  v_exp_f32 v76, v76
  v_exp_f32 v77, v77
  v_exp_f32 v78, v78
  v_exp_f32 v79, v79
  v_cvt_pk_bf16_f32 v228, v72, v73
  v_cvt_pk_bf16_f32 v229, v74, v75
  v_cvt_pk_bf16_f32 v230, v76, v77
  v_cvt_pk_bf16_f32 v231, v78, v79
  v_mfma_f32_32x32x16_bf16 v[64:79], v[96:99], v[24:27], 0
  v_exp_f32 v48, v48
  v_exp_f32 v49, v49
  v_exp_f32 v50, v50
  v_exp_f32 v51, v51
  v_mfma_f32_32x32x16_bf16 v[192:207], v[92:95], v[228:231], v[192:207]
  v_exp_f32 v52, v52
  v_exp_f32 v53, v53
  v_exp_f32 v54, v54
  v_smfmac_f32_16x16x64_bf16 v[220:223], v[12:15], v[224:231], v11
  v_exp_f32 v55, v55
  v_mfma_f32_32x32x16_bf16 v[64:79], v[100:103], v[28:31], v[64:79]
  v_cvt_pk_bf16_f32 v224, v48, v49
  v_cvt_pk_bf16_f32 v225, v50, v51
  v_cvt_pk_bf16_f32 v226, v52, v53
  v_cvt_pk_bf16_f32 v227, v54, v55
  v_exp_f32 v56, v56
  v_exp_f32 v57, v57
  v_exp_f32 v58, v58
  v_exp_f32 v59, v59
  v_mfma_f32_32x32x16_bf16 v[144:159], v[104:107], v[224:227], v[144:159]
  v_exp_f32 v60, v60
  v_exp_f32 v61, v61
  v_exp_f32 v62, v62
  v_exp_f32 v63, v63
  v_cvt_pk_bf16_f32 v228, v56, v57
  v_cvt_pk_bf16_f32 v229, v58, v59
  v_cvt_pk_bf16_f32 v230, v60, v61
  v_cvt_pk_bf16_f32 v231, v62, v63
  v_mfma_f32_32x32x16_bf16 v[48:63], v[96:99], v[32:35], 0
  v_exp_f32 v64, v64
  v_exp_f32 v65, v65
  v_exp_f32 v66, v66
  v_exp_f32 v67, v67
  v_mfma_f32_32x32x16_bf16 v[144:159], v[108:111], v[228:231], v[144:159]
  v_exp_f32 v68, v68
  v_exp_f32 v69, v69
  v_exp_f32 v70, v70
  v_smfmac_f32_16x16x64_bf16 v[208:211], v[12:15], v[224:231], v11
  v_exp_f32 v71, v71
  v_mfma_f32_32x32x16_bf16 v[48:63], v[100:103], v[36:39], v[48:63]
  v_cvt_pk_bf16_f32 v224, v64, v65
  v_cvt_pk_bf16_f32 v225, v66, v67
  v_cvt_pk_bf16_f32 v226, v68, v69
  v_cvt_pk_bf16_f32 v227, v70, v71
  v_exp_f32 v72, v72
  v_exp_f32 v73, v73
  v_exp_f32 v74, v74
  v_exp_f32 v75, v75
  v_mfma_f32_32x32x16_bf16 v[160:175], v[104:107], v[224:227], v[160:175]
  ds_read_b32 v7, v6
  v_exp_f32 v76, v76
  v_exp_f32 v77, v77
  v_exp_f32 v78, v78
  v_exp_f32 v79, v79
  v_cvt_pk_bf16_f32 v228, v72, v73
  v_cvt_pk_bf16_f32 v229, v74, v75
  v_cvt_pk_bf16_f32 v230, v76, v77
  v_cvt_pk_bf16_f32 v231, v78, v79
  s_waitcnt lgkmcnt(0)
  v_readfirstlane_b32 s39, v7
  s_andn2_b32 s39, s39, s34
  s_cbranch_scc0 .fz_kernel_a_p0
  s_ff1_i32_b32 s33, s36
  s_bitset0_b32 s36, s33
  s_lshl_b32 s33, s33, 14
  s_add_u32 s30, s33, s35
  s_cbranch_scc1 .fz_kernel_pk26c
.fz_kernel_pk26:
  buffer_load_dwordx4 v[112:115], v3, s[4:7], s30 offen offset:0
  buffer_load_dwordx4 v[116:119], v3, s[4:7], s30 offen offset:1024
  buffer_load_dwordx4 v[120:123], v3, s[4:7], s30 offen offset:2048
  buffer_load_dwordx4 v[124:127], v3, s[4:7], s30 offen offset:3072
  buffer_load_dwordx4 v[128:131], v10, s[4:7], s30 offen offset:0
  buffer_load_dwordx4 v[132:135], v10, s[4:7], s30 offen offset:1024
  buffer_load_dwordx4 v[136:139], v10, s[4:7], s30 offen offset:2048
  buffer_load_dwordx4 v[140:143], v10, s[4:7], s30 offen offset:3072
.fz_kernel_a_p0:
  v_mfma_f32_32x32x16_bf16 v[64:79], v[96:99], v[40:43], 0
  v_exp_f32 v48, v48
  v_exp_f32 v49, v49
  v_exp_f32 v50, v50
  v_exp_f32 v51, v51
  v_mfma_f32_32x32x16_bf16 v[160:175], v[108:111], v[228:231], v[160:175]
  v_exp_f32 v52, v52
  v_exp_f32 v53, v53
  v_exp_f32 v54, v54
  v_smfmac_f32_16x16x64_bf16 v[212:215], v[12:15], v[224:231], v11
  v_exp_f32 v55, v55
  v_mfma_f32_32x32x16_bf16 v[64:79], v[100:103], v[44:47], v[64:79]
  v_cvt_pk_bf16_f32 v224, v48, v49
  v_cvt_pk_bf16_f32 v225, v50, v51
  v_cvt_pk_bf16_f32 v226, v52, v53
  v_cvt_pk_bf16_f32 v227, v54, v55
  v_exp_f32 v56, v56
  v_exp_f32 v57, v57
  v_exp_f32 v58, v58
  v_exp_f32 v59, v59
  v_mfma_f32_32x32x16_bf16 v[176:191], v[104:107], v[224:227], v[176:191]
  v_exp_f32 v60, v60
  v_exp_f32 v61, v61
  v_exp_f32 v62, v62
  v_exp_f32 v63, v63
  v_cvt_pk_bf16_f32 v228, v56, v57
  v_cvt_pk_bf16_f32 v229, v58, v59
  v_cvt_pk_bf16_f32 v230, v60, v61
  v_cvt_pk_bf16_f32 v231, v62, v63
  v_exp_f32 v64, v64
  v_exp_f32 v65, v65
  v_exp_f32 v66, v66
  v_exp_f32 v67, v67
  v_mfma_f32_32x32x16_bf16 v[176:191], v[108:111], v[228:231], v[176:191]
  v_exp_f32 v68, v68
  v_exp_f32 v69, v69
  v_exp_f32 v70, v70
  v_smfmac_f32_16x16x64_bf16 v[216:219], v[12:15], v[224:231], v11
  v_exp_f32 v71, v71
  v_cvt_pk_bf16_f32 v224, v64, v65
  v_cvt_pk_bf16_f32 v225, v66, v67
  v_cvt_pk_bf16_f32 v226, v68, v69
  v_cvt_pk_bf16_f32 v227, v70, v71
  v_exp_f32 v72, v72
  v_exp_f32 v73, v73
  v_exp_f32 v74, v74
  v_exp_f32 v75, v75
  v_mfma_f32_32x32x16_bf16 v[192:207], v[104:107], v[224:227], v[192:207]
  v_exp_f32 v76, v76
  v_exp_f32 v77, v77
  v_exp_f32 v78, v78
  v_exp_f32 v79, v79
  v_cvt_pk_bf16_f32 v228, v72, v73
  v_cvt_pk_bf16_f32 v229, v74, v75
  v_cvt_pk_bf16_f32 v230, v76, v77
  v_cvt_pk_bf16_f32 v231, v78, v79
  s_cmp_lg_u32 s39, 0
  s_cbranch_scc1 .fz_kernel_a_p1
  s_ff1_i32_b32 s33, s36
  s_bitset0_b32 s36, s33
  s_lshl_b32 s33, s33, 14
  s_add_u32 s30, s33, s35
  s_cbranch_scc1 .fz_kernel_pk27c
.fz_kernel_pk27:
  buffer_load_dwordx4 v[112:115], v3, s[4:7], s30 offen offset:0
  buffer_load_dwordx4 v[116:119], v3, s[4:7], s30 offen offset:1024
  buffer_load_dwordx4 v[120:123], v3, s[4:7], s30 offen offset:2048
  buffer_load_dwordx4 v[124:127], v3, s[4:7], s30 offen offset:3072
  buffer_load_dwordx4 v[128:131], v10, s[4:7], s30 offen offset:0
  buffer_load_dwordx4 v[132:135], v10, s[4:7], s30 offen offset:1024
  buffer_load_dwordx4 v[136:139], v10, s[4:7], s30 offen offset:2048
  buffer_load_dwordx4 v[140:143], v10, s[4:7], s30 offen offset:3072
.fz_kernel_a_p1:
  s_ff1_i32_b32 s33, s36
  s_bitset0_b32 s36, s33
  s_lshl_b32 s33, s33, 14
  s_add_u32 s30, s33, s35
  s_cbranch_scc1 .fz_kernel_pk28c
.fz_kernel_pk28:
  buffer_load_dwordx4 v[80:83], v3, s[4:7], s30 offen offset:0
  buffer_load_dwordx4 v[84:87], v3, s[4:7], s30 offen offset:1024
  buffer_load_dwordx4 v[88:91], v3, s[4:7], s30 offen offset:2048
  buffer_load_dwordx4 v[92:95], v3, s[4:7], s30 offen offset:3072
  buffer_load_dwordx4 v[96:99], v10, s[4:7], s30 offen offset:0
  s_waitcnt vmcnt(11)
  v_mfma_f32_32x32x16_bf16 v[48:63], v[112:115], v[16:19], 0
  v_mfma_f32_32x32x16_bf16 v[48:63], v[116:119], v[20:23], v[48:63]
  s_nop 9
  s_branch .fz_kernel_a_b2
.fz_kernel_a_e:
  s_mov_b32 s36, s33
  s_or_b32 s34, s34, s39
  s_ff1_i32_b32 s33, s36
  s_bitset0_b32 s36, s33
  s_lshl_b32 s33, s33, 14
  s_add_u32 s30, s33, s35
  v_mfma_f32_32x32x16_bf16 v[48:63], v[96:99], v[16:19], 0
  buffer_load_dwordx4 v[112:115], v3, s[4:7], s30 offen offset:0
  v_exp_f32 v64, v64
  v_exp_f32 v65, v65
  v_exp_f32 v66, v66
  v_exp_f32 v67, v67
  v_mfma_f32_32x32x16_bf16 v[176:191], v[92:95], v[228:231], v[176:191]
  buffer_load_dwordx4 v[116:119], v3, s[4:7], s30 offen offset:1024
  v_exp_f32 v68, v68
  v_exp_f32 v69, v69
  v_exp_f32 v70, v70
  v_smfmac_f32_16x16x64_bf16 v[216:219], v[12:15], v[224:231], v11
  buffer_load_dwordx4 v[120:123], v3, s[4:7], s30 offen offset:2048
  v_exp_f32 v71, v71
  v_mfma_f32_32x32x16_bf16 v[48:63], v[100:103], v[20:23], v[48:63]
  buffer_load_dwordx4 v[124:127], v3, s[4:7], s30 offen offset:3072
  v_cvt_pk_bf16_f32 v224, v64, v65
  v_cvt_pk_bf16_f32 v225, v66, v67
  v_cvt_pk_bf16_f32 v226, v68, v69
  v_cvt_pk_bf16_f32 v227, v70, v71
  v_exp_f32 v72, v72
  v_exp_f32 v73, v73
  v_exp_f32 v74, v74
  v_exp_f32 v75, v75
  v_mfma_f32_32x32x16_bf16 v[192:207], v[88:91], v[224:227], 0
  buffer_load_dwordx4 v[128:131], v10, s[4:7], s30 offen offset:0
  v_exp_f32 v76, v76
  v_exp_f32 v77, v77
  v_exp_f32 v78, v78
  v_exp_f32 v79, v79
  v_cvt_pk_bf16_f32 v228, v72, v73
  v_cvt_pk_bf16_f32 v229, v74, v75
  v_cvt_pk_bf16_f32 v230, v76, v77
  v_cvt_pk_bf16_f32 v231, v78, v79
  v_mfma_f32_32x32x16_bf16 v[64:79], v[96:99], v[24:27], 0
  buffer_load_dwordx4 v[132:135], v10, s[4:7], s30 offen offset:1024
  v_exp_f32 v48, v48
  v_exp_f32 v49, v49
  v_exp_f32 v50, v50
  v_exp_f32 v51, v51
  v_mfma_f32_32x32x16_bf16 v[192:207], v[92:95], v[228:231], v[192:207]
  buffer_load_dwordx4 v[136:139], v10, s[4:7], s30 offen offset:2048
  v_exp_f32 v52, v52
  v_exp_f32 v53, v53
  v_exp_f32 v54, v54
  v_smfmac_f32_16x16x64_bf16 v[220:223], v[12:15], v[224:231], v11
  buffer_load_dwordx4 v[140:143], v10, s[4:7], s30 offen offset:3072
  v_exp_f32 v55, v55
  v_mfma_f32_32x32x16_bf16 v[64:79], v[100:103], v[28:31], v[64:79]
  s_ff1_i32_b32 s33, s36
  v_cvt_pk_bf16_f32 v224, v48, v49
  v_cvt_pk_bf16_f32 v225, v50, v51
  v_cvt_pk_bf16_f32 v226, v52, v53
  v_cvt_pk_bf16_f32 v227, v54, v55
  v_exp_f32 v56, v56
  v_exp_f32 v57, v57
  v_exp_f32 v58, v58
  v_exp_f32 v59, v59
  v_mfma_f32_32x32x16_bf16 v[144:159], v[104:107], v[224:227], v[144:159]
  s_bitset0_b32 s36, s33
  v_exp_f32 v60, v60
  v_exp_f32 v61, v61
  v_exp_f32 v62, v62
  v_exp_f32 v63, v63
  v_cvt_pk_bf16_f32 v228, v56, v57
  v_cvt_pk_bf16_f32 v229, v58, v59
  v_cvt_pk_bf16_f32 v230, v60, v61
  v_cvt_pk_bf16_f32 v231, v62, v63
  v_mfma_f32_32x32x16_bf16 v[48:63], v[96:99], v[32:35], 0
  s_lshl_b32 s33, s33, 14
  v_exp_f32 v64, v64
  v_exp_f32 v65, v65
  v_exp_f32 v66, v66
  v_exp_f32 v67, v67
  v_mfma_f32_32x32x16_bf16 v[144:159], v[108:111], v[228:231], v[144:159]
  s_add_u32 s30, s33, s35
  v_exp_f32 v68, v68
  v_exp_f32 v69, v69
  v_exp_f32 v70, v70
  v_smfmac_f32_16x16x64_bf16 v[208:211], v[12:15], v[224:231], v11
  buffer_load_dwordx4 v[80:83], v3, s[4:7], s30 offen offset:0
  v_exp_f32 v71, v71
  v_mfma_f32_32x32x16_bf16 v[48:63], v[100:103], v[36:39], v[48:63]
  buffer_load_dwordx4 v[84:87], v3, s[4:7], s30 offen offset:1024
  v_cvt_pk_bf16_f32 v224, v64, v65
  v_cvt_pk_bf16_f32 v225, v66, v67
  v_cvt_pk_bf16_f32 v226, v68, v69
  v_cvt_pk_bf16_f32 v227, v70, v71
  v_exp_f32 v72, v72
  v_exp_f32 v73, v73
  v_exp_f32 v74, v74
  v_exp_f32 v75, v75
  v_mfma_f32_32x32x16_bf16 v[160:175], v[104:107], v[224:227], v[160:175]
  buffer_load_dwordx4 v[88:91], v3, s[4:7], s30 offen offset:2048
  v_exp_f32 v76, v76
  v_exp_f32 v77, v77
  v_exp_f32 v78, v78
  v_exp_f32 v79, v79
  v_cvt_pk_bf16_f32 v228, v72, v73
  v_cvt_pk_bf16_f32 v229, v74, v75
  v_cvt_pk_bf16_f32 v230, v76, v77
  v_cvt_pk_bf16_f32 v231, v78, v79
  v_mfma_f32_32x32x16_bf16 v[64:79], v[96:99], v[40:43], 0
  buffer_load_dwordx4 v[92:95], v3, s[4:7], s30 offen offset:3072
  v_exp_f32 v48, v48
  v_exp_f32 v49, v49
  v_exp_f32 v50, v50
  v_exp_f32 v51, v51
  v_mfma_f32_32x32x16_bf16 v[160:175], v[108:111], v[228:231], v[160:175]
  v_exp_f32 v52, v52
  v_exp_f32 v53, v53
  v_exp_f32 v54, v54
  v_smfmac_f32_16x16x64_bf16 v[212:215], v[12:15], v[224:231], v11
  v_exp_f32 v55, v55
  v_mfma_f32_32x32x16_bf16 v[64:79], v[100:103], v[44:47], v[64:79]
  v_cvt_pk_bf16_f32 v224, v48, v49
  v_cvt_pk_bf16_f32 v225, v50, v51
  v_cvt_pk_bf16_f32 v226, v52, v53
  v_cvt_pk_bf16_f32 v227, v54, v55
  v_exp_f32 v56, v56
  v_exp_f32 v57, v57
  v_exp_f32 v58, v58
  v_exp_f32 v59, v59
  v_mfma_f32_32x32x16_bf16 v[176:191], v[104:107], v[224:227], v[176:191]
  s_waitcnt vmcnt(10)
  v_exp_f32 v60, v60
  v_exp_f32 v61, v61
  v_exp_f32 v62, v62
  v_exp_f32 v63, v63
  v_cvt_pk_bf16_f32 v228, v56, v57
  v_cvt_pk_bf16_f32 v229, v58, v59
  v_cvt_pk_bf16_f32 v230, v60, v61
  v_cvt_pk_bf16_f32 v231, v62, v63
  v_mfma_f32_32x32x16_bf16 v[48:63], v[112:115], v[16:19], 0
  v_exp_f32 v64, v64
  v_exp_f32 v65, v65
  v_exp_f32 v66, v66
  v_exp_f32 v67, v67
  v_mfma_f32_32x32x16_bf16 v[176:191], v[108:111], v[228:231], v[176:191]
  buffer_load_dwordx4 v[96:99], v10, s[4:7], s30 offen offset:0
  v_exp_f32 v68, v68
  v_exp_f32 v69, v69
  v_exp_f32 v70, v70
  v_smfmac_f32_16x16x64_bf16 v[216:219], v[12:15], v[224:231], v11
  v_exp_f32 v71, v71
  v_mfma_f32_32x32x16_bf16 v[48:63], v[116:119], v[20:23], v[48:63]
  v_cvt_pk_bf16_f32 v224, v64, v65
  v_cvt_pk_bf16_f32 v225, v66, v67
  v_cvt_pk_bf16_f32 v226, v68, v69
  v_cvt_pk_bf16_f32 v227, v70, v71
  v_exp_f32 v72, v72
  v_exp_f32 v73, v73
  v_exp_f32 v74, v74
  v_exp_f32 v75, v75
  v_mfma_f32_32x32x16_bf16 v[192:207], v[104:107], v[224:227], v[192:207]
  v_exp_f32 v76, v76
  v_exp_f32 v77, v77
  v_exp_f32 v78, v78
  v_exp_f32 v79, v79
  v_cvt_pk_bf16_f32 v228, v72, v73
  v_cvt_pk_bf16_f32 v229, v74, v75
  v_cvt_pk_bf16_f32 v230, v76, v77
  v_cvt_pk_bf16_f32 v231, v78, v79
  s_branch .fz_kernel_a_b2
  .p2align 6
.fz_kernel_a_loop:
  v_mfma_f32_32x32x16_bf16 v[64:79], v[80:83], v[24:27], 0
  v_exp_f32 v48, v48
  v_exp_f32 v49, v49
  v_exp_f32 v50, v50
  v_exp_f32 v51, v51
  v_mfma_f32_32x32x16_bf16 v[192:207], v[140:143], v[228:231], v[192:207]
  v_exp_f32 v52, v52
  v_exp_f32 v53, v53
  v_exp_f32 v54, v54
  v_smfmac_f32_16x16x64_bf16 v[220:223], v[12:15], v[224:231], v11
  buffer_load_dwordx4 v[132:135], v10, s[4:7], s30 offen offset:1024
  v_exp_f32 v55, v55
  v_mfma_f32_32x32x16_bf16 v[64:79], v[84:87], v[28:31], v[64:79]
  s_waitcnt vmcnt(10)
  v_cvt_pk_bf16_f32 v224, v48, v49
  v_cvt_pk_bf16_f32 v225, v50, v51
  v_cvt_pk_bf16_f32 v226, v52, v53
  v_cvt_pk_bf16_f32 v227, v54, v55
  v_exp_f32 v56, v56
  v_exp_f32 v57, v57
  v_exp_f32 v58, v58
  v_exp_f32 v59, v59
  v_mfma_f32_32x32x16_bf16 v[144:159], v[88:91], v[224:227], v[144:159]
  v_exp_f32 v60, v60
  v_exp_f32 v61, v61
  v_exp_f32 v62, v62
  v_exp_f32 v63, v63
  v_cvt_pk_bf16_f32 v228, v56, v57
  v_cvt_pk_bf16_f32 v229, v58, v59
  v_cvt_pk_bf16_f32 v230, v60, v61
  v_cvt_pk_bf16_f32 v231, v62, v63
  v_mfma_f32_32x32x16_bf16 v[48:63], v[80:83], v[32:35], 0
  v_exp_f32 v64, v64
  v_exp_f32 v65, v65
  v_exp_f32 v66, v66
  v_exp_f32 v67, v67
  v_mfma_f32_32x32x16_bf16 v[144:159], v[92:95], v[228:231], v[144:159]
  v_exp_f32 v68, v68
  v_exp_f32 v69, v69
  v_exp_f32 v70, v70
  v_smfmac_f32_16x16x64_bf16 v[208:211], v[12:15], v[224:231], v11
  buffer_load_dwordx4 v[136:139], v10, s[4:7], s30 offen offset:2048
  v_exp_f32 v71, v71
  v_mfma_f32_32x32x16_bf16 v[48:63], v[84:87], v[36:39], v[48:63]
  s_ff1_i32_b32 s33, s36
  v_cvt_pk_bf16_f32 v224, v64, v65
  v_cvt_pk_bf16_f32 v225, v66, v67
  v_cvt_pk_bf16_f32 v226, v68, v69
  v_cvt_pk_bf16_f32 v227, v70, v71
  v_exp_f32 v72, v72
  v_exp_f32 v73, v73
  v_exp_f32 v74, v74
  v_exp_f32 v75, v75
  v_mfma_f32_32x32x16_bf16 v[160:175], v[88:91], v[224:227], v[160:175]
  s_bitset0_b32 s36, s33
  v_exp_f32 v76, v76
  v_exp_f32 v77, v77
  v_exp_f32 v78, v78
  v_exp_f32 v79, v79
  v_cvt_pk_bf16_f32 v228, v72, v73
  v_cvt_pk_bf16_f32 v229, v74, v75
  v_cvt_pk_bf16_f32 v230, v76, v77
  v_cvt_pk_bf16_f32 v231, v78, v79
  v_mfma_f32_32x32x16_bf16 v[64:79], v[80:83], v[40:43], 0
  s_lshl_b32 s33, s33, 14
  v_exp_f32 v48, v48
  v_exp_f32 v49, v49
  v_exp_f32 v50, v50
  v_exp_f32 v51, v51
  v_mfma_f32_32x32x16_bf16 v[160:175], v[92:95], v[228:231], v[160:175]
  v_exp_f32 v52, v52
  v_exp_f32 v53, v53
  v_exp_f32 v54, v54
  v_smfmac_f32_16x16x64_bf16 v[212:215], v[12:15], v[224:231], v11
  buffer_load_dwordx4 v[140:143], v10, s[4:7], s30 offen offset:3072
  v_exp_f32 v55, v55
  v_mfma_f32_32x32x16_bf16 v[64:79], v[84:87], v[44:47], v[64:79]
  s_add_u32 s30, s33, s35
  v_cvt_pk_bf16_f32 v224, v48, v49
  v_cvt_pk_bf16_f32 v225, v50, v51
  v_cvt_pk_bf16_f32 v226, v52, v53
  v_cvt_pk_bf16_f32 v227, v54, v55
  v_exp_f32 v56, v56
  v_exp_f32 v57, v57
  v_exp_f32 v58, v58
  v_exp_f32 v59, v59
  v_mfma_f32_32x32x16_bf16 v[176:191], v[88:91], v[224:227], v[176:191]
  s_waitcnt vmcnt(10)
  v_exp_f32 v60, v60
  v_exp_f32 v61, v61
  v_exp_f32 v62, v62
  v_exp_f32 v63, v63
  v_cvt_pk_bf16_f32 v228, v56, v57
  v_cvt_pk_bf16_f32 v229, v58, v59
  v_cvt_pk_bf16_f32 v230, v60, v61
  v_cvt_pk_bf16_f32 v231, v62, v63
  v_mfma_f32_32x32x16_bf16 v[48:63], v[96:99], v[16:19], 0
  s_cbranch_scc1 .fz_kernel_pk31c
.fz_kernel_pk31:
  v_exp_f32 v64, v64
  v_exp_f32 v65, v65
  v_exp_f32 v66, v66
  v_exp_f32 v67, v67
  v_mfma_f32_32x32x16_bf16 v[176:191], v[92:95], v[228:231], v[176:191]
  v_exp_f32 v68, v68
  v_exp_f32 v69, v69
  v_exp_f32 v70, v70
  v_smfmac_f32_16x16x64_bf16 v[216:219], v[12:15], v[224:231], v11
  buffer_load_dwordx4 v[80:83], v3, s[4:7], s30 offen offset:0
  v_exp_f32 v71, v71
  v_mfma_f32_32x32x16_bf16 v[48:63], v[100:103], v[20:23], v[48:63]
  v_cvt_pk_bf16_f32 v224, v64, v65
  v_cvt_pk_bf16_f32 v225, v66, v67
  v_cvt_pk_bf16_f32 v226, v68, v69
  v_cvt_pk_bf16_f32 v227, v70, v71
  v_exp_f32 v72, v72
  v_exp_f32 v73, v73
  v_exp_f32 v74, v74
  v_exp_f32 v75, v75
  v_mfma_f32_32x32x16_bf16 v[192:207], v[88:91], v[224:227], v[192:207]
  v_exp_f32 v76, v76
  v_exp_f32 v77, v77
  v_exp_f32 v78, v78
  v_exp_f32 v79, v79
  v_cvt_pk_bf16_f32 v228, v72, v73
  v_cvt_pk_bf16_f32 v229, v74, v75
  v_cvt_pk_bf16_f32 v230, v76, v77
  v_cvt_pk_bf16_f32 v231, v78, v79
  v_mfma_f32_32x32x16_bf16 v[64:79], v[96:99], v[24:27], 0
  v_exp_f32 v48, v48
  v_exp_f32 v49, v49
  v_exp_f32 v50, v50
  v_exp_f32 v51, v51
  v_mfma_f32_32x32x16_bf16 v[192:207], v[92:95], v[228:231], v[192:207]
  v_exp_f32 v52, v52
  v_exp_f32 v53, v53
  v_exp_f32 v54, v54
  v_smfmac_f32_16x16x64_bf16 v[220:223], v[12:15], v[224:231], v11
  buffer_load_dwordx4 v[84:87], v3, s[4:7], s30 offen offset:1024
  v_exp_f32 v55, v55
  v_mfma_f32_32x32x16_bf16 v[64:79], v[100:103], v[28:31], v[64:79]
  s_waitcnt vmcnt(10)
  v_cvt_pk_bf16_f32 v224, v48, v49
  v_cvt_pk_bf16_f32 v225, v50, v51
  v_cvt_pk_bf16_f32 v226, v52, v53
  v_cvt_pk_bf16_f32 v227, v54, v55
  v_exp_f32 v56, v56
  v_exp_f32 v57, v57
  v_exp_f32 v58, v58
  v_exp_f32 v59, v59
  v_mfma_f32_32x32x16_bf16 v[144:159], v[104:107], v[224:227], v[144:159]
  v_exp_f32 v60, v60
  v_exp_f32 v61, v61
  v_exp_f32 v62, v62
  v_exp_f32 v63, v63
  v_cvt_pk_bf16_f32 v228, v56, v57
  v_cvt_pk_bf16_f32 v229, v58, v59
  v_cvt_pk_bf16_f32 v230, v60, v61
  v_cvt_pk_bf16_f32 v231, v62, v63
  v_mfma_f32_32x32x16_bf16 v[48:63], v[96:99], v[32:35], 0
  v_exp_f32 v64, v64
  v_exp_f32 v65, v65
  v_exp_f32 v66, v66
  v_exp_f32 v67, v67
  v_mfma_f32_32x32x16_bf16 v[144:159], v[108:111], v[228:231], v[144:159]
  v_exp_f32 v68, v68
  v_exp_f32 v69, v69
  v_exp_f32 v70, v70
  v_smfmac_f32_16x16x64_bf16 v[208:211], v[12:15], v[224:231], v11
  buffer_load_dwordx4 v[88:91], v3, s[4:7], s30 offen offset:2048
  v_exp_f32 v71, v71
  v_mfma_f32_32x32x16_bf16 v[48:63], v[100:103], v[36:39], v[48:63]
  v_cvt_pk_bf16_f32 v224, v64, v65
  v_cvt_pk_bf16_f32 v225, v66, v67
  v_cvt_pk_bf16_f32 v226, v68, v69
  v_cvt_pk_bf16_f32 v227, v70, v71
  v_exp_f32 v72, v72
  v_exp_f32 v73, v73
  v_exp_f32 v74, v74
  v_exp_f32 v75, v75
  v_mfma_f32_32x32x16_bf16 v[160:175], v[104:107], v[224:227], v[160:175]
  v_exp_f32 v76, v76
  v_exp_f32 v77, v77
  v_exp_f32 v78, v78
  v_exp_f32 v79, v79
  v_cvt_pk_bf16_f32 v228, v72, v73
  v_cvt_pk_bf16_f32 v229, v74, v75
  v_cvt_pk_bf16_f32 v230, v76, v77
  v_cvt_pk_bf16_f32 v231, v78, v79
  v_mfma_f32_32x32x16_bf16 v[64:79], v[96:99], v[40:43], 0
  v_exp_f32 v48, v48
  v_exp_f32 v49, v49
  v_exp_f32 v50, v50
  v_exp_f32 v51, v51
  v_mfma_f32_32x32x16_bf16 v[160:175], v[108:111], v[228:231], v[160:175]
  v_exp_f32 v52, v52
  v_exp_f32 v53, v53
  v_exp_f32 v54, v54
  v_smfmac_f32_16x16x64_bf16 v[212:215], v[12:15], v[224:231], v11
  buffer_load_dwordx4 v[92:95], v3, s[4:7], s30 offen offset:3072
  v_exp_f32 v55, v55
  v_mfma_f32_32x32x16_bf16 v[64:79], v[100:103], v[44:47], v[64:79]
  v_cvt_pk_bf16_f32 v224, v48, v49
  v_cvt_pk_bf16_f32 v225, v50, v51
  v_cvt_pk_bf16_f32 v226, v52, v53
  v_cvt_pk_bf16_f32 v227, v54, v55
  v_exp_f32 v56, v56
  v_exp_f32 v57, v57
  v_exp_f32 v58, v58
  v_exp_f32 v59, v59
  v_mfma_f32_32x32x16_bf16 v[176:191], v[104:107], v[224:227], v[176:191]
  s_waitcnt vmcnt(10)
  v_exp_f32 v60, v60
  v_exp_f32 v61, v61
  v_exp_f32 v62, v62
  v_exp_f32 v63, v63
  v_cvt_pk_bf16_f32 v228, v56, v57
  v_cvt_pk_bf16_f32 v229, v58, v59
  v_cvt_pk_bf16_f32 v230, v60, v61
  v_cvt_pk_bf16_f32 v231, v62, v63
  v_mfma_f32_32x32x16_bf16 v[48:63], v[112:115], v[16:19], 0
  v_exp_f32 v64, v64
  v_exp_f32 v65, v65
  v_exp_f32 v66, v66
  v_exp_f32 v67, v67
  v_mfma_f32_32x32x16_bf16 v[176:191], v[108:111], v[228:231], v[176:191]
  v_exp_f32 v68, v68
  v_exp_f32 v69, v69
  v_exp_f32 v70, v70
  v_smfmac_f32_16x16x64_bf16 v[216:219], v[12:15], v[224:231], v11
  buffer_load_dwordx4 v[96:99], v10, s[4:7], s30 offen offset:0
  v_exp_f32 v71, v71
  v_mfma_f32_32x32x16_bf16 v[48:63], v[116:119], v[20:23], v[48:63]
  v_cvt_pk_bf16_f32 v224, v64, v65
  v_cvt_pk_bf16_f32 v225, v66, v67
  v_cvt_pk_bf16_f32 v226, v68, v69
  v_cvt_pk_bf16_f32 v227, v70, v71
  v_exp_f32 v72, v72
  v_exp_f32 v73, v73
  v_exp_f32 v74, v74
  v_exp_f32 v75, v75
  v_mfma_f32_32x32x16_bf16 v[192:207], v[104:107], v[224:227], v[192:207]
  v_exp_f32 v76, v76
  v_exp_f32 v77, v77
  v_exp_f32 v78, v78
  v_exp_f32 v79, v79
  v_cvt_pk_bf16_f32 v228, v72, v73
  v_cvt_pk_bf16_f32 v229, v74, v75
  v_cvt_pk_bf16_f32 v230, v76, v77
  v_cvt_pk_bf16_f32 v231, v78, v79
.fz_kernel_a_b2:
  v_mfma_f32_32x32x16_bf16 v[64:79], v[112:115], v[24:27], 0
  v_exp_f32 v48, v48
  v_exp_f32 v49, v49
  v_exp_f32 v50, v50
  v_exp_f32 v51, v51
  v_mfma_f32_32x32x16_bf16 v[192:207], v[108:111], v[228:231], v[192:207]
  v_exp_f32 v52, v52
  v_exp_f32 v53, v53
  v_exp_f32 v54, v54
  v_smfmac_f32_16x16x64_bf16 v[220:223], v[12:15], v[224:231], v11
  buffer_load_dwordx4 v[100:103], v10, s[4:7], s30 offen offset:1024
  v_exp_f32 v55, v55
  v_mfma_f32_32x32x16_bf16 v[64:79], v[116:119], v[28:31], v[64:79]
  s_waitcnt vmcnt(10)
  v_cvt_pk_bf16_f32 v224, v48, v49
  v_cvt_pk_bf16_f32 v225, v50, v51
  v_cvt_pk_bf16_f32 v226, v52, v53
  v_cvt_pk_bf16_f32 v227, v54, v55
  v_exp_f32 v56, v56
  v_exp_f32 v57, v57
  v_exp_f32 v58, v58
  v_exp_f32 v59, v59
  v_mfma_f32_32x32x16_bf16 v[144:159], v[120:123], v[224:227], v[144:159]
  v_exp_f32 v60, v60
  v_exp_f32 v61, v61
  v_exp_f32 v62, v62
  v_exp_f32 v63, v63
  v_cvt_pk_bf16_f32 v228, v56, v57
  v_cvt_pk_bf16_f32 v229, v58, v59
  v_cvt_pk_bf16_f32 v230, v60, v61
  v_cvt_pk_bf16_f32 v231, v62, v63
  v_mfma_f32_32x32x16_bf16 v[48:63], v[112:115], v[32:35], 0
  v_exp_f32 v64, v64
  v_exp_f32 v65, v65
  v_exp_f32 v66, v66
  v_exp_f32 v67, v67
  v_mfma_f32_32x32x16_bf16 v[144:159], v[124:127], v[228:231], v[144:159]
  v_exp_f32 v68, v68
  v_exp_f32 v69, v69
  v_exp_f32 v70, v70
  v_smfmac_f32_16x16x64_bf16 v[208:211], v[12:15], v[224:231], v11
  buffer_load_dwordx4 v[104:107], v10, s[4:7], s30 offen offset:2048
  v_exp_f32 v71, v71
  v_mfma_f32_32x32x16_bf16 v[48:63], v[116:119], v[36:39], v[48:63]
  s_ff1_i32_b32 s33, s36
  v_cvt_pk_bf16_f32 v224, v64, v65
  v_cvt_pk_bf16_f32 v225, v66, v67
  v_cvt_pk_bf16_f32 v226, v68, v69
  v_cvt_pk_bf16_f32 v227, v70, v71
  v_exp_f32 v72, v72
  v_exp_f32 v73, v73
  v_exp_f32 v74, v74
  v_exp_f32 v75, v75
  v_mfma_f32_32x32x16_bf16 v[160:175], v[120:123], v[224:227], v[160:175]
  s_bitset0_b32 s36, s33
  v_exp_f32 v76, v76
  v_exp_f32 v77, v77
  v_exp_f32 v78, v78
  v_exp_f32 v79, v79
  v_cvt_pk_bf16_f32 v228, v72, v73
  v_cvt_pk_bf16_f32 v229, v74, v75
  v_cvt_pk_bf16_f32 v230, v76, v77
  v_cvt_pk_bf16_f32 v231, v78, v79
  v_mfma_f32_32x32x16_bf16 v[64:79], v[112:115], v[40:43], 0
  s_lshl_b32 s33, s33, 14
  v_exp_f32 v48, v48
  v_exp_f32 v49, v49
  v_exp_f32 v50, v50
  v_exp_f32 v51, v51
  v_mfma_f32_32x32x16_bf16 v[160:175], v[124:127], v[228:231], v[160:175]
  v_exp_f32 v52, v52
  v_exp_f32 v53, v53
  v_exp_f32 v54, v54
  v_smfmac_f32_16x16x64_bf16 v[212:215], v[12:15], v[224:231], v11
  buffer_load_dwordx4 v[108:111], v10, s[4:7], s30 offen offset:3072
  v_exp_f32 v55, v55
  v_mfma_f32_32x32x16_bf16 v[64:79], v[116:119], v[44:47], v[64:79]
  s_add_u32 s30, s33, s35
  v_cvt_pk_bf16_f32 v224, v48, v49
  v_cvt_pk_bf16_f32 v225, v50, v51
  v_cvt_pk_bf16_f32 v226, v52, v53
  v_cvt_pk_bf16_f32 v227, v54, v55
  v_exp_f32 v56, v56
  v_exp_f32 v57, v57
  v_exp_f32 v58, v58
  v_exp_f32 v59, v59
  v_mfma_f32_32x32x16_bf16 v[176:191], v[120:123], v[224:227], v[176:191]
  s_waitcnt vmcnt(10)
  v_exp_f32 v60, v60
  v_exp_f32 v61, v61
  v_exp_f32 v62, v62
  v_exp_f32 v63, v63
  v_cvt_pk_bf16_f32 v228, v56, v57
  v_cvt_pk_bf16_f32 v229, v58, v59
  v_cvt_pk_bf16_f32 v230, v60, v61
  v_cvt_pk_bf16_f32 v231, v62, v63
  v_mfma_f32_32x32x16_bf16 v[48:63], v[128:131], v[16:19], 0
  s_cbranch_scc1 .fz_kernel_pk32c
.fz_kernel_pk32:
  v_exp_f32 v64, v64
  v_exp_f32 v65, v65
  v_exp_f32 v66, v66
  v_exp_f32 v67, v67
  v_mfma_f32_32x32x16_bf16 v[176:191], v[124:127], v[228:231], v[176:191]
  v_exp_f32 v68, v68
  v_exp_f32 v69, v69
  v_exp_f32 v70, v70
  v_smfmac_f32_16x16x64_bf16 v[216:219], v[12:15], v[224:231], v11
  buffer_load_dwordx4 v[112:115], v3, s[4:7], s30 offen offset:0
  v_exp_f32 v71, v71
  v_mfma_f32_32x32x16_bf16 v[48:63], v[132:135], v[20:23], v[48:63]
  v_cvt_pk_bf16_f32 v224, v64, v65
  v_cvt_pk_bf16_f32 v225, v66, v67
  v_cvt_pk_bf16_f32 v226, v68, v69
  v_cvt_pk_bf16_f32 v227, v70, v71
  v_exp_f32 v72, v72
  v_exp_f32 v73, v73
  v_exp_f32 v74, v74
  v_exp_f32 v75, v75
  v_mfma_f32_32x32x16_bf16 v[192:207], v[120:123], v[224:227], v[192:207]
  v_exp_f32 v76, v76
  v_exp_f32 v77, v77
  v_exp_f32 v78, v78
  v_exp_f32 v79, v79
  v_cvt_pk_bf16_f32 v228, v72, v73
  v_cvt_pk_bf16_f32 v229, v74, v75
  v_cvt_pk_bf16_f32 v230, v76, v77
  v_cvt_pk_bf16_f32 v231, v78, v79
  v_mfma_f32_32x32x16_bf16 v[64:79], v[128:131], v[24:27], 0
  v_exp_f32 v48, v48
  v_exp_f32 v49, v49
  v_exp_f32 v50, v50
  v_exp_f32 v51, v51
  v_mfma_f32_32x32x16_bf16 v[192:207], v[124:127], v[228:231], v[192:207]
  v_exp_f32 v52, v52
  v_exp_f32 v53, v53
  v_exp_f32 v54, v54
  v_smfmac_f32_16x16x64_bf16 v[220:223], v[12:15], v[224:231], v11
  buffer_load_dwordx4 v[116:119], v3, s[4:7], s30 offen offset:1024
  v_exp_f32 v55, v55
  v_mfma_f32_32x32x16_bf16 v[64:79], v[132:135], v[28:31], v[64:79]
  s_waitcnt vmcnt(10)
  v_cvt_pk_bf16_f32 v224, v48, v49
  v_cvt_pk_bf16_f32 v225, v50, v51
  v_cvt_pk_bf16_f32 v226, v52, v53
  v_cvt_pk_bf16_f32 v227, v54, v55
  v_exp_f32 v56, v56
  v_exp_f32 v57, v57
  v_exp_f32 v58, v58
  v_exp_f32 v59, v59
  v_mfma_f32_32x32x16_bf16 v[144:159], v[136:139], v[224:227], v[144:159]
  v_exp_f32 v60, v60
  v_exp_f32 v61, v61
  v_exp_f32 v62, v62
  v_exp_f32 v63, v63
  v_cvt_pk_bf16_f32 v228, v56, v57
  v_cvt_pk_bf16_f32 v229, v58, v59
  v_cvt_pk_bf16_f32 v230, v60, v61
  v_cvt_pk_bf16_f32 v231, v62, v63
  v_mfma_f32_32x32x16_bf16 v[48:63], v[128:131], v[32:35], 0
  s_sub_u32 s32, s32, 1
  v_exp_f32 v64, v64
  v_exp_f32 v65, v65
  v_exp_f32 v66, v66
  v_exp_f32 v67, v67
  v_mfma_f32_32x32x16_bf16 v[144:159], v[140:143], v[228:231], v[144:159]
  s_cmp_eq_u32 s32, 0
  v_exp_f32 v68, v68
  v_exp_f32 v69, v69
  v_exp_f32 v70, v70
  v_smfmac_f32_16x16x64_bf16 v[208:211], v[12:15], v[224:231], v11
  buffer_load_dwordx4 v[120:123], v3, s[4:7], s30 offen offset:2048
  v_exp_f32 v71, v71
  v_mfma_f32_32x32x16_bf16 v[48:63], v[132:135], v[36:39], v[48:63]
  v_cvt_pk_bf16_f32 v224, v64, v65
  v_cvt_pk_bf16_f32 v225, v66, v67
  v_cvt_pk_bf16_f32 v226, v68, v69
  v_cvt_pk_bf16_f32 v227, v70, v71
  v_exp_f32 v72, v72
  v_exp_f32 v73, v73
  v_exp_f32 v74, v74
  v_exp_f32 v75, v75
  v_mfma_f32_32x32x16_bf16 v[160:175], v[136:139], v[224:227], v[160:175]
  v_exp_f32 v76, v76
  v_exp_f32 v77, v77
  v_exp_f32 v78, v78
  v_exp_f32 v79, v79
  v_cvt_pk_bf16_f32 v228, v72, v73
  v_cvt_pk_bf16_f32 v229, v74, v75
  v_cvt_pk_bf16_f32 v230, v76, v77
  v_cvt_pk_bf16_f32 v231, v78, v79
  s_cbranch_scc1 .fz_kernel_a_x
  v_mfma_f32_32x32x16_bf16 v[64:79], v[128:131], v[40:43], 0
  v_exp_f32 v48, v48
  v_exp_f32 v49, v49
  v_exp_f32 v50, v50
  v_exp_f32 v51, v51
  v_mfma_f32_32x32x16_bf16 v[160:175], v[140:143], v[228:231], v[160:175]
  v_exp_f32 v52, v52
  v_exp_f32 v53, v53
  v_exp_f32 v54, v54
  v_smfmac_f32_16x16x64_bf16 v[212:215], v[12:15], v[224:231], v11
  buffer_load_dwordx4 v[124:127], v3, s[4:7], s30 offen offset:3072
  v_exp_f32 v55, v55
  v_mfma_f32_32x32x16_bf16 v[64:79], v[132:135], v[44:47], v[64:79]
  v_cvt_pk_bf16_f32 v224, v48, v49
  v_cvt_pk_bf16_f32 v225, v50, v51
  v_cvt_pk_bf16_f32 v226, v52, v53
  v_cvt_pk_bf16_f32 v227, v54, v55
  v_exp_f32 v56, v56
  v_exp_f32 v57, v57
  v_exp_f32 v58, v58
  v_exp_f32 v59, v59
  v_mfma_f32_32x32x16_bf16 v[176:191], v[136:139], v[224:227], v[176:191]
  s_waitcnt vmcnt(10)
  v_exp_f32 v60, v60
  v_exp_f32 v61, v61
  v_exp_f32 v62, v62
  v_exp_f32 v63, v63
  v_cvt_pk_bf16_f32 v228, v56, v57
  v_cvt_pk_bf16_f32 v229, v58, v59
  v_cvt_pk_bf16_f32 v230, v60, v61
  v_cvt_pk_bf16_f32 v231, v62, v63
  v_mfma_f32_32x32x16_bf16 v[48:63], v[80:83], v[16:19], 0
  v_exp_f32 v64, v64
  v_exp_f32 v65, v65
  v_exp_f32 v66, v66
  v_exp_f32 v67, v67
  v_mfma_f32_32x32x16_bf16 v[176:191], v[140:143], v[228:231], v[176:191]
  v_exp_f32 v68, v68
  v_exp_f32 v69, v69
  v_exp_f32 v70, v70
  v_smfmac_f32_16x16x64_bf16 v[216:219], v[12:15], v[224:231], v11
  buffer_load_dwordx4 v[128:131], v10, s[4:7], s30 offen offset:0
  v_exp_f32 v71, v71
  v_mfma_f32_32x32x16_bf16 v[48:63], v[84:87], v[20:23], v[48:63]
  v_cvt_pk_bf16_f32 v224, v64, v65
  v_cvt_pk_bf16_f32 v225, v66, v67
  v_cvt_pk_bf16_f32 v226, v68, v69
  v_cvt_pk_bf16_f32 v227, v70, v71
  v_exp_f32 v72, v72
  v_exp_f32 v73, v73
  v_exp_f32 v74, v74
  v_exp_f32 v75, v75
  v_mfma_f32_32x32x16_bf16 v[192:207], v[136:139], v[224:227], v[192:207]
  v_exp_f32 v76, v76
  v_exp_f32 v77, v77
  v_exp_f32 v78, v78
  v_exp_f32 v79, v79
  v_cvt_pk_bf16_f32 v228, v72, v73
  v_cvt_pk_bf16_f32 v229, v74, v75
  v_cvt_pk_bf16_f32 v230, v76, v77
  v_cvt_pk_bf16_f32 v231, v78, v79
  s_branch .fz_kernel_a_loop
.fz_kernel_a_x:
  v_cvt_pk_bf16_f32 v144, v144, v145
  v_cvt_pk_bf16_f32 v145, v146, v147
  v_cvt_pk_bf16_f32 v146, v148, v149
  v_cvt_pk_bf16_f32 v147, v150, v151
  ds_write_b128 v9, v[144:147] offset:0
  v_cvt_pk_bf16_f32 v148, v152, v153
  v_cvt_pk_bf16_f32 v149, v154, v155
  v_cvt_pk_bf16_f32 v150, v156, v157
  v_cvt_pk_bf16_f32 v151, v158, v159
  ds_write_b128 v9, v[148:151] offset:1024
  v_add_f32 v208, v208, v210
  v_add_f32 v209, v209, v211
  v_cndmask_b32 v30, v208, v209, s[26:27]
  v_mfma_f32_32x32x16_bf16 v[64:79], v[128:131], v[40:43], 0
  v_exp_f32 v48, v48
  v_exp_f32 v49, v49
  v_exp_f32 v50, v50
  v_exp_f32 v51, v51
  v_mfma_f32_32x32x16_bf16 v[160:175], v[140:143], v[228:231], v[160:175]
  v_exp_f32 v52, v52
  v_exp_f32 v53, v53
  v_exp_f32 v54, v54
  v_smfmac_f32_16x16x64_bf16 v[212:215], v[12:15], v[224:231], v11
  v_exp_f32 v55, v55
  v_mfma_f32_32x32x16_bf16 v[64:79], v[132:135], v[44:47], v[64:79]
  v_cvt_pk_bf16_f32 v224, v48, v49
  v_cvt_pk_bf16_f32 v225, v50, v51
  v_cvt_pk_bf16_f32 v226, v52, v53
  v_cvt_pk_bf16_f32 v227, v54, v55
  v_exp_f32 v56, v56
  v_exp_f32 v57, v57
  v_exp_f32 v58, v58
  v_exp_f32 v59, v59
  v_mfma_f32_32x32x16_bf16 v[176:191], v[136:139], v[224:227], v[176:191]
  v_exp_f32 v60, v60
  v_exp_f32 v61, v61
  v_exp_f32 v62, v62
  v_exp_f32 v63, v63
  v_cvt_pk_bf16_f32 v228, v56, v57
  v_cvt_pk_bf16_f32 v229, v58, v59
  v_cvt_pk_bf16_f32 v230, v60, v61
  v_cvt_pk_bf16_f32 v231, v62, v63
  v_cvt_pk_bf16_f32 v160, v160, v161
  v_cvt_pk_bf16_f32 v161, v162, v163
  v_cvt_pk_bf16_f32 v162, v164, v165
  v_cvt_pk_bf16_f32 v163, v166, v167
  ds_write_b128 v9, v[160:163] offset:2048
  v_cvt_pk_bf16_f32 v164, v168, v169
  v_cvt_pk_bf16_f32 v165, v170, v171
  v_cvt_pk_bf16_f32 v166, v172, v173
  v_cvt_pk_bf16_f32 v167, v174, v175
  ds_write_b128 v9, v[164:167] offset:3072
  v_add_f32 v212, v212, v214
  v_add_f32 v213, v213, v215
  v_cndmask_b32 v31, v212, v213, s[26:27]
  ds_write_b64 v1, v[30:31]
  v_xor_b32 v1, 512, v1
  v_exp_f32 v64, v64
  v_exp_f32 v65, v65
  v_exp_f32 v66, v66
  v_exp_f32 v67, v67
  v_mfma_f32_32x32x16_bf16 v[176:191], v[140:143], v[228:231], v[176:191]
  v_exp_f32 v68, v68
  v_exp_f32 v69, v69
  v_exp_f32 v70, v70
  v_smfmac_f32_16x16x64_bf16 v[216:219], v[12:15], v[224:231], v11
  s_waitcnt vmcnt(0) lgkmcnt(0)
  s_barrier
  ds_read_b128 v[48:51], v8 offset:0
  ds_read_b128 v[52:55], v8 offset:1024
  ds_read_b128 v[56:59], v8 offset:2048
  ds_read_b128 v[60:63], v8 offset:3072
  ds_read_b64 v[30:31], v1
  v_exp_f32 v71, v71
  v_cvt_pk_bf16_f32 v224, v64, v65
  v_cvt_pk_bf16_f32 v225, v66, v67
  v_cvt_pk_bf16_f32 v226, v68, v69
  v_cvt_pk_bf16_f32 v227, v70, v71
  v_exp_f32 v72, v72
  v_exp_f32 v73, v73
  s_waitcnt lgkmcnt(3)
  v_mfma_f32_32x32x16_bf16 v[176:191], v[248:251], v[48:51], v[176:191]
  v_exp_f32 v74, v74
  v_exp_f32 v75, v75
  v_mfma_f32_32x32x16_bf16 v[192:207], v[136:139], v[224:227], v[192:207]
  v_exp_f32 v76, v76
  v_exp_f32 v77, v77
  s_waitcnt lgkmcnt(0)
  v_mfma_f32_32x32x16_bf16 v[176:191], v[252:255], v[52:55], v[176:191]
  v_exp_f32 v78, v78
  v_exp_f32 v79, v79
  v_mfma_f32_32x32x16_bf16 v[192:207], v[248:251], v[56:59], v[192:207]
  v_cvt_pk_bf16_f32 v228, v72, v73
  v_cvt_pk_bf16_f32 v229, v74, v75
  v_cvt_pk_bf16_f32 v230, v76, v77
  v_cvt_pk_bf16_f32 v231, v78, v79
  v_mfma_f32_32x32x16_bf16 v[192:207], v[252:255], v[60:63], v[192:207]
  v_add_f32 v216, v216, v218
  v_add_f32 v217, v217, v219
  v_cndmask_b32 v24, v216, v217, s[26:27]
  v_add_f32 v24, v24, v30
  s_mov_b64 s[36:37], -1
  v_smfmac_f32_16x16x64_bf16 v[220:223], v[12:15], v[224:231], v11
  v_mfma_f32_32x32x16_bf16 v[192:207], v[140:143], v[228:231], v[192:207]
  v_rcp_f32 v26, v24
  v_cmp_le_f32 vcc, s24, v24
  s_and_b64 s[36:37], s[36:37], vcc
  v_cmp_ge_f32 vcc, s25, v24
  s_and_b64 s[36:37], s[36:37], vcc
  v_pk_mul_f32 v[176:177], v[176:177], v[26:27] op_sel_hi:[1,0]
  v_pk_mul_f32 v[178:179], v[178:179], v[26:27] op_sel_hi:[1,0]
  v_pk_mul_f32 v[180:181], v[180:181], v[26:27] op_sel_hi:[1,0]
  v_pk_mul_f32 v[182:183], v[182:183], v[26:27] op_sel_hi:[1,0]
  v_cvt_pk_bf16_f32 v48, v176, v177
  v_cvt_pk_bf16_f32 v49, v178, v179
  v_cvt_pk_bf16_f32 v50, v180, v181
  v_cvt_pk_bf16_f32 v51, v182, v183
  buffer_store_dwordx4 v[48:51], v3, s[4:7], s28 offen offset:0 sc1
  v_pk_mul_f32 v[184:185], v[184:185], v[26:27] op_sel_hi:[1,0]
  v_pk_mul_f32 v[186:187], v[186:187], v[26:27] op_sel_hi:[1,0]
  v_pk_mul_f32 v[188:189], v[188:189], v[26:27] op_sel_hi:[1,0]
  v_pk_mul_f32 v[190:191], v[190:191], v[26:27] op_sel_hi:[1,0]
  v_cvt_pk_bf16_f32 v52, v184, v185
  v_cvt_pk_bf16_f32 v53, v186, v187
  v_cvt_pk_bf16_f32 v54, v188, v189
  v_cvt_pk_bf16_f32 v55, v190, v191
  buffer_store_dwordx4 v[52:55], v3, s[4:7], s28 offen offset:1024 sc1
  v_add_f32 v220, v220, v222
  v_add_f32 v221, v221, v223
  v_cndmask_b32 v25, v220, v221, s[26:27]
  v_add_f32 v25, v25, v31
.fz_kernel_a_fin:
  v_rcp_f32 v28, v25
  v_cmp_le_f32 vcc, s24, v25
  s_and_b64 s[36:37], s[36:37], vcc
  v_cmp_ge_f32 vcc, s25, v25
  s_and_b64 s[36:37], s[36:37], vcc
  v_pk_mul_f32 v[192:193], v[192:193], v[28:29] op_sel_hi:[1,0]
  v_pk_mul_f32 v[194:195], v[194:195], v[28:29] op_sel_hi:[1,0]
  v_pk_mul_f32 v[196:197], v[196:197], v[28:29] op_sel_hi:[1,0]
  v_pk_mul_f32 v[198:199], v[198:199], v[28:29] op_sel_hi:[1,0]
  v_cvt_pk_bf16_f32 v56, v192, v193
  v_cvt_pk_bf16_f32 v57, v194, v195
  v_cvt_pk_bf16_f32 v58, v196, v197
  v_cvt_pk_bf16_f32 v59, v198, v199
  buffer_store_dwordx4 v[56:59], v3, s[4:7], s29 offen offset:0 sc1
  v_pk_mul_f32 v[200:201], v[200:201], v[28:29] op_sel_hi:[1,0]
  v_pk_mul_f32 v[202:203], v[202:203], v[28:29] op_sel_hi:[1,0]
  v_pk_mul_f32 v[204:205], v[204:205], v[28:29] op_sel_hi:[1,0]
  v_pk_mul_f32 v[206:207], v[206:207], v[28:29] op_sel_hi:[1,0]
  v_cvt_pk_bf16_f32 v60, v200, v201
  v_cvt_pk_bf16_f32 v61, v202, v203
  v_cvt_pk_bf16_f32 v62, v204, v205
  v_cvt_pk_bf16_f32 v63, v206, v207
  buffer_store_dwordx4 v[60:63], v3, s[4:7], s29 offen offset:1024 sc1
  ds_read_b32 v7, v6 offset:8
  v_pk_fma_f32 v[64:65], v[176:177], 0, 0 op_sel_hi:[1,0,0]
  v_pk_fma_f32 v[66:67], v[178:179], 0, 0 op_sel_hi:[1,0,0]
  v_pk_fma_f32 v[64:65], v[180:181], 0, v[64:65] op_sel_hi:[1,0,1]
  v_pk_fma_f32 v[66:67], v[182:183], 0, v[66:67] op_sel_hi:[1,0,1]
  v_pk_fma_f32 v[64:65], v[184:185], 0, v[64:65] op_sel_hi:[1,0,1]
  v_pk_fma_f32 v[66:67], v[186:187], 0, v[66:67] op_sel_hi:[1,0,1]
  v_pk_fma_f32 v[64:65], v[188:189], 0, v[64:65] op_sel_hi:[1,0,1]
  v_pk_fma_f32 v[66:67], v[190:191], 0, v[66:67] op_sel_hi:[1,0,1]
  v_pk_fma_f32 v[64:65], v[192:193], 0, v[64:65] op_sel_hi:[1,0,1]
  v_pk_fma_f32 v[66:67], v[194:195], 0, v[66:67] op_sel_hi:[1,0,1]
  v_pk_fma_f32 v[64:65], v[196:197], 0, v[64:65] op_sel_hi:[1,0,1]
  v_pk_fma_f32 v[66:67], v[198:199], 0, v[66:67] op_sel_hi:[1,0,1]
  v_pk_fma_f32 v[64:65], v[200:201], 0, v[64:65] op_sel_hi:[1,0,1]
  v_pk_fma_f32 v[66:67], v[202:203], 0, v[66:67] op_sel_hi:[1,0,1]
  v_pk_fma_f32 v[64:65], v[204:205], 0, v[64:65] op_sel_hi:[1,0,1]
  v_pk_fma_f32 v[66:67], v[206:207], 0, v[66:67] op_sel_hi:[1,0,1]
  v_pk_add_f32 v[64:65], v[64:65], v[66:67]
  v_cmp_o_f32 vcc, v64, v65
  s_and_b64 s[36:37], s[36:37], vcc
  s_cmp_eq_u64 s[36:37], -1
  s_cbranch_scc0 .fz_kernel_a_slow
.fz_kernel_a_ok:
  s_mov_b32 s8, s48
  s_mov_b32 s9, s49
  s_mov_b32 s10, 0x800
  s_mov_b32 s11, 0x00020000
  v_lshrrev_b32 v17, 5, v2
  v_lshlrev_b32 v19, 4, v17
  s_lshl_b32 s22, s18, 7
  s_lshl2_add_u32 s32, s17, s16
  s_lshl_b32 s35, s32, 16
  s_add_u32 s35, s35, s64
  s_mov_b32 s34, 0
  v_add_u32 v6, 8, v6
  buffer_load_dwordx4 v[48:51], v19, s[8:11], s22 offen offset:0
  buffer_load_dwordx4 v[52:55], v19, s[8:11], s22 offen offset:32
  buffer_load_dwordx4 v[56:59], v19, s[8:11], s22 offen offset:64
  buffer_load_dwordx4 v[60:63], v19, s[8:11], s22 offen offset:96
  s_waitcnt lgkmcnt(0)
  v_readfirstlane_b32 s36, v7
  s_bcnt1_i32_b32 s29, s36
  s_cmp_lt_u32 s29, 3
  s_cbranch_scc1 .fz_kernel_w_e0
  s_andn2_b32 s33, s36, s34
  s_cbranch_scc0 .fz_kernel_pk41c
.fz_kernel_pk41:
  s_ff1_i32_b32 s33, s33
  s_bitset1_b32 s34, s33
  s_lshl_b32 s20, s33, 13
  s_lshl_b32 s33, s33, 12
  s_add_u32 s30, s33, s35
  buffer_load_dwordx4 v[96:99], v3, s[4:7], s30 offen offset:0
  buffer_load_dwordx4 v[100:103], v3, s[4:7], s30 offen offset:1024
  buffer_load_dwordx4 v[104:107], v3, s[4:7], s30 offen offset:2048
  buffer_load_dwordx4 v[108:111], v3, s[4:7], s30 offen offset:3072
  s_andn2_b32 s33, s36, s34
  s_cbranch_scc0 .fz_kernel_pk42c
.fz_kernel_pk42:
  s_ff1_i32_b32 s33, s33
  s_bitset1_b32 s34, s33
  s_lshl_b32 s21, s33, 13
  s_lshl_b32 s33, s33, 12
  s_add_u32 s30, s33, s35
  buffer_load_dwordx4 v[112:115], v3, s[4:7], s30 offen offset:0
  buffer_load_dwordx4 v[116:119], v3, s[4:7], s30 offen offset:1024
  buffer_load_dwordx4 v[120:123], v3, s[4:7], s30 offen offset:2048
  buffer_load_dwordx4 v[124:127], v3, s[4:7], s30 offen offset:3072
  s_andn2_b32 s33, s36, s34
  s_cbranch_scc0 .fz_kernel_pk43c
.fz_kernel_pk43:
  s_ff1_i32_b32 s33, s33
  s_bitset1_b32 s34, s33
  s_lshl_b32 s22, s33, 13
  s_lshl_b32 s33, s33, 12
  s_add_u32 s30, s33, s35
  buffer_load_dwordx4 v[128:131], v3, s[4:7], s30 offen offset:0
  buffer_load_dwordx4 v[132:135], v3, s[4:7], s30 offen offset:1024
  buffer_load_dwordx4 v[136:139], v3, s[4:7], s30 offen offset:2048
  buffer_load_dwordx4 v[140:143], v3, s[4:7], s30 offen offset:3072
.fz_kernel_w_e0:
  v_and_b32 v18, 31, v2
  s_lshl_b32 s39, s17, 4
  s_add_u32 s39, s39, s18
  s_lshl_b32 s39, s39, 2
  s_add_u32 s39, s39, s16
  s_lshl_b32 s39, s39, 12
  v_and_b32 v16, 16, v2
  v_lshlrev_b32 v16, 7, v16
  v_lshl_add_u32 v16, v17, 8, v16
  v_and_b32 v1, 0xf0, v3
  v_add_u32 v16, v16, v1
  s_add_u32 s39, s39, s65
  s_lshl_b32 s31, s16, 5
  v_add_u32 v45, s31, v18
  v_lshlrev_b32 v11, 2, v45
  v_add_u32 v11, 155648, v11
  v_mov_b32 v44, 159952
  ds_read_b32 v40, v11 offset:6400
  ds_read_b32 v42, v11 offset:6912
  ds_read_b32 v46, v44 offset:8
  ds_read_b32 v44, v44
  v_mov_b32 v47, 0.32768
  v_add_u32 v45, 1, v45
  v_bfe_u32 v11, v2, 2, 2
  v_lshl_add_u32 v12, v17, 2, v11
  v_lshlrev_b32 v12, 7, v12
  v_lshrrev_b32 v13, 1, v11
  v_lshl_add_u32 v12, v13, 6, v12
  v_bfe_u32 v13, v2, 4, 1
  v_lshl_add_u32 v12, v13, 5, v12
  v_and_b32 v13, 1, v2
  v_lshl_add_u32 v12, v13, 4, v12
  v_bfe_u32 v13, v2, 1, 1
  v_lshl_add_u32 v14, v13, 3, v12
  v_xor_b32 v15, 64, v14
  s_mov_b64 exec, 1
  s_cmp_lt_u32 s29, 3
  s_cbranch_scc1 .fz_kernel_w_e1
  s_waitcnt vmcnt(16)
  s_branch .fz_kernel_w_e3
.fz_kernel_w_e1:
  s_waitcnt vmcnt(4)
.fz_kernel_w_e3:
  ds_add_u32 v6, v5 offset:0x100
  s_mov_b64 exec, -1
  v_lshlrev_b32 v64, 16, v232
  v_and_b32 v65, 0xffff0000, v232
  v_lshlrev_b32 v66, 16, v233
  v_and_b32 v67, 0xffff0000, v233
  v_lshlrev_b32 v68, 16, v234
  v_and_b32 v69, 0xffff0000, v234
  v_lshlrev_b32 v70, 16, v235
  v_and_b32 v71, 0xffff0000, v235
  v_lshlrev_b32 v72, 16, v236
  v_and_b32 v73, 0xffff0000, v236
  v_lshlrev_b32 v74, 16, v237
  v_and_b32 v75, 0xffff0000, v237
  v_lshlrev_b32 v76, 16, v238
  v_and_b32 v77, 0xffff0000, v238
  v_lshlrev_b32 v78, 16, v239
  v_and_b32 v79, 0xffff0000, v239
  v_lshlrev_b32 v80, 16, v240
  v_and_b32 v81, 0xffff0000, v240
  v_lshlrev_b32 v82, 16, v241
  v_and_b32 v83, 0xffff0000, v241
  v_lshlrev_b32 v84, 16, v242
  v_and_b32 v85, 0xffff0000, v242
  v_lshlrev_b32 v86, 16, v243
  v_and_b32 v87, 0xffff0000, v243
  v_lshlrev_b32 v88, 16, v244
  v_and_b32 v89, 0xffff0000, v244
  v_lshlrev_b32 v90, 16, v245
  v_and_b32 v91, 0xffff0000, v245
  v_lshlrev_b32 v92, 16, v246
  v_and_b32 v93, 0xffff0000, v246
  v_lshlrev_b32 v94, 16, v247
  v_and_b32 v95, 0xffff0000, v247
  s_waitcnt lgkmcnt(0)
  v_pk_fma_f32 v[64:65], v[64:65], v[40:41], v[42:43] op_sel_hi:[1,0,0]
  v_pk_fma_f32 v[66:67], v[66:67], v[40:41], v[42:43] op_sel_hi:[1,0,0]
  v_pk_fma_f32 v[68:69], v[68:69], v[40:41], v[42:43] op_sel_hi:[1,0,0]
  v_pk_fma_f32 v[70:71], v[70:71], v[40:41], v[42:43] op_sel_hi:[1,0,0]
  v_pk_fma_f32 v[72:73], v[72:73], v[40:41], v[42:43] op_sel_hi:[1,0,0]
  v_pk_fma_f32 v[74:75], v[74:75], v[40:41], v[42:43] op_sel_hi:[1,0,0]
  v_pk_fma_f32 v[76:77], v[76:77], v[40:41], v[42:43] op_sel_hi:[1,0,0]
  v_pk_fma_f32 v[78:79], v[78:79], v[40:41], v[42:43] op_sel_hi:[1,0,0]
  v_pk_fma_f32 v[80:81], v[80:81], v[40:41], v[42:43] op_sel_hi:[1,0,0]
  v_pk_fma_f32 v[82:83], v[82:83], v[40:41], v[42:43] op_sel_hi:[1,0,0]
  v_pk_fma_f32 v[84:85], v[84:85], v[40:41], v[42:43] op_sel_hi:[1,0,0]
  v_pk_fma_f32 v[86:87], v[86:87], v[40:41], v[42:43] op_sel_hi:[1,0,0]
  v_pk_fma_f32 v[88:89], v[88:89], v[40:41], v[42:43] op_sel_hi:[1,0,0]
  v_pk_fma_f32 v[90:91], v[90:91], v[40:41], v[42:43] op_sel_hi:[1,0,0]
  v_pk_fma_f32 v[92:93], v[92:93], v[40:41], v[42:43] op_sel_hi:[1,0,0]
  v_pk_fma_f32 v[94:95], v[94:95], v[40:41], v[42:43] op_sel_hi:[1,0,0]
  v_cmp_eq_u32 vcc, v44, v45
  s_cbranch_vccnz .fz_kernel_w_pt
.fz_kernel_w_pb:
  s_cmp_ge_u32 s29, 3
  s_cbranch_scc1 .fz_kernel_w_e2
  s_andn2_b32 s33, s36, s34
  s_cbranch_scc0 .fz_kernel_pk44c
.fz_kernel_pk44:
  s_ff1_i32_b32 s33, s33
  s_bitset1_b32 s34, s33
  s_lshl_b32 s20, s33, 13
  s_lshl_b32 s33, s33, 12
  s_add_u32 s30, s33, s35
  buffer_load_dwordx4 v[96:99], v3, s[4:7], s30 offen offset:0
  buffer_load_dwordx4 v[100:103], v3, s[4:7], s30 offen offset:1024
  buffer_load_dwordx4 v[104:107], v3, s[4:7], s30 offen offset:2048
  buffer_load_dwordx4 v[108:111], v3, s[4:7], s30 offen offset:3072
  s_andn2_b32 s33, s36, s34
  s_cbranch_scc0 .fz_kernel_pk45c
.fz_kernel_pk45:
  s_ff1_i32_b32 s33, s33
  s_bitset1_b32 s34, s33
  s_lshl_b32 s21, s33, 13
  s_lshl_b32 s33, s33, 12
  s_add_u32 s30, s33, s35
  buffer_load_dwordx4 v[112:115], v3, s[4:7], s30 offen offset:0
  buffer_load_dwordx4 v[116:119], v3, s[4:7], s30 offen offset:1024
  buffer_load_dwordx4 v[120:123], v3, s[4:7], s30 offen offset:2048
  buffer_load_dwordx4 v[124:127], v3, s[4:7], s30 offen offset:3072
  s_andn2_b32 s33, s36, s34
  s_cbranch_scc0 .fz_kernel_pk46c
.fz_kernel_pk46:
  s_ff1_i32_b32 s33, s33
  s_bitset1_b32 s34, s33
  s_lshl_b32 s22, s33, 13
  s_lshl_b32 s33, s33, 12
  s_add_u32 s30, s33, s35
  buffer_load_dwordx4 v[128:131], v3, s[4:7], s30 offen offset:0
  buffer_load_dwordx4 v[132:135], v3, s[4:7], s30 offen offset:1024
  buffer_load_dwordx4 v[136:139], v3, s[4:7], s30 offen offset:2048
  buffer_load_dwordx4 v[140:143], v3, s[4:7], s30 offen offset:3072
.fz_kernel_w_e2:
  v_add_u32 v10, s20, v14
  v_add_u32 v11, s20, v15
  ds_read_b64_tr_b16 v[224:225], v10 offset:0
  ds_read_b64_tr_b16 v[226:227], v10 offset:1024
  ds_read_b64_tr_b16 v[228:229], v11 offset:0
  ds_read_b64_tr_b16 v[230:231], v11 offset:1024
  ds_read_b64_tr_b16 v[232:233], v10 offset:2048
  ds_read_b64_tr_b16 v[234:235], v10 offset:3072
  ds_read_b64_tr_b16 v[236:237], v11 offset:2048
  ds_read_b64_tr_b16 v[238:239], v11 offset:3072
  s_andn2_b32 s33, s36, s34
  s_cbranch_scc0 .fz_kernel_pk47c
.fz_kernel_pk47:
  s_ff1_i32_b32 s33, s33
  s_bitset1_b32 s34, s33
  s_lshl_b32 s23, s33, 13
  s_lshl_b32 s33, s33, 12
  s_add_u32 s30, s33, s35
  s_waitcnt vmcnt(11) lgkmcnt(6)
  v_mfma_f32_32x32x16_bf16 v[64:79], v[224:227], v[96:99], v[64:79]
  v_add_u32 v12, s21, v14
  v_add_u32 v13, s21, v15
  buffer_load_dwordx4 v[144:147], v3, s[4:7], s30 offen offset:0
  ds_read_b64_tr_b16 v[240:241], v10 offset:4096
  s_waitcnt lgkmcnt(5)
  v_mfma_f32_32x32x16_bf16 v[80:95], v[228:231], v[96:99], v[80:95]
  ds_read_b64_tr_b16 v[242:243], v10 offset:5120
  ds_read_b64_tr_b16 v[244:245], v11 offset:4096
  ds_read_b64_tr_b16 v[246:247], v11 offset:5120
  s_waitcnt vmcnt(11) lgkmcnt(6)
  v_mfma_f32_32x32x16_bf16 v[64:79], v[232:235], v[100:103], v[64:79]
  buffer_load_dwordx4 v[148:151], v3, s[4:7], s30 offen offset:1024
  ds_read_b64_tr_b16 v[248:249], v10 offset:6144
  s_waitcnt lgkmcnt(5)
  v_mfma_f32_32x32x16_bf16 v[80:95], v[236:239], v[100:103], v[80:95]
  ds_read_b64_tr_b16 v[250:251], v10 offset:7168
  ds_read_b64_tr_b16 v[252:253], v11 offset:6144
  ds_read_b64_tr_b16 v[254:255], v11 offset:7168
  s_waitcnt vmcnt(11) lgkmcnt(6)
  v_mfma_f32_32x32x16_bf16 v[64:79], v[240:243], v[104:107], v[64:79]
  buffer_load_dwordx4 v[152:155], v3, s[4:7], s30 offen offset:2048
  ds_read_b64_tr_b16 v[224:225], v12 offset:0
  s_waitcnt lgkmcnt(5)
  v_mfma_f32_32x32x16_bf16 v[80:95], v[244:247], v[104:107], v[80:95]
  ds_read_b64_tr_b16 v[226:227], v12 offset:1024
  ds_read_b64_tr_b16 v[228:229], v13 offset:0
  ds_read_b64_tr_b16 v[230:231], v13 offset:1024
  s_waitcnt vmcnt(11) lgkmcnt(6)
  v_mfma_f32_32x32x16_bf16 v[64:79], v[248:251], v[108:111], v[64:79]
  buffer_load_dwordx4 v[156:159], v3, s[4:7], s30 offen offset:3072
  ds_read_b64_tr_b16 v[232:233], v12 offset:2048
  s_waitcnt lgkmcnt(5)
  v_mfma_f32_32x32x16_bf16 v[80:95], v[252:255], v[108:111], v[80:95]
  ds_read_b64_tr_b16 v[234:235], v12 offset:3072
  ds_read_b64_tr_b16 v[236:237], v13 offset:2048
  ds_read_b64_tr_b16 v[238:239], v13 offset:3072
  s_andn2_b32 s33, s36, s34
  s_cbranch_scc0 .fz_kernel_pk48c
.fz_kernel_pk48:
  s_ff1_i32_b32 s33, s33
  s_bitset1_b32 s34, s33
  s_lshl_b32 s24, s33, 13
  s_lshl_b32 s33, s33, 12
  s_add_u32 s30, s33, s35
  s_waitcnt vmcnt(11) lgkmcnt(6)
  v_mfma_f32_32x32x16_bf16 v[64:79], v[224:227], v[112:115], v[64:79]
  v_add_u32 v10, s22, v14
  v_add_u32 v11, s22, v15
  buffer_load_dwordx4 v[160:163], v3, s[4:7], s30 offen offset:0
  ds_read_b64_tr_b16 v[240:241], v12 offset:4096
  s_waitcnt lgkmcnt(5)
  v_mfma_f32_32x32x16_bf16 v[80:95], v[228:231], v[112:115], v[80:95]
  ds_read_b64_tr_b16 v[242:243], v12 offset:5120
  ds_read_b64_tr_b16 v[244:245], v13 offset:4096
  ds_read_b64_tr_b16 v[246:247], v13 offset:5120
  s_waitcnt vmcnt(11) lgkmcnt(6)
  v_mfma_f32_32x32x16_bf16 v[64:79], v[232:235], v[116:119], v[64:79]
  buffer_load_dwordx4 v[164:167], v3, s[4:7], s30 offen offset:1024
  ds_read_b64_tr_b16 v[248:249], v12 offset:6144
  s_waitcnt lgkmcnt(5)
  v_mfma_f32_32x32x16_bf16 v[80:95], v[236:239], v[116:119], v[80:95]
  ds_read_b64_tr_b16 v[250:251], v12 offset:7168
  ds_read_b64_tr_b16 v[252:253], v13 offset:6144
  ds_read_b64_tr_b16 v[254:255], v13 offset:7168
  s_waitcnt vmcnt(11) lgkmcnt(6)
  v_mfma_f32_32x32x16_bf16 v[64:79], v[240:243], v[120:123], v[64:79]
  buffer_load_dwordx4 v[168:171], v3, s[4:7], s30 offen offset:2048
  ds_read_b64_tr_b16 v[224:225], v10 offset:0
  s_waitcnt lgkmcnt(5)
  v_mfma_f32_32x32x16_bf16 v[80:95], v[244:247], v[120:123], v[80:95]
  ds_read_b64_tr_b16 v[226:227], v10 offset:1024
  ds_read_b64_tr_b16 v[228:229], v11 offset:0
  ds_read_b64_tr_b16 v[230:231], v11 offset:1024
  s_waitcnt vmcnt(11) lgkmcnt(6)
  v_mfma_f32_32x32x16_bf16 v[64:79], v[248:251], v[124:127], v[64:79]
  buffer_load_dwordx4 v[172:175], v3, s[4:7], s30 offen offset:3072
  ds_read_b64_tr_b16 v[232:233], v10 offset:2048
  s_waitcnt lgkmcnt(5)
  v_mfma_f32_32x32x16_bf16 v[80:95], v[252:255], v[124:127], v[80:95]
  ds_read_b64_tr_b16 v[234:235], v10 offset:3072
  ds_read_b64_tr_b16 v[236:237], v11 offset:2048
  ds_read_b64_tr_b16 v[238:239], v11 offset:3072
  s_andn2_b32 s33, s36, s34
  s_cbranch_scc0 .fz_kernel_pk49c
.fz_kernel_pk49:
  s_ff1_i32_b32 s33, s33
  s_bitset1_b32 s34, s33
  s_lshl_b32 s25, s33, 13
  s_lshl_b32 s33, s33, 12
  s_add_u32 s30, s33, s35
  s_waitcnt vmcnt(11) lgkmcnt(6)
  v_mfma_f32_32x32x16_bf16 v[64:79], v[224:227], v[128:131], v[64:79]
  v_add_u32 v12, s23, v14
  v_add_u32 v13, s23, v15
  buffer_load_dwordx4 v[176:179], v3, s[4:7], s30 offen offset:0
  ds_read_b64_tr_b16 v[240:241], v10 offset:4096
  s_waitcnt lgkmcnt(5)
  v_mfma_f32_32x32x16_bf16 v[80:95], v[228:231], v[128:131], v[80:95]
  ds_read_b64_tr_b16 v[242:243], v10 offset:5120
  ds_read_b64_tr_b16 v[244:245], v11 offset:4096
  ds_read_b64_tr_b16 v[246:247], v11 offset:5120
  s_waitcnt vmcnt(11) lgkmcnt(6)
  v_mfma_f32_32x32x16_bf16 v[64:79], v[232:235], v[132:135], v[64:79]
  buffer_load_dwordx4 v[180:183], v3, s[4:7], s30 offen offset:1024
  ds_read_b64_tr_b16 v[248:249], v10 offset:6144
  s_waitcnt lgkmcnt(5)
  v_mfma_f32_32x32x16_bf16 v[80:95], v[236:239], v[132:135], v[80:95]
  ds_read_b64_tr_b16 v[250:251], v10 offset:7168
  ds_read_b64_tr_b16 v[252:253], v11 offset:6144
  ds_read_b64_tr_b16 v[254:255], v11 offset:7168
  s_waitcnt vmcnt(11) lgkmcnt(6)
  v_mfma_f32_32x32x16_bf16 v[64:79], v[240:243], v[136:139], v[64:79]
  buffer_load_dwordx4 v[184:187], v3, s[4:7], s30 offen offset:2048
  ds_read_b64_tr_b16 v[224:225], v12 offset:0
  s_waitcnt lgkmcnt(5)
  v_mfma_f32_32x32x16_bf16 v[80:95], v[244:247], v[136:139], v[80:95]
  ds_read_b64_tr_b16 v[226:227], v12 offset:1024
  ds_read_b64_tr_b16 v[228:229], v13 offset:0
  ds_read_b64_tr_b16 v[230:231], v13 offset:1024
  s_waitcnt vmcnt(11) lgkmcnt(6)
  v_mfma_f32_32x32x16_bf16 v[64:79], v[248:251], v[140:143], v[64:79]
  buffer_load_dwordx4 v[188:191], v3, s[4:7], s30 offen offset:3072
  ds_read_b64_tr_b16 v[232:233], v12 offset:2048
  s_waitcnt lgkmcnt(5)
  v_mfma_f32_32x32x16_bf16 v[80:95], v[252:255], v[140:143], v[80:95]
  ds_read_b64_tr_b16 v[234:235], v12 offset:3072
  ds_read_b64_tr_b16 v[236:237], v13 offset:2048
  ds_read_b64_tr_b16 v[238:239], v13 offset:3072
  s_andn2_b32 s33, s36, s34
  s_cbranch_scc0 .fz_kernel_pk50c
.fz_kernel_pk50:
  s_ff1_i32_b32 s33, s33
  s_bitset1_b32 s34, s33
  s_lshl_b32 s26, s33, 13
  s_lshl_b32 s33, s33, 12
  s_add_u32 s30, s33, s35
  s_waitcnt vmcnt(11) lgkmcnt(6)
  v_mfma_f32_32x32x16_bf16 v[64:79], v[224:227], v[144:147], v[64:79]
  v_add_u32 v10, s24, v14
  v_add_u32 v11, s24, v15
  buffer_load_dwordx4 v[192:195], v3, s[4:7], s30 offen offset:0
  ds_read_b64_tr_b16 v[240:241], v12 offset:4096
  s_waitcnt lgkmcnt(5)
  v_mfma_f32_32x32x16_bf16 v[80:95], v[228:231], v[144:147], v[80:95]
  ds_read_b64_tr_b16 v[242:243], v12 offset:5120
  ds_read_b64_tr_b16 v[244:245], v13 offset:4096
  ds_read_b64_tr_b16 v[246:247], v13 offset:5120
  s_waitcnt vmcnt(11) lgkmcnt(6)
  v_mfma_f32_32x32x16_bf16 v[64:79], v[232:235], v[148:151], v[64:79]
  buffer_load_dwordx4 v[196:199], v3, s[4:7], s30 offen offset:1024
  ds_read_b64_tr_b16 v[248:249], v12 offset:6144
  s_waitcnt lgkmcnt(5)
  v_mfma_f32_32x32x16_bf16 v[80:95], v[236:239], v[148:151], v[80:95]
  ds_read_b64_tr_b16 v[250:251], v12 offset:7168
  ds_read_b64_tr_b16 v[252:253], v13 offset:6144
  ds_read_b64_tr_b16 v[254:255], v13 offset:7168
  s_waitcnt vmcnt(11) lgkmcnt(6)
  v_mfma_f32_32x32x16_bf16 v[64:79], v[240:243], v[152:155], v[64:79]
  buffer_load_dwordx4 v[200:203], v3, s[4:7], s30 offen offset:2048
  ds_read_b64_tr_b16 v[224:225], v10 offset:0
  s_waitcnt lgkmcnt(5)
  v_mfma_f32_32x32x16_bf16 v[80:95], v[244:247], v[152:155], v[80:95]
  ds_read_b64_tr_b16 v[226:227], v10 offset:1024
  ds_read_b64_tr_b16 v[228:229], v11 offset:0
  ds_read_b64_tr_b16 v[230:231], v11 offset:1024
  s_waitcnt vmcnt(11) lgkmcnt(6)
  v_mfma_f32_32x32x16_bf16 v[64:79], v[248:251], v[156:159], v[64:79]
  buffer_load_dwordx4 v[204:207], v3, s[4:7], s30 offen offset:3072
  ds_read_b64_tr_b16 v[232:233], v10 offset:2048
  s_waitcnt lgkmcnt(5)
  v_mfma_f32_32x32x16_bf16 v[80:95], v[252:255], v[156:159], v[80:95]
  ds_read_b64_tr_b16 v[234:235], v10 offset:3072
  ds_read_b64_tr_b16 v[236:237], v11 offset:2048
  ds_read_b64_tr_b16 v[238:239], v11 offset:3072
  s_andn2_b32 s33, s36, s34
  s_cbranch_scc0 .fz_kernel_pk51c
.fz_kernel_pk51:
  s_ff1_i32_b32 s33, s33
  s_bitset1_b32 s34, s33
  s_lshl_b32 s27, s33, 13
  s_lshl_b32 s33, s33, 12
  s_add_u32 s30, s33, s35
  s_waitcnt vmcnt(11) lgkmcnt(6)
  v_mfma_f32_32x32x16_bf16 v[64:79], v[224:227], v[160:163], v[64:79]
  v_add_u32 v12, s25, v14
  v_add_u32 v13, s25, v15
  buffer_load_dwordx4 v[208:211], v3, s[4:7], s30 offen offset:0
  ds_read_b64_tr_b16 v[240:241], v10 offset:4096
  s_waitcnt lgkmcnt(5)
  v_mfma_f32_32x32x16_bf16 v[80:95], v[228:231], v[160:163], v[80:95]
  ds_read_b64_tr_b16 v[242:243], v10 offset:5120
  ds_read_b64_tr_b16 v[244:245], v11 offset:4096
  ds_read_b64_tr_b16 v[246:247], v11 offset:5120
  s_waitcnt vmcnt(11) lgkmcnt(6)
  v_mfma_f32_32x32x16_bf16 v[64:79], v[232:235], v[164:167], v[64:79]
  buffer_load_dwordx4 v[212:215], v3, s[4:7], s30 offen offset:1024
  ds_read_b64_tr_b16 v[248:249], v10 offset:6144
  s_waitcnt lgkmcnt(5)
  v_mfma_f32_32x32x16_bf16 v[80:95], v[236:239], v[164:167], v[80:95]
  ds_read_b64_tr_b16 v[250:251], v10 offset:7168
  ds_read_b64_tr_b16 v[252:253], v11 offset:6144
  ds_read_b64_tr_b16 v[254:255], v11 offset:7168
  s_waitcnt vmcnt(11) lgkmcnt(6)
  v_mfma_f32_32x32x16_bf16 v[64:79], v[240:243], v[168:171], v[64:79]
  buffer_load_dwordx4 v[216:219], v3, s[4:7], s30 offen offset:2048
  ds_read_b64_tr_b16 v[224:225], v12 offset:0
  s_waitcnt lgkmcnt(5)
  v_mfma_f32_32x32x16_bf16 v[80:95], v[244:247], v[168:171], v[80:95]
  ds_read_b64_tr_b16 v[226:227], v12 offset:1024
  ds_read_b64_tr_b16 v[228:229], v13 offset:0
  ds_read_b64_tr_b16 v[230:231], v13 offset:1024
  s_waitcnt vmcnt(11) lgkmcnt(6)
  v_mfma_f32_32x32x16_bf16 v[64:79], v[248:251], v[172:175], v[64:79]
  buffer_load_dwordx4 v[220:223], v3, s[4:7], s30 offen offset:3072
  ds_read_b64_tr_b16 v[232:233], v12 offset:2048
  s_waitcnt lgkmcnt(5)
  v_mfma_f32_32x32x16_bf16 v[80:95], v[252:255], v[172:175], v[80:95]
  ds_read_b64_tr_b16 v[234:235], v12 offset:3072
  ds_read_b64_tr_b16 v[236:237], v13 offset:2048
  ds_read_b64_tr_b16 v[238:239], v13 offset:3072
  s_andn2_b32 s33, s36, s34
  s_cbranch_scc0 .fz_kernel_pk52c
.fz_kernel_pk52:
  s_ff1_i32_b32 s33, s33
  s_bitset1_b32 s34, s33
  s_lshl_b32 s20, s33, 13
  s_lshl_b32 s33, s33, 12
  s_add_u32 s30, s33, s35
  s_waitcnt vmcnt(11) lgkmcnt(6)
  v_mfma_f32_32x32x16_bf16 v[64:79], v[224:227], v[176:179], v[64:79]
  v_add_u32 v10, s26, v14
  v_add_u32 v11, s26, v15
  buffer_load_dwordx4 v[96:99], v3, s[4:7], s30 offen offset:0
  ds_read_b64_tr_b16 v[240:241], v12 offset:4096
  s_waitcnt lgkmcnt(5)
  v_mfma_f32_32x32x16_bf16 v[80:95], v[228:231], v[176:179], v[80:95]
  ds_read_b64_tr_b16 v[242:243], v12 offset:5120
  ds_read_b64_tr_b16 v[244:245], v13 offset:4096
  ds_read_b64_tr_b16 v[246:247], v13 offset:5120
  s_waitcnt vmcnt(11) lgkmcnt(6)
  v_mfma_f32_32x32x16_bf16 v[64:79], v[232:235], v[180:183], v[64:79]
  buffer_load_dwordx4 v[100:103], v3, s[4:7], s30 offen offset:1024
  ds_read_b64_tr_b16 v[248:249], v12 offset:6144
  s_waitcnt lgkmcnt(5)
  v_mfma_f32_32x32x16_bf16 v[80:95], v[236:239], v[180:183], v[80:95]
  ds_read_b64_tr_b16 v[250:251], v12 offset:7168
  ds_read_b64_tr_b16 v[252:253], v13 offset:6144
  ds_read_b64_tr_b16 v[254:255], v13 offset:7168
  s_waitcnt vmcnt(11) lgkmcnt(6)
  v_mfma_f32_32x32x16_bf16 v[64:79], v[240:243], v[184:187], v[64:79]
  buffer_load_dwordx4 v[104:107], v3, s[4:7], s30 offen offset:2048
  ds_read_b64_tr_b16 v[224:225], v10 offset:0
  s_waitcnt lgkmcnt(5)
  v_mfma_f32_32x32x16_bf16 v[80:95], v[244:247], v[184:187], v[80:95]
  ds_read_b64_tr_b16 v[226:227], v10 offset:1024
  ds_read_b64_tr_b16 v[228:229], v11 offset:0
  ds_read_b64_tr_b16 v[230:231], v11 offset:1024
  s_waitcnt vmcnt(11) lgkmcnt(6)
  v_mfma_f32_32x32x16_bf16 v[64:79], v[248:251], v[188:191], v[64:79]
  buffer_load_dwordx4 v[108:111], v3, s[4:7], s30 offen offset:3072
  ds_read_b64_tr_b16 v[232:233], v10 offset:2048
  s_waitcnt lgkmcnt(5)
  v_mfma_f32_32x32x16_bf16 v[80:95], v[252:255], v[188:191], v[80:95]
  ds_read_b64_tr_b16 v[234:235], v10 offset:3072
  ds_read_b64_tr_b16 v[236:237], v11 offset:2048
  ds_read_b64_tr_b16 v[238:239], v11 offset:3072
  s_andn2_b32 s33, s36, s34
  s_cbranch_scc0 .fz_kernel_pk53c
.fz_kernel_pk53:
  s_ff1_i32_b32 s33, s33
  s_bitset1_b32 s34, s33
  s_lshl_b32 s21, s33, 13
  s_lshl_b32 s33, s33, 12
  s_add_u32 s30, s33, s35
  s_waitcnt vmcnt(11) lgkmcnt(6)
  v_mfma_f32_32x32x16_bf16 v[64:79], v[224:227], v[192:195], v[64:79]
  v_add_u32 v12, s27, v14
  v_add_u32 v13, s27, v15
  buffer_load_dwordx4 v[112:115], v3, s[4:7], s30 offen offset:0
  ds_read_b64_tr_b16 v[240:241], v10 offset:4096
  s_waitcnt lgkmcnt(5)
  v_mfma_f32_32x32x16_bf16 v[80:95], v[228:231], v[192:195], v[80:95]
  ds_read_b64_tr_b16 v[242:243], v10 offset:5120
  ds_read_b64_tr_b16 v[244:245], v11 offset:4096
  ds_read_b64_tr_b16 v[246:247], v11 offset:5120
  s_waitcnt vmcnt(11) lgkmcnt(6)
  v_mfma_f32_32x32x16_bf16 v[64:79], v[232:235], v[196:199], v[64:79]
  buffer_load_dwordx4 v[116:119], v3, s[4:7], s30 offen offset:1024
  ds_read_b64_tr_b16 v[248:249], v10 offset:6144
  s_waitcnt lgkmcnt(5)
  v_mfma_f32_32x32x16_bf16 v[80:95], v[236:239], v[196:199], v[80:95]
  ds_read_b64_tr_b16 v[250:251], v10 offset:7168
  ds_read_b64_tr_b16 v[252:253], v11 offset:6144
  ds_read_b64_tr_b16 v[254:255], v11 offset:7168
  s_waitcnt vmcnt(11) lgkmcnt(6)
  v_mfma_f32_32x32x16_bf16 v[64:79], v[240:243], v[200:203], v[64:79]
  buffer_load_dwordx4 v[120:123], v3, s[4:7], s30 offen offset:2048
  ds_read_b64_tr_b16 v[224:225], v12 offset:0
  s_waitcnt lgkmcnt(5)
  v_mfma_f32_32x32x16_bf16 v[80:95], v[244:247], v[200:203], v[80:95]
  ds_read_b64_tr_b16 v[226:227], v12 offset:1024
  ds_read_b64_tr_b16 v[228:229], v13 offset:0
  ds_read_b64_tr_b16 v[230:231], v13 offset:1024
  s_waitcnt vmcnt(11) lgkmcnt(6)
  v_mfma_f32_32x32x16_bf16 v[64:79], v[248:251], v[204:207], v[64:79]
  buffer_load_dwordx4 v[124:127], v3, s[4:7], s30 offen offset:3072
  ds_read_b64_tr_b16 v[232:233], v12 offset:2048
  s_waitcnt lgkmcnt(5)
  v_mfma_f32_32x32x16_bf16 v[80:95], v[252:255], v[204:207], v[80:95]
  ds_read_b64_tr_b16 v[234:235], v12 offset:3072
  ds_read_b64_tr_b16 v[236:237], v13 offset:2048
  ds_read_b64_tr_b16 v[238:239], v13 offset:3072
  s_andn2_b32 s33, s36, s34
  s_cbranch_scc0 .fz_kernel_pk54c
.fz_kernel_pk54:
  s_ff1_i32_b32 s33, s33
  s_bitset1_b32 s34, s33
  s_lshl_b32 s22, s33, 13
  s_lshl_b32 s33, s33, 12
  s_add_u32 s30, s33, s35
  s_waitcnt vmcnt(11) lgkmcnt(6)
  v_mfma_f32_32x32x16_bf16 v[64:79], v[224:227], v[208:211], v[64:79]
  v_add_u32 v10, s20, v14
  v_add_u32 v11, s20, v15
  buffer_load_dwordx4 v[128:131], v3, s[4:7], s30 offen offset:0
  ds_read_b64_tr_b16 v[240:241], v12 offset:4096
  s_waitcnt lgkmcnt(5)
  v_mfma_f32_32x32x16_bf16 v[80:95], v[228:231], v[208:211], v[80:95]
  ds_read_b64_tr_b16 v[242:243], v12 offset:5120
  ds_read_b64_tr_b16 v[244:245], v13 offset:4096
  ds_read_b64_tr_b16 v[246:247], v13 offset:5120
  s_waitcnt vmcnt(11) lgkmcnt(6)
  v_mfma_f32_32x32x16_bf16 v[64:79], v[232:235], v[212:215], v[64:79]
  buffer_load_dwordx4 v[132:135], v3, s[4:7], s30 offen offset:1024
  ds_read_b64_tr_b16 v[248:249], v12 offset:6144
  s_waitcnt lgkmcnt(5)
  v_mfma_f32_32x32x16_bf16 v[80:95], v[236:239], v[212:215], v[80:95]
  ds_read_b64_tr_b16 v[250:251], v12 offset:7168
  ds_read_b64_tr_b16 v[252:253], v13 offset:6144
  ds_read_b64_tr_b16 v[254:255], v13 offset:7168
  s_waitcnt vmcnt(11) lgkmcnt(6)
  v_mfma_f32_32x32x16_bf16 v[64:79], v[240:243], v[216:219], v[64:79]
  buffer_load_dwordx4 v[136:139], v3, s[4:7], s30 offen offset:2048
  ds_read_b64_tr_b16 v[224:225], v10 offset:0
  s_waitcnt lgkmcnt(5)
  v_mfma_f32_32x32x16_bf16 v[80:95], v[244:247], v[216:219], v[80:95]
  ds_read_b64_tr_b16 v[226:227], v10 offset:1024
  ds_read_b64_tr_b16 v[228:229], v11 offset:0
  ds_read_b64_tr_b16 v[230:231], v11 offset:1024
  s_waitcnt vmcnt(11) lgkmcnt(6)
  v_mfma_f32_32x32x16_bf16 v[64:79], v[248:251], v[220:223], v[64:79]
  buffer_load_dwordx4 v[140:143], v3, s[4:7], s30 offen offset:3072
  ds_read_b64_tr_b16 v[232:233], v10 offset:2048
  s_waitcnt lgkmcnt(5)
  v_mfma_f32_32x32x16_bf16 v[80:95], v[252:255], v[220:223], v[80:95]
  ds_read_b64_tr_b16 v[234:235], v10 offset:3072
  ds_read_b64_tr_b16 v[236:237], v11 offset:2048
  ds_read_b64_tr_b16 v[238:239], v11 offset:3072
  s_andn2_b32 s33, s36, s34
  s_cbranch_scc0 .fz_kernel_pk55c
.fz_kernel_pk55:
  s_ff1_i32_b32 s33, s33
  s_bitset1_b32 s34, s33
  s_lshl_b32 s23, s33, 13
  s_lshl_b32 s33, s33, 12
  s_add_u32 s30, s33, s35
  s_waitcnt vmcnt(11) lgkmcnt(6)
  v_mfma_f32_32x32x16_bf16 v[64:79], v[224:227], v[96:99], v[64:79]
  v_add_u32 v12, s21, v14
  v_add_u32 v13, s21, v15
  buffer_load_dwordx4 v[144:147], v3, s[4:7], s30 offen offset:0
  ds_read_b64_tr_b16 v[240:241], v10 offset:4096
  s_waitcnt lgkmcnt(5)
  v_mfma_f32_32x32x16_bf16 v[80:95], v[228:231], v[96:99], v[80:95]
  ds_read_b64_tr_b16 v[242:243], v10 offset:5120
  ds_read_b64_tr_b16 v[244:245], v11 offset:4096
  ds_read_b64_tr_b16 v[246:247], v11 offset:5120
  s_waitcnt vmcnt(11) lgkmcnt(6)
  v_mfma_f32_32x32x16_bf16 v[64:79], v[232:235], v[100:103], v[64:79]
  buffer_load_dwordx4 v[148:151], v3, s[4:7], s30 offen offset:1024
  ds_read_b64_tr_b16 v[248:249], v10 offset:6144
  s_waitcnt lgkmcnt(5)
  v_mfma_f32_32x32x16_bf16 v[80:95], v[236:239], v[100:103], v[80:95]
  ds_read_b64_tr_b16 v[250:251], v10 offset:7168
  ds_read_b64_tr_b16 v[252:253], v11 offset:6144
  ds_read_b64_tr_b16 v[254:255], v11 offset:7168
  s_waitcnt vmcnt(11) lgkmcnt(6)
  v_mfma_f32_32x32x16_bf16 v[64:79], v[240:243], v[104:107], v[64:79]
  buffer_load_dwordx4 v[152:155], v3, s[4:7], s30 offen offset:2048
  ds_read_b64_tr_b16 v[224:225], v12 offset:0
  s_waitcnt lgkmcnt(5)
  v_mfma_f32_32x32x16_bf16 v[80:95], v[244:247], v[104:107], v[80:95]
  ds_read_b64_tr_b16 v[226:227], v12 offset:1024
  ds_read_b64_tr_b16 v[228:229], v13 offset:0
  ds_read_b64_tr_b16 v[230:231], v13 offset:1024
  s_waitcnt vmcnt(11) lgkmcnt(6)
  v_mfma_f32_32x32x16_bf16 v[64:79], v[248:251], v[108:111], v[64:79]
  buffer_load_dwordx4 v[156:159], v3, s[4:7], s30 offen offset:3072
  ds_read_b64_tr_b16 v[232:233], v12 offset:2048
  s_waitcnt lgkmcnt(5)
  v_mfma_f32_32x32x16_bf16 v[80:95], v[252:255], v[108:111], v[80:95]
  ds_read_b64_tr_b16 v[234:235], v12 offset:3072
  ds_read_b64_tr_b16 v[236:237], v13 offset:2048
  ds_read_b64_tr_b16 v[238:239], v13 offset:3072
  s_andn2_b32 s33, s36, s34
  s_cbranch_scc0 .fz_kernel_pk56c
.fz_kernel_pk56:
  s_ff1_i32_b32 s33, s33
  s_bitset1_b32 s34, s33
  s_lshl_b32 s24, s33, 13
  s_lshl_b32 s33, s33, 12
  s_add_u32 s30, s33, s35
  s_waitcnt vmcnt(11) lgkmcnt(6)
  v_mfma_f32_32x32x16_bf16 v[64:79], v[224:227], v[112:115], v[64:79]
  v_add_u32 v10, s22, v14
  v_add_u32 v11, s22, v15
  buffer_load_dwordx4 v[160:163], v3, s[4:7], s30 offen offset:0
  ds_read_b64_tr_b16 v[240:241], v12 offset:4096
  s_waitcnt lgkmcnt(5)
  v_mfma_f32_32x32x16_bf16 v[80:95], v[228:231], v[112:115], v[80:95]
  ds_read_b64_tr_b16 v[242:243], v12 offset:5120
  ds_read_b64_tr_b16 v[244:245], v13 offset:4096
  ds_read_b64_tr_b16 v[246:247], v13 offset:5120
  s_waitcnt vmcnt(11) lgkmcnt(6)
  v_mfma_f32_32x32x16_bf16 v[64:79], v[232:235], v[116:119], v[64:79]
  buffer_load_dwordx4 v[164:167], v3, s[4:7], s30 offen offset:1024
  ds_read_b64_tr_b16 v[248:249], v12 offset:6144
  s_waitcnt lgkmcnt(5)
  v_mfma_f32_32x32x16_bf16 v[80:95], v[236:239], v[116:119], v[80:95]
  ds_read_b64_tr_b16 v[250:251], v12 offset:7168
  ds_read_b64_tr_b16 v[252:253], v13 offset:6144
  ds_read_b64_tr_b16 v[254:255], v13 offset:7168
  s_waitcnt vmcnt(11) lgkmcnt(6)
  v_mfma_f32_32x32x16_bf16 v[64:79], v[240:243], v[120:123], v[64:79]
  buffer_load_dwordx4 v[168:171], v3, s[4:7], s30 offen offset:2048
  ds_read_b64_tr_b16 v[224:225], v10 offset:0
  s_waitcnt lgkmcnt(5)
  v_mfma_f32_32x32x16_bf16 v[80:95], v[244:247], v[120:123], v[80:95]
  ds_read_b64_tr_b16 v[226:227], v10 offset:1024
  ds_read_b64_tr_b16 v[228:229], v11 offset:0
  ds_read_b64_tr_b16 v[230:231], v11 offset:1024
  s_waitcnt vmcnt(11) lgkmcnt(6)
  v_mfma_f32_32x32x16_bf16 v[64:79], v[248:251], v[124:127], v[64:79]
  buffer_load_dwordx4 v[172:175], v3, s[4:7], s30 offen offset:3072
  ds_read_b64_tr_b16 v[232:233], v10 offset:2048
  s_waitcnt lgkmcnt(5)
  v_mfma_f32_32x32x16_bf16 v[80:95], v[252:255], v[124:127], v[80:95]
  ds_read_b64_tr_b16 v[234:235], v10 offset:3072
  ds_read_b64_tr_b16 v[236:237], v11 offset:2048
  ds_read_b64_tr_b16 v[238:239], v11 offset:3072
  s_andn2_b32 s33, s36, s34
  s_cbranch_scc0 .fz_kernel_pk57c
.fz_kernel_pk57:
  s_ff1_i32_b32 s33, s33
  s_bitset1_b32 s34, s33
  s_lshl_b32 s25, s33, 13
  s_lshl_b32 s33, s33, 12
  s_add_u32 s30, s33, s35
  s_waitcnt vmcnt(11) lgkmcnt(6)
  v_mfma_f32_32x32x16_bf16 v[64:79], v[224:227], v[128:131], v[64:79]
  v_add_u32 v12, s23, v14
  v_add_u32 v13, s23, v15
  buffer_load_dwordx4 v[176:179], v3, s[4:7], s30 offen offset:0
  ds_read_b64_tr_b16 v[240:241], v10 offset:4096
  s_waitcnt lgkmcnt(5)
  v_mfma_f32_32x32x16_bf16 v[80:95], v[228:231], v[128:131], v[80:95]
  ds_read_b64_tr_b16 v[242:243], v10 offset:5120
  ds_read_b64_tr_b16 v[244:245], v11 offset:4096
  ds_read_b64_tr_b16 v[246:247], v11 offset:5120
  s_waitcnt vmcnt(11) lgkmcnt(6)
  v_mfma_f32_32x32x16_bf16 v[64:79], v[232:235], v[132:135], v[64:79]
  buffer_load_dwordx4 v[180:183], v3, s[4:7], s30 offen offset:1024
  ds_read_b64_tr_b16 v[248:249], v10 offset:6144
  s_waitcnt lgkmcnt(5)
  v_mfma_f32_32x32x16_bf16 v[80:95], v[236:239], v[132:135], v[80:95]
  ds_read_b64_tr_b16 v[250:251], v10 offset:7168
  ds_read_b64_tr_b16 v[252:253], v11 offset:6144
  ds_read_b64_tr_b16 v[254:255], v11 offset:7168
  s_waitcnt vmcnt(11) lgkmcnt(6)
  v_mfma_f32_32x32x16_bf16 v[64:79], v[240:243], v[136:139], v[64:79]
  buffer_load_dwordx4 v[184:187], v3, s[4:7], s30 offen offset:2048
  ds_read_b64_tr_b16 v[224:225], v12 offset:0
  s_waitcnt lgkmcnt(5)
  v_mfma_f32_32x32x16_bf16 v[80:95], v[244:247], v[136:139], v[80:95]
  ds_read_b64_tr_b16 v[226:227], v12 offset:1024
  ds_read_b64_tr_b16 v[228:229], v13 offset:0
  ds_read_b64_tr_b16 v[230:231], v13 offset:1024
  s_waitcnt vmcnt(11) lgkmcnt(6)
  v_mfma_f32_32x32x16_bf16 v[64:79], v[248:251], v[140:143], v[64:79]
  buffer_load_dwordx4 v[188:191], v3, s[4:7], s30 offen offset:3072
  ds_read_b64_tr_b16 v[232:233], v12 offset:2048
  s_waitcnt lgkmcnt(5)
  v_mfma_f32_32x32x16_bf16 v[80:95], v[252:255], v[140:143], v[80:95]
  ds_read_b64_tr_b16 v[234:235], v12 offset:3072
  ds_read_b64_tr_b16 v[236:237], v13 offset:2048
  ds_read_b64_tr_b16 v[238:239], v13 offset:3072
  s_andn2_b32 s33, s36, s34
  s_cbranch_scc0 .fz_kernel_pk58c
.fz_kernel_pk58:
  s_ff1_i32_b32 s33, s33
  s_bitset1_b32 s34, s33
  s_lshl_b32 s26, s33, 13
  s_lshl_b32 s33, s33, 12
  s_add_u32 s30, s33, s35
  s_waitcnt vmcnt(11) lgkmcnt(6)
  v_mfma_f32_32x32x16_bf16 v[64:79], v[224:227], v[144:147], v[64:79]
  v_add_u32 v10, s24, v14
  v_add_u32 v11, s24, v15
  buffer_load_dwordx4 v[192:195], v3, s[4:7], s30 offen offset:0
  ds_read_b64_tr_b16 v[240:241], v12 offset:4096
  s_waitcnt lgkmcnt(5)
  v_mfma_f32_32x32x16_bf16 v[80:95], v[228:231], v[144:147], v[80:95]
  ds_read_b64_tr_b16 v[242:243], v12 offset:5120
  ds_read_b64_tr_b16 v[244:245], v13 offset:4096
  ds_read_b64_tr_b16 v[246:247], v13 offset:5120
  s_waitcnt vmcnt(11) lgkmcnt(6)
  v_mfma_f32_32x32x16_bf16 v[64:79], v[232:235], v[148:151], v[64:79]
  buffer_load_dwordx4 v[196:199], v3, s[4:7], s30 offen offset:1024
  ds_read_b64_tr_b16 v[248:249], v12 offset:6144
  s_waitcnt lgkmcnt(5)
  v_mfma_f32_32x32x16_bf16 v[80:95], v[236:239], v[148:151], v[80:95]
  ds_read_b64_tr_b16 v[250:251], v12 offset:7168
  ds_read_b64_tr_b16 v[252:253], v13 offset:6144
  ds_read_b64_tr_b16 v[254:255], v13 offset:7168
  s_waitcnt vmcnt(11) lgkmcnt(6)
  v_mfma_f32_32x32x16_bf16 v[64:79], v[240:243], v[152:155], v[64:79]
  buffer_load_dwordx4 v[200:203], v3, s[4:7], s30 offen offset:2048
  ds_read_b64_tr_b16 v[224:225], v10 offset:0
  s_waitcnt lgkmcnt(5)
  v_mfma_f32_32x32x16_bf16 v[80:95], v[244:247], v[152:155], v[80:95]
  ds_read_b64_tr_b16 v[226:227], v10 offset:1024
  ds_read_b64_tr_b16 v[228:229], v11 offset:0
  ds_read_b64_tr_b16 v[230:231], v11 offset:1024
  s_waitcnt vmcnt(11) lgkmcnt(6)
  v_mfma_f32_32x32x16_bf16 v[64:79], v[248:251], v[156:159], v[64:79]
  buffer_load_dwordx4 v[204:207], v3, s[4:7], s30 offen offset:3072
  ds_read_b64_tr_b16 v[232:233], v10 offset:2048
  s_waitcnt lgkmcnt(5)
  v_mfma_f32_32x32x16_bf16 v[80:95], v[252:255], v[156:159], v[80:95]
  ds_read_b64_tr_b16 v[234:235], v10 offset:3072
  ds_read_b64_tr_b16 v[236:237], v11 offset:2048
  ds_read_b64_tr_b16 v[238:239], v11 offset:3072
  s_andn2_b32 s33, s36, s34
  s_cbranch_scc0 .fz_kernel_pk59c
.fz_kernel_pk59:
  s_ff1_i32_b32 s33, s33
  s_bitset1_b32 s34, s33
  s_lshl_b32 s27, s33, 13
  s_lshl_b32 s33, s33, 12
  s_add_u32 s30, s33, s35
  s_waitcnt vmcnt(11) lgkmcnt(6)
  v_mfma_f32_32x32x16_bf16 v[64:79], v[224:227], v[160:163], v[64:79]
  v_add_u32 v12, s25, v14
  v_add_u32 v13, s25, v15
  buffer_load_dwordx4 v[208:211], v3, s[4:7], s30 offen offset:0
  ds_read_b64_tr_b16 v[240:241], v10 offset:4096
  s_waitcnt lgkmcnt(5)
  v_mfma_f32_32x32x16_bf16 v[80:95], v[228:231], v[160:163], v[80:95]
  ds_read_b64_tr_b16 v[242:243], v10 offset:5120
  ds_read_b64_tr_b16 v[244:245], v11 offset:4096
  ds_read_b64_tr_b16 v[246:247], v11 offset:5120
  s_waitcnt vmcnt(11) lgkmcnt(6)
  v_mfma_f32_32x32x16_bf16 v[64:79], v[232:235], v[164:167], v[64:79]
  buffer_load_dwordx4 v[212:215], v3, s[4:7], s30 offen offset:1024
  ds_read_b64_tr_b16 v[248:249], v10 offset:6144
  s_waitcnt lgkmcnt(5)
  v_mfma_f32_32x32x16_bf16 v[80:95], v[236:239], v[164:167], v[80:95]
  ds_read_b64_tr_b16 v[250:251], v10 offset:7168
  ds_read_b64_tr_b16 v[252:253], v11 offset:6144
  ds_read_b64_tr_b16 v[254:255], v11 offset:7168
  s_waitcnt vmcnt(11) lgkmcnt(6)
  v_mfma_f32_32x32x16_bf16 v[64:79], v[240:243], v[168:171], v[64:79]
  buffer_load_dwordx4 v[216:219], v3, s[4:7], s30 offen offset:2048
  ds_read_b64_tr_b16 v[224:225], v12 offset:0
  s_waitcnt lgkmcnt(5)
  v_mfma_f32_32x32x16_bf16 v[80:95], v[244:247], v[168:171], v[80:95]
  ds_read_b64_tr_b16 v[226:227], v12 offset:1024
  ds_read_b64_tr_b16 v[228:229], v13 offset:0
  ds_read_b64_tr_b16 v[230:231], v13 offset:1024
  s_waitcnt vmcnt(11) lgkmcnt(6)
  v_mfma_f32_32x32x16_bf16 v[64:79], v[248:251], v[172:175], v[64:79]
  buffer_load_dwordx4 v[220:223], v3, s[4:7], s30 offen offset:3072
  ds_read_b64_tr_b16 v[232:233], v12 offset:2048
  s_waitcnt lgkmcnt(5)
  v_mfma_f32_32x32x16_bf16 v[80:95], v[252:255], v[172:175], v[80:95]
  ds_read_b64_tr_b16 v[234:235], v12 offset:3072
  ds_read_b64_tr_b16 v[236:237], v13 offset:2048
  ds_read_b64_tr_b16 v[238:239], v13 offset:3072
  s_waitcnt vmcnt(11) lgkmcnt(6)
  v_mfma_f32_32x32x16_bf16 v[64:79], v[224:227], v[176:179], v[64:79]
  v_add_u32 v10, s26, v14
  v_add_u32 v11, s26, v15
  ds_read_b64_tr_b16 v[240:241], v12 offset:4096
  s_waitcnt lgkmcnt(5)
  v_mfma_f32_32x32x16_bf16 v[80:95], v[228:231], v[176:179], v[80:95]
  ds_read_b64_tr_b16 v[242:243], v12 offset:5120
  ds_read_b64_tr_b16 v[244:245], v13 offset:4096
  ds_read_b64_tr_b16 v[246:247], v13 offset:5120
  s_waitcnt vmcnt(10) lgkmcnt(6)
  v_mfma_f32_32x32x16_bf16 v[64:79], v[232:235], v[180:183], v[64:79]
  ds_read_b64_tr_b16 v[248:249], v12 offset:6144
  s_waitcnt lgkmcnt(5)
  v_mfma_f32_32x32x16_bf16 v[80:95], v[236:239], v[180:183], v[80:95]
  ds_read_b64_tr_b16 v[250:251], v12 offset:7168
  ds_read_b64_tr_b16 v[252:253], v13 offset:6144
  ds_read_b64_tr_b16 v[254:255], v13 offset:7168
  s_waitcnt vmcnt(9) lgkmcnt(6)
  v_mfma_f32_32x32x16_bf16 v[64:79], v[240:243], v[184:187], v[64:79]
  ds_read_b64_tr_b16 v[224:225], v10 offset:0
  s_waitcnt lgkmcnt(5)
  v_mfma_f32_32x32x16_bf16 v[80:95], v[244:247], v[184:187], v[80:95]
  ds_read_b64_tr_b16 v[226:227], v10 offset:1024
  ds_read_b64_tr_b16 v[228:229], v11 offset:0
  ds_read_b64_tr_b16 v[230:231], v11 offset:1024
  s_waitcnt vmcnt(8) lgkmcnt(6)
  v_mfma_f32_32x32x16_bf16 v[64:79], v[248:251], v[188:191], v[64:79]
  ds_read_b64_tr_b16 v[232:233], v10 offset:2048
  s_waitcnt lgkmcnt(5)
  v_mfma_f32_32x32x16_bf16 v[80:95], v[252:255], v[188:191], v[80:95]
  ds_read_b64_tr_b16 v[234:235], v10 offset:3072
  ds_read_b64_tr_b16 v[236:237], v11 offset:2048
  ds_read_b64_tr_b16 v[238:239], v11 offset:3072
  s_waitcnt vmcnt(7) lgkmcnt(6)
  v_mfma_f32_32x32x16_bf16 v[64:79], v[224:227], v[192:195], v[64:79]
  v_add_u32 v12, s27, v14
  v_add_u32 v13, s27, v15
  ds_read_b64_tr_b16 v[240:241], v10 offset:4096
  s_waitcnt lgkmcnt(5)
  v_mfma_f32_32x32x16_bf16 v[80:95], v[228:231], v[192:195], v[80:95]
  ds_read_b64_tr_b16 v[242:243], v10 offset:5120
  ds_read_b64_tr_b16 v[244:245], v11 offset:4096
  ds_read_b64_tr_b16 v[246:247], v11 offset:5120
  s_waitcnt vmcnt(6) lgkmcnt(6)
  v_mfma_f32_32x32x16_bf16 v[64:79], v[232:235], v[196:199], v[64:79]
  ds_read_b64_tr_b16 v[248:249], v10 offset:6144
  s_waitcnt lgkmcnt(5)
  v_mfma_f32_32x32x16_bf16 v[80:95], v[236:239], v[196:199], v[80:95]
  ds_read_b64_tr_b16 v[250:251], v10 offset:7168
  ds_read_b64_tr_b16 v[252:253], v11 offset:6144
  ds_read_b64_tr_b16 v[254:255], v11 offset:7168
  s_waitcnt vmcnt(5) lgkmcnt(6)
  v_mfma_f32_32x32x16_bf16 v[64:79], v[240:243], v[200:203], v[64:79]
  ds_read_b64_tr_b16 v[224:225], v12 offset:0
  s_waitcnt lgkmcnt(5)
  v_mfma_f32_32x32x16_bf16 v[80:95], v[244:247], v[200:203], v[80:95]
  ds_read_b64_tr_b16 v[226:227], v12 offset:1024
  ds_read_b64_tr_b16 v[228:229], v13 offset:0
  ds_read_b64_tr_b16 v[230:231], v13 offset:1024
  s_waitcnt vmcnt(4) lgkmcnt(6)
  v_mfma_f32_32x32x16_bf16 v[64:79], v[248:251], v[204:207], v[64:79]
  ds_read_b64_tr_b16 v[232:233], v12 offset:2048
  s_waitcnt lgkmcnt(5)
  v_mfma_f32_32x32x16_bf16 v[80:95], v[252:255], v[204:207], v[80:95]
  ds_read_b64_tr_b16 v[234:235], v12 offset:3072
  ds_read_b64_tr_b16 v[236:237], v13 offset:2048
  ds_read_b64_tr_b16 v[238:239], v13 offset:3072
  s_waitcnt vmcnt(3) lgkmcnt(6)
  v_mfma_f32_32x32x16_bf16 v[64:79], v[224:227], v[208:211], v[64:79]
  ds_read_b64_tr_b16 v[240:241], v12 offset:4096
  s_waitcnt lgkmcnt(5)
  v_mfma_f32_32x32x16_bf16 v[80:95], v[228:231], v[208:211], v[80:95]
  ds_read_b64_tr_b16 v[242:243], v12 offset:5120
  ds_read_b64_tr_b16 v[244:245], v13 offset:4096
  ds_read_b64_tr_b16 v[246:247], v13 offset:5120
  s_waitcnt vmcnt(2) lgkmcnt(6)
  v_mfma_f32_32x32x16_bf16 v[64:79], v[232:235], v[212:215], v[64:79]
  ds_read_b64_tr_b16 v[248:249], v12 offset:6144
  s_waitcnt lgkmcnt(5)
  v_mfma_f32_32x32x16_bf16 v[80:95], v[236:239], v[212:215], v[80:95]
  ds_read_b64_tr_b16 v[250:251], v12 offset:7168
  ds_read_b64_tr_b16 v[252:253], v13 offset:6144
  ds_read_b64_tr_b16 v[254:255], v13 offset:7168
  s_waitcnt vmcnt(1) lgkmcnt(6)
  v_mfma_f32_32x32x16_bf16 v[64:79], v[240:243], v[216:219], v[64:79]
  s_waitcnt lgkmcnt(4)
  v_mfma_f32_32x32x16_bf16 v[80:95], v[244:247], v[216:219], v[80:95]
  s_waitcnt vmcnt(0) lgkmcnt(0)
  v_mfma_f32_32x32x16_bf16 v[64:79], v[248:251], v[220:223], v[64:79]
  v_mfma_f32_32x32x16_bf16 v[80:95], v[252:255], v[220:223], v[80:95]
  s_mov_b32 s36, 0x3f803f80
  v_mov_b32 v8, 0
  v_mov_b32 v9, 0
  v_mov_b32 v10, 0
  v_mov_b32 v11, 0
  v_mov_b32 v12, 0
  v_mov_b32 v13, 0
  v_lshlrev_b32 v19, 2, v18
  v_lshl_add_u32 v19, v17, 13, v19
  s_lshl_b32 s34, s32, 7
  s_add_u32 s34, s34, s66
  s_add_u32 s34, s34, 16384
  s_add_u32 s37, s34, 16384
  v_cvt_pk_bf16_f32 v20, v64, v65
  v_cvt_pk_bf16_f32 v21, v66, v67
  v_cvt_pk_bf16_f32 v22, v68, v69
  v_cvt_pk_bf16_f32 v23, v70, v71
  buffer_store_dwordx4 v[20:23], v16, s[4:7], s39 offen offset:0 sc1
  v_cvt_pk_bf16_f32 v24, v72, v73
  v_cvt_pk_bf16_f32 v25, v74, v75
  v_cvt_pk_bf16_f32 v26, v76, v77
  v_cvt_pk_bf16_f32 v27, v78, v79
  buffer_store_dwordx4 v[24:27], v16, s[4:7], s39 offen offset:512 sc1
  v_cvt_pk_bf16_f32 v28, v80, v81
  v_cvt_pk_bf16_f32 v29, v82, v83
  v_cvt_pk_bf16_f32 v30, v84, v85
  v_cvt_pk_bf16_f32 v31, v86, v87
  buffer_store_dwordx4 v[28:31], v16, s[4:7], s39 offen offset:1024 sc1
  v_cvt_pk_bf16_f32 v32, v88, v89
  v_cvt_pk_bf16_f32 v33, v90, v91
  v_cvt_pk_bf16_f32 v34, v92, v93
  v_cvt_pk_bf16_f32 v35, v94, v95
  buffer_store_dwordx4 v[32:35], v16, s[4:7], s39 offen offset:1536 sc1
  v_dot2c_f32_bf16 v8, s36, v20
  v_dot2c_f32_bf16 v9, v20, v20
  v_dot2c_f32_bf16 v10, v20, v48
  v_dot2c_f32_bf16 v11, s36, v21
  v_dot2c_f32_bf16 v12, v21, v21
  v_dot2c_f32_bf16 v13, v21, v49
  v_dot2c_f32_bf16 v8, s36, v22
  v_dot2c_f32_bf16 v9, v22, v22
  v_dot2c_f32_bf16 v10, v22, v50
  v_dot2c_f32_bf16 v11, s36, v23
  v_dot2c_f32_bf16 v12, v23, v23
  v_dot2c_f32_bf16 v13, v23, v51
  v_dot2c_f32_bf16 v8, s36, v24
  v_dot2c_f32_bf16 v9, v24, v24
  v_dot2c_f32_bf16 v10, v24, v52
  v_dot2c_f32_bf16 v11, s36, v25
  v_dot2c_f32_bf16 v12, v25, v25
  v_dot2c_f32_bf16 v13, v25, v53
  v_dot2c_f32_bf16 v8, s36, v26
  v_dot2c_f32_bf16 v9, v26, v26
  v_dot2c_f32_bf16 v10, v26, v54
  v_dot2c_f32_bf16 v11, s36, v27
  v_dot2c_f32_bf16 v12, v27, v27
  v_dot2c_f32_bf16 v13, v27, v55
  v_dot2c_f32_bf16 v8, s36, v28
  v_dot2c_f32_bf16 v9, v28, v28
  v_dot2c_f32_bf16 v10, v28, v56
  v_dot2c_f32_bf16 v11, s36, v29
  v_dot2c_f32_bf16 v12, v29, v29
  v_dot2c_f32_bf16 v13, v29, v57
  v_dot2c_f32_bf16 v8, s36, v30
  v_dot2c_f32_bf16 v9, v30, v30
  v_dot2c_f32_bf16 v10, v30, v58
  v_dot2c_f32_bf16 v11, s36, v31
  v_dot2c_f32_bf16 v12, v31, v31
  v_dot2c_f32_bf16 v13, v31, v59
  v_dot2c_f32_bf16 v8, s36, v32
  v_dot2c_f32_bf16 v9, v32, v32
  v_dot2c_f32_bf16 v10, v32, v60
  v_dot2c_f32_bf16 v11, s36, v33
  v_dot2c_f32_bf16 v12, v33, v33
  v_dot2c_f32_bf16 v13, v33, v61
  v_dot2c_f32_bf16 v8, s36, v34
  v_dot2c_f32_bf16 v9, v34, v34
  v_dot2c_f32_bf16 v10, v34, v62
  v_dot2c_f32_bf16 v11, s36, v35
  v_dot2c_f32_bf16 v12, v35, v35
  v_dot2c_f32_bf16 v13, v35, v63
  s_nop 0
  v_add_f32 v36, v8, v11
  v_add_f32 v37, v9, v12
  v_add_f32 v38, v10, v13
  v_fma_f32 v38, -v36, v46, v38
  v_fmac_f32 v47, 0x44800000, v37
  v_mov_b32 v39, v38
  s_nop 0
  v_permlane32_swap_b32 v36, v47
  v_permlane32_swap_b32 v38, v39
  v_add_f32 v36, v36, v47
  v_add_f32 v38, v38, v39
  buffer_atomic_add_f32 v36, v19, s[4:7], s34 offen sc1
  s_mov_b32 exec_hi, 0
  buffer_atomic_add_f32 v38, v19, s[4:7], s37 offen sc1
  s_mov_b64 exec, -1
  s_barrier
  v_add_u32 v1, 4, v6
  s_mov_b32 s72, s66
  s_mov_b32 s73, s65
  s_mov_b32 s74, s67
  s_mov_b32 s75, s62
  s_cmp_lg_u32 s62, 0
  s_cbranch_scc1 .fz_kernel_tail
  s_mov_b32 s62, 1
  s_mov_b32 s63, 0x2000000
  s_mov_b32 s64, 0x2800000
  s_mov_b32 s65, 0x1400000
  s_mov_b32 s66, 0x1c42000
  s_mov_b32 s67, 12
  s_mov_b32 s71, 159776
  v_mov_b32 v6, 159832
  s_branch .fz_kernel_q_cons2
.fz_kernel_tail:
  s_mov_b32 s28, s56
  s_mov_b32 s29, s57
  s_mov_b32 s30, 0x400000
  s_mov_b32 s31, 0x00020000
  v_lshlrev_b32 v37, 2, v45
  v_add_u32 v37, 155644, v37
  v_mov_b32 v36, 159952
  v_lshlrev_b32 v38, 11, v18
  v_lshl_add_u32 v38, v17, 4, v38
  s_lshl_b32 s32, s32, 16
  s_lshl_b32 s33, s18, 7
  s_add_u32 s32, s32, s33
  v_lshlrev_b32 v64, 16, v20
  v_and_b32 v65, 0xffff0000, v20
  v_lshlrev_b32 v66, 16, v21
  v_and_b32 v67, 0xffff0000, v21
  v_lshlrev_b32 v68, 16, v22
  v_and_b32 v69, 0xffff0000, v22
  v_lshlrev_b32 v70, 16, v23
  v_and_b32 v71, 0xffff0000, v23
  v_lshlrev_b32 v72, 16, v24
  v_and_b32 v73, 0xffff0000, v24
  v_lshlrev_b32 v74, 16, v25
  v_and_b32 v75, 0xffff0000, v25
  v_lshlrev_b32 v76, 16, v26
  v_and_b32 v77, 0xffff0000, v26
  v_lshlrev_b32 v78, 16, v27
  v_and_b32 v79, 0xffff0000, v27
  v_lshlrev_b32 v80, 16, v28
  v_and_b32 v81, 0xffff0000, v28
  v_lshlrev_b32 v82, 16, v29
  v_and_b32 v83, 0xffff0000, v29
  v_lshlrev_b32 v84, 16, v30
  v_and_b32 v85, 0xffff0000, v30
  v_lshlrev_b32 v86, 16, v31
  v_and_b32 v87, 0xffff0000, v31
  v_lshlrev_b32 v88, 16, v32
  v_and_b32 v89, 0xffff0000, v32
  v_lshlrev_b32 v90, 16, v33
  v_and_b32 v91, 0xffff0000, v33
  v_lshlrev_b32 v92, 16, v34
  v_and_b32 v93, 0xffff0000, v34
  v_lshlrev_b32 v94, 16, v35
  v_and_b32 v95, 0xffff0000, v35
  s_mov_b64 exec, 1
  s_waitcnt vmcnt(0)
  ds_add_u32 v1, v5 offset:0x100
  s_mov_b64 exec, -1
  s_barrier
  ds_read_b32 v40, v37 offset:6400
  ds_read_b32 v42, v37 offset:6912
  ds_read_b32 v36, v36
  s_waitcnt lgkmcnt(0)
  v_cmp_ne_u32 vcc, v36, v45
  s_mov_b64 exec, vcc
  v_pk_fma_f32 v[64:65], v[64:65], v[40:41], v[42:43] op_sel_hi:[1,0,0]
  v_pk_fma_f32 v[66:67], v[66:67], v[40:41], v[42:43] op_sel_hi:[1,0,0]
  v_pk_fma_f32 v[68:69], v[68:69], v[40:41], v[42:43] op_sel_hi:[1,0,0]
  v_pk_fma_f32 v[70:71], v[70:71], v[40:41], v[42:43] op_sel_hi:[1,0,0]
  v_cvt_pk_bf16_f32 v20, v64, v65
  v_cvt_pk_bf16_f32 v21, v66, v67
  v_cvt_pk_bf16_f32 v22, v68, v69
  v_cvt_pk_bf16_f32 v23, v70, v71
  buffer_store_dwordx4 v[20:23], v38, s[28:31], s32 offen offset:0
  v_pk_fma_f32 v[72:73], v[72:73], v[40:41], v[42:43] op_sel_hi:[1,0,0]
  v_pk_fma_f32 v[74:75], v[74:75], v[40:41], v[42:43] op_sel_hi:[1,0,0]
  v_pk_fma_f32 v[76:77], v[76:77], v[40:41], v[42:43] op_sel_hi:[1,0,0]
  v_pk_fma_f32 v[78:79], v[78:79], v[40:41], v[42:43] op_sel_hi:[1,0,0]
  v_cvt_pk_bf16_f32 v24, v72, v73
  v_cvt_pk_bf16_f32 v25, v74, v75
  v_cvt_pk_bf16_f32 v26, v76, v77
  v_cvt_pk_bf16_f32 v27, v78, v79
  buffer_store_dwordx4 v[24:27], v38, s[28:31], s32 offen offset:32
  v_pk_fma_f32 v[80:81], v[80:81], v[40:41], v[42:43] op_sel_hi:[1,0,0]
  v_pk_fma_f32 v[82:83], v[82:83], v[40:41], v[42:43] op_sel_hi:[1,0,0]
  v_pk_fma_f32 v[84:85], v[84:85], v[40:41], v[42:43] op_sel_hi:[1,0,0]
  v_pk_fma_f32 v[86:87], v[86:87], v[40:41], v[42:43] op_sel_hi:[1,0,0]
  v_cvt_pk_bf16_f32 v28, v80, v81
  v_cvt_pk_bf16_f32 v29, v82, v83
  v_cvt_pk_bf16_f32 v30, v84, v85
  v_cvt_pk_bf16_f32 v31, v86, v87
  buffer_store_dwordx4 v[28:31], v38, s[28:31], s32 offen offset:64
  v_pk_fma_f32 v[88:89], v[88:89], v[40:41], v[42:43] op_sel_hi:[1,0,0]
  v_pk_fma_f32 v[90:91], v[90:91], v[40:41], v[42:43] op_sel_hi:[1,0,0]
  v_pk_fma_f32 v[92:93], v[92:93], v[40:41], v[42:43] op_sel_hi:[1,0,0]
  v_pk_fma_f32 v[94:95], v[94:95], v[40:41], v[42:43] op_sel_hi:[1,0,0]
  v_cvt_pk_bf16_f32 v32, v88, v89
  v_cvt_pk_bf16_f32 v33, v90, v91
  v_cvt_pk_bf16_f32 v34, v92, v93
  v_cvt_pk_bf16_f32 v35, v94, v95
  buffer_store_dwordx4 v[32:35], v38, s[28:31], s32 offen offset:96
  s_mov_b64 exec, -1
  s_branch .fz_kernel_fin
.fz_kernel_chain:
  s_setprio 0
  s_bitcmp1_b32 s18, 0
  s_cselect_b32 s8, s52, s50
  s_cselect_b32 s9, s53, s51
  s_mov_b32 s10, 0x700000
  s_mov_b32 s11, 0x00020000
  s_lshl_b32 s12, s16, 8
  s_and_b32 s12, s12, 511
  s_and_b32 s31, s18, 2
  s_lshl_b32 s31, s31, 8
  s_add_u32 s12, s12, s31
  s_mul_i32 s12, s12, 7168
  s_lshl_b32 s31, s17, 2
  s_lshr_b32 s33, s18, 2
  s_add_u32 s31, s31, s33
  s_lshl_b32 s31, s31, 7
  s_add_u32 s12, s12, s31
  v_lshrrev_b32 v13, 3, v2
  v_mul_u32_u24 v13, 229376, v13
  v_and_b32 v11, 7, v2
  v_lshl_add_u32 v13, v11, 4, v13
  s_mov_b32 s24, s44
  s_mov_b32 s25, s45
  s_mov_b32 s26, 0x200000
  s_mov_b32 s27, 0x00020000
  v_lshrrev_b32 v8, 3, v2
  v_and_b32 v9, 7, v2
  v_bfe_u32 v10, v2, 4, 1
  v_lshlrev_b32 v10, 2, v10
  v_xor_b32 v9, v9, v10
  v_lshlrev_b32 v9, 4, v9
  v_lshl_add_u32 v10, v8, 11, v9
  s_mov_b32 s24, s54
  s_mov_b32 s25, s55
  s_mov_b32 s26, 0x700000
  s_mov_b32 s27, 0x00020000
  s_mov_b32 s36, 0x05040100
  s_mov_b32 s37, 0x07060302
  s_and_b32 s20, s16, 1
  s_lshl1_add_u32 s13, s17, s20
  s_lshl_b32 s13, s13, 18
  s_lshl_b32 s14, s18, 7
  s_add_u32 s13, s13, s14
  s_cmp_ge_u32 s17, 14
  s_cbranch_scc1 .fz_kernel_c_nl
  s_mov_b32 s38, 0
.fz_kernel_kw60:
  s_sleep 2
  ds_read_b32 v7, v6 offset:0
  s_add_u32 s38, s38, 1
  s_waitcnt lgkmcnt(0)
  v_readfirstlane_b32 s31, v7
  s_bcnt1_i32_b32 s31, s31
  s_cmp_ge_u32 s31, 16
  s_cbranch_scc1 .fz_kernel_kw60d
  s_cmp_lt_u32 s38, 1048576
  s_cbranch_scc1 .fz_kernel_kw60
.fz_kernel_kw60d:
  buffer_load_dwordx4 v[112:115], v13, s[8:11], s12 offen nt
  s_add_u32 s12, s12, 7168
  s_waitcnt vmcnt(2)
  buffer_load_dwordx4 v[116:119], v13, s[8:11], s12 offen nt
  s_add_u32 s12, s12, 7168
  s_waitcnt vmcnt(2)
  buffer_load_dwordx4 v[120:123], v13, s[8:11], s12 offen nt
  s_add_u32 s12, s12, 7168
  s_waitcnt vmcnt(2)
  buffer_load_dwordx4 v[124:127], v13, s[8:11], s12 offen nt
  s_add_u32 s12, s12, 7168
  s_waitcnt vmcnt(2)
  buffer_load_dwordx4 v[128:131], v13, s[8:11], s12 offen nt
  s_add_u32 s12, s12, 7168
  s_waitcnt vmcnt(2)
  buffer_load_dwordx4 v[132:135], v13, s[8:11], s12 offen nt
  s_add_u32 s12, s12, 7168
  s_waitcnt vmcnt(2)
  buffer_load_dwordx4 v[136:139], v13, s[8:11], s12 offen nt
  s_add_u32 s12, s12, 7168
  s_waitcnt vmcnt(2)
  buffer_load_dwordx4 v[140:143], v13, s[8:11], s12 offen nt
  s_add_u32 s12, s12, 7168
  s_waitcnt vmcnt(2)
  buffer_load_dwordx4 v[144:147], v13, s[8:11], s12 offen nt
  s_add_u32 s12, s12, 7168
  s_waitcnt vmcnt(2)
  buffer_load_dwordx4 v[148:151], v13, s[8:11], s12 offen nt
  s_add_u32 s12, s12, 7168
  s_waitcnt vmcnt(2)
  buffer_load_dwordx4 v[152:155], v13, s[8:11], s12 offen nt
  s_add_u32 s12, s12, 7168
  s_waitcnt vmcnt(2)
  buffer_load_dwordx4 v[156:159], v13, s[8:11], s12 offen nt
  s_add_u32 s12, s12, 7168
  s_waitcnt vmcnt(2)
  buffer_load_dwordx4 v[160:163], v13, s[8:11], s12 offen nt
  s_add_u32 s12, s12, 7168
  s_waitcnt vmcnt(2)
  buffer_load_dwordx4 v[164:167], v13, s[8:11], s12 offen nt
  s_add_u32 s12, s12, 7168
  s_waitcnt vmcnt(2)
  buffer_load_dwordx4 v[168:171], v13, s[8:11], s12 offen nt
  s_add_u32 s12, s12, 7168
  s_waitcnt vmcnt(2)
  buffer_load_dwordx4 v[172:175], v13, s[8:11], s12 offen nt
  s_add_u32 s12, s12, 7168
  s_waitcnt vmcnt(2)
  buffer_load_dwordx4 v[176:179], v13, s[8:11], s12 offen nt
  s_add_u32 s12, s12, 7168
  s_waitcnt vmcnt(2)
  buffer_load_dwordx4 v[180:183], v13, s[8:11], s12 offen nt
  s_add_u32 s12, s12, 7168
  s_waitcnt vmcnt(2)
  buffer_load_dwordx4 v[184:187], v13, s[8:11], s12 offen nt
  s_add_u32 s12, s12, 7168
  s_waitcnt vmcnt(2)
  buffer_load_dwordx4 v[188:191], v13, s[8:11], s12 offen nt
  s_add_u32 s12, s12, 7168
  s_waitcnt vmcnt(2)
  buffer_load_dwordx4 v[192:195], v13, s[8:11], s12 offen nt
  s_add_u32 s12, s12, 7168
  s_waitcnt vmcnt(2)
  buffer_load_dwordx4 v[196:199], v13, s[8:11], s12 offen nt
  s_add_u32 s12, s12, 7168
  s_waitcnt vmcnt(2)
  buffer_load_dwordx4 v[200:203], v13, s[8:11], s12 offen nt
  s_add_u32 s12, s12, 7168
  s_waitcnt vmcnt(2)
  buffer_load_dwordx4 v[204:207], v13, s[8:11], s12 offen nt
  s_add_u32 s12, s12, 7168
  s_waitcnt vmcnt(2)
  buffer_load_dwordx4 v[208:211], v13, s[8:11], s12 offen nt
  s_add_u32 s12, s12, 7168
  s_waitcnt vmcnt(2)
  buffer_load_dwordx4 v[212:215], v13, s[8:11], s12 offen nt
  s_add_u32 s12, s12, 7168
  s_waitcnt vmcnt(2)
  buffer_load_dwordx4 v[216:219], v13, s[8:11], s12 offen nt
  s_add_u32 s12, s12, 7168
  s_waitcnt vmcnt(2)
  buffer_load_dwordx4 v[220:223], v13, s[8:11], s12 offen nt
  s_add_u32 s12, s12, 7168
  s_waitcnt vmcnt(2)
  buffer_load_dwordx4 v[224:227], v13, s[8:11], s12 offen nt
  s_add_u32 s12, s12, 7168
  s_waitcnt vmcnt(2)
  buffer_load_dwordx4 v[228:231], v13, s[8:11], s12 offen nt
  s_add_u32 s12, s12, 7168
  s_waitcnt vmcnt(2)
  buffer_load_dwordx4 v[232:235], v13, s[8:11], s12 offen nt
  s_add_u32 s12, s12, 7168
  s_waitcnt vmcnt(2)
  buffer_load_dwordx4 v[236:239], v13, s[8:11], s12 offen nt
  s_add_u32 s12, s12, 7168
  s_waitcnt vmcnt(2)
  buffer_load_dwordx4 v[32:35], v10, s[24:27], s13 offen nt
  s_add_u32 s13, s13, 16384
  s_waitcnt vmcnt(2)
  buffer_load_dwordx4 v[36:39], v10, s[24:27], s13 offen nt
  s_add_u32 s13, s13, 16384
  s_waitcnt vmcnt(2)
  buffer_load_dwordx4 v[40:43], v10, s[24:27], s13 offen nt
  s_add_u32 s13, s13, 16384
  s_waitcnt vmcnt(2)
  buffer_load_dwordx4 v[44:47], v10, s[24:27], s13 offen nt
  s_add_u32 s13, s13, 16384
  s_waitcnt vmcnt(2)
  buffer_load_dwordx4 v[48:51], v10, s[24:27], s13 offen nt
  s_add_u32 s13, s13, 16384
  s_waitcnt vmcnt(2)
  buffer_load_dwordx4 v[52:55], v10, s[24:27], s13 offen nt
  s_add_u32 s13, s13, 16384
  s_waitcnt vmcnt(2)
  buffer_load_dwordx4 v[56:59], v10, s[24:27], s13 offen nt
  s_add_u32 s13, s13, 16384
  s_waitcnt vmcnt(2)
  buffer_load_dwordx4 v[60:63], v10, s[24:27], s13 offen nt
  s_add_u32 s13, s13, 16384
  s_waitcnt vmcnt(2)
  buffer_load_dwordx4 v[64:67], v10, s[24:27], s13 offen nt
  s_add_u32 s13, s13, 16384
  s_waitcnt vmcnt(2)
  buffer_load_dwordx4 v[68:71], v10, s[24:27], s13 offen nt
  s_add_u32 s13, s13, 16384
  s_waitcnt vmcnt(2)
  buffer_load_dwordx4 v[72:75], v10, s[24:27], s13 offen nt
  s_add_u32 s13, s13, 16384
  s_waitcnt vmcnt(2)
  buffer_load_dwordx4 v[76:79], v10, s[24:27], s13 offen nt
  s_add_u32 s13, s13, 16384
  s_waitcnt vmcnt(2)
  buffer_load_dwordx4 v[240:243], v10, s[24:27], s13 offen nt
  s_add_u32 s13, s13, 16384
  s_waitcnt vmcnt(2)
  buffer_load_dwordx4 v[244:247], v10, s[24:27], s13 offen nt
  s_add_u32 s13, s13, 16384
  s_waitcnt vmcnt(2)
  buffer_load_dwordx4 v[248:251], v10, s[24:27], s13 offen nt
  s_add_u32 s13, s13, 16384
  s_waitcnt vmcnt(2)
  buffer_load_dwordx4 v[252:255], v10, s[24:27], s13 offen nt
  s_add_u32 s13, s13, 16384
  s_waitcnt vmcnt(2)
  v_mov_b32 v16, 0x3f803f80
  v_mov_b32 v17, 0x3f803f80
  v_mov_b32 v18, 0x3f803f80
  v_mov_b32 v19, 0x3f803f80
  s_waitcnt vmcnt(0)
  s_barrier
  v_perm_b32 v80, v116, v112, s36
  v_perm_b32 v84, v116, v112, s37
  v_perm_b32 v88, v117, v113, s36
  v_perm_b32 v92, v117, v113, s37
  v_perm_b32 v96, v118, v114, s36
  v_perm_b32 v100, v118, v114, s37
  v_perm_b32 v104, v119, v115, s36
  v_perm_b32 v108, v119, v115, s37
  v_perm_b32 v81, v124, v120, s36
  v_perm_b32 v85, v124, v120, s37
  v_perm_b32 v89, v125, v121, s36
  v_perm_b32 v93, v125, v121, s37
  v_perm_b32 v97, v126, v122, s36
  v_perm_b32 v101, v126, v122, s37
  v_perm_b32 v105, v127, v123, s36
  v_perm_b32 v109, v127, v123, s37
  v_perm_b32 v82, v132, v128, s36
  v_perm_b32 v86, v132, v128, s37
  v_perm_b32 v90, v133, v129, s36
  v_perm_b32 v94, v133, v129, s37
  v_perm_b32 v98, v134, v130, s36
  v_perm_b32 v102, v134, v130, s37
  v_perm_b32 v106, v135, v131, s36
  v_perm_b32 v110, v135, v131, s37
  v_perm_b32 v83, v140, v136, s36
  v_perm_b32 v87, v140, v136, s37
  v_perm_b32 v91, v141, v137, s36
  v_perm_b32 v95, v141, v137, s37
  v_perm_b32 v99, v142, v138, s36
  v_perm_b32 v103, v142, v138, s37
  v_perm_b32 v107, v143, v139, s36
  v_perm_b32 v111, v143, v139, s37
  v_perm_b32 v112, v148, v144, s36
  v_perm_b32 v116, v148, v144, s37
  v_perm_b32 v120, v149, v145, s36
  v_perm_b32 v124, v149, v145, s37
  v_perm_b32 v128, v150, v146, s36
  v_perm_b32 v132, v150, v146, s37
  v_perm_b32 v136, v151, v147, s36
  v_perm_b32 v140, v151, v147, s37
  v_perm_b32 v113, v156, v152, s36
  v_perm_b32 v117, v156, v152, s37
  v_perm_b32 v121, v157, v153, s36
  v_perm_b32 v125, v157, v153, s37
  v_perm_b32 v129, v158, v154, s36
  v_perm_b32 v133, v158, v154, s37
  v_perm_b32 v137, v159, v155, s36
  v_perm_b32 v141, v159, v155, s37
  v_perm_b32 v114, v164, v160, s36
  v_perm_b32 v118, v164, v160, s37
  v_perm_b32 v122, v165, v161, s36
  v_perm_b32 v126, v165, v161, s37
  v_perm_b32 v130, v166, v162, s36
  v_perm_b32 v134, v166, v162, s37
  v_perm_b32 v138, v167, v163, s36
  v_perm_b32 v142, v167, v163, s37
  v_perm_b32 v115, v172, v168, s36
  v_perm_b32 v119, v172, v168, s37
  v_perm_b32 v123, v173, v169, s36
  v_perm_b32 v127, v173, v169, s37
  v_perm_b32 v131, v174, v170, s36
  v_perm_b32 v135, v174, v170, s37
  v_perm_b32 v139, v175, v171, s36
  v_perm_b32 v143, v175, v171, s37
  v_perm_b32 v144, v180, v176, s36
  v_perm_b32 v148, v180, v176, s37
  v_perm_b32 v152, v181, v177, s36
  v_perm_b32 v156, v181, v177, s37
  v_perm_b32 v160, v182, v178, s36
  v_perm_b32 v164, v182, v178, s37
  v_perm_b32 v168, v183, v179, s36
  v_perm_b32 v172, v183, v179, s37
  v_perm_b32 v145, v188, v184, s36
  v_perm_b32 v149, v188, v184, s37
  v_perm_b32 v153, v189, v185, s36
  v_perm_b32 v157, v189, v185, s37
  v_perm_b32 v161, v190, v186, s36
  v_perm_b32 v165, v190, v186, s37
  v_perm_b32 v169, v191, v187, s36
  v_perm_b32 v173, v191, v187, s37
  v_perm_b32 v146, v196, v192, s36
  v_perm_b32 v150, v196, v192, s37
  v_perm_b32 v154, v197, v193, s36
  v_perm_b32 v158, v197, v193, s37
  v_perm_b32 v162, v198, v194, s36
  v_perm_b32 v166, v198, v194, s37
  v_perm_b32 v170, v199, v195, s36
  v_perm_b32 v174, v199, v195, s37
  v_perm_b32 v147, v204, v200, s36
  v_perm_b32 v151, v204, v200, s37
  v_perm_b32 v155, v205, v201, s36
  v_perm_b32 v159, v205, v201, s37
  v_perm_b32 v163, v206, v202, s36
  v_perm_b32 v167, v206, v202, s37
  v_perm_b32 v171, v207, v203, s36
  v_perm_b32 v175, v207, v203, s37
  v_perm_b32 v176, v212, v208, s36
  v_perm_b32 v180, v212, v208, s37
  v_perm_b32 v184, v213, v209, s36
  v_perm_b32 v188, v213, v209, s37
  v_perm_b32 v192, v214, v210, s36
  v_perm_b32 v196, v214, v210, s37
  v_perm_b32 v200, v215, v211, s36
  v_perm_b32 v204, v215, v211, s37
  v_perm_b32 v177, v220, v216, s36
  v_perm_b32 v181, v220, v216, s37
  v_perm_b32 v185, v221, v217, s36
  v_perm_b32 v189, v221, v217, s37
  v_perm_b32 v193, v222, v218, s36
  v_perm_b32 v197, v222, v218, s37
  v_perm_b32 v201, v223, v219, s36
  v_perm_b32 v205, v223, v219, s37
  v_perm_b32 v178, v228, v224, s36
  v_perm_b32 v182, v228, v224, s37
  v_perm_b32 v186, v229, v225, s36
  v_perm_b32 v190, v229, v225, s37
  v_perm_b32 v194, v230, v226, s36
  v_perm_b32 v198, v230, v226, s37
  v_perm_b32 v202, v231, v227, s36
  v_perm_b32 v206, v231, v227, s37
  v_perm_b32 v179, v236, v232, s36
  v_perm_b32 v183, v236, v232, s37
  v_perm_b32 v187, v237, v233, s36
  v_perm_b32 v191, v237, v233, s37
  v_perm_b32 v195, v238, v234, s36
  v_perm_b32 v199, v238, v234, s37
  v_perm_b32 v203, v239, v235, s36
  v_perm_b32 v207, v239, v235, s37
  v_mfma_f32_16x16x32_bf16 v[208:211], v[16:19], v[80:83], 0
  v_mfma_f32_16x16x32_bf16 v[212:215], v[16:19], v[84:87], 0
  v_mfma_f32_16x16x32_bf16 v[216:219], v[16:19], v[88:91], 0
  v_mfma_f32_16x16x32_bf16 v[220:223], v[16:19], v[92:95], 0
  v_mfma_f32_16x16x32_bf16 v[224:227], v[16:19], v[96:99], 0
  v_mfma_f32_16x16x32_bf16 v[228:231], v[16:19], v[100:103], 0
  v_mfma_f32_16x16x32_bf16 v[232:235], v[16:19], v[104:107], 0
  v_mfma_f32_16x16x32_bf16 v[236:239], v[16:19], v[108:111], 0
  v_mfma_f32_16x16x32_bf16 v[208:211], v[16:19], v[112:115], v[208:211]
  v_mfma_f32_16x16x32_bf16 v[212:215], v[16:19], v[116:119], v[212:215]
  v_mfma_f32_16x16x32_bf16 v[216:219], v[16:19], v[120:123], v[216:219]
  v_mfma_f32_16x16x32_bf16 v[220:223], v[16:19], v[124:127], v[220:223]
  v_mfma_f32_16x16x32_bf16 v[224:227], v[16:19], v[128:131], v[224:227]
  v_mfma_f32_16x16x32_bf16 v[228:231], v[16:19], v[132:135], v[228:231]
  v_mfma_f32_16x16x32_bf16 v[232:235], v[16:19], v[136:139], v[232:235]
  v_mfma_f32_16x16x32_bf16 v[236:239], v[16:19], v[140:143], v[236:239]
  v_mfma_f32_16x16x32_bf16 v[208:211], v[16:19], v[144:147], v[208:211]
  v_mfma_f32_16x16x32_bf16 v[212:215], v[16:19], v[148:151], v[212:215]
  v_mfma_f32_16x16x32_bf16 v[216:219], v[16:19], v[152:155], v[216:219]
  v_mfma_f32_16x16x32_bf16 v[220:223], v[16:19], v[156:159], v[220:223]
  v_mfma_f32_16x16x32_bf16 v[224:227], v[16:19], v[160:163], v[224:227]
  v_mfma_f32_16x16x32_bf16 v[228:231], v[16:19], v[164:167], v[228:231]
  v_mfma_f32_16x16x32_bf16 v[232:235], v[16:19], v[168:171], v[232:235]
  v_mfma_f32_16x16x32_bf16 v[236:239], v[16:19], v[172:175], v[236:239]
  v_mfma_f32_16x16x32_bf16 v[208:211], v[16:19], v[176:179], v[208:211]
  v_mfma_f32_16x16x32_bf16 v[212:215], v[16:19], v[180:183], v[212:215]
  v_mfma_f32_16x16x32_bf16 v[216:219], v[16:19], v[184:187], v[216:219]
  v_mfma_f32_16x16x32_bf16 v[220:223], v[16:19], v[188:191], v[220:223]
  v_mfma_f32_16x16x32_bf16 v[224:227], v[16:19], v[192:195], v[224:227]
  v_mfma_f32_16x16x32_bf16 v[228:231], v[16:19], v[196:199], v[228:231]
  v_mfma_f32_16x16x32_bf16 v[232:235], v[16:19], v[200:203], v[232:235]
  v_mfma_f32_16x16x32_bf16 v[236:239], v[16:19], v[204:207], v[236:239]
  s_nop 0
  v_add_f32 v28, v209, v208 row_ror:8 row_mask:0xf bank_mask:0x3
  v_add_f32 v29, v213, v212 row_ror:8 row_mask:0xf bank_mask:0x3
  v_add_f32 v30, v217, v216 row_ror:8 row_mask:0xf bank_mask:0x3
  v_add_f32 v31, v221, v220 row_ror:8 row_mask:0xf bank_mask:0x3
  v_add_f32 v28, v224, v225 row_ror:8 row_mask:0xf bank_mask:0xc
  v_add_f32 v29, v228, v229 row_ror:8 row_mask:0xf bank_mask:0xc
  v_add_f32 v30, v232, v233 row_ror:8 row_mask:0xf bank_mask:0xc
  v_add_f32 v31, v236, v237 row_ror:8 row_mask:0xf bank_mask:0xc
  v_mul_f32 v28, 0.0009765625, v28
  v_mul_f32 v29, 0.0009765625, v29
  v_mul_f32 v30, 0.0009765625, v30
  v_mul_f32 v31, 0.0009765625, v31
.fz_kernel_c_np:
  v_mov_b32 v27, v6
  s_mov_b32 s72, s66
  s_mov_b32 s73, s65
  s_mov_b32 s74, s67
  s_mov_b32 s75, s62
  s_cmp_lg_u32 s62, 0
  s_cbranch_scc1 .fz_kernel_c_n2
  s_mov_b32 s62, 1
  s_mov_b32 s63, 0x2000000
  s_mov_b32 s64, 0x2800000
  s_mov_b32 s65, 0x1400000
  s_mov_b32 s66, 0x1c42000
  s_mov_b32 s67, 12
  s_mov_b32 s71, 159776
  v_mov_b32 v6, 159832
.fz_kernel_c_n2:
  s_lshr_b32 s21, s17, 3
  s_add_u32 s70, s18, s21
  s_lshl1_add_u32 s70, s17, s70
  s_and_b32 s70, s70, 15
  s_cmp_eq_u32 s75, 0
  s_cselect_b32 s3, 32, 0
  s_cselect_b32 s70, s70, s18
  s_and_b32 s20, s16, 1
  s_mov_b32 s34, 0x00030003
  s_mov_b32 s35, 0x00030003
  s_mov_b32 s71, 0
  s_lshl1_add_u32 s26, s17, s20
  v_lshrrev_b32 v8, 4, v2
  v_bfe_u32 v12, v2, 3, 1
  v_lshl_add_u32 v12, v12, 2, v8
  v_lshlrev_b32 v10, 7, v2
  s_lshl_b32 s25, s20, 1
  v_lshrrev_b32 v14, 4, v2
  v_bfe_u32 v15, v2, 2, 2
  v_lshl_add_u32 v16, v14, 3, v15
  v_lshlrev_b32 v16, 7, v16
  v_and_b32 v14, 1, v14
  v_lshrrev_b32 v15, 1, v15
  v_lshl_add_u32 v14, v14, 1, v15
  v_xor_b32 v14, s25, v14
  v_lshl_add_u32 v16, v14, 5, v16
  v_and_b32 v14, 3, v2
  v_lshl_add_u32 v16, v14, 3, v16
  v_add_u32 v7, 65536, v16
  v_xor_b32 v9, 32, v7
  s_add_u32 s21, s74, 0x1800008
  s_sub_u32 s22, s72, 32768
  v_mov_b32 v14, s21
  v_mov_b32 v15, s22
  v_cmp_gt_u32 vcc, 16, v2
  s_nop 1
  v_cndmask_b32 v14, v15, v14, vcc
  v_lshl_add_u32 v14, v2, 11, v14
  s_lshl_b32 s25, s17, 7
  s_lshl_b32 s22, 1, s18
  v_mov_b32 v15, s22
  v_lshlrev_b32 v16, 3, v2
  s_and_b32 s21, s2, 7
  s_lshl_b32 s21, s21, 11
  s_lshl_b32 s22, s20, 10
  s_add_u32 s21, s21, s22
  s_add_u32 s21, s21, s72
  s_lshl_b32 s22, s20, 12
  s_add_u32 s22, s22, s72
  s_add_u32 s22, s22, 16384
  s_add_u32 s23, s22, 8192
  s_add_u32 s24, s22, 16384
  v_and_b32 v17, 1, v8
  v_lshlrev_b32 v17, 13, v17
  v_lshrrev_b32 v18, 1, v8
  v_mul_u32_u24 v18, 320, v18
  v_add_u32 v17, v17, v18
  v_bfe_u32 v18, v2, 3, 1
  v_lshl_add_u32 v17, v18, 9, v17
  v_bfe_u32 v18, v2, 2, 1
  v_lshl_add_u32 v17, v18, 7, v17
  v_and_b32 v18, 3, v2
  v_lshl_add_u32 v17, v18, 3, v17
  s_lshl_b32 s27, s20, 14
  s_add_u32 s27, s27, 114688
  v_add_u32 v17, s27, v17
  v_xor_b32 v18, 64, v17
  v_and_b32 v19, 15, v2
  v_lshlrev_b32 v19, 6, v19
  v_lshl_add_u32 v19, v8, 4, v19
  v_and_b32 v20, 7, v2
  v_lshlrev_b32 v20, 5, v20
  v_and_b32 v21, 8, v2
  v_lshl_add_u32 v20, v21, 1, v20
  v_and_b32 v21, 31, v2
  v_lshlrev_b32 v21, 4, v21
  v_lshrrev_b32 v22, 5, v2
  v_lshl_add_u32 v21, v22, 11, v21
  v_mov_b32 v23, 0.0009765625
  v_mov_b32 v24, 9.5367431640625e-07
  v_mov_b32 v25, 1e-05
  v_add_u32 v26, 155648, v16
  s_lshl_b32 s14, s17, 9
  s_add_u32 s14, s14, s72
  s_add_u32 s14, s14, 16384
  s_add_u32 s15, s14, 8192
  v_add_u32 v13, s27, v3
  s_barrier
.fz_kernel_c_n3:
  s_mov_b32 s13, 0xffffff
  s_cmp_eq_u32 s20, 0
  s_cbranch_scc1 .fz_kernel_c_nf
  s_cmp_eq_u32 s75, 0
  s_cselect_b32 exec_lo, 0xffff, s13
  s_mov_b32 exec_hi, 0
  s_mov_b32 s38, 0
.fz_kernel_cw61:
  s_sleep 1
  ds_read_u8 v22, v27 offset:268
  s_add_u32 s38, s38, 1
  s_waitcnt lgkmcnt(0)
  v_cmp_gt_u32 vcc, 4, v22
  s_cbranch_vccz .fz_kernel_cw61d
  s_cmp_lt_u32 s38, 8388608
  s_cbranch_scc1 .fz_kernel_cw61
.fz_kernel_cw61d:
  buffer_atomic_or v15, v14, s[4:7], s25 offen sc1
  s_mov_b64 exec, -1
.fz_kernel_c_nf:
  s_add_u32 s13, s19, s74
  s_mov_b64 exec, 1
  buffer_load_dword v11, v4, s[4:7], s13 offen offset:8 sc1
  s_mov_b64 exec, -1
  ds_write_b128 v13, v[32:35] offset:0
  ds_write_b128 v13, v[36:39] offset:1024
  ds_write_b128 v13, v[40:43] offset:2048
  ds_write_b128 v13, v[44:47] offset:3072
  ds_write_b128 v13, v[48:51] offset:4096
  ds_write_b128 v13, v[52:55] offset:5120
  ds_write_b128 v13, v[56:59] offset:6144
  ds_write_b128 v13, v[60:63] offset:7168
  ds_write_b128 v13, v[64:67] offset:8192
  ds_write_b128 v13, v[68:71] offset:9216
  ds_write_b128 v13, v[72:75] offset:10240
  ds_write_b128 v13, v[76:79] offset:11264
  ds_write_b128 v13, v[240:243] offset:12288
  ds_write_b128 v13, v[244:247] offset:13312
  ds_write_b128 v13, v[248:251] offset:14336
  ds_write_b128 v13, v[252:255] offset:15360
  v_and_b32 v14, 1, v2
  v_lshlrev_b32 v14, 10, v14
  v_lshl_add_u32 v14, v8, 14, v14
  s_waitcnt lgkmcnt(0)
  s_cmp_lg_u32 s75, 0
  s_cbranch_scc1 .fz_kernel_c_nw
  v_mov_b32 v13, v9
  s_lshl_b32 s21, s18, 10
  s_add_u32 s21, s21, s72
  s_cmp_lg_u32 s20, 0
  s_cbranch_scc1 .fz_kernel_c_c7
  s_add_u32 s22, s19, s74
  s_add_u32 s23, s14, 16384
  s_mov_b64 exec, 1
  s_mov_b32 s38, 0
  s_branch .fz_kernel_c_c00
.fz_kernel_c_c0:
  buffer_load_dword v11, v4, s[4:7], s22 offen offset:8 sc1
.fz_kernel_c_c00:
  s_add_u32 s38, s38, 1
  s_waitcnt vmcnt(0)
  ds_or_b32 v6, v11 offset:0x114
  v_or_b32 v11, v11, v15
  v_cmp_ne_u32 vcc, 0xffff, v11
  s_cbranch_vccz .fz_kernel_c_c1
  s_cmp_lt_u32 s38, 131072
  s_cbranch_scc1 .fz_kernel_c_c0
.fz_kernel_c_c1:
  s_mov_b32 s38, 0
.fz_kernel_cw62:
  s_sleep 1
  ds_read_u8 v22, v27 offset:268
  s_add_u32 s38, s38, 1
  s_waitcnt lgkmcnt(0)
  v_cmp_gt_u32 vcc, 4, v22
  s_cbranch_vccz .fz_kernel_cw62d
  s_cmp_lt_u32 s38, 8388608
  s_cbranch_scc1 .fz_kernel_cw62
.fz_kernel_cw62d:
  ds_or_b32 v6, v11 offset:0x114
  s_mov_b64 exec, -1
  buffer_load_dwordx2 v[240:241], v16, s[4:7], s14 offen
  buffer_load_dwordx2 v[242:243], v16, s[4:7], s15 offen
  buffer_load_dwordx2 v[244:245], v16, s[4:7], s23 offen
  s_lshl_b32 s23, s17, 6
  s_add_u32 s23, s23, s21
  s_lshl_b32 s24, s17, 7
  s_add_u32 s24, s24, 1
  s_mov_b32 s38, 0
.fz_kernel_cw63:
  s_sleep 1
  ds_read_u8 v22, v6 offset:272
  s_add_u32 s38, s38, 1
  s_waitcnt lgkmcnt(0)
  v_cmp_gt_u32 vcc, 2, v22
  s_cbranch_vccz .fz_kernel_cw63d
  s_cmp_lt_u32 s38, 8388608
  s_cbranch_scc1 .fz_kernel_cw63
.fz_kernel_cw63d:
  ds_read_b64_tr_b16 v[32:33], v7 offset:0
  ds_read_b64_tr_b16 v[34:35], v7 offset:512
  ds_read_b64_tr_b16 v[36:37], v13 offset:0
  ds_read_b64_tr_b16 v[38:39], v13 offset:512
  ds_read_b64_tr_b16 v[40:41], v7 offset:4096
  ds_read_b64_tr_b16 v[42:43], v7 offset:4608
  ds_read_b64_tr_b16 v[44:45], v13 offset:4096
  ds_read_b64_tr_b16 v[46:47], v13 offset:4608
  ds_read_b64_tr_b16 v[48:49], v7 offset:8192
  ds_read_b64_tr_b16 v[50:51], v7 offset:8704
  ds_read_b64_tr_b16 v[52:53], v13 offset:8192
  ds_read_b64_tr_b16 v[54:55], v13 offset:8704
  s_waitcnt lgkmcnt(0)
  ds_read_b64_tr_b16 v[56:57], v7 offset:12288
  ds_read_b64_tr_b16 v[58:59], v7 offset:12800
  ds_read_b64_tr_b16 v[60:61], v13 offset:12288
  ds_read_b64_tr_b16 v[62:63], v13 offset:12800
  ds_read_b64_tr_b16 v[64:65], v7 offset:16384
  ds_read_b64_tr_b16 v[66:67], v7 offset:16896
  ds_read_b64_tr_b16 v[68:69], v13 offset:16384
  ds_read_b64_tr_b16 v[70:71], v13 offset:16896
  ds_read_b64_tr_b16 v[72:73], v7 offset:20480
  ds_read_b64_tr_b16 v[74:75], v7 offset:20992
  ds_read_b64_tr_b16 v[76:77], v13 offset:20480
  ds_read_b64_tr_b16 v[78:79], v13 offset:20992
  s_waitcnt lgkmcnt(0)
  s_waitcnt vmcnt(0)
  v_fma_f32 v208, -v240, v240, v242
  v_fma_f32 v209, -v241, v241, v243
  v_rsq_f32 v208, abs(v208)
  v_rsq_f32 v209, abs(v209)
  v_mul_f32 v208, v208, v244
  v_mul_f32 v209, v209, v245
  v_and_b32 v208, -2, v208
  v_or_b32 v209, 1, v209
  v_cmp_gt_f32 vcc, v209, v208
  v_max_f32 v9, v208, v209
  s_nop 0
  v_cndmask_b32 v210, v240, v241, vcc
  v_max_f32 v7, v9, v9 row_ror:8 row_mask:0xf bank_mask:0xf
  v_cndmask_b32 v211, v242, v243, vcc
  s_nop 0
  v_max_f32 v7, v7, v7 row_ror:4 row_mask:0xf bank_mask:0xf
  s_nop 1
  v_max_f32 v7, v7, v7 row_ror:2 row_mask:0xf bank_mask:0xf
  s_nop 1
  v_max_f32 v7, v7, v7 row_ror:1 row_mask:0xf bank_mask:0xf
  s_nop 1
  v_max_f32 v7, v7, v7 row_bcast:15 row_mask:0xa bank_mask:0xf
  s_nop 1
  v_max_f32 v7, v7, v7 row_bcast:31 row_mask:0xc bank_mask:0xf
  v_and_b32 v209, 1, v9
  v_lshl_add_u32 v209, v2, 1, v209
  v_readlane_b32 s22, v7, 63
  v_add_u32 v209, s24, v209
  v_mov_b32 v208, v9
  v_cmp_eq_u32 vcc, s22, v9
  s_ff1_i32_b64 s22, vcc
  s_lshl_b64 exec, 1, s22
  buffer_store_dwordx4 v[208:211], v4, s[4:7], s23 offen sc1
  s_mov_b64 exec, -1
.fz_kernel_c_c2:
  s_cmp_lg_u32 s20, 0
  s_cbranch_scc1 .fz_kernel_c_c21
  s_call_b64 s[68:69], .fz_kernel_c_coef
  ds_write_b64 v26, v[248:249] offset:4608
  ds_write_b64 v26, v[250:251] offset:5120
  ds_write_b64 v26, v[252:253] offset:6400
  ds_write_b64 v26, v[254:255] offset:6912
.fz_kernel_c_c21:
  s_cmp_eq_u32 s3, 0
  s_cbranch_scc1 .fz_kernel_hb65
  s_barrier
  s_sub_u32 s3, s3, 1
.fz_kernel_hb65:
  s_cmp_eq_u32 s3, 0
  s_cbranch_scc1 .fz_kernel_hb66
  s_barrier
  s_sub_u32 s3, s3, 1
.fz_kernel_hb66:
  s_cmp_eq_u32 s3, 0
  s_cbranch_scc1 .fz_kernel_hb67
  s_barrier
  s_sub_u32 s3, s3, 1
.fz_kernel_hb67:
.fz_kernel_c_c3:
  v_lshlrev_b32 v22, 6, v2
  s_mov_b64 exec, 0xffff
  s_mov_b32 s38, 0
.fz_kernel_c_c4:
  buffer_load_dwordx4 v[224:227], v22, s[4:7], s21 offen sc1
  s_add_u32 s38, s38, 1
  s_mov_b32 s46, 0
  s_call_b64 s[0:1], .fz_kernel_hw
  s_waitcnt vmcnt(0)
  v_min_u32 v9, v225, v227
  v_max_f32 v7, v224, v224 row_ror:8 row_mask:0xf bank_mask:0xf
  v_cmp_eq_u32 vcc, 0, v9
  s_cbranch_vccz .fz_kernel_c_c5
  s_cmp_lt_u32 s38, 131072
  s_cbranch_scc1 .fz_kernel_c_c4
.fz_kernel_c_c5:
  s_waitcnt lgkmcnt(0)
  v_max_f32 v7, v7, v7 row_ror:4 row_mask:0xf bank_mask:0xf
  s_nop 1
  v_max_f32 v7, v7, v7 row_ror:2 row_mask:0xf bank_mask:0xf
  s_nop 1
  v_max_f32 v7, v7, v7 row_ror:1 row_mask:0xf bank_mask:0xf
  v_cmp_eq_u32 vcc, v7, v224
  s_or_b32 s22, vcc_lo, 0x8000
  s_ff1_i32_b32 s22, s22
  v_readlane_b32 s77, v225, s22
  v_readlane_b32 s27, v224, s22
  v_readlane_b32 s23, v226, s22
  v_readlane_b32 s24, v227, s22
  s_mov_b64 exec, -1
  v_mov_b32 v11, s23
  v_mov_b32 v15, s24
  s_branch .fz_kernel_c_idx
.fz_kernel_c_nw:
  s_mov_b64 exec, 0xff
  s_mov_b32 s38, 0
.fz_kernel_c_gm:
  buffer_load_dword v9, v10, s[4:7], s21 offen sc1
  s_add_u32 s38, s38, 1
  s_mov_b32 s46, 0
  s_call_b64 s[0:1], .fz_kernel_hw
  s_waitcnt vmcnt(0)
  v_cmp_ne_u32 vcc, 0xffff, v9
  s_cbranch_vccz .fz_kernel_c_gmd
  s_cmp_eq_u32 s3, 0
  s_cbranch_scc1 .fz_kernel_hb68
  s_barrier
  s_sub_u32 s3, s3, 1
.fz_kernel_hb68:
  s_cmp_lt_u32 s38, 131072
  s_cbranch_scc1 .fz_kernel_c_gm
.fz_kernel_c_gmd:
  s_mov_b64 exec, -1
  buffer_load_dwordx4 v[208:211], v3, s[4:7], s22 offen offset:0
  buffer_load_dwordx4 v[212:215], v3, s[4:7], s23 offen offset:0
  buffer_load_dwordx4 v[216:219], v3, s[4:7], s24 offen offset:0
  buffer_load_dwordx4 v[220:223], v3, s[4:7], s22 offen offset:1024
  buffer_load_dwordx4 v[224:227], v3, s[4:7], s23 offen offset:1024
  buffer_load_dwordx4 v[228:231], v3, s[4:7], s24 offen offset:1024
  buffer_load_dwordx4 v[232:235], v3, s[4:7], s22 offen offset:2048
  buffer_load_dwordx4 v[236:239], v3, s[4:7], s23 offen offset:2048
  buffer_load_dwordx4 v[240:243], v3, s[4:7], s24 offen offset:2048
  buffer_load_dwordx4 v[244:247], v3, s[4:7], s22 offen offset:3072
  buffer_load_dwordx4 v[248:251], v3, s[4:7], s23 offen offset:3072
  buffer_load_dwordx4 v[252:255], v3, s[4:7], s24 offen offset:3072
  s_lshl_b32 s21, s75, 4
  s_add_u32 s21, s21, 159968
  v_mov_b32 v10, s21
  s_lshl_b32 s22, s20, 3
  v_add_u32 v13, s22, v10
  s_mov_b32 s46, 6
  s_call_b64 s[0:1], .fz_kernel_hw
  s_waitcnt vmcnt(6)
  s_waitcnt vmcnt(10)
  v_fma_f32 v212, -v208, v208, v212
  v_fma_f32 v213, -v209, v209, v213
  v_fma_f32 v214, -v210, v210, v214
  v_fma_f32 v215, -v211, v211, v215
  s_cmp_eq_u32 s3, 0
  s_cbranch_scc1 .fz_kernel_hb76
  s_barrier
  s_sub_u32 s3, s3, 1
.fz_kernel_hb76:
  v_rsq_f32 v212, abs(v212)
  v_rsq_f32 v213, abs(v213)
  v_rsq_f32 v214, abs(v214)
  v_rsq_f32 v215, abs(v215)
  s_waitcnt vmcnt(9)
  v_mul_f32 v216, v216, v212
  v_mul_f32 v217, v217, v213
  v_mul_f32 v218, v218, v214
  v_mul_f32 v219, v219, v215
  v_and_or_b32 v216, v216, -16, 0
  v_and_or_b32 v217, v217, -16, 1
  v_and_or_b32 v218, v218, -16, 2
  v_and_or_b32 v219, v219, -16, 3
  v_max3_f32 v9, v216, v217, v218
  v_max_f32 v9, v9, v219
  s_waitcnt vmcnt(7)
  v_fma_f32 v224, -v220, v220, v224
  v_fma_f32 v225, -v221, v221, v225
  v_fma_f32 v226, -v222, v222, v226
  v_fma_f32 v227, -v223, v223, v227
  v_rsq_f32 v224, abs(v224)
  v_rsq_f32 v225, abs(v225)
  v_rsq_f32 v226, abs(v226)
  v_rsq_f32 v227, abs(v227)
  s_waitcnt vmcnt(6)
  v_mul_f32 v228, v228, v224
  v_mul_f32 v229, v229, v225
  v_mul_f32 v230, v230, v226
  v_mul_f32 v231, v231, v227
  s_cmp_eq_u32 s3, 0
  s_cbranch_scc1 .fz_kernel_hb77
  s_barrier
  s_sub_u32 s3, s3, 1
.fz_kernel_hb77:
  v_and_or_b32 v228, v228, -16, 4
  v_and_or_b32 v229, v229, -16, 5
  v_and_or_b32 v230, v230, -16, 6
  v_and_or_b32 v231, v231, -16, 7
  v_max3_f32 v9, v9, v228, v229
  v_max3_f32 v9, v9, v230, v231
  s_waitcnt vmcnt(4)
  v_fma_f32 v236, -v232, v232, v236
  v_fma_f32 v237, -v233, v233, v237
  v_fma_f32 v238, -v234, v234, v238
  v_fma_f32 v239, -v235, v235, v239
  v_rsq_f32 v236, abs(v236)
  v_rsq_f32 v237, abs(v237)
  v_rsq_f32 v238, abs(v238)
  v_rsq_f32 v239, abs(v239)
  s_waitcnt vmcnt(3)
  v_mul_f32 v240, v240, v236
  v_mul_f32 v241, v241, v237
  v_mul_f32 v242, v242, v238
  v_mul_f32 v243, v243, v239
  v_and_or_b32 v240, v240, -16, 8
  v_and_or_b32 v241, v241, -16, 9
  v_and_or_b32 v242, v242, -16, 10
  v_and_or_b32 v243, v243, -16, 11
  v_max3_f32 v9, v9, v240, v241
  v_max3_f32 v9, v9, v242, v243
  s_waitcnt vmcnt(1)
  v_fma_f32 v248, -v244, v244, v248
  v_fma_f32 v249, -v245, v245, v249
  v_fma_f32 v250, -v246, v246, v250
  v_fma_f32 v251, -v247, v247, v251
  v_rsq_f32 v248, abs(v248)
  s_cmp_eq_u32 s3, 0
  s_cbranch_scc1 .fz_kernel_hb78
  s_barrier
  s_sub_u32 s3, s3, 1
.fz_kernel_hb78:
  v_rsq_f32 v249, abs(v249)
  v_rsq_f32 v250, abs(v250)
  v_rsq_f32 v251, abs(v251)
  s_waitcnt vmcnt(0)
  v_mul_f32 v252, v252, v248
  v_mul_f32 v253, v253, v249
  v_mul_f32 v254, v254, v250
  v_mul_f32 v255, v255, v251
  v_and_or_b32 v252, v252, -16, 12
  v_and_or_b32 v253, v253, -16, 13
  v_and_or_b32 v254, v254, -16, 14
  v_and_or_b32 v255, v255, -16, 15
  v_max3_f32 v9, v9, v252, v253
  v_max3_f32 v9, v9, v254, v255
  s_nop 1
  v_max_f32 v7, v9, v9 row_ror:8 row_mask:0xf bank_mask:0xf
  s_nop 1
  v_max_f32 v7, v7, v7 row_ror:4 row_mask:0xf bank_mask:0xf
  s_nop 1
  v_max_f32 v7, v7, v7 row_ror:2 row_mask:0xf bank_mask:0xf
  s_nop 1
  v_max_f32 v7, v7, v7 row_ror:1 row_mask:0xf bank_mask:0xf
  s_nop 1
  v_max_f32 v7, v7, v7 row_bcast:15 row_mask:0xa bank_mask:0xf
  s_nop 1
  v_max_f32 v7, v7, v7 row_bcast:31 row_mask:0xc bank_mask:0xf
  s_nop 0
  v_readlane_b32 s21, v7, 63
  s_nop 1
  v_cmp_eq_u32 vcc, s21, v9
  s_ff1_i32_b64 s22, vcc
  s_lshl_b32 s22, s22, 2
  s_and_b32 s23, s21, 3
  s_add_u32 s22, s22, s23
  s_and_b32 s23, s21, 12
  s_lshl_b32 s23, s23, 6
  s_add_u32 s22, s22, s23
  s_and_b32 s22, s22, 1023
  s_lshl_b32 s23, s20, 10
  s_add_u32 s22, s22, s23
  s_add_u32 s22, s22, 1
  v_mov_b32 v224, s21
  v_mov_b32 v225, s22
  s_mov_b64 exec, 1
  ds_write_b64 v13, v[224:225]
  s_mov_b32 s38, 0
.fz_kernel_c_am:
  s_cmp_eq_u32 s3, 0
  s_cbranch_scc1 .fz_kernel_hb79
  s_barrier
  s_sub_u32 s3, s3, 1
.fz_kernel_hb79:
  ds_read_b128 v[224:227], v10
  s_add_u32 s38, s38, 1
  s_waitcnt lgkmcnt(0)
  v_min_u32 v9, v225, v227
  v_cmp_eq_u32 vcc, 0, v9
  s_cbranch_vccz .fz_kernel_c_amd
  s_cmp_eq_u32 s3, 0
  s_cbranch_scc1 .fz_kernel_hb69
  s_barrier
  s_sub_u32 s3, s3, 1
.fz_kernel_hb69:
  s_cmp_lt_u32 s38, 524288
  s_cbranch_scc1 .fz_kernel_c_am
.fz_kernel_c_amd:
  v_cmp_gt_f32 vcc, v226, v224
  s_nop 1
  v_cndmask_b32 v225, v225, v227, vcc
  v_cndmask_b32 v224, v224, v226, vcc
  v_readfirstlane_b32 s77, v225
  v_readfirstlane_b32 s27, v224
  s_mov_b64 exec, -1
  s_sub_u32 s21, s77, 1
  s_and_b32 s21, s21, 2047
  s_lshl_b32 s21, s21, 2
  s_add_u32 s21, s21, s72
  s_add_u32 s21, s21, 16384
  s_add_u32 s22, s21, 8192
  buffer_load_dword v11, v4, s[4:7], s21 offen
  buffer_load_dword v15, v4, s[4:7], s22 offen
.fz_kernel_c_idx:
  s_mov_b64 exec, s[34:35]
  s_sub_u32 s77, s77, 1
  s_and_b32 s77, s77, 2047
  s_lshr_b32 s78, s77, 7
  s_lshl_b32 s78, s78, 18
  s_and_b32 s21, s77, 0x70
  s_lshl_b32 s21, s21, 7
  s_add_u32 s78, s78, s21
  s_and_b32 s21, s77, 15
  s_lshl_b32 s21, s21, 4
  s_add_u32 s78, s78, s21
  s_add_u32 s78, s78, s73
  s_and_b32 s25, s18, 2
  s_add_u32 s25, s25, s20
  s_lshl_b32 s21, s25, 16
  s_add_u32 s21, s21, s78
  buffer_load_dwordx4 v[208:211], v14, s[4:7], s21 offen offset:0
  buffer_load_dwordx4 v[212:215], v14, s[4:7], s21 offen offset:256
  buffer_load_dwordx4 v[216:219], v14, s[4:7], s21 offen offset:512
  buffer_load_dwordx4 v[220:223], v14, s[4:7], s21 offen offset:768
  s_mov_b64 exec, -1
  s_lshr_b32 s21, s77, 7
  s_and_b32 s79, s77, 127
  s_add_u32 s79, s79, 1
  s_cmp_eq_u32 s21, s17
  s_cselect_b32 s79, s79, 0
  s_and_b32 s21, s18, 1
  s_lshl_b32 s21, s21, 2
  s_add_u32 s21, s21, s25
  s_lshl_b32 s21, s21, 9
  s_lshl_b32 s22, s17, 13
  s_add_u32 s21, s21, s22
  s_and_b32 s22, s18, 8
  s_lshl_b32 s22, s22, 9
  s_add_u32 s21, s21, s22
  s_and_b32 s22, s18, 4
  s_lshl_b32 s22, s22, 6
  s_add_u32 s21, s21, s22
  s_add_u32 s21, s21, s72
  s_add_u32 s21, s21, 40960
  s_cmp_eq_u32 s3, 0
  s_cbranch_scc1 .fz_kernel_hb80
  s_barrier
  s_sub_u32 s3, s3, 1
.fz_kernel_hb80:
  v_mov_b32 v1, -1477.3197218702985
  v_mul_f32 v1, s27, v1
  v_exp_f32 v1, v1
  s_nop 0
  v_add_f32 v1, 1.0, v1
  v_rcp_f32 v1, v1
  v_and_b32 v14, 8, v2
  v_lshlrev_b32 v14, 7, v14
  v_lshl_add_u32 v14, v8, 8, v14
  s_lshl_b32 s23, s70, 14
  s_add_u32 s23, s23, s78
  s_mov_b32 s46, 0
  s_call_b64 s[0:1], .fz_kernel_hw
  s_waitcnt vmcnt(0)
  s_cmp_ge_u32 s17, 14
  s_cbranch_scc1 .fz_kernel_c_ng
  s_setprio 2
  v_mfma_f32_16x16x32_bf16 v[224:227], v[208:211], v[80:83], 0
  v_mfma_f32_16x16x32_bf16 v[228:231], v[208:211], v[84:87], 0
  v_mfma_f32_16x16x32_bf16 v[232:235], v[208:211], v[88:91], 0
  v_mfma_f32_16x16x32_bf16 v[236:239], v[208:211], v[92:95], 0
  v_mfma_f32_16x16x32_bf16 v[240:243], v[208:211], v[96:99], 0
  v_mfma_f32_16x16x32_bf16 v[244:247], v[208:211], v[100:103], 0
  v_mfma_f32_16x16x32_bf16 v[248:251], v[208:211], v[104:107], 0
  v_mfma_f32_16x16x32_bf16 v[252:255], v[208:211], v[108:111], 0
  v_mfma_f32_16x16x32_bf16 v[224:227], v[212:215], v[112:115], v[224:227]
  v_mfma_f32_16x16x32_bf16 v[228:231], v[212:215], v[116:119], v[228:231]
  v_mfma_f32_16x16x32_bf16 v[232:235], v[212:215], v[120:123], v[232:235]
  v_mfma_f32_16x16x32_bf16 v[236:239], v[212:215], v[124:127], v[236:239]
  v_mfma_f32_16x16x32_bf16 v[240:243], v[212:215], v[128:131], v[240:243]
  v_mfma_f32_16x16x32_bf16 v[244:247], v[212:215], v[132:135], v[244:247]
  v_mfma_f32_16x16x32_bf16 v[248:251], v[212:215], v[136:139], v[248:251]
  v_mfma_f32_16x16x32_bf16 v[252:255], v[212:215], v[140:143], v[252:255]
  v_mfma_f32_16x16x32_bf16 v[224:227], v[216:219], v[144:147], v[224:227]
  v_mfma_f32_16x16x32_bf16 v[228:231], v[216:219], v[148:151], v[228:231]
  v_mfma_f32_16x16x32_bf16 v[232:235], v[216:219], v[152:155], v[232:235]
  v_mfma_f32_16x16x32_bf16 v[236:239], v[216:219], v[156:159], v[236:239]
  v_mfma_f32_16x16x32_bf16 v[240:243], v[216:219], v[160:163], v[240:243]
  v_mfma_f32_16x16x32_bf16 v[244:247], v[216:219], v[164:167], v[244:247]
  v_mfma_f32_16x16x32_bf16 v[248:251], v[216:219], v[168:171], v[248:251]
  v_mfma_f32_16x16x32_bf16 v[252:255], v[216:219], v[172:175], v[252:255]
  v_mfma_f32_16x16x32_bf16 v[224:227], v[220:223], v[176:179], v[224:227]
  v_mfma_f32_16x16x32_bf16 v[228:231], v[220:223], v[180:183], v[228:231]
  v_mfma_f32_16x16x32_bf16 v[232:235], v[220:223], v[184:187], v[232:235]
  v_mfma_f32_16x16x32_bf16 v[236:239], v[220:223], v[188:191], v[236:239]
  v_mfma_f32_16x16x32_bf16 v[240:243], v[220:223], v[192:195], v[240:243]
  v_mfma_f32_16x16x32_bf16 v[244:247], v[220:223], v[196:199], v[244:247]
  v_mfma_f32_16x16x32_bf16 v[248:251], v[220:223], v[200:203], v[248:251]
  v_mfma_f32_16x16x32_bf16 v[252:255], v[220:223], v[204:207], v[252:255]
  s_nop 0
  v_add_f32 v208, v225, v224 row_ror:8 row_mask:0xf bank_mask:0x3
  v_add_f32 v209, v229, v228 row_ror:8 row_mask:0xf bank_mask:0x3
  v_add_f32 v210, v233, v232 row_ror:8 row_mask:0xf bank_mask:0x3
  v_add_f32 v211, v237, v236 row_ror:8 row_mask:0xf bank_mask:0x3
  v_add_f32 v208, v240, v241 row_ror:8 row_mask:0xf bank_mask:0xc
  v_add_f32 v209, v244, v245 row_ror:8 row_mask:0xf bank_mask:0xc
  v_add_f32 v210, v248, v249 row_ror:8 row_mask:0xf bank_mask:0xc
  v_add_f32 v211, v252, v253 row_ror:8 row_mask:0xf bank_mask:0xc
  v_fma_f32 v208, -v11, v28, v208
  v_fma_f32 v209, -v11, v29, v209
  v_or_b32 v208, 1, v208
  v_fma_f32 v210, -v11, v30, v210
  v_fma_f32 v211, -v11, v31, v211
  v_or_b32 v210, 1, v210
  s_mov_b64 exec, 0xffff
  buffer_store_dwordx4 v[208:211], v20, s[4:7], s21 offen offset:0 sc1
  s_mov_b64 exec, -1
  s_setprio 0
  s_cmp_eq_u32 s3, 0
  s_cbranch_scc1 .fz_kernel_hb70
  s_barrier
  s_sub_u32 s3, s3, 1
.fz_kernel_hb70:
.fz_kernel_c_ng:
  s_cmp_eq_u32 s20, 0
  s_cbranch_scc1 .fz_kernel_c_ng1
  buffer_load_dwordx4 v[200:203], v14, s[4:7], s23 offen
  s_branch .fz_kernel_c_ng2
.fz_kernel_c_ng1:
  s_cmp_eq_u32 s75, 0
  s_cbranch_scc1 .fz_kernel_c_ng2
  buffer_load_dwordx2 v[240:241], v16, s[4:7], s14 offen
  buffer_load_dwordx2 v[242:243], v16, s[4:7], s15 offen
.fz_kernel_c_ng2:
  s_cmp_ge_u32 s17, 14
  s_cbranch_scc1 .fz_kernel_c_g1
  ds_read_b64_tr_b16 v[80:81], v17 offset:0
  ds_read_b64_tr_b16 v[82:83], v17 offset:1024
  ds_read_b64_tr_b16 v[84:85], v17 offset:32
  ds_read_b64_tr_b16 v[86:87], v17 offset:1056
  ds_read_b64_tr_b16 v[88:89], v18 offset:0
  ds_read_b64_tr_b16 v[90:91], v18 offset:1024
  ds_read_b64_tr_b16 v[92:93], v18 offset:32
  ds_read_b64_tr_b16 v[94:95], v18 offset:1056
  ds_read_b64_tr_b16 v[96:97], v17 offset:2048
  ds_read_b64_tr_b16 v[98:99], v17 offset:3072
  ds_read_b64_tr_b16 v[100:101], v17 offset:2080
  ds_read_b64_tr_b16 v[102:103], v17 offset:3104
  ds_read_b64_tr_b16 v[104:105], v18 offset:2048
  s_cmp_eq_u32 s3, 0
  s_cbranch_scc1 .fz_kernel_hb81
  s_barrier
  s_sub_u32 s3, s3, 1
.fz_kernel_hb81:
  ds_read_b64_tr_b16 v[106:107], v18 offset:3072
  ds_read_b64_tr_b16 v[108:109], v18 offset:2080
  ds_read_b64_tr_b16 v[110:111], v18 offset:3104
  s_waitcnt lgkmcnt(4)
  ds_read_b64_tr_b16 v[112:113], v17 offset:4096
  ds_read_b64_tr_b16 v[114:115], v17 offset:5120
  ds_read_b64_tr_b16 v[116:117], v17 offset:4128
  ds_read_b64_tr_b16 v[118:119], v17 offset:5152
  ds_read_b64_tr_b16 v[120:121], v18 offset:4096
  ds_read_b64_tr_b16 v[122:123], v18 offset:5120
  ds_read_b64_tr_b16 v[124:125], v18 offset:4128
  ds_read_b64_tr_b16 v[126:127], v18 offset:5152
  ds_read_b64_tr_b16 v[128:129], v17 offset:6144
  ds_read_b64_tr_b16 v[130:131], v17 offset:7168
  ds_read_b64_tr_b16 v[132:133], v17 offset:6176
  ds_read_b64_tr_b16 v[134:135], v17 offset:7200
  ds_read_b64_tr_b16 v[136:137], v18 offset:6144
  ds_read_b64_tr_b16 v[138:139], v18 offset:7168
  s_cmp_eq_u32 s3, 0
  s_cbranch_scc1 .fz_kernel_hb82
  s_barrier
  s_sub_u32 s3, s3, 1
.fz_kernel_hb82:
  ds_read_b64_tr_b16 v[140:141], v18 offset:6176
  ds_read_b64_tr_b16 v[142:143], v18 offset:7200
.fz_kernel_c_g1:
  v_fma_f32 v15, -v11, v11, v15
  v_rsq_f32 v15, abs(v15)
  s_nop 0
  v_mul_f32 v179, v11, v15
  v_mul_f32 v15, 0x44800000, v15
  v_sub_f32 v179, 0, v179
  v_add_f32 v178, 1.0, v15
  v_mul_f32 v177, -1.4426950408889634, v15
  v_mul_f32 v15, v15, v15
  v_mul_f32 v1, v1, v15
  s_cmp_eq_u32 s75, 0
  s_cbranch_scc1 .fz_kernel_c_d0
  s_cmp_lg_u32 s20, 0
  s_cbranch_scc1 .fz_kernel_c_t2
  s_waitcnt vmcnt(0)
  s_call_b64 s[68:69], .fz_kernel_c_coef
  v_mov_b32 v9, 159952
  v_mov_b32 v7, s79
  ds_write_b64 v26, v[252:253] offset:6400
  ds_write_b64 v26, v[254:255] offset:6912
  ds_write_b32 v9, v7
  s_waitcnt lgkmcnt(0)
.fz_kernel_c_t2:
  s_barrier
.fz_kernel_c_d0:
  s_cmp_ge_u32 s17, 14
  s_cbranch_scc1 .fz_kernel_c_nd
  s_lshl_b32 s21, s26, 12
  s_add_u32 s21, s21, s72
  s_add_u32 s21, s21, 40960
  s_mul_i32 s27, s18, 28
  s_add_u32 s27, s27, s26
  s_lshl_b32 s27, s27, 8
  s_add_u32 s27, s27, s72
  s_add_u32 s27, s27, 155648
  s_cmp_eq_u32 s3, 0
  s_cbranch_scc1 .fz_kernel_hb72
  s_barrier
  s_sub_u32 s3, s3, 1
.fz_kernel_hb72:
  buffer_load_dwordx4 v[144:147], v21, s[4:7], s21 offen offset:0 sc1
  buffer_load_dwordx4 v[148:151], v21, s[4:7], s21 offen offset:512 sc1
  buffer_load_dwordx4 v[152:155], v21, s[4:7], s21 offen offset:1024 sc1
  buffer_load_dwordx4 v[156:159], v21, s[4:7], s21 offen offset:1536 sc1
  s_mov_b32 s38, 0
.fz_kernel_c_gu:
  s_mov_b32 s46, 0
  s_call_b64 s[0:1], .fz_kernel_hw
  s_waitcnt vmcnt(0)
  v_min3_u32 v9, v144, v146, v148
  v_min3_u32 v9, v9, v150, v152
  v_min3_u32 v9, v9, v154, v156
  v_min_u32 v9, v9, v158
  v_cmp_eq_u32 vcc, 0, v9
  v_add_f32 v160, v144, v148
  v_add_f32 v161, v145, v149
  v_add_f32 v162, v146, v150
  v_add_f32 v163, v147, v151
  s_cbranch_vccnz .fz_kernel_c_gur
.fz_kernel_c_gud:
  v_add_f32 v152, v152, v156
  v_add_f32 v153, v153, v157
  v_add_f32 v154, v154, v158
  v_add_f32 v155, v155, v159
  v_add_f32 v144, v152, v160
  v_add_f32 v145, v153, v161
  v_add_f32 v146, v154, v162
  v_add_f32 v147, v155, v163
  s_nop 0
  v_permlane32_swap_b32 v144, v146
  v_permlane32_swap_b32 v145, v147
  v_mul_f32 v148, v144, v177
  v_mul_f32 v149, v145, v177
  v_exp_f32 v148, v148
  s_cmp_eq_u32 s3, 0
  s_cbranch_scc1 .fz_kernel_hb83
  s_barrier
  s_sub_u32 s3, s3, 1
.fz_kernel_hb83:
  v_exp_f32 v149, v149
  v_mul_f32 v144, v144, v146
  v_add_f32 v148, 1.0, v148
  v_add_f32 v149, 1.0, v149
  v_rcp_f32 v148, v148
  v_rcp_f32 v149, v149
  v_mul_f32 v145, v145, v147
  v_mul_f32 v144, v144, v148
  v_mul_f32 v145, v145, v149
  v_cvt_pk_bf16_f32 v144, v144, v145
  s_waitcnt lgkmcnt(0)
  s_setprio 2
  v_mov_b32 v160, v144 row_newbcast:0 row_mask:0xf bank_mask:0xf
  v_mov_b32 v161, v144 row_newbcast:1 row_mask:0xf bank_mask:0xf
  v_mov_b32 v162, v144 row_newbcast:2 row_mask:0xf bank_mask:0xf
  v_mov_b32 v163, v144 row_newbcast:3 row_mask:0xf bank_mask:0xf
  v_mov_b32 v164, v144 row_newbcast:4 row_mask:0xf bank_mask:0xf
  v_mov_b32 v165, v144 row_newbcast:5 row_mask:0xf bank_mask:0xf
  v_mov_b32 v166, v144 row_newbcast:6 row_mask:0xf bank_mask:0xf
  v_mov_b32 v167, v144 row_newbcast:7 row_mask:0xf bank_mask:0xf
  v_mfma_f32_16x16x32_bf16 v[208:211], v[80:83], v[160:163], 0
  v_mfma_f32_16x16x32_bf16 v[212:215], v[84:87], v[160:163], 0
  v_mfma_f32_16x16x32_bf16 v[216:219], v[88:91], v[160:163], 0
  v_mfma_f32_16x16x32_bf16 v[220:223], v[92:95], v[160:163], 0
  v_mov_b32 v168, v144 row_newbcast:8 row_mask:0xf bank_mask:0xf
  v_mov_b32 v169, v144 row_newbcast:9 row_mask:0xf bank_mask:0xf
  v_mov_b32 v170, v144 row_newbcast:10 row_mask:0xf bank_mask:0xf
  v_mov_b32 v171, v144 row_newbcast:11 row_mask:0xf bank_mask:0xf
  v_mfma_f32_16x16x32_bf16 v[208:211], v[96:99], v[164:167], v[208:211]
  v_mfma_f32_16x16x32_bf16 v[212:215], v[100:103], v[164:167], v[212:215]
  v_mfma_f32_16x16x32_bf16 v[216:219], v[104:107], v[164:167], v[216:219]
  v_mfma_f32_16x16x32_bf16 v[220:223], v[108:111], v[164:167], v[220:223]
  v_mov_b32 v172, v144 row_newbcast:12 row_mask:0xf bank_mask:0xf
  v_mov_b32 v173, v144 row_newbcast:13 row_mask:0xf bank_mask:0xf
  v_mov_b32 v174, v144 row_newbcast:14 row_mask:0xf bank_mask:0xf
  v_mov_b32 v175, v144 row_newbcast:15 row_mask:0xf bank_mask:0xf
  v_mfma_f32_16x16x32_bf16 v[208:211], v[112:115], v[168:171], v[208:211]
  v_mfma_f32_16x16x32_bf16 v[212:215], v[116:119], v[168:171], v[212:215]
  v_mfma_f32_16x16x32_bf16 v[216:219], v[120:123], v[168:171], v[216:219]
  v_mfma_f32_16x16x32_bf16 v[220:223], v[124:127], v[168:171], v[220:223]
  v_mfma_f32_16x16x32_bf16 v[208:211], v[128:131], v[172:175], v[208:211]
  v_mfma_f32_16x16x32_bf16 v[212:215], v[132:135], v[172:175], v[212:215]
  v_mfma_f32_16x16x32_bf16 v[216:219], v[136:139], v[172:175], v[216:219]
  v_mfma_f32_16x16x32_bf16 v[220:223], v[140:143], v[172:175], v[220:223]
  s_mov_b32 exec_lo, 0x20002
  s_mov_b32 exec_hi, 0x20002
  s_nop 3
  v_mov_b32 v208, v212
  v_mov_b32 v209, v213
  v_mov_b32 v210, v214
  v_mov_b32 v211, v215
  s_mov_b32 exec_lo, 0x40004
  s_mov_b32 exec_hi, 0x40004
  v_mov_b32 v208, v216
  v_mov_b32 v209, v217
  v_mov_b32 v210, v218
  v_mov_b32 v211, v219
  s_mov_b32 exec_lo, 0x80008
  s_mov_b32 exec_hi, 0x80008
  v_mov_b32 v208, v220
  v_mov_b32 v209, v221
  v_mov_b32 v210, v222
  v_mov_b32 v211, v223
  s_mov_b32 exec_lo, 0xf000f
  s_mov_b32 exec_hi, 0xf000f
  v_or_b32 v208, 1, v208
  v_or_b32 v210, 1, v210
  buffer_store_dwordx4 v[208:211], v19, s[4:7], s27 offen sc1
  s_mov_b64 exec, -1
  s_setprio 0
.fz_kernel_c_nd:
  s_cmp_eq_u32 s75, 0
  s_cbranch_scc1 .fz_kernel_c_m0
  s_lshl_b32 s21, s17, 1
  s_add_u32 s21, s21, s20
  s_cmp_lg_u32 s21, 31
  s_cbranch_scc1 .fz_kernel_fin
  s_branch .fz_kernel_c_pp
.fz_kernel_c_m0:
  s_cmp_eq_u32 s79, 0
  s_cselect_b32 s21, 2, 0
  s_add_u32 s3, s3, s21
.fz_kernel_c_pp:
  s_cmp_eq_u32 s3, 0
  s_cbranch_scc1 .fz_kernel_hb84
  s_barrier
  s_sub_u32 s3, s3, 1
.fz_kernel_hb84:
  v_and_b32 v10, 7, v2
  v_lshlrev_b32 v10, 8, v10
  v_lshl_add_u32 v10, v12, 5, v10
  s_mul_i32 s21, s70, 7168
  s_add_u32 s21, s21, s72
  s_add_u32 s21, s21, 155648
  s_add_u32 s22, s21, 4096
  s_mov_b32 s24, 0x0f0f0f0f
  s_mov_b32 s25, 0x0f0f0f0f
  s_lshl_b32 s27, s18, 4
  s_add_u32 s27, s27, s17
  s_lshl_b32 s27, s27, 10
  s_add_u32 s27, s27, 0x1c84000
  v_mov_b32 v168, 1
  v_mov_b32 v169, 1
  v_mov_b32 v170, 1
  v_mov_b32 v171, 1
  v_mov_b32 v172, 1
  v_mov_b32 v173, 1
  v_mov_b32 v174, 1
  v_mov_b32 v175, 1
  s_cmp_eq_u32 s3, 0
  s_cbranch_scc1 .fz_kernel_hb73
  s_barrier
  s_sub_u32 s3, s3, 1
.fz_kernel_hb73:
  s_cmp_eq_u32 s3, 0
  s_cbranch_scc1 .fz_kernel_hb74
  s_barrier
  s_sub_u32 s3, s3, 1
.fz_kernel_hb74:
  buffer_load_dwordx4 v[144:147], v10, s[4:7], s21 offen offset:0 sc1
  buffer_load_dwordx4 v[148:151], v10, s[4:7], s21 offen offset:16 sc1
  buffer_load_dwordx4 v[152:155], v10, s[4:7], s21 offen offset:2048 sc1
  buffer_load_dwordx4 v[156:159], v10, s[4:7], s21 offen offset:2064 sc1
  buffer_load_dwordx4 v[160:163], v10, s[4:7], s22 offen offset:0 sc1
  buffer_load_dwordx4 v[164:167], v10, s[4:7], s22 offen offset:16 sc1
  s_mov_b64 exec, s[24:25]
  buffer_load_dwordx4 v[168:171], v10, s[4:7], s22 offen offset:2048 sc1
  buffer_load_dwordx4 v[172:175], v10, s[4:7], s22 offen offset:2064 sc1
  s_mov_b64 exec, -1
  s_mov_b32 s38, 0
  s_cmp_eq_u32 s20, 0
  s_cbranch_scc1 .fz_kernel_c_pu
  s_waitcnt vmcnt(8)
  v_lshlrev_b32 v184, 16, v200
  v_and_b32 v185, 0xffff0000, v200
  v_lshlrev_b32 v186, 16, v201
  v_and_b32 v187, 0xffff0000, v201
  v_lshlrev_b32 v188, 16, v202
  v_and_b32 v189, 0xffff0000, v202
  v_lshlrev_b32 v190, 16, v203
  v_and_b32 v191, 0xffff0000, v203
  v_fma_f32 v184, v184, v178, v179
  v_fma_f32 v185, v185, v178, v179
  v_fma_f32 v186, v186, v178, v179
  v_fma_f32 v187, v187, v178, v179
  v_fma_f32 v188, v188, v178, v179
  v_fma_f32 v189, v189, v178, v179
  v_fma_f32 v190, v190, v178, v179
  v_fma_f32 v191, v191, v178, v179
.fz_kernel_c_pu:
  s_mov_b32 s46, 0
  s_call_b64 s[0:1], .fz_kernel_hw
  s_waitcnt vmcnt(0)
  s_cmp_eq_u32 s3, 0
  s_cbranch_scc1 .fz_kernel_hb85
  s_barrier
  s_sub_u32 s3, s3, 1
.fz_kernel_hb85:
  v_min3_u32 v9, v144, v146, v148
  v_min3_u32 v9, v9, v150, v152
  v_min3_u32 v9, v9, v154, v156
  v_min3_u32 v9, v9, v158, v160
  v_min3_u32 v9, v9, v162, v164
  v_min3_u32 v9, v9, v166, v168
  v_min3_u32 v9, v9, v170, v172
  v_min_u32 v9, v9, v174
  v_cmp_eq_u32 vcc, 0, v9
  v_add_f32 v236, v144, v152
  v_add_f32 v237, v145, v153
  v_add_f32 v238, v146, v154
  v_add_f32 v239, v147, v155
  s_cbranch_vccnz .fz_kernel_c_pur
.fz_kernel_c_pud:
  v_add_f32 v240, v148, v156
  v_add_f32 v241, v149, v157
  v_add_f32 v242, v150, v158
  v_add_f32 v243, v151, v159
  v_add_f32 v160, v160, v168
  v_add_f32 v161, v161, v169
  v_add_f32 v162, v162, v170
  v_add_f32 v163, v163, v171
  v_add_f32 v164, v164, v172
  v_add_f32 v165, v165, v173
  v_add_f32 v166, v166, v174
  v_add_f32 v167, v167, v175
  v_add_f32 v144, v236, v160
  v_add_f32 v145, v237, v161
  v_add_f32 v146, v238, v162
  v_add_f32 v147, v239, v163
  v_add_f32 v148, v240, v164
  v_add_f32 v149, v241, v165
  v_add_f32 v150, v242, v166
  v_add_f32 v151, v243, v167
  v_add_f32 v144, v144, v144 quad_perm:[1,0,3,2] row_mask:0xf bank_mask:0xf
  v_add_f32 v145, v145, v145 quad_perm:[1,0,3,2] row_mask:0xf bank_mask:0xf
  s_cmp_eq_u32 s3, 0
  s_cbranch_scc1 .fz_kernel_hb86
  s_barrier
  s_sub_u32 s3, s3, 1
.fz_kernel_hb86:
  v_add_f32 v146, v146, v146 quad_perm:[1,0,3,2] row_mask:0xf bank_mask:0xf
  v_add_f32 v147, v147, v147 quad_perm:[1,0,3,2] row_mask:0xf bank_mask:0xf
  v_add_f32 v148, v148, v148 quad_perm:[1,0,3,2] row_mask:0xf bank_mask:0xf
  v_add_f32 v149, v149, v149 quad_perm:[1,0,3,2] row_mask:0xf bank_mask:0xf
  v_add_f32 v150, v150, v150 quad_perm:[1,0,3,2] row_mask:0xf bank_mask:0xf
  v_add_f32 v151, v151, v151 quad_perm:[1,0,3,2] row_mask:0xf bank_mask:0xf
  v_add_f32 v144, v144, v144 quad_perm:[2,3,0,1] row_mask:0xf bank_mask:0xf
  v_add_f32 v145, v145, v145 quad_perm:[2,3,0,1] row_mask:0xf bank_mask:0xf
  v_add_f32 v146, v146, v146 quad_perm:[2,3,0,1] row_mask:0xf bank_mask:0xf
  v_add_f32 v147, v147, v147 quad_perm:[2,3,0,1] row_mask:0xf bank_mask:0xf
  v_add_f32 v148, v148, v148 quad_perm:[2,3,0,1] row_mask:0xf bank_mask:0xf
  v_add_f32 v149, v149, v149 quad_perm:[2,3,0,1] row_mask:0xf bank_mask:0xf
  v_add_f32 v150, v150, v150 quad_perm:[2,3,0,1] row_mask:0xf bank_mask:0xf
  v_add_f32 v151, v151, v151 quad_perm:[2,3,0,1] row_mask:0xf bank_mask:0xf
  v_add_f32 v144, v144, v144 row_half_mirror row_mask:0xf bank_mask:0xf
  v_add_f32 v145, v145, v145 row_half_mirror row_mask:0xf bank_mask:0xf
  v_add_f32 v146, v146, v146 row_half_mirror row_mask:0xf bank_mask:0xf
  v_add_f32 v147, v147, v147 row_half_mirror row_mask:0xf bank_mask:0xf
  v_add_f32 v148, v148, v148 row_half_mirror row_mask:0xf bank_mask:0xf
  v_add_f32 v149, v149, v149 row_half_mirror row_mask:0xf bank_mask:0xf
  v_add_f32 v150, v150, v150 row_half_mirror row_mask:0xf bank_mask:0xf
  v_add_f32 v151, v151, v151 row_half_mirror row_mask:0xf bank_mask:0xf
  v_mul_f32 v144, v144, v1
  v_mul_f32 v145, v145, v1
  v_mul_f32 v146, v146, v1
  v_mul_f32 v147, v147, v1
  v_mul_f32 v148, v148, v1
  v_mul_f32 v149, v149, v1
  v_mul_f32 v150, v150, v1
  v_mul_f32 v151, v151, v1
  v_cvt_pk_bf16_f32 v180, v144, v145
  v_cvt_pk_bf16_f32 v181, v146, v147
  v_cvt_pk_bf16_f32 v182, v148, v149
  v_cvt_pk_bf16_f32 v183, v150, v151
  s_or_b32 s21, s75, s71
  s_cbranch_scc1 .fz_kernel_c_w7
  s_mul_i32 s21, s20, 384
  s_add_u32 s21, s21, s27
  s_setprio 2
  v_mfma_f32_16x16x32_bf16 v[208:211], v[180:183], v[32:35], 0
  v_mov_b32 v232, v180 row_ror:8 row_mask:0xf bank_mask:0xf
  v_mfma_f32_16x16x32_bf16 v[212:215], v[180:183], v[36:39], 0
  v_mov_b32 v233, v181 row_ror:8 row_mask:0xf bank_mask:0xf
  v_mfma_f32_16x16x32_bf16 v[216:219], v[180:183], v[40:43], 0
  v_mov_b32 v234, v182 row_ror:8 row_mask:0xf bank_mask:0xf
  v_mfma_f32_16x16x32_bf16 v[220:223], v[180:183], v[44:47], 0
  v_mov_b32 v235, v183 row_ror:8 row_mask:0xf bank_mask:0xf
  v_mfma_f32_16x16x32_bf16 v[224:227], v[180:183], v[48:51], 0
  v_mfma_f32_16x16x32_bf16 v[228:231], v[180:183], v[52:55], 0
  v_mfma_f32_16x16x32_bf16 v[208:211], v[232:235], v[56:59], v[208:211]
  v_mfma_f32_16x16x32_bf16 v[212:215], v[232:235], v[60:63], v[212:215]
  v_mfma_f32_16x16x32_bf16 v[216:219], v[232:235], v[64:67], v[216:219]
  v_mfma_f32_16x16x32_bf16 v[220:223], v[232:235], v[68:71], v[220:223]
  v_mfma_f32_16x16x32_bf16 v[224:227], v[232:235], v[72:75], v[224:227]
  v_mfma_f32_16x16x32_bf16 v[228:231], v[232:235], v[76:79], v[228:231]
  s_nop 2
  v_or_b32 v208, 1, v208
  v_mov_b32 v209, v212
  v_or_b32 v210, 1, v216
  v_mov_b32 v211, v220
  s_mov_b64 exec, 0xffff
  buffer_store_dwordx4 v[208:211], v3, s[4:7], s21 offen offset:0 sc1
  v_or_b32 v224, 1, v224
  v_mov_b32 v225, v228
  buffer_store_dwordx2 v[224:225], v16, s[4:7], s21 offen offset:256 sc1
  s_mov_b64 exec, -1
  s_setprio 0
  s_cmp_lg_u32 s20, 0
  s_cbranch_scc1 .fz_kernel_c_w7
  s_cmp_eq_u32 s79, 0
  s_cbranch_scc1 .fz_kernel_c_no2
  s_cmp_eq_u32 s3, 0
  s_cbranch_scc1 .fz_kernel_hb87
  s_barrier
  s_sub_u32 s3, s3, 1
.fz_kernel_hb87:
  v_add_u32 v13, 155648, v3
  s_lshl_b32 s21, s18, 14
  s_add_u32 s21, s21, 0x1c84000
  s_add_u32 s22, s21, 4096
  s_add_u32 s23, s21, 8192
  s_add_u32 s24, s21, 12288
  v_rcp_f32 v144, v178
  v_lshlrev_b32 v146, 1, v2
  v_sub_u32 v146, s79, v146
  v_cmp_eq_u32 s[28:29], 1, v146
  v_cmp_eq_u32 s[30:31], 2, v146
  s_nop 0
  v_cndmask_b32 v148, 0, v144, s[28:29]
  v_cndmask_b32 v149, 0, v144, s[30:31]
  v_mov_b32 v9, 159952
  v_mov_b32 v7, s79
  ds_write_b32 v9, v7
  ds_write_b64 v26, v[148:149] offset:512
  s_lshl_b32 s25, s79, 2
  s_add_u32 s25, s25, 155644
  v_mov_b32 v7, s25
  v_mov_b32 v152, 0
  v_mov_b32 v153, 0
  v_mov_b32 v154, 0
  v_mov_b32 v155, 0
  s_bfm_b64 exec, 49, 0
  s_mov_b32 s38, 0
  s_mov_b32 s25, 15
.fz_kernel_c_pd:
  s_bitcmp1_b32 s25, 0
  s_cbranch_scc0 .fz_kernel_c_pl0
  buffer_load_dwordx4 v[80:83], v3, s[4:7], s21 offen offset:0 sc1
  buffer_load_dwordx4 v[84:87], v3, s[4:7], s21 offen offset:1024 sc1
  buffer_load_dwordx4 v[88:91], v3, s[4:7], s21 offen offset:2048 sc1
  buffer_load_dwordx4 v[92:95], v3, s[4:7], s21 offen offset:3072 sc1
.fz_kernel_c_pl0:
  s_bitcmp1_b32 s25, 1
  s_cbranch_scc0 .fz_kernel_c_pl1
  s_cmp_eq_u32 s3, 0
  s_cbranch_scc1 .fz_kernel_hb88
  s_barrier
  s_sub_u32 s3, s3, 1
.fz_kernel_hb88:
  buffer_load_dwordx4 v[96:99], v3, s[4:7], s22 offen offset:0 sc1
  buffer_load_dwordx4 v[100:103], v3, s[4:7], s22 offen offset:1024 sc1
  buffer_load_dwordx4 v[104:107], v3, s[4:7], s22 offen offset:2048 sc1
  buffer_load_dwordx4 v[108:111], v3, s[4:7], s22 offen offset:3072 sc1
.fz_kernel_c_pl1:
  s_bitcmp1_b32 s25, 2
  s_cbranch_scc0 .fz_kernel_c_pl2
  buffer_load_dwordx4 v[112:115], v3, s[4:7], s23 offen offset:0 sc1
  buffer_load_dwordx4 v[116:119], v3, s[4:7], s23 offen offset:1024 sc1
  buffer_load_dwordx4 v[120:123], v3, s[4:7], s23 offen offset:2048 sc1
  buffer_load_dwordx4 v[124:127], v3, s[4:7], s23 offen offset:3072 sc1
.fz_kernel_c_pl2:
  s_bitcmp1_b32 s25, 3
  s_cbranch_scc0 .fz_kernel_c_pl3
  buffer_load_dwordx4 v[128:131], v3, s[4:7], s24 offen offset:0 sc1
  buffer_load_dwordx4 v[132:135], v3, s[4:7], s24 offen offset:1024 sc1
  buffer_load_dwordx4 v[136:139], v3, s[4:7], s24 offen offset:2048 sc1
  buffer_load_dwordx4 v[140:143], v3, s[4:7], s24 offen offset:3072 sc1
.fz_kernel_c_pl3:
  s_add_u32 s38, s38, 1
  s_mov_b32 s46, 0
  s_call_b64 s[0:1], .fz_kernel_hw
  s_waitcnt vmcnt(0)
  s_bitcmp1_b32 s25, 0
  s_cbranch_scc0 .fz_kernel_c_pa0
  v_min3_u32 v9, v80, v82, v84
  v_min3_u32 v9, v9, v86, v88
  v_min3_u32 v9, v9, v90, v92
  v_min_u32 v9, v9, v94
  v_cmp_eq_u32 vcc, 0, v9
  v_add_f32 v80, v80, v84
  v_add_f32 v81, v81, v85
  s_cmp_eq_u32 s3, 0
  s_cbranch_scc1 .fz_kernel_hb89
  s_barrier
  s_sub_u32 s3, s3, 1
.fz_kernel_hb89:
  v_add_f32 v82, v82, v86
  v_add_f32 v83, v83, v87
  s_cbranch_vccnz .fz_kernel_c_pa0
  v_add_f32 v88, v88, v92
  v_add_f32 v89, v89, v93
  v_add_f32 v90, v90, v94
  v_add_f32 v91, v91, v95
  v_add_f32 v152, v152, v80
  v_add_f32 v153, v153, v81
  v_add_f32 v154, v154, v82
  v_add_f32 v155, v155, v83
  v_add_f32 v152, v152, v88
  v_add_f32 v153, v153, v89
  v_add_f32 v154, v154, v90
  v_add_f32 v155, v155, v91
  s_bitset0_b32 s25, 0
.fz_kernel_c_pa0:
  s_bitcmp1_b32 s25, 1
  s_cbranch_scc0 .fz_kernel_c_pa1
  v_min3_u32 v9, v96, v98, v100
  v_min3_u32 v9, v9, v102, v104
  v_min3_u32 v9, v9, v106, v108
  v_min_u32 v9, v9, v110
  v_cmp_eq_u32 vcc, 0, v9
  v_add_f32 v96, v96, v100
  v_add_f32 v97, v97, v101
  v_add_f32 v98, v98, v102
  v_add_f32 v99, v99, v103
  s_cbranch_vccnz .fz_kernel_c_pa1
  v_add_f32 v104, v104, v108
  v_add_f32 v105, v105, v109
  v_add_f32 v106, v106, v110
  v_add_f32 v107, v107, v111
  v_add_f32 v152, v152, v96
  v_add_f32 v153, v153, v97
  v_add_f32 v154, v154, v98
  v_add_f32 v155, v155, v99
  v_add_f32 v152, v152, v104
  v_add_f32 v153, v153, v105
  s_cmp_eq_u32 s3, 0
  s_cbranch_scc1 .fz_kernel_hb90
  s_barrier
  s_sub_u32 s3, s3, 1
.fz_kernel_hb90:
  v_add_f32 v154, v154, v106
  v_add_f32 v155, v155, v107
  s_bitset0_b32 s25, 1
.fz_kernel_c_pa1:
  s_bitcmp1_b32 s25, 2
  s_cbranch_scc0 .fz_kernel_c_pa2
  v_min3_u32 v9, v112, v114, v116
  v_min3_u32 v9, v9, v118, v120
  v_min3_u32 v9, v9, v122, v124
  v_min_u32 v9, v9, v126
  v_cmp_eq_u32 vcc, 0, v9
  v_add_f32 v112, v112, v116
  v_add_f32 v113, v113, v117
  v_add_f32 v114, v114, v118
  v_add_f32 v115, v115, v119
  s_cbranch_vccnz .fz_kernel_c_pa2
  v_add_f32 v120, v120, v124
  v_add_f32 v121, v121, v125
  v_add_f32 v122, v122, v126
  v_add_f32 v123, v123, v127
  v_add_f32 v152, v152, v112
  v_add_f32 v153, v153, v113
  v_add_f32 v154, v154, v114
  v_add_f32 v155, v155, v115
  v_add_f32 v152, v152, v120
  v_add_f32 v153, v153, v121
  v_add_f32 v154, v154, v122
  v_add_f32 v155, v155, v123
  s_bitset0_b32 s25, 2
.fz_kernel_c_pa2:
  s_bitcmp1_b32 s25, 3
  s_cbranch_scc0 .fz_kernel_c_pa3
  v_min3_u32 v9, v128, v130, v132
  v_min3_u32 v9, v9, v134, v136
  v_min3_u32 v9, v9, v138, v140
  v_min_u32 v9, v9, v142
  v_cmp_eq_u32 vcc, 0, v9
  v_add_f32 v128, v128, v132
  v_add_f32 v129, v129, v133
  v_add_f32 v130, v130, v134
  v_add_f32 v131, v131, v135
  s_cbranch_vccnz .fz_kernel_c_pa3
  s_cmp_eq_u32 s3, 0
  s_cbranch_scc1 .fz_kernel_hb91
  s_barrier
  s_sub_u32 s3, s3, 1
.fz_kernel_hb91:
  v_add_f32 v136, v136, v140
  v_add_f32 v137, v137, v141
  v_add_f32 v138, v138, v142
  v_add_f32 v139, v139, v143
  v_add_f32 v152, v152, v128
  v_add_f32 v153, v153, v129
  v_add_f32 v154, v154, v130
  v_add_f32 v155, v155, v131
  v_add_f32 v152, v152, v136
  v_add_f32 v153, v153, v137
  v_add_f32 v154, v154, v138
  v_add_f32 v155, v155, v139
  s_bitset0_b32 s25, 3
.fz_kernel_c_pa3:
  s_cmp_eq_u32 s25, 0
  s_cbranch_scc1 .fz_kernel_c_pdd
  s_cmp_lt_u32 s38, 131072
  s_cbranch_scc1 .fz_kernel_c_pd
.fz_kernel_c_pdd:
  s_mov_b32 exec_hi, 0xffff
  ds_write_b128 v13, v[152:155] offset:1536
  s_mov_b64 exec, -1
  v_readlane_b32 s21, v152, 48
  v_readlane_b32 s22, v154, 48
  s_nop 0
  v_mul_f32 v144, s21, v23
  v_fma_f32 v145, s22, v23, v25
  v_fma_f32 v145, -v144, v144, v145
  v_rsq_f32 v145, abs(v145)
  v_sub_f32 v144, v179, v144
  v_mul_f32 v146, v145, v178
  v_mul_f32 v147, v145, v144
  ds_write_b32 v7, v146 offset:4608
  ds_write_b32 v7, v147 offset:5120
  s_waitcnt lgkmcnt(0)
  s_add_u32 s3, s3, 2
.fz_kernel_c_no2:
  s_branch .fz_kernel_q_he
.fz_kernel_c_w7:
  s_setprio 2
  v_lshlrev_b32 v144, 16, v180
  v_and_b32 v145, 0xffff0000, v180
  v_lshlrev_b32 v146, 16, v181
  v_and_b32 v147, 0xffff0000, v181
  v_lshlrev_b32 v148, 16, v182
  v_and_b32 v149, 0xffff0000, v182
  v_lshlrev_b32 v150, 16, v183
  v_and_b32 v151, 0xffff0000, v183
  s_cmp_lg_u32 s71, 0
  s_cbranch_scc1 .fz_kernel_c_eu
  v_add_f32 v184, v184, v144
  v_add_f32 v185, v185, v145
  v_add_f32 v186, v186, v146
  v_add_f32 v187, v187, v147
  v_add_f32 v188, v188, v148
  v_add_f32 v189, v189, v149
  v_add_f32 v190, v190, v150
  v_add_f32 v191, v191, v151
  s_cmp_lg_u32 s75, 0
  s_cbranch_scc1 .fz_kernel_c_t3
  v_mul_f32 v152, v184, v184
  v_add_f32 v154, v184, v185
  v_fmac_f32 v152, v185, v185
  v_fmac_f32 v152, v186, v186
  v_add_f32 v154, v154, v186
  v_fmac_f32 v152, v187, v187
  v_add_f32 v154, v154, v187
  v_fmac_f32 v152, v188, v188
  v_add_f32 v154, v154, v188
  v_fmac_f32 v152, v189, v189
  v_add_f32 v154, v154, v189
  v_fmac_f32 v152, v190, v190
  v_add_f32 v154, v154, v190
  v_fmac_f32 v152, v191, v191
  v_add_f32 v154, v154, v191
  v_lshrrev_b32 v9, 5, v2
  v_lshlrev_b32 v9, 3, v9
  v_permlane32_swap_b32 v154, v152
  v_add_f32 v154, v154, v152
  s_nop 1
  v_add_f32 v154, v154, v154 row_ror:8 row_mask:0xf bank_mask:0xf
  s_nop 1
  v_add_f32 v154, v154, v154 row_bcast:15 row_mask:0xa bank_mask:0xf
  v_or_b32 v154, 1, v154
  s_mov_b32 exec_lo, 0x10000
  s_mov_b32 exec_hi, 0x10000
  buffer_store_dword v154, v9, s[4:7], s27 offen offset:768 sc1
  s_mov_b64 exec, -1
  s_setprio 0
  s_cmp_eq_u32 s79, 0
  s_cbranch_scc1 .fz_kernel_q_he
  s_add_u32 s3, s3, 2
  s_mov_b32 s71, 1
  s_mov_b32 s70, s18
  s_branch .fz_kernel_c_pp
.fz_kernel_c_eu:
  s_cmp_eq_u32 s3, 0
  s_cbranch_scc1 .fz_kernel_hb92
  s_barrier
  s_sub_u32 s3, s3, 1
.fz_kernel_hb92:
  v_lshlrev_b32 v9, 5, v12
  v_add_u32 v9, 155648, v9
  s_mov_b32 exec_lo, 0x01010101
  s_mov_b32 exec_hi, 0x01010101
  ds_write_b128 v9, v[144:147] offset:7424
  ds_write_b128 v9, v[148:151] offset:7440
  s_mov_b64 exec, -1
  s_waitcnt lgkmcnt(0)
  s_branch .fz_kernel_q_he
.fz_kernel_c_t3:
  s_mov_b32 s28, s56
  s_mov_b32 s29, s57
  s_mov_b32 s30, 0x400000
  s_mov_b32 s31, 0x00020000
  v_cvt_pk_bf16_f32 v144, v184, v185
  v_cvt_pk_bf16_f32 v145, v186, v187
  v_cvt_pk_bf16_f32 v146, v188, v189
  v_cvt_pk_bf16_f32 v147, v190, v191
  v_lshlrev_b32 v9, 4, v12
  s_lshl_b32 s21, s77, 11
  s_lshl_b32 s22, s18, 7
  s_add_u32 s21, s21, s22
  s_mov_b32 exec_lo, 0x01010101
  s_mov_b32 exec_hi, 0x01010101
  buffer_store_dwordx4 v[144:147], v9, s[28:31], s21 offen
  s_mov_b64 exec, -1
.fz_kernel_fin:
.fz_kernel_end:
  s_endpgm
.fz_kernel_pick:
  s_mov_b32 s33, 1
  s_cmp_eq_u32 s34, 0xffff
  s_cselect_b32 s35, 0x40000000, s35
  s_cbranch_scc1 .fz_kernel_pick_ret
  s_mov_b32 s38, 0
.fz_kernel_pick_l:
  ds_read_b32 v7, v6
  s_add_u32 s38, s38, 1
  s_waitcnt lgkmcnt(0)
  v_readfirstlane_b32 s36, v7
  s_andn2_b32 s33, s36, s34
  s_cbranch_scc1 .fz_kernel_pick_ret
  s_cmp_lt_u32 s38, 1048576
  s_cbranch_scc1 .fz_kernel_pick_l
  s_mov_b32 s36, 0xffff
  s_andn2_b32 s33, s36, s34
.fz_kernel_pick_ret:
  s_nop 4
  s_setpc_b64 s[68:69]
.fz_kernel_hw:
  s_mov_b32 s47, 0
.fz_kernel_hwl:
  s_getreg_b32 s100, hwreg(HW_REG_IB_STS)
  s_bfe_u32 s101, s100, 0x20016
  s_and_b32 s100, s100, 15
  s_lshl4_add_u32 s100, s101, s100
  s_cmp_le_u32 s100, s46
  s_cbranch_scc1 .fz_kernel_hwr
  s_sub_u32 s47, s47, 1
  s_cbranch_scc0 .fz_kernel_hwl
  s_cmp_eq_u32 s3, 0
  s_cbranch_scc1 .fz_kernel_hwr
  s_cmp_eq_u32 s3, 32
  s_cbranch_scc1 .fz_kernel_hwp
.fz_kernel_hwb:
  s_barrier
  s_sub_u32 s3, s3, 1
  s_mov_b32 s47, 2
  s_branch .fz_kernel_hwl
.fz_kernel_hwr:
  s_setpc_b64 s[0:1]
  .fz_kernel_hwp:
  ds_read_b32 v27, v6 offset:0x110
  s_mov_b32 s47, 0
  s_waitcnt lgkmcnt(0)
  v_readfirstlane_b32 s100, v27
  s_cmp_ge_u32 s100, 0x200
  s_cbranch_scc1 .fz_kernel_hwb
  s_branch .fz_kernel_hwl
.fz_kernel_q_cons2:
  s_setprio 0
  s_lshr_b32 s26, s16, 1
  s_lshl_b32 s28, s26, 13
  v_add_u32 v8, s28, v3
  v_add_u32 v9, 1024, v8
  v_mov_b32 v232, v20
  v_mov_b32 v233, v21
  v_mov_b32 v234, v22
  v_mov_b32 v235, v23
  v_mov_b32 v236, v24
  v_mov_b32 v237, v25
  v_mov_b32 v238, v26
  v_mov_b32 v239, v27
  v_mov_b32 v240, v28
  v_mov_b32 v241, v29
  v_mov_b32 v242, v30
  v_mov_b32 v243, v31
  v_mov_b32 v244, v32
  v_mov_b32 v245, v33
  v_mov_b32 v246, v34
  v_mov_b32 v247, v35
  s_branch .fz_kernel_q_cs
.fz_kernel_q_patch:
  s_mul_i32 s31, s27, 384
  s_add_u32 s31, s31, 155648
  v_and_b32 v73, 48, v2
  v_lshlrev_b32 v73, 2, v73
  v_add_u32 v73, s31, v73
  v_and_b32 v75, 15, v2
  v_lshlrev_b32 v75, 3, v75
  v_add_u32 v75, s31, v75
  ds_read_b32 v72, v14 offset:512
  ds_read_b32 v74, v14 offset:576
  ds_read_b32 v76, v14 offset:640
  ds_read_b32 v78, v14 offset:704
  ds_read_b128 v[80:83], v73 offset:1536
  ds_read_b128 v[84:87], v73 offset:1552
  ds_read_b128 v[88:91], v73 offset:1568
  ds_read_b128 v[92:95], v73 offset:1584
  s_waitcnt lgkmcnt(0)
  v_fmac_f32 v160, v82, v72
  v_fmac_f32 v161, v86, v72
  v_fmac_f32 v162, v90, v72
  v_fmac_f32 v163, v94, v72
  v_fmac_f32 v164, v82, v74
  v_fmac_f32 v165, v86, v74
  v_fmac_f32 v166, v90, v74
  v_fmac_f32 v167, v94, v74
  v_fmac_f32 v168, v82, v76
  v_fmac_f32 v169, v86, v76
  v_fmac_f32 v170, v90, v76
  v_fmac_f32 v171, v94, v76
  v_fmac_f32 v172, v82, v78
  v_fmac_f32 v173, v86, v78
  v_fmac_f32 v174, v90, v78
  v_fmac_f32 v175, v94, v78
  v_fmac_f32 v176, v83, v72
  v_fmac_f32 v177, v87, v72
  v_fmac_f32 v178, v91, v72
  v_fmac_f32 v179, v95, v72
  v_fmac_f32 v180, v83, v74
  v_fmac_f32 v181, v87, v74
  v_fmac_f32 v182, v91, v74
  v_fmac_f32 v183, v95, v74
  v_fmac_f32 v184, v83, v76
  v_fmac_f32 v185, v87, v76
  v_fmac_f32 v186, v91, v76
  v_fmac_f32 v187, v95, v76
  v_fmac_f32 v188, v83, v78
  v_fmac_f32 v189, v87, v78
  v_fmac_f32 v190, v91, v78
  v_fmac_f32 v191, v95, v78
  v_fmac_f32 v128, v80, v72
  v_fmac_f32 v129, v84, v72
  v_fmac_f32 v130, v88, v72
  v_fmac_f32 v131, v92, v72
  v_fmac_f32 v132, v80, v74
  v_fmac_f32 v133, v84, v74
  v_fmac_f32 v134, v88, v74
  v_fmac_f32 v135, v92, v74
  v_fmac_f32 v136, v80, v76
  v_fmac_f32 v137, v84, v76
  v_fmac_f32 v138, v88, v76
  v_fmac_f32 v139, v92, v76
  v_fmac_f32 v140, v80, v78
  v_fmac_f32 v141, v84, v78
  v_fmac_f32 v142, v88, v78
  v_fmac_f32 v143, v92, v78
  v_fmac_f32 v144, v81, v72
  v_fmac_f32 v145, v85, v72
  v_fmac_f32 v146, v89, v72
  v_fmac_f32 v147, v93, v72
  v_fmac_f32 v148, v81, v74
  v_fmac_f32 v149, v85, v74
  v_fmac_f32 v150, v89, v74
  v_fmac_f32 v151, v93, v74
  v_fmac_f32 v152, v81, v76
  v_fmac_f32 v153, v85, v76
  v_fmac_f32 v154, v89, v76
  v_fmac_f32 v155, v93, v76
  v_fmac_f32 v156, v81, v78
  v_fmac_f32 v157, v85, v78
  v_fmac_f32 v158, v89, v78
  v_fmac_f32 v159, v93, v78
  ds_read_b128 v[80:83], v15 offset:512
  ds_read_b128 v[84:87], v15 offset:576
  ds_read_b128 v[88:91], v15 offset:640
  ds_read_b128 v[92:95], v15 offset:704
  ds_read_b64 v[72:73], v75 offset:1792
  s_waitcnt lgkmcnt(0)
  v_fmac_f32 v192, v80, v72
  v_fmac_f32 v193, v81, v72
  v_fmac_f32 v194, v82, v72
  v_fmac_f32 v195, v83, v72
  v_fmac_f32 v196, v84, v72
  v_fmac_f32 v197, v85, v72
  v_fmac_f32 v198, v86, v72
  v_fmac_f32 v199, v87, v72
  v_fmac_f32 v200, v88, v72
  v_fmac_f32 v201, v89, v72
  v_fmac_f32 v202, v90, v72
  v_fmac_f32 v203, v91, v72
  v_fmac_f32 v204, v92, v72
  v_fmac_f32 v205, v93, v72
  v_fmac_f32 v206, v94, v72
  v_fmac_f32 v207, v95, v72
  v_fmac_f32 v208, v80, v73
  v_fmac_f32 v209, v81, v73
  v_fmac_f32 v210, v82, v73
  v_fmac_f32 v211, v83, v73
  v_fmac_f32 v212, v84, v73
  v_fmac_f32 v213, v85, v73
  v_fmac_f32 v214, v86, v73
  v_fmac_f32 v215, v87, v73
  v_fmac_f32 v216, v88, v73
  v_fmac_f32 v217, v89, v73
  v_fmac_f32 v218, v90, v73
  v_fmac_f32 v219, v91, v73
  v_fmac_f32 v220, v92, v73
  v_fmac_f32 v221, v93, v73
  v_fmac_f32 v222, v94, v73
  v_fmac_f32 v223, v95, v73
  s_branch .fz_kernel_q_pback
.fz_kernel_q_prod2:
  s_mov_b64 s[8:9], s[4:5]
  s_mov_b64 s[10:11], s[6:7]
  s_mov_b64 s[12:13], s[42:43]
  s_lshl_b32 s35, s17, 6
  s_and_b32 s31, s16, 1
  s_add_u32 s35, s35, s31
  s_lshl_b32 s35, s35, 12
  s_add_u32 s35, s35, s73
  s_lshr_b32 s33, s17, 3
  s_add_u32 s29, s18, s33
  s_lshl1_add_u32 s29, s17, s29
  s_and_b32 s29, s29, 15
  s_mov_b32 s22, 16384
  s_mov_b32 s23, 8192
  s_mov_b32 s36, 0
  s_add_u32 s37, s19, s74
  s_add_u32 s37, s37, 8
  v_mov_b32 v40, v3
  v_mov_b32 v41, v3
  v_mov_b32 v42, v3
  v_mov_b32 v43, v3
  s_branch .fz_kernel_q_pc
.fz_kernel_xok1w:
  s_call_b64 s[68:69], .fz_kernel_q_xw
  s_branch .fz_kernel_xok1
.fz_kernel_xok2w:
  s_call_b64 s[68:69], .fz_kernel_q_xw
  s_branch .fz_kernel_xok2
.fz_kernel_q_xw:
  s_mov_b64 exec, 1
  s_mov_b32 s38, 0
.fz_kernel_q_xwl:
  ds_read_b32 v11, v6 offset:0x114
  s_add_u32 s38, s38, 1
  s_waitcnt lgkmcnt(0)
  v_readfirstlane_b32 s36, v11
  s_bitcmp1_b32 s36, s24
  s_cbranch_scc1 .fz_kernel_q_xwd
  s_cmp_lt_u32 s38, 1048576
  s_cbranch_scc1 .fz_kernel_q_xwl
  s_mov_b32 s36, -1
.fz_kernel_q_xwd:
  s_mov_b64 exec, -1
  s_nop 4
  s_setpc_b64 s[68:69]
.fz_kernel_xok3w:
  s_call_b64 s[68:69], .fz_kernel_q_xw
  s_branch .fz_kernel_xok3
.fz_kernel_lz20a:
  v_lshlrev_b32 v16, 3, v2
  buffer_atomic_and_x2 v[12:13], v16, s[4:7], s36 offen offset:0 sc1
  buffer_atomic_and_x2 v[12:13], v16, s[4:7], s36 offen offset:512 sc1
  buffer_atomic_and_x2 v[12:13], v16, s[4:7], s36 offen offset:1024 sc1
  buffer_atomic_and_x2 v[12:13], v16, s[4:7], s36 offen offset:1536 sc1
  buffer_atomic_and_x2 v[12:13], v16, s[4:7], s36 offen offset:2048 sc1
  buffer_atomic_and_x2 v[12:13], v16, s[4:7], s36 offen offset:2560 sc1
  buffer_atomic_and_x2 v[12:13], v16, s[4:7], s36 offen offset:3072 sc1
  buffer_atomic_and_x2 v[12:13], v16, s[4:7], s36 offen offset:3584 sc1
  s_branch .fz_kernel_lz20
.fz_kernel_a_pick:
  s_cmp_eq_u32 s34, 0xffff
  s_cbranch_scc1 .fz_kernel_a_picke
  s_mov_b32 s38, 0
.fz_kernel_a_pickl:
  ds_read_b32 v7, v6
  s_add_u32 s38, s38, 1
  s_waitcnt lgkmcnt(0)
  v_readfirstlane_b32 s33, v7
  s_cmp_lt_u32 s38, 1048576
  s_cselect_b32 s33, s33, 0xffff
  s_andn2_b32 s36, s33, s34
  s_cbranch_scc0 .fz_kernel_a_pickl
  s_or_b32 s34, s34, s33
  s_ff1_i32_b32 s33, s36
  s_bitset0_b32 s36, s33
  s_lshl_b32 s33, s33, 14
  s_add_u32 s30, s33, s35
  s_setpc_b64 s[68:69]
.fz_kernel_a_picke:
  s_mov_b32 s30, 0x40000000
  ds_write_b32 v6, v5 offset:0x104
  s_setpc_b64 s[68:69]
.fz_kernel_pk26c:
  s_call_b64 s[68:69], .fz_kernel_a_pick
  s_branch .fz_kernel_pk26
.fz_kernel_pk27c:
  s_call_b64 s[68:69], .fz_kernel_a_pick
  s_branch .fz_kernel_pk27
.fz_kernel_pk28c:
  s_call_b64 s[68:69], .fz_kernel_a_pick
  s_branch .fz_kernel_pk28
.fz_kernel_pk31c:
  s_call_b64 s[68:69], .fz_kernel_a_pick
  s_branch .fz_kernel_pk31
.fz_kernel_pk32c:
  s_call_b64 s[68:69], .fz_kernel_a_pick
  s_branch .fz_kernel_pk32
.fz_kernel_a_slow:
  s_cmp_lg_u32 s73, 0
  s_cbranch_scc1 .fz_kernel_a_ok
  s_mov_b32 s73, 1
  s_and_b32 s39, s16, 1
  v_mov_b32 v16, v32
  v_mov_b32 v17, v33
  v_mov_b32 v18, v34
  v_mov_b32 v19, v35
  v_mov_b32 v20, v36
  v_mov_b32 v21, v37
  v_mov_b32 v22, v38
  v_mov_b32 v23, v39
  s_call_b64 s[68:69], .fz_kernel_a_sl
  v_mov_b32 v176, v144
  v_mov_b32 v177, v145
  v_mov_b32 v178, v146
  v_mov_b32 v179, v147
  v_mov_b32 v180, v148
  v_mov_b32 v181, v149
  v_mov_b32 v182, v150
  v_mov_b32 v183, v151
  v_mov_b32 v184, v152
  v_mov_b32 v185, v153
  v_mov_b32 v186, v154
  v_mov_b32 v187, v155
  v_mov_b32 v188, v156
  v_mov_b32 v189, v157
  v_mov_b32 v190, v158
  v_mov_b32 v191, v159
  v_mov_b32 v24, v25
  v_mov_b32 v16, v40
  v_mov_b32 v17, v41
  v_mov_b32 v18, v42
  v_mov_b32 v19, v43
  v_mov_b32 v20, v44
  v_mov_b32 v21, v45
  v_mov_b32 v22, v46
  v_mov_b32 v23, v47
  s_call_b64 s[68:69], .fz_kernel_a_sl
  v_mov_b32 v192, v144
  v_mov_b32 v193, v145
  v_mov_b32 v194, v146
  v_mov_b32 v195, v147
  v_mov_b32 v196, v148
  v_mov_b32 v197, v149
  v_mov_b32 v198, v150
  v_mov_b32 v199, v151
  v_mov_b32 v200, v152
  v_mov_b32 v201, v153
  v_mov_b32 v202, v154
  v_mov_b32 v203, v155
  v_mov_b32 v204, v156
  v_mov_b32 v205, v157
  v_mov_b32 v206, v158
  v_mov_b32 v207, v159
  v_rcp_f32 v26, v24
  v_cmp_le_f32 vcc, s24, v24
  s_and_b64 s[36:37], s[36:37], vcc
  v_cmp_ge_f32 vcc, s25, v24
  s_and_b64 s[36:37], s[36:37], vcc
  v_pk_mul_f32 v[176:177], v[176:177], v[26:27] op_sel_hi:[1,0]
  v_pk_mul_f32 v[178:179], v[178:179], v[26:27] op_sel_hi:[1,0]
  v_pk_mul_f32 v[180:181], v[180:181], v[26:27] op_sel_hi:[1,0]
  v_pk_mul_f32 v[182:183], v[182:183], v[26:27] op_sel_hi:[1,0]
  v_cvt_pk_bf16_f32 v48, v176, v177
  v_cvt_pk_bf16_f32 v49, v178, v179
  v_cvt_pk_bf16_f32 v50, v180, v181
  v_cvt_pk_bf16_f32 v51, v182, v183
  buffer_store_dwordx4 v[48:51], v3, s[4:7], s28 offen offset:0 sc1
  v_pk_mul_f32 v[184:185], v[184:185], v[26:27] op_sel_hi:[1,0]
  v_pk_mul_f32 v[186:187], v[186:187], v[26:27] op_sel_hi:[1,0]
  v_pk_mul_f32 v[188:189], v[188:189], v[26:27] op_sel_hi:[1,0]
  v_pk_mul_f32 v[190:191], v[190:191], v[26:27] op_sel_hi:[1,0]
  v_cvt_pk_bf16_f32 v52, v184, v185
  v_cvt_pk_bf16_f32 v53, v186, v187
  v_cvt_pk_bf16_f32 v54, v188, v189
  v_cvt_pk_bf16_f32 v55, v190, v191
  buffer_store_dwordx4 v[52:55], v3, s[4:7], s28 offen offset:1024 sc1
  s_branch .fz_kernel_a_fin
.fz_kernel_a_sl:
  s_waitcnt vmcnt(0)
  s_lshl_b32 s23, s18, 1
  s_add_u32 s23, s23, s39
  s_lshl_b32 s23, s23, 18
  s_add_u32 s23, s23, s63
  s_mov_b32 s30, s23
  s_mov_b32 s33, 64
  v_mov_b32 v27, 0xff800000
.fz_kernel_a_s1:
  buffer_load_dwordx4 v[80:83], v3, s[4:7], s30 offen offset:0
  buffer_load_dwordx4 v[84:87], v3, s[4:7], s30 offen offset:1024
  s_waitcnt vmcnt(0)
  v_mfma_f32_32x32x16_bf16 v[48:63], v[80:83], v[16:19], 0
  v_mfma_f32_32x32x16_bf16 v[48:63], v[84:87], v[20:23], v[48:63]
  s_nop 11
  v_max3_f32 v27, v27, v48, v49
  v_max3_f32 v27, v27, v50, v51
  v_max3_f32 v27, v27, v52, v53
  v_max3_f32 v27, v27, v54, v55
  v_max3_f32 v27, v27, v56, v57
  v_max3_f32 v27, v27, v58, v59
  v_max3_f32 v27, v27, v60, v61
  v_max3_f32 v27, v27, v62, v63
  s_add_u32 s30, s30, 4096
  s_sub_u32 s33, s33, 1
  s_cmp_lg_u32 s33, 0
  s_cbranch_scc1 .fz_kernel_a_s1
  v_mov_b32 v29, v27
  s_nop 1
  v_permlane32_swap_b32 v29, v27
  v_max_f32 v27, v27, v29
  v_sub_f32 v27, 0, v27
  v_mov_b32 v64, v27
  v_mov_b32 v144, 0
  v_mov_b32 v65, v27
  v_mov_b32 v145, 0
  v_mov_b32 v66, v27
  v_mov_b32 v146, 0
  v_mov_b32 v67, v27
  v_mov_b32 v147, 0
  v_mov_b32 v68, v27
  v_mov_b32 v148, 0
  v_mov_b32 v69, v27
  v_mov_b32 v149, 0
  v_mov_b32 v70, v27
  v_mov_b32 v150, 0
  v_mov_b32 v71, v27
  v_mov_b32 v151, 0
  v_mov_b32 v72, v27
  v_mov_b32 v152, 0
  v_mov_b32 v73, v27
  v_mov_b32 v153, 0
  v_mov_b32 v74, v27
  v_mov_b32 v154, 0
  v_mov_b32 v75, v27
  v_mov_b32 v155, 0
  v_mov_b32 v76, v27
  v_mov_b32 v156, 0
  v_mov_b32 v77, v27
  v_mov_b32 v157, 0
  v_mov_b32 v78, v27
  v_mov_b32 v158, 0
  v_mov_b32 v79, v27
  v_mov_b32 v159, 0
  v_mov_b32 v208, 0
  v_mov_b32 v209, 0
  v_mov_b32 v210, 0
  v_mov_b32 v211, 0
  s_mov_b32 s30, s23
  s_mov_b32 s33, 64
.fz_kernel_a_s2:
  buffer_load_dwordx4 v[80:83], v3, s[4:7], s30 offen offset:0
  buffer_load_dwordx4 v[84:87], v3, s[4:7], s30 offen offset:1024
  buffer_load_dwordx4 v[88:91], v3, s[4:7], s30 offen offset:2048
  buffer_load_dwordx4 v[92:95], v3, s[4:7], s30 offen offset:3072
  s_waitcnt vmcnt(0)
  v_mfma_f32_32x32x16_bf16 v[48:63], v[80:83], v[16:19], v[64:79]
  v_mfma_f32_32x32x16_bf16 v[48:63], v[84:87], v[20:23], v[48:63]
  s_nop 11
  v_exp_f32 v48, v48
  v_exp_f32 v49, v49
  v_exp_f32 v50, v50
  v_exp_f32 v51, v51
  v_exp_f32 v52, v52
  v_exp_f32 v53, v53
  v_exp_f32 v54, v54
  v_exp_f32 v55, v55
  v_exp_f32 v56, v56
  v_exp_f32 v57, v57
  v_exp_f32 v58, v58
  v_exp_f32 v59, v59
  v_exp_f32 v60, v60
  v_exp_f32 v61, v61
  v_exp_f32 v62, v62
  v_exp_f32 v63, v63
  v_cvt_pk_bf16_f32 v224, v48, v49
  v_cvt_pk_bf16_f32 v225, v50, v51
  v_cvt_pk_bf16_f32 v226, v52, v53
  v_cvt_pk_bf16_f32 v227, v54, v55
  v_cvt_pk_bf16_f32 v228, v56, v57
  v_cvt_pk_bf16_f32 v229, v58, v59
  v_cvt_pk_bf16_f32 v230, v60, v61
  v_cvt_pk_bf16_f32 v231, v62, v63
  v_mfma_f32_32x32x16_bf16 v[144:159], v[88:91], v[224:227], v[144:159]
  s_nop 0
  v_mfma_f32_32x32x16_bf16 v[144:159], v[92:95], v[228:231], v[144:159]
  v_smfmac_f32_16x16x64_bf16 v[208:211], v[12:15], v[224:231], v11
  s_add_u32 s30, s30, 4096
  s_sub_u32 s33, s33, 1
  s_cmp_lg_u32 s33, 0
  s_cbranch_scc1 .fz_kernel_a_s2
  s_nop 7
  v_add_f32 v208, v208, v210
  v_add_f32 v209, v209, v211
  v_cndmask_b32 v25, v208, v209, s[26:27]
  s_nop 7
  s_setpc_b64 s[68:69]
.fz_kernel_serv:
  s_setprio 3
  s_mov_b32 s24, s44
  s_mov_b32 s25, s45
  s_mov_b32 s26, 0x200000
  s_mov_b32 s27, 0x00020000
  v_lshrrev_b32 v8, 3, v2
  v_and_b32 v9, 7, v2
  v_bfe_u32 v10, v2, 4, 1
  v_lshlrev_b32 v10, 2, v10
  v_xor_b32 v9, v9, v10
  v_lshlrev_b32 v9, 4, v9
  v_lshl_add_u32 v10, v8, 11, v9
  s_cmp_eq_u32 s16, 5
  s_cbranch_scc1 .fz_kernel_sv1
  s_barrier
  v_lshlrev_b32 v7, 7, v2
  s_lshl_b32 s31, s18, 11
  s_lshl_b32 s33, 1, s17
  s_add_u32 s31, s31, s67
  s_add_u32 s31, s31, 0x1800000
  v_mov_b32 v8, s33
  s_mov_b64 exec, 0xffff
  s_mov_b32 s38, 0
.fz_kernel_cw33:
  s_sleep 1
  ds_read_u8 v9, v6 offset:256
  s_add_u32 s38, s38, 1
  s_waitcnt lgkmcnt(0)
  v_cmp_gt_u32 vcc, 4, v9
  s_cbranch_vccz .fz_kernel_cw33d
  s_cmp_lt_u32 s38, 8388608
  s_cbranch_scc1 .fz_kernel_cw33
.fz_kernel_cw33d:
  buffer_atomic_or v8, v7, s[4:7], s31 offen sc1
  s_mov_b64 exec, -1
  s_setprio 0
  s_mov_b32 s38, 0
.fz_kernel_kw34:
  s_sleep 2
  ds_read_b32 v7, v6 offset:0
  s_add_u32 s38, s38, 1
  s_waitcnt lgkmcnt(0)
  v_readfirstlane_b32 s31, v7
  s_bcnt1_i32_b32 s31, s31
  s_cmp_ge_u32 s31, 16
  s_cbranch_scc1 .fz_kernel_kw34d
  s_cmp_lt_u32 s38, 1048576
  s_cbranch_scc1 .fz_kernel_kw34
.fz_kernel_kw34d:
  s_branch .fz_kernel_sv2
.fz_kernel_sv1:
  s_add_u32 s37, s19, s67
  s_mov_b64 exec, 1
  buffer_load_dword v7, v4, s[4:7], s37 offen sc1
  s_waitcnt vmcnt(0)
  ds_or_b32 v6, v7
  buffer_load_dword v9, v4, s[4:7], s37 offen sc1
  s_barrier
  s_waitcnt vmcnt(0)
  ds_or_b32 v6, v9
  s_add_u32 s37, s19, s67
  s_mov_b64 exec, 1
  s_mov_b32 s38, 0
.fz_kernel_po35:
  buffer_load_dword v7, v4, s[4:7], s37 offen offset:0 sc1
  s_add_u32 s38, s38, 1
  s_waitcnt vmcnt(0)
  ds_or_b32 v6, v7 offset:0
  v_cmp_ne_u32 vcc, 0xffff, v7
  s_cbranch_vccz .fz_kernel_po35d
  s_cmp_lt_u32 s38, 131072
  s_cbranch_scc1 .fz_kernel_po35
.fz_kernel_po35d:
  s_mov_b64 exec, -1
  s_setprio 0
  s_mov_b32 s38, 0
.fz_kernel_kw36:
  s_sleep 2
  ds_read_b32 v7, v6 offset:0
  s_add_u32 s38, s38, 1
  s_waitcnt lgkmcnt(0)
  v_readfirstlane_b32 s31, v7
  s_bcnt1_i32_b32 s31, s31
  s_cmp_ge_u32 s31, 16
  s_cbranch_scc1 .fz_kernel_kw36d
  s_cmp_lt_u32 s38, 1048576
  s_cbranch_scc1 .fz_kernel_kw36
.fz_kernel_kw36d:
.fz_kernel_sv2:
  s_and_b32 s30, s16, 1
  s_lshl_b32 s30, s30, 16
  s_add_u32 s32, s30, 65536
  s_lshl_b32 s31, s18, 7
  v_add_u32 v10, s31, v10
.fz_kernel_sv3:
  s_mov_b32 m0, s30
  s_lshl_b32 s31, s30, 4
  s_add_u32 s30, s30, 1024
  buffer_load_dwordx4 v10, s[24:27], s31 offen  lds
  s_cmp_lg_u32 s30, s32
  s_waitcnt vmcnt(3)
  s_cbranch_scc1 .fz_kernel_sv3
  s_cmp_lg_u32 s62, 0
  s_cbranch_scc1 .fz_kernel_wt37
  s_mov_b32 s12, s42
  s_mov_b32 s13, s43
  s_mov_b32 s14, 0x600000
  s_mov_b32 s15, 0x00020000
  s_and_b32 s30, s16, 1
  s_lshl1_add_u32 s30, s17, s30
  s_and_b32 s30, s30, 15
  s_mul_i32 s30, s30, 393216
  s_lshl_b32 s31, s18, 7
  s_add_u32 s30, s30, s31
  v_mul_u32_u24 v11, 6144, v2
  buffer_load_dword v1, v11, s[12:15], s30 offen
  s_add_u32 s30, s30, 2048
  s_waitcnt vmcnt(0)
  buffer_load_dword v1, v11, s[12:15], s30 offen
  s_add_u32 s30, s30, 2048
  s_waitcnt vmcnt(0)
  buffer_load_dword v1, v11, s[12:15], s30 offen
  s_add_u32 s30, s30, 2048
  s_waitcnt vmcnt(0)
.fz_kernel_wt37:
  s_cmp_lg_u32 s16, 4
  s_cbranch_scc1 .fz_kernel_ct38e
  s_getpc_b64 s[0:1]
.fz_kernel_ct38:
  s_sub_u32 s0, s0, .fz_kernel_ct38-fz_kernel
  s_subb_u32 s1, s1, 0
  s_lshr_b32 s31, s2, 3
  s_mulk_i32 s31, 0x500
  v_lshl_add_u32 v1, v2, 7, s31
  v_min_u32 v1, .fz_kernel_last-fz_kernel, v1
  s_mov_b64 exec, 0x3ff
  global_load_dword v1, v1, s[0:1]
  s_mov_b64 exec, -1
.fz_kernel_ct38e:
  s_waitcnt vmcnt(0)
  s_cmp_lg_u32 s16, 5
  s_cbranch_scc1 .fz_kernel_sv35
  s_mov_b64 exec, 1
  s_mov_b32 s38, 0
.fz_kernel_sv34:
  s_sleep 4
  buffer_load_dword v7, v4, s[4:7], s37 offen offset:4 sc1
  ds_read_b32 v8, v6 offset:0x104
  s_add_u32 s38, s38, 1
  s_waitcnt vmcnt(0) lgkmcnt(0)
  ds_or_b32 v6, v7 offset:8
  v_cmp_ne_u32 vcc, 0, v8
  s_cbranch_vccnz .fz_kernel_sv35
  s_cmp_lt_u32 s38, 131072
  s_cbranch_scc1 .fz_kernel_sv34
.fz_kernel_sv35:
  s_mov_b64 exec, -1
  s_setprio 3
  s_barrier
  s_cmp_eq_u32 s16, 5
  s_cbranch_scc1 .fz_kernel_sv4
  v_lshlrev_b32 v7, 11, v2
  s_lshl_b32 s31, s17, 7
  s_lshl_b32 s33, 1, s18
  s_add_u32 s31, s31, s67
  s_add_u32 s31, s31, 0x1800004
  v_mov_b32 v8, s33
  s_mov_b64 exec, 0xffff
  s_mov_b32 s38, 0
.fz_kernel_cw39:
  s_sleep 1
  ds_read_u8 v9, v6 offset:264
  s_add_u32 s38, s38, 1
  s_waitcnt lgkmcnt(0)
  v_cmp_gt_u32 vcc, 4, v9
  s_cbranch_vccz .fz_kernel_cw39d
  s_cmp_lt_u32 s38, 8388608
  s_cbranch_scc1 .fz_kernel_cw39
.fz_kernel_cw39d:
  buffer_atomic_or v8, v7, s[4:7], s31 offen sc1
  s_mov_b64 exec, -1
  s_mov_b64 exec, 1
  ds_or_b32 v6, v8 offset:8
  s_mov_b64 exec, -1
  s_branch .fz_kernel_sv5
.fz_kernel_sv4:
  s_add_u32 s37, s19, s67
  s_mov_b64 exec, 1
  s_mov_b32 s38, 0
.fz_kernel_po40:
  buffer_load_dword v7, v4, s[4:7], s37 offen offset:4 sc1
  s_add_u32 s38, s38, 1
  s_waitcnt vmcnt(0)
  ds_or_b32 v6, v7 offset:8
  v_cmp_ne_u32 vcc, 0xffff, v7
  s_cbranch_vccz .fz_kernel_po40d
  s_cmp_lt_u32 s38, 131072
  s_cbranch_scc1 .fz_kernel_po40
.fz_kernel_po40d:
  s_mov_b64 exec, -1
.fz_kernel_sv5:
  s_mov_b32 s72, s66
  s_mov_b32 s73, s65
  s_mov_b32 s74, s67
  s_mov_b32 s75, s62
  s_cmp_lg_u32 s62, 0
  s_cbranch_scc1 .fz_kernel_w_lt
  s_mov_b32 s62, 1
  s_mov_b32 s63, 0x2000000
  s_mov_b32 s64, 0x2800000
  s_mov_b32 s65, 0x1400000
  s_mov_b32 s66, 0x1c42000
  s_mov_b32 s67, 12
  s_mov_b32 s71, 159776
  v_mov_b32 v6, 159832
  s_branch .fz_kernel_q_prod2
.fz_kernel_w_lt:
  s_barrier
  s_barrier
  s_branch .fz_kernel_fin
.fz_kernel_pk41c:
  s_call_b64 s[68:69], .fz_kernel_pick
  s_branch .fz_kernel_pk41
.fz_kernel_pk42c:
  s_call_b64 s[68:69], .fz_kernel_pick
  s_branch .fz_kernel_pk42
.fz_kernel_pk43c:
  s_call_b64 s[68:69], .fz_kernel_pick
  s_branch .fz_kernel_pk43
.fz_kernel_w_pt:
  v_lshlrev_b32 v44, 5, v17
  v_add_u32 v44, 155648, v44
  s_mov_b64 exec, vcc
  ds_read_b128 v[232:235], v44 offset:7424
  ds_read_b128 v[236:239], v44 offset:7440
  ds_read_b128 v[240:243], v44 offset:7488
  ds_read_b128 v[244:247], v44 offset:7504
  s_waitcnt lgkmcnt(0)
  v_pk_add_f32 v[64:65], v[64:65], v[232:233]
  v_pk_add_f32 v[66:67], v[66:67], v[234:235]
  v_pk_add_f32 v[68:69], v[68:69], v[236:237]
  v_pk_add_f32 v[70:71], v[70:71], v[238:239]
  v_pk_add_f32 v[72:73], v[72:73], v[240:241]
  v_pk_add_f32 v[74:75], v[74:75], v[242:243]
  v_pk_add_f32 v[76:77], v[76:77], v[244:245]
  v_pk_add_f32 v[78:79], v[78:79], v[246:247]
  ds_read_b128 v[232:235], v44 offset:7552
  ds_read_b128 v[236:239], v44 offset:7568
  ds_read_b128 v[240:243], v44 offset:7616
  ds_read_b128 v[244:247], v44 offset:7632
  s_waitcnt lgkmcnt(0)
  v_pk_add_f32 v[80:81], v[80:81], v[232:233]
  v_pk_add_f32 v[82:83], v[82:83], v[234:235]
  v_pk_add_f32 v[84:85], v[84:85], v[236:237]
  v_pk_add_f32 v[86:87], v[86:87], v[238:239]
  v_pk_add_f32 v[88:89], v[88:89], v[240:241]
  v_pk_add_f32 v[90:91], v[90:91], v[242:243]
  v_pk_add_f32 v[92:93], v[92:93], v[244:245]
  v_pk_add_f32 v[94:95], v[94:95], v[246:247]
  s_mov_b64 exec, -1
  s_branch .fz_kernel_w_pb
.fz_kernel_pk44c:
  s_call_b64 s[68:69], .fz_kernel_pick
  s_branch .fz_kernel_pk44
.fz_kernel_pk45c:
  s_call_b64 s[68:69], .fz_kernel_pick
  s_branch .fz_kernel_pk45
.fz_kernel_pk46c:
  s_call_b64 s[68:69], .fz_kernel_pick
  s_branch .fz_kernel_pk46
.fz_kernel_pk47c:
  s_call_b64 s[68:69], .fz_kernel_pick
  s_branch .fz_kernel_pk47
.fz_kernel_pk48c:
  s_call_b64 s[68:69], .fz_kernel_pick
  s_branch .fz_kernel_pk48
.fz_kernel_pk49c:
  s_call_b64 s[68:69], .fz_kernel_pick
  s_branch .fz_kernel_pk49
.fz_kernel_pk50c:
  s_call_b64 s[68:69], .fz_kernel_pick
  s_branch .fz_kernel_pk50
.fz_kernel_pk51c:
  s_call_b64 s[68:69], .fz_kernel_pick
  s_branch .fz_kernel_pk51
.fz_kernel_pk52c:
  s_call_b64 s[68:69], .fz_kernel_pick
  s_branch .fz_kernel_pk52
.fz_kernel_pk53c:
  s_call_b64 s[68:69], .fz_kernel_pick
  s_branch .fz_kernel_pk53
.fz_kernel_pk54c:
  s_call_b64 s[68:69], .fz_kernel_pick
  s_branch .fz_kernel_pk54
.fz_kernel_pk55c:
  s_call_b64 s[68:69], .fz_kernel_pick
  s_branch .fz_kernel_pk55
.fz_kernel_pk56c:
  s_call_b64 s[68:69], .fz_kernel_pick
  s_branch .fz_kernel_pk56
.fz_kernel_pk57c:
  s_call_b64 s[68:69], .fz_kernel_pick
  s_branch .fz_kernel_pk57
.fz_kernel_pk58c:
  s_call_b64 s[68:69], .fz_kernel_pick
  s_branch .fz_kernel_pk58
.fz_kernel_pk59c:
  s_call_b64 s[68:69], .fz_kernel_pick
  s_branch .fz_kernel_pk59
.fz_kernel_c_nl:
  s_barrier
  s_branch .fz_kernel_c_np
.fz_kernel_c_c7:
  s_mov_b32 s38, 0
.fz_kernel_cw64:
  s_sleep 1
  ds_read_u8 v22, v6 offset:272
  s_add_u32 s38, s38, 1
  s_waitcnt lgkmcnt(0)
  v_cmp_gt_u32 vcc, 2, v22
  s_cbranch_vccz .fz_kernel_cw64d
  s_cmp_lt_u32 s38, 8388608
  s_cbranch_scc1 .fz_kernel_cw64
.fz_kernel_cw64d:
  ds_read_b64_tr_b16 v[32:33], v7 offset:0
  ds_read_b64_tr_b16 v[34:35], v7 offset:512
  ds_read_b64_tr_b16 v[36:37], v13 offset:0
  ds_read_b64_tr_b16 v[38:39], v13 offset:512
  ds_read_b64_tr_b16 v[40:41], v7 offset:4096
  ds_read_b64_tr_b16 v[42:43], v7 offset:4608
  ds_read_b64_tr_b16 v[44:45], v13 offset:4096
  ds_read_b64_tr_b16 v[46:47], v13 offset:4608
  ds_read_b64_tr_b16 v[48:49], v7 offset:8192
  ds_read_b64_tr_b16 v[50:51], v7 offset:8704
  ds_read_b64_tr_b16 v[52:53], v13 offset:8192
  ds_read_b64_tr_b16 v[54:55], v13 offset:8704
  s_waitcnt lgkmcnt(0)
  ds_read_b64_tr_b16 v[56:57], v7 offset:12288
  ds_read_b64_tr_b16 v[58:59], v7 offset:12800
  ds_read_b64_tr_b16 v[60:61], v13 offset:12288
  ds_read_b64_tr_b16 v[62:63], v13 offset:12800
  ds_read_b64_tr_b16 v[64:65], v7 offset:16384
  ds_read_b64_tr_b16 v[66:67], v7 offset:16896
  ds_read_b64_tr_b16 v[68:69], v13 offset:16384
  ds_read_b64_tr_b16 v[70:71], v13 offset:16896
  ds_read_b64_tr_b16 v[72:73], v7 offset:20480
  ds_read_b64_tr_b16 v[74:75], v7 offset:20992
  ds_read_b64_tr_b16 v[76:77], v13 offset:20480
  ds_read_b64_tr_b16 v[78:79], v13 offset:20992
  s_waitcnt lgkmcnt(0)
  s_branch .fz_kernel_c_c2
.fz_kernel_c_coef:
  v_fma_f32 v242, -v240, v240, v242
  v_fma_f32 v243, -v241, v241, v243
  v_rsq_f32 v248, abs(v242)
  v_rsq_f32 v249, abs(v243)
  v_mul_f32 v254, v240, v248
  v_sub_f32 v254, 0, v254
  v_mov_b32 v252, 1.0
  v_fmac_f32 v252, 0x44800000, v248
  v_fma_f32 v242, v242, v24, -v25
  v_max_f32 v242, 0, v242
  v_mul_f32 v248, v252, v252
  v_fma_f32 v248, v248, v242, v25
  v_rsq_f32 v248, v248
  v_mul_f32 v240, v23, v240
  v_mul_f32 v248, v248, v252
  v_mul_f32 v250, v248, v240
  v_sub_f32 v250, 0, v250
  v_mul_f32 v255, v241, v249
  v_sub_f32 v255, 0, v255
  v_mov_b32 v253, 1.0
  v_fmac_f32 v253, 0x44800000, v249
  s_cmp_eq_u32 s3, 0
  s_cbranch_scc1 .fz_kernel_hb71
  s_barrier
  s_sub_u32 s3, s3, 1
.fz_kernel_hb71:
  v_fma_f32 v243, v243, v24, -v25
  v_max_f32 v243, 0, v243
  v_mul_f32 v249, v253, v253
  v_fma_f32 v249, v249, v243, v25
  v_rsq_f32 v249, v249
  v_mul_f32 v241, v23, v241
  v_mul_f32 v249, v249, v253
  v_mul_f32 v251, v249, v241
  v_sub_f32 v251, 0, v251
  s_setpc_b64 s[68:69]
.fz_kernel_c_gur:
  v_min_u32 v9, v144, v146
  v_cmp_eq_u32 s[8:9], 0, v9
  v_min_u32 v9, v148, v150
  v_cmp_eq_u32 s[10:11], 0, v9
  v_min_u32 v9, v152, v154
  v_cmp_eq_u32 s[12:13], 0, v9
  v_min_u32 v9, v156, v158
  v_cmp_eq_u32 s[14:15], 0, v9
  s_add_u32 s38, s38, 1
  s_cmp_ge_u32 s38, 131072
  s_cbranch_scc1 .fz_kernel_c_gud
  s_or_b64 exec, s[8:9], 1
  buffer_load_dwordx4 v[144:147], v21, s[4:7], s21 offen offset:0 sc1
  s_or_b64 exec, s[10:11], 1
  buffer_load_dwordx4 v[148:151], v21, s[4:7], s21 offen offset:512 sc1
  s_or_b64 exec, s[12:13], 1
  buffer_load_dwordx4 v[152:155], v21, s[4:7], s21 offen offset:1024 sc1
  s_or_b64 exec, s[14:15], 1
  buffer_load_dwordx4 v[156:159], v21, s[4:7], s21 offen offset:1536 sc1
  s_mov_b64 exec, -1
  s_branch .fz_kernel_c_gu
.fz_kernel_c_pur:
  v_min3_u32 v9, v144, v146, v148
  v_min_u32 v9, v9, v150
  v_cmp_eq_u32 s[8:9], 0, v9
  v_min3_u32 v9, v152, v154, v156
  v_min_u32 v9, v9, v158
  v_cmp_eq_u32 s[10:11], 0, v9
  v_min3_u32 v9, v160, v162, v164
  v_min_u32 v9, v9, v166
  v_cmp_eq_u32 s[12:13], 0, v9
  v_min3_u32 v9, v168, v170, v172
  v_min_u32 v9, v9, v174
  v_cmp_eq_u32 s[14:15], 0, v9
  s_cmp_eq_u32 s3, 0
  s_cbranch_scc1 .fz_kernel_hb75
  s_barrier
  s_sub_u32 s3, s3, 1
.fz_kernel_hb75:
  s_add_u32 s38, s38, 1
  s_cmp_ge_u32 s38, 131072
  s_cbranch_scc1 .fz_kernel_c_pud
  s_and_b64 exec, s[8:9], -1
  s_cbranch_scc0 .fz_kernel_c_ps0
  buffer_load_dwordx4 v[144:147], v10, s[4:7], s21 offen offset:0 sc1
  buffer_load_dwordx4 v[148:151], v10, s[4:7], s21 offen offset:16 sc1
.fz_kernel_c_ps0:
  s_and_b64 exec, s[10:11], -1
  s_cbranch_scc0 .fz_kernel_c_ps1
  buffer_load_dwordx4 v[152:155], v10, s[4:7], s21 offen offset:2048 sc1
  buffer_load_dwordx4 v[156:159], v10, s[4:7], s21 offen offset:2064 sc1
.fz_kernel_c_ps1:
  s_and_b64 exec, s[12:13], -1
  s_cbranch_scc0 .fz_kernel_c_ps2
  buffer_load_dwordx4 v[160:163], v10, s[4:7], s22 offen offset:0 sc1
  buffer_load_dwordx4 v[164:167], v10, s[4:7], s22 offen offset:16 sc1
.fz_kernel_c_ps2:
  s_and_b64 exec, s[14:15], -1
  s_cbranch_scc0 .fz_kernel_c_ps3
  buffer_load_dwordx4 v[168:171], v10, s[4:7], s22 offen offset:2048 sc1
  buffer_load_dwordx4 v[172:175], v10, s[4:7], s22 offen offset:2064 sc1
.fz_kernel_c_ps3:
  s_mov_b64 exec, -1
  s_branch .fz_kernel_c_pu
.fz_kernel_last:
  s_endpgm

.section .rodata,"a"
.p2align 6
.amdhsa_kernel fz_kernel
  .amdhsa_next_free_vgpr 256
  .amdhsa_next_free_sgpr 102
  .amdhsa_accum_offset 256
  .amdhsa_group_segment_fixed_size 0
  .amdhsa_kernarg_size 88
  .amdhsa_user_sgpr_count 2
  .amdhsa_user_sgpr_kernarg_segment_ptr 1
  .amdhsa_system_sgpr_workgroup_id_x 1
.end_amdhsa_kernel
```

```asm
; @launch kernel=fz_kernel grid=(256,1,1) block=(512,1,1) lds=163840
.amdgcn_target "amdgcn-amd-amdhsa--gfx950"
.text
.globl fz_kernel
.p2align 8
.type fz_kernel,@function
fz_kernel:
  s_cmp_ge_u32 s2, 256
  s_cbranch_scc1 .fz_kernel_end
  s_load_dwordx2 s[8:9], s[0:1], 0
  s_load_dwordx2 s[12:13], s[0:1], 8
  s_load_dwordx2 s[4:5], s[0:1], 80
  s_load_dwordx16 s[40:55], s[0:1], 0
  s_load_dwordx4 s[56:59], s[0:1], 64
  v_lshrrev_b32 v1, 6, v0
  v_and_b32 v2, 63, v0
  v_readfirstlane_b32 s16, v1
  s_and_b32 s21, s2, 7
  s_lshr_b32 s22, s2, 3
  s_and_b32 s23, s21, 3
  s_lshl_b32 s23, s23, 2
  s_and_b32 s24, s22, 3
  s_add_u32 s18, s23, s24
  s_lshr_b32 s24, s21, 2
  s_lshl_b32 s24, s24, 3
  s_lshr_b32 s25, s22, 2
  s_add_u32 s17, s24, s25
  s_lshl_b32 s19, s18, 4
  s_add_u32 s19, s19, s17
  s_lshl_b32 s19, s19, 7
  s_add_u32 s19, s19, 0x1800000
  v_lshlrev_b32 v3, 4, v2
  v_mov_b32 v4, 0
  v_mov_b32 v5, 1
  s_mov_b32 s6, 0x2c00000
  s_mov_b32 s7, 0x00020000
  s_mov_b32 s62, 0
  s_mov_b32 s63, 0x400000
  s_mov_b32 s64, 0xc00000
  s_mov_b32 s65, 0x1000000
  s_mov_b32 s66, 0x1c00000
  s_mov_b32 s67, 0
  s_mov_b32 s71, 159744
  v_mov_b32 v6, 159808
  s_cmp_lt_u32 s16, 4
  s_cbranch_scc1 .fz_kernel_q_cons1
  s_cmp_ge_u32 s16, 6
  s_cbranch_scc1 .fz_kernel_q_help1
  s_mov_b32 s10, 0x400000
  s_mov_b32 s11, 0x00020000
  v_lshrrev_b32 v20, 3, v2
  v_and_b32 v21, 7, v2
  v_lshrrev_b32 v22, 4, v2
  v_xor_b32 v23, v21, v22
  v_lshlrev_b32 v23, 4, v23
  v_lshl_add_u32 v24, v20, 11, v23
  v_xor_b32 v25, 64, v24
  s_lshl_b32 s35, s17, 2
  s_and_b32 s31, s16, 1
  s_add_u32 s35, s35, s31
  s_lshl_b32 s35, s35, 16
  s_and_b32 s29, s18, 12
  s_lshr_b32 s33, s17, 3
  s_lshl1_add_u32 s29, s33, s29
  s_lshl2_add_u32 s29, s17, s29
  s_and_b32 s29, s29, 15
  s_mov_b32 s22, 128
  s_mov_b32 s23, 131072
  s_mov_b32 s36, -1
  v_add_u32 v40, 0, v24
  v_add_u32 v41, 15360, v25
  v_add_u32 v42, 30720, v24
  v_add_u32 v43, 46080, v25
.fz_kernel_q_pc:
  s_mov_b32 s14, 0x600000
  s_mov_b32 s15, 0x00020000
  v_lshrrev_b32 v28, 3, v2
  v_and_b32 v29, 7, v2
  v_bfe_u32 v30, v2, 4, 1
  v_lshlrev_b32 v30, 1, v30
  v_xor_b32 v31, v29, v30
  v_lshlrev_b32 v31, 4, v31
  v_mul_u32_u24 v28, 6144, v28
  v_add_u32 v28, v28, v31
  v_xor_b32 v29, 64, v28
  s_lshl_b32 s32, s18, 7
  s_add_u32 s39, s32, 6291456
  s_mul_i32 s33, s29, 393216
  s_add_u32 s33, s33, s32
  s_lshl_b32 s29, s29, 1
  s_mul_i32 s25, s31, 6144
  s_add_u32 s25, s25, 65536
  s_mov_b32 s30, s25
  s_add_u32 s26, s25, 49152
  s_lshl_b32 s21, s31, 12
  s_cmp_eq_u32 s31, 0
  s_mov_b32 s24, 100352
  s_cselect_b32 s24, 0, s24
  v_add_u32 v32, s24, v28
  s_mov_b32 s24, 148480
  s_cselect_b32 s24, 48128, s24
  v_add_u32 v33, s24, v29
  s_mov_b32 s24, 2048
  s_cselect_b32 s24, 96256, s24
  v_add_u32 v34, s24, v28
  s_mov_b32 s24, 50176
  s_cselect_b32 s24, 144384, s24
  v_add_u32 v35, s24, v29
  s_mov_b32 s24, 102400
  s_cselect_b32 s24, 2048, s24
  v_add_u32 v36, s24, v28
  s_mov_b32 s24, 150528
  s_cselect_b32 s24, 50176, s24
  v_add_u32 v37, s24, v29
  s_cmp_lg_u32 s62, 0
  s_cbranch_scc1 .fz_kernel_q_st2
  s_waitcnt lgkmcnt(0)
  s_mov_b32 s34, 32
  s_call_b64 s[0:1], .fz_kernel_q_ix
  s_call_b64 s[0:1], .fz_kernel_q_iu
  s_call_b64 s[0:1], .fz_kernel_q_iu
  s_call_b64 s[0:1], .fz_kernel_q_iu
  s_waitcnt vmcnt(20)
  s_barrier
  s_call_b64 s[0:1], .fz_kernel_q_iu
  s_waitcnt vmcnt(24)
  s_barrier
  s_call_b64 s[0:1], .fz_kernel_q_iu
  s_branch .fz_kernel_q_pl
.fz_kernel_q_ix:
  s_bfe_u32 s24, s29, 0x40001
  s_mul_i32 s20, s24, s22
  s_bitcmp1_b32 s29, 0
  s_cselect_b32 s31, s23, 0
  s_add_u32 s20, s20, s35
  s_add_u32 s20, s20, s31
  s_bitcmp1_b32 s36, s24
  s_cbranch_scc0 .fz_kernel_xok1w
.fz_kernel_xok1:
  s_mov_b32 m0, s21
  s_add_u32 s21, s21, 8192
  s_and_b32 s21, s21, 0xffff
  s_add_u32 s29, s29, 1
  buffer_load_dwordx4 v40, s[8:11], s20 offen offset:0 lds
  buffer_load_dwordx4 v41, s[8:11], s20 offen offset:1024 lds
  buffer_load_dwordx4 v42, s[8:11], s20 offen offset:2048 lds
  buffer_load_dwordx4 v43, s[8:11], s20 offen offset:3072 lds
  s_setpc_b64 s[0:1]
.fz_kernel_q_iu:
  s_mov_b32 m0, s30
  s_add_u32 s30, s30, 12288
  buffer_load_dwordx4 v32, s[12:15], s33 offen offset:0 lds
  s_bfe_u32 s24, s29, 0x40001
  buffer_load_dwordx4 v33, s[12:15], s33 offen offset:1024 lds
  s_mul_i32 s20, s24, s22
  buffer_load_dwordx4 v34, s[12:15], s33 offen offset:2048 lds
  s_bitcmp1_b32 s29, 0
  s_cselect_b32 s31, s23, 0
  buffer_load_dwordx4 v35, s[12:15], s33 offen offset:3072 lds
  s_add_u32 m0, m0, 4096
  s_add_u32 s20, s20, s35
  buffer_load_dwordx4 v36, s[12:15], s33 offen offset:0 lds
  s_add_u32 s20, s20, s31
  buffer_load_dwordx4 v37, s[12:15], s33 offen offset:1024 lds
  s_bitcmp1_b32 s36, s24
  s_cbranch_scc0 .fz_kernel_xok2w
.fz_kernel_xok2:
  s_mov_b32 m0, s21
  s_add_u32 s21, s21, 8192
  s_and_b32 s21, s21, 0xffff
  s_add_u32 s29, s29, 1
  buffer_load_dwordx4 v40, s[8:11], s20 offen offset:0 lds
  s_add_u32 s33, s33, 196608
  s_cmp_eq_u32 s33, s39
  s_cselect_b32 s33, s32, s33
  buffer_load_dwordx4 v41, s[8:11], s20 offen offset:1024 lds
  s_cmp_eq_u32 s30, s26
  s_cselect_b32 s30, s25, s30
  buffer_load_dwordx4 v42, s[8:11], s20 offen offset:2048 lds
  s_sub_u32 s34, s34, 1
  s_cmp_lg_u32 s34, 0
  buffer_load_dwordx4 v43, s[8:11], s20 offen offset:3072 lds
  s_setpc_b64 s[0:1]
.fz_kernel_q_iw:
  s_mov_b32 m0, s30
  s_add_u32 s30, s30, 12288
  buffer_load_dwordx4 v32, s[12:15], s33 offen offset:0 lds
  s_nop 0
  buffer_load_dwordx4 v33, s[12:15], s33 offen offset:1024 lds
  s_nop 0
  buffer_load_dwordx4 v34, s[12:15], s33 offen offset:2048 lds
  s_nop 0
  buffer_load_dwordx4 v35, s[12:15], s33 offen offset:3072 lds
  s_add_u32 m0, m0, 4096
  s_nop 0
  buffer_load_dwordx4 v36, s[12:15], s33 offen offset:0 lds
  buffer_load_dwordx4 v37, s[12:15], s33 offen offset:1024 lds
  s_add_u32 s33, s33, 196608
  s_cmp_eq_u32 s33, s39
  s_cselect_b32 s33, s32, s33
  s_cmp_eq_u32 s30, s26
  s_cselect_b32 s30, s25, s30
  s_sub_u32 s34, s34, 1
  s_cmp_lg_u32 s34, 0
  s_setpc_b64 s[0:1]
.fz_kernel_q_st2:
  s_mov_b32 s34, 32
  s_waitcnt vmcnt(0)
  s_barrier
  s_call_b64 s[0:1], .fz_kernel_q_iw
  s_call_b64 s[0:1], .fz_kernel_q_iw
  s_call_b64 s[0:1], .fz_kernel_q_iw
  s_call_b64 s[0:1], .fz_kernel_q_iw
  s_call_b64 s[0:1], .fz_kernel_q_ix
  s_call_b64 s[0:1], .fz_kernel_q_ix
  s_mov_b64 exec, 1
  s_waitcnt vmcnt(20)
  ds_add_u32 v6, v5 offset:0x110
  s_mov_b64 exec, -1
  v_mov_b32 v12, 0x100
  s_call_b64 s[0:1], .fz_kernel_q_ix
  s_call_b64 s[0:1], .fz_kernel_q_ix
  s_waitcnt vmcnt(8)
  s_mov_b64 exec, 1
  ds_add_u32 v6, v12 offset:0x110
  s_mov_b64 exec, -1
  s_barrier
  s_waitcnt vmcnt(8)
  s_barrier
  s_call_b64 s[0:1], .fz_kernel_q_ix
  s_call_b64 s[0:1], .fz_kernel_q_iu
  s_waitcnt vmcnt(14)
  s_barrier
  s_call_b64 s[0:1], .fz_kernel_q_iu
  s_waitcnt vmcnt(20)
  s_barrier
  s_call_b64 s[0:1], .fz_kernel_q_iu
.fz_kernel_q_pl:
  s_waitcnt vmcnt(20)
  s_barrier
  s_mov_b32 m0, s30
  s_add_u32 s30, s30, 12288
  buffer_load_dwordx4 v32, s[12:15], s33 offen offset:0 lds
  s_bfe_u32 s24, s29, 0x40001
  buffer_load_dwordx4 v33, s[12:15], s33 offen offset:1024 lds
  s_mul_i32 s20, s24, s22
  buffer_load_dwordx4 v34, s[12:15], s33 offen offset:2048 lds
  s_bitcmp1_b32 s29, 0
  s_cselect_b32 s31, s23, 0
  buffer_load_dwordx4 v35, s[12:15], s33 offen offset:3072 lds
  s_add_u32 m0, m0, 4096
  s_add_u32 s20, s20, s35
  buffer_load_dwordx4 v36, s[12:15], s33 offen offset:0 lds
  s_add_u32 s20, s20, s31
  buffer_load_dwordx4 v37, s[12:15], s33 offen offset:1024 lds
  s_bitcmp1_b32 s36, s24
  s_cbranch_scc0 .fz_kernel_xok3w
.fz_kernel_xok3:
  s_mov_b32 m0, s21
  s_add_u32 s21, s21, 8192
  s_and_b32 s21, s21, 0xffff
  s_add_u32 s29, s29, 1
  buffer_load_dwordx4 v40, s[8:11], s20 offen offset:0 lds
  s_add_u32 s33, s33, 196608
  s_cmp_eq_u32 s33, s39
  s_cselect_b32 s33, s32, s33
  buffer_load_dwordx4 v41, s[8:11], s20 offen offset:1024 lds
  s_cmp_eq_u32 s30, s26
  s_cselect_b32 s30, s25, s30
  buffer_load_dwordx4 v42, s[8:11], s20 offen offset:2048 lds
  s_sub_u32 s34, s34, 1
  s_cmp_lg_u32 s34, 0
  buffer_load_dwordx4 v43, s[8:11], s20 offen offset:3072 lds
  s_cbranch_scc1 .fz_kernel_q_pl
  s_waitcnt vmcnt(20)
  s_barrier
  s_waitcnt vmcnt(10)
  s_barrier
  s_waitcnt vmcnt(0)
  s_barrier
  s_barrier
  s_branch .fz_kernel_serv
.fz_kernel_q_cons1:
  s_waitcnt lgkmcnt(0)
  s_mov_b32 s12, s42
  s_mov_b32 s13, s43
  s_mov_b32 s14, 0x600000
  s_mov_b32 s15, 0x00020000
  s_and_b32 s20, s18, 4
  s_add_u32 s20, s20, s16
  s_cmp_ge_u32 s20, 3
  s_cbranch_scc1 .fz_kernel_q_nsp
  s_and_b32 s20, s17, 7
  s_and_b32 s21, s18, 3
  s_lshl2_add_u32 s20, s20, s21
  s_mul_i32 s20, s20, 196608
  s_or_b32 s21, s18, 3
  s_lshl4_add_u32 s21, s16, s21
  s_lshl_b32 s21, s21, 7
  s_add_u32 s20, s20, s21
  v_mul_u32_u24 v20, 6144, v2
  s_mov_b32 exec_hi, 0
  buffer_load_dword v231, v20, s[12:15], s20 offen
  s_mov_b32 exec_hi, -1
.fz_kernel_q_nsp:
  v_lshlrev_b32 v20, 2, v0
  v_add_u32 v20, 159744, v20
  s_cmp_ge_u32 s16, 2
  s_cbranch_scc1 .fz_kernel_q_nz
  ds_write_b32 v20, v4
.fz_kernel_q_nz:
  s_lshr_b32 s26, s16, 1
  s_lshl_b32 s28, s26, 13
  v_and_b32 v20, 15, v2
  v_lshrrev_b32 v21, 4, v2
  v_bfe_u32 v22, v2, 1, 3
  v_xor_b32 v22, v22, v21
  v_lshlrev_b32 v20, 7, v20
  v_lshl_add_u32 v20, v22, 4, v20
  v_add_u32 v8, s28, v20
  v_xor_b32 v9, 64, v8
.fz_kernel_q_cs:
  s_and_b32 s27, s16, 1
  s_lshl_b32 s28, s27, 1
  v_lshrrev_b32 v14, 4, v2
  v_bfe_u32 v15, v2, 2, 2
  v_lshl_add_u32 v16, v14, 3, v15
  v_lshlrev_b32 v16, 7, v16
  v_and_b32 v14, 1, v14
  v_lshrrev_b32 v15, 1, v15
  v_lshl_add_u32 v14, v14, 1, v15
  v_xor_b32 v14, s28, v14
  v_lshl_add_u32 v16, v14, 5, v16
  v_and_b32 v14, 3, v2
  v_lshl_add_u32 v16, v14, 3, v16
  v_add_u32 v12, 65536, v16
  v_xor_b32 v13, 32, v12
  v_mov_b32 v10, v12
  v_mov_b32 v11, v13
  s_mov_b32 s29, 16
  s_mov_b32 s30, 0
  v_mov_b32 v128, 0
  v_mov_b32 v129, 0
  v_mov_b32 v130, 0
  v_mov_b32 v131, 0
  v_mov_b32 v132, 0
  v_mov_b32 v133, 0
  v_mov_b32 v134, 0
  v_mov_b32 v135, 0
  v_mov_b32 v136, 0
  v_mov_b32 v137, 0
  v_mov_b32 v138, 0
  v_mov_b32 v139, 0
  v_mov_b32 v140, 0
  v_mov_b32 v141, 0
  v_mov_b32 v142, 0
  v_mov_b32 v143, 0
  v_mov_b32 v144, 0
  v_mov_b32 v145, 0
  v_mov_b32 v146, 0
  v_mov_b32 v147, 0
  v_mov_b32 v148, 0
  v_mov_b32 v149, 0
  v_mov_b32 v150, 0
  v_mov_b32 v151, 0
  v_mov_b32 v152, 0
  v_mov_b32 v153, 0
  v_mov_b32 v154, 0
  v_mov_b32 v155, 0
  v_mov_b32 v156, 0
  v_mov_b32 v157, 0
  v_mov_b32 v158, 0
  v_mov_b32 v159, 0
  v_mov_b32 v160, 0
  v_mov_b32 v161, 0
  v_mov_b32 v162, 0
  v_mov_b32 v163, 0
  v_mov_b32 v164, 0
  v_mov_b32 v165, 0
  v_mov_b32 v166, 0
  v_mov_b32 v167, 0
  v_mov_b32 v168, 0
  v_mov_b32 v169, 0
  v_mov_b32 v170, 0
  v_mov_b32 v171, 0
  v_mov_b32 v172, 0
  v_mov_b32 v173, 0
  v_mov_b32 v174, 0
  v_mov_b32 v175, 0
  s_cmp_eq_u32 s62, 0
  s_cbranch_scc1 .fz_kernel_q_i1
  s_mov_b64 exec, 1
  s_waitcnt vmcnt(0)
  ds_add_u32 v1, v5 offset:0x100
  s_mov_b64 exec, -1
.fz_kernel_q_i1:
  v_mov_b32 v176, 0
  v_mov_b32 v177, 0
  v_mov_b32 v178, 0
  v_mov_b32 v179, 0
  v_mov_b32 v180, 0
  v_mov_b32 v181, 0
  v_mov_b32 v182, 0
  v_mov_b32 v183, 0
  v_mov_b32 v184, 0
  v_mov_b32 v185, 0
  v_mov_b32 v186, 0
  v_mov_b32 v187, 0
  v_mov_b32 v188, 0
  v_mov_b32 v189, 0
  v_mov_b32 v190, 0
  v_mov_b32 v191, 0
  v_mov_b32 v192, 0
  v_mov_b32 v193, 0
  v_mov_b32 v194, 0
  v_mov_b32 v195, 0
  v_mov_b32 v196, 0
  v_mov_b32 v197, 0
  v_mov_b32 v198, 0
  v_mov_b32 v199, 0
  v_mov_b32 v200, 0
  v_mov_b32 v201, 0
  v_mov_b32 v202, 0
  v_mov_b32 v203, 0
  v_mov_b32 v204, 0
  v_mov_b32 v205, 0
  v_mov_b32 v206, 0
  v_mov_b32 v207, 0
  v_mov_b32 v208, 0
  v_mov_b32 v209, 0
  v_mov_b32 v210, 0
  v_mov_b32 v211, 0
  v_mov_b32 v212, 0
  v_mov_b32 v213, 0
  v_mov_b32 v214, 0
  v_mov_b32 v215, 0
  v_mov_b32 v216, 0
  v_mov_b32 v217, 0
  v_mov_b32 v218, 0
  v_mov_b32 v219, 0
  v_mov_b32 v220, 0
  v_mov_b32 v221, 0
  v_mov_b32 v222, 0
  v_mov_b32 v223, 0
  v_and_b32 v14, 1, v2
  v_lshlrev_b32 v14, 4, v14
  v_mov_b32 v15, 0x3f80
  v_lshlrev_b32 v14, v14, v15
  v_mov_b32 v248, 0
  v_mov_b32 v249, 0
  v_mov_b32 v250, 0
  v_mov_b32 v251, 0
  v_mov_b32 v252, 0
  v_mov_b32 v253, 0
  v_mov_b32 v254, 0
  v_mov_b32 v255, 0
  s_mov_b32 exec_lo, 0x3
  s_mov_b32 exec_hi, 0x30
  v_mov_b32 v248, v14
  s_mov_b32 exec_lo, 0xc
  s_mov_b32 exec_hi, 0xc0
  v_mov_b32 v249, v14
  s_mov_b32 exec_lo, 0x300
  s_mov_b32 exec_hi, 0x3000
  v_mov_b32 v250, v14
  s_mov_b32 exec_lo, 0xc00
  s_mov_b32 exec_hi, 0xc000
  v_mov_b32 v251, v14
  s_mov_b32 exec_lo, 0x30000
  s_mov_b32 exec_hi, 0x300000
  v_mov_b32 v252, v14
  s_mov_b32 exec_lo, 0xc0000
  s_mov_b32 exec_hi, 0xc00000
  v_mov_b32 v253, v14
  s_mov_b32 exec_lo, 0x3000000
  s_mov_b32 exec_hi, 0x30000000
  v_mov_b32 v254, v14
  s_mov_b32 exec_lo, 0xc000000
  s_mov_b32 exec_hi, 0xc0000000
  v_mov_b32 v255, v14
  s_mov_b64 exec, -1
  s_mov_b32 s12, s40
  s_mov_b32 s13, s41
  s_mov_b32 s14, 0x400000
  s_mov_b32 s15, 0x00020000
  v_lshrrev_b32 v14, 5, v2
  v_and_b32 v15, 31, v2
  v_lshlrev_b32 v14, 4, v14
  v_lshl_add_u32 v15, v15, 11, v14
  s_lshl2_add_u32 s23, s17, s16
  s_lshl_b32 s23, s23, 16
  s_lshl_b32 s22, s18, 7
  s_add_u32 s23, s22, s23
  s_waitcnt lgkmcnt(0)
  s_barrier
  ds_read_b64_tr_b16 v[56:57], v10 offset:4096
  ds_read_b64_tr_b16 v[58:59], v10 offset:4608
  ds_read_b128 v[32:35], v8 offset:0
  ds_read_b128 v[36:39], v8 offset:2048
  ds_read_b128 v[40:43], v8 offset:4096
  ds_read_b128 v[44:47], v8 offset:6144
  ds_read_b64_tr_b16 v[60:61], v11 offset:4096
  ds_read_b64_tr_b16 v[62:63], v11 offset:4608
  ds_read_b64_tr_b16 v[64:65], v10 offset:8192
  ds_read_b64_tr_b16 v[66:67], v10 offset:8704
  ds_read_b64_tr_b16 v[68:69], v11 offset:8192
  ds_read_b64_tr_b16 v[70:71], v11 offset:8704
  ds_read_b64_tr_b16 v[48:49], v10 offset:0
  ds_read_b64_tr_b16 v[50:51], v10 offset:512
  ds_read_b64_tr_b16 v[52:53], v11 offset:0
  ds_read_b64_tr_b16 v[54:55], v11 offset:512
  s_add_u32 s30, s30, 12288
  s_cmp_eq_u32 s30, 49152
  s_cselect_b32 s30, 0, s30
  v_add_u32 v8, 0x4000, v8
  v_add_u32 v10, s30, v12
  v_add_u32 v11, s30, v13
  v_and_b32 v8, 0xffff, v8
  s_waitcnt lgkmcnt(0)
  s_branch .fz_kernel_q_l0
  .p2align 6
.fz_kernel_q_loop:
  v_mfma_f32_16x16x32_bf16 v[148:151], v[52:55], v[36:39], v[148:151]
  v_mfma_f32_16x16x32_bf16 v[152:155], v[52:55], v[40:43], v[152:155]
  s_waitcnt lgkmcnt(0)
  v_mfma_f32_16x16x32_bf16 v[156:159], v[52:55], v[44:47], v[156:159]
  s_barrier
  v_mfma_f32_16x16x32_bf16 v[160:163], v[96:99], v[72:75], v[160:163]
  ds_read_b64_tr_b16 v[56:57], v10 offset:4096
  v_mfma_f32_16x16x32_bf16 v[164:167], v[96:99], v[76:79], v[164:167]
  ds_read_b64_tr_b16 v[58:59], v10 offset:4608
  v_mfma_f32_16x16x32_bf16 v[168:171], v[96:99], v[80:83], v[168:171]
  ds_read_b128 v[32:35], v8 offset:0
  v_mfma_f32_16x16x32_bf16 v[172:175], v[96:99], v[84:87], v[172:175]
  ds_read_b128 v[36:39], v8 offset:2048
  v_mfma_f32_16x16x32_bf16 v[176:179], v[100:103], v[72:75], v[176:179]
  ds_read_b128 v[40:43], v8 offset:4096
  v_mfma_f32_16x16x32_bf16 v[180:183], v[100:103], v[76:79], v[180:183]
  ds_read_b128 v[44:47], v8 offset:6144
  v_mfma_f32_16x16x32_bf16 v[184:187], v[100:103], v[80:83], v[184:187]
  ds_read_b64_tr_b16 v[60:61], v11 offset:4096
  v_mfma_f32_16x16x32_bf16 v[188:191], v[100:103], v[84:87], v[188:191]
  ds_read_b64_tr_b16 v[62:63], v11 offset:4608
  v_mfma_f32_16x16x32_bf16 v[192:195], v[72:75], v[104:107], v[192:195]
  ds_read_b64_tr_b16 v[64:65], v10 offset:8192
  s_add_u32 s30, s30, 12288
  v_mfma_f32_16x16x32_bf16 v[196:199], v[76:79], v[104:107], v[196:199]
  ds_read_b64_tr_b16 v[66:67], v10 offset:8704
  s_cmp_eq_u32 s30, 49152
  v_mfma_f32_16x16x32_bf16 v[200:203], v[80:83], v[104:107], v[200:203]
  ds_read_b64_tr_b16 v[68:69], v11 offset:8192
  s_cselect_b32 s30, 0, s30
  v_mfma_f32_16x16x32_bf16 v[204:207], v[84:87], v[104:107], v[204:207]
  ds_read_b64_tr_b16 v[70:71], v11 offset:8704
  v_mfma_f32_16x16x32_bf16 v[208:211], v[72:75], v[108:111], v[208:211]
  ds_read_b64_tr_b16 v[48:49], v10 offset:0
  v_mfma_f32_16x16x32_bf16 v[212:215], v[76:79], v[108:111], v[212:215]
  ds_read_b64_tr_b16 v[50:51], v10 offset:512
  v_mfma_f32_16x16x32_bf16 v[216:219], v[80:83], v[108:111], v[216:219]
  ds_read_b64_tr_b16 v[52:53], v11 offset:0
  v_mfma_f32_16x16x32_bf16 v[220:223], v[84:87], v[108:111], v[220:223]
  ds_read_b64_tr_b16 v[54:55], v11 offset:512
  v_mfma_f32_16x16x32_bf16 v[128:131], v[88:91], v[72:75], v[128:131]
  v_add_u32 v8, 0x4000, v8
  v_mfma_f32_16x16x32_bf16 v[132:135], v[88:91], v[76:79], v[132:135]
  v_add_u32 v10, s30, v12
  v_mfma_f32_16x16x32_bf16 v[136:139], v[88:91], v[80:83], v[136:139]
  v_add_u32 v11, s30, v13
  v_mfma_f32_16x16x32_bf16 v[140:143], v[88:91], v[84:87], v[140:143]
  v_and_b32 v8, 0xffff, v8
  v_mfma_f32_16x16x32_bf16 v[144:147], v[92:95], v[72:75], v[144:147]
  v_mfma_f32_16x16x32_bf16 v[148:151], v[92:95], v[76:79], v[148:151]
  v_mfma_f32_16x16x32_bf16 v[152:155], v[92:95], v[80:83], v[152:155]
  s_waitcnt lgkmcnt(0)
  v_mfma_f32_16x16x32_bf16 v[156:159], v[92:95], v[84:87], v[156:159]
.fz_kernel_q_l0:
  s_barrier
  v_mfma_f32_16x16x32_bf16 v[160:163], v[56:59], v[32:35], v[160:163]
  ds_read_b64_tr_b16 v[96:97], v10 offset:4096
  v_mfma_f32_16x16x32_bf16 v[164:167], v[56:59], v[36:39], v[164:167]
  ds_read_b64_tr_b16 v[98:99], v10 offset:4608
  v_mfma_f32_16x16x32_bf16 v[168:171], v[56:59], v[40:43], v[168:171]
  ds_read_b128 v[72:75], v9 offset:0
  v_mfma_f32_16x16x32_bf16 v[172:175], v[56:59], v[44:47], v[172:175]
  ds_read_b128 v[76:79], v9 offset:2048
  v_mfma_f32_16x16x32_bf16 v[176:179], v[60:63], v[32:35], v[176:179]
  ds_read_b128 v[80:83], v9 offset:4096
  v_mfma_f32_16x16x32_bf16 v[180:183], v[60:63], v[36:39], v[180:183]
  ds_read_b128 v[84:87], v9 offset:6144
  v_mfma_f32_16x16x32_bf16 v[184:187], v[60:63], v[40:43], v[184:187]
  ds_read_b64_tr_b16 v[100:101], v11 offset:4096
  v_mfma_f32_16x16x32_bf16 v[188:191], v[60:63], v[44:47], v[188:191]
  ds_read_b64_tr_b16 v[102:103], v11 offset:4608
  v_mfma_f32_16x16x32_bf16 v[192:195], v[32:35], v[64:67], v[192:195]
  ds_read_b64_tr_b16 v[104:105], v10 offset:8192
  s_add_u32 s30, s30, 12288
  v_mfma_f32_16x16x32_bf16 v[196:199], v[36:39], v[64:67], v[196:199]
  ds_read_b64_tr_b16 v[106:107], v10 offset:8704
  s_cmp_eq_u32 s30, 49152
  v_mfma_f32_16x16x32_bf16 v[200:203], v[40:43], v[64:67], v[200:203]
  ds_read_b64_tr_b16 v[108:109], v11 offset:8192
  s_cselect_b32 s30, 0, s30
  v_mfma_f32_16x16x32_bf16 v[204:207], v[44:47], v[64:67], v[204:207]
  ds_read_b64_tr_b16 v[110:111], v11 offset:8704
  s_sub_u32 s29, s29, 1
  v_mfma_f32_16x16x32_bf16 v[208:211], v[32:35], v[68:71], v[208:211]
  ds_read_b64_tr_b16 v[88:89], v10 offset:0
  s_cmp_lg_u32 s29, 0
  v_mfma_f32_16x16x32_bf16 v[212:215], v[36:39], v[68:71], v[212:215]
  ds_read_b64_tr_b16 v[90:91], v10 offset:512
  v_mfma_f32_16x16x32_bf16 v[216:219], v[40:43], v[68:71], v[216:219]
  ds_read_b64_tr_b16 v[92:93], v11 offset:0
  v_mfma_f32_16x16x32_bf16 v[220:223], v[44:47], v[68:71], v[220:223]
  ds_read_b64_tr_b16 v[94:95], v11 offset:512
  v_mfma_f32_16x16x32_bf16 v[128:131], v[48:51], v[32:35], v[128:131]
  v_add_u32 v9, 0x4000, v9
  v_mfma_f32_16x16x32_bf16 v[132:135], v[48:51], v[36:39], v[132:135]
  v_add_u32 v10, s30, v12
  v_mfma_f32_16x16x32_bf16 v[136:139], v[48:51], v[40:43], v[136:139]
  v_add_u32 v11, s30, v13
  v_mfma_f32_16x16x32_bf16 v[140:143], v[48:51], v[44:47], v[140:143]
  v_and_b32 v9, 0xffff, v9
  v_mfma_f32_16x16x32_bf16 v[144:147], v[52:55], v[32:35], v[144:147]
  s_cbranch_scc1 .fz_kernel_q_loop
  v_mfma_f32_16x16x32_bf16 v[148:151], v[52:55], v[36:39], v[148:151]
  v_mfma_f32_16x16x32_bf16 v[152:155], v[52:55], v[40:43], v[152:155]
  s_waitcnt lgkmcnt(0)
  v_mfma_f32_16x16x32_bf16 v[156:159], v[52:55], v[44:47], v[156:159]
  s_cmp_lg_u32 s62, 0
  s_cbranch_scc1 .fz_kernel_q_nr
  buffer_load_dwordx4 v[232:235], v15, s[12:15], s23 offen offset:0
  buffer_load_dwordx4 v[236:239], v15, s[12:15], s23 offen offset:32
  buffer_load_dwordx4 v[240:243], v15, s[12:15], s23 offen offset:64
  buffer_load_dwordx4 v[244:247], v15, s[12:15], s23 offen offset:96
.fz_kernel_q_nr:
  s_barrier
  v_mfma_f32_16x16x32_bf16 v[160:163], v[96:99], v[72:75], v[160:163]
  s_lshl_b32 s31, s26, 8
  s_add_u32 s31, s31, 155648
  v_and_b32 v14, 15, v2
  v_and_b32 v15, 48, v2
  v_mfma_f32_16x16x32_bf16 v[164:167], v[96:99], v[76:79], v[164:167]
  s_lshl_b32 s33, s27, 7
  s_add_u32 s33, s33, 155648
  v_lshlrev_b32 v14, 2, v14
  v_mov_b32 v1, 159952
  v_mfma_f32_16x16x32_bf16 v[168:171], v[96:99], v[80:83], v[168:171]
  v_add_u32 v29, s33, v14
  v_add_u32 v14, s31, v14
  v_mfma_f32_16x16x32_bf16 v[172:175], v[96:99], v[84:87], v[172:175]
  v_add_u32 v28, s33, v15
  v_add_u32 v15, s31, v15
  v_mfma_f32_16x16x32_bf16 v[176:179], v[100:103], v[72:75], v[176:179]
  ds_read_b32 v1, v1
  v_add_u32 v64, 4608, v14
  v_mfma_f32_16x16x32_bf16 v[180:183], v[100:103], v[76:79], v[180:183]
  ds_read_b128 v[120:123], v28 offset:5888
  v_mfma_f32_16x16x32_bf16 v[184:187], v[100:103], v[80:83], v[184:187]
  ds_read_b128 v[124:127], v28 offset:5952
  v_mfma_f32_16x16x32_bf16 v[188:191], v[100:103], v[84:87], v[188:191]
  ds_read2_b32 v[224:225], v64 offset0:0 offset1:128
  v_mfma_f32_16x16x32_bf16 v[192:195], v[72:75], v[104:107], v[192:195]
  ds_read2_b32 v[226:227], v64 offset0:16 offset1:144
  v_mfma_f32_16x16x32_bf16 v[196:199], v[76:79], v[104:107], v[196:199]
  ds_read2_b32 v[228:229], v64 offset0:32 offset1:160
  v_mfma_f32_16x16x32_bf16 v[200:203], v[80:83], v[104:107], v[200:203]
  ds_read2_b32 v[230:231], v64 offset0:48 offset1:176
  v_mfma_f32_16x16x32_bf16 v[204:207], v[84:87], v[104:107], v[204:207]
  ds_read_b32 v24, v29 offset:6144
  v_mfma_f32_16x16x32_bf16 v[208:211], v[72:75], v[108:111], v[208:211]
  ds_read_b32 v26, v29 offset:6208
  v_mfma_f32_16x16x32_bf16 v[212:215], v[76:79], v[108:111], v[212:215]
  ds_read_b128 v[32:35], v15 offset:4608
  ds_read_b128 v[48:51], v15 offset:5120
  v_mfma_f32_16x16x32_bf16 v[216:219], v[80:83], v[108:111], v[216:219]
  ds_read_b128 v[36:39], v15 offset:4672
  ds_read_b128 v[52:55], v15 offset:5184
  v_mfma_f32_16x16x32_bf16 v[220:223], v[84:87], v[108:111], v[220:223]
  ds_read_b128 v[40:43], v15 offset:4736
  ds_read_b128 v[56:59], v15 offset:5248
  v_mfma_f32_16x16x32_bf16 v[128:131], v[88:91], v[72:75], v[128:131]
  ds_read_b128 v[44:47], v15 offset:4800
  ds_read_b128 v[60:63], v15 offset:5312
  v_mfma_f32_16x16x32_bf16 v[132:135], v[88:91], v[76:79], v[132:135]
  ds_read_b128 v[112:115], v28 offset:5632
  ds_read_b128 v[116:119], v28 offset:5696
  v_mfma_f32_16x16x32_bf16 v[136:139], v[88:91], v[80:83], v[136:139]
  s_lshl1_add_u32 s34, s18, s27
  s_lshl4_add_u32 s34, s34, s17
  s_lshl1_add_u32 s34, s34, s26
  v_mfma_f32_16x16x32_bf16 v[140:143], v[88:91], v[84:87], v[140:143]
  s_lshl_b32 s36, s34, 13
  s_add_u32 s36, s36, s63
  s_add_u32 s37, s36, 4096
  v_mfma_f32_16x16x32_bf16 v[144:147], v[92:95], v[72:75], v[144:147]
  s_lshl_b32 s34, s16, 12
  s_add_u32 s34, s34, 131072
  v_add_u32 v9, s34, v3
  v_mfma_f32_16x16x32_bf16 v[148:151], v[92:95], v[76:79], v[148:151]
  v_xor_b32 v8, 8192, v9
  v_mfma_f32_16x16x32_bf16 v[152:155], v[92:95], v[80:83], v[152:155]
  v_mfma_f32_16x16x32_bf16 v[156:159], v[92:95], v[84:87], v[156:159]
  s_waitcnt lgkmcnt(12)
  v_add_u32 v1, -1, v1
  v_lshrrev_b32 v1, 6, v1
  v_cmp_eq_u32 vcc, s26, v1
  s_cbranch_vccnz .fz_kernel_q_patch
.fz_kernel_q_pback:
  v_pk_mul_f32 v[64:65], v[120:121], v[224:225] op_sel:[0,1] op_sel_hi:[1,1]
  v_pk_fma_f32 v[160:161], v[160:161], v[224:225], v[64:65] op_sel_hi:[1,0,1]
  v_pk_mul_f32 v[66:67], v[122:123], v[224:225] op_sel:[0,1] op_sel_hi:[1,1]
  v_pk_fma_f32 v[162:163], v[162:163], v[224:225], v[66:67] op_sel_hi:[1,0,1]
  v_pk_mul_f32 v[68:69], v[124:125], v[224:225] op_sel:[0,1] op_sel_hi:[1,1]
  v_pk_fma_f32 v[176:177], v[176:177], v[224:225], v[68:69] op_sel_hi:[1,0,1]
  v_pk_mul_f32 v[70:71], v[126:127], v[224:225] op_sel:[0,1] op_sel_hi:[1,1]
  v_pk_fma_f32 v[178:179], v[178:179], v[224:225], v[70:71] op_sel_hi:[1,0,1]
  v_cvt_pk_bf16_f32 v80, v160, v161
  v_cvt_pk_bf16_f32 v81, v162, v163
  v_cvt_pk_bf16_f32 v82, v176, v177
  v_cvt_pk_bf16_f32 v83, v178, v179
  v_pk_mul_f32 v[64:65], v[120:121], v[226:227] op_sel:[0,1] op_sel_hi:[1,1]
  v_pk_fma_f32 v[164:165], v[164:165], v[226:227], v[64:65] op_sel_hi:[1,0,1]
  v_pk_mul_f32 v[66:67], v[122:123], v[226:227] op_sel:[0,1] op_sel_hi:[1,1]
  v_pk_fma_f32 v[166:167], v[166:167], v[226:227], v[66:67] op_sel_hi:[1,0,1]
  v_pk_mul_f32 v[68:69], v[124:125], v[226:227] op_sel:[0,1] op_sel_hi:[1,1]
  v_pk_fma_f32 v[180:181], v[180:181], v[226:227], v[68:69] op_sel_hi:[1,0,1]
  v_pk_mul_f32 v[70:71], v[126:127], v[226:227] op_sel:[0,1] op_sel_hi:[1,1]
  v_pk_fma_f32 v[182:183], v[182:183], v[226:227], v[70:71] op_sel_hi:[1,0,1]
  v_cvt_pk_bf16_f32 v84, v164, v165
  v_cvt_pk_bf16_f32 v85, v166, v167
  v_cvt_pk_bf16_f32 v86, v180, v181
  v_cvt_pk_bf16_f32 v87, v182, v183
  v_permlane16_swap_b32 v80, v84
  v_permlane16_swap_b32 v81, v85
  v_permlane16_swap_b32 v82, v86
  v_permlane16_swap_b32 v83, v87
  buffer_store_dwordx4 v[80:83], v3, s[4:7], s36 offen offset:0 sc1
  buffer_store_dwordx4 v[84:87], v3, s[4:7], s36 offen offset:1024 sc1
  v_pk_mul_f32 v[64:65], v[120:121], v[228:229] op_sel:[0,1] op_sel_hi:[1,1]
  v_pk_fma_f32 v[168:169], v[168:169], v[228:229], v[64:65] op_sel_hi:[1,0,1]
  v_pk_mul_f32 v[66:67], v[122:123], v[228:229] op_sel:[0,1] op_sel_hi:[1,1]
  v_pk_fma_f32 v[170:171], v[170:171], v[228:229], v[66:67] op_sel_hi:[1,0,1]
  v_pk_mul_f32 v[68:69], v[124:125], v[228:229] op_sel:[0,1] op_sel_hi:[1,1]
  v_pk_fma_f32 v[184:185], v[184:185], v[228:229], v[68:69] op_sel_hi:[1,0,1]
  v_pk_mul_f32 v[70:71], v[126:127], v[228:229] op_sel:[0,1] op_sel_hi:[1,1]
  v_pk_fma_f32 v[186:187], v[186:187], v[228:229], v[70:71] op_sel_hi:[1,0,1]
  v_cvt_pk_bf16_f32 v96, v168, v169
  v_cvt_pk_bf16_f32 v97, v170, v171
  v_cvt_pk_bf16_f32 v98, v184, v185
  v_cvt_pk_bf16_f32 v99, v186, v187
  v_pk_mul_f32 v[64:65], v[120:121], v[230:231] op_sel:[0,1] op_sel_hi:[1,1]
  v_pk_fma_f32 v[172:173], v[172:173], v[230:231], v[64:65] op_sel_hi:[1,0,1]
  v_pk_mul_f32 v[66:67], v[122:123], v[230:231] op_sel:[0,1] op_sel_hi:[1,1]
  v_pk_fma_f32 v[174:175], v[174:175], v[230:231], v[66:67] op_sel_hi:[1,0,1]
  v_pk_mul_f32 v[68:69], v[124:125], v[230:231] op_sel:[0,1] op_sel_hi:[1,1]
  v_pk_fma_f32 v[188:189], v[188:189], v[230:231], v[68:69] op_sel_hi:[1,0,1]
  v_pk_mul_f32 v[70:71], v[126:127], v[230:231] op_sel:[0,1] op_sel_hi:[1,1]
  v_pk_fma_f32 v[190:191], v[190:191], v[230:231], v[70:71] op_sel_hi:[1,0,1]
  v_cvt_pk_bf16_f32 v100, v172, v173
  v_cvt_pk_bf16_f32 v101, v174, v175
  v_cvt_pk_bf16_f32 v102, v188, v189
  v_cvt_pk_bf16_f32 v103, v190, v191
  v_permlane16_swap_b32 v96, v100
  v_permlane16_swap_b32 v97, v101
  v_permlane16_swap_b32 v98, v102
  v_permlane16_swap_b32 v99, v103
  buffer_store_dwordx4 v[96:99], v3, s[4:7], s37 offen offset:0 sc1
  buffer_store_dwordx4 v[100:103], v3, s[4:7], s37 offen offset:1024 sc1
  s_waitcnt lgkmcnt(0)
  v_pk_mul_f32 v[64:65], v[48:49], v[24:25] op_sel_hi:[1,0]
  v_pk_fma_f32 v[192:193], v[192:193], v[32:33], v[64:65]
  v_pk_mul_f32 v[66:67], v[50:51], v[24:25] op_sel_hi:[1,0]
  v_pk_fma_f32 v[194:195], v[194:195], v[34:35], v[66:67]
  v_pk_mul_f32 v[68:69], v[48:49], v[26:27] op_sel_hi:[1,0]
  v_pk_fma_f32 v[208:209], v[208:209], v[32:33], v[68:69]
  v_pk_mul_f32 v[70:71], v[50:51], v[26:27] op_sel_hi:[1,0]
  v_pk_fma_f32 v[210:211], v[210:211], v[34:35], v[70:71]
  v_cvt_pk_bf16_f32 v88, v192, v193
  v_cvt_pk_bf16_f32 v90, v208, v209
  v_cvt_pk_bf16_f32 v89, v194, v195
  v_cvt_pk_bf16_f32 v91, v210, v211
  v_pk_mul_f32 v[64:65], v[52:53], v[24:25] op_sel_hi:[1,0]
  v_pk_fma_f32 v[196:197], v[196:197], v[36:37], v[64:65]
  v_pk_mul_f32 v[66:67], v[54:55], v[24:25] op_sel_hi:[1,0]
  v_pk_fma_f32 v[198:199], v[198:199], v[38:39], v[66:67]
  v_pk_mul_f32 v[68:69], v[52:53], v[26:27] op_sel_hi:[1,0]
  v_pk_fma_f32 v[212:213], v[212:213], v[36:37], v[68:69]
  v_pk_mul_f32 v[70:71], v[54:55], v[26:27] op_sel_hi:[1,0]
  v_pk_fma_f32 v[214:215], v[214:215], v[38:39], v[70:71]
  v_cvt_pk_bf16_f32 v92, v196, v197
  v_cvt_pk_bf16_f32 v94, v212, v213
  v_cvt_pk_bf16_f32 v93, v198, v199
  v_cvt_pk_bf16_f32 v95, v214, v215
  v_permlane16_swap_b32 v88, v90
  v_permlane16_swap_b32 v89, v91
  v_permlane16_swap_b32 v92, v94
  v_permlane16_swap_b32 v93, v95
  v_permlane32_swap_b32 v88, v90
  v_permlane32_swap_b32 v89, v91
  v_permlane32_swap_b32 v92, v94
  v_permlane32_swap_b32 v93, v95
  buffer_store_dwordx4 v[88:91], v3, s[4:7], s36 offen offset:2048 sc1
  buffer_store_dwordx4 v[92:95], v3, s[4:7], s36 offen offset:3072 sc1
  v_pk_mul_f32 v[64:65], v[56:57], v[24:25] op_sel_hi:[1,0]
  v_pk_fma_f32 v[200:201], v[200:201], v[40:41], v[64:65]
  v_pk_mul_f32 v[66:67], v[58:59], v[24:25] op_sel_hi:[1,0]
  v_pk_fma_f32 v[202:203], v[202:203], v[42:43], v[66:67]
  v_pk_mul_f32 v[68:69], v[56:57], v[26:27] op_sel_hi:[1,0]
  v_pk_fma_f32 v[216:217], v[216:217], v[40:41], v[68:69]
  v_pk_mul_f32 v[70:71], v[58:59], v[26:27] op_sel_hi:[1,0]
  v_pk_fma_f32 v[218:219], v[218:219], v[42:43], v[70:71]
  v_cvt_pk_bf16_f32 v104, v200, v201
  v_cvt_pk_bf16_f32 v106, v216, v217
  v_cvt_pk_bf16_f32 v105, v202, v203
  v_cvt_pk_bf16_f32 v107, v218, v219
  v_pk_mul_f32 v[64:65], v[60:61], v[24:25] op_sel_hi:[1,0]
  v_pk_fma_f32 v[204:205], v[204:205], v[44:45], v[64:65]
  v_pk_mul_f32 v[66:67], v[62:63], v[24:25] op_sel_hi:[1,0]
  v_pk_fma_f32 v[206:207], v[206:207], v[46:47], v[66:67]
  v_pk_mul_f32 v[68:69], v[60:61], v[26:27] op_sel_hi:[1,0]
  v_pk_fma_f32 v[220:221], v[220:221], v[44:45], v[68:69]
  v_pk_mul_f32 v[70:71], v[62:63], v[26:27] op_sel_hi:[1,0]
  v_pk_fma_f32 v[222:223], v[222:223], v[46:47], v[70:71]
  v_cvt_pk_bf16_f32 v108, v204, v205
  v_cvt_pk_bf16_f32 v110, v220, v221
  v_cvt_pk_bf16_f32 v109, v206, v207
  v_cvt_pk_bf16_f32 v111, v222, v223
  v_permlane16_swap_b32 v104, v106
  v_permlane16_swap_b32 v105, v107
  v_permlane16_swap_b32 v108, v110
  v_permlane16_swap_b32 v109, v111
  v_permlane32_swap_b32 v104, v106
  v_permlane32_swap_b32 v105, v107
  v_permlane32_swap_b32 v108, v110
  v_permlane32_swap_b32 v109, v111
  buffer_store_dwordx4 v[104:107], v3, s[4:7], s37 offen offset:2048 sc1
  buffer_store_dwordx4 v[108:111], v3, s[4:7], s37 offen offset:3072 sc1
  v_mul_f32 v224, 0.25503486164919736, v224
  v_mul_f32 v225, 0.25503486164919736, v225
  v_mul_f32 v226, 0.25503486164919736, v226
  v_mul_f32 v227, 0.25503486164919736, v227
  v_mul_f32 v228, 0.25503486164919736, v228
  v_mul_f32 v229, 0.25503486164919736, v229
  v_mul_f32 v230, 0.25503486164919736, v230
  v_mul_f32 v231, 0.25503486164919736, v231
  v_pk_mul_f32 v[64:65], v[112:113], v[224:225] op_sel:[0,1] op_sel_hi:[1,1]
  v_pk_fma_f32 v[128:129], v[128:129], v[224:225], v[64:65] op_sel_hi:[1,0,1]
  v_pk_mul_f32 v[66:67], v[114:115], v[224:225] op_sel:[0,1] op_sel_hi:[1,1]
  v_pk_fma_f32 v[130:131], v[130:131], v[224:225], v[66:67] op_sel_hi:[1,0,1]
  v_pk_mul_f32 v[68:69], v[116:117], v[224:225] op_sel:[0,1] op_sel_hi:[1,1]
  v_pk_fma_f32 v[144:145], v[144:145], v[224:225], v[68:69] op_sel_hi:[1,0,1]
  v_pk_mul_f32 v[70:71], v[118:119], v[224:225] op_sel:[0,1] op_sel_hi:[1,1]
  v_pk_fma_f32 v[146:147], v[146:147], v[224:225], v[70:71] op_sel_hi:[1,0,1]
  v_cvt_pk_bf16_f32 v16, v128, v129
  v_cvt_pk_bf16_f32 v17, v130, v131
  v_cvt_pk_bf16_f32 v18, v144, v145
  v_cvt_pk_bf16_f32 v19, v146, v147
  v_pk_mul_f32 v[64:65], v[112:113], v[226:227] op_sel:[0,1] op_sel_hi:[1,1]
  v_pk_fma_f32 v[132:133], v[132:133], v[226:227], v[64:65] op_sel_hi:[1,0,1]
  v_pk_mul_f32 v[66:67], v[114:115], v[226:227] op_sel:[0,1] op_sel_hi:[1,1]
  v_pk_fma_f32 v[134:135], v[134:135], v[226:227], v[66:67] op_sel_hi:[1,0,1]
  v_pk_mul_f32 v[68:69], v[116:117], v[226:227] op_sel:[0,1] op_sel_hi:[1,1]
  v_pk_fma_f32 v[148:149], v[148:149], v[226:227], v[68:69] op_sel_hi:[1,0,1]
  v_pk_mul_f32 v[70:71], v[118:119], v[226:227] op_sel:[0,1] op_sel_hi:[1,1]
  v_pk_fma_f32 v[150:151], v[150:151], v[226:227], v[70:71] op_sel_hi:[1,0,1]
  v_cvt_pk_bf16_f32 v20, v132, v133
  v_cvt_pk_bf16_f32 v21, v134, v135
  v_cvt_pk_bf16_f32 v22, v148, v149
  v_cvt_pk_bf16_f32 v23, v150, v151
  v_permlane16_swap_b32 v16, v20
  v_permlane16_swap_b32 v17, v21
  v_permlane16_swap_b32 v18, v22
  v_permlane16_swap_b32 v19, v23
  ds_write_b128 v8, v[16:19] offset:0
  ds_write_b128 v8, v[20:23] offset:1024
  v_pk_mul_f32 v[64:65], v[112:113], v[228:229] op_sel:[0,1] op_sel_hi:[1,1]
  v_pk_fma_f32 v[136:137], v[136:137], v[228:229], v[64:65] op_sel_hi:[1,0,1]
  v_pk_mul_f32 v[66:67], v[114:115], v[228:229] op_sel:[0,1] op_sel_hi:[1,1]
  v_pk_fma_f32 v[138:139], v[138:139], v[228:229], v[66:67] op_sel_hi:[1,0,1]
  v_pk_mul_f32 v[68:69], v[116:117], v[228:229] op_sel:[0,1] op_sel_hi:[1,1]
  v_pk_fma_f32 v[152:153], v[152:153], v[228:229], v[68:69] op_sel_hi:[1,0,1]
  v_pk_mul_f32 v[70:71], v[118:119], v[228:229] op_sel:[0,1] op_sel_hi:[1,1]
  v_pk_fma_f32 v[154:155], v[154:155], v[228:229], v[70:71] op_sel_hi:[1,0,1]
  v_cvt_pk_bf16_f32 v24, v136, v137
  v_cvt_pk_bf16_f32 v25, v138, v139
  v_cvt_pk_bf16_f32 v26, v152, v153
  v_cvt_pk_bf16_f32 v27, v154, v155
  v_pk_mul_f32 v[64:65], v[112:113], v[230:231] op_sel:[0,1] op_sel_hi:[1,1]
  v_pk_fma_f32 v[140:141], v[140:141], v[230:231], v[64:65] op_sel_hi:[1,0,1]
  v_pk_mul_f32 v[66:67], v[114:115], v[230:231] op_sel:[0,1] op_sel_hi:[1,1]
  v_pk_fma_f32 v[142:143], v[142:143], v[230:231], v[66:67] op_sel_hi:[1,0,1]
  v_pk_mul_f32 v[68:69], v[116:117], v[230:231] op_sel:[0,1] op_sel_hi:[1,1]
  v_pk_fma_f32 v[156:157], v[156:157], v[230:231], v[68:69] op_sel_hi:[1,0,1]
  v_pk_mul_f32 v[70:71], v[118:119], v[230:231] op_sel:[0,1] op_sel_hi:[1,1]
  v_pk_fma_f32 v[158:159], v[158:159], v[230:231], v[70:71] op_sel_hi:[1,0,1]
  v_cvt_pk_bf16_f32 v28, v140, v141
  v_cvt_pk_bf16_f32 v29, v142, v143
  v_cvt_pk_bf16_f32 v30, v156, v157
  v_cvt_pk_bf16_f32 v31, v158, v159
  v_permlane16_swap_b32 v24, v28
  v_permlane16_swap_b32 v25, v29
  v_permlane16_swap_b32 v26, v30
  v_permlane16_swap_b32 v27, v31
  ds_write_b128 v8, v[24:27] offset:2048
  ds_write_b128 v8, v[28:31] offset:3072
  s_branch .fz_kernel_att
.fz_kernel_q_help1:
  s_waitcnt lgkmcnt(0)
  s_mov_b32 s3, 32
  s_cmp_eq_u32 s16, 7
  s_cbranch_scc1 .fz_kernel_q_h7
  s_getpc_b64 s[0:1]
.fz_kernel_ct4:
  s_sub_u32 s0, s0, .fz_kernel_ct4-fz_kernel
  s_subb_u32 s1, s1, 0
  s_lshr_b32 s31, s2, 3
  s_mulk_i32 s31, 0x500
  v_lshl_add_u32 v1, v2, 7, s31
  v_min_u32 v1, .fz_kernel_last-fz_kernel, v1
  s_mov_b64 exec, 0x3ff
  global_load_dword v1, v1, s[0:1]
  s_mov_b64 exec, -1
.fz_kernel_ct4e:
  s_mov_b32 s12, s58
  s_mov_b32 s13, s59
  s_mov_b32 s14, 0x100
  s_mov_b32 s15, 0x00020000
  s_mov_b32 s30, 0
  s_and_b32 s31, s18, 3
  s_sub_u32 s31, s31, s30
  s_and_b32 s30, s31, 3
  s_lshl_b32 s30, s30, 14
  v_and_b32 v20, 15, v2
  v_lshrrev_b32 v21, 4, v2
  v_bfe_u32 v22, v2, 1, 3
  v_xor_b32 v22, v22, v21
  v_lshlrev_b32 v21, 7, v20
  v_lshl_add_u32 v21, v22, 4, v21
  v_add_u32 v21, s30, v21
  v_xor_b32 v22, 64, v21
  v_lshlrev_b32 v20, 3, v20
  s_lshl_b32 s30, s17, 10
  s_add_u32 s30, s30, 0x1808000
  s_mov_b32 exec_lo, 0x00f0000f
  s_mov_b32 exec_hi, 0xf0000f00
  v_add_u32 v20, 4, v20
  s_mov_b64 exec, -1
  v_mov_b32 v24, 0x3f803f80
  v_mov_b32 v25, v24
  v_mov_b32 v26, v24
  v_mov_b32 v27, v24
  s_lshl_b32 s31, s31, 1
  s_sub_u32 s31, 31, s31
  s_mov_b32 s20, s48
  s_mov_b32 s21, s49
  s_mov_b32 s22, 0x800
  s_mov_b32 s23, 0x00020000
  v_lshlrev_b32 v40, 5, v2
  buffer_load_dwordx4 v[44:47], v40, s[20:23], 0 offen
  buffer_load_dwordx4 v[48:51], v40, s[20:23], 0 offen offset:16
  v_mov_b32 v40, 0
  s_waitcnt vmcnt(0)
  v_lshlrev_b32 v41, 16, v44
  v_and_b32 v42, 0xffff0000, v44
  v_add_f32 v40, v40, v41
  v_add_f32 v40, v40, v42
  v_lshlrev_b32 v41, 16, v45
  v_and_b32 v42, 0xffff0000, v45
  v_add_f32 v40, v40, v41
  v_add_f32 v40, v40, v42
  v_lshlrev_b32 v41, 16, v46
  v_and_b32 v42, 0xffff0000, v46
  v_add_f32 v40, v40, v41
  v_add_f32 v40, v40, v42
  v_lshlrev_b32 v41, 16, v47
  v_and_b32 v42, 0xffff0000, v47
  v_add_f32 v40, v40, v41
  v_add_f32 v40, v40, v42
  v_lshlrev_b32 v41, 16, v48
  v_and_b32 v42, 0xffff0000, v48
  v_add_f32 v40, v40, v41
  v_add_f32 v40, v40, v42
  v_lshlrev_b32 v41, 16, v49
  v_and_b32 v42, 0xffff0000, v49
  v_add_f32 v40, v40, v41
  v_add_f32 v40, v40, v42
  v_lshlrev_b32 v41, 16, v50
  v_and_b32 v42, 0xffff0000, v50
  v_add_f32 v40, v40, v41
  v_add_f32 v40, v40, v42
  v_lshlrev_b32 v41, 16, v51
  v_and_b32 v42, 0xffff0000, v51
  v_add_f32 v40, v40, v41
  v_add_f32 v40, v40, v42
  s_nop 1
  v_add_f32 v40, v40, v40 quad_perm:[1,0,3,2] row_mask:0xf bank_mask:0xf
  s_nop 1
  v_add_f32 v40, v40, v40 quad_perm:[2,3,0,1] row_mask:0xf bank_mask:0xf
  s_nop 1
  v_add_f32 v40, v40, v40 row_half_mirror row_mask:0xf bank_mask:0xf
  s_nop 1
  v_add_f32 v40, v40, v40 row_mirror row_mask:0xf bank_mask:0xf
  s_nop 0
  v_readlane_b32 s20, v40, 16
  v_readlane_b32 s21, v40, 32
  v_readlane_b32 s22, v40, 48
  v_add_f32 v40, s20, v40
  v_add_f32 v40, s21, v40
  v_add_f32 v40, s22, v40
  v_mul_f32 v40, 0x3a800000, v40
  s_nop 0
  v_readfirstlane_b32 s76, v40
.fz_kernel_xs5:
  s_barrier
  s_sub_u32 s3, s3, 1
  s_cmp_lg_u32 s3, s31
  s_cbranch_scc1 .fz_kernel_xs5
  ds_read_b128 v[64:67], v21 offset:0
  ds_read_b128 v[72:75], v21 offset:2048
  ds_read_b128 v[80:83], v21 offset:4096
  ds_read_b128 v[88:91], v21 offset:6144
  ds_read_b128 v[96:99], v21 offset:8192
  ds_read_b128 v[104:107], v21 offset:10240
  ds_read_b128 v[112:115], v21 offset:12288
  ds_read_b128 v[120:123], v21 offset:14336
  ds_read_b128 v[68:71], v22 offset:0
  ds_read_b128 v[76:79], v22 offset:2048
  ds_read_b128 v[84:87], v22 offset:4096
  ds_read_b128 v[92:95], v22 offset:6144
  ds_read_b128 v[100:103], v22 offset:8192
  ds_read_b128 v[108:111], v22 offset:10240
  ds_read_b128 v[116:119], v22 offset:12288
  ds_read_b128 v[124:127], v22 offset:14336
  s_waitcnt lgkmcnt(0)
  s_cmp_eq_u32 s3, 0
  s_cbranch_scc1 .fz_kernel_hb6
  s_barrier
  s_sub_u32 s3, s3, 1
.fz_kernel_hb6:
  s_setprio 2
  v_mfma_f32_16x16x32_bf16 v[128:131], v[24:27], v[64:67], 0
  v_mfma_f32_16x16x32_bf16 v[160:163], v[64:67], v[64:67], 0
  v_mfma_f32_16x16x32_bf16 v[132:135], v[24:27], v[72:75], 0
  v_mfma_f32_16x16x32_bf16 v[164:167], v[72:75], v[72:75], 0
  v_mfma_f32_16x16x32_bf16 v[136:139], v[24:27], v[80:83], 0
  v_mfma_f32_16x16x32_bf16 v[168:171], v[80:83], v[80:83], 0
  v_mfma_f32_16x16x32_bf16 v[140:143], v[24:27], v[88:91], 0
  v_mfma_f32_16x16x32_bf16 v[172:175], v[88:91], v[88:91], 0
  v_mfma_f32_16x16x32_bf16 v[144:147], v[24:27], v[96:99], 0
  v_mfma_f32_16x16x32_bf16 v[176:179], v[96:99], v[96:99], 0
  v_mfma_f32_16x16x32_bf16 v[148:151], v[24:27], v[104:107], 0
  v_mfma_f32_16x16x32_bf16 v[180:183], v[104:107], v[104:107], 0
  v_mfma_f32_16x16x32_bf16 v[152:155], v[24:27], v[112:115], 0
  v_mfma_f32_16x16x32_bf16 v[184:187], v[112:115], v[112:115], 0
  v_mfma_f32_16x16x32_bf16 v[156:159], v[24:27], v[120:123], 0
  v_mfma_f32_16x16x32_bf16 v[188:191], v[120:123], v[120:123], 0
  v_mfma_f32_16x16x32_bf16 v[128:131], v[24:27], v[68:71], v[128:131]
  v_mfma_f32_16x16x32_bf16 v[160:163], v[68:71], v[68:71], v[160:163]
  v_mfma_f32_16x16x32_bf16 v[132:135], v[24:27], v[76:79], v[132:135]
  v_mfma_f32_16x16x32_bf16 v[164:167], v[76:79], v[76:79], v[164:167]
  v_mfma_f32_16x16x32_bf16 v[136:139], v[24:27], v[84:87], v[136:139]
  v_mfma_f32_16x16x32_bf16 v[168:171], v[84:87], v[84:87], v[168:171]
  v_mfma_f32_16x16x32_bf16 v[140:143], v[24:27], v[92:95], v[140:143]
  v_mfma_f32_16x16x32_bf16 v[172:175], v[92:95], v[92:95], v[172:175]
  v_mfma_f32_16x16x32_bf16 v[144:147], v[24:27], v[100:103], v[144:147]
  v_mfma_f32_16x16x32_bf16 v[176:179], v[100:103], v[100:103], v[176:179]
  v_mfma_f32_16x16x32_bf16 v[148:151], v[24:27], v[108:111], v[148:151]
  v_mfma_f32_16x16x32_bf16 v[180:183], v[108:111], v[108:111], v[180:183]
  v_mfma_f32_16x16x32_bf16 v[152:155], v[24:27], v[116:119], v[152:155]
  v_mfma_f32_16x16x32_bf16 v[184:187], v[116:119], v[116:119], v[184:187]
  v_mfma_f32_16x16x32_bf16 v[156:159], v[24:27], v[124:127], v[156:159]
  v_mfma_f32_16x16x32_bf16 v[188:191], v[124:127], v[124:127], v[188:191]
  s_setprio 0
  s_cmp_eq_u32 s3, 0
  s_cbranch_scc1 .fz_kernel_hb7
  s_barrier
  s_sub_u32 s3, s3, 1
.fz_kernel_hb7:
  s_mov_b32 exec_lo, 0x100001
  s_mov_b32 exec_hi, 0x10000100
  buffer_load_dword v9, v4, s[12:15], 0 offen sc1
  v_mov_b32 v128, v160
  v_mov_b32 v132, v164
  v_mov_b32 v136, v168
  v_mov_b32 v140, v172
  v_mov_b32 v144, v176
  v_mov_b32 v148, v180
  v_mov_b32 v152, v184
  v_mov_b32 v156, v188
  s_mov_b32 exec_lo, 0x200002
  s_mov_b32 exec_hi, 0x20000200
  v_mov_b32 v128, v161
  v_mov_b32 v132, v165
  v_mov_b32 v136, v169
  v_mov_b32 v140, v173
  v_mov_b32 v144, v177
  v_mov_b32 v148, v181
  v_mov_b32 v152, v185
  v_mov_b32 v156, v189
  s_mov_b32 exec_lo, 0x400004
  s_mov_b32 exec_hi, 0x40000400
  v_mov_b32 v128, v162
  v_mov_b32 v132, v166
  v_mov_b32 v136, v170
  v_mov_b32 v140, v174
  v_mov_b32 v144, v178
  v_mov_b32 v148, v182
  v_mov_b32 v152, v186
  v_mov_b32 v156, v190
  s_mov_b32 exec_lo, 0x800008
  s_mov_b32 exec_hi, 0x80000800
  v_mov_b32 v128, v163
  v_mov_b32 v132, v167
  v_mov_b32 v136, v171
  v_mov_b32 v140, v175
  v_mov_b32 v144, v179
  v_mov_b32 v148, v183
  v_mov_b32 v152, v187
  v_mov_b32 v156, v191
  s_mov_b64 exec, 1
  s_mov_b32 s38, 0
.fz_kernel_pw8:
  s_mov_b32 s46, 0
  s_call_b64 s[0:1], .fz_kernel_hw
  s_waitcnt vmcnt(0)
  v_readfirstlane_b32 s31, v9
  s_cmp_eq_u32 s31, 64
  s_cbranch_scc1 .fz_kernel_pw8d
  s_cmp_eq_u32 s3, 0
  s_cbranch_scc1 .fz_kernel_hb9
  s_barrier
  s_sub_u32 s3, s3, 1
.fz_kernel_hb9:
  s_cmp_eq_u32 s3, 0
  s_cbranch_scc1 .fz_kernel_hb10
  s_barrier
  s_sub_u32 s3, s3, 1
.fz_kernel_hb10:
  buffer_load_dword v9, v4, s[12:15], 0 offen sc1
  s_add_u32 s38, s38, 1
  s_cmp_lt_u32 s38, 131072
  s_cbranch_scc1 .fz_kernel_pw8
  s_waitcnt vmcnt(0)
.fz_kernel_pw8d:
  s_mov_b64 exec, -1
  s_mov_b32 exec_lo, 0x00fff00f
  s_mov_b32 exec_hi, 0xff000ff0
  buffer_atomic_add_f32 v128, v20, s[4:7], s30 offen offset:0 sc1
  buffer_atomic_add_f32 v132, v20, s[4:7], s30 offen offset:128 sc1
  buffer_atomic_add_f32 v136, v20, s[4:7], s30 offen offset:256 sc1
  buffer_atomic_add_f32 v140, v20, s[4:7], s30 offen offset:384 sc1
  buffer_atomic_add_f32 v144, v20, s[4:7], s30 offen offset:512 sc1
  buffer_atomic_add_f32 v148, v20, s[4:7], s30 offen offset:640 sc1
  buffer_atomic_add_f32 v152, v20, s[4:7], s30 offen offset:768 sc1
  buffer_atomic_add_f32 v156, v20, s[4:7], s30 offen offset:896 sc1
  s_mov_b64 exec, -1
  s_mov_b32 s46, 0
  s_call_b64 s[0:1], .fz_kernel_hw
  s_waitcnt vmcnt(0)
  v_lshlrev_b32 v7, 11, v2
  s_lshl_b32 s31, s17, 7
  s_lshl_b32 s33, 1, s18
  s_add_u32 s31, s31, s67
  s_add_u32 s31, s31, 0x1800018
  v_mov_b32 v8, s33
  s_mov_b64 exec, 0xffff
  buffer_atomic_or v8, v7, s[4:7], s31 offen sc1
  s_mov_b64 exec, -1
  s_add_u32 s37, s19, 24
.fz_kernel_f111:
  s_cmp_le_u32 s3, 8
  s_cbranch_scc1 .fz_kernel_f111d
  s_barrier
  s_sub_u32 s3, s3, 1
  s_branch .fz_kernel_f111
.fz_kernel_f111d:
  s_mov_b64 exec, 1
  buffer_load_dword v9, v4, s[4:7], s37 offen sc1
  s_mov_b64 exec, 1
  s_mov_b32 s38, 0
.fz_kernel_pw12:
  s_mov_b32 s46, 0
  s_call_b64 s[0:1], .fz_kernel_hw
  s_waitcnt vmcnt(0)
  v_readfirstlane_b32 s31, v9
  s_cmp_eq_u32 s31, 65535
  s_cbranch_scc1 .fz_kernel_pw12d
  s_cmp_eq_u32 s3, 0
  s_cbranch_scc1 .fz_kernel_hb13
  s_barrier
  s_sub_u32 s3, s3, 1
.fz_kernel_hb13:
  s_cmp_eq_u32 s3, 0
  s_cbranch_scc1 .fz_kernel_hb14
  s_barrier
  s_sub_u32 s3, s3, 1
.fz_kernel_hb14:
  buffer_load_dword v9, v4, s[4:7], s37 offen sc1
  s_add_u32 s38, s38, 1
  s_cmp_lt_u32 s38, 131072
  s_cbranch_scc1 .fz_kernel_pw12
  s_waitcnt vmcnt(0)
.fz_kernel_pw12d:
  s_mov_b64 exec, -1
  buffer_load_dwordx4 v[64:67], v3, s[4:7], s30 offen sc1
  s_mov_b32 s46, 0
  s_call_b64 s[0:1], .fz_kernel_hw
  s_waitcnt vmcnt(0)
  v_mov_b32 v26, 0.0009765625
  v_mul_f32 v20, v26, v64
  v_mul_f32 v27, v20, v20
  v_fma_f32 v22, v65, v26, -v27
  v_max_f32 v22, 0, v22
  v_add_f32 v22, 1e-05, v22
  v_rsq_f32 v22, v22
  s_nop 0
  v_mul_f32 v20, v20, v22
  v_sub_f32 v20, 0, v20
  v_mul_f32 v21, v26, v66
  v_mul_f32 v27, v21, v21
  v_fma_f32 v23, v67, v26, -v27
  v_max_f32 v23, 0, v23
  v_add_f32 v23, 1e-05, v23
  v_rsq_f32 v23, v23
  s_nop 0
  v_mul_f32 v21, v21, v23
  v_sub_f32 v21, 0, v21
  v_lshlrev_b32 v24, 3, v2
  v_add_u32 v24, 155648, v24
  ds_write_b64 v24, v[22:23] offset:4608
  ds_write_b64 v24, v[20:21] offset:5120
  v_mov_b32 v20, 1.0
  v_mov_b32 v21, 1.0
  v_mov_b32 v22, 0
  v_mov_b32 v23, 0
  ds_write_b64 v24, v[20:21] offset:6400
  ds_write_b64 v24, v[22:23] offset:6912
  v_mov_b32 v24, 159952
  v_mov_b32 v25, s76
  ds_write_b32 v24, v25 offset:8
  s_waitcnt lgkmcnt(0)
.fz_kernel_q_hw2:
  s_add_u32 s3, s3, 2
.fz_kernel_q_he:
  s_cmp_eq_u32 s3, 0
  s_cbranch_scc1 .fz_kernel_chain
  s_barrier
  s_sub_u32 s3, s3, 1
  s_branch .fz_kernel_q_he
.fz_kernel_q_h7:
  s_mov_b32 s8, s58
  s_mov_b32 s9, s59
  s_mov_b32 s10, 0x100
  s_mov_b32 s11, 0x00020000
  v_mov_b32 v12, 0
  v_mov_b32 v13, 0
  v_mov_b32 v14, 0
  v_mov_b32 v15, 0
  s_cmp_ge_u32 s2, 64
  s_cbranch_scc1 .fz_kernel_q_nzero
  s_lshl_b32 s36, s2, 10
  s_add_u32 s36, s36, 0x1800000
  buffer_store_dwordx4 v[12:15], v3, s[4:7], s36 offen sc1
.fz_kernel_q_nzero:
  v_and_b32 v21, 7, v2
  v_and_b32 v20, 16, v2
  v_lshlrev_b32 v20, 1, v20
  v_xor_b32 v20, v20, v3
  s_bfe_u32 s33, s17, 0x10002
  s_lshl_b32 s33, s33, 1
  s_and_b32 s31, s33, 3
  s_mul_i32 s31, s31, 12288
  s_add_u32 s31, s31, 65536
  v_add_u32 v16, s31, v20
  v_xor_b32 v17, 64, v16
  s_add_u32 s31, s31, 12288
  v_add_u32 v18, s31, v20
  v_xor_b32 v19, 64, v18
  s_sub_u32 s33, 31, s33
  v_lshlrev_b32 v21, 5, v21
  v_and_b32 v22, 24, v2
  v_add_u32 v21, v22, v21
  v_lshrrev_b32 v22, 5, v2
  v_lshl_add_u32 v21, v22, 2, v21
  s_lshl_b32 s30, s18, 10
  s_add_u32 s30, s30, 0x180c000
  v_and_b32 v22, 1, v2
  v_lshlrev_b32 v22, 4, v22
  v_mov_b32 v23, 0x3f80
  v_lshlrev_b32 v22, v22, v23
  v_mov_b32 v24, 0
  v_mov_b32 v25, 0
  v_mov_b32 v26, 0
  v_mov_b32 v27, 0
  s_mov_b32 exec_lo, 0x3030303
  s_mov_b32 exec_hi, 0x3030303
  v_mov_b32 v24, v22
  s_mov_b32 exec_lo, 0xc0c0c0c
  s_mov_b32 exec_hi, 0xc0c0c0c
  v_mov_b32 v25, v22
  s_mov_b32 exec_lo, 0x30303030
  s_mov_b32 exec_hi, 0x30303030
  v_mov_b32 v26, v22
  s_mov_b32 exec_lo, 0xc0c0c0c0
  s_mov_b32 exec_hi, 0xc0c0c0c0
  v_mov_b32 v27, v22
  s_mov_b64 exec, -1
  s_cmp_ge_u32 s2, 64
  s_cbranch_scc1 .fz_kernel_nz2
  s_mov_b64 exec, 1
  s_waitcnt vmcnt(0)
  buffer_atomic_add v5, v4, s[8:11], 0 offen sc1
  s_mov_b64 exec, -1
.fz_kernel_nz2:
  s_barrier
  s_sub_u32 s3, s3, 1
  s_cmp_lg_u32 s3, s33
  s_cbranch_scc1 .fz_kernel_nz2
  ds_read_b128 v[64:67], v16 offset:0
  ds_read_b128 v[68:71], v16 offset:4096
  ds_read_b128 v[72:75], v16 offset:8192
  ds_read_b128 v[76:79], v17 offset:1024
  ds_read_b128 v[80:83], v17 offset:5120
  ds_read_b128 v[84:87], v17 offset:9216
  ds_read_b128 v[88:91], v16 offset:2048
  ds_read_b128 v[92:95], v16 offset:6144
  ds_read_b128 v[96:99], v16 offset:10240
  ds_read_b128 v[100:103], v17 offset:3072
  ds_read_b128 v[104:107], v17 offset:7168
  ds_read_b128 v[108:111], v17 offset:11264
  s_waitcnt lgkmcnt(0)
  s_cmp_eq_u32 s3, 0
  s_cbranch_scc1 .fz_kernel_hb15
  s_barrier
  s_sub_u32 s3, s3, 1
.fz_kernel_hb15:
  ds_read_b128 v[112:115], v18 offset:0
  ds_read_b128 v[116:119], v18 offset:4096
  ds_read_b128 v[120:123], v18 offset:8192
  ds_read_b128 v[124:127], v19 offset:1024
  ds_read_b128 v[128:131], v19 offset:5120
  ds_read_b128 v[132:135], v19 offset:9216
  ds_read_b128 v[136:139], v18 offset:2048
  ds_read_b128 v[140:143], v18 offset:6144
  ds_read_b128 v[144:147], v18 offset:10240
  ds_read_b128 v[148:151], v19 offset:3072
  ds_read_b128 v[152:155], v19 offset:7168
  ds_read_b128 v[156:159], v19 offset:11264
  s_waitcnt lgkmcnt(0)
  s_cmp_eq_u32 s3, 0
  s_cbranch_scc1 .fz_kernel_hb16
  s_barrier
  s_sub_u32 s3, s3, 1
.fz_kernel_hb16:
  s_setprio 2
  v_mfma_f32_16x16x32_bf16 v[160:163], v[24:27], v[64:67], 0
  v_mfma_f32_16x16x32_bf16 v[164:167], v[24:27], v[68:71], 0
  v_mfma_f32_16x16x32_bf16 v[168:171], v[24:27], v[72:75], 0
  v_mfma_f32_16x16x32_bf16 v[160:163], v[24:27], v[76:79], v[160:163]
  v_mfma_f32_16x16x32_bf16 v[164:167], v[24:27], v[80:83], v[164:167]
  v_mfma_f32_16x16x32_bf16 v[168:171], v[24:27], v[84:87], v[168:171]
  v_mfma_f32_16x16x32_bf16 v[160:163], v[24:27], v[88:91], v[160:163]
  v_mfma_f32_16x16x32_bf16 v[164:167], v[24:27], v[92:95], v[164:167]
  v_mfma_f32_16x16x32_bf16 v[168:171], v[24:27], v[96:99], v[168:171]
  v_mfma_f32_16x16x32_bf16 v[160:163], v[24:27], v[100:103], v[160:163]
  v_mfma_f32_16x16x32_bf16 v[164:167], v[24:27], v[104:107], v[164:167]
  v_mfma_f32_16x16x32_bf16 v[168:171], v[24:27], v[108:111], v[168:171]
  v_mfma_f32_16x16x32_bf16 v[160:163], v[24:27], v[112:115], v[160:163]
  v_mfma_f32_16x16x32_bf16 v[164:167], v[24:27], v[116:119], v[164:167]
  v_mfma_f32_16x16x32_bf16 v[168:171], v[24:27], v[120:123], v[168:171]
  v_mfma_f32_16x16x32_bf16 v[160:163], v[24:27], v[124:127], v[160:163]
  v_mfma_f32_16x16x32_bf16 v[164:167], v[24:27], v[128:131], v[164:167]
  v_mfma_f32_16x16x32_bf16 v[168:171], v[24:27], v[132:135], v[168:171]
  v_mfma_f32_16x16x32_bf16 v[160:163], v[24:27], v[136:139], v[160:163]
  v_mfma_f32_16x16x32_bf16 v[164:167], v[24:27], v[140:143], v[164:167]
  v_mfma_f32_16x16x32_bf16 v[168:171], v[24:27], v[144:147], v[168:171]
  v_mfma_f32_16x16x32_bf16 v[160:163], v[24:27], v[148:151], v[160:163]
  v_mfma_f32_16x16x32_bf16 v[164:167], v[24:27], v[152:155], v[164:167]
  v_mfma_f32_16x16x32_bf16 v[168:171], v[24:27], v[156:159], v[168:171]
  s_setprio 0
  s_mov_b64 exec, 1
  buffer_load_dword v9, v4, s[8:11], 0 offen sc1
  s_mov_b64 exec, -1
  s_nop 1
  v_add_f32 v160, v160, v160 row_ror:8 row_mask:0xf bank_mask:0xf
  v_add_f32 v161, v161, v161 row_ror:8 row_mask:0xf bank_mask:0xf
  v_add_f32 v162, v162, v162 row_ror:8 row_mask:0xf bank_mask:0xf
  v_add_f32 v163, v163, v163 row_ror:8 row_mask:0xf bank_mask:0xf
  v_add_f32 v164, v164, v164 row_ror:8 row_mask:0xf bank_mask:0xf
  v_add_f32 v165, v165, v165 row_ror:8 row_mask:0xf bank_mask:0xf
  v_add_f32 v166, v166, v166 row_ror:8 row_mask:0xf bank_mask:0xf
  v_add_f32 v167, v167, v167 row_ror:8 row_mask:0xf bank_mask:0xf
  v_add_f32 v168, v168, v168 row_ror:8 row_mask:0xf bank_mask:0xf
  v_add_f32 v169, v169, v169 row_ror:8 row_mask:0xf bank_mask:0xf
  v_add_f32 v170, v170, v170 row_ror:8 row_mask:0xf bank_mask:0xf
  v_add_f32 v171, v171, v171 row_ror:8 row_mask:0xf bank_mask:0xf
  s_mov_b32 exec_lo, 0x0
  s_mov_b32 exec_hi, 0xff00ff
  v_mov_b32 v160, v161
  v_mov_b32 v164, v165
  v_mov_b32 v168, v169
  s_mov_b32 exec_lo, 0xff00ff00
  s_mov_b32 exec_hi, 0x0
  v_mov_b32 v160, v162
  v_mov_b32 v164, v166
  v_mov_b32 v168, v170
  s_mov_b32 exec_lo, 0x0
  s_mov_b32 exec_hi, 0xff00ff00
  v_mov_b32 v160, v163
  v_mov_b32 v164, v167
  v_mov_b32 v168, v171
  s_mov_b64 exec, 1
  s_mov_b32 s38, 0
.fz_kernel_pw17:
  s_mov_b32 s46, 0
  s_call_b64 s[0:1], .fz_kernel_hw
  s_waitcnt vmcnt(0)
  v_readfirstlane_b32 s31, v9
  s_cmp_eq_u32 s31, 64
  s_cbranch_scc1 .fz_kernel_pw17d
  s_cmp_eq_u32 s3, 0
  s_cbranch_scc1 .fz_kernel_hb18
  s_barrier
  s_sub_u32 s3, s3, 1
.fz_kernel_hb18:
  s_cmp_eq_u32 s3, 0
  s_cbranch_scc1 .fz_kernel_hb19
  s_barrier
  s_sub_u32 s3, s3, 1
.fz_kernel_hb19:
  buffer_load_dword v9, v4, s[8:11], 0 offen sc1
  s_add_u32 s38, s38, 1
  s_cmp_lt_u32 s38, 131072
  s_cbranch_scc1 .fz_kernel_pw17
  s_waitcnt vmcnt(0)
.fz_kernel_pw17d:
  s_mov_b64 exec, -1
  buffer_atomic_add_f32 v160, v21, s[4:7], s30 offen offset:0 sc1
  buffer_atomic_add_f32 v164, v21, s[4:7], s30 offen offset:256 sc1
  buffer_atomic_add_f32 v168, v21, s[4:7], s30 offen offset:512 sc1
  s_mov_b32 s46, 0
  s_call_b64 s[0:1], .fz_kernel_hw
  s_waitcnt vmcnt(0)
  v_lshlrev_b32 v7, 7, v2
  s_lshl_b32 s31, s18, 11
  s_lshl_b32 s33, 1, s17
  s_add_u32 s31, s31, s67
  s_add_u32 s31, s31, 0x180001c
  v_mov_b32 v8, s33
  s_mov_b64 exec, 0xffff
  buffer_atomic_or v8, v7, s[4:7], s31 offen sc1
  s_mov_b64 exec, -1
  s_cmp_ge_u32 s2, 196
  s_cbranch_scc1 .fz_kernel_lz20
  s_lshl_b32 s36, s2, 12
  s_add_u32 s36, s36, 0x1c00000
  s_sub_u32 s31, s2, 66
  s_min_u32 s31, s31, s2
  s_sub_u32 s31, s31, 4
  s_cmp_lt_u32 s31, 6
  s_cbranch_scc1 .fz_kernel_lz20a
  buffer_store_dwordx4 v[12:15], v3, s[4:7], s36 offen sc1
  buffer_store_dwordx4 v[12:15], v3, s[4:7], s36 offen offset:1024 sc1
  buffer_store_dwordx4 v[12:15], v3, s[4:7], s36 offen offset:2048 sc1
  buffer_store_dwordx4 v[12:15], v3, s[4:7], s36 offen offset:3072 sc1
.fz_kernel_lz20:
  s_add_u32 s37, s19, 28
.fz_kernel_f121:
  s_cmp_le_u32 s3, 8
  s_cbranch_scc1 .fz_kernel_f121d
  s_barrier
  s_sub_u32 s3, s3, 1
  s_branch .fz_kernel_f121
.fz_kernel_f121d:
  s_mov_b64 exec, 1
  buffer_load_dword v9, v4, s[4:7], s37 offen sc1
  s_mov_b64 exec, 1
  s_mov_b32 s38, 0
.fz_kernel_pw22:
  s_mov_b32 s46, 0
  s_call_b64 s[0:1], .fz_kernel_hw
  s_waitcnt vmcnt(0)
  v_readfirstlane_b32 s31, v9
  s_cmp_eq_u32 s31, 65535
  s_cbranch_scc1 .fz_kernel_pw22d
  s_cmp_eq_u32 s3, 0
  s_cbranch_scc1 .fz_kernel_hb23
  s_barrier
  s_sub_u32 s3, s3, 1
.fz_kernel_hb23:
  s_cmp_eq_u32 s3, 0
  s_cbranch_scc1 .fz_kernel_hb24
  s_barrier
  s_sub_u32 s3, s3, 1
.fz_kernel_hb24:
  buffer_load_dword v9, v4, s[4:7], s37 offen sc1
  s_add_u32 s38, s38, 1
  s_cmp_lt_u32 s38, 131072
  s_cbranch_scc1 .fz_kernel_pw22
  s_waitcnt vmcnt(0)
.fz_kernel_pw22d:
  s_mov_b64 exec, -1
  buffer_load_dwordx4 v[64:67], v3, s[4:7], s30 offen sc1
  s_mov_b32 s46, 0
  s_call_b64 s[0:1], .fz_kernel_hw
  s_waitcnt vmcnt(0)
  v_add_u32 v24, 155648, v3
  s_mov_b32 exec_hi, 0xffff
  ds_write_b128 v24, v[64:67] offset:5632
  s_mov_b64 exec, -1
  s_waitcnt lgkmcnt(0)
  s_getpc_b64 s[0:1]
.fz_kernel_ct25:
  s_sub_u32 s0, s0, .fz_kernel_ct25-fz_kernel
  s_subb_u32 s1, s1, 0
  s_lshr_b32 s31, s2, 3
  s_mulk_i32 s31, 0x500
  v_lshl_add_u32 v1, v2, 7, s31
  v_min_u32 v1, .fz_kernel_last-fz_kernel, v1
  s_mov_b64 exec, 0x3ff
  global_load_dword v1, v1, s[0:1]
  s_mov_b64 exec, -1
.fz_kernel_ct25e:
  s_branch .fz_kernel_q_hw2
.fz_kernel_att:
  s_setprio 1
  s_and_b32 s39, s16, 1
  s_lshr_b32 s32, s16, 1
  s_lshl1_add_u32 s35, s18, s39
  s_lshl_b32 s35, s35, 5
  s_add_u32 s35, s35, s32
  s_lshl_b32 s35, s35, 13
  s_add_u32 s35, s35, s63
  s_lshl_b32 s34, 1, s17
  s_mov_b32 s36, 0
  v_add_u32 v10, 4096, v3
  v_mfma_f32_32x32x16_bf16 v[48:63], v[80:83], v[16:19], 0
  v_mfma_f32_32x32x16_bf16 v[48:63], v[84:87], v[20:23], v[48:63]
  v_mov_b32 v1, 0x3f803f80
  v_mov_b32 v11, 0x4444
  v_mov_b32 v12, v1
  v_mov_b32 v14, 0
  s_mov_b32 exec_lo, 0xaaaaaaaa
  s_mov_b32 exec_hi, 0xaaaaaaaa
  v_mov_b32 v12, 0
  v_mov_b32 v14, v1
  s_mov_b32 exec_lo, 0xcccccccc
  s_mov_b32 exec_hi, 0xcccccccc
  v_mov_b32 v11, 0xeeee
  s_mov_b64 exec, -1
  v_mov_b32 v13, v12
  v_mov_b32 v15, v14
  s_lshl_b32 s31, s16, 8
  s_add_u32 s31, s31, 147456
  v_and_b32 v1, 31, v2
  v_lshl_add_u32 v1, v1, 3, s31
  s_mov_b32 s26, 0xffff0000
  s_mov_b32 s27, 0xffff0000
  s_mov_b32 s24, 0x21800000
  s_mov_b32 s25, 0x5d800000
  s_andn2_b32 s31, 2, s16
  s_lshl2_add_u32 s31, s17, s31
  s_lshl4_add_u32 s31, s31, s18
  s_lshl1_add_u32 s31, s31, s39
  s_lshl_b32 s31, s31, 11
  s_add_u32 s28, s31, s64
  s_add_u32 s29, s28, 65536
  s_mov_b32 s73, 0
  v_mov_b32 v208, 0
  v_mov_b32 v209, 0
  v_mov_b32 v210, 0
  v_mov_b32 v211, 0
  v_mov_b32 v212, 0
  v_mov_b32 v213, 0
  v_mov_b32 v214, 0
  v_mov_b32 v215, 0
  v_mov_b32 v216, 0
  v_mov_b32 v217, 0
  v_mov_b32 v218, 0
  v_mov_b32 v219, 0
  v_mov_b32 v220, 0
  v_mov_b32 v221, 0
  v_mov_b32 v222, 0
  v_mov_b32 v223, 0
  s_mov_b32 s32, 7
  s_waitcnt lgkmcnt(0)
  s_barrier
  ds_read_b128 v[32:35], v9 offset:0
  ds_read_b128 v[36:39], v9 offset:1024
  ds_read_b128 v[40:43], v9 offset:2048
  ds_read_b128 v[44:47], v9 offset:3072
  v_mfma_f32_32x32x16_bf16 v[64:79], v[80:83], v[24:27], 0
  v_exp_f32 v48, v48
  v_exp_f32 v49, v49
  v_exp_f32 v50, v50
  v_exp_f32 v51, v51
  v_exp_f32 v52, v52
  v_exp_f32 v53, v53
  v_exp_f32 v54, v54
  v_exp_f32 v55, v55
  v_mfma_f32_32x32x16_bf16 v[64:79], v[84:87], v[28:31], v[64:79]
  v_cvt_pk_bf16_f32 v224, v48, v49
  v_cvt_pk_bf16_f32 v225, v50, v51
  v_cvt_pk_bf16_f32 v226, v52, v53
  v_cvt_pk_bf16_f32 v227, v54, v55
  v_exp_f32 v56, v56
  v_exp_f32 v57, v57
  v_exp_f32 v58, v58
  v_exp_f32 v59, v59
  v_mfma_f32_32x32x16_bf16 v[144:159], v[88:91], v[224:227], 0
  v_exp_f32 v60, v60
  v_exp_f32 v61, v61
  v_exp_f32 v62, v62
  v_exp_f32 v63, v63
  v_cvt_pk_bf16_f32 v228, v56, v57
  v_cvt_pk_bf16_f32 v229, v58, v59
  v_cvt_pk_bf16_f32 v230, v60, v61
  v_cvt_pk_bf16_f32 v231, v62, v63
  s_waitcnt lgkmcnt(0)
  v_mfma_f32_32x32x16_bf16 v[48:63], v[80:83], v[32:35], 0
  v_exp_f32 v64, v64
  v_exp_f32 v65, v65
  v_exp_f32 v66, v66
  v_exp_f32 v67, v67
  v_mfma_f32_32x32x16_bf16 v[144:159], v[92:95], v[228:231], v[144:159]
  v_exp_f32 v68, v68
  v_exp_f32 v69, v69
  v_exp_f32 v70, v70
  v_smfmac_f32_16x16x64_bf16 v[208:211], v[12:15], v[224:231], v11
  v_exp_f32 v71, v71
  v_mfma_f32_32x32x16_bf16 v[48:63], v[84:87], v[36:39], v[48:63]
  v_cvt_pk_bf16_f32 v224, v64, v65
  v_cvt_pk_bf16_f32 v225, v66, v67
  v_cvt_pk_bf16_f32 v226, v68, v69
  v_cvt_pk_bf16_f32 v227, v70, v71
  v_exp_f32 v72, v72
  v_exp_f32 v73, v73
  v_exp_f32 v74, v74
  v_exp_f32 v75, v75
  v_mfma_f32_32x32x16_bf16 v[160:175], v[88:91], v[224:227], 0
  v_exp_f32 v76, v76
  v_exp_f32 v77, v77
  v_exp_f32 v78, v78
  v_exp_f32 v79, v79
  v_cvt_pk_bf16_f32 v228, v72, v73
  v_cvt_pk_bf16_f32 v229, v74, v75
  v_cvt_pk_bf16_f32 v230, v76, v77
  v_cvt_pk_bf16_f32 v231, v78, v79
  s_mov_b64 exec, 1
  s_waitcnt vmcnt(0)
  ds_add_u32 v6, v5 offset:0x100
  s_mov_b64 exec, -1
  v_mfma_f32_32x32x16_bf16 v[64:79], v[80:83], v[40:43], 0
  v_exp_f32 v48, v48
  v_exp_f32 v49, v49
  v_exp_f32 v50, v50
  v_exp_f32 v51, v51
  v_mfma_f32_32x32x16_bf16 v[160:175], v[92:95], v[228:231], v[160:175]
  v_exp_f32 v52, v52
  v_exp_f32 v53, v53
  v_exp_f32 v54, v54
  v_smfmac_f32_16x16x64_bf16 v[212:215], v[12:15], v[224:231], v11
  v_exp_f32 v55, v55
  v_mfma_f32_32x32x16_bf16 v[64:79], v[84:87], v[44:47], v[64:79]
  v_cvt_pk_bf16_f32 v224, v48, v49
  v_cvt_pk_bf16_f32 v225, v50, v51
  v_cvt_pk_bf16_f32 v226, v52, v53
  v_cvt_pk_bf16_f32 v227, v54, v55
  v_exp_f32 v56, v56
  v_exp_f32 v57, v57
  v_exp_f32 v58, v58
  v_exp_f32 v59, v59
  v_mfma_f32_32x32x16_bf16 v[176:191], v[88:91], v[224:227], 0
  ds_read_b32 v7, v6
  v_exp_f32 v60, v60
  v_exp_f32 v61, v61
  v_exp_f32 v62, v62
  v_exp_f32 v63, v63
  v_cvt_pk_bf16_f32 v228, v56, v57
  v_cvt_pk_bf16_f32 v229, v58, v59
  v_cvt_pk_bf16_f32 v230, v60, v61
  v_cvt_pk_bf16_f32 v231, v62, v63
  s_waitcnt lgkmcnt(0)
  v_readfirstlane_b32 s39, v7
  s_andn2_b32 s33, s39, s34
  s_bcnt1_i32_b32 s31, s33
  s_cmp_ge_u32 s31, 2
  s_cbranch_scc1 .fz_kernel_a_e
  v_mfma_f32_32x32x16_bf16 v[48:63], v[96:99], v[16:19], 0
  v_exp_f32 v64, v64
  v_exp_f32 v65, v65
  v_exp_f32 v66, v66
  v_exp_f32 v67, v67
  v_mfma_f32_32x32x16_bf16 v[176:191], v[92:95], v[228:231], v[176:191]
  v_exp_f32 v68, v68
  v_exp_f32 v69, v69
  v_exp_f32 v70, v70
  v_smfmac_f32_16x16x64_bf16 v[216:219], v[12:15], v[224:231], v11
  v_exp_f32 v71, v71
  v_mfma_f32_32x32x16_bf16 v[48:63], v[100:103], v[20:23], v[48:63]
  v_cvt_pk_bf16_f32 v224, v64, v65
  v_cvt_pk_bf16_f32 v225, v66, v67
  v_cvt_pk_bf16_f32 v226, v68, v69
  v_cvt_pk_bf16_f32 v227, v70, v71
  v_exp_f32 v72, v72
  v_exp_f32 v73, v73
  v_exp_f32 v74, v74
  v_exp_f32 v75, v75
  v_mfma_f32_32x32x16_bf16 v[192:207], v[88:91], v[224:227], 0
  v_exp_f32 v76, v76
  v_exp_f32 v77, v77
  v_exp_f32 v78, v78
  v_exp_f32 v79, v79
  v_cvt_pk_bf16_f32 v228, v72, v73
  v_cvt_pk_bf16_f32 v229, v74, v75
  v_cvt_pk_bf16_f32 v230, v76, v77
  v_cvt_pk_bf16_f32 v231, v78, v79
  v_mfma_f32_32x32x16_bf16 v[64:79], v[96:99], v[24:27], 0
  v_exp_f32 v48, v48
  v_exp_f32 v49, v49
  v_exp_f32 v50, v50
  v_exp_f32 v51, v51
  v_mfma_f32_32x32x16_bf16 v[192:207], v[92:95], v[228:231], v[192:207]
  v_exp_f32 v52, v52
  v_exp_f32 v53, v53
  v_exp_f32 v54, v54
  v_smfmac_f32_16x16x64_bf16 v[220:223], v[12:15], v[224:231], v11
  v_exp_f32 v55, v55
  v_mfma_f32_32x32x16_bf16 v[64:79], v[100:103], v[28:31], v[64:79]
  v_cvt_pk_bf16_f32 v224, v48, v49
  v_cvt_pk_bf16_f32 v225, v50, v51
  v_cvt_pk_bf16_f32 v226, v52, v53
  v_cvt_pk_bf16_f32 v227, v54, v55
  v_exp_f32 v56, v56
  v_exp_f32 v57, v57
  v_exp_f32 v58, v58
  v_exp_f32 v59, v59
  v_mfma_f32_32x32x16_bf16 v[144:159], v[104:107], v[224:227], v[144:159]
  v_exp_f32 v60, v60
  v_exp_f32 v61, v61
  v_exp_f32 v62, v62
  v_exp_f32 v63, v63
  v_cvt_pk_bf16_f32 v228, v56, v57
  v_cvt_pk_bf16_f32 v229, v58, v59
  v_cvt_pk_bf16_f32 v230, v60, v61
  v_cvt_pk_bf16_f32 v231, v62, v63
  v_mfma_f32_32x32x16_bf16 v[48:63], v[96:99], v[32:35], 0
  v_exp_f32 v64, v64
  v_exp_f32 v65, v65
  v_exp_f32 v66, v66
  v_exp_f32 v67, v67
  v_mfma_f32_32x32x16_bf16 v[144:159], v[108:111], v[228:231], v[144:159]
  v_exp_f32 v68, v68
  v_exp_f32 v69, v69
  v_exp_f32 v70, v70
  v_smfmac_f32_16x16x64_bf16 v[208:211], v[12:15], v[224:231], v11
  v_exp_f32 v71, v71
  v_mfma_f32_32x32x16_bf16 v[48:63], v[100:103], v[36:39], v[48:63]
  v_cvt_pk_bf16_f32 v224, v64, v65
  v_cvt_pk_bf16_f32 v225, v66, v67
  v_cvt_pk_bf16_f32 v226, v68, v69
  v_cvt_pk_bf16_f32 v227, v70, v71
  v_exp_f32 v72, v72
  v_exp_f32 v73, v73
  v_exp_f32 v74, v74
  v_exp_f32 v75, v75
  v_mfma_f32_32x32x16_bf16 v[160:175], v[104:107], v[224:227], v[160:175]
  ds_read_b32 v7, v6
  v_exp_f32 v76, v76
  v_exp_f32 v77, v77
  v_exp_f32 v78, v78
  v_exp_f32 v79, v79
  v_cvt_pk_bf16_f32 v228, v72, v73
  v_cvt_pk_bf16_f32 v229, v74, v75
  v_cvt_pk_bf16_f32 v230, v76, v77
  v_cvt_pk_bf16_f32 v231, v78, v79
  s_waitcnt lgkmcnt(0)
  v_readfirstlane_b32 s39, v7
  s_andn2_b32 s39, s39, s34
  s_cbranch_scc0 .fz_kernel_a_p0
  s_ff1_i32_b32 s33, s36
  s_bitset0_b32 s36, s33
  s_lshl_b32 s33, s33, 14
  s_add_u32 s30, s33, s35
  s_cbranch_scc1 .fz_kernel_pk26c
.fz_kernel_pk26:
  buffer_load_dwordx4 v[112:115], v3, s[4:7], s30 offen offset:0
  buffer_load_dwordx4 v[116:119], v3, s[4:7], s30 offen offset:1024
  buffer_load_dwordx4 v[120:123], v3, s[4:7], s30 offen offset:2048
  buffer_load_dwordx4 v[124:127], v3, s[4:7], s30 offen offset:3072
  buffer_load_dwordx4 v[128:131], v10, s[4:7], s30 offen offset:0
  buffer_load_dwordx4 v[132:135], v10, s[4:7], s30 offen offset:1024
  buffer_load_dwordx4 v[136:139], v10, s[4:7], s30 offen offset:2048
  buffer_load_dwordx4 v[140:143], v10, s[4:7], s30 offen offset:3072
.fz_kernel_a_p0:
  v_mfma_f32_32x32x16_bf16 v[64:79], v[96:99], v[40:43], 0
  v_exp_f32 v48, v48
  v_exp_f32 v49, v49
  v_exp_f32 v50, v50
  v_exp_f32 v51, v51
  v_mfma_f32_32x32x16_bf16 v[160:175], v[108:111], v[228:231], v[160:175]
  v_exp_f32 v52, v52
  v_exp_f32 v53, v53
  v_exp_f32 v54, v54
  v_smfmac_f32_16x16x64_bf16 v[212:215], v[12:15], v[224:231], v11
  v_exp_f32 v55, v55
  v_mfma_f32_32x32x16_bf16 v[64:79], v[100:103], v[44:47], v[64:79]
  v_cvt_pk_bf16_f32 v224, v48, v49
  v_cvt_pk_bf16_f32 v225, v50, v51
  v_cvt_pk_bf16_f32 v226, v52, v53
  v_cvt_pk_bf16_f32 v227, v54, v55
  v_exp_f32 v56, v56
  v_exp_f32 v57, v57
  v_exp_f32 v58, v58
  v_exp_f32 v59, v59
  v_mfma_f32_32x32x16_bf16 v[176:191], v[104:107], v[224:227], v[176:191]
  v_exp_f32 v60, v60
  v_exp_f32 v61, v61
  v_exp_f32 v62, v62
  v_exp_f32 v63, v63
  v_cvt_pk_bf16_f32 v228, v56, v57
  v_cvt_pk_bf16_f32 v229, v58, v59
  v_cvt_pk_bf16_f32 v230, v60, v61
  v_cvt_pk_bf16_f32 v231, v62, v63
  v_exp_f32 v64, v64
  v_exp_f32 v65, v65
  v_exp_f32 v66, v66
  v_exp_f32 v67, v67
  v_mfma_f32_32x32x16_bf16 v[176:191], v[108:111], v[228:231], v[176:191]
  v_exp_f32 v68, v68
  v_exp_f32 v69, v69
  v_exp_f32 v70, v70
  v_smfmac_f32_16x16x64_bf16 v[216:219], v[12:15], v[224:231], v11
  v_exp_f32 v71, v71
  v_cvt_pk_bf16_f32 v224, v64, v65
  v_cvt_pk_bf16_f32 v225, v66, v67
  v_cvt_pk_bf16_f32 v226, v68, v69
  v_cvt_pk_bf16_f32 v227, v70, v71
  v_exp_f32 v72, v72
  v_exp_f32 v73, v73
  v_exp_f32 v74, v74
  v_exp_f32 v75, v75
  v_mfma_f32_32x32x16_bf16 v[192:207], v[104:107], v[224:227], v[192:207]
  v_exp_f32 v76, v76
  v_exp_f32 v77, v77
  v_exp_f32 v78, v78
  v_exp_f32 v79, v79
  v_cvt_pk_bf16_f32 v228, v72, v73
  v_cvt_pk_bf16_f32 v229, v74, v75
  v_cvt_pk_bf16_f32 v230, v76, v77
  v_cvt_pk_bf16_f32 v231, v78, v79
  s_cmp_lg_u32 s39, 0
  s_cbranch_scc1 .fz_kernel_a_p1
  s_ff1_i32_b32 s33, s36
  s_bitset0_b32 s36, s33
  s_lshl_b32 s33, s33, 14
  s_add_u32 s30, s33, s35
  s_cbranch_scc1 .fz_kernel_pk27c
.fz_kernel_pk27:
  buffer_load_dwordx4 v[112:115], v3, s[4:7], s30 offen offset:0
  buffer_load_dwordx4 v[116:119], v3, s[4:7], s30 offen offset:1024
  buffer_load_dwordx4 v[120:123], v3, s[4:7], s30 offen offset:2048
  buffer_load_dwordx4 v[124:127], v3, s[4:7], s30 offen offset:3072
  buffer_load_dwordx4 v[128:131], v10, s[4:7], s30 offen offset:0
  buffer_load_dwordx4 v[132:135], v10, s[4:7], s30 offen offset:1024
  buffer_load_dwordx4 v[136:139], v10, s[4:7], s30 offen offset:2048
  buffer_load_dwordx4 v[140:143], v10, s[4:7], s30 offen offset:3072
.fz_kernel_a_p1:
  s_ff1_i32_b32 s33, s36
  s_bitset0_b32 s36, s33
  s_lshl_b32 s33, s33, 14
  s_add_u32 s30, s33, s35
  s_cbranch_scc1 .fz_kernel_pk28c
.fz_kernel_pk28:
  buffer_load_dwordx4 v[80:83], v3, s[4:7], s30 offen offset:0
  buffer_load_dwordx4 v[84:87], v3, s[4:7], s30 offen offset:1024
  buffer_load_dwordx4 v[88:91], v3, s[4:7], s30 offen offset:2048
  buffer_load_dwordx4 v[92:95], v3, s[4:7], s30 offen offset:3072
  buffer_load_dwordx4 v[96:99], v10, s[4:7], s30 offen offset:0
  s_waitcnt vmcnt(11)
  v_mfma_f32_32x32x16_bf16 v[48:63], v[112:115], v[16:19], 0
  v_mfma_f32_32x32x16_bf16 v[48:63], v[116:119], v[20:23], v[48:63]
  s_nop 9
  s_branch .fz_kernel_a_b2
.fz_kernel_a_e:
  s_mov_b32 s36, s33
  s_or_b32 s34, s34, s39
  s_ff1_i32_b32 s33, s36
  s_bitset0_b32 s36, s33
  s_lshl_b32 s33, s33, 14
  s_add_u32 s30, s33, s35
  v_mfma_f32_32x32x16_bf16 v[48:63], v[96:99], v[16:19], 0
  buffer_load_dwordx4 v[112:115], v3, s[4:7], s30 offen offset:0
  v_exp_f32 v64, v64
  v_exp_f32 v65, v65
  v_exp_f32 v66, v66
  v_exp_f32 v67, v67
  v_mfma_f32_32x32x16_bf16 v[176:191], v[92:95], v[228:231], v[176:191]
  buffer_load_dwordx4 v[116:119], v3, s[4:7], s30 offen offset:1024
  v_exp_f32 v68, v68
  v_exp_f32 v69, v69
  v_exp_f32 v70, v70
  v_smfmac_f32_16x16x64_bf16 v[216:219], v[12:15], v[224:231], v11
  buffer_load_dwordx4 v[120:123], v3, s[4:7], s30 offen offset:2048
  v_exp_f32 v71, v71
  v_mfma_f32_32x32x16_bf16 v[48:63], v[100:103], v[20:23], v[48:63]
  buffer_load_dwordx4 v[124:127], v3, s[4:7], s30 offen offset:3072
  v_cvt_pk_bf16_f32 v224, v64, v65
  v_cvt_pk_bf16_f32 v225, v66, v67
  v_cvt_pk_bf16_f32 v226, v68, v69
  v_cvt_pk_bf16_f32 v227, v70, v71
  v_exp_f32 v72, v72
  v_exp_f32 v73, v73
  v_exp_f32 v74, v74
  v_exp_f32 v75, v75
  v_mfma_f32_32x32x16_bf16 v[192:207], v[88:91], v[224:227], 0
  buffer_load_dwordx4 v[128:131], v10, s[4:7], s30 offen offset:0
  v_exp_f32 v76, v76
  v_exp_f32 v77, v77
  v_exp_f32 v78, v78
  v_exp_f32 v79, v79
  v_cvt_pk_bf16_f32 v228, v72, v73
  v_cvt_pk_bf16_f32 v229, v74, v75
  v_cvt_pk_bf16_f32 v230, v76, v77
  v_cvt_pk_bf16_f32 v231, v78, v79
  v_mfma_f32_32x32x16_bf16 v[64:79], v[96:99], v[24:27], 0
  buffer_load_dwordx4 v[132:135], v10, s[4:7], s30 offen offset:1024
  v_exp_f32 v48, v48
  v_exp_f32 v49, v49
  v_exp_f32 v50, v50
  v_exp_f32 v51, v51
  v_mfma_f32_32x32x16_bf16 v[192:207], v[92:95], v[228:231], v[192:207]
  buffer_load_dwordx4 v[136:139], v10, s[4:7], s30 offen offset:2048
  v_exp_f32 v52, v52
  v_exp_f32 v53, v53
  v_exp_f32 v54, v54
  v_smfmac_f32_16x16x64_bf16 v[220:223], v[12:15], v[224:231], v11
  buffer_load_dwordx4 v[140:143], v10, s[4:7], s30 offen offset:3072
  v_exp_f32 v55, v55
  v_mfma_f32_32x32x16_bf16 v[64:79], v[100:103], v[28:31], v[64:79]
  s_ff1_i32_b32 s33, s36
  v_cvt_pk_bf16_f32 v224, v48, v49
  v_cvt_pk_bf16_f32 v225, v50, v51
  v_cvt_pk_bf16_f32 v226, v52, v53
  v_cvt_pk_bf16_f32 v227, v54, v55
  v_exp_f32 v56, v56
  v_exp_f32 v57, v57
  v_exp_f32 v58, v58
  v_exp_f32 v59, v59
  v_mfma_f32_32x32x16_bf16 v[144:159], v[104:107], v[224:227], v[144:159]
  s_bitset0_b32 s36, s33
  v_exp_f32 v60, v60
  v_exp_f32 v61, v61
  v_exp_f32 v62, v62
  v_exp_f32 v63, v63
  v_cvt_pk_bf16_f32 v228, v56, v57
  v_cvt_pk_bf16_f32 v229, v58, v59
  v_cvt_pk_bf16_f32 v230, v60, v61
  v_cvt_pk_bf16_f32 v231, v62, v63
  v_mfma_f32_32x32x16_bf16 v[48:63], v[96:99], v[32:35], 0
  s_lshl_b32 s33, s33, 14
  v_exp_f32 v64, v64
  v_exp_f32 v65, v65
  v_exp_f32 v66, v66
  v_exp_f32 v67, v67
  v_mfma_f32_32x32x16_bf16 v[144:159], v[108:111], v[228:231], v[144:159]
  s_add_u32 s30, s33, s35
  v_exp_f32 v68, v68
  v_exp_f32 v69, v69
  v_exp_f32 v70, v70
  v_smfmac_f32_16x16x64_bf16 v[208:211], v[12:15], v[224:231], v11
  buffer_load_dwordx4 v[80:83], v3, s[4:7], s30 offen offset:0
  v_exp_f32 v71, v71
  v_mfma_f32_32x32x16_bf16 v[48:63], v[100:103], v[36:39], v[48:63]
  buffer_load_dwordx4 v[84:87], v3, s[4:7], s30 offen offset:1024
  v_cvt_pk_bf16_f32 v224, v64, v65
  v_cvt_pk_bf16_f32 v225, v66, v67
  v_cvt_pk_bf16_f32 v226, v68, v69
  v_cvt_pk_bf16_f32 v227, v70, v71
  v_exp_f32 v72, v72
  v_exp_f32 v73, v73
  v_exp_f32 v74, v74
  v_exp_f32 v75, v75
  v_mfma_f32_32x32x16_bf16 v[160:175], v[104:107], v[224:227], v[160:175]
  buffer_load_dwordx4 v[88:91], v3, s[4:7], s30 offen offset:2048
  v_exp_f32 v76, v76
  v_exp_f32 v77, v77
  v_exp_f32 v78, v78
  v_exp_f32 v79, v79
  v_cvt_pk_bf16_f32 v228, v72, v73
  v_cvt_pk_bf16_f32 v229, v74, v75
  v_cvt_pk_bf16_f32 v230, v76, v77
  v_cvt_pk_bf16_f32 v231, v78, v79
  v_mfma_f32_32x32x16_bf16 v[64:79], v[96:99], v[40:43], 0
  buffer_load_dwordx4 v[92:95], v3, s[4:7], s30 offen offset:3072
  v_exp_f32 v48, v48
  v_exp_f32 v49, v49
  v_exp_f32 v50, v50
  v_exp_f32 v51, v51
  v_mfma_f32_32x32x16_bf16 v[160:175], v[108:111], v[228:231], v[160:175]
  v_exp_f32 v52, v52
  v_exp_f32 v53, v53
  v_exp_f32 v54, v54
  v_smfmac_f32_16x16x64_bf16 v[212:215], v[12:15], v[224:231], v11
  v_exp_f32 v55, v55
  v_mfma_f32_32x32x16_bf16 v[64:79], v[100:103], v[44:47], v[64:79]
  v_cvt_pk_bf16_f32 v224, v48, v49
  v_cvt_pk_bf16_f32 v225, v50, v51
  v_cvt_pk_bf16_f32 v226, v52, v53
  v_cvt_pk_bf16_f32 v227, v54, v55
  v_exp_f32 v56, v56
  v_exp_f32 v57, v57
  v_exp_f32 v58, v58
  v_exp_f32 v59, v59
  v_mfma_f32_32x32x16_bf16 v[176:191], v[104:107], v[224:227], v[176:191]
  s_waitcnt vmcnt(10)
  v_exp_f32 v60, v60
  v_exp_f32 v61, v61
  v_exp_f32 v62, v62
  v_exp_f32 v63, v63
  v_cvt_pk_bf16_f32 v228, v56, v57
  v_cvt_pk_bf16_f32 v229, v58, v59
  v_cvt_pk_bf16_f32 v230, v60, v61
  v_cvt_pk_bf16_f32 v231, v62, v63
  v_mfma_f32_32x32x16_bf16 v[48:63], v[112:115], v[16:19], 0
  v_exp_f32 v64, v64
  v_exp_f32 v65, v65
  v_exp_f32 v66, v66
  v_exp_f32 v67, v67
  v_mfma_f32_32x32x16_bf16 v[176:191], v[108:111], v[228:231], v[176:191]
  buffer_load_dwordx4 v[96:99], v10, s[4:7], s30 offen offset:0
  v_exp_f32 v68, v68
  v_exp_f32 v69, v69
  v_exp_f32 v70, v70
  v_smfmac_f32_16x16x64_bf16 v[216:219], v[12:15], v[224:231], v11
  v_exp_f32 v71, v71
  v_mfma_f32_32x32x16_bf16 v[48:63], v[116:119], v[20:23], v[48:63]
  v_cvt_pk_bf16_f32 v224, v64, v65
  v_cvt_pk_bf16_f32 v225, v66, v67
  v_cvt_pk_bf16_f32 v226, v68, v69
  v_cvt_pk_bf16_f32 v227, v70, v71
  v_exp_f32 v72, v72
  v_exp_f32 v73, v73
  v_exp_f32 v74, v74
  v_exp_f32 v75, v75
  v_mfma_f32_32x32x16_bf16 v[192:207], v[104:107], v[224:227], v[192:207]
  v_exp_f32 v76, v76
  v_exp_f32 v77, v77
  v_exp_f32 v78, v78
  v_exp_f32 v79, v79
  v_cvt_pk_bf16_f32 v228, v72, v73
  v_cvt_pk_bf16_f32 v229, v74, v75
  v_cvt_pk_bf16_f32 v230, v76, v77
  v_cvt_pk_bf16_f32 v231, v78, v79
  s_branch .fz_kernel_a_b2
  .p2align 6
.fz_kernel_a_loop:
  v_mfma_f32_32x32x16_bf16 v[64:79], v[80:83], v[24:27], 0
  v_exp_f32 v48, v48
  v_exp_f32 v49, v49
  v_exp_f32 v50, v50
  v_exp_f32 v51, v51
  v_mfma_f32_32x32x16_bf16 v[192:207], v[140:143], v[228:231], v[192:207]
  v_exp_f32 v52, v52
  v_exp_f32 v53, v53
  v_exp_f32 v54, v54
  v_smfmac_f32_16x16x64_bf16 v[220:223], v[12:15], v[224:231], v11
  buffer_load_dwordx4 v[132:135], v10, s[4:7], s30 offen offset:1024
  v_exp_f32 v55, v55
  v_mfma_f32_32x32x16_bf16 v[64:79], v[84:87], v[28:31], v[64:79]
  s_waitcnt vmcnt(10)
  v_cvt_pk_bf16_f32 v224, v48, v49
  v_cvt_pk_bf16_f32 v225, v50, v51
  v_cvt_pk_bf16_f32 v226, v52, v53
  v_cvt_pk_bf16_f32 v227, v54, v55
  v_exp_f32 v56, v56
  v_exp_f32 v57, v57
  v_exp_f32 v58, v58
  v_exp_f32 v59, v59
  v_mfma_f32_32x32x16_bf16 v[144:159], v[88:91], v[224:227], v[144:159]
  v_exp_f32 v60, v60
  v_exp_f32 v61, v61
  v_exp_f32 v62, v62
  v_exp_f32 v63, v63
  v_cvt_pk_bf16_f32 v228, v56, v57
  v_cvt_pk_bf16_f32 v229, v58, v59
  v_cvt_pk_bf16_f32 v230, v60, v61
  v_cvt_pk_bf16_f32 v231, v62, v63
  v_mfma_f32_32x32x16_bf16 v[48:63], v[80:83], v[32:35], 0
  v_exp_f32 v64, v64
  v_exp_f32 v65, v65
  v_exp_f32 v66, v66
  v_exp_f32 v67, v67
  v_mfma_f32_32x32x16_bf16 v[144:159], v[92:95], v[228:231], v[144:159]
  v_exp_f32 v68, v68
  v_exp_f32 v69, v69
  v_exp_f32 v70, v70
  v_smfmac_f32_16x16x64_bf16 v[208:211], v[12:15], v[224:231], v11
  buffer_load_dwordx4 v[136:139], v10, s[4:7], s30 offen offset:2048
  v_exp_f32 v71, v71
  v_mfma_f32_32x32x16_bf16 v[48:63], v[84:87], v[36:39], v[48:63]
  s_ff1_i32_b32 s33, s36
  v_cvt_pk_bf16_f32 v224, v64, v65
  v_cvt_pk_bf16_f32 v225, v66, v67
  v_cvt_pk_bf16_f32 v226, v68, v69
  v_cvt_pk_bf16_f32 v227, v70, v71
  v_exp_f32 v72, v72
  v_exp_f32 v73, v73
  v_exp_f32 v74, v74
  v_exp_f32 v75, v75
  v_mfma_f32_32x32x16_bf16 v[160:175], v[88:91], v[224:227], v[160:175]
  s_bitset0_b32 s36, s33
  v_exp_f32 v76, v76
  v_exp_f32 v77, v77
  v_exp_f32 v78, v78
  v_exp_f32 v79, v79
  v_cvt_pk_bf16_f32 v228, v72, v73
  v_cvt_pk_bf16_f32 v229, v74, v75
  v_cvt_pk_bf16_f32 v230, v76, v77
  v_cvt_pk_bf16_f32 v231, v78, v79
  v_mfma_f32_32x32x16_bf16 v[64:79], v[80:83], v[40:43], 0
  s_lshl_b32 s33, s33, 14
  v_exp_f32 v48, v48
  v_exp_f32 v49, v49
  v_exp_f32 v50, v50
  v_exp_f32 v51, v51
  v_mfma_f32_32x32x16_bf16 v[160:175], v[92:95], v[228:231], v[160:175]
  v_exp_f32 v52, v52
  v_exp_f32 v53, v53
  v_exp_f32 v54, v54
  v_smfmac_f32_16x16x64_bf16 v[212:215], v[12:15], v[224:231], v11
  buffer_load_dwordx4 v[140:143], v10, s[4:7], s30 offen offset:3072
  v_exp_f32 v55, v55
  v_mfma_f32_32x32x16_bf16 v[64:79], v[84:87], v[44:47], v[64:79]
  s_add_u32 s30, s33, s35
  v_cvt_pk_bf16_f32 v224, v48, v49
  v_cvt_pk_bf16_f32 v225, v50, v51
  v_cvt_pk_bf16_f32 v226, v52, v53
  v_cvt_pk_bf16_f32 v227, v54, v55
  v_exp_f32 v56, v56
  v_exp_f32 v57, v57
  v_exp_f32 v58, v58
  v_exp_f32 v59, v59
  v_mfma_f32_32x32x16_bf16 v[176:191], v[88:91], v[224:227], v[176:191]
  s_waitcnt vmcnt(10)
  v_exp_f32 v60, v60
  v_exp_f32 v61, v61
  v_exp_f32 v62, v62
  v_exp_f32 v63, v63
  v_cvt_pk_bf16_f32 v228, v56, v57
  v_cvt_pk_bf16_f32 v229, v58, v59
  v_cvt_pk_bf16_f32 v230, v60, v61
  v_cvt_pk_bf16_f32 v231, v62, v63
  v_mfma_f32_32x32x16_bf16 v[48:63], v[96:99], v[16:19], 0
  s_cbranch_scc1 .fz_kernel_pk31c
.fz_kernel_pk31:
  v_exp_f32 v64, v64
  v_exp_f32 v65, v65
  v_exp_f32 v66, v66
  v_exp_f32 v67, v67
  v_mfma_f32_32x32x16_bf16 v[176:191], v[92:95], v[228:231], v[176:191]
  v_exp_f32 v68, v68
  v_exp_f32 v69, v69
  v_exp_f32 v70, v70
  v_smfmac_f32_16x16x64_bf16 v[216:219], v[12:15], v[224:231], v11
  buffer_load_dwordx4 v[80:83], v3, s[4:7], s30 offen offset:0
  v_exp_f32 v71, v71
  v_mfma_f32_32x32x16_bf16 v[48:63], v[100:103], v[20:23], v[48:63]
  v_cvt_pk_bf16_f32 v224, v64, v65
  v_cvt_pk_bf16_f32 v225, v66, v67
  v_cvt_pk_bf16_f32 v226, v68, v69
  v_cvt_pk_bf16_f32 v227, v70, v71
  v_exp_f32 v72, v72
  v_exp_f32 v73, v73
  v_exp_f32 v74, v74
  v_exp_f32 v75, v75
  v_mfma_f32_32x32x16_bf16 v[192:207], v[88:91], v[224:227], v[192:207]
  v_exp_f32 v76, v76
  v_exp_f32 v77, v77
  v_exp_f32 v78, v78
  v_exp_f32 v79, v79
  v_cvt_pk_bf16_f32 v228, v72, v73
  v_cvt_pk_bf16_f32 v229, v74, v75
  v_cvt_pk_bf16_f32 v230, v76, v77
  v_cvt_pk_bf16_f32 v231, v78, v79
  v_mfma_f32_32x32x16_bf16 v[64:79], v[96:99], v[24:27], 0
  v_exp_f32 v48, v48
  v_exp_f32 v49, v49
  v_exp_f32 v50, v50
  v_exp_f32 v51, v51
  v_mfma_f32_32x32x16_bf16 v[192:207], v[92:95], v[228:231], v[192:207]
  v_exp_f32 v52, v52
  v_exp_f32 v53, v53
  v_exp_f32 v54, v54
  v_smfmac_f32_16x16x64_bf16 v[220:223], v[12:15], v[224:231], v11
  buffer_load_dwordx4 v[84:87], v3, s[4:7], s30 offen offset:1024
  v_exp_f32 v55, v55
  v_mfma_f32_32x32x16_bf16 v[64:79], v[100:103], v[28:31], v[64:79]
  s_waitcnt vmcnt(10)
  v_cvt_pk_bf16_f32 v224, v48, v49
  v_cvt_pk_bf16_f32 v225, v50, v51
  v_cvt_pk_bf16_f32 v226, v52, v53
  v_cvt_pk_bf16_f32 v227, v54, v55
  v_exp_f32 v56, v56
  v_exp_f32 v57, v57
  v_exp_f32 v58, v58
  v_exp_f32 v59, v59
  v_mfma_f32_32x32x16_bf16 v[144:159], v[104:107], v[224:227], v[144:159]
  v_exp_f32 v60, v60
  v_exp_f32 v61, v61
  v_exp_f32 v62, v62
  v_exp_f32 v63, v63
  v_cvt_pk_bf16_f32 v228, v56, v57
  v_cvt_pk_bf16_f32 v229, v58, v59
  v_cvt_pk_bf16_f32 v230, v60, v61
  v_cvt_pk_bf16_f32 v231, v62, v63
  v_mfma_f32_32x32x16_bf16 v[48:63], v[96:99], v[32:35], 0
  v_exp_f32 v64, v64
  v_exp_f32 v65, v65
  v_exp_f32 v66, v66
  v_exp_f32 v67, v67
  v_mfma_f32_32x32x16_bf16 v[144:159], v[108:111], v[228:231], v[144:159]
  v_exp_f32 v68, v68
  v_exp_f32 v69, v69
  v_exp_f32 v70, v70
  v_smfmac_f32_16x16x64_bf16 v[208:211], v[12:15], v[224:231], v11
  buffer_load_dwordx4 v[88:91], v3, s[4:7], s30 offen offset:2048
  v_exp_f32 v71, v71
  v_mfma_f32_32x32x16_bf16 v[48:63], v[100:103], v[36:39], v[48:63]
  v_cvt_pk_bf16_f32 v224, v64, v65
  v_cvt_pk_bf16_f32 v225, v66, v67
  v_cvt_pk_bf16_f32 v226, v68, v69
  v_cvt_pk_bf16_f32 v227, v70, v71
  v_exp_f32 v72, v72
  v_exp_f32 v73, v73
  v_exp_f32 v74, v74
  v_exp_f32 v75, v75
  v_mfma_f32_32x32x16_bf16 v[160:175], v[104:107], v[224:227], v[160:175]
  v_exp_f32 v76, v76
  v_exp_f32 v77, v77
  v_exp_f32 v78, v78
  v_exp_f32 v79, v79
  v_cvt_pk_bf16_f32 v228, v72, v73
  v_cvt_pk_bf16_f32 v229, v74, v75
  v_cvt_pk_bf16_f32 v230, v76, v77
  v_cvt_pk_bf16_f32 v231, v78, v79
  v_mfma_f32_32x32x16_bf16 v[64:79], v[96:99], v[40:43], 0
  v_exp_f32 v48, v48
  v_exp_f32 v49, v49
  v_exp_f32 v50, v50
  v_exp_f32 v51, v51
  v_mfma_f32_32x32x16_bf16 v[160:175], v[108:111], v[228:231], v[160:175]
  v_exp_f32 v52, v52
  v_exp_f32 v53, v53
  v_exp_f32 v54, v54
  v_smfmac_f32_16x16x64_bf16 v[212:215], v[12:15], v[224:231], v11
  buffer_load_dwordx4 v[92:95], v3, s[4:7], s30 offen offset:3072
  v_exp_f32 v55, v55
  v_mfma_f32_32x32x16_bf16 v[64:79], v[100:103], v[44:47], v[64:79]
  v_cvt_pk_bf16_f32 v224, v48, v49
  v_cvt_pk_bf16_f32 v225, v50, v51
  v_cvt_pk_bf16_f32 v226, v52, v53
  v_cvt_pk_bf16_f32 v227, v54, v55
  v_exp_f32 v56, v56
  v_exp_f32 v57, v57
  v_exp_f32 v58, v58
  v_exp_f32 v59, v59
  v_mfma_f32_32x32x16_bf16 v[176:191], v[104:107], v[224:227], v[176:191]
  s_waitcnt vmcnt(10)
  v_exp_f32 v60, v60
  v_exp_f32 v61, v61
  v_exp_f32 v62, v62
  v_exp_f32 v63, v63
  v_cvt_pk_bf16_f32 v228, v56, v57
  v_cvt_pk_bf16_f32 v229, v58, v59
  v_cvt_pk_bf16_f32 v230, v60, v61
  v_cvt_pk_bf16_f32 v231, v62, v63
  v_mfma_f32_32x32x16_bf16 v[48:63], v[112:115], v[16:19], 0
  v_exp_f32 v64, v64
  v_exp_f32 v65, v65
  v_exp_f32 v66, v66
  v_exp_f32 v67, v67
  v_mfma_f32_32x32x16_bf16 v[176:191], v[108:111], v[228:231], v[176:191]
  v_exp_f32 v68, v68
  v_exp_f32 v69, v69
  v_exp_f32 v70, v70
  v_smfmac_f32_16x16x64_bf16 v[216:219], v[12:15], v[224:231], v11
  buffer_load_dwordx4 v[96:99], v10, s[4:7], s30 offen offset:0
  v_exp_f32 v71, v71
  v_mfma_f32_32x32x16_bf16 v[48:63], v[116:119], v[20:23], v[48:63]
  s_sub_u32 s32, s32, 1
  v_cvt_pk_bf16_f32 v224, v64, v65
  v_cvt_pk_bf16_f32 v225, v66, v67
  v_cvt_pk_bf16_f32 v226, v68, v69
  v_cvt_pk_bf16_f32 v227, v70, v71
  v_exp_f32 v72, v72
  v_exp_f32 v73, v73
  v_exp_f32 v74, v74
  v_exp_f32 v75, v75
  v_mfma_f32_32x32x16_bf16 v[192:207], v[104:107], v[224:227], v[192:207]
  s_cmp_eq_u32 s32, 0
  v_exp_f32 v76, v76
  v_exp_f32 v77, v77
  v_exp_f32 v78, v78
  v_exp_f32 v79, v79
  v_cvt_pk_bf16_f32 v228, v72, v73
  v_cvt_pk_bf16_f32 v229, v74, v75
  v_cvt_pk_bf16_f32 v230, v76, v77
  v_cvt_pk_bf16_f32 v231, v78, v79
  s_cbranch_scc1 .fz_kernel_a_x
.fz_kernel_a_b2:
  v_mfma_f32_32x32x16_bf16 v[64:79], v[112:115], v[24:27], 0
  v_exp_f32 v48, v48
  v_exp_f32 v49, v49
  v_exp_f32 v50, v50
  v_exp_f32 v51, v51
  v_mfma_f32_32x32x16_bf16 v[192:207], v[108:111], v[228:231], v[192:207]
  v_exp_f32 v52, v52
  v_exp_f32 v53, v53
  v_exp_f32 v54, v54
  v_smfmac_f32_16x16x64_bf16 v[220:223], v[12:15], v[224:231], v11
  buffer_load_dwordx4 v[100:103], v10, s[4:7], s30 offen offset:1024
  v_exp_f32 v55, v55
  v_mfma_f32_32x32x16_bf16 v[64:79], v[116:119], v[28:31], v[64:79]
  s_waitcnt vmcnt(10)
  v_cvt_pk_bf16_f32 v224, v48, v49
  v_cvt_pk_bf16_f32 v225, v50, v51
  v_cvt_pk_bf16_f32 v226, v52, v53
  v_cvt_pk_bf16_f32 v227, v54, v55
  v_exp_f32 v56, v56
  v_exp_f32 v57, v57
  v_exp_f32 v58, v58
  v_exp_f32 v59, v59
  v_mfma_f32_32x32x16_bf16 v[144:159], v[120:123], v[224:227], v[144:159]
  v_exp_f32 v60, v60
  v_exp_f32 v61, v61
  v_exp_f32 v62, v62
  v_exp_f32 v63, v63
  v_cvt_pk_bf16_f32 v228, v56, v57
  v_cvt_pk_bf16_f32 v229, v58, v59
  v_cvt_pk_bf16_f32 v230, v60, v61
  v_cvt_pk_bf16_f32 v231, v62, v63
  v_mfma_f32_32x32x16_bf16 v[48:63], v[112:115], v[32:35], 0
  v_exp_f32 v64, v64
  v_exp_f32 v65, v65
  v_exp_f32 v66, v66
  v_exp_f32 v67, v67
  v_mfma_f32_32x32x16_bf16 v[144:159], v[124:127], v[228:231], v[144:159]
  v_exp_f32 v68, v68
  v_exp_f32 v69, v69
  v_exp_f32 v70, v70
  v_smfmac_f32_16x16x64_bf16 v[208:211], v[12:15], v[224:231], v11
  buffer_load_dwordx4 v[104:107], v10, s[4:7], s30 offen offset:2048
  v_exp_f32 v71, v71
  v_mfma_f32_32x32x16_bf16 v[48:63], v[116:119], v[36:39], v[48:63]
  s_ff1_i32_b32 s33, s36
  v_cvt_pk_bf16_f32 v224, v64, v65
  v_cvt_pk_bf16_f32 v225, v66, v67
  v_cvt_pk_bf16_f32 v226, v68, v69
  v_cvt_pk_bf16_f32 v227, v70, v71
  v_exp_f32 v72, v72
  v_exp_f32 v73, v73
  v_exp_f32 v74, v74
  v_exp_f32 v75, v75
  v_mfma_f32_32x32x16_bf16 v[160:175], v[120:123], v[224:227], v[160:175]
  s_bitset0_b32 s36, s33
  v_exp_f32 v76, v76
  v_exp_f32 v77, v77
  v_exp_f32 v78, v78
  v_exp_f32 v79, v79
  v_cvt_pk_bf16_f32 v228, v72, v73
  v_cvt_pk_bf16_f32 v229, v74, v75
  v_cvt_pk_bf16_f32 v230, v76, v77
  v_cvt_pk_bf16_f32 v231, v78, v79
  v_mfma_f32_32x32x16_bf16 v[64:79], v[112:115], v[40:43], 0
  s_lshl_b32 s33, s33, 14
  v_exp_f32 v48, v48
  v_exp_f32 v49, v49
  v_exp_f32 v50, v50
  v_exp_f32 v51, v51
  v_mfma_f32_32x32x16_bf16 v[160:175], v[124:127], v[228:231], v[160:175]
  v_exp_f32 v52, v52
  v_exp_f32 v53, v53
  v_exp_f32 v54, v54
  v_smfmac_f32_16x16x64_bf16 v[212:215], v[12:15], v[224:231], v11
  buffer_load_dwordx4 v[108:111], v10, s[4:7], s30 offen offset:3072
  v_exp_f32 v55, v55
  v_mfma_f32_32x32x16_bf16 v[64:79], v[116:119], v[44:47], v[64:79]
  s_add_u32 s30, s33, s35
  v_cvt_pk_bf16_f32 v224, v48, v49
  v_cvt_pk_bf16_f32 v225, v50, v51
  v_cvt_pk_bf16_f32 v226, v52, v53
  v_cvt_pk_bf16_f32 v227, v54, v55
  v_exp_f32 v56, v56
  v_exp_f32 v57, v57
  v_exp_f32 v58, v58
  v_exp_f32 v59, v59
  v_mfma_f32_32x32x16_bf16 v[176:191], v[120:123], v[224:227], v[176:191]
  s_waitcnt vmcnt(10)
  v_exp_f32 v60, v60
  v_exp_f32 v61, v61
  v_exp_f32 v62, v62
  v_exp_f32 v63, v63
  v_cvt_pk_bf16_f32 v228, v56, v57
  v_cvt_pk_bf16_f32 v229, v58, v59
  v_cvt_pk_bf16_f32 v230, v60, v61
  v_cvt_pk_bf16_f32 v231, v62, v63
  v_mfma_f32_32x32x16_bf16 v[48:63], v[128:131], v[16:19], 0
  s_cbranch_scc1 .fz_kernel_pk32c
.fz_kernel_pk32:
  v_exp_f32 v64, v64
  v_exp_f32 v65, v65
  v_exp_f32 v66, v66
  v_exp_f32 v67, v67
  v_mfma_f32_32x32x16_bf16 v[176:191], v[124:127], v[228:231], v[176:191]
  v_exp_f32 v68, v68
  v_exp_f32 v69, v69
  v_exp_f32 v70, v70
  v_smfmac_f32_16x16x64_bf16 v[216:219], v[12:15], v[224:231], v11
  buffer_load_dwordx4 v[112:115], v3, s[4:7], s30 offen offset:0
  v_exp_f32 v71, v71
  v_mfma_f32_32x32x16_bf16 v[48:63], v[132:135], v[20:23], v[48:63]
  v_cvt_pk_bf16_f32 v224, v64, v65
  v_cvt_pk_bf16_f32 v225, v66, v67
  v_cvt_pk_bf16_f32 v226, v68, v69
  v_cvt_pk_bf16_f32 v227, v70, v71
  v_exp_f32 v72, v72
  v_exp_f32 v73, v73
  v_exp_f32 v74, v74
  v_exp_f32 v75, v75
  v_mfma_f32_32x32x16_bf16 v[192:207], v[120:123], v[224:227], v[192:207]
  v_exp_f32 v76, v76
  v_exp_f32 v77, v77
  v_exp_f32 v78, v78
  v_exp_f32 v79, v79
  v_cvt_pk_bf16_f32 v228, v72, v73
  v_cvt_pk_bf16_f32 v229, v74, v75
  v_cvt_pk_bf16_f32 v230, v76, v77
  v_cvt_pk_bf16_f32 v231, v78, v79
  v_mfma_f32_32x32x16_bf16 v[64:79], v[128:131], v[24:27], 0
  v_exp_f32 v48, v48
  v_exp_f32 v49, v49
  v_exp_f32 v50, v50
  v_exp_f32 v51, v51
  v_mfma_f32_32x32x16_bf16 v[192:207], v[124:127], v[228:231], v[192:207]
  v_exp_f32 v52, v52
  v_exp_f32 v53, v53
  v_exp_f32 v54, v54
  v_smfmac_f32_16x16x64_bf16 v[220:223], v[12:15], v[224:231], v11
  buffer_load_dwordx4 v[116:119], v3, s[4:7], s30 offen offset:1024
  v_exp_f32 v55, v55
  v_mfma_f32_32x32x16_bf16 v[64:79], v[132:135], v[28:31], v[64:79]
  s_waitcnt vmcnt(10)
  v_cvt_pk_bf16_f32 v224, v48, v49
  v_cvt_pk_bf16_f32 v225, v50, v51
  v_cvt_pk_bf16_f32 v226, v52, v53
  v_cvt_pk_bf16_f32 v227, v54, v55
  v_exp_f32 v56, v56
  v_exp_f32 v57, v57
  v_exp_f32 v58, v58
  v_exp_f32 v59, v59
  v_mfma_f32_32x32x16_bf16 v[144:159], v[136:139], v[224:227], v[144:159]
  v_exp_f32 v60, v60
  v_exp_f32 v61, v61
  v_exp_f32 v62, v62
  v_exp_f32 v63, v63
  v_cvt_pk_bf16_f32 v228, v56, v57
  v_cvt_pk_bf16_f32 v229, v58, v59
  v_cvt_pk_bf16_f32 v230, v60, v61
  v_cvt_pk_bf16_f32 v231, v62, v63
  v_mfma_f32_32x32x16_bf16 v[48:63], v[128:131], v[32:35], 0
  v_exp_f32 v64, v64
  v_exp_f32 v65, v65
  v_exp_f32 v66, v66
  v_exp_f32 v67, v67
  v_mfma_f32_32x32x16_bf16 v[144:159], v[140:143], v[228:231], v[144:159]
  v_exp_f32 v68, v68
  v_exp_f32 v69, v69
  v_exp_f32 v70, v70
  v_smfmac_f32_16x16x64_bf16 v[208:211], v[12:15], v[224:231], v11
  buffer_load_dwordx4 v[120:123], v3, s[4:7], s30 offen offset:2048
  v_exp_f32 v71, v71
  v_mfma_f32_32x32x16_bf16 v[48:63], v[132:135], v[36:39], v[48:63]
  v_cvt_pk_bf16_f32 v224, v64, v65
  v_cvt_pk_bf16_f32 v225, v66, v67
  v_cvt_pk_bf16_f32 v226, v68, v69
  v_cvt_pk_bf16_f32 v227, v70, v71
  v_exp_f32 v72, v72
  v_exp_f32 v73, v73
  v_exp_f32 v74, v74
  v_exp_f32 v75, v75
  v_mfma_f32_32x32x16_bf16 v[160:175], v[136:139], v[224:227], v[160:175]
  v_exp_f32 v76, v76
  v_exp_f32 v77, v77
  v_exp_f32 v78, v78
  v_exp_f32 v79, v79
  v_cvt_pk_bf16_f32 v228, v72, v73
  v_cvt_pk_bf16_f32 v229, v74, v75
  v_cvt_pk_bf16_f32 v230, v76, v77
  v_cvt_pk_bf16_f32 v231, v78, v79
  v_mfma_f32_32x32x16_bf16 v[64:79], v[128:131], v[40:43], 0
  v_exp_f32 v48, v48
  v_exp_f32 v49, v49
  v_exp_f32 v50, v50
  v_exp_f32 v51, v51
  v_mfma_f32_32x32x16_bf16 v[160:175], v[140:143], v[228:231], v[160:175]
  v_exp_f32 v52, v52
  v_exp_f32 v53, v53
  v_exp_f32 v54, v54
  v_smfmac_f32_16x16x64_bf16 v[212:215], v[12:15], v[224:231], v11
  buffer_load_dwordx4 v[124:127], v3, s[4:7], s30 offen offset:3072
  v_exp_f32 v55, v55
  v_mfma_f32_32x32x16_bf16 v[64:79], v[132:135], v[44:47], v[64:79]
  v_cvt_pk_bf16_f32 v224, v48, v49
  v_cvt_pk_bf16_f32 v225, v50, v51
  v_cvt_pk_bf16_f32 v226, v52, v53
  v_cvt_pk_bf16_f32 v227, v54, v55
  v_exp_f32 v56, v56
  v_exp_f32 v57, v57
  v_exp_f32 v58, v58
  v_exp_f32 v59, v59
  v_mfma_f32_32x32x16_bf16 v[176:191], v[136:139], v[224:227], v[176:191]
  s_waitcnt vmcnt(10)
  v_exp_f32 v60, v60
  v_exp_f32 v61, v61
  v_exp_f32 v62, v62
  v_exp_f32 v63, v63
  v_cvt_pk_bf16_f32 v228, v56, v57
  v_cvt_pk_bf16_f32 v229, v58, v59
  v_cvt_pk_bf16_f32 v230, v60, v61
  v_cvt_pk_bf16_f32 v231, v62, v63
  v_mfma_f32_32x32x16_bf16 v[48:63], v[80:83], v[16:19], 0
  v_exp_f32 v64, v64
  v_exp_f32 v65, v65
  v_exp_f32 v66, v66
  v_exp_f32 v67, v67
  v_mfma_f32_32x32x16_bf16 v[176:191], v[140:143], v[228:231], v[176:191]
  v_exp_f32 v68, v68
  v_exp_f32 v69, v69
  v_exp_f32 v70, v70
  v_smfmac_f32_16x16x64_bf16 v[216:219], v[12:15], v[224:231], v11
  buffer_load_dwordx4 v[128:131], v10, s[4:7], s30 offen offset:0
  v_exp_f32 v71, v71
  v_mfma_f32_32x32x16_bf16 v[48:63], v[84:87], v[20:23], v[48:63]
  v_cvt_pk_bf16_f32 v224, v64, v65
  v_cvt_pk_bf16_f32 v225, v66, v67
  v_cvt_pk_bf16_f32 v226, v68, v69
  v_cvt_pk_bf16_f32 v227, v70, v71
  v_exp_f32 v72, v72
  v_exp_f32 v73, v73
  v_exp_f32 v74, v74
  v_exp_f32 v75, v75
  v_mfma_f32_32x32x16_bf16 v[192:207], v[136:139], v[224:227], v[192:207]
  v_exp_f32 v76, v76
  v_exp_f32 v77, v77
  v_exp_f32 v78, v78
  v_exp_f32 v79, v79
  v_cvt_pk_bf16_f32 v228, v72, v73
  v_cvt_pk_bf16_f32 v229, v74, v75
  v_cvt_pk_bf16_f32 v230, v76, v77
  v_cvt_pk_bf16_f32 v231, v78, v79
  s_branch .fz_kernel_a_loop
.fz_kernel_a_x:
  s_waitcnt vmcnt(7)
  v_mfma_f32_32x32x16_bf16 v[64:79], v[128:131], v[16:19], 0
  v_exp_f32 v48, v48
  v_exp_f32 v49, v49
  v_exp_f32 v50, v50
  v_exp_f32 v51, v51
  v_mfma_f32_32x32x16_bf16 v[192:207], v[108:111], v[228:231], v[192:207]
  v_exp_f32 v52, v52
  v_exp_f32 v53, v53
  v_exp_f32 v54, v54
  v_smfmac_f32_16x16x64_bf16 v[220:223], v[12:15], v[224:231], v11
  v_exp_f32 v55, v55
  v_mfma_f32_32x32x16_bf16 v[64:79], v[132:135], v[20:23], v[64:79]
  s_waitcnt vmcnt(5)
  v_cvt_pk_bf16_f32 v224, v48, v49
  v_cvt_pk_bf16_f32 v225, v50, v51
  v_cvt_pk_bf16_f32 v226, v52, v53
  v_cvt_pk_bf16_f32 v227, v54, v55
  v_exp_f32 v56, v56
  v_exp_f32 v57, v57
  v_exp_f32 v58, v58
  v_exp_f32 v59, v59
  v_mfma_f32_32x32x16_bf16 v[144:159], v[120:123], v[224:227], v[144:159]
  v_exp_f32 v60, v60
  v_exp_f32 v61, v61
  v_exp_f32 v62, v62
  v_exp_f32 v63, v63
  v_cvt_pk_bf16_f32 v228, v56, v57
  v_cvt_pk_bf16_f32 v229, v58, v59
  v_cvt_pk_bf16_f32 v230, v60, v61
  v_cvt_pk_bf16_f32 v231, v62, v63
  v_mfma_f32_32x32x16_bf16 v[48:63], v[112:115], v[24:27], 0
  v_exp_f32 v64, v64
  v_exp_f32 v65, v65
  v_exp_f32 v66, v66
  v_exp_f32 v67, v67
  v_mfma_f32_32x32x16_bf16 v[144:159], v[124:127], v[228:231], v[144:159]
  v_exp_f32 v68, v68
  v_exp_f32 v69, v69
  v_exp_f32 v70, v70
  v_smfmac_f32_16x16x64_bf16 v[208:211], v[12:15], v[224:231], v11
  v_exp_f32 v71, v71
  v_mfma_f32_32x32x16_bf16 v[48:63], v[116:119], v[28:31], v[48:63]
  v_cvt_pk_bf16_f32 v224, v64, v65
  v_cvt_pk_bf16_f32 v225, v66, v67
  v_cvt_pk_bf16_f32 v226, v68, v69
  v_cvt_pk_bf16_f32 v227, v70, v71
  v_exp_f32 v72, v72
  v_exp_f32 v73, v73
  v_exp_f32 v74, v74
  v_exp_f32 v75, v75
  v_mfma_f32_32x32x16_bf16 v[144:159], v[136:139], v[224:227], v[144:159]
  v_exp_f32 v76, v76
  v_exp_f32 v77, v77
  v_exp_f32 v78, v78
  v_exp_f32 v79, v79
  v_cvt_pk_bf16_f32 v228, v72, v73
  v_cvt_pk_bf16_f32 v229, v74, v75
  v_cvt_pk_bf16_f32 v230, v76, v77
  v_cvt_pk_bf16_f32 v231, v78, v79
  v_mfma_f32_32x32x16_bf16 v[64:79], v[128:131], v[24:27], 0
  v_exp_f32 v48, v48
  v_exp_f32 v49, v49
  v_exp_f32 v50, v50
  v_exp_f32 v51, v51
  v_mfma_f32_32x32x16_bf16 v[144:159], v[140:143], v[228:231], v[144:159]
  v_exp_f32 v52, v52
  v_exp_f32 v53, v53
  v_exp_f32 v54, v54
  v_smfmac_f32_16x16x64_bf16 v[208:211], v[12:15], v[224:231], v11
  v_exp_f32 v55, v55
  v_mfma_f32_32x32x16_bf16 v[64:79], v[132:135], v[28:31], v[64:79]
  v_cvt_pk_bf16_f32 v224, v48, v49
  v_cvt_pk_bf16_f32 v225, v50, v51
  v_cvt_pk_bf16_f32 v226, v52, v53
  v_cvt_pk_bf16_f32 v227, v54, v55
  v_exp_f32 v56, v56
  v_exp_f32 v57, v57
  v_exp_f32 v58, v58
  v_exp_f32 v59, v59
  v_mfma_f32_32x32x16_bf16 v[160:175], v[120:123], v[224:227], v[160:175]
  v_exp_f32 v60, v60
  v_exp_f32 v61, v61
  v_exp_f32 v62, v62
  v_exp_f32 v63, v63
  v_cvt_pk_bf16_f32 v228, v56, v57
  v_cvt_pk_bf16_f32 v229, v58, v59
  v_cvt_pk_bf16_f32 v230, v60, v61
  v_cvt_pk_bf16_f32 v231, v62, v63
  v_cvt_pk_bf16_f32 v144, v144, v145
  v_cvt_pk_bf16_f32 v145, v146, v147
  v_cvt_pk_bf16_f32 v146, v148, v149
  v_cvt_pk_bf16_f32 v147, v150, v151
  ds_write_b128 v9, v[144:147] offset:0
  v_cvt_pk_bf16_f32 v148, v152, v153
  v_cvt_pk_bf16_f32 v149, v154, v155
  v_cvt_pk_bf16_f32 v150, v156, v157
  v_cvt_pk_bf16_f32 v151, v158, v159
  ds_write_b128 v9, v[148:151] offset:1024
  v_add_f32 v208, v208, v210
  v_add_f32 v209, v209, v211
  v_cndmask_b32 v30, v208, v209, s[26:27]
  v_mfma_f32_32x32x16_bf16 v[48:63], v[112:115], v[32:35], 0
  v_exp_f32 v64, v64
  v_exp_f32 v65, v65
  v_exp_f32 v66, v66
  v_exp_f32 v67, v67
  v_mfma_f32_32x32x16_bf16 v[160:175], v[124:127], v[228:231], v[160:175]
  v_exp_f32 v68, v68
  v_exp_f32 v69, v69
  v_exp_f32 v70, v70
  v_smfmac_f32_16x16x64_bf16 v[212:215], v[12:15], v[224:231], v11
  v_exp_f32 v71, v71
  v_mfma_f32_32x32x16_bf16 v[48:63], v[116:119], v[36:39], v[48:63]
  v_cvt_pk_bf16_f32 v224, v64, v65
  v_cvt_pk_bf16_f32 v225, v66, v67
  v_cvt_pk_bf16_f32 v226, v68, v69
  v_cvt_pk_bf16_f32 v227, v70, v71
  v_exp_f32 v72, v72
  v_exp_f32 v73, v73
  v_exp_f32 v74, v74
  v_exp_f32 v75, v75
  v_mfma_f32_32x32x16_bf16 v[160:175], v[136:139], v[224:227], v[160:175]
  v_exp_f32 v76, v76
  v_exp_f32 v77, v77
  v_exp_f32 v78, v78
  v_exp_f32 v79, v79
  v_cvt_pk_bf16_f32 v228, v72, v73
  v_cvt_pk_bf16_f32 v229, v74, v75
  v_cvt_pk_bf16_f32 v230, v76, v77
  v_cvt_pk_bf16_f32 v231, v78, v79
  v_mfma_f32_32x32x16_bf16 v[64:79], v[128:131], v[32:35], 0
  v_exp_f32 v48, v48
  v_exp_f32 v49, v49
  v_exp_f32 v50, v50
  v_exp_f32 v51, v51
  v_mfma_f32_32x32x16_bf16 v[160:175], v[140:143], v[228:231], v[160:175]
  v_exp_f32 v52, v52
  v_exp_f32 v53, v53
  v_exp_f32 v54, v54
  v_smfmac_f32_16x16x64_bf16 v[212:215], v[12:15], v[224:231], v11
  v_exp_f32 v55, v55
  v_mfma_f32_32x32x16_bf16 v[64:79], v[132:135], v[36:39], v[64:79]
  v_cvt_pk_bf16_f32 v224, v48, v49
  v_cvt_pk_bf16_f32 v225, v50, v51
  v_cvt_pk_bf16_f32 v226, v52, v53
  v_cvt_pk_bf16_f32 v227, v54, v55
  v_exp_f32 v56, v56
  v_exp_f32 v57, v57
  v_exp_f32 v58, v58
  v_exp_f32 v59, v59
  v_mfma_f32_32x32x16_bf16 v[176:191], v[120:123], v[224:227], v[176:191]
  v_exp_f32 v60, v60
  v_exp_f32 v61, v61
  v_exp_f32 v62, v62
  v_exp_f32 v63, v63
  v_cvt_pk_bf16_f32 v228, v56, v57
  v_cvt_pk_bf16_f32 v229, v58, v59
  v_cvt_pk_bf16_f32 v230, v60, v61
  v_cvt_pk_bf16_f32 v231, v62, v63
  v_cvt_pk_bf16_f32 v160, v160, v161
  v_cvt_pk_bf16_f32 v161, v162, v163
  v_cvt_pk_bf16_f32 v162, v164, v165
  v_cvt_pk_bf16_f32 v163, v166, v167
  ds_write_b128 v9, v[160:163] offset:2048
  v_cvt_pk_bf16_f32 v164, v168, v169
  v_cvt_pk_bf16_f32 v165, v170, v171
  v_cvt_pk_bf16_f32 v166, v172, v173
  v_cvt_pk_bf16_f32 v167, v174, v175
  ds_write_b128 v9, v[164:167] offset:3072
  v_add_f32 v212, v212, v214
  v_add_f32 v213, v213, v215
  v_cndmask_b32 v31, v212, v213, s[26:27]
  ds_write_b64 v1, v[30:31]
  v_xor_b32 v1, 512, v1
  v_mfma_f32_32x32x16_bf16 v[48:63], v[112:115], v[40:43], 0
  v_exp_f32 v64, v64
  v_exp_f32 v65, v65
  v_exp_f32 v66, v66
  v_exp_f32 v67, v67
  v_mfma_f32_32x32x16_bf16 v[176:191], v[124:127], v[228:231], v[176:191]
  v_exp_f32 v68, v68
  v_exp_f32 v69, v69
  v_exp_f32 v70, v70
  v_smfmac_f32_16x16x64_bf16 v[216:219], v[12:15], v[224:231], v11
  s_waitcnt vmcnt(0) lgkmcnt(0)
  s_barrier
  ds_read_b128 v[80:83], v8 offset:0
  ds_read_b128 v[84:87], v8 offset:1024
  ds_read_b128 v[88:91], v8 offset:2048
  ds_read_b128 v[92:95], v8 offset:3072
  ds_read_b64 v[30:31], v1
  v_exp_f32 v71, v71
  v_mfma_f32_32x32x16_bf16 v[48:63], v[116:119], v[44:47], v[48:63]
  v_cvt_pk_bf16_f32 v224, v64, v65
  v_cvt_pk_bf16_f32 v225, v66, v67
  v_cvt_pk_bf16_f32 v226, v68, v69
  v_cvt_pk_bf16_f32 v227, v70, v71
  v_exp_f32 v72, v72
  v_exp_f32 v73, v73
  v_exp_f32 v74, v74
  v_exp_f32 v75, v75
  v_mfma_f32_32x32x16_bf16 v[176:191], v[136:139], v[224:227], v[176:191]
  v_exp_f32 v76, v76
  v_exp_f32 v77, v77
  s_waitcnt lgkmcnt(0)
  v_mfma_f32_32x32x16_bf16 v[176:191], v[248:251], v[80:83], v[176:191]
  v_exp_f32 v78, v78
  v_exp_f32 v79, v79
  v_mfma_f32_32x32x16_bf16 v[176:191], v[252:255], v[84:87], v[176:191]
  v_cvt_pk_bf16_f32 v228, v72, v73
  v_cvt_pk_bf16_f32 v229, v74, v75
  v_cvt_pk_bf16_f32 v230, v76, v77
  v_cvt_pk_bf16_f32 v231, v78, v79
  v_mfma_f32_32x32x16_bf16 v[64:79], v[128:131], v[40:43], 0
  v_exp_f32 v48, v48
  v_exp_f32 v49, v49
  v_exp_f32 v50, v50
  v_exp_f32 v51, v51
  v_mfma_f32_32x32x16_bf16 v[176:191], v[140:143], v[228:231], v[176:191]
  v_exp_f32 v52, v52
  v_exp_f32 v53, v53
  v_exp_f32 v54, v54
  v_smfmac_f32_16x16x64_bf16 v[216:219], v[12:15], v[224:231], v11
  v_exp_f32 v55, v55
  v_mfma_f32_32x32x16_bf16 v[64:79], v[132:135], v[44:47], v[64:79]
  v_cvt_pk_bf16_f32 v224, v48, v49
  v_cvt_pk_bf16_f32 v225, v50, v51
  v_cvt_pk_bf16_f32 v226, v52, v53
  v_cvt_pk_bf16_f32 v227, v54, v55
  v_exp_f32 v56, v56
  v_exp_f32 v57, v57
  v_exp_f32 v58, v58
  v_exp_f32 v59, v59
  s_nop 1
  v_add_f32 v216, v216, v218
  v_add_f32 v217, v217, v219
  v_cndmask_b32 v24, v216, v217, s[26:27]
  v_add_f32 v24, v24, v30
  s_mov_b64 s[36:37], -1
  v_rcp_f32 v26, v24
  v_cmp_le_f32 vcc, s24, v24
  s_and_b64 s[36:37], s[36:37], vcc
  v_cmp_ge_f32 vcc, s25, v24
  s_and_b64 s[36:37], s[36:37], vcc
  v_pk_mul_f32 v[176:177], v[176:177], v[26:27] op_sel_hi:[1,0]
  v_pk_mul_f32 v[178:179], v[178:179], v[26:27] op_sel_hi:[1,0]
  v_pk_mul_f32 v[180:181], v[180:181], v[26:27] op_sel_hi:[1,0]
  v_pk_mul_f32 v[182:183], v[182:183], v[26:27] op_sel_hi:[1,0]
  v_cvt_pk_bf16_f32 v80, v176, v177
  v_cvt_pk_bf16_f32 v81, v178, v179
  v_cvt_pk_bf16_f32 v82, v180, v181
  v_cvt_pk_bf16_f32 v83, v182, v183
  buffer_store_dwordx4 v[80:83], v3, s[4:7], s28 offen offset:0 sc1
  v_pk_mul_f32 v[184:185], v[184:185], v[26:27] op_sel_hi:[1,0]
  v_pk_mul_f32 v[186:187], v[186:187], v[26:27] op_sel_hi:[1,0]
  v_pk_mul_f32 v[188:189], v[188:189], v[26:27] op_sel_hi:[1,0]
  v_pk_mul_f32 v[190:191], v[190:191], v[26:27] op_sel_hi:[1,0]
  v_cvt_pk_bf16_f32 v84, v184, v185
  v_cvt_pk_bf16_f32 v85, v186, v187
  v_cvt_pk_bf16_f32 v86, v188, v189
  v_cvt_pk_bf16_f32 v87, v190, v191
  buffer_store_dwordx4 v[84:87], v3, s[4:7], s28 offen offset:1024 sc1
  v_mfma_f32_32x32x16_bf16 v[192:207], v[120:123], v[224:227], v[192:207]
  v_exp_f32 v60, v60
  v_exp_f32 v61, v61
  v_exp_f32 v62, v62
  v_exp_f32 v63, v63
  v_cvt_pk_bf16_f32 v228, v56, v57
  v_cvt_pk_bf16_f32 v229, v58, v59
  v_cvt_pk_bf16_f32 v230, v60, v61
  v_cvt_pk_bf16_f32 v231, v62, v63
  v_mfma_f32_32x32x16_bf16 v[192:207], v[248:251], v[88:91], v[192:207]
  v_exp_f32 v64, v64
  v_exp_f32 v65, v65
  v_exp_f32 v66, v66
  v_exp_f32 v67, v67
  v_mfma_f32_32x32x16_bf16 v[192:207], v[124:127], v[228:231], v[192:207]
  v_exp_f32 v68, v68
  v_exp_f32 v69, v69
  v_exp_f32 v70, v70
  v_smfmac_f32_16x16x64_bf16 v[220:223], v[12:15], v[224:231], v11
  v_exp_f32 v71, v71
  v_mfma_f32_32x32x16_bf16 v[192:207], v[252:255], v[92:95], v[192:207]
  v_cvt_pk_bf16_f32 v224, v64, v65
  v_cvt_pk_bf16_f32 v225, v66, v67
  v_cvt_pk_bf16_f32 v226, v68, v69
  v_cvt_pk_bf16_f32 v227, v70, v71
  v_exp_f32 v72, v72
  v_exp_f32 v73, v73
  v_exp_f32 v74, v74
  v_exp_f32 v75, v75
  v_mfma_f32_32x32x16_bf16 v[192:207], v[136:139], v[224:227], v[192:207]
  v_exp_f32 v76, v76
  v_exp_f32 v77, v77
  v_exp_f32 v78, v78
  v_exp_f32 v79, v79
  v_cvt_pk_bf16_f32 v228, v72, v73
  v_cvt_pk_bf16_f32 v229, v74, v75
  v_cvt_pk_bf16_f32 v230, v76, v77
  v_cvt_pk_bf16_f32 v231, v78, v79
  s_nop 1
  v_smfmac_f32_16x16x64_bf16 v[220:223], v[12:15], v[224:231], v11
  v_mfma_f32_32x32x16_bf16 v[192:207], v[140:143], v[228:231], v[192:207]
  s_nop 10
  v_add_f32 v220, v220, v222
  v_add_f32 v221, v221, v223
  v_cndmask_b32 v25, v220, v221, s[26:27]
  v_add_f32 v25, v25, v31
.fz_kernel_a_fin:
  v_rcp_f32 v28, v25
  v_cmp_le_f32 vcc, s24, v25
  s_and_b64 s[36:37], s[36:37], vcc
  v_cmp_ge_f32 vcc, s25, v25
  s_and_b64 s[36:37], s[36:37], vcc
  v_pk_mul_f32 v[192:193], v[192:193], v[28:29] op_sel_hi:[1,0]
  v_pk_mul_f32 v[194:195], v[194:195], v[28:29] op_sel_hi:[1,0]
  v_pk_mul_f32 v[196:197], v[196:197], v[28:29] op_sel_hi:[1,0]
  v_pk_mul_f32 v[198:199], v[198:199], v[28:29] op_sel_hi:[1,0]
  v_cvt_pk_bf16_f32 v88, v192, v193
  v_cvt_pk_bf16_f32 v89, v194, v195
  v_cvt_pk_bf16_f32 v90, v196, v197
  v_cvt_pk_bf16_f32 v91, v198, v199
  buffer_store_dwordx4 v[88:91], v3, s[4:7], s29 offen offset:0 sc1
  v_pk_mul_f32 v[200:201], v[200:201], v[28:29] op_sel_hi:[1,0]
  v_pk_mul_f32 v[202:203], v[202:203], v[28:29] op_sel_hi:[1,0]
  v_pk_mul_f32 v[204:205], v[204:205], v[28:29] op_sel_hi:[1,0]
  v_pk_mul_f32 v[206:207], v[206:207], v[28:29] op_sel_hi:[1,0]
  v_cvt_pk_bf16_f32 v92, v200, v201
  v_cvt_pk_bf16_f32 v93, v202, v203
  v_cvt_pk_bf16_f32 v94, v204, v205
  v_cvt_pk_bf16_f32 v95, v206, v207
  buffer_store_dwordx4 v[92:95], v3, s[4:7], s29 offen offset:1024 sc1
  ds_read_b32 v7, v6 offset:8
  v_pk_fma_f32 v[64:65], v[176:177], 0, 0 op_sel_hi:[1,0,0]
  v_pk_fma_f32 v[66:67], v[178:179], 0, 0 op_sel_hi:[1,0,0]
  v_pk_fma_f32 v[64:65], v[180:181], 0, v[64:65] op_sel_hi:[1,0,1]
  v_pk_fma_f32 v[66:67], v[182:183], 0, v[66:67] op_sel_hi:[1,0,1]
  v_pk_fma_f32 v[64:65], v[184:185], 0, v[64:65] op_sel_hi:[1,0,1]
  v_pk_fma_f32 v[66:67], v[186:187], 0, v[66:67] op_sel_hi:[1,0,1]
  v_pk_fma_f32 v[64:65], v[188:189], 0, v[64:65] op_sel_hi:[1,0,1]
  v_pk_fma_f32 v[66:67], v[190:191], 0, v[66:67] op_sel_hi:[1,0,1]
  v_pk_fma_f32 v[64:65], v[192:193], 0, v[64:65] op_sel_hi:[1,0,1]
  v_pk_fma_f32 v[66:67], v[194:195], 0, v[66:67] op_sel_hi:[1,0,1]
  v_pk_fma_f32 v[64:65], v[196:197], 0, v[64:65] op_sel_hi:[1,0,1]
  v_pk_fma_f32 v[66:67], v[198:199], 0, v[66:67] op_sel_hi:[1,0,1]
  v_pk_fma_f32 v[64:65], v[200:201], 0, v[64:65] op_sel_hi:[1,0,1]
  v_pk_fma_f32 v[66:67], v[202:203], 0, v[66:67] op_sel_hi:[1,0,1]
  v_pk_fma_f32 v[64:65], v[204:205], 0, v[64:65] op_sel_hi:[1,0,1]
  v_pk_fma_f32 v[66:67], v[206:207], 0, v[66:67] op_sel_hi:[1,0,1]
  v_pk_add_f32 v[64:65], v[64:65], v[66:67]
  v_cmp_o_f32 vcc, v64, v65
  s_and_b64 s[36:37], s[36:37], vcc
  s_cmp_eq_u64 s[36:37], -1
  s_cbranch_scc0 .fz_kernel_a_slow
.fz_kernel_a_ok:
  s_mov_b32 s8, s48
  s_mov_b32 s9, s49
  s_mov_b32 s10, 0x800
  s_mov_b32 s11, 0x00020000
  v_lshrrev_b32 v17, 5, v2
  v_lshlrev_b32 v19, 4, v17
  s_lshl_b32 s22, s18, 7
  s_lshl2_add_u32 s32, s17, s16
  s_lshl_b32 s35, s32, 16
  s_add_u32 s35, s35, s64
  s_mov_b32 s34, 0
  s_and_b32 s28, s18, 3
  s_mul_i32 s28, s28, 0
  v_add_u32 v6, 8, v6
  buffer_load_dwordx4 v[48:51], v19, s[8:11], s22 offen offset:0
  buffer_load_dwordx4 v[52:55], v19, s[8:11], s22 offen offset:32
  buffer_load_dwordx4 v[56:59], v19, s[8:11], s22 offen offset:64
  buffer_load_dwordx4 v[60:63], v19, s[8:11], s22 offen offset:96
  s_waitcnt lgkmcnt(0)
  v_readfirstlane_b32 s36, v7
  s_bcnt1_i32_b32 s29, s36
  s_cmp_lt_u32 s29, 2
  s_cbranch_scc1 .fz_kernel_w_e0
  s_andn2_b32 s33, s36, s34
  s_cbranch_scc0 .fz_kernel_pk41c
.fz_kernel_pk41:
  s_ff1_i32_b32 s33, s33
  s_bitset1_b32 s34, s33
  s_lshl_b32 s20, s33, 13
  s_lshl_b32 s33, s33, 12
  s_add_u32 s30, s33, s35
  buffer_load_dwordx4 v[96:99], v3, s[4:7], s30 offen offset:0
  buffer_load_dwordx4 v[100:103], v3, s[4:7], s30 offen offset:1024
  buffer_load_dwordx4 v[104:107], v3, s[4:7], s30 offen offset:2048
  buffer_load_dwordx4 v[108:111], v3, s[4:7], s30 offen offset:3072
  s_andn2_b32 s33, s36, s34
  s_cbranch_scc0 .fz_kernel_pk42c
.fz_kernel_pk42:
  s_ff1_i32_b32 s33, s33
  s_bitset1_b32 s34, s33
  s_lshl_b32 s21, s33, 13
  s_lshl_b32 s33, s33, 12
  s_add_u32 s30, s33, s35
  buffer_load_dwordx4 v[112:115], v3, s[4:7], s30 offen offset:0
  buffer_load_dwordx4 v[116:119], v3, s[4:7], s30 offen offset:1024
  buffer_load_dwordx4 v[120:123], v3, s[4:7], s30 offen offset:2048
  buffer_load_dwordx4 v[124:127], v3, s[4:7], s30 offen offset:3072
.fz_kernel_w_e0:
  v_and_b32 v18, 31, v2
  s_lshl_b32 s39, s17, 4
  s_add_u32 s39, s39, s18
  s_lshl_b32 s39, s39, 2
  s_add_u32 s39, s39, s16
  s_lshl_b32 s39, s39, 12
  v_and_b32 v16, 16, v2
  v_lshlrev_b32 v16, 7, v16
  v_lshl_add_u32 v16, v17, 8, v16
  v_and_b32 v1, 0xf0, v3
  v_add_u32 v16, v16, v1
  s_add_u32 s39, s39, s65
  s_lshl_b32 s31, s16, 5
  v_add_u32 v45, s31, v18
  v_lshlrev_b32 v11, 2, v45
  v_add_u32 v11, 155648, v11
  v_mov_b32 v44, 159952
  ds_read_b32 v40, v11 offset:6400
  ds_read_b32 v42, v11 offset:6912
  ds_read_b32 v46, v44 offset:8
  ds_read_b32 v44, v44
  v_mov_b32 v47, 0.32768
  v_add_u32 v45, 1, v45
  v_bfe_u32 v11, v2, 2, 2
  v_lshl_add_u32 v12, v17, 2, v11
  v_lshlrev_b32 v12, 7, v12
  v_lshrrev_b32 v13, 1, v11
  v_lshl_add_u32 v12, v13, 6, v12
  v_bfe_u32 v13, v2, 4, 1
  v_lshl_add_u32 v12, v13, 5, v12
  v_and_b32 v13, 1, v2
  v_lshl_add_u32 v12, v13, 4, v12
  v_bfe_u32 v13, v2, 1, 1
  v_lshl_add_u32 v14, v13, 3, v12
  v_xor_b32 v15, 64, v14
  s_mov_b64 exec, 1
  s_cmp_lt_u32 s29, 2
  s_cbranch_scc1 .fz_kernel_w_e1
  s_waitcnt vmcnt(12)
  s_branch .fz_kernel_w_e3
.fz_kernel_w_e1:
  s_waitcnt vmcnt(4)
.fz_kernel_w_e3:
  ds_add_u32 v6, v5 offset:0x100
  s_mov_b64 exec, -1
  v_lshlrev_b32 v64, 16, v232
  v_and_b32 v65, 0xffff0000, v232
  v_lshlrev_b32 v66, 16, v233
  v_and_b32 v67, 0xffff0000, v233
  v_lshlrev_b32 v68, 16, v234
  v_and_b32 v69, 0xffff0000, v234
  v_lshlrev_b32 v70, 16, v235
  v_and_b32 v71, 0xffff0000, v235
  v_lshlrev_b32 v72, 16, v236
  v_and_b32 v73, 0xffff0000, v236
  v_lshlrev_b32 v74, 16, v237
  v_and_b32 v75, 0xffff0000, v237
  v_lshlrev_b32 v76, 16, v238
  v_and_b32 v77, 0xffff0000, v238
  v_lshlrev_b32 v78, 16, v239
  v_and_b32 v79, 0xffff0000, v239
  v_lshlrev_b32 v80, 16, v240
  v_and_b32 v81, 0xffff0000, v240
  v_lshlrev_b32 v82, 16, v241
  v_and_b32 v83, 0xffff0000, v241
  v_lshlrev_b32 v84, 16, v242
  v_and_b32 v85, 0xffff0000, v242
  v_lshlrev_b32 v86, 16, v243
  v_and_b32 v87, 0xffff0000, v243
  v_lshlrev_b32 v88, 16, v244
  v_and_b32 v89, 0xffff0000, v244
  v_lshlrev_b32 v90, 16, v245
  v_and_b32 v91, 0xffff0000, v245
  v_lshlrev_b32 v92, 16, v246
  v_and_b32 v93, 0xffff0000, v246
  v_lshlrev_b32 v94, 16, v247
  v_and_b32 v95, 0xffff0000, v247
  s_waitcnt lgkmcnt(0)
  v_pk_fma_f32 v[64:65], v[64:65], v[40:41], v[42:43] op_sel_hi:[1,0,0]
  v_pk_fma_f32 v[66:67], v[66:67], v[40:41], v[42:43] op_sel_hi:[1,0,0]
  v_pk_fma_f32 v[68:69], v[68:69], v[40:41], v[42:43] op_sel_hi:[1,0,0]
  v_pk_fma_f32 v[70:71], v[70:71], v[40:41], v[42:43] op_sel_hi:[1,0,0]
  v_pk_fma_f32 v[72:73], v[72:73], v[40:41], v[42:43] op_sel_hi:[1,0,0]
  v_pk_fma_f32 v[74:75], v[74:75], v[40:41], v[42:43] op_sel_hi:[1,0,0]
  v_pk_fma_f32 v[76:77], v[76:77], v[40:41], v[42:43] op_sel_hi:[1,0,0]
  v_pk_fma_f32 v[78:79], v[78:79], v[40:41], v[42:43] op_sel_hi:[1,0,0]
  v_pk_fma_f32 v[80:81], v[80:81], v[40:41], v[42:43] op_sel_hi:[1,0,0]
  v_pk_fma_f32 v[82:83], v[82:83], v[40:41], v[42:43] op_sel_hi:[1,0,0]
  v_pk_fma_f32 v[84:85], v[84:85], v[40:41], v[42:43] op_sel_hi:[1,0,0]
  v_pk_fma_f32 v[86:87], v[86:87], v[40:41], v[42:43] op_sel_hi:[1,0,0]
  v_pk_fma_f32 v[88:89], v[88:89], v[40:41], v[42:43] op_sel_hi:[1,0,0]
  v_pk_fma_f32 v[90:91], v[90:91], v[40:41], v[42:43] op_sel_hi:[1,0,0]
  v_pk_fma_f32 v[92:93], v[92:93], v[40:41], v[42:43] op_sel_hi:[1,0,0]
  v_pk_fma_f32 v[94:95], v[94:95], v[40:41], v[42:43] op_sel_hi:[1,0,0]
  v_cmp_eq_u32 vcc, v44, v45
  s_cbranch_vccnz .fz_kernel_w_pt
.fz_kernel_w_pb:
  s_cmp_ge_u32 s29, 2
  s_cbranch_scc1 .fz_kernel_w_e2
  s_andn2_b32 s33, s36, s34
  s_cbranch_scc0 .fz_kernel_pk43c
.fz_kernel_pk43:
  s_ff1_i32_b32 s33, s33
  s_bitset1_b32 s34, s33
  s_lshl_b32 s20, s33, 13
  s_lshl_b32 s33, s33, 12
  s_add_u32 s30, s33, s35
  buffer_load_dwordx4 v[96:99], v3, s[4:7], s30 offen offset:0
  buffer_load_dwordx4 v[100:103], v3, s[4:7], s30 offen offset:1024
  buffer_load_dwordx4 v[104:107], v3, s[4:7], s30 offen offset:2048
  buffer_load_dwordx4 v[108:111], v3, s[4:7], s30 offen offset:3072
  s_andn2_b32 s33, s36, s34
  s_cbranch_scc0 .fz_kernel_pk44c
.fz_kernel_pk44:
  s_ff1_i32_b32 s33, s33
  s_bitset1_b32 s34, s33
  s_lshl_b32 s21, s33, 13
  s_lshl_b32 s33, s33, 12
  s_add_u32 s30, s33, s35
  buffer_load_dwordx4 v[112:115], v3, s[4:7], s30 offen offset:0
  buffer_load_dwordx4 v[116:119], v3, s[4:7], s30 offen offset:1024
  buffer_load_dwordx4 v[120:123], v3, s[4:7], s30 offen offset:2048
  buffer_load_dwordx4 v[124:127], v3, s[4:7], s30 offen offset:3072
.fz_kernel_w_e2:
  s_andn2_b32 s33, s36, s34
  s_cbranch_scc0 .fz_kernel_pk45c
.fz_kernel_pk45:
  s_ff1_i32_b32 s33, s33
  s_bitset1_b32 s34, s33
  s_lshl_b32 s22, s33, 13
  s_lshl_b32 s33, s33, 12
  s_add_u32 s30, s33, s35
  buffer_load_dwordx4 v[128:131], v3, s[4:7], s30 offen offset:0
  buffer_load_dwordx4 v[132:135], v3, s[4:7], s30 offen offset:1024
  buffer_load_dwordx4 v[136:139], v3, s[4:7], s30 offen offset:2048
  buffer_load_dwordx4 v[140:143], v3, s[4:7], s30 offen offset:3072
  v_add_u32 v10, s20, v14
  v_add_u32 v11, s20, v15
  ds_read_b64_tr_b16 v[224:225], v10 offset:0
  ds_read_b64_tr_b16 v[226:227], v10 offset:1024
  ds_read_b64_tr_b16 v[228:229], v11 offset:0
  ds_read_b64_tr_b16 v[230:231], v11 offset:1024
  ds_read_b64_tr_b16 v[232:233], v10 offset:2048
  ds_read_b64_tr_b16 v[234:235], v10 offset:3072
  ds_read_b64_tr_b16 v[236:237], v11 offset:2048
  ds_read_b64_tr_b16 v[238:239], v11 offset:3072
  s_andn2_b32 s33, s36, s34
  s_cbranch_scc0 .fz_kernel_pk46c
.fz_kernel_pk46:
  s_ff1_i32_b32 s33, s33
  s_bitset1_b32 s34, s33
  s_lshl_b32 s23, s33, 13
  s_lshl_b32 s33, s33, 12
  s_add_u32 s30, s33, s35
  s_waitcnt vmcnt(11) lgkmcnt(6)
  v_mfma_f32_32x32x16_bf16 v[64:79], v[224:227], v[96:99], v[64:79]
  v_add_u32 v12, s21, v14
  v_add_u32 v13, s21, v15
  buffer_load_dwordx4 v[144:147], v3, s[4:7], s30 offen offset:0
  ds_read_b64_tr_b16 v[240:241], v10 offset:4096
  s_waitcnt lgkmcnt(5)
  v_mfma_f32_32x32x16_bf16 v[80:95], v[228:231], v[96:99], v[80:95]
  ds_read_b64_tr_b16 v[242:243], v10 offset:5120
  ds_read_b64_tr_b16 v[244:245], v11 offset:4096
  ds_read_b64_tr_b16 v[246:247], v11 offset:5120
  s_waitcnt vmcnt(11) lgkmcnt(6)
  v_mfma_f32_32x32x16_bf16 v[64:79], v[232:235], v[100:103], v[64:79]
  buffer_load_dwordx4 v[148:151], v3, s[4:7], s30 offen offset:1024
  ds_read_b64_tr_b16 v[248:249], v10 offset:6144
  s_waitcnt lgkmcnt(5)
  v_mfma_f32_32x32x16_bf16 v[80:95], v[236:239], v[100:103], v[80:95]
  ds_read_b64_tr_b16 v[250:251], v10 offset:7168
  ds_read_b64_tr_b16 v[252:253], v11 offset:6144
  ds_read_b64_tr_b16 v[254:255], v11 offset:7168
  s_waitcnt vmcnt(11) lgkmcnt(6)
  v_mfma_f32_32x32x16_bf16 v[64:79], v[240:243], v[104:107], v[64:79]
  buffer_load_dwordx4 v[152:155], v3, s[4:7], s30 offen offset:2048
  ds_read_b64_tr_b16 v[224:225], v12 offset:0
  s_waitcnt lgkmcnt(5)
  v_mfma_f32_32x32x16_bf16 v[80:95], v[244:247], v[104:107], v[80:95]
  ds_read_b64_tr_b16 v[226:227], v12 offset:1024
  ds_read_b64_tr_b16 v[228:229], v13 offset:0
  ds_read_b64_tr_b16 v[230:231], v13 offset:1024
  s_waitcnt vmcnt(11) lgkmcnt(6)
  v_mfma_f32_32x32x16_bf16 v[64:79], v[248:251], v[108:111], v[64:79]
  buffer_load_dwordx4 v[156:159], v3, s[4:7], s30 offen offset:3072
  ds_read_b64_tr_b16 v[232:233], v12 offset:2048
  s_waitcnt lgkmcnt(5)
  v_mfma_f32_32x32x16_bf16 v[80:95], v[252:255], v[108:111], v[80:95]
  ds_read_b64_tr_b16 v[234:235], v12 offset:3072
  ds_read_b64_tr_b16 v[236:237], v13 offset:2048
  ds_read_b64_tr_b16 v[238:239], v13 offset:3072
  s_andn2_b32 s33, s36, s34
  s_cbranch_scc0 .fz_kernel_pk47c
.fz_kernel_pk47:
  s_ff1_i32_b32 s33, s33
  s_bitset1_b32 s34, s33
  s_lshl_b32 s24, s33, 13
  s_lshl_b32 s33, s33, 12
  s_add_u32 s30, s33, s35
  s_waitcnt vmcnt(11) lgkmcnt(6)
  v_mfma_f32_32x32x16_bf16 v[64:79], v[224:227], v[112:115], v[64:79]
  v_add_u32 v10, s22, v14
  v_add_u32 v11, s22, v15
  buffer_load_dwordx4 v[160:163], v3, s[4:7], s30 offen offset:0
  ds_read_b64_tr_b16 v[240:241], v12 offset:4096
  s_waitcnt lgkmcnt(5)
  v_mfma_f32_32x32x16_bf16 v[80:95], v[228:231], v[112:115], v[80:95]
  ds_read_b64_tr_b16 v[242:243], v12 offset:5120
  ds_read_b64_tr_b16 v[244:245], v13 offset:4096
  ds_read_b64_tr_b16 v[246:247], v13 offset:5120
  s_waitcnt vmcnt(11) lgkmcnt(6)
  v_mfma_f32_32x32x16_bf16 v[64:79], v[232:235], v[116:119], v[64:79]
  buffer_load_dwordx4 v[164:167], v3, s[4:7], s30 offen offset:1024
  ds_read_b64_tr_b16 v[248:249], v12 offset:6144
  s_waitcnt lgkmcnt(5)
  v_mfma_f32_32x32x16_bf16 v[80:95], v[236:239], v[116:119], v[80:95]
  ds_read_b64_tr_b16 v[250:251], v12 offset:7168
  ds_read_b64_tr_b16 v[252:253], v13 offset:6144
  ds_read_b64_tr_b16 v[254:255], v13 offset:7168
  s_waitcnt vmcnt(11) lgkmcnt(6)
  v_mfma_f32_32x32x16_bf16 v[64:79], v[240:243], v[120:123], v[64:79]
  buffer_load_dwordx4 v[168:171], v3, s[4:7], s30 offen offset:2048
  ds_read_b64_tr_b16 v[224:225], v10 offset:0
  s_waitcnt lgkmcnt(5)
  v_mfma_f32_32x32x16_bf16 v[80:95], v[244:247], v[120:123], v[80:95]
  ds_read_b64_tr_b16 v[226:227], v10 offset:1024
  ds_read_b64_tr_b16 v[228:229], v11 offset:0
  ds_read_b64_tr_b16 v[230:231], v11 offset:1024
  s_waitcnt vmcnt(11) lgkmcnt(6)
  v_mfma_f32_32x32x16_bf16 v[64:79], v[248:251], v[124:127], v[64:79]
  buffer_load_dwordx4 v[172:175], v3, s[4:7], s30 offen offset:3072
  ds_read_b64_tr_b16 v[232:233], v10 offset:2048
  s_waitcnt lgkmcnt(5)
  v_mfma_f32_32x32x16_bf16 v[80:95], v[252:255], v[124:127], v[80:95]
  ds_read_b64_tr_b16 v[234:235], v10 offset:3072
  ds_read_b64_tr_b16 v[236:237], v11 offset:2048
  ds_read_b64_tr_b16 v[238:239], v11 offset:3072
  s_andn2_b32 s33, s36, s34
  s_cbranch_scc0 .fz_kernel_pk48c
.fz_kernel_pk48:
  s_ff1_i32_b32 s33, s33
  s_bitset1_b32 s34, s33
  s_lshl_b32 s25, s33, 13
  s_lshl_b32 s33, s33, 12
  s_add_u32 s30, s33, s35
  s_waitcnt vmcnt(11) lgkmcnt(6)
  v_mfma_f32_32x32x16_bf16 v[64:79], v[224:227], v[128:131], v[64:79]
  v_add_u32 v12, s23, v14
  v_add_u32 v13, s23, v15
  buffer_load_dwordx4 v[176:179], v3, s[4:7], s30 offen offset:0
  ds_read_b64_tr_b16 v[240:241], v10 offset:4096
  s_waitcnt lgkmcnt(5)
  v_mfma_f32_32x32x16_bf16 v[80:95], v[228:231], v[128:131], v[80:95]
  ds_read_b64_tr_b16 v[242:243], v10 offset:5120
  ds_read_b64_tr_b16 v[244:245], v11 offset:4096
  ds_read_b64_tr_b16 v[246:247], v11 offset:5120
  s_waitcnt vmcnt(11) lgkmcnt(6)
  v_mfma_f32_32x32x16_bf16 v[64:79], v[232:235], v[132:135], v[64:79]
  buffer_load_dwordx4 v[180:183], v3, s[4:7], s30 offen offset:1024
  ds_read_b64_tr_b16 v[248:249], v10 offset:6144
  s_waitcnt lgkmcnt(5)
  v_mfma_f32_32x32x16_bf16 v[80:95], v[236:239], v[132:135], v[80:95]
  ds_read_b64_tr_b16 v[250:251], v10 offset:7168
  ds_read_b64_tr_b16 v[252:253], v11 offset:6144
  ds_read_b64_tr_b16 v[254:255], v11 offset:7168
  s_waitcnt vmcnt(11) lgkmcnt(6)
  v_mfma_f32_32x32x16_bf16 v[64:79], v[240:243], v[136:139], v[64:79]
  buffer_load_dwordx4 v[184:187], v3, s[4:7], s30 offen offset:2048
  ds_read_b64_tr_b16 v[224:225], v12 offset:0
  s_waitcnt lgkmcnt(5)
  v_mfma_f32_32x32x16_bf16 v[80:95], v[244:247], v[136:139], v[80:95]
  ds_read_b64_tr_b16 v[226:227], v12 offset:1024
  ds_read_b64_tr_b16 v[228:229], v13 offset:0
  ds_read_b64_tr_b16 v[230:231], v13 offset:1024
  s_waitcnt vmcnt(11) lgkmcnt(6)
  v_mfma_f32_32x32x16_bf16 v[64:79], v[248:251], v[140:143], v[64:79]
  buffer_load_dwordx4 v[188:191], v3, s[4:7], s30 offen offset:3072
  ds_read_b64_tr_b16 v[232:233], v12 offset:2048
  s_waitcnt lgkmcnt(5)
  v_mfma_f32_32x32x16_bf16 v[80:95], v[252:255], v[140:143], v[80:95]
  ds_read_b64_tr_b16 v[234:235], v12 offset:3072
  ds_read_b64_tr_b16 v[236:237], v13 offset:2048
  ds_read_b64_tr_b16 v[238:239], v13 offset:3072
  s_andn2_b32 s33, s36, s34
  s_cbranch_scc0 .fz_kernel_pk49c
.fz_kernel_pk49:
  s_ff1_i32_b32 s33, s33
  s_bitset1_b32 s34, s33
  s_lshl_b32 s26, s33, 13
  s_lshl_b32 s33, s33, 12
  s_add_u32 s30, s33, s35
  s_waitcnt vmcnt(11) lgkmcnt(6)
  v_mfma_f32_32x32x16_bf16 v[64:79], v[224:227], v[144:147], v[64:79]
  v_add_u32 v10, s24, v14
  v_add_u32 v11, s24, v15
  buffer_load_dwordx4 v[192:195], v3, s[4:7], s30 offen offset:0
  ds_read_b64_tr_b16 v[240:241], v12 offset:4096
  s_waitcnt lgkmcnt(5)
  v_mfma_f32_32x32x16_bf16 v[80:95], v[228:231], v[144:147], v[80:95]
  ds_read_b64_tr_b16 v[242:243], v12 offset:5120
  ds_read_b64_tr_b16 v[244:245], v13 offset:4096
  ds_read_b64_tr_b16 v[246:247], v13 offset:5120
  s_waitcnt vmcnt(11) lgkmcnt(6)
  v_mfma_f32_32x32x16_bf16 v[64:79], v[232:235], v[148:151], v[64:79]
  buffer_load_dwordx4 v[196:199], v3, s[4:7], s30 offen offset:1024
  ds_read_b64_tr_b16 v[248:249], v12 offset:6144
  s_waitcnt lgkmcnt(5)
  v_mfma_f32_32x32x16_bf16 v[80:95], v[236:239], v[148:151], v[80:95]
  ds_read_b64_tr_b16 v[250:251], v12 offset:7168
  ds_read_b64_tr_b16 v[252:253], v13 offset:6144
  ds_read_b64_tr_b16 v[254:255], v13 offset:7168
  s_waitcnt vmcnt(11) lgkmcnt(6)
  v_mfma_f32_32x32x16_bf16 v[64:79], v[240:243], v[152:155], v[64:79]
  buffer_load_dwordx4 v[200:203], v3, s[4:7], s30 offen offset:2048
  ds_read_b64_tr_b16 v[224:225], v10 offset:0
  s_waitcnt lgkmcnt(5)
  v_mfma_f32_32x32x16_bf16 v[80:95], v[244:247], v[152:155], v[80:95]
  ds_read_b64_tr_b16 v[226:227], v10 offset:1024
  ds_read_b64_tr_b16 v[228:229], v11 offset:0
  ds_read_b64_tr_b16 v[230:231], v11 offset:1024
  s_waitcnt vmcnt(11) lgkmcnt(6)
  v_mfma_f32_32x32x16_bf16 v[64:79], v[248:251], v[156:159], v[64:79]
  buffer_load_dwordx4 v[204:207], v3, s[4:7], s30 offen offset:3072
  ds_read_b64_tr_b16 v[232:233], v10 offset:2048
  s_waitcnt lgkmcnt(5)
  v_mfma_f32_32x32x16_bf16 v[80:95], v[252:255], v[156:159], v[80:95]
  ds_read_b64_tr_b16 v[234:235], v10 offset:3072
  ds_read_b64_tr_b16 v[236:237], v11 offset:2048
  ds_read_b64_tr_b16 v[238:239], v11 offset:3072
  s_andn2_b32 s33, s36, s34
  s_cbranch_scc0 .fz_kernel_pk50c
.fz_kernel_pk50:
  s_ff1_i32_b32 s33, s33
  s_bitset1_b32 s34, s33
  s_lshl_b32 s27, s33, 13
  s_lshl_b32 s33, s33, 12
  s_add_u32 s30, s33, s35
  s_waitcnt vmcnt(11) lgkmcnt(6)
  v_mfma_f32_32x32x16_bf16 v[64:79], v[224:227], v[160:163], v[64:79]
  v_add_u32 v12, s25, v14
  v_add_u32 v13, s25, v15
  buffer_load_dwordx4 v[208:211], v3, s[4:7], s30 offen offset:0
  ds_read_b64_tr_b16 v[240:241], v10 offset:4096
  s_waitcnt lgkmcnt(5)
  v_mfma_f32_32x32x16_bf16 v[80:95], v[228:231], v[160:163], v[80:95]
  ds_read_b64_tr_b16 v[242:243], v10 offset:5120
  ds_read_b64_tr_b16 v[244:245], v11 offset:4096
  ds_read_b64_tr_b16 v[246:247], v11 offset:5120
  s_waitcnt vmcnt(11) lgkmcnt(6)
  v_mfma_f32_32x32x16_bf16 v[64:79], v[232:235], v[164:167], v[64:79]
  buffer_load_dwordx4 v[212:215], v3, s[4:7], s30 offen offset:1024
  ds_read_b64_tr_b16 v[248:249], v10 offset:6144
  s_waitcnt lgkmcnt(5)
  v_mfma_f32_32x32x16_bf16 v[80:95], v[236:239], v[164:167], v[80:95]
  ds_read_b64_tr_b16 v[250:251], v10 offset:7168
  ds_read_b64_tr_b16 v[252:253], v11 offset:6144
  ds_read_b64_tr_b16 v[254:255], v11 offset:7168
  s_waitcnt vmcnt(11) lgkmcnt(6)
  v_mfma_f32_32x32x16_bf16 v[64:79], v[240:243], v[168:171], v[64:79]
  buffer_load_dwordx4 v[216:219], v3, s[4:7], s30 offen offset:2048
  ds_read_b64_tr_b16 v[224:225], v12 offset:0
  s_waitcnt lgkmcnt(5)
  v_mfma_f32_32x32x16_bf16 v[80:95], v[244:247], v[168:171], v[80:95]
  ds_read_b64_tr_b16 v[226:227], v12 offset:1024
  ds_read_b64_tr_b16 v[228:229], v13 offset:0
  ds_read_b64_tr_b16 v[230:231], v13 offset:1024
  s_waitcnt vmcnt(11) lgkmcnt(6)
  v_mfma_f32_32x32x16_bf16 v[64:79], v[248:251], v[172:175], v[64:79]
  buffer_load_dwordx4 v[220:223], v3, s[4:7], s30 offen offset:3072
  ds_read_b64_tr_b16 v[232:233], v12 offset:2048
  s_waitcnt lgkmcnt(5)
  v_mfma_f32_32x32x16_bf16 v[80:95], v[252:255], v[172:175], v[80:95]
  ds_read_b64_tr_b16 v[234:235], v12 offset:3072
  ds_read_b64_tr_b16 v[236:237], v13 offset:2048
  ds_read_b64_tr_b16 v[238:239], v13 offset:3072
  s_andn2_b32 s33, s36, s34
  s_cbranch_scc0 .fz_kernel_pk51c
.fz_kernel_pk51:
  s_ff1_i32_b32 s33, s33
  s_bitset1_b32 s34, s33
  s_lshl_b32 s20, s33, 13
  s_lshl_b32 s33, s33, 12
  s_add_u32 s30, s33, s35
  s_waitcnt vmcnt(11) lgkmcnt(6)
  v_mfma_f32_32x32x16_bf16 v[64:79], v[224:227], v[176:179], v[64:79]
  v_add_u32 v10, s26, v14
  v_add_u32 v11, s26, v15
  buffer_load_dwordx4 v[96:99], v3, s[4:7], s30 offen offset:0
  ds_read_b64_tr_b16 v[240:241], v12 offset:4096
  s_waitcnt lgkmcnt(5)
  v_mfma_f32_32x32x16_bf16 v[80:95], v[228:231], v[176:179], v[80:95]
  ds_read_b64_tr_b16 v[242:243], v12 offset:5120
  ds_read_b64_tr_b16 v[244:245], v13 offset:4096
  ds_read_b64_tr_b16 v[246:247], v13 offset:5120
  s_waitcnt vmcnt(11) lgkmcnt(6)
  v_mfma_f32_32x32x16_bf16 v[64:79], v[232:235], v[180:183], v[64:79]
  buffer_load_dwordx4 v[100:103], v3, s[4:7], s30 offen offset:1024
  ds_read_b64_tr_b16 v[248:249], v12 offset:6144
  s_waitcnt lgkmcnt(5)
  v_mfma_f32_32x32x16_bf16 v[80:95], v[236:239], v[180:183], v[80:95]
  ds_read_b64_tr_b16 v[250:251], v12 offset:7168
  ds_read_b64_tr_b16 v[252:253], v13 offset:6144
  ds_read_b64_tr_b16 v[254:255], v13 offset:7168
  s_waitcnt vmcnt(11) lgkmcnt(6)
  v_mfma_f32_32x32x16_bf16 v[64:79], v[240:243], v[184:187], v[64:79]
  buffer_load_dwordx4 v[104:107], v3, s[4:7], s30 offen offset:2048
  ds_read_b64_tr_b16 v[224:225], v10 offset:0
  s_waitcnt lgkmcnt(5)
  v_mfma_f32_32x32x16_bf16 v[80:95], v[244:247], v[184:187], v[80:95]
  ds_read_b64_tr_b16 v[226:227], v10 offset:1024
  ds_read_b64_tr_b16 v[228:229], v11 offset:0
  ds_read_b64_tr_b16 v[230:231], v11 offset:1024
  s_waitcnt vmcnt(11) lgkmcnt(6)
  v_mfma_f32_32x32x16_bf16 v[64:79], v[248:251], v[188:191], v[64:79]
  buffer_load_dwordx4 v[108:111], v3, s[4:7], s30 offen offset:3072
  ds_read_b64_tr_b16 v[232:233], v10 offset:2048
  s_waitcnt lgkmcnt(5)
  v_mfma_f32_32x32x16_bf16 v[80:95], v[252:255], v[188:191], v[80:95]
  ds_read_b64_tr_b16 v[234:235], v10 offset:3072
  ds_read_b64_tr_b16 v[236:237], v11 offset:2048
  ds_read_b64_tr_b16 v[238:239], v11 offset:3072
  s_andn2_b32 s33, s36, s34
  s_cbranch_scc0 .fz_kernel_pk52c
.fz_kernel_pk52:
  s_ff1_i32_b32 s33, s33
  s_bitset1_b32 s34, s33
  s_lshl_b32 s21, s33, 13
  s_lshl_b32 s33, s33, 12
  s_add_u32 s30, s33, s35
  s_waitcnt vmcnt(11) lgkmcnt(6)
  v_mfma_f32_32x32x16_bf16 v[64:79], v[224:227], v[192:195], v[64:79]
  v_add_u32 v12, s27, v14
  v_add_u32 v13, s27, v15
  buffer_load_dwordx4 v[112:115], v3, s[4:7], s30 offen offset:0
  ds_read_b64_tr_b16 v[240:241], v10 offset:4096
  s_waitcnt lgkmcnt(5)
  v_mfma_f32_32x32x16_bf16 v[80:95], v[228:231], v[192:195], v[80:95]
  ds_read_b64_tr_b16 v[242:243], v10 offset:5120
  ds_read_b64_tr_b16 v[244:245], v11 offset:4096
  ds_read_b64_tr_b16 v[246:247], v11 offset:5120
  s_waitcnt vmcnt(11) lgkmcnt(6)
  v_mfma_f32_32x32x16_bf16 v[64:79], v[232:235], v[196:199], v[64:79]
  buffer_load_dwordx4 v[116:119], v3, s[4:7], s30 offen offset:1024
  ds_read_b64_tr_b16 v[248:249], v10 offset:6144
  s_waitcnt lgkmcnt(5)
  v_mfma_f32_32x32x16_bf16 v[80:95], v[236:239], v[196:199], v[80:95]
  ds_read_b64_tr_b16 v[250:251], v10 offset:7168
  ds_read_b64_tr_b16 v[252:253], v11 offset:6144
  ds_read_b64_tr_b16 v[254:255], v11 offset:7168
  s_waitcnt vmcnt(11) lgkmcnt(6)
  v_mfma_f32_32x32x16_bf16 v[64:79], v[240:243], v[200:203], v[64:79]
  buffer_load_dwordx4 v[120:123], v3, s[4:7], s30 offen offset:2048
  ds_read_b64_tr_b16 v[224:225], v12 offset:0
  s_waitcnt lgkmcnt(5)
  v_mfma_f32_32x32x16_bf16 v[80:95], v[244:247], v[200:203], v[80:95]
  ds_read_b64_tr_b16 v[226:227], v12 offset:1024
  ds_read_b64_tr_b16 v[228:229], v13 offset:0
  ds_read_b64_tr_b16 v[230:231], v13 offset:1024
  s_waitcnt vmcnt(11) lgkmcnt(6)
  v_mfma_f32_32x32x16_bf16 v[64:79], v[248:251], v[204:207], v[64:79]
  buffer_load_dwordx4 v[124:127], v3, s[4:7], s30 offen offset:3072
  ds_read_b64_tr_b16 v[232:233], v12 offset:2048
  s_waitcnt lgkmcnt(5)
  v_mfma_f32_32x32x16_bf16 v[80:95], v[252:255], v[204:207], v[80:95]
  ds_read_b64_tr_b16 v[234:235], v12 offset:3072
  ds_read_b64_tr_b16 v[236:237], v13 offset:2048
  ds_read_b64_tr_b16 v[238:239], v13 offset:3072
  s_andn2_b32 s33, s36, s34
  s_cbranch_scc0 .fz_kernel_pk53c
.fz_kernel_pk53:
  s_ff1_i32_b32 s33, s33
  s_bitset1_b32 s34, s33
  s_lshl_b32 s22, s33, 13
  s_lshl_b32 s33, s33, 12
  s_add_u32 s30, s33, s35
  s_waitcnt vmcnt(11) lgkmcnt(6)
  v_mfma_f32_32x32x16_bf16 v[64:79], v[224:227], v[208:211], v[64:79]
  v_add_u32 v10, s20, v14
  v_add_u32 v11, s20, v15
  buffer_load_dwordx4 v[128:131], v3, s[4:7], s30 offen offset:0
  ds_read_b64_tr_b16 v[240:241], v12 offset:4096
  s_waitcnt lgkmcnt(5)
  v_mfma_f32_32x32x16_bf16 v[80:95], v[228:231], v[208:211], v[80:95]
  ds_read_b64_tr_b16 v[242:243], v12 offset:5120
  ds_read_b64_tr_b16 v[244:245], v13 offset:4096
  ds_read_b64_tr_b16 v[246:247], v13 offset:5120
  s_waitcnt vmcnt(11) lgkmcnt(6)
  v_mfma_f32_32x32x16_bf16 v[64:79], v[232:235], v[212:215], v[64:79]
  buffer_load_dwordx4 v[132:135], v3, s[4:7], s30 offen offset:1024
  ds_read_b64_tr_b16 v[248:249], v12 offset:6144
  s_waitcnt lgkmcnt(5)
  v_mfma_f32_32x32x16_bf16 v[80:95], v[236:239], v[212:215], v[80:95]
  ds_read_b64_tr_b16 v[250:251], v12 offset:7168
  ds_read_b64_tr_b16 v[252:253], v13 offset:6144
  ds_read_b64_tr_b16 v[254:255], v13 offset:7168
  s_waitcnt vmcnt(11) lgkmcnt(6)
  v_mfma_f32_32x32x16_bf16 v[64:79], v[240:243], v[216:219], v[64:79]
  buffer_load_dwordx4 v[136:139], v3, s[4:7], s30 offen offset:2048
  ds_read_b64_tr_b16 v[224:225], v10 offset:0
  s_waitcnt lgkmcnt(5)
  v_mfma_f32_32x32x16_bf16 v[80:95], v[244:247], v[216:219], v[80:95]
  ds_read_b64_tr_b16 v[226:227], v10 offset:1024
  ds_read_b64_tr_b16 v[228:229], v11 offset:0
  ds_read_b64_tr_b16 v[230:231], v11 offset:1024
  s_waitcnt vmcnt(11) lgkmcnt(6)
  v_mfma_f32_32x32x16_bf16 v[64:79], v[248:251], v[220:223], v[64:79]
  buffer_load_dwordx4 v[140:143], v3, s[4:7], s30 offen offset:3072
  ds_read_b64_tr_b16 v[232:233], v10 offset:2048
  s_waitcnt lgkmcnt(5)
  v_mfma_f32_32x32x16_bf16 v[80:95], v[252:255], v[220:223], v[80:95]
  ds_read_b64_tr_b16 v[234:235], v10 offset:3072
  ds_read_b64_tr_b16 v[236:237], v11 offset:2048
  ds_read_b64_tr_b16 v[238:239], v11 offset:3072
  s_andn2_b32 s33, s36, s34
  s_cbranch_scc0 .fz_kernel_pk54c
.fz_kernel_pk54:
  s_ff1_i32_b32 s33, s33
  s_bitset1_b32 s34, s33
  s_lshl_b32 s23, s33, 13
  s_lshl_b32 s33, s33, 12
  s_add_u32 s30, s33, s35
  s_waitcnt vmcnt(11) lgkmcnt(6)
  v_mfma_f32_32x32x16_bf16 v[64:79], v[224:227], v[96:99], v[64:79]
  v_add_u32 v12, s21, v14
  v_add_u32 v13, s21, v15
  buffer_load_dwordx4 v[144:147], v3, s[4:7], s30 offen offset:0
  ds_read_b64_tr_b16 v[240:241], v10 offset:4096
  s_waitcnt lgkmcnt(5)
  v_mfma_f32_32x32x16_bf16 v[80:95], v[228:231], v[96:99], v[80:95]
  ds_read_b64_tr_b16 v[242:243], v10 offset:5120
  ds_read_b64_tr_b16 v[244:245], v11 offset:4096
  ds_read_b64_tr_b16 v[246:247], v11 offset:5120
  s_waitcnt vmcnt(11) lgkmcnt(6)
  v_mfma_f32_32x32x16_bf16 v[64:79], v[232:235], v[100:103], v[64:79]
  buffer_load_dwordx4 v[148:151], v3, s[4:7], s30 offen offset:1024
  ds_read_b64_tr_b16 v[248:249], v10 offset:6144
  s_waitcnt lgkmcnt(5)
  v_mfma_f32_32x32x16_bf16 v[80:95], v[236:239], v[100:103], v[80:95]
  ds_read_b64_tr_b16 v[250:251], v10 offset:7168
  ds_read_b64_tr_b16 v[252:253], v11 offset:6144
  ds_read_b64_tr_b16 v[254:255], v11 offset:7168
  s_waitcnt vmcnt(11) lgkmcnt(6)
  v_mfma_f32_32x32x16_bf16 v[64:79], v[240:243], v[104:107], v[64:79]
  buffer_load_dwordx4 v[152:155], v3, s[4:7], s30 offen offset:2048
  ds_read_b64_tr_b16 v[224:225], v12 offset:0
  s_waitcnt lgkmcnt(5)
  v_mfma_f32_32x32x16_bf16 v[80:95], v[244:247], v[104:107], v[80:95]
  ds_read_b64_tr_b16 v[226:227], v12 offset:1024
  ds_read_b64_tr_b16 v[228:229], v13 offset:0
  ds_read_b64_tr_b16 v[230:231], v13 offset:1024
  s_waitcnt vmcnt(11) lgkmcnt(6)
  v_mfma_f32_32x32x16_bf16 v[64:79], v[248:251], v[108:111], v[64:79]
  buffer_load_dwordx4 v[156:159], v3, s[4:7], s30 offen offset:3072
  ds_read_b64_tr_b16 v[232:233], v12 offset:2048
  s_waitcnt lgkmcnt(5)
  v_mfma_f32_32x32x16_bf16 v[80:95], v[252:255], v[108:111], v[80:95]
  ds_read_b64_tr_b16 v[234:235], v12 offset:3072
  ds_read_b64_tr_b16 v[236:237], v13 offset:2048
  ds_read_b64_tr_b16 v[238:239], v13 offset:3072
  s_andn2_b32 s33, s36, s34
  s_cbranch_scc0 .fz_kernel_pk55c
.fz_kernel_pk55:
  s_ff1_i32_b32 s33, s33
  s_bitset1_b32 s34, s33
  s_lshl_b32 s24, s33, 13
  s_lshl_b32 s33, s33, 12
  s_add_u32 s30, s33, s35
  s_waitcnt vmcnt(11) lgkmcnt(6)
  v_mfma_f32_32x32x16_bf16 v[64:79], v[224:227], v[112:115], v[64:79]
  v_add_u32 v10, s22, v14
  v_add_u32 v11, s22, v15
  buffer_load_dwordx4 v[160:163], v3, s[4:7], s30 offen offset:0
  ds_read_b64_tr_b16 v[240:241], v12 offset:4096
  s_waitcnt lgkmcnt(5)
  v_mfma_f32_32x32x16_bf16 v[80:95], v[228:231], v[112:115], v[80:95]
  ds_read_b64_tr_b16 v[242:243], v12 offset:5120
  ds_read_b64_tr_b16 v[244:245], v13 offset:4096
  ds_read_b64_tr_b16 v[246:247], v13 offset:5120
  s_waitcnt vmcnt(11) lgkmcnt(6)
  v_mfma_f32_32x32x16_bf16 v[64:79], v[232:235], v[116:119], v[64:79]
  buffer_load_dwordx4 v[164:167], v3, s[4:7], s30 offen offset:1024
  ds_read_b64_tr_b16 v[248:249], v12 offset:6144
  s_waitcnt lgkmcnt(5)
  v_mfma_f32_32x32x16_bf16 v[80:95], v[236:239], v[116:119], v[80:95]
  ds_read_b64_tr_b16 v[250:251], v12 offset:7168
  ds_read_b64_tr_b16 v[252:253], v13 offset:6144
  ds_read_b64_tr_b16 v[254:255], v13 offset:7168
  s_waitcnt vmcnt(11) lgkmcnt(6)
  v_mfma_f32_32x32x16_bf16 v[64:79], v[240:243], v[120:123], v[64:79]
  buffer_load_dwordx4 v[168:171], v3, s[4:7], s30 offen offset:2048
  ds_read_b64_tr_b16 v[224:225], v10 offset:0
  s_waitcnt lgkmcnt(5)
  v_mfma_f32_32x32x16_bf16 v[80:95], v[244:247], v[120:123], v[80:95]
  ds_read_b64_tr_b16 v[226:227], v10 offset:1024
  ds_read_b64_tr_b16 v[228:229], v11 offset:0
  ds_read_b64_tr_b16 v[230:231], v11 offset:1024
  s_waitcnt vmcnt(11) lgkmcnt(6)
  v_mfma_f32_32x32x16_bf16 v[64:79], v[248:251], v[124:127], v[64:79]
  buffer_load_dwordx4 v[172:175], v3, s[4:7], s30 offen offset:3072
  ds_read_b64_tr_b16 v[232:233], v10 offset:2048
  s_waitcnt lgkmcnt(5)
  v_mfma_f32_32x32x16_bf16 v[80:95], v[252:255], v[124:127], v[80:95]
  ds_read_b64_tr_b16 v[234:235], v10 offset:3072
  ds_read_b64_tr_b16 v[236:237], v11 offset:2048
  ds_read_b64_tr_b16 v[238:239], v11 offset:3072
  s_andn2_b32 s33, s36, s34
  s_cbranch_scc0 .fz_kernel_pk56c
.fz_kernel_pk56:
  s_ff1_i32_b32 s33, s33
  s_bitset1_b32 s34, s33
  s_lshl_b32 s25, s33, 13
  s_lshl_b32 s33, s33, 12
  s_add_u32 s30, s33, s35
  s_waitcnt vmcnt(11) lgkmcnt(6)
  v_mfma_f32_32x32x16_bf16 v[64:79], v[224:227], v[128:131], v[64:79]
  v_add_u32 v12, s23, v14
  v_add_u32 v13, s23, v15
  buffer_load_dwordx4 v[176:179], v3, s[4:7], s30 offen offset:0
  ds_read_b64_tr_b16 v[240:241], v10 offset:4096
  s_waitcnt lgkmcnt(5)
  v_mfma_f32_32x32x16_bf16 v[80:95], v[228:231], v[128:131], v[80:95]
  ds_read_b64_tr_b16 v[242:243], v10 offset:5120
  ds_read_b64_tr_b16 v[244:245], v11 offset:4096
  ds_read_b64_tr_b16 v[246:247], v11 offset:5120
  s_waitcnt vmcnt(11) lgkmcnt(6)
  v_mfma_f32_32x32x16_bf16 v[64:79], v[232:235], v[132:135], v[64:79]
  buffer_load_dwordx4 v[180:183], v3, s[4:7], s30 offen offset:1024
  ds_read_b64_tr_b16 v[248:249], v10 offset:6144
  s_waitcnt lgkmcnt(5)
  v_mfma_f32_32x32x16_bf16 v[80:95], v[236:239], v[132:135], v[80:95]
  ds_read_b64_tr_b16 v[250:251], v10 offset:7168
  ds_read_b64_tr_b16 v[252:253], v11 offset:6144
  ds_read_b64_tr_b16 v[254:255], v11 offset:7168
  s_waitcnt vmcnt(11) lgkmcnt(6)
  v_mfma_f32_32x32x16_bf16 v[64:79], v[240:243], v[136:139], v[64:79]
  buffer_load_dwordx4 v[184:187], v3, s[4:7], s30 offen offset:2048
  ds_read_b64_tr_b16 v[224:225], v12 offset:0
  s_waitcnt lgkmcnt(5)
  v_mfma_f32_32x32x16_bf16 v[80:95], v[244:247], v[136:139], v[80:95]
  ds_read_b64_tr_b16 v[226:227], v12 offset:1024
  ds_read_b64_tr_b16 v[228:229], v13 offset:0
  ds_read_b64_tr_b16 v[230:231], v13 offset:1024
  s_waitcnt vmcnt(11) lgkmcnt(6)
  v_mfma_f32_32x32x16_bf16 v[64:79], v[248:251], v[140:143], v[64:79]
  buffer_load_dwordx4 v[188:191], v3, s[4:7], s30 offen offset:3072
  ds_read_b64_tr_b16 v[232:233], v12 offset:2048
  s_waitcnt lgkmcnt(5)
  v_mfma_f32_32x32x16_bf16 v[80:95], v[252:255], v[140:143], v[80:95]
  ds_read_b64_tr_b16 v[234:235], v12 offset:3072
  ds_read_b64_tr_b16 v[236:237], v13 offset:2048
  ds_read_b64_tr_b16 v[238:239], v13 offset:3072
  s_andn2_b32 s33, s36, s34
  s_cbranch_scc0 .fz_kernel_pk57c
.fz_kernel_pk57:
  s_ff1_i32_b32 s33, s33
  s_bitset1_b32 s34, s33
  s_lshl_b32 s26, s33, 13
  s_lshl_b32 s33, s33, 12
  s_add_u32 s30, s33, s35
  s_waitcnt vmcnt(11) lgkmcnt(6)
  v_mfma_f32_32x32x16_bf16 v[64:79], v[224:227], v[144:147], v[64:79]
  v_add_u32 v10, s24, v14
  v_add_u32 v11, s24, v15
  buffer_load_dwordx4 v[192:195], v3, s[4:7], s30 offen offset:0
  ds_read_b64_tr_b16 v[240:241], v12 offset:4096
  s_waitcnt lgkmcnt(5)
  v_mfma_f32_32x32x16_bf16 v[80:95], v[228:231], v[144:147], v[80:95]
  ds_read_b64_tr_b16 v[242:243], v12 offset:5120
  ds_read_b64_tr_b16 v[244:245], v13 offset:4096
  ds_read_b64_tr_b16 v[246:247], v13 offset:5120
  s_waitcnt vmcnt(11) lgkmcnt(6)
  v_mfma_f32_32x32x16_bf16 v[64:79], v[232:235], v[148:151], v[64:79]
  buffer_load_dwordx4 v[196:199], v3, s[4:7], s30 offen offset:1024
  ds_read_b64_tr_b16 v[248:249], v12 offset:6144
  s_waitcnt lgkmcnt(5)
  v_mfma_f32_32x32x16_bf16 v[80:95], v[236:239], v[148:151], v[80:95]
  ds_read_b64_tr_b16 v[250:251], v12 offset:7168
  ds_read_b64_tr_b16 v[252:253], v13 offset:6144
  ds_read_b64_tr_b16 v[254:255], v13 offset:7168
  s_waitcnt vmcnt(11) lgkmcnt(6)
  v_mfma_f32_32x32x16_bf16 v[64:79], v[240:243], v[152:155], v[64:79]
  buffer_load_dwordx4 v[200:203], v3, s[4:7], s30 offen offset:2048
  ds_read_b64_tr_b16 v[224:225], v10 offset:0
  s_waitcnt lgkmcnt(5)
  v_mfma_f32_32x32x16_bf16 v[80:95], v[244:247], v[152:155], v[80:95]
  ds_read_b64_tr_b16 v[226:227], v10 offset:1024
  ds_read_b64_tr_b16 v[228:229], v11 offset:0
  ds_read_b64_tr_b16 v[230:231], v11 offset:1024
  s_waitcnt vmcnt(11) lgkmcnt(6)
  v_mfma_f32_32x32x16_bf16 v[64:79], v[248:251], v[156:159], v[64:79]
  buffer_load_dwordx4 v[204:207], v3, s[4:7], s30 offen offset:3072
  ds_read_b64_tr_b16 v[232:233], v10 offset:2048
  s_waitcnt lgkmcnt(5)
  v_mfma_f32_32x32x16_bf16 v[80:95], v[252:255], v[156:159], v[80:95]
  ds_read_b64_tr_b16 v[234:235], v10 offset:3072
  ds_read_b64_tr_b16 v[236:237], v11 offset:2048
  ds_read_b64_tr_b16 v[238:239], v11 offset:3072
  s_andn2_b32 s33, s36, s34
  s_cbranch_scc0 .fz_kernel_pk58c
.fz_kernel_pk58:
  s_ff1_i32_b32 s33, s33
  s_bitset1_b32 s34, s33
  s_lshl_b32 s27, s33, 13
  s_lshl_b32 s33, s33, 12
  s_add_u32 s30, s33, s35
  s_waitcnt vmcnt(11) lgkmcnt(6)
  v_mfma_f32_32x32x16_bf16 v[64:79], v[224:227], v[160:163], v[64:79]
  v_add_u32 v12, s25, v14
  v_add_u32 v13, s25, v15
  buffer_load_dwordx4 v[208:211], v3, s[4:7], s30 offen offset:0
  ds_read_b64_tr_b16 v[240:241], v10 offset:4096
  s_waitcnt lgkmcnt(5)
  v_mfma_f32_32x32x16_bf16 v[80:95], v[228:231], v[160:163], v[80:95]
  ds_read_b64_tr_b16 v[242:243], v10 offset:5120
  ds_read_b64_tr_b16 v[244:245], v11 offset:4096
  ds_read_b64_tr_b16 v[246:247], v11 offset:5120
  s_waitcnt vmcnt(11) lgkmcnt(6)
  v_mfma_f32_32x32x16_bf16 v[64:79], v[232:235], v[164:167], v[64:79]
  buffer_load_dwordx4 v[212:215], v3, s[4:7], s30 offen offset:1024
  ds_read_b64_tr_b16 v[248:249], v10 offset:6144
  s_waitcnt lgkmcnt(5)
  v_mfma_f32_32x32x16_bf16 v[80:95], v[236:239], v[164:167], v[80:95]
  ds_read_b64_tr_b16 v[250:251], v10 offset:7168
  ds_read_b64_tr_b16 v[252:253], v11 offset:6144
  ds_read_b64_tr_b16 v[254:255], v11 offset:7168
  s_waitcnt vmcnt(11) lgkmcnt(6)
  v_mfma_f32_32x32x16_bf16 v[64:79], v[240:243], v[168:171], v[64:79]
  buffer_load_dwordx4 v[216:219], v3, s[4:7], s30 offen offset:2048
  ds_read_b64_tr_b16 v[224:225], v12 offset:0
  s_waitcnt lgkmcnt(5)
  v_mfma_f32_32x32x16_bf16 v[80:95], v[244:247], v[168:171], v[80:95]
  ds_read_b64_tr_b16 v[226:227], v12 offset:1024
  ds_read_b64_tr_b16 v[228:229], v13 offset:0
  ds_read_b64_tr_b16 v[230:231], v13 offset:1024
  s_waitcnt vmcnt(11) lgkmcnt(6)
  v_mfma_f32_32x32x16_bf16 v[64:79], v[248:251], v[172:175], v[64:79]
  buffer_load_dwordx4 v[220:223], v3, s[4:7], s30 offen offset:3072
  ds_read_b64_tr_b16 v[232:233], v12 offset:2048
  s_waitcnt lgkmcnt(5)
  v_mfma_f32_32x32x16_bf16 v[80:95], v[252:255], v[172:175], v[80:95]
  ds_read_b64_tr_b16 v[234:235], v12 offset:3072
  ds_read_b64_tr_b16 v[236:237], v13 offset:2048
  ds_read_b64_tr_b16 v[238:239], v13 offset:3072
  s_waitcnt vmcnt(11) lgkmcnt(6)
  v_mfma_f32_32x32x16_bf16 v[64:79], v[224:227], v[176:179], v[64:79]
  v_add_u32 v10, s26, v14
  v_add_u32 v11, s26, v15
  ds_read_b64_tr_b16 v[240:241], v12 offset:4096
  s_waitcnt lgkmcnt(5)
  v_mfma_f32_32x32x16_bf16 v[80:95], v[228:231], v[176:179], v[80:95]
  ds_read_b64_tr_b16 v[242:243], v12 offset:5120
  ds_read_b64_tr_b16 v[244:245], v13 offset:4096
  ds_read_b64_tr_b16 v[246:247], v13 offset:5120
  s_waitcnt vmcnt(10) lgkmcnt(6)
  v_mfma_f32_32x32x16_bf16 v[64:79], v[232:235], v[180:183], v[64:79]
  ds_read_b64_tr_b16 v[248:249], v12 offset:6144
  s_waitcnt lgkmcnt(5)
  v_mfma_f32_32x32x16_bf16 v[80:95], v[236:239], v[180:183], v[80:95]
  ds_read_b64_tr_b16 v[250:251], v12 offset:7168
  ds_read_b64_tr_b16 v[252:253], v13 offset:6144
  ds_read_b64_tr_b16 v[254:255], v13 offset:7168
  s_waitcnt vmcnt(9) lgkmcnt(6)
  v_mfma_f32_32x32x16_bf16 v[64:79], v[240:243], v[184:187], v[64:79]
  ds_read_b64_tr_b16 v[224:225], v10 offset:0
  s_waitcnt lgkmcnt(5)
  v_mfma_f32_32x32x16_bf16 v[80:95], v[244:247], v[184:187], v[80:95]
  ds_read_b64_tr_b16 v[226:227], v10 offset:1024
  ds_read_b64_tr_b16 v[228:229], v11 offset:0
  ds_read_b64_tr_b16 v[230:231], v11 offset:1024
  s_waitcnt vmcnt(8) lgkmcnt(6)
  v_mfma_f32_32x32x16_bf16 v[64:79], v[248:251], v[188:191], v[64:79]
  ds_read_b64_tr_b16 v[232:233], v10 offset:2048
  s_waitcnt lgkmcnt(5)
  v_mfma_f32_32x32x16_bf16 v[80:95], v[252:255], v[188:191], v[80:95]
  ds_read_b64_tr_b16 v[234:235], v10 offset:3072
  ds_read_b64_tr_b16 v[236:237], v11 offset:2048
  ds_read_b64_tr_b16 v[238:239], v11 offset:3072
  s_waitcnt vmcnt(7) lgkmcnt(6)
  v_mfma_f32_32x32x16_bf16 v[64:79], v[224:227], v[192:195], v[64:79]
  v_add_u32 v12, s27, v14
  v_add_u32 v13, s27, v15
  ds_read_b64_tr_b16 v[240:241], v10 offset:4096
  s_waitcnt lgkmcnt(5)
  v_mfma_f32_32x32x16_bf16 v[80:95], v[228:231], v[192:195], v[80:95]
  ds_read_b64_tr_b16 v[242:243], v10 offset:5120
  ds_read_b64_tr_b16 v[244:245], v11 offset:4096
  ds_read_b64_tr_b16 v[246:247], v11 offset:5120
  s_waitcnt vmcnt(6) lgkmcnt(6)
  v_mfma_f32_32x32x16_bf16 v[64:79], v[232:235], v[196:199], v[64:79]
  ds_read_b64_tr_b16 v[248:249], v10 offset:6144
  s_waitcnt lgkmcnt(5)
  v_mfma_f32_32x32x16_bf16 v[80:95], v[236:239], v[196:199], v[80:95]
  ds_read_b64_tr_b16 v[250:251], v10 offset:7168
  ds_read_b64_tr_b16 v[252:253], v11 offset:6144
  ds_read_b64_tr_b16 v[254:255], v11 offset:7168
  s_waitcnt vmcnt(5) lgkmcnt(6)
  v_mfma_f32_32x32x16_bf16 v[64:79], v[240:243], v[200:203], v[64:79]
  ds_read_b64_tr_b16 v[224:225], v12 offset:0
  s_waitcnt lgkmcnt(5)
  v_mfma_f32_32x32x16_bf16 v[80:95], v[244:247], v[200:203], v[80:95]
  ds_read_b64_tr_b16 v[226:227], v12 offset:1024
  ds_read_b64_tr_b16 v[228:229], v13 offset:0
  ds_read_b64_tr_b16 v[230:231], v13 offset:1024
  s_waitcnt vmcnt(4) lgkmcnt(6)
  v_mfma_f32_32x32x16_bf16 v[64:79], v[248:251], v[204:207], v[64:79]
  ds_read_b64_tr_b16 v[232:233], v12 offset:2048
  s_waitcnt lgkmcnt(5)
  v_mfma_f32_32x32x16_bf16 v[80:95], v[252:255], v[204:207], v[80:95]
  ds_read_b64_tr_b16 v[234:235], v12 offset:3072
  ds_read_b64_tr_b16 v[236:237], v13 offset:2048
  ds_read_b64_tr_b16 v[238:239], v13 offset:3072
  s_waitcnt vmcnt(3) lgkmcnt(6)
  v_mfma_f32_32x32x16_bf16 v[64:79], v[224:227], v[208:211], v[64:79]
  ds_read_b64_tr_b16 v[240:241], v12 offset:4096
  s_waitcnt lgkmcnt(5)
  v_mfma_f32_32x32x16_bf16 v[80:95], v[228:231], v[208:211], v[80:95]
  ds_read_b64_tr_b16 v[242:243], v12 offset:5120
  ds_read_b64_tr_b16 v[244:245], v13 offset:4096
  ds_read_b64_tr_b16 v[246:247], v13 offset:5120
  s_waitcnt vmcnt(2) lgkmcnt(6)
  v_mfma_f32_32x32x16_bf16 v[64:79], v[232:235], v[212:215], v[64:79]
  ds_read_b64_tr_b16 v[248:249], v12 offset:6144
  s_waitcnt lgkmcnt(5)
  v_mfma_f32_32x32x16_bf16 v[80:95], v[236:239], v[212:215], v[80:95]
  ds_read_b64_tr_b16 v[250:251], v12 offset:7168
  ds_read_b64_tr_b16 v[252:253], v13 offset:6144
  ds_read_b64_tr_b16 v[254:255], v13 offset:7168
  s_waitcnt vmcnt(1) lgkmcnt(6)
  v_mfma_f32_32x32x16_bf16 v[64:79], v[240:243], v[216:219], v[64:79]
  s_waitcnt lgkmcnt(4)
  v_mfma_f32_32x32x16_bf16 v[80:95], v[244:247], v[216:219], v[80:95]
  s_waitcnt vmcnt(0) lgkmcnt(0)
  v_mfma_f32_32x32x16_bf16 v[64:79], v[248:251], v[220:223], v[64:79]
  v_mfma_f32_32x32x16_bf16 v[80:95], v[252:255], v[220:223], v[80:95]
  s_mov_b32 s36, 0x3f803f80
  v_mov_b32 v8, 0
  v_mov_b32 v9, 0
  v_mov_b32 v10, 0
  v_mov_b32 v11, 0
  v_mov_b32 v12, 0
  v_mov_b32 v13, 0
  v_lshlrev_b32 v19, 2, v18
  v_lshl_add_u32 v19, v17, 13, v19
  s_lshl_b32 s34, s32, 7
  s_add_u32 s34, s34, s66
  s_add_u32 s34, s34, 16384
  s_add_u32 s37, s34, 16384
  v_cvt_pk_bf16_f32 v20, v64, v65
  v_cvt_pk_bf16_f32 v21, v66, v67
  v_cvt_pk_bf16_f32 v22, v68, v69
  v_cvt_pk_bf16_f32 v23, v70, v71
  buffer_store_dwordx4 v[20:23], v16, s[4:7], s39 offen offset:0 sc1
  v_cvt_pk_bf16_f32 v24, v72, v73
  v_cvt_pk_bf16_f32 v25, v74, v75
  v_cvt_pk_bf16_f32 v26, v76, v77
  v_cvt_pk_bf16_f32 v27, v78, v79
  buffer_store_dwordx4 v[24:27], v16, s[4:7], s39 offen offset:512 sc1
  v_cvt_pk_bf16_f32 v28, v80, v81
  v_cvt_pk_bf16_f32 v29, v82, v83
  v_cvt_pk_bf16_f32 v30, v84, v85
  v_cvt_pk_bf16_f32 v31, v86, v87
  buffer_store_dwordx4 v[28:31], v16, s[4:7], s39 offen offset:1024 sc1
  v_cvt_pk_bf16_f32 v32, v88, v89
  v_cvt_pk_bf16_f32 v33, v90, v91
  v_cvt_pk_bf16_f32 v34, v92, v93
  v_cvt_pk_bf16_f32 v35, v94, v95
  buffer_store_dwordx4 v[32:35], v16, s[4:7], s39 offen offset:1536 sc1
  v_dot2c_f32_bf16 v8, s36, v20
  v_dot2c_f32_bf16 v9, v20, v20
  v_dot2c_f32_bf16 v10, v20, v48
  v_dot2c_f32_bf16 v11, s36, v21
  v_dot2c_f32_bf16 v12, v21, v21
  v_dot2c_f32_bf16 v13, v21, v49
  v_dot2c_f32_bf16 v8, s36, v22
  v_dot2c_f32_bf16 v9, v22, v22
  v_dot2c_f32_bf16 v10, v22, v50
  v_dot2c_f32_bf16 v11, s36, v23
  v_dot2c_f32_bf16 v12, v23, v23
  v_dot2c_f32_bf16 v13, v23, v51
  v_dot2c_f32_bf16 v8, s36, v24
  v_dot2c_f32_bf16 v9, v24, v24
  v_dot2c_f32_bf16 v10, v24, v52
  v_dot2c_f32_bf16 v11, s36, v25
  v_dot2c_f32_bf16 v12, v25, v25
  v_dot2c_f32_bf16 v13, v25, v53
  v_dot2c_f32_bf16 v8, s36, v26
  v_dot2c_f32_bf16 v9, v26, v26
  v_dot2c_f32_bf16 v10, v26, v54
  v_dot2c_f32_bf16 v11, s36, v27
  v_dot2c_f32_bf16 v12, v27, v27
  v_dot2c_f32_bf16 v13, v27, v55
  v_dot2c_f32_bf16 v8, s36, v28
  v_dot2c_f32_bf16 v9, v28, v28
  v_dot2c_f32_bf16 v10, v28, v56
  v_dot2c_f32_bf16 v11, s36, v29
  v_dot2c_f32_bf16 v12, v29, v29
  v_dot2c_f32_bf16 v13, v29, v57
  v_dot2c_f32_bf16 v8, s36, v30
  v_dot2c_f32_bf16 v9, v30, v30
  v_dot2c_f32_bf16 v10, v30, v58
  v_dot2c_f32_bf16 v11, s36, v31
  v_dot2c_f32_bf16 v12, v31, v31
  v_dot2c_f32_bf16 v13, v31, v59
  v_dot2c_f32_bf16 v8, s36, v32
  v_dot2c_f32_bf16 v9, v32, v32
  v_dot2c_f32_bf16 v10, v32, v60
  v_dot2c_f32_bf16 v11, s36, v33
  v_dot2c_f32_bf16 v12, v33, v33
  v_dot2c_f32_bf16 v13, v33, v61
  v_dot2c_f32_bf16 v8, s36, v34
  v_dot2c_f32_bf16 v9, v34, v34
  v_dot2c_f32_bf16 v10, v34, v62
  v_dot2c_f32_bf16 v11, s36, v35
  v_dot2c_f32_bf16 v12, v35, v35
  v_dot2c_f32_bf16 v13, v35, v63
  s_nop 0
  v_add_f32 v36, v8, v11
  v_add_f32 v37, v9, v12
  v_add_f32 v38, v10, v13
  v_fma_f32 v38, -v36, v46, v38
  v_fmac_f32 v47, 0x44800000, v37
  v_mov_b32 v39, v38
  s_nop 0
  v_permlane32_swap_b32 v36, v47
  v_permlane32_swap_b32 v38, v39
  v_add_f32 v36, v36, v47
  v_add_f32 v38, v38, v39
  buffer_atomic_add_f32 v36, v19, s[4:7], s34 offen sc1
  s_mov_b32 exec_hi, 0
  buffer_atomic_add_f32 v38, v19, s[4:7], s37 offen sc1
  s_mov_b64 exec, -1
  s_barrier
  v_add_u32 v1, 4, v6
  s_mov_b32 s72, s66
  s_mov_b32 s73, s65
  s_mov_b32 s74, s67
  s_mov_b32 s75, s62
  s_cmp_lg_u32 s62, 0
  s_cbranch_scc1 .fz_kernel_tail
  s_mov_b32 s62, 1
  s_mov_b32 s63, 0x2000000
  s_mov_b32 s64, 0x2800000
  s_mov_b32 s65, 0x1400000
  s_mov_b32 s66, 0x1c42000
  s_mov_b32 s67, 12
  s_mov_b32 s71, 159776
  v_mov_b32 v6, 159832
  s_branch .fz_kernel_q_cons2
.fz_kernel_tail:
  s_mov_b32 s28, s56
  s_mov_b32 s29, s57
  s_mov_b32 s30, 0x400000
  s_mov_b32 s31, 0x00020000
  v_lshlrev_b32 v37, 2, v45
  v_add_u32 v37, 155644, v37
  v_mov_b32 v36, 159952
  v_lshlrev_b32 v38, 11, v18
  v_lshl_add_u32 v38, v17, 4, v38
  s_lshl_b32 s32, s32, 16
  s_lshl_b32 s33, s18, 7
  s_add_u32 s32, s32, s33
  v_lshlrev_b32 v64, 16, v20
  v_and_b32 v65, 0xffff0000, v20
  v_lshlrev_b32 v66, 16, v21
  v_and_b32 v67, 0xffff0000, v21
  v_lshlrev_b32 v68, 16, v22
  v_and_b32 v69, 0xffff0000, v22
  v_lshlrev_b32 v70, 16, v23
  v_and_b32 v71, 0xffff0000, v23
  v_lshlrev_b32 v72, 16, v24
  v_and_b32 v73, 0xffff0000, v24
  v_lshlrev_b32 v74, 16, v25
  v_and_b32 v75, 0xffff0000, v25
  v_lshlrev_b32 v76, 16, v26
  v_and_b32 v77, 0xffff0000, v26
  v_lshlrev_b32 v78, 16, v27
  v_and_b32 v79, 0xffff0000, v27
  v_lshlrev_b32 v80, 16, v28
  v_and_b32 v81, 0xffff0000, v28
  v_lshlrev_b32 v82, 16, v29
  v_and_b32 v83, 0xffff0000, v29
  v_lshlrev_b32 v84, 16, v30
  v_and_b32 v85, 0xffff0000, v30
  v_lshlrev_b32 v86, 16, v31
  v_and_b32 v87, 0xffff0000, v31
  v_lshlrev_b32 v88, 16, v32
  v_and_b32 v89, 0xffff0000, v32
  v_lshlrev_b32 v90, 16, v33
  v_and_b32 v91, 0xffff0000, v33
  v_lshlrev_b32 v92, 16, v34
  v_and_b32 v93, 0xffff0000, v34
  v_lshlrev_b32 v94, 16, v35
  v_and_b32 v95, 0xffff0000, v35
  s_mov_b64 exec, 1
  s_waitcnt vmcnt(0)
  ds_add_u32 v1, v5 offset:0x100
  s_mov_b64 exec, -1
  s_barrier
  ds_read_b32 v40, v37 offset:6400
  ds_read_b32 v42, v37 offset:6912
  ds_read_b32 v36, v36
  s_waitcnt lgkmcnt(0)
  v_cmp_ne_u32 vcc, v36, v45
  s_mov_b64 exec, vcc
  v_pk_fma_f32 v[64:65], v[64:65], v[40:41], v[42:43] op_sel_hi:[1,0,0]
  v_pk_fma_f32 v[66:67], v[66:67], v[40:41], v[42:43] op_sel_hi:[1,0,0]
  v_pk_fma_f32 v[68:69], v[68:69], v[40:41], v[42:43] op_sel_hi:[1,0,0]
  v_pk_fma_f32 v[70:71], v[70:71], v[40:41], v[42:43] op_sel_hi:[1,0,0]
  v_cvt_pk_bf16_f32 v20, v64, v65
  v_cvt_pk_bf16_f32 v21, v66, v67
  v_cvt_pk_bf16_f32 v22, v68, v69
  v_cvt_pk_bf16_f32 v23, v70, v71
  buffer_store_dwordx4 v[20:23], v38, s[28:31], s32 offen offset:0
  v_pk_fma_f32 v[72:73], v[72:73], v[40:41], v[42:43] op_sel_hi:[1,0,0]
  v_pk_fma_f32 v[74:75], v[74:75], v[40:41], v[42:43] op_sel_hi:[1,0,0]
  v_pk_fma_f32 v[76:77], v[76:77], v[40:41], v[42:43] op_sel_hi:[1,0,0]
  v_pk_fma_f32 v[78:79], v[78:79], v[40:41], v[42:43] op_sel_hi:[1,0,0]
  v_cvt_pk_bf16_f32 v24, v72, v73
  v_cvt_pk_bf16_f32 v25, v74, v75
  v_cvt_pk_bf16_f32 v26, v76, v77
  v_cvt_pk_bf16_f32 v27, v78, v79
  buffer_store_dwordx4 v[24:27], v38, s[28:31], s32 offen offset:32
  v_pk_fma_f32 v[80:81], v[80:81], v[40:41], v[42:43] op_sel_hi:[1,0,0]
  v_pk_fma_f32 v[82:83], v[82:83], v[40:41], v[42:43] op_sel_hi:[1,0,0]
  v_pk_fma_f32 v[84:85], v[84:85], v[40:41], v[42:43] op_sel_hi:[1,0,0]
  v_pk_fma_f32 v[86:87], v[86:87], v[40:41], v[42:43] op_sel_hi:[1,0,0]
  v_cvt_pk_bf16_f32 v28, v80, v81
  v_cvt_pk_bf16_f32 v29, v82, v83
  v_cvt_pk_bf16_f32 v30, v84, v85
  v_cvt_pk_bf16_f32 v31, v86, v87
  buffer_store_dwordx4 v[28:31], v38, s[28:31], s32 offen offset:64
  v_pk_fma_f32 v[88:89], v[88:89], v[40:41], v[42:43] op_sel_hi:[1,0,0]
  v_pk_fma_f32 v[90:91], v[90:91], v[40:41], v[42:43] op_sel_hi:[1,0,0]
  v_pk_fma_f32 v[92:93], v[92:93], v[40:41], v[42:43] op_sel_hi:[1,0,0]
  v_pk_fma_f32 v[94:95], v[94:95], v[40:41], v[42:43] op_sel_hi:[1,0,0]
  v_cvt_pk_bf16_f32 v32, v88, v89
  v_cvt_pk_bf16_f32 v33, v90, v91
  v_cvt_pk_bf16_f32 v34, v92, v93
  v_cvt_pk_bf16_f32 v35, v94, v95
  buffer_store_dwordx4 v[32:35], v38, s[28:31], s32 offen offset:96
  s_mov_b64 exec, -1
  s_branch .fz_kernel_fin
.fz_kernel_chain:
  s_setprio 0
  s_bitcmp1_b32 s18, 0
  s_cselect_b32 s8, s52, s50
  s_cselect_b32 s9, s53, s51
  s_mov_b32 s10, 0x700000
  s_mov_b32 s11, 0x00020000
  s_lshl_b32 s12, s16, 8
  s_and_b32 s12, s12, 511
  s_and_b32 s31, s18, 2
  s_lshl_b32 s31, s31, 8
  s_add_u32 s12, s12, s31
  s_mul_i32 s12, s12, 7168
  s_lshl_b32 s31, s17, 2
  s_lshr_b32 s33, s18, 2
  s_add_u32 s31, s31, s33
  s_lshl_b32 s31, s31, 7
  s_add_u32 s12, s12, s31
  v_lshrrev_b32 v13, 3, v2
  v_mul_u32_u24 v13, 229376, v13
  v_and_b32 v11, 7, v2
  v_lshl_add_u32 v13, v11, 4, v13
  s_mov_b32 s24, s44
  s_mov_b32 s25, s45
  s_mov_b32 s26, 0x200000
  s_mov_b32 s27, 0x00020000
  v_lshrrev_b32 v8, 3, v2
  v_and_b32 v9, 7, v2
  v_bfe_u32 v10, v2, 4, 1
  v_lshlrev_b32 v10, 2, v10
  v_xor_b32 v9, v9, v10
  v_lshlrev_b32 v9, 4, v9
  v_lshl_add_u32 v10, v8, 11, v9
  s_mov_b32 s24, s54
  s_mov_b32 s25, s55
  s_mov_b32 s26, 0x700000
  s_mov_b32 s27, 0x00020000
  s_mov_b32 s36, 0x05040100
  s_mov_b32 s37, 0x07060302
  s_and_b32 s20, s16, 1
  s_lshl1_add_u32 s13, s17, s20
  s_lshl_b32 s13, s13, 18
  s_lshl_b32 s14, s18, 7
  s_add_u32 s13, s13, s14
  s_cmp_ge_u32 s17, 14
  s_cbranch_scc1 .fz_kernel_c_nl
  s_mov_b32 s38, 0
.fz_kernel_kw59:
  s_sleep 2
  ds_read_b32 v7, v6 offset:0
  s_add_u32 s38, s38, 1
  s_waitcnt lgkmcnt(0)
  v_readfirstlane_b32 s31, v7
  s_bcnt1_i32_b32 s31, s31
  s_cmp_ge_u32 s31, 16
  s_cbranch_scc1 .fz_kernel_kw59d
  s_cmp_lt_u32 s38, 1048576
  s_cbranch_scc1 .fz_kernel_kw59
.fz_kernel_kw59d:
  buffer_load_dwordx4 v[112:115], v13, s[8:11], s12 offen nt
  s_add_u32 s12, s12, 7168
  s_waitcnt vmcnt(2)
  buffer_load_dwordx4 v[116:119], v13, s[8:11], s12 offen nt
  s_add_u32 s12, s12, 7168
  s_waitcnt vmcnt(2)
  buffer_load_dwordx4 v[120:123], v13, s[8:11], s12 offen nt
  s_add_u32 s12, s12, 7168
  s_waitcnt vmcnt(2)
  buffer_load_dwordx4 v[124:127], v13, s[8:11], s12 offen nt
  s_add_u32 s12, s12, 7168
  s_waitcnt vmcnt(2)
  buffer_load_dwordx4 v[128:131], v13, s[8:11], s12 offen nt
  s_add_u32 s12, s12, 7168
  s_waitcnt vmcnt(2)
  buffer_load_dwordx4 v[132:135], v13, s[8:11], s12 offen nt
  s_add_u32 s12, s12, 7168
  s_waitcnt vmcnt(2)
  buffer_load_dwordx4 v[136:139], v13, s[8:11], s12 offen nt
  s_add_u32 s12, s12, 7168
  s_waitcnt vmcnt(2)
  buffer_load_dwordx4 v[140:143], v13, s[8:11], s12 offen nt
  s_add_u32 s12, s12, 7168
  s_waitcnt vmcnt(2)
  buffer_load_dwordx4 v[144:147], v13, s[8:11], s12 offen nt
  s_add_u32 s12, s12, 7168
  s_waitcnt vmcnt(2)
  buffer_load_dwordx4 v[148:151], v13, s[8:11], s12 offen nt
  s_add_u32 s12, s12, 7168
  s_waitcnt vmcnt(2)
  buffer_load_dwordx4 v[152:155], v13, s[8:11], s12 offen nt
  s_add_u32 s12, s12, 7168
  s_waitcnt vmcnt(2)
  buffer_load_dwordx4 v[156:159], v13, s[8:11], s12 offen nt
  s_add_u32 s12, s12, 7168
  s_waitcnt vmcnt(2)
  buffer_load_dwordx4 v[160:163], v13, s[8:11], s12 offen nt
  s_add_u32 s12, s12, 7168
  s_waitcnt vmcnt(2)
  buffer_load_dwordx4 v[164:167], v13, s[8:11], s12 offen nt
  s_add_u32 s12, s12, 7168
  s_waitcnt vmcnt(2)
  buffer_load_dwordx4 v[168:171], v13, s[8:11], s12 offen nt
  s_add_u32 s12, s12, 7168
  s_waitcnt vmcnt(2)
  buffer_load_dwordx4 v[172:175], v13, s[8:11], s12 offen nt
  s_add_u32 s12, s12, 7168
  s_waitcnt vmcnt(2)
  buffer_load_dwordx4 v[176:179], v13, s[8:11], s12 offen nt
  s_add_u32 s12, s12, 7168
  s_waitcnt vmcnt(2)
  buffer_load_dwordx4 v[180:183], v13, s[8:11], s12 offen nt
  s_add_u32 s12, s12, 7168
  s_waitcnt vmcnt(2)
  buffer_load_dwordx4 v[184:187], v13, s[8:11], s12 offen nt
  s_add_u32 s12, s12, 7168
  s_waitcnt vmcnt(2)
  buffer_load_dwordx4 v[188:191], v13, s[8:11], s12 offen nt
  s_add_u32 s12, s12, 7168
  s_waitcnt vmcnt(2)
  buffer_load_dwordx4 v[192:195], v13, s[8:11], s12 offen nt
  s_add_u32 s12, s12, 7168
  s_waitcnt vmcnt(2)
  buffer_load_dwordx4 v[196:199], v13, s[8:11], s12 offen nt
  s_add_u32 s12, s12, 7168
  s_waitcnt vmcnt(2)
  buffer_load_dwordx4 v[200:203], v13, s[8:11], s12 offen nt
  s_add_u32 s12, s12, 7168
  s_waitcnt vmcnt(2)
  buffer_load_dwordx4 v[204:207], v13, s[8:11], s12 offen nt
  s_add_u32 s12, s12, 7168
  s_waitcnt vmcnt(2)
  buffer_load_dwordx4 v[208:211], v13, s[8:11], s12 offen nt
  s_add_u32 s12, s12, 7168
  s_waitcnt vmcnt(2)
  buffer_load_dwordx4 v[212:215], v13, s[8:11], s12 offen nt
  s_add_u32 s12, s12, 7168
  s_waitcnt vmcnt(2)
  buffer_load_dwordx4 v[216:219], v13, s[8:11], s12 offen nt
  s_add_u32 s12, s12, 7168
  s_waitcnt vmcnt(2)
  buffer_load_dwordx4 v[220:223], v13, s[8:11], s12 offen nt
  s_add_u32 s12, s12, 7168
  s_waitcnt vmcnt(2)
  buffer_load_dwordx4 v[224:227], v13, s[8:11], s12 offen nt
  s_add_u32 s12, s12, 7168
  s_waitcnt vmcnt(2)
  buffer_load_dwordx4 v[228:231], v13, s[8:11], s12 offen nt
  s_add_u32 s12, s12, 7168
  s_waitcnt vmcnt(2)
  buffer_load_dwordx4 v[232:235], v13, s[8:11], s12 offen nt
  s_add_u32 s12, s12, 7168
  s_waitcnt vmcnt(2)
  buffer_load_dwordx4 v[236:239], v13, s[8:11], s12 offen nt
  s_add_u32 s12, s12, 7168
  s_waitcnt vmcnt(2)
  buffer_load_dwordx4 v[32:35], v10, s[24:27], s13 offen nt
  s_add_u32 s13, s13, 16384
  s_waitcnt vmcnt(2)
  buffer_load_dwordx4 v[36:39], v10, s[24:27], s13 offen nt
  s_add_u32 s13, s13, 16384
  s_waitcnt vmcnt(2)
  buffer_load_dwordx4 v[40:43], v10, s[24:27], s13 offen nt
  s_add_u32 s13, s13, 16384
  s_waitcnt vmcnt(2)
  buffer_load_dwordx4 v[44:47], v10, s[24:27], s13 offen nt
  s_add_u32 s13, s13, 16384
  s_waitcnt vmcnt(2)
  buffer_load_dwordx4 v[48:51], v10, s[24:27], s13 offen nt
  s_add_u32 s13, s13, 16384
  s_waitcnt vmcnt(2)
  buffer_load_dwordx4 v[52:55], v10, s[24:27], s13 offen nt
  s_add_u32 s13, s13, 16384
  s_waitcnt vmcnt(2)
  buffer_load_dwordx4 v[56:59], v10, s[24:27], s13 offen nt
  s_add_u32 s13, s13, 16384
  s_waitcnt vmcnt(2)
  buffer_load_dwordx4 v[60:63], v10, s[24:27], s13 offen nt
  s_add_u32 s13, s13, 16384
  s_waitcnt vmcnt(2)
  buffer_load_dwordx4 v[64:67], v10, s[24:27], s13 offen nt
  s_add_u32 s13, s13, 16384
  s_waitcnt vmcnt(2)
  buffer_load_dwordx4 v[68:71], v10, s[24:27], s13 offen nt
  s_add_u32 s13, s13, 16384
  s_waitcnt vmcnt(2)
  buffer_load_dwordx4 v[72:75], v10, s[24:27], s13 offen nt
  s_add_u32 s13, s13, 16384
  s_waitcnt vmcnt(2)
  buffer_load_dwordx4 v[76:79], v10, s[24:27], s13 offen nt
  s_add_u32 s13, s13, 16384
  s_waitcnt vmcnt(2)
  buffer_load_dwordx4 v[240:243], v10, s[24:27], s13 offen nt
  s_add_u32 s13, s13, 16384
  s_waitcnt vmcnt(2)
  buffer_load_dwordx4 v[244:247], v10, s[24:27], s13 offen nt
  s_add_u32 s13, s13, 16384
  s_waitcnt vmcnt(2)
  buffer_load_dwordx4 v[248:251], v10, s[24:27], s13 offen nt
  s_add_u32 s13, s13, 16384
  s_waitcnt vmcnt(2)
  buffer_load_dwordx4 v[252:255], v10, s[24:27], s13 offen nt
  s_add_u32 s13, s13, 16384
  s_waitcnt vmcnt(2)
  v_mov_b32 v16, 0x3f803f80
  v_mov_b32 v17, 0x3f803f80
  v_mov_b32 v18, 0x3f803f80
  v_mov_b32 v19, 0x3f803f80
  s_waitcnt vmcnt(0)
  s_barrier
  v_perm_b32 v80, v116, v112, s36
  v_perm_b32 v84, v116, v112, s37
  v_perm_b32 v88, v117, v113, s36
  v_perm_b32 v92, v117, v113, s37
  v_perm_b32 v96, v118, v114, s36
  v_perm_b32 v100, v118, v114, s37
  v_perm_b32 v104, v119, v115, s36
  v_perm_b32 v108, v119, v115, s37
  v_perm_b32 v81, v124, v120, s36
  v_perm_b32 v85, v124, v120, s37
  v_perm_b32 v89, v125, v121, s36
  v_perm_b32 v93, v125, v121, s37
  v_perm_b32 v97, v126, v122, s36
  v_perm_b32 v101, v126, v122, s37
  v_perm_b32 v105, v127, v123, s36
  v_perm_b32 v109, v127, v123, s37
  v_perm_b32 v82, v132, v128, s36
  v_perm_b32 v86, v132, v128, s37
  v_perm_b32 v90, v133, v129, s36
  v_perm_b32 v94, v133, v129, s37
  v_perm_b32 v98, v134, v130, s36
  v_perm_b32 v102, v134, v130, s37
  v_perm_b32 v106, v135, v131, s36
  v_perm_b32 v110, v135, v131, s37
  v_perm_b32 v83, v140, v136, s36
  v_perm_b32 v87, v140, v136, s37
  v_perm_b32 v91, v141, v137, s36
  v_perm_b32 v95, v141, v137, s37
  v_perm_b32 v99, v142, v138, s36
  v_perm_b32 v103, v142, v138, s37
  v_perm_b32 v107, v143, v139, s36
  v_perm_b32 v111, v143, v139, s37
  v_perm_b32 v112, v148, v144, s36
  v_perm_b32 v116, v148, v144, s37
  v_perm_b32 v120, v149, v145, s36
  v_perm_b32 v124, v149, v145, s37
  v_perm_b32 v128, v150, v146, s36
  v_perm_b32 v132, v150, v146, s37
  v_perm_b32 v136, v151, v147, s36
  v_perm_b32 v140, v151, v147, s37
  v_perm_b32 v113, v156, v152, s36
  v_perm_b32 v117, v156, v152, s37
  v_perm_b32 v121, v157, v153, s36
  v_perm_b32 v125, v157, v153, s37
  v_perm_b32 v129, v158, v154, s36
  v_perm_b32 v133, v158, v154, s37
  v_perm_b32 v137, v159, v155, s36
  v_perm_b32 v141, v159, v155, s37
  v_perm_b32 v114, v164, v160, s36
  v_perm_b32 v118, v164, v160, s37
  v_perm_b32 v122, v165, v161, s36
  v_perm_b32 v126, v165, v161, s37
  v_perm_b32 v130, v166, v162, s36
  v_perm_b32 v134, v166, v162, s37
  v_perm_b32 v138, v167, v163, s36
  v_perm_b32 v142, v167, v163, s37
  v_perm_b32 v115, v172, v168, s36
  v_perm_b32 v119, v172, v168, s37
  v_perm_b32 v123, v173, v169, s36
  v_perm_b32 v127, v173, v169, s37
  v_perm_b32 v131, v174, v170, s36
  v_perm_b32 v135, v174, v170, s37
  v_perm_b32 v139, v175, v171, s36
  v_perm_b32 v143, v175, v171, s37
  v_perm_b32 v144, v180, v176, s36
  v_perm_b32 v148, v180, v176, s37
  v_perm_b32 v152, v181, v177, s36
  v_perm_b32 v156, v181, v177, s37
  v_perm_b32 v160, v182, v178, s36
  v_perm_b32 v164, v182, v178, s37
  v_perm_b32 v168, v183, v179, s36
  v_perm_b32 v172, v183, v179, s37
  v_perm_b32 v145, v188, v184, s36
  v_perm_b32 v149, v188, v184, s37
  v_perm_b32 v153, v189, v185, s36
  v_perm_b32 v157, v189, v185, s37
  v_perm_b32 v161, v190, v186, s36
  v_perm_b32 v165, v190, v186, s37
  v_perm_b32 v169, v191, v187, s36
  v_perm_b32 v173, v191, v187, s37
  v_perm_b32 v146, v196, v192, s36
  v_perm_b32 v150, v196, v192, s37
  v_perm_b32 v154, v197, v193, s36
  v_perm_b32 v158, v197, v193, s37
  v_perm_b32 v162, v198, v194, s36
  v_perm_b32 v166, v198, v194, s37
  v_perm_b32 v170, v199, v195, s36
  v_perm_b32 v174, v199, v195, s37
  v_perm_b32 v147, v204, v200, s36
  v_perm_b32 v151, v204, v200, s37
  v_perm_b32 v155, v205, v201, s36
  v_perm_b32 v159, v205, v201, s37
  v_perm_b32 v163, v206, v202, s36
  v_perm_b32 v167, v206, v202, s37
  v_perm_b32 v171, v207, v203, s36
  v_perm_b32 v175, v207, v203, s37
  v_perm_b32 v176, v212, v208, s36
  v_perm_b32 v180, v212, v208, s37
  v_perm_b32 v184, v213, v209, s36
  v_perm_b32 v188, v213, v209, s37
  v_perm_b32 v192, v214, v210, s36
  v_perm_b32 v196, v214, v210, s37
  v_perm_b32 v200, v215, v211, s36
  v_perm_b32 v204, v215, v211, s37
  v_perm_b32 v177, v220, v216, s36
  v_perm_b32 v181, v220, v216, s37
  v_perm_b32 v185, v221, v217, s36
  v_perm_b32 v189, v221, v217, s37
  v_perm_b32 v193, v222, v218, s36
  v_perm_b32 v197, v222, v218, s37
  v_perm_b32 v201, v223, v219, s36
  v_perm_b32 v205, v223, v219, s37
  v_perm_b32 v178, v228, v224, s36
  v_perm_b32 v182, v228, v224, s37
  v_perm_b32 v186, v229, v225, s36
  v_perm_b32 v190, v229, v225, s37
  v_perm_b32 v194, v230, v226, s36
  v_perm_b32 v198, v230, v226, s37
  v_perm_b32 v202, v231, v227, s36
  v_perm_b32 v206, v231, v227, s37
  v_perm_b32 v179, v236, v232, s36
  v_perm_b32 v183, v236, v232, s37
  v_perm_b32 v187, v237, v233, s36
  v_perm_b32 v191, v237, v233, s37
  v_perm_b32 v195, v238, v234, s36
  v_perm_b32 v199, v238, v234, s37
  v_perm_b32 v203, v239, v235, s36
  v_perm_b32 v207, v239, v235, s37
  v_mfma_f32_16x16x32_bf16 v[208:211], v[16:19], v[80:83], 0
  v_mfma_f32_16x16x32_bf16 v[212:215], v[16:19], v[84:87], 0
  v_mfma_f32_16x16x32_bf16 v[216:219], v[16:19], v[88:91], 0
  v_mfma_f32_16x16x32_bf16 v[220:223], v[16:19], v[92:95], 0
  v_mfma_f32_16x16x32_bf16 v[224:227], v[16:19], v[96:99], 0
  v_mfma_f32_16x16x32_bf16 v[228:231], v[16:19], v[100:103], 0
  v_mfma_f32_16x16x32_bf16 v[232:235], v[16:19], v[104:107], 0
  v_mfma_f32_16x16x32_bf16 v[236:239], v[16:19], v[108:111], 0
  v_mfma_f32_16x16x32_bf16 v[208:211], v[16:19], v[112:115], v[208:211]
  v_mfma_f32_16x16x32_bf16 v[212:215], v[16:19], v[116:119], v[212:215]
  v_mfma_f32_16x16x32_bf16 v[216:219], v[16:19], v[120:123], v[216:219]
  v_mfma_f32_16x16x32_bf16 v[220:223], v[16:19], v[124:127], v[220:223]
  v_mfma_f32_16x16x32_bf16 v[224:227], v[16:19], v[128:131], v[224:227]
  v_mfma_f32_16x16x32_bf16 v[228:231], v[16:19], v[132:135], v[228:231]
  v_mfma_f32_16x16x32_bf16 v[232:235], v[16:19], v[136:139], v[232:235]
  v_mfma_f32_16x16x32_bf16 v[236:239], v[16:19], v[140:143], v[236:239]
  v_mfma_f32_16x16x32_bf16 v[208:211], v[16:19], v[144:147], v[208:211]
  v_mfma_f32_16x16x32_bf16 v[212:215], v[16:19], v[148:151], v[212:215]
  v_mfma_f32_16x16x32_bf16 v[216:219], v[16:19], v[152:155], v[216:219]
  v_mfma_f32_16x16x32_bf16 v[220:223], v[16:19], v[156:159], v[220:223]
  v_mfma_f32_16x16x32_bf16 v[224:227], v[16:19], v[160:163], v[224:227]
  v_mfma_f32_16x16x32_bf16 v[228:231], v[16:19], v[164:167], v[228:231]
  v_mfma_f32_16x16x32_bf16 v[232:235], v[16:19], v[168:171], v[232:235]
  v_mfma_f32_16x16x32_bf16 v[236:239], v[16:19], v[172:175], v[236:239]
  v_mfma_f32_16x16x32_bf16 v[208:211], v[16:19], v[176:179], v[208:211]
  v_mfma_f32_16x16x32_bf16 v[212:215], v[16:19], v[180:183], v[212:215]
  v_mfma_f32_16x16x32_bf16 v[216:219], v[16:19], v[184:187], v[216:219]
  v_mfma_f32_16x16x32_bf16 v[220:223], v[16:19], v[188:191], v[220:223]
  v_mfma_f32_16x16x32_bf16 v[224:227], v[16:19], v[192:195], v[224:227]
  v_mfma_f32_16x16x32_bf16 v[228:231], v[16:19], v[196:199], v[228:231]
  v_mfma_f32_16x16x32_bf16 v[232:235], v[16:19], v[200:203], v[232:235]
  v_mfma_f32_16x16x32_bf16 v[236:239], v[16:19], v[204:207], v[236:239]
  s_nop 0
  v_add_f32 v28, v209, v208 row_ror:8 row_mask:0xf bank_mask:0x3
  v_add_f32 v29, v213, v212 row_ror:8 row_mask:0xf bank_mask:0x3
  v_add_f32 v30, v217, v216 row_ror:8 row_mask:0xf bank_mask:0x3
  v_add_f32 v31, v221, v220 row_ror:8 row_mask:0xf bank_mask:0x3
  v_add_f32 v28, v224, v225 row_ror:8 row_mask:0xf bank_mask:0xc
  v_add_f32 v29, v228, v229 row_ror:8 row_mask:0xf bank_mask:0xc
  v_add_f32 v30, v232, v233 row_ror:8 row_mask:0xf bank_mask:0xc
  v_add_f32 v31, v236, v237 row_ror:8 row_mask:0xf bank_mask:0xc
  v_mul_f32 v28, 0.0009765625, v28
  v_mul_f32 v29, 0.0009765625, v29
  v_mul_f32 v30, 0.0009765625, v30
  v_mul_f32 v31, 0.0009765625, v31
.fz_kernel_c_np:
  v_mov_b32 v27, v6
  s_mov_b32 s72, s66
  s_mov_b32 s73, s65
  s_mov_b32 s74, s67
  s_mov_b32 s75, s62
  s_cmp_lg_u32 s62, 0
  s_cbranch_scc1 .fz_kernel_c_n2
  s_mov_b32 s62, 1
  s_mov_b32 s63, 0x2000000
  s_mov_b32 s64, 0x2800000
  s_mov_b32 s65, 0x1400000
  s_mov_b32 s66, 0x1c42000
  s_mov_b32 s67, 12
  s_mov_b32 s71, 159776
  v_mov_b32 v6, 159832
.fz_kernel_c_n2:
  s_lshr_b32 s21, s17, 3
  s_add_u32 s70, s18, s21
  s_lshl1_add_u32 s70, s17, s70
  s_and_b32 s70, s70, 15
  s_cmp_eq_u32 s75, 0
  s_cselect_b32 s3, 32, 0
  s_cselect_b32 s70, s70, s18
  s_and_b32 s20, s16, 1
  s_mov_b32 s34, 0x00030003
  s_mov_b32 s35, 0x00030003
  s_mov_b32 s71, 0
  s_lshl1_add_u32 s26, s17, s20
  v_lshrrev_b32 v8, 4, v2
  v_bfe_u32 v12, v2, 3, 1
  v_lshl_add_u32 v12, v12, 2, v8
  v_lshlrev_b32 v10, 7, v2
  s_lshl_b32 s25, s20, 1
  v_lshrrev_b32 v14, 4, v2
  v_bfe_u32 v15, v2, 2, 2
  v_lshl_add_u32 v16, v14, 3, v15
  v_lshlrev_b32 v16, 7, v16
  v_and_b32 v14, 1, v14
  v_lshrrev_b32 v15, 1, v15
  v_lshl_add_u32 v14, v14, 1, v15
  v_xor_b32 v14, s25, v14
  v_lshl_add_u32 v16, v14, 5, v16
  v_and_b32 v14, 3, v2
  v_lshl_add_u32 v16, v14, 3, v16
  v_add_u32 v7, 65536, v16
  v_xor_b32 v9, 32, v7
  s_add_u32 s21, s74, 0x1800008
  s_sub_u32 s22, s72, 32768
  v_mov_b32 v14, s21
  v_mov_b32 v15, s22
  v_cmp_gt_u32 vcc, 16, v2
  s_nop 1
  v_cndmask_b32 v14, v15, v14, vcc
  v_lshl_add_u32 v14, v2, 11, v14
  s_lshl_b32 s25, s17, 7
  s_lshl_b32 s22, 1, s18
  v_mov_b32 v15, s22
  v_lshlrev_b32 v16, 3, v2
  s_and_b32 s21, s2, 7
  s_lshl_b32 s21, s21, 11
  s_lshl_b32 s22, s20, 10
  s_add_u32 s21, s21, s22
  s_add_u32 s21, s21, s72
  s_lshl_b32 s22, s20, 12
  s_add_u32 s22, s22, s72
  s_add_u32 s22, s22, 16384
  s_add_u32 s23, s22, 8192
  s_add_u32 s24, s22, 16384
  v_and_b32 v17, 1, v8
  v_lshlrev_b32 v17, 13, v17
  v_lshrrev_b32 v18, 1, v8
  v_mul_u32_u24 v18, 320, v18
  v_add_u32 v17, v17, v18
  v_bfe_u32 v18, v2, 3, 1
  v_lshl_add_u32 v17, v18, 9, v17
  v_bfe_u32 v18, v2, 2, 1
  v_lshl_add_u32 v17, v18, 7, v17
  v_and_b32 v18, 3, v2
  v_lshl_add_u32 v17, v18, 3, v17
  s_lshl_b32 s27, s20, 14
  s_add_u32 s27, s27, 114688
  v_add_u32 v17, s27, v17
  v_xor_b32 v18, 64, v17
  v_and_b32 v19, 15, v2
  v_lshlrev_b32 v19, 6, v19
  v_lshl_add_u32 v19, v8, 4, v19
  v_and_b32 v20, 7, v2
  v_lshlrev_b32 v20, 5, v20
  v_and_b32 v21, 8, v2
  v_lshl_add_u32 v20, v21, 1, v20
  v_and_b32 v21, 31, v2
  v_lshlrev_b32 v21, 4, v21
  v_lshrrev_b32 v22, 5, v2
  v_lshl_add_u32 v21, v22, 11, v21
  v_mov_b32 v23, 0.0009765625
  v_mov_b32 v24, 9.5367431640625e-07
  v_mov_b32 v25, 1e-05
  v_add_u32 v26, 155648, v16
  s_lshl_b32 s14, s17, 9
  s_add_u32 s14, s14, s72
  s_add_u32 s14, s14, 16384
  s_add_u32 s15, s14, 8192
  v_add_u32 v13, s27, v3
  s_barrier
.fz_kernel_c_n3:
  s_mov_b32 s13, 0xff0000
  s_cmp_eq_u32 s20, 0
  s_cbranch_scc1 .fz_kernel_c_nf
  s_cmp_eq_u32 s75, 0
  s_cselect_b32 exec_lo, 0xffff, s13
  s_mov_b32 exec_hi, 0
  s_mov_b32 s38, 0
.fz_kernel_cw60:
  s_sleep 1
  ds_read_u8 v22, v27 offset:268
  s_add_u32 s38, s38, 1
  s_waitcnt lgkmcnt(0)
  v_cmp_gt_u32 vcc, 4, v22
  s_cbranch_vccz .fz_kernel_cw60d
  s_cmp_lt_u32 s38, 8388608
  s_cbranch_scc1 .fz_kernel_cw60
.fz_kernel_cw60d:
  buffer_atomic_or v15, v14, s[4:7], s25 offen sc1
  s_mov_b64 exec, -1
.fz_kernel_c_nf:
  s_add_u32 s13, s19, s74
  s_mov_b64 exec, 1
  buffer_load_dword v11, v4, s[4:7], s13 offen offset:8 sc1
  s_mov_b64 exec, -1
  ds_write_b128 v13, v[32:35] offset:0
  ds_write_b128 v13, v[36:39] offset:1024
  ds_write_b128 v13, v[40:43] offset:2048
  ds_write_b128 v13, v[44:47] offset:3072
  ds_write_b128 v13, v[48:51] offset:4096
  ds_write_b128 v13, v[52:55] offset:5120
  ds_write_b128 v13, v[56:59] offset:6144
  ds_write_b128 v13, v[60:63] offset:7168
  ds_write_b128 v13, v[64:67] offset:8192
  ds_write_b128 v13, v[68:71] offset:9216
  ds_write_b128 v13, v[72:75] offset:10240
  ds_write_b128 v13, v[76:79] offset:11264
  ds_write_b128 v13, v[240:243] offset:12288
  ds_write_b128 v13, v[244:247] offset:13312
  ds_write_b128 v13, v[248:251] offset:14336
  ds_write_b128 v13, v[252:255] offset:15360
  v_and_b32 v14, 1, v2
  v_lshlrev_b32 v14, 10, v14
  v_lshl_add_u32 v14, v8, 14, v14
  s_waitcnt lgkmcnt(0)
  s_cmp_lg_u32 s75, 0
  s_cbranch_scc1 .fz_kernel_c_nw
  v_mov_b32 v13, v9
  s_lshl_b32 s21, s18, 10
  s_add_u32 s21, s21, s72
  s_cmp_lg_u32 s20, 0
  s_cbranch_scc1 .fz_kernel_c_c7
  s_add_u32 s22, s19, s74
  s_add_u32 s23, s14, 16384
  s_mov_b64 exec, 1
  s_mov_b32 s38, 0
  s_branch .fz_kernel_c_c00
.fz_kernel_c_c0:
  s_sleep 6
  buffer_load_dword v11, v4, s[4:7], s22 offen offset:8 sc1
.fz_kernel_c_c00:
  s_add_u32 s38, s38, 1
  s_waitcnt vmcnt(0)
  ds_or_b32 v6, v11 offset:0x114
  v_or_b32 v11, v11, v15
  v_cmp_ne_u32 vcc, 0xffff, v11
  s_cbranch_vccz .fz_kernel_c_c1
  s_cmp_lt_u32 s38, 131072
  s_cbranch_scc1 .fz_kernel_c_c0
.fz_kernel_c_c1:
  s_mov_b32 s38, 0
.fz_kernel_cw61:
  s_sleep 1
  ds_read_u8 v22, v27 offset:268
  s_add_u32 s38, s38, 1
  s_waitcnt lgkmcnt(0)
  v_cmp_gt_u32 vcc, 4, v22
  s_cbranch_vccz .fz_kernel_cw61d
  s_cmp_lt_u32 s38, 8388608
  s_cbranch_scc1 .fz_kernel_cw61
.fz_kernel_cw61d:
  ds_or_b32 v6, v11 offset:0x114
  s_mov_b64 exec, -1
  buffer_load_dwordx2 v[240:241], v16, s[4:7], s14 offen
  buffer_load_dwordx2 v[242:243], v16, s[4:7], s15 offen
  buffer_load_dwordx2 v[244:245], v16, s[4:7], s23 offen
  s_lshl_b32 s23, s17, 6
  s_add_u32 s23, s23, s21
  s_lshl_b32 s24, s17, 7
  s_add_u32 s24, s24, 1
  s_mov_b32 s38, 0
.fz_kernel_cw62:
  s_sleep 1
  ds_read_u8 v22, v6 offset:272
  s_add_u32 s38, s38, 1
  s_waitcnt lgkmcnt(0)
  v_cmp_gt_u32 vcc, 2, v22
  s_cbranch_vccz .fz_kernel_cw62d
  s_cmp_lt_u32 s38, 8388608
  s_cbranch_scc1 .fz_kernel_cw62
.fz_kernel_cw62d:
  ds_read_b64_tr_b16 v[32:33], v7 offset:0
  ds_read_b64_tr_b16 v[34:35], v7 offset:512
  ds_read_b64_tr_b16 v[36:37], v13 offset:0
  ds_read_b64_tr_b16 v[38:39], v13 offset:512
  ds_read_b64_tr_b16 v[40:41], v7 offset:4096
  ds_read_b64_tr_b16 v[42:43], v7 offset:4608
  ds_read_b64_tr_b16 v[44:45], v13 offset:4096
  ds_read_b64_tr_b16 v[46:47], v13 offset:4608
  ds_read_b64_tr_b16 v[48:49], v7 offset:8192
  ds_read_b64_tr_b16 v[50:51], v7 offset:8704
  ds_read_b64_tr_b16 v[52:53], v13 offset:8192
  ds_read_b64_tr_b16 v[54:55], v13 offset:8704
  s_waitcnt lgkmcnt(0)
  ds_read_b64_tr_b16 v[56:57], v7 offset:12288
  ds_read_b64_tr_b16 v[58:59], v7 offset:12800
  ds_read_b64_tr_b16 v[60:61], v13 offset:12288
  ds_read_b64_tr_b16 v[62:63], v13 offset:12800
  ds_read_b64_tr_b16 v[64:65], v7 offset:16384
  ds_read_b64_tr_b16 v[66:67], v7 offset:16896
  ds_read_b64_tr_b16 v[68:69], v13 offset:16384
  ds_read_b64_tr_b16 v[70:71], v13 offset:16896
  ds_read_b64_tr_b16 v[72:73], v7 offset:20480
  ds_read_b64_tr_b16 v[74:75], v7 offset:20992
  ds_read_b64_tr_b16 v[76:77], v13 offset:20480
  ds_read_b64_tr_b16 v[78:79], v13 offset:20992
  s_waitcnt lgkmcnt(0)
  s_waitcnt vmcnt(0)
  v_fma_f32 v208, -v240, v240, v242
  v_fma_f32 v209, -v241, v241, v243
  v_rsq_f32 v208, abs(v208)
  v_rsq_f32 v209, abs(v209)
  v_mul_f32 v208, v208, v244
  v_mul_f32 v209, v209, v245
  v_and_b32 v208, -2, v208
  v_or_b32 v209, 1, v209
  v_cmp_gt_f32 vcc, v209, v208
  v_max_f32 v9, v208, v209
  s_nop 0
  v_cndmask_b32 v210, v240, v241, vcc
  v_max_f32 v7, v9, v9 row_ror:8 row_mask:0xf bank_mask:0xf
  v_cndmask_b32 v211, v242, v243, vcc
  s_nop 0
  v_max_f32 v7, v7, v7 row_ror:4 row_mask:0xf bank_mask:0xf
  s_nop 1
  v_max_f32 v7, v7, v7 row_ror:2 row_mask:0xf bank_mask:0xf
  s_nop 1
  v_max_f32 v7, v7, v7 row_ror:1 row_mask:0xf bank_mask:0xf
  s_nop 1
  v_max_f32 v7, v7, v7 row_bcast:15 row_mask:0xa bank_mask:0xf
  s_nop 1
  v_max_f32 v7, v7, v7 row_bcast:31 row_mask:0xc bank_mask:0xf
  v_and_b32 v209, 1, v9
  v_lshl_add_u32 v209, v2, 1, v209
  v_readlane_b32 s22, v7, 63
  v_add_u32 v209, s24, v209
  v_mov_b32 v208, v9
  v_cmp_eq_u32 vcc, s22, v9
  s_ff1_i32_b64 s22, vcc
  s_lshl_b64 exec, 1, s22
  buffer_store_dwordx4 v[208:211], v4, s[4:7], s23 offen sc1
  s_mov_b64 exec, -1
.fz_kernel_c_c2:
  s_cmp_lg_u32 s20, 0
  s_cbranch_scc1 .fz_kernel_c_c21
  s_call_b64 s[68:69], .fz_kernel_c_coef
  ds_write_b64 v26, v[248:249] offset:4608
  ds_write_b64 v26, v[250:251] offset:5120
  ds_write_b64 v26, v[252:253] offset:6400
  ds_write_b64 v26, v[254:255] offset:6912
.fz_kernel_c_c21:
  s_cmp_eq_u32 s3, 0
  s_cbranch_scc1 .fz_kernel_hb64
  s_barrier
  s_sub_u32 s3, s3, 1
.fz_kernel_hb64:
  s_cmp_eq_u32 s3, 0
  s_cbranch_scc1 .fz_kernel_hb65
  s_barrier
  s_sub_u32 s3, s3, 1
.fz_kernel_hb65:
  s_cmp_eq_u32 s3, 0
  s_cbranch_scc1 .fz_kernel_hb66
  s_barrier
  s_sub_u32 s3, s3, 1
.fz_kernel_hb66:
.fz_kernel_c_c3:
  v_lshlrev_b32 v22, 6, v2
  s_mov_b64 exec, 0xffff
  s_mov_b32 s38, 0
.fz_kernel_c_c4:
  buffer_load_dwordx4 v[224:227], v22, s[4:7], s21 offen sc1
  s_add_u32 s38, s38, 1
  s_mov_b32 s46, 0
  s_call_b64 s[0:1], .fz_kernel_hw
  s_waitcnt vmcnt(0)
  v_min_u32 v9, v225, v227
  v_max_f32 v7, v224, v224 row_ror:8 row_mask:0xf bank_mask:0xf
  v_cmp_eq_u32 vcc, 0, v9
  s_cbranch_vccz .fz_kernel_c_c5
  s_cmp_lt_u32 s38, 131072
  s_cbranch_scc1 .fz_kernel_c_c4
.fz_kernel_c_c5:
  s_waitcnt lgkmcnt(0)
  v_max_f32 v7, v7, v7 row_ror:4 row_mask:0xf bank_mask:0xf
  s_nop 1
  v_max_f32 v7, v7, v7 row_ror:2 row_mask:0xf bank_mask:0xf
  s_nop 1
  v_max_f32 v7, v7, v7 row_ror:1 row_mask:0xf bank_mask:0xf
  v_cmp_eq_u32 vcc, v7, v224
  s_or_b32 s22, vcc_lo, 0x8000
  s_ff1_i32_b32 s22, s22
  v_readlane_b32 s77, v225, s22
  v_readlane_b32 s27, v224, s22
  v_readlane_b32 s23, v226, s22
  v_readlane_b32 s24, v227, s22
  s_mov_b64 exec, -1
  v_mov_b32 v11, s23
  v_mov_b32 v15, s24
  s_branch .fz_kernel_c_idx
.fz_kernel_c_nw:
  s_mov_b64 exec, 0xff
  s_mov_b32 s38, 0
.fz_kernel_c_gm:
  buffer_load_dword v9, v10, s[4:7], s21 offen sc1
  s_add_u32 s38, s38, 1
  s_waitcnt vmcnt(0)
  v_cmp_ne_u32 vcc, 0xffff, v9
  s_cbranch_vccz .fz_kernel_c_gmd
  s_sleep 10
  s_cmp_lt_u32 s38, 131072
  s_cbranch_scc1 .fz_kernel_c_gm
.fz_kernel_c_gmd:
  s_mov_b64 exec, -1
  buffer_load_dwordx4 v[208:211], v3, s[4:7], s22 offen offset:0
  buffer_load_dwordx4 v[212:215], v3, s[4:7], s23 offen offset:0
  buffer_load_dwordx4 v[216:219], v3, s[4:7], s24 offen offset:0
  buffer_load_dwordx4 v[220:223], v3, s[4:7], s22 offen offset:1024
  buffer_load_dwordx4 v[224:227], v3, s[4:7], s23 offen offset:1024
  buffer_load_dwordx4 v[228:231], v3, s[4:7], s24 offen offset:1024
  buffer_load_dwordx4 v[232:235], v3, s[4:7], s22 offen offset:2048
  buffer_load_dwordx4 v[236:239], v3, s[4:7], s23 offen offset:2048
  buffer_load_dwordx4 v[240:243], v3, s[4:7], s24 offen offset:2048
  buffer_load_dwordx4 v[244:247], v3, s[4:7], s22 offen offset:3072
  buffer_load_dwordx4 v[248:251], v3, s[4:7], s23 offen offset:3072
  buffer_load_dwordx4 v[252:255], v3, s[4:7], s24 offen offset:3072
  s_lshl_b32 s21, s75, 4
  s_add_u32 s21, s21, 159968
  v_mov_b32 v10, s21
  s_lshl_b32 s22, s20, 3
  v_add_u32 v13, s22, v10
  s_waitcnt vmcnt(10)
  v_fma_f32 v212, -v208, v208, v212
  v_fma_f32 v213, -v209, v209, v213
  v_fma_f32 v214, -v210, v210, v214
  v_fma_f32 v215, -v211, v211, v215
  v_rsq_f32 v212, abs(v212)
  v_rsq_f32 v213, abs(v213)
  v_rsq_f32 v214, abs(v214)
  v_rsq_f32 v215, abs(v215)
  s_waitcnt vmcnt(9)
  v_mul_f32 v216, v216, v212
  v_mul_f32 v217, v217, v213
  v_mul_f32 v218, v218, v214
  v_mul_f32 v219, v219, v215
  v_and_or_b32 v216, v216, -16, 0
  v_and_or_b32 v217, v217, -16, 1
  v_and_or_b32 v218, v218, -16, 2
  v_and_or_b32 v219, v219, -16, 3
  v_max3_f32 v9, v216, v217, v218
  v_max_f32 v9, v9, v219
  s_waitcnt vmcnt(7)
  v_fma_f32 v224, -v220, v220, v224
  v_fma_f32 v225, -v221, v221, v225
  v_fma_f32 v226, -v222, v222, v226
  v_fma_f32 v227, -v223, v223, v227
  v_rsq_f32 v224, abs(v224)
  v_rsq_f32 v225, abs(v225)
  v_rsq_f32 v226, abs(v226)
  v_rsq_f32 v227, abs(v227)
  s_waitcnt vmcnt(6)
  v_mul_f32 v228, v228, v224
  v_mul_f32 v229, v229, v225
  v_mul_f32 v230, v230, v226
  v_mul_f32 v231, v231, v227
  v_and_or_b32 v228, v228, -16, 4
  v_and_or_b32 v229, v229, -16, 5
  v_and_or_b32 v230, v230, -16, 6
  v_and_or_b32 v231, v231, -16, 7
  v_max3_f32 v9, v9, v228, v229
  v_max3_f32 v9, v9, v230, v231
  s_waitcnt vmcnt(4)
  v_fma_f32 v236, -v232, v232, v236
  v_fma_f32 v237, -v233, v233, v237
  v_fma_f32 v238, -v234, v234, v238
  v_fma_f32 v239, -v235, v235, v239
  v_rsq_f32 v236, abs(v236)
  v_rsq_f32 v237, abs(v237)
  v_rsq_f32 v238, abs(v238)
  v_rsq_f32 v239, abs(v239)
  s_waitcnt vmcnt(3)
  v_mul_f32 v240, v240, v236
  v_mul_f32 v241, v241, v237
  v_mul_f32 v242, v242, v238
  v_mul_f32 v243, v243, v239
  v_and_or_b32 v240, v240, -16, 8
  v_and_or_b32 v241, v241, -16, 9
  v_and_or_b32 v242, v242, -16, 10
  v_and_or_b32 v243, v243, -16, 11
  v_max3_f32 v9, v9, v240, v241
  v_max3_f32 v9, v9, v242, v243
  s_waitcnt vmcnt(1)
  v_fma_f32 v248, -v244, v244, v248
  v_fma_f32 v249, -v245, v245, v249
  v_fma_f32 v250, -v246, v246, v250
  v_fma_f32 v251, -v247, v247, v251
  v_rsq_f32 v248, abs(v248)
  v_rsq_f32 v249, abs(v249)
  v_rsq_f32 v250, abs(v250)
  v_rsq_f32 v251, abs(v251)
  s_waitcnt vmcnt(0)
  v_mul_f32 v252, v252, v248
  v_mul_f32 v253, v253, v249
  v_mul_f32 v254, v254, v250
  v_mul_f32 v255, v255, v251
  v_and_or_b32 v252, v252, -16, 12
  v_and_or_b32 v253, v253, -16, 13
  v_and_or_b32 v254, v254, -16, 14
  v_and_or_b32 v255, v255, -16, 15
  v_max3_f32 v9, v9, v252, v253
  v_max3_f32 v9, v9, v254, v255
  s_nop 1
  v_max_f32 v7, v9, v9 row_ror:8 row_mask:0xf bank_mask:0xf
  s_nop 1
  v_max_f32 v7, v7, v7 row_ror:4 row_mask:0xf bank_mask:0xf
  s_nop 1
  v_max_f32 v7, v7, v7 row_ror:2 row_mask:0xf bank_mask:0xf
  s_nop 1
  v_max_f32 v7, v7, v7 row_ror:1 row_mask:0xf bank_mask:0xf
  s_nop 1
  v_max_f32 v7, v7, v7 row_bcast:15 row_mask:0xa bank_mask:0xf
  s_nop 1
  v_max_f32 v7, v7, v7 row_bcast:31 row_mask:0xc bank_mask:0xf
  s_nop 0
  v_readlane_b32 s21, v7, 63
  s_nop 1
  v_cmp_eq_u32 vcc, s21, v9
  s_ff1_i32_b64 s22, vcc
  s_lshl_b32 s22, s22, 2
  s_and_b32 s23, s21, 3
  s_add_u32 s22, s22, s23
  s_and_b32 s23, s21, 12
  s_lshl_b32 s23, s23, 6
  s_add_u32 s22, s22, s23
  s_and_b32 s22, s22, 1023
  s_lshl_b32 s23, s20, 10
  s_add_u32 s22, s22, s23
  s_add_u32 s22, s22, 1
  v_mov_b32 v224, s21
  v_mov_b32 v225, s22
  s_mov_b64 exec, 1
  ds_write_b64 v13, v[224:225]
  s_mov_b32 s38, 0
.fz_kernel_c_am:
  ds_read_b128 v[224:227], v10
  s_add_u32 s38, s38, 1
  s_waitcnt lgkmcnt(0)
  v_min_u32 v9, v225, v227
  v_cmp_eq_u32 vcc, 0, v9
  s_cbranch_vccz .fz_kernel_c_amd
  s_cmp_lt_u32 s38, 524288
  s_cbranch_scc1 .fz_kernel_c_am
.fz_kernel_c_amd:
  v_cmp_gt_f32 vcc, v226, v224
  s_nop 1
  v_cndmask_b32 v225, v225, v227, vcc
  v_cndmask_b32 v224, v224, v226, vcc
  v_readfirstlane_b32 s77, v225
  v_readfirstlane_b32 s27, v224
  s_mov_b64 exec, -1
  s_sub_u32 s21, s77, 1
  s_and_b32 s21, s21, 2047
  s_lshl_b32 s21, s21, 2
  s_add_u32 s21, s21, s72
  s_add_u32 s21, s21, 16384
  s_add_u32 s22, s21, 8192
  buffer_load_dword v11, v4, s[4:7], s21 offen
  buffer_load_dword v15, v4, s[4:7], s22 offen
.fz_kernel_c_idx:
  s_mov_b64 exec, s[34:35]
  s_sub_u32 s77, s77, 1
  s_and_b32 s77, s77, 2047
  s_lshr_b32 s78, s77, 7
  s_lshl_b32 s78, s78, 18
  s_and_b32 s21, s77, 0x70
  s_lshl_b32 s21, s21, 7
  s_add_u32 s78, s78, s21
  s_and_b32 s21, s77, 15
  s_lshl_b32 s21, s21, 4
  s_add_u32 s78, s78, s21
  s_add_u32 s78, s78, s73
  s_and_b32 s25, s18, 2
  s_add_u32 s25, s25, s20
  s_lshl_b32 s21, s25, 16
  s_add_u32 s21, s21, s78
  buffer_load_dwordx4 v[208:211], v14, s[4:7], s21 offen offset:0
  buffer_load_dwordx4 v[212:215], v14, s[4:7], s21 offen offset:256
  buffer_load_dwordx4 v[216:219], v14, s[4:7], s21 offen offset:512
  buffer_load_dwordx4 v[220:223], v14, s[4:7], s21 offen offset:768
  s_mov_b64 exec, -1
  s_lshr_b32 s21, s77, 7
  s_and_b32 s79, s77, 127
  s_add_u32 s79, s79, 1
  s_cmp_eq_u32 s21, s17
  s_cselect_b32 s79, s79, 0
  s_and_b32 s21, s18, 1
  s_lshl_b32 s21, s21, 2
  s_add_u32 s21, s21, s25
  s_lshl_b32 s21, s21, 9
  s_lshl_b32 s22, s17, 13
  s_add_u32 s21, s21, s22
  s_and_b32 s22, s18, 8
  s_lshl_b32 s22, s22, 9
  s_add_u32 s21, s21, s22
  s_and_b32 s22, s18, 4
  s_lshl_b32 s22, s22, 6
  s_add_u32 s21, s21, s22
  s_add_u32 s21, s21, s72
  s_add_u32 s21, s21, 40960
  s_cmp_eq_u32 s3, 0
  s_cbranch_scc1 .fz_kernel_hb73
  s_barrier
  s_sub_u32 s3, s3, 1
.fz_kernel_hb73:
  v_mov_b32 v1, -1477.3197218702985
  v_mul_f32 v1, s27, v1
  v_exp_f32 v1, v1
  s_nop 0
  v_add_f32 v1, 1.0, v1
  v_rcp_f32 v1, v1
  v_and_b32 v14, 8, v2
  v_lshlrev_b32 v14, 7, v14
  v_lshl_add_u32 v14, v8, 8, v14
  s_lshl_b32 s23, s70, 14
  s_add_u32 s23, s23, s78
  s_mov_b32 s46, 0
  s_call_b64 s[0:1], .fz_kernel_hw
  s_waitcnt vmcnt(0)
  s_cmp_ge_u32 s17, 14
  s_cbranch_scc1 .fz_kernel_c_ng
  s_setprio 2
  v_mfma_f32_16x16x32_bf16 v[224:227], v[208:211], v[80:83], 0
  v_mfma_f32_16x16x32_bf16 v[228:231], v[208:211], v[84:87], 0
  v_mfma_f32_16x16x32_bf16 v[232:235], v[208:211], v[88:91], 0
  v_mfma_f32_16x16x32_bf16 v[236:239], v[208:211], v[92:95], 0
  v_mfma_f32_16x16x32_bf16 v[240:243], v[208:211], v[96:99], 0
  v_mfma_f32_16x16x32_bf16 v[244:247], v[208:211], v[100:103], 0
  v_mfma_f32_16x16x32_bf16 v[248:251], v[208:211], v[104:107], 0
  v_mfma_f32_16x16x32_bf16 v[252:255], v[208:211], v[108:111], 0
  v_mfma_f32_16x16x32_bf16 v[224:227], v[212:215], v[112:115], v[224:227]
  v_mfma_f32_16x16x32_bf16 v[228:231], v[212:215], v[116:119], v[228:231]
  v_mfma_f32_16x16x32_bf16 v[232:235], v[212:215], v[120:123], v[232:235]
  v_mfma_f32_16x16x32_bf16 v[236:239], v[212:215], v[124:127], v[236:239]
  v_mfma_f32_16x16x32_bf16 v[240:243], v[212:215], v[128:131], v[240:243]
  v_mfma_f32_16x16x32_bf16 v[244:247], v[212:215], v[132:135], v[244:247]
  v_mfma_f32_16x16x32_bf16 v[248:251], v[212:215], v[136:139], v[248:251]
  v_mfma_f32_16x16x32_bf16 v[252:255], v[212:215], v[140:143], v[252:255]
  v_mfma_f32_16x16x32_bf16 v[224:227], v[216:219], v[144:147], v[224:227]
  v_mfma_f32_16x16x32_bf16 v[228:231], v[216:219], v[148:151], v[228:231]
  v_mfma_f32_16x16x32_bf16 v[232:235], v[216:219], v[152:155], v[232:235]
  v_mfma_f32_16x16x32_bf16 v[236:239], v[216:219], v[156:159], v[236:239]
  v_mfma_f32_16x16x32_bf16 v[240:243], v[216:219], v[160:163], v[240:243]
  v_mfma_f32_16x16x32_bf16 v[244:247], v[216:219], v[164:167], v[244:247]
  v_mfma_f32_16x16x32_bf16 v[248:251], v[216:219], v[168:171], v[248:251]
  v_mfma_f32_16x16x32_bf16 v[252:255], v[216:219], v[172:175], v[252:255]
  v_mfma_f32_16x16x32_bf16 v[224:227], v[220:223], v[176:179], v[224:227]
  v_mfma_f32_16x16x32_bf16 v[228:231], v[220:223], v[180:183], v[228:231]
  v_mfma_f32_16x16x32_bf16 v[232:235], v[220:223], v[184:187], v[232:235]
  v_mfma_f32_16x16x32_bf16 v[236:239], v[220:223], v[188:191], v[236:239]
  v_mfma_f32_16x16x32_bf16 v[240:243], v[220:223], v[192:195], v[240:243]
  v_mfma_f32_16x16x32_bf16 v[244:247], v[220:223], v[196:199], v[244:247]
  v_mfma_f32_16x16x32_bf16 v[248:251], v[220:223], v[200:203], v[248:251]
  v_mfma_f32_16x16x32_bf16 v[252:255], v[220:223], v[204:207], v[252:255]
  s_nop 0
  v_add_f32 v208, v225, v224 row_ror:8 row_mask:0xf bank_mask:0x3
  v_add_f32 v209, v229, v228 row_ror:8 row_mask:0xf bank_mask:0x3
  v_add_f32 v210, v233, v232 row_ror:8 row_mask:0xf bank_mask:0x3
  v_add_f32 v211, v237, v236 row_ror:8 row_mask:0xf bank_mask:0x3
  v_add_f32 v208, v240, v241 row_ror:8 row_mask:0xf bank_mask:0xc
  v_add_f32 v209, v244, v245 row_ror:8 row_mask:0xf bank_mask:0xc
  v_add_f32 v210, v248, v249 row_ror:8 row_mask:0xf bank_mask:0xc
  v_add_f32 v211, v252, v253 row_ror:8 row_mask:0xf bank_mask:0xc
  v_fma_f32 v208, -v11, v28, v208
  v_fma_f32 v209, -v11, v29, v209
  v_or_b32 v208, 1, v208
  v_fma_f32 v210, -v11, v30, v210
  v_fma_f32 v211, -v11, v31, v211
  v_or_b32 v210, 1, v210
  s_mov_b64 exec, 0xffff
  buffer_store_dwordx4 v[208:211], v20, s[4:7], s21 offen offset:0 sc1
  s_mov_b64 exec, -1
  s_setprio 0
  s_cmp_eq_u32 s3, 0
  s_cbranch_scc1 .fz_kernel_hb67
  s_barrier
  s_sub_u32 s3, s3, 1
.fz_kernel_hb67:
.fz_kernel_c_ng:
  s_cmp_eq_u32 s20, 0
  s_cbranch_scc1 .fz_kernel_c_ng1
  buffer_load_dwordx4 v[200:203], v14, s[4:7], s23 offen
  s_branch .fz_kernel_c_ng2
.fz_kernel_c_ng1:
  s_cmp_eq_u32 s75, 0
  s_cbranch_scc1 .fz_kernel_c_ng2
  buffer_load_dwordx2 v[240:241], v16, s[4:7], s14 offen
  buffer_load_dwordx2 v[242:243], v16, s[4:7], s15 offen
.fz_kernel_c_ng2:
  s_cmp_ge_u32 s17, 14
  s_cbranch_scc1 .fz_kernel_c_g1
  ds_read_b64_tr_b16 v[80:81], v17 offset:0
  ds_read_b64_tr_b16 v[82:83], v17 offset:1024
  ds_read_b64_tr_b16 v[84:85], v17 offset:32
  ds_read_b64_tr_b16 v[86:87], v17 offset:1056
  ds_read_b64_tr_b16 v[88:89], v18 offset:0
  ds_read_b64_tr_b16 v[90:91], v18 offset:1024
  ds_read_b64_tr_b16 v[92:93], v18 offset:32
  ds_read_b64_tr_b16 v[94:95], v18 offset:1056
  ds_read_b64_tr_b16 v[96:97], v17 offset:2048
  ds_read_b64_tr_b16 v[98:99], v17 offset:3072
  ds_read_b64_tr_b16 v[100:101], v17 offset:2080
  ds_read_b64_tr_b16 v[102:103], v17 offset:3104
  ds_read_b64_tr_b16 v[104:105], v18 offset:2048
  s_cmp_eq_u32 s3, 0
  s_cbranch_scc1 .fz_kernel_hb74
  s_barrier
  s_sub_u32 s3, s3, 1
.fz_kernel_hb74:
  ds_read_b64_tr_b16 v[106:107], v18 offset:3072
  ds_read_b64_tr_b16 v[108:109], v18 offset:2080
  ds_read_b64_tr_b16 v[110:111], v18 offset:3104
  s_waitcnt lgkmcnt(4)
  ds_read_b64_tr_b16 v[112:113], v17 offset:4096
  ds_read_b64_tr_b16 v[114:115], v17 offset:5120
  ds_read_b64_tr_b16 v[116:117], v17 offset:4128
  ds_read_b64_tr_b16 v[118:119], v17 offset:5152
  ds_read_b64_tr_b16 v[120:121], v18 offset:4096
  ds_read_b64_tr_b16 v[122:123], v18 offset:5120
  ds_read_b64_tr_b16 v[124:125], v18 offset:4128
  ds_read_b64_tr_b16 v[126:127], v18 offset:5152
  ds_read_b64_tr_b16 v[128:129], v17 offset:6144
  ds_read_b64_tr_b16 v[130:131], v17 offset:7168
  ds_read_b64_tr_b16 v[132:133], v17 offset:6176
  ds_read_b64_tr_b16 v[134:135], v17 offset:7200
  ds_read_b64_tr_b16 v[136:137], v18 offset:6144
  ds_read_b64_tr_b16 v[138:139], v18 offset:7168
  s_cmp_eq_u32 s3, 0
  s_cbranch_scc1 .fz_kernel_hb75
  s_barrier
  s_sub_u32 s3, s3, 1
.fz_kernel_hb75:
  ds_read_b64_tr_b16 v[140:141], v18 offset:6176
  ds_read_b64_tr_b16 v[142:143], v18 offset:7200
.fz_kernel_c_g1:
  v_fma_f32 v15, -v11, v11, v15
  v_rsq_f32 v15, abs(v15)
  s_nop 0
  v_mul_f32 v179, v11, v15
  v_mul_f32 v15, 0x44800000, v15
  v_sub_f32 v179, 0, v179
  v_add_f32 v178, 1.0, v15
  v_mul_f32 v177, -1.4426950408889634, v15
  v_mul_f32 v15, v15, v15
  v_mul_f32 v1, v1, v15
  s_cmp_eq_u32 s75, 0
  s_cbranch_scc1 .fz_kernel_c_d0
  s_cmp_lg_u32 s20, 0
  s_cbranch_scc1 .fz_kernel_c_t2
  s_waitcnt vmcnt(0)
  s_call_b64 s[68:69], .fz_kernel_c_coef
  v_mov_b32 v9, 159952
  v_mov_b32 v7, s79
  ds_write_b64 v26, v[252:253] offset:6400
  ds_write_b64 v26, v[254:255] offset:6912
  ds_write_b32 v9, v7
  s_waitcnt lgkmcnt(0)
.fz_kernel_c_t2:
  s_barrier
.fz_kernel_c_d0:
  s_cmp_ge_u32 s17, 14
  s_cbranch_scc1 .fz_kernel_c_nd
  s_lshl_b32 s21, s26, 12
  s_add_u32 s21, s21, s72
  s_add_u32 s21, s21, 40960
  s_mul_i32 s27, s18, 28
  s_add_u32 s27, s27, s26
  s_lshl_b32 s27, s27, 8
  s_add_u32 s27, s27, s72
  s_add_u32 s27, s27, 155648
  s_cmp_eq_u32 s3, 0
  s_cbranch_scc1 .fz_kernel_hb69
  s_barrier
  s_sub_u32 s3, s3, 1
.fz_kernel_hb69:
  buffer_load_dwordx4 v[144:147], v21, s[4:7], s21 offen offset:0 sc1
  buffer_load_dwordx4 v[148:151], v21, s[4:7], s21 offen offset:512 sc1
  buffer_load_dwordx4 v[152:155], v21, s[4:7], s21 offen offset:1024 sc1
  buffer_load_dwordx4 v[156:159], v21, s[4:7], s21 offen offset:1536 sc1
  s_mov_b32 s38, 0
.fz_kernel_c_gu:
  s_mov_b32 s46, 0
  s_call_b64 s[0:1], .fz_kernel_hw
  s_waitcnt vmcnt(0)
  v_min3_u32 v9, v144, v146, v148
  v_min3_u32 v9, v9, v150, v152
  v_min3_u32 v9, v9, v154, v156
  v_min_u32 v9, v9, v158
  v_cmp_eq_u32 vcc, 0, v9
  v_add_f32 v160, v144, v148
  v_add_f32 v161, v145, v149
  v_add_f32 v162, v146, v150
  v_add_f32 v163, v147, v151
  s_cbranch_vccnz .fz_kernel_c_gur
.fz_kernel_c_gud:
  v_add_f32 v152, v152, v156
  v_add_f32 v153, v153, v157
  v_add_f32 v154, v154, v158
  v_add_f32 v155, v155, v159
  v_add_f32 v144, v152, v160
  v_add_f32 v145, v153, v161
  v_add_f32 v146, v154, v162
  v_add_f32 v147, v155, v163
  s_nop 0
  v_permlane32_swap_b32 v144, v146
  v_permlane32_swap_b32 v145, v147
  v_mul_f32 v148, v144, v177
  v_mul_f32 v149, v145, v177
  v_exp_f32 v148, v148
  s_cmp_eq_u32 s3, 0
  s_cbranch_scc1 .fz_kernel_hb76
  s_barrier
  s_sub_u32 s3, s3, 1
.fz_kernel_hb76:
  v_exp_f32 v149, v149
  v_mul_f32 v144, v144, v146
  v_add_f32 v148, 1.0, v148
  v_add_f32 v149, 1.0, v149
  v_rcp_f32 v148, v148
  v_rcp_f32 v149, v149
  v_mul_f32 v145, v145, v147
  v_mul_f32 v144, v144, v148
  v_mul_f32 v145, v145, v149
  v_cvt_pk_bf16_f32 v144, v144, v145
  s_waitcnt lgkmcnt(0)
  s_setprio 2
  v_mov_b32 v160, v144 row_newbcast:0 row_mask:0xf bank_mask:0xf
  v_mov_b32 v161, v144 row_newbcast:1 row_mask:0xf bank_mask:0xf
  v_mov_b32 v162, v144 row_newbcast:2 row_mask:0xf bank_mask:0xf
  v_mov_b32 v163, v144 row_newbcast:3 row_mask:0xf bank_mask:0xf
  v_mov_b32 v164, v144 row_newbcast:4 row_mask:0xf bank_mask:0xf
  v_mov_b32 v165, v144 row_newbcast:5 row_mask:0xf bank_mask:0xf
  v_mov_b32 v166, v144 row_newbcast:6 row_mask:0xf bank_mask:0xf
  v_mov_b32 v167, v144 row_newbcast:7 row_mask:0xf bank_mask:0xf
  v_mfma_f32_16x16x32_bf16 v[208:211], v[80:83], v[160:163], 0
  v_mfma_f32_16x16x32_bf16 v[212:215], v[84:87], v[160:163], 0
  v_mfma_f32_16x16x32_bf16 v[216:219], v[88:91], v[160:163], 0
  v_mfma_f32_16x16x32_bf16 v[220:223], v[92:95], v[160:163], 0
  v_mov_b32 v168, v144 row_newbcast:8 row_mask:0xf bank_mask:0xf
  v_mov_b32 v169, v144 row_newbcast:9 row_mask:0xf bank_mask:0xf
  v_mov_b32 v170, v144 row_newbcast:10 row_mask:0xf bank_mask:0xf
  v_mov_b32 v171, v144 row_newbcast:11 row_mask:0xf bank_mask:0xf
  v_mfma_f32_16x16x32_bf16 v[208:211], v[96:99], v[164:167], v[208:211]
  v_mfma_f32_16x16x32_bf16 v[212:215], v[100:103], v[164:167], v[212:215]
  v_mfma_f32_16x16x32_bf16 v[216:219], v[104:107], v[164:167], v[216:219]
  v_mfma_f32_16x16x32_bf16 v[220:223], v[108:111], v[164:167], v[220:223]
  v_mov_b32 v172, v144 row_newbcast:12 row_mask:0xf bank_mask:0xf
  v_mov_b32 v173, v144 row_newbcast:13 row_mask:0xf bank_mask:0xf
  v_mov_b32 v174, v144 row_newbcast:14 row_mask:0xf bank_mask:0xf
  v_mov_b32 v175, v144 row_newbcast:15 row_mask:0xf bank_mask:0xf
  v_mfma_f32_16x16x32_bf16 v[208:211], v[112:115], v[168:171], v[208:211]
  v_mfma_f32_16x16x32_bf16 v[212:215], v[116:119], v[168:171], v[212:215]
  v_mfma_f32_16x16x32_bf16 v[216:219], v[120:123], v[168:171], v[216:219]
  v_mfma_f32_16x16x32_bf16 v[220:223], v[124:127], v[168:171], v[220:223]
  v_mfma_f32_16x16x32_bf16 v[208:211], v[128:131], v[172:175], v[208:211]
  v_mfma_f32_16x16x32_bf16 v[212:215], v[132:135], v[172:175], v[212:215]
  v_mfma_f32_16x16x32_bf16 v[216:219], v[136:139], v[172:175], v[216:219]
  v_mfma_f32_16x16x32_bf16 v[220:223], v[140:143], v[172:175], v[220:223]
  s_mov_b32 exec_lo, 0x20002
  s_mov_b32 exec_hi, 0x20002
  s_nop 3
  v_mov_b32 v208, v212
  v_mov_b32 v209, v213
  v_mov_b32 v210, v214
  v_mov_b32 v211, v215
  s_mov_b32 exec_lo, 0x40004
  s_mov_b32 exec_hi, 0x40004
  v_mov_b32 v208, v216
  v_mov_b32 v209, v217
  v_mov_b32 v210, v218
  v_mov_b32 v211, v219
  s_mov_b32 exec_lo, 0x80008
  s_mov_b32 exec_hi, 0x80008
  v_mov_b32 v208, v220
  v_mov_b32 v209, v221
  v_mov_b32 v210, v222
  v_mov_b32 v211, v223
  s_mov_b32 exec_lo, 0xf000f
  s_mov_b32 exec_hi, 0xf000f
  v_or_b32 v208, 1, v208
  v_or_b32 v210, 1, v210
  buffer_store_dwordx4 v[208:211], v19, s[4:7], s27 offen sc1
  s_mov_b64 exec, -1
  s_setprio 0
.fz_kernel_c_nd:
  s_cmp_eq_u32 s75, 0
  s_cbranch_scc1 .fz_kernel_c_m0
  s_lshl_b32 s21, s17, 1
  s_add_u32 s21, s21, s20
  s_cmp_lg_u32 s21, 31
  s_cbranch_scc1 .fz_kernel_fin
  s_branch .fz_kernel_c_pp
.fz_kernel_c_m0:
  s_cmp_eq_u32 s79, 0
  s_cselect_b32 s21, 2, 0
  s_add_u32 s3, s3, s21
.fz_kernel_c_pp:
  s_cmp_eq_u32 s3, 0
  s_cbranch_scc1 .fz_kernel_hb77
  s_barrier
  s_sub_u32 s3, s3, 1
.fz_kernel_hb77:
  v_and_b32 v10, 7, v2
  v_lshlrev_b32 v10, 8, v10
  v_lshl_add_u32 v10, v12, 5, v10
  s_mul_i32 s21, s70, 7168
  s_add_u32 s21, s21, s72
  s_add_u32 s21, s21, 155648
  s_add_u32 s22, s21, 4096
  s_mov_b32 s24, 0x0f0f0f0f
  s_mov_b32 s25, 0x0f0f0f0f
  s_lshl_b32 s27, s18, 4
  s_add_u32 s27, s27, s17
  s_lshl_b32 s27, s27, 10
  s_add_u32 s27, s27, 0x1c84000
  v_mov_b32 v168, 1
  v_mov_b32 v169, 1
  v_mov_b32 v170, 1
  v_mov_b32 v171, 1
  v_mov_b32 v172, 1
  v_mov_b32 v173, 1
  v_mov_b32 v174, 1
  v_mov_b32 v175, 1
  s_cmp_eq_u32 s3, 0
  s_cbranch_scc1 .fz_kernel_hb70
  s_barrier
  s_sub_u32 s3, s3, 1
.fz_kernel_hb70:
  s_cmp_eq_u32 s3, 0
  s_cbranch_scc1 .fz_kernel_hb71
  s_barrier
  s_sub_u32 s3, s3, 1
.fz_kernel_hb71:
  buffer_load_dwordx4 v[144:147], v10, s[4:7], s21 offen offset:0 sc1
  buffer_load_dwordx4 v[148:151], v10, s[4:7], s21 offen offset:16 sc1
  buffer_load_dwordx4 v[152:155], v10, s[4:7], s21 offen offset:2048 sc1
  buffer_load_dwordx4 v[156:159], v10, s[4:7], s21 offen offset:2064 sc1
  buffer_load_dwordx4 v[160:163], v10, s[4:7], s22 offen offset:0 sc1
  buffer_load_dwordx4 v[164:167], v10, s[4:7], s22 offen offset:16 sc1
  s_mov_b64 exec, s[24:25]
  buffer_load_dwordx4 v[168:171], v10, s[4:7], s22 offen offset:2048 sc1
  buffer_load_dwordx4 v[172:175], v10, s[4:7], s22 offen offset:2064 sc1
  s_mov_b64 exec, -1
  s_mov_b32 s38, 0
  s_cmp_eq_u32 s20, 0
  s_cbranch_scc1 .fz_kernel_c_pu
  s_waitcnt vmcnt(8)
  v_lshlrev_b32 v184, 16, v200
  v_and_b32 v185, 0xffff0000, v200
  v_lshlrev_b32 v186, 16, v201
  v_and_b32 v187, 0xffff0000, v201
  v_lshlrev_b32 v188, 16, v202
  v_and_b32 v189, 0xffff0000, v202
  v_lshlrev_b32 v190, 16, v203
  v_and_b32 v191, 0xffff0000, v203
  v_fma_f32 v184, v184, v178, v179
  v_fma_f32 v185, v185, v178, v179
  v_fma_f32 v186, v186, v178, v179
  v_fma_f32 v187, v187, v178, v179
  v_fma_f32 v188, v188, v178, v179
  v_fma_f32 v189, v189, v178, v179
  v_fma_f32 v190, v190, v178, v179
  v_fma_f32 v191, v191, v178, v179
.fz_kernel_c_pu:
  s_mov_b32 s46, 0
  s_call_b64 s[0:1], .fz_kernel_hw
  s_waitcnt vmcnt(0)
  s_cmp_eq_u32 s3, 0
  s_cbranch_scc1 .fz_kernel_hb78
  s_barrier
  s_sub_u32 s3, s3, 1
.fz_kernel_hb78:
  v_min3_u32 v9, v144, v146, v148
  v_min3_u32 v9, v9, v150, v152
  v_min3_u32 v9, v9, v154, v156
  v_min3_u32 v9, v9, v158, v160
  v_min3_u32 v9, v9, v162, v164
  v_min3_u32 v9, v9, v166, v168
  v_min3_u32 v9, v9, v170, v172
  v_min_u32 v9, v9, v174
  v_cmp_eq_u32 vcc, 0, v9
  v_add_f32 v236, v144, v152
  v_add_f32 v237, v145, v153
  v_add_f32 v238, v146, v154
  v_add_f32 v239, v147, v155
  s_cbranch_vccnz .fz_kernel_c_pur
.fz_kernel_c_pud:
  v_add_f32 v240, v148, v156
  v_add_f32 v241, v149, v157
  v_add_f32 v242, v150, v158
  v_add_f32 v243, v151, v159
  v_add_f32 v160, v160, v168
  v_add_f32 v161, v161, v169
  v_add_f32 v162, v162, v170
  v_add_f32 v163, v163, v171
  v_add_f32 v164, v164, v172
  v_add_f32 v165, v165, v173
  v_add_f32 v166, v166, v174
  v_add_f32 v167, v167, v175
  v_add_f32 v144, v236, v160
  v_add_f32 v145, v237, v161
  v_add_f32 v146, v238, v162
  v_add_f32 v147, v239, v163
  v_add_f32 v148, v240, v164
  v_add_f32 v149, v241, v165
  v_add_f32 v150, v242, v166
  v_add_f32 v151, v243, v167
  v_add_f32 v144, v144, v144 quad_perm:[1,0,3,2] row_mask:0xf bank_mask:0xf
  v_add_f32 v145, v145, v145 quad_perm:[1,0,3,2] row_mask:0xf bank_mask:0xf
  s_cmp_eq_u32 s3, 0
  s_cbranch_scc1 .fz_kernel_hb79
  s_barrier
  s_sub_u32 s3, s3, 1
.fz_kernel_hb79:
  v_add_f32 v146, v146, v146 quad_perm:[1,0,3,2] row_mask:0xf bank_mask:0xf
  v_add_f32 v147, v147, v147 quad_perm:[1,0,3,2] row_mask:0xf bank_mask:0xf
  v_add_f32 v148, v148, v148 quad_perm:[1,0,3,2] row_mask:0xf bank_mask:0xf
  v_add_f32 v149, v149, v149 quad_perm:[1,0,3,2] row_mask:0xf bank_mask:0xf
  v_add_f32 v150, v150, v150 quad_perm:[1,0,3,2] row_mask:0xf bank_mask:0xf
  v_add_f32 v151, v151, v151 quad_perm:[1,0,3,2] row_mask:0xf bank_mask:0xf
  v_add_f32 v144, v144, v144 quad_perm:[2,3,0,1] row_mask:0xf bank_mask:0xf
  v_add_f32 v145, v145, v145 quad_perm:[2,3,0,1] row_mask:0xf bank_mask:0xf
  v_add_f32 v146, v146, v146 quad_perm:[2,3,0,1] row_mask:0xf bank_mask:0xf
  v_add_f32 v147, v147, v147 quad_perm:[2,3,0,1] row_mask:0xf bank_mask:0xf
  v_add_f32 v148, v148, v148 quad_perm:[2,3,0,1] row_mask:0xf bank_mask:0xf
  v_add_f32 v149, v149, v149 quad_perm:[2,3,0,1] row_mask:0xf bank_mask:0xf
  v_add_f32 v150, v150, v150 quad_perm:[2,3,0,1] row_mask:0xf bank_mask:0xf
  v_add_f32 v151, v151, v151 quad_perm:[2,3,0,1] row_mask:0xf bank_mask:0xf
  v_add_f32 v144, v144, v144 row_half_mirror row_mask:0xf bank_mask:0xf
  v_add_f32 v145, v145, v145 row_half_mirror row_mask:0xf bank_mask:0xf
  v_add_f32 v146, v146, v146 row_half_mirror row_mask:0xf bank_mask:0xf
  v_add_f32 v147, v147, v147 row_half_mirror row_mask:0xf bank_mask:0xf
  v_add_f32 v148, v148, v148 row_half_mirror row_mask:0xf bank_mask:0xf
  v_add_f32 v149, v149, v149 row_half_mirror row_mask:0xf bank_mask:0xf
  v_add_f32 v150, v150, v150 row_half_mirror row_mask:0xf bank_mask:0xf
  v_add_f32 v151, v151, v151 row_half_mirror row_mask:0xf bank_mask:0xf
  v_mul_f32 v144, v144, v1
  v_mul_f32 v145, v145, v1
  v_mul_f32 v146, v146, v1
  v_mul_f32 v147, v147, v1
  v_mul_f32 v148, v148, v1
  v_mul_f32 v149, v149, v1
  v_mul_f32 v150, v150, v1
  v_mul_f32 v151, v151, v1
  v_cvt_pk_bf16_f32 v180, v144, v145
  v_cvt_pk_bf16_f32 v181, v146, v147
  v_cvt_pk_bf16_f32 v182, v148, v149
  v_cvt_pk_bf16_f32 v183, v150, v151
  s_or_b32 s21, s75, s71
  s_cbranch_scc1 .fz_kernel_c_w7
  s_mul_i32 s21, s20, 384
  s_add_u32 s21, s21, s27
  s_setprio 2
  v_mfma_f32_16x16x32_bf16 v[208:211], v[180:183], v[32:35], 0
  v_mov_b32 v232, v180 row_ror:8 row_mask:0xf bank_mask:0xf
  v_mfma_f32_16x16x32_bf16 v[212:215], v[180:183], v[36:39], 0
  v_mov_b32 v233, v181 row_ror:8 row_mask:0xf bank_mask:0xf
  v_mfma_f32_16x16x32_bf16 v[216:219], v[180:183], v[40:43], 0
  v_mov_b32 v234, v182 row_ror:8 row_mask:0xf bank_mask:0xf
  v_mfma_f32_16x16x32_bf16 v[220:223], v[180:183], v[44:47], 0
  v_mov_b32 v235, v183 row_ror:8 row_mask:0xf bank_mask:0xf
  v_mfma_f32_16x16x32_bf16 v[224:227], v[180:183], v[48:51], 0
  v_mfma_f32_16x16x32_bf16 v[228:231], v[180:183], v[52:55], 0
  v_mfma_f32_16x16x32_bf16 v[208:211], v[232:235], v[56:59], v[208:211]
  v_mfma_f32_16x16x32_bf16 v[212:215], v[232:235], v[60:63], v[212:215]
  v_mfma_f32_16x16x32_bf16 v[216:219], v[232:235], v[64:67], v[216:219]
  v_mfma_f32_16x16x32_bf16 v[220:223], v[232:235], v[68:71], v[220:223]
  v_mfma_f32_16x16x32_bf16 v[224:227], v[232:235], v[72:75], v[224:227]
  v_mfma_f32_16x16x32_bf16 v[228:231], v[232:235], v[76:79], v[228:231]
  s_nop 2
  v_or_b32 v208, 1, v208
  v_mov_b32 v209, v212
  v_or_b32 v210, 1, v216
  v_mov_b32 v211, v220
  s_mov_b64 exec, 0xffff
  buffer_store_dwordx4 v[208:211], v3, s[4:7], s21 offen offset:0 sc1
  v_or_b32 v224, 1, v224
  v_mov_b32 v225, v228
  buffer_store_dwordx2 v[224:225], v16, s[4:7], s21 offen offset:256 sc1
  s_mov_b64 exec, -1
  s_setprio 0
  s_cmp_lg_u32 s20, 0
  s_cbranch_scc1 .fz_kernel_c_w7
  s_cmp_eq_u32 s79, 0
  s_cbranch_scc1 .fz_kernel_c_no2
  s_cmp_eq_u32 s3, 0
  s_cbranch_scc1 .fz_kernel_hb80
  s_barrier
  s_sub_u32 s3, s3, 1
.fz_kernel_hb80:
  v_add_u32 v13, 155648, v3
  s_lshl_b32 s21, s18, 14
  s_add_u32 s21, s21, 0x1c84000
  s_add_u32 s22, s21, 4096
  s_add_u32 s23, s21, 8192
  s_add_u32 s24, s21, 12288
  v_rcp_f32 v144, v178
  v_lshlrev_b32 v146, 1, v2
  v_sub_u32 v146, s79, v146
  v_cmp_eq_u32 s[28:29], 1, v146
  v_cmp_eq_u32 s[30:31], 2, v146
  s_nop 0
  v_cndmask_b32 v148, 0, v144, s[28:29]
  v_cndmask_b32 v149, 0, v144, s[30:31]
  v_mov_b32 v9, 159952
  v_mov_b32 v7, s79
  ds_write_b32 v9, v7
  ds_write_b64 v26, v[148:149] offset:512
  s_lshl_b32 s25, s79, 2
  s_add_u32 s25, s25, 155644
  v_mov_b32 v7, s25
  v_mov_b32 v152, 0
  v_mov_b32 v153, 0
  v_mov_b32 v154, 0
  v_mov_b32 v155, 0
  s_bfm_b64 exec, 49, 0
  s_mov_b32 s38, 0
  s_mov_b32 s25, 15
.fz_kernel_c_pd:
  s_bitcmp1_b32 s25, 0
  s_cbranch_scc0 .fz_kernel_c_pl0
  buffer_load_dwordx4 v[80:83], v3, s[4:7], s21 offen offset:0 sc1
  buffer_load_dwordx4 v[84:87], v3, s[4:7], s21 offen offset:1024 sc1
  buffer_load_dwordx4 v[88:91], v3, s[4:7], s21 offen offset:2048 sc1
  buffer_load_dwordx4 v[92:95], v3, s[4:7], s21 offen offset:3072 sc1
.fz_kernel_c_pl0:
  s_bitcmp1_b32 s25, 1
  s_cbranch_scc0 .fz_kernel_c_pl1
  s_cmp_eq_u32 s3, 0
  s_cbranch_scc1 .fz_kernel_hb81
  s_barrier
  s_sub_u32 s3, s3, 1
.fz_kernel_hb81:
  buffer_load_dwordx4 v[96:99], v3, s[4:7], s22 offen offset:0 sc1
  buffer_load_dwordx4 v[100:103], v3, s[4:7], s22 offen offset:1024 sc1
  buffer_load_dwordx4 v[104:107], v3, s[4:7], s22 offen offset:2048 sc1
  buffer_load_dwordx4 v[108:111], v3, s[4:7], s22 offen offset:3072 sc1
.fz_kernel_c_pl1:
  s_bitcmp1_b32 s25, 2
  s_cbranch_scc0 .fz_kernel_c_pl2
  buffer_load_dwordx4 v[112:115], v3, s[4:7], s23 offen offset:0 sc1
  buffer_load_dwordx4 v[116:119], v3, s[4:7], s23 offen offset:1024 sc1
  buffer_load_dwordx4 v[120:123], v3, s[4:7], s23 offen offset:2048 sc1
  buffer_load_dwordx4 v[124:127], v3, s[4:7], s23 offen offset:3072 sc1
.fz_kernel_c_pl2:
  s_bitcmp1_b32 s25, 3
  s_cbranch_scc0 .fz_kernel_c_pl3
  buffer_load_dwordx4 v[128:131], v3, s[4:7], s24 offen offset:0 sc1
  buffer_load_dwordx4 v[132:135], v3, s[4:7], s24 offen offset:1024 sc1
  buffer_load_dwordx4 v[136:139], v3, s[4:7], s24 offen offset:2048 sc1
  buffer_load_dwordx4 v[140:143], v3, s[4:7], s24 offen offset:3072 sc1
.fz_kernel_c_pl3:
  s_add_u32 s38, s38, 1
  s_mov_b32 s46, 0
  s_call_b64 s[0:1], .fz_kernel_hw
  s_waitcnt vmcnt(0)
  s_bitcmp1_b32 s25, 0
  s_cbranch_scc0 .fz_kernel_c_pa0
  v_min3_u32 v9, v80, v82, v84
  v_min3_u32 v9, v9, v86, v88
  v_min3_u32 v9, v9, v90, v92
  v_min_u32 v9, v9, v94
  v_cmp_eq_u32 vcc, 0, v9
  v_add_f32 v80, v80, v84
  v_add_f32 v81, v81, v85
  s_cmp_eq_u32 s3, 0
  s_cbranch_scc1 .fz_kernel_hb82
  s_barrier
  s_sub_u32 s3, s3, 1
.fz_kernel_hb82:
  v_add_f32 v82, v82, v86
  v_add_f32 v83, v83, v87
  s_cbranch_vccnz .fz_kernel_c_pa0
  v_add_f32 v88, v88, v92
  v_add_f32 v89, v89, v93
  v_add_f32 v90, v90, v94
  v_add_f32 v91, v91, v95
  v_add_f32 v152, v152, v80
  v_add_f32 v153, v153, v81
  v_add_f32 v154, v154, v82
  v_add_f32 v155, v155, v83
  v_add_f32 v152, v152, v88
  v_add_f32 v153, v153, v89
  v_add_f32 v154, v154, v90
  v_add_f32 v155, v155, v91
  s_bitset0_b32 s25, 0
.fz_kernel_c_pa0:
  s_bitcmp1_b32 s25, 1
  s_cbranch_scc0 .fz_kernel_c_pa1
  v_min3_u32 v9, v96, v98, v100
  v_min3_u32 v9, v9, v102, v104
  v_min3_u32 v9, v9, v106, v108
  v_min_u32 v9, v9, v110
  v_cmp_eq_u32 vcc, 0, v9
  v_add_f32 v96, v96, v100
  v_add_f32 v97, v97, v101
  v_add_f32 v98, v98, v102
  v_add_f32 v99, v99, v103
  s_cbranch_vccnz .fz_kernel_c_pa1
  v_add_f32 v104, v104, v108
  v_add_f32 v105, v105, v109
  v_add_f32 v106, v106, v110
  v_add_f32 v107, v107, v111
  v_add_f32 v152, v152, v96
  v_add_f32 v153, v153, v97
  v_add_f32 v154, v154, v98
  v_add_f32 v155, v155, v99
  v_add_f32 v152, v152, v104
  v_add_f32 v153, v153, v105
  s_cmp_eq_u32 s3, 0
  s_cbranch_scc1 .fz_kernel_hb83
  s_barrier
  s_sub_u32 s3, s3, 1
.fz_kernel_hb83:
  v_add_f32 v154, v154, v106
  v_add_f32 v155, v155, v107
  s_bitset0_b32 s25, 1
.fz_kernel_c_pa1:
  s_bitcmp1_b32 s25, 2
  s_cbranch_scc0 .fz_kernel_c_pa2
  v_min3_u32 v9, v112, v114, v116
  v_min3_u32 v9, v9, v118, v120
  v_min3_u32 v9, v9, v122, v124
  v_min_u32 v9, v9, v126
  v_cmp_eq_u32 vcc, 0, v9
  v_add_f32 v112, v112, v116
  v_add_f32 v113, v113, v117
  v_add_f32 v114, v114, v118
  v_add_f32 v115, v115, v119
  s_cbranch_vccnz .fz_kernel_c_pa2
  v_add_f32 v120, v120, v124
  v_add_f32 v121, v121, v125
  v_add_f32 v122, v122, v126
  v_add_f32 v123, v123, v127
  v_add_f32 v152, v152, v112
  v_add_f32 v153, v153, v113
  v_add_f32 v154, v154, v114
  v_add_f32 v155, v155, v115
  v_add_f32 v152, v152, v120
  v_add_f32 v153, v153, v121
  v_add_f32 v154, v154, v122
  v_add_f32 v155, v155, v123
  s_bitset0_b32 s25, 2
.fz_kernel_c_pa2:
  s_bitcmp1_b32 s25, 3
  s_cbranch_scc0 .fz_kernel_c_pa3
  v_min3_u32 v9, v128, v130, v132
  v_min3_u32 v9, v9, v134, v136
  v_min3_u32 v9, v9, v138, v140
  v_min_u32 v9, v9, v142
  v_cmp_eq_u32 vcc, 0, v9
  v_add_f32 v128, v128, v132
  v_add_f32 v129, v129, v133
  v_add_f32 v130, v130, v134
  v_add_f32 v131, v131, v135
  s_cbranch_vccnz .fz_kernel_c_pa3
  s_cmp_eq_u32 s3, 0
  s_cbranch_scc1 .fz_kernel_hb84
  s_barrier
  s_sub_u32 s3, s3, 1
.fz_kernel_hb84:
  v_add_f32 v136, v136, v140
  v_add_f32 v137, v137, v141
  v_add_f32 v138, v138, v142
  v_add_f32 v139, v139, v143
  v_add_f32 v152, v152, v128
  v_add_f32 v153, v153, v129
  v_add_f32 v154, v154, v130
  v_add_f32 v155, v155, v131
  v_add_f32 v152, v152, v136
  v_add_f32 v153, v153, v137
  v_add_f32 v154, v154, v138
  v_add_f32 v155, v155, v139
  s_bitset0_b32 s25, 3
.fz_kernel_c_pa3:
  s_cmp_eq_u32 s25, 0
  s_cbranch_scc1 .fz_kernel_c_pdd
  s_cmp_lt_u32 s38, 131072
  s_cbranch_scc1 .fz_kernel_c_pd
.fz_kernel_c_pdd:
  s_mov_b32 exec_hi, 0xffff
  ds_write_b128 v13, v[152:155] offset:1536
  s_mov_b64 exec, -1
  v_readlane_b32 s21, v152, 48
  v_readlane_b32 s22, v154, 48
  s_nop 0
  v_mul_f32 v144, s21, v23
  v_fma_f32 v145, s22, v23, v25
  v_fma_f32 v145, -v144, v144, v145
  v_rsq_f32 v145, abs(v145)
  v_sub_f32 v144, v179, v144
  v_mul_f32 v146, v145, v178
  v_mul_f32 v147, v145, v144
  ds_write_b32 v7, v146 offset:4608
  ds_write_b32 v7, v147 offset:5120
  s_waitcnt lgkmcnt(0)
  s_add_u32 s3, s3, 2
.fz_kernel_c_no2:
  s_branch .fz_kernel_q_he
.fz_kernel_c_w7:
  s_setprio 2
  v_lshlrev_b32 v144, 16, v180
  v_and_b32 v145, 0xffff0000, v180
  v_lshlrev_b32 v146, 16, v181
  v_and_b32 v147, 0xffff0000, v181
  v_lshlrev_b32 v148, 16, v182
  v_and_b32 v149, 0xffff0000, v182
  v_lshlrev_b32 v150, 16, v183
  v_and_b32 v151, 0xffff0000, v183
  s_cmp_lg_u32 s71, 0
  s_cbranch_scc1 .fz_kernel_c_eu
  v_add_f32 v184, v184, v144
  v_add_f32 v185, v185, v145
  v_add_f32 v186, v186, v146
  v_add_f32 v187, v187, v147
  v_add_f32 v188, v188, v148
  v_add_f32 v189, v189, v149
  v_add_f32 v190, v190, v150
  v_add_f32 v191, v191, v151
  s_cmp_lg_u32 s75, 0
  s_cbranch_scc1 .fz_kernel_c_t3
  v_mul_f32 v152, v184, v184
  v_add_f32 v154, v184, v185
  v_fmac_f32 v152, v185, v185
  v_fmac_f32 v152, v186, v186
  v_add_f32 v154, v154, v186
  v_fmac_f32 v152, v187, v187
  v_add_f32 v154, v154, v187
  v_fmac_f32 v152, v188, v188
  v_add_f32 v154, v154, v188
  v_fmac_f32 v152, v189, v189
  v_add_f32 v154, v154, v189
  v_fmac_f32 v152, v190, v190
  v_add_f32 v154, v154, v190
  v_fmac_f32 v152, v191, v191
  v_add_f32 v154, v154, v191
  v_lshrrev_b32 v9, 5, v2
  v_lshlrev_b32 v9, 3, v9
  v_permlane32_swap_b32 v154, v152
  v_add_f32 v154, v154, v152
  s_nop 1
  v_add_f32 v154, v154, v154 row_ror:8 row_mask:0xf bank_mask:0xf
  s_nop 1
  v_add_f32 v154, v154, v154 row_bcast:15 row_mask:0xa bank_mask:0xf
  v_or_b32 v154, 1, v154
  s_mov_b32 exec_lo, 0x10000
  s_mov_b32 exec_hi, 0x10000
  buffer_store_dword v154, v9, s[4:7], s27 offen offset:768 sc1
  s_mov_b64 exec, -1
  s_setprio 0
  s_cmp_eq_u32 s79, 0
  s_cbranch_scc1 .fz_kernel_q_he
  s_add_u32 s3, s3, 2
  s_mov_b32 s71, 1
  s_mov_b32 s70, s18
  s_branch .fz_kernel_c_pp
.fz_kernel_c_eu:
  s_cmp_eq_u32 s3, 0
  s_cbranch_scc1 .fz_kernel_hb85
  s_barrier
  s_sub_u32 s3, s3, 1
.fz_kernel_hb85:
  v_lshlrev_b32 v9, 5, v12
  v_add_u32 v9, 155648, v9
  s_mov_b32 exec_lo, 0x01010101
  s_mov_b32 exec_hi, 0x01010101
  ds_write_b128 v9, v[144:147] offset:7424
  ds_write_b128 v9, v[148:151] offset:7440
  s_mov_b64 exec, -1
  s_waitcnt lgkmcnt(0)
  s_branch .fz_kernel_q_he
.fz_kernel_c_t3:
  s_mov_b32 s28, s56
  s_mov_b32 s29, s57
  s_mov_b32 s30, 0x400000
  s_mov_b32 s31, 0x00020000
  v_cvt_pk_bf16_f32 v144, v184, v185
  v_cvt_pk_bf16_f32 v145, v186, v187
  v_cvt_pk_bf16_f32 v146, v188, v189
  v_cvt_pk_bf16_f32 v147, v190, v191
  v_lshlrev_b32 v9, 4, v12
  s_lshl_b32 s21, s77, 11
  s_lshl_b32 s22, s18, 7
  s_add_u32 s21, s21, s22
  s_mov_b32 exec_lo, 0x01010101
  s_mov_b32 exec_hi, 0x01010101
  buffer_store_dwordx4 v[144:147], v9, s[28:31], s21 offen
  s_mov_b64 exec, -1
.fz_kernel_fin:
.fz_kernel_end:
  s_endpgm
.fz_kernel_pick:
  s_mov_b32 s33, 1
  s_cmp_eq_u32 s34, 0xffff
  s_cselect_b32 s35, 0x40000000, s35
  s_cbranch_scc1 .fz_kernel_pick_ret
  s_mov_b32 s38, 0
.fz_kernel_pick_l:
  ds_read_b32 v7, v6
  s_add_u32 s38, s38, 1
  s_waitcnt lgkmcnt(0)
  v_readfirstlane_b32 s36, v7
  s_andn2_b32 s33, s36, s34
  s_cbranch_scc1 .fz_kernel_pick_ret
  s_cmp_lt_u32 s38, 1048576
  s_cbranch_scc1 .fz_kernel_pick_l
  s_mov_b32 s36, 0xffff
  s_andn2_b32 s33, s36, s34
.fz_kernel_pick_ret:
  s_nop 4
  s_setpc_b64 s[68:69]
.fz_kernel_hw:
  s_mov_b32 s47, 0
.fz_kernel_hwl:
  s_getreg_b32 s100, hwreg(HW_REG_IB_STS)
  s_bfe_u32 s101, s100, 0x20016
  s_and_b32 s100, s100, 15
  s_lshl4_add_u32 s100, s101, s100
  s_cmp_le_u32 s100, s46
  s_cbranch_scc1 .fz_kernel_hwr
  s_sub_u32 s47, s47, 1
  s_cbranch_scc0 .fz_kernel_hwl
  s_cmp_eq_u32 s3, 0
  s_cbranch_scc1 .fz_kernel_hwr
  s_cmp_eq_u32 s3, 32
  s_cbranch_scc1 .fz_kernel_hwp
.fz_kernel_hwb:
  s_barrier
  s_sub_u32 s3, s3, 1
  s_mov_b32 s47, 2
  s_branch .fz_kernel_hwl
.fz_kernel_hwr:
  s_setpc_b64 s[0:1]
  .fz_kernel_hwp:
  ds_read_b32 v27, v6 offset:0x110
  s_mov_b32 s47, 0
  s_waitcnt lgkmcnt(0)
  v_readfirstlane_b32 s100, v27
  s_cmp_ge_u32 s100, 0x200
  s_cbranch_scc1 .fz_kernel_hwb
  s_branch .fz_kernel_hwl
.fz_kernel_q_cons2:
  s_setprio 0
  s_lshr_b32 s26, s16, 1
  s_lshl_b32 s28, s26, 13
  v_add_u32 v8, s28, v3
  v_add_u32 v9, 1024, v8
  v_mov_b32 v232, v20
  v_mov_b32 v233, v21
  v_mov_b32 v234, v22
  v_mov_b32 v235, v23
  v_mov_b32 v236, v24
  v_mov_b32 v237, v25
  v_mov_b32 v238, v26
  v_mov_b32 v239, v27
  v_mov_b32 v240, v28
  v_mov_b32 v241, v29
  v_mov_b32 v242, v30
  v_mov_b32 v243, v31
  v_mov_b32 v244, v32
  v_mov_b32 v245, v33
  v_mov_b32 v246, v34
  v_mov_b32 v247, v35
  s_branch .fz_kernel_q_cs
.fz_kernel_q_patch:
  s_mul_i32 s31, s27, 384
  s_add_u32 s31, s31, 155648
  v_and_b32 v73, 48, v2
  v_lshlrev_b32 v73, 2, v73
  v_add_u32 v73, s31, v73
  v_and_b32 v75, 15, v2
  v_lshlrev_b32 v75, 3, v75
  v_add_u32 v75, s31, v75
  ds_read_b32 v72, v14 offset:512
  ds_read_b32 v74, v14 offset:576
  ds_read_b32 v76, v14 offset:640
  ds_read_b32 v78, v14 offset:704
  ds_read_b128 v[80:83], v73 offset:1536
  ds_read_b128 v[84:87], v73 offset:1552
  ds_read_b128 v[88:91], v73 offset:1568
  ds_read_b128 v[92:95], v73 offset:1584
  s_waitcnt lgkmcnt(0)
  v_fmac_f32 v160, v82, v72
  v_fmac_f32 v161, v86, v72
  v_fmac_f32 v162, v90, v72
  v_fmac_f32 v163, v94, v72
  v_fmac_f32 v164, v82, v74
  v_fmac_f32 v165, v86, v74
  v_fmac_f32 v166, v90, v74
  v_fmac_f32 v167, v94, v74
  v_fmac_f32 v168, v82, v76
  v_fmac_f32 v169, v86, v76
  v_fmac_f32 v170, v90, v76
  v_fmac_f32 v171, v94, v76
  v_fmac_f32 v172, v82, v78
  v_fmac_f32 v173, v86, v78
  v_fmac_f32 v174, v90, v78
  v_fmac_f32 v175, v94, v78
  v_fmac_f32 v176, v83, v72
  v_fmac_f32 v177, v87, v72
  v_fmac_f32 v178, v91, v72
  v_fmac_f32 v179, v95, v72
  v_fmac_f32 v180, v83, v74
  v_fmac_f32 v181, v87, v74
  v_fmac_f32 v182, v91, v74
  v_fmac_f32 v183, v95, v74
  v_fmac_f32 v184, v83, v76
  v_fmac_f32 v185, v87, v76
  v_fmac_f32 v186, v91, v76
  v_fmac_f32 v187, v95, v76
  v_fmac_f32 v188, v83, v78
  v_fmac_f32 v189, v87, v78
  v_fmac_f32 v190, v91, v78
  v_fmac_f32 v191, v95, v78
  v_fmac_f32 v128, v80, v72
  v_fmac_f32 v129, v84, v72
  v_fmac_f32 v130, v88, v72
  v_fmac_f32 v131, v92, v72
  v_fmac_f32 v132, v80, v74
  v_fmac_f32 v133, v84, v74
  v_fmac_f32 v134, v88, v74
  v_fmac_f32 v135, v92, v74
  v_fmac_f32 v136, v80, v76
  v_fmac_f32 v137, v84, v76
  v_fmac_f32 v138, v88, v76
  v_fmac_f32 v139, v92, v76
  v_fmac_f32 v140, v80, v78
  v_fmac_f32 v141, v84, v78
  v_fmac_f32 v142, v88, v78
  v_fmac_f32 v143, v92, v78
  v_fmac_f32 v144, v81, v72
  v_fmac_f32 v145, v85, v72
  v_fmac_f32 v146, v89, v72
  v_fmac_f32 v147, v93, v72
  v_fmac_f32 v148, v81, v74
  v_fmac_f32 v149, v85, v74
  v_fmac_f32 v150, v89, v74
  v_fmac_f32 v151, v93, v74
  v_fmac_f32 v152, v81, v76
  v_fmac_f32 v153, v85, v76
  v_fmac_f32 v154, v89, v76
  v_fmac_f32 v155, v93, v76
  v_fmac_f32 v156, v81, v78
  v_fmac_f32 v157, v85, v78
  v_fmac_f32 v158, v89, v78
  v_fmac_f32 v159, v93, v78
  ds_read_b128 v[80:83], v15 offset:512
  ds_read_b128 v[84:87], v15 offset:576
  ds_read_b128 v[88:91], v15 offset:640
  ds_read_b128 v[92:95], v15 offset:704
  ds_read_b64 v[72:73], v75 offset:1792
  s_waitcnt lgkmcnt(0)
  v_fmac_f32 v192, v80, v72
  v_fmac_f32 v193, v81, v72
  v_fmac_f32 v194, v82, v72
  v_fmac_f32 v195, v83, v72
  v_fmac_f32 v196, v84, v72
  v_fmac_f32 v197, v85, v72
  v_fmac_f32 v198, v86, v72
  v_fmac_f32 v199, v87, v72
  v_fmac_f32 v200, v88, v72
  v_fmac_f32 v201, v89, v72
  v_fmac_f32 v202, v90, v72
  v_fmac_f32 v203, v91, v72
  v_fmac_f32 v204, v92, v72
  v_fmac_f32 v205, v93, v72
  v_fmac_f32 v206, v94, v72
  v_fmac_f32 v207, v95, v72
  v_fmac_f32 v208, v80, v73
  v_fmac_f32 v209, v81, v73
  v_fmac_f32 v210, v82, v73
  v_fmac_f32 v211, v83, v73
  v_fmac_f32 v212, v84, v73
  v_fmac_f32 v213, v85, v73
  v_fmac_f32 v214, v86, v73
  v_fmac_f32 v215, v87, v73
  v_fmac_f32 v216, v88, v73
  v_fmac_f32 v217, v89, v73
  v_fmac_f32 v218, v90, v73
  v_fmac_f32 v219, v91, v73
  v_fmac_f32 v220, v92, v73
  v_fmac_f32 v221, v93, v73
  v_fmac_f32 v222, v94, v73
  v_fmac_f32 v223, v95, v73
  s_branch .fz_kernel_q_pback
.fz_kernel_q_prod2:
  s_mov_b64 s[8:9], s[4:5]
  s_mov_b64 s[10:11], s[6:7]
  s_mov_b64 s[12:13], s[42:43]
  s_lshl_b32 s35, s17, 6
  s_and_b32 s31, s16, 1
  s_add_u32 s35, s35, s31
  s_lshl_b32 s35, s35, 12
  s_add_u32 s35, s35, s73
  s_lshr_b32 s33, s17, 3
  s_add_u32 s29, s18, s33
  s_lshl1_add_u32 s29, s17, s29
  s_and_b32 s29, s29, 15
  s_mov_b32 s22, 16384
  s_mov_b32 s23, 8192
  s_mov_b32 s36, 0
  s_add_u32 s37, s19, s74
  s_add_u32 s37, s37, 8
  v_mov_b32 v40, v3
  v_mov_b32 v41, v3
  v_mov_b32 v42, v3
  v_mov_b32 v43, v3
  s_branch .fz_kernel_q_pc
.fz_kernel_xok1w:
  s_call_b64 s[68:69], .fz_kernel_q_xw
  s_branch .fz_kernel_xok1
.fz_kernel_xok2w:
  s_call_b64 s[68:69], .fz_kernel_q_xw
  s_branch .fz_kernel_xok2
.fz_kernel_q_xw:
  s_mov_b64 exec, 1
  s_mov_b32 s38, 0
.fz_kernel_q_xwl:
  ds_read_b32 v11, v6 offset:0x114
  s_add_u32 s38, s38, 1
  s_waitcnt lgkmcnt(0)
  v_readfirstlane_b32 s36, v11
  s_bitcmp1_b32 s36, s24
  s_cbranch_scc1 .fz_kernel_q_xwd
  s_cmp_lt_u32 s38, 1048576
  s_cbranch_scc1 .fz_kernel_q_xwl
  s_mov_b32 s36, -1
.fz_kernel_q_xwd:
  s_mov_b64 exec, -1
  s_nop 4
  s_setpc_b64 s[68:69]
.fz_kernel_xok3w:
  s_call_b64 s[68:69], .fz_kernel_q_xw
  s_branch .fz_kernel_xok3
.fz_kernel_lz20a:
  v_lshlrev_b32 v16, 3, v2
  buffer_atomic_and_x2 v[12:13], v16, s[4:7], s36 offen offset:0 sc1
  buffer_atomic_and_x2 v[12:13], v16, s[4:7], s36 offen offset:512 sc1
  buffer_atomic_and_x2 v[12:13], v16, s[4:7], s36 offen offset:1024 sc1
  buffer_atomic_and_x2 v[12:13], v16, s[4:7], s36 offen offset:1536 sc1
  buffer_atomic_and_x2 v[12:13], v16, s[4:7], s36 offen offset:2048 sc1
  buffer_atomic_and_x2 v[12:13], v16, s[4:7], s36 offen offset:2560 sc1
  buffer_atomic_and_x2 v[12:13], v16, s[4:7], s36 offen offset:3072 sc1
  buffer_atomic_and_x2 v[12:13], v16, s[4:7], s36 offen offset:3584 sc1
  s_branch .fz_kernel_lz20
.fz_kernel_a_pick:
  s_cmp_eq_u32 s34, 0xffff
  s_cbranch_scc1 .fz_kernel_a_picke
  s_mov_b32 s38, 0
.fz_kernel_a_pickl:
  ds_read_b32 v7, v6
  s_add_u32 s38, s38, 1
  s_waitcnt lgkmcnt(0)
  v_readfirstlane_b32 s33, v7
  s_cmp_lt_u32 s38, 1048576
  s_cselect_b32 s33, s33, 0xffff
  s_andn2_b32 s36, s33, s34
  s_cbranch_scc0 .fz_kernel_a_pickl
  s_or_b32 s34, s34, s33
  s_ff1_i32_b32 s33, s36
  s_bitset0_b32 s36, s33
  s_lshl_b32 s33, s33, 14
  s_add_u32 s30, s33, s35
  s_setpc_b64 s[68:69]
.fz_kernel_a_picke:
  s_mov_b32 s30, 0x40000000
  ds_write_b32 v6, v5 offset:0x104
  s_setpc_b64 s[68:69]
.fz_kernel_pk26c:
  s_call_b64 s[68:69], .fz_kernel_a_pick
  s_branch .fz_kernel_pk26
.fz_kernel_pk27c:
  s_call_b64 s[68:69], .fz_kernel_a_pick
  s_branch .fz_kernel_pk27
.fz_kernel_pk28c:
  s_call_b64 s[68:69], .fz_kernel_a_pick
  s_branch .fz_kernel_pk28
.fz_kernel_pk31c:
  s_call_b64 s[68:69], .fz_kernel_a_pick
  s_branch .fz_kernel_pk31
.fz_kernel_pk32c:
  s_call_b64 s[68:69], .fz_kernel_a_pick
  s_branch .fz_kernel_pk32
.fz_kernel_a_slow:
  s_cmp_lg_u32 s73, 0
  s_cbranch_scc1 .fz_kernel_a_ok
  s_mov_b32 s73, 1
  s_and_b32 s39, s16, 1
  v_mov_b32 v16, v32
  v_mov_b32 v17, v33
  v_mov_b32 v18, v34
  v_mov_b32 v19, v35
  v_mov_b32 v20, v36
  v_mov_b32 v21, v37
  v_mov_b32 v22, v38
  v_mov_b32 v23, v39
  s_call_b64 s[68:69], .fz_kernel_a_sl
  v_mov_b32 v176, v144
  v_mov_b32 v177, v145
  v_mov_b32 v178, v146
  v_mov_b32 v179, v147
  v_mov_b32 v180, v148
  v_mov_b32 v181, v149
  v_mov_b32 v182, v150
  v_mov_b32 v183, v151
  v_mov_b32 v184, v152
  v_mov_b32 v185, v153
  v_mov_b32 v186, v154
  v_mov_b32 v187, v155
  v_mov_b32 v188, v156
  v_mov_b32 v189, v157
  v_mov_b32 v190, v158
  v_mov_b32 v191, v159
  v_mov_b32 v24, v25
  v_mov_b32 v16, v40
  v_mov_b32 v17, v41
  v_mov_b32 v18, v42
  v_mov_b32 v19, v43
  v_mov_b32 v20, v44
  v_mov_b32 v21, v45
  v_mov_b32 v22, v46
  v_mov_b32 v23, v47
  s_call_b64 s[68:69], .fz_kernel_a_sl
  v_mov_b32 v192, v144
  v_mov_b32 v193, v145
  v_mov_b32 v194, v146
  v_mov_b32 v195, v147
  v_mov_b32 v196, v148
  v_mov_b32 v197, v149
  v_mov_b32 v198, v150
  v_mov_b32 v199, v151
  v_mov_b32 v200, v152
  v_mov_b32 v201, v153
  v_mov_b32 v202, v154
  v_mov_b32 v203, v155
  v_mov_b32 v204, v156
  v_mov_b32 v205, v157
  v_mov_b32 v206, v158
  v_mov_b32 v207, v159
  v_rcp_f32 v26, v24
  v_cmp_le_f32 vcc, s24, v24
  s_and_b64 s[36:37], s[36:37], vcc
  v_cmp_ge_f32 vcc, s25, v24
  s_and_b64 s[36:37], s[36:37], vcc
  v_pk_mul_f32 v[176:177], v[176:177], v[26:27] op_sel_hi:[1,0]
  v_pk_mul_f32 v[178:179], v[178:179], v[26:27] op_sel_hi:[1,0]
  v_pk_mul_f32 v[180:181], v[180:181], v[26:27] op_sel_hi:[1,0]
  v_pk_mul_f32 v[182:183], v[182:183], v[26:27] op_sel_hi:[1,0]
  v_cvt_pk_bf16_f32 v80, v176, v177
  v_cvt_pk_bf16_f32 v81, v178, v179
  v_cvt_pk_bf16_f32 v82, v180, v181
  v_cvt_pk_bf16_f32 v83, v182, v183
  buffer_store_dwordx4 v[80:83], v3, s[4:7], s28 offen offset:0 sc1
  v_pk_mul_f32 v[184:185], v[184:185], v[26:27] op_sel_hi:[1,0]
  v_pk_mul_f32 v[186:187], v[186:187], v[26:27] op_sel_hi:[1,0]
  v_pk_mul_f32 v[188:189], v[188:189], v[26:27] op_sel_hi:[1,0]
  v_pk_mul_f32 v[190:191], v[190:191], v[26:27] op_sel_hi:[1,0]
  v_cvt_pk_bf16_f32 v84, v184, v185
  v_cvt_pk_bf16_f32 v85, v186, v187
  v_cvt_pk_bf16_f32 v86, v188, v189
  v_cvt_pk_bf16_f32 v87, v190, v191
  buffer_store_dwordx4 v[84:87], v3, s[4:7], s28 offen offset:1024 sc1
  s_branch .fz_kernel_a_fin
.fz_kernel_a_sl:
  s_waitcnt vmcnt(0)
  s_lshl_b32 s23, s18, 1
  s_add_u32 s23, s23, s39
  s_lshl_b32 s23, s23, 18
  s_add_u32 s23, s23, s63
  s_mov_b32 s30, s23
  s_mov_b32 s33, 64
  v_mov_b32 v27, 0xff800000
.fz_kernel_a_s1:
  buffer_load_dwordx4 v[80:83], v3, s[4:7], s30 offen offset:0
  buffer_load_dwordx4 v[84:87], v3, s[4:7], s30 offen offset:1024
  s_waitcnt vmcnt(0)
  v_mfma_f32_32x32x16_bf16 v[48:63], v[80:83], v[16:19], 0
  v_mfma_f32_32x32x16_bf16 v[48:63], v[84:87], v[20:23], v[48:63]
  s_nop 11
  v_max3_f32 v27, v27, v48, v49
  v_max3_f32 v27, v27, v50, v51
  v_max3_f32 v27, v27, v52, v53
  v_max3_f32 v27, v27, v54, v55
  v_max3_f32 v27, v27, v56, v57
  v_max3_f32 v27, v27, v58, v59
  v_max3_f32 v27, v27, v60, v61
  v_max3_f32 v27, v27, v62, v63
  s_add_u32 s30, s30, 4096
  s_sub_u32 s33, s33, 1
  s_cmp_lg_u32 s33, 0
  s_cbranch_scc1 .fz_kernel_a_s1
  v_mov_b32 v29, v27
  s_nop 1
  v_permlane32_swap_b32 v29, v27
  v_max_f32 v27, v27, v29
  v_sub_f32 v27, 0, v27
  v_mov_b32 v64, v27
  v_mov_b32 v144, 0
  v_mov_b32 v65, v27
  v_mov_b32 v145, 0
  v_mov_b32 v66, v27
  v_mov_b32 v146, 0
  v_mov_b32 v67, v27
  v_mov_b32 v147, 0
  v_mov_b32 v68, v27
  v_mov_b32 v148, 0
  v_mov_b32 v69, v27
  v_mov_b32 v149, 0
  v_mov_b32 v70, v27
  v_mov_b32 v150, 0
  v_mov_b32 v71, v27
  v_mov_b32 v151, 0
  v_mov_b32 v72, v27
  v_mov_b32 v152, 0
  v_mov_b32 v73, v27
  v_mov_b32 v153, 0
  v_mov_b32 v74, v27
  v_mov_b32 v154, 0
  v_mov_b32 v75, v27
  v_mov_b32 v155, 0
  v_mov_b32 v76, v27
  v_mov_b32 v156, 0
  v_mov_b32 v77, v27
  v_mov_b32 v157, 0
  v_mov_b32 v78, v27
  v_mov_b32 v158, 0
  v_mov_b32 v79, v27
  v_mov_b32 v159, 0
  v_mov_b32 v208, 0
  v_mov_b32 v209, 0
  v_mov_b32 v210, 0
  v_mov_b32 v211, 0
  s_mov_b32 s30, s23
  s_mov_b32 s33, 64
.fz_kernel_a_s2:
  buffer_load_dwordx4 v[80:83], v3, s[4:7], s30 offen offset:0
  buffer_load_dwordx4 v[84:87], v3, s[4:7], s30 offen offset:1024
  buffer_load_dwordx4 v[88:91], v3, s[4:7], s30 offen offset:2048
  buffer_load_dwordx4 v[92:95], v3, s[4:7], s30 offen offset:3072
  s_waitcnt vmcnt(0)
  v_mfma_f32_32x32x16_bf16 v[48:63], v[80:83], v[16:19], v[64:79]
  v_mfma_f32_32x32x16_bf16 v[48:63], v[84:87], v[20:23], v[48:63]
  s_nop 11
  v_exp_f32 v48, v48
  v_exp_f32 v49, v49
  v_exp_f32 v50, v50
  v_exp_f32 v51, v51
  v_exp_f32 v52, v52
  v_exp_f32 v53, v53
  v_exp_f32 v54, v54
  v_exp_f32 v55, v55
  v_exp_f32 v56, v56
  v_exp_f32 v57, v57
  v_exp_f32 v58, v58
  v_exp_f32 v59, v59
  v_exp_f32 v60, v60
  v_exp_f32 v61, v61
  v_exp_f32 v62, v62
  v_exp_f32 v63, v63
  v_cvt_pk_bf16_f32 v224, v48, v49
  v_cvt_pk_bf16_f32 v225, v50, v51
  v_cvt_pk_bf16_f32 v226, v52, v53
  v_cvt_pk_bf16_f32 v227, v54, v55
  v_cvt_pk_bf16_f32 v228, v56, v57
  v_cvt_pk_bf16_f32 v229, v58, v59
  v_cvt_pk_bf16_f32 v230, v60, v61
  v_cvt_pk_bf16_f32 v231, v62, v63
  v_mfma_f32_32x32x16_bf16 v[144:159], v[88:91], v[224:227], v[144:159]
  s_nop 0
  v_mfma_f32_32x32x16_bf16 v[144:159], v[92:95], v[228:231], v[144:159]
  v_smfmac_f32_16x16x64_bf16 v[208:211], v[12:15], v[224:231], v11
  s_add_u32 s30, s30, 4096
  s_sub_u32 s33, s33, 1
  s_cmp_lg_u32 s33, 0
  s_cbranch_scc1 .fz_kernel_a_s2
  s_nop 7
  v_add_f32 v208, v208, v210
  v_add_f32 v209, v209, v211
  v_cndmask_b32 v25, v208, v209, s[26:27]
  s_nop 7
  s_setpc_b64 s[68:69]
.fz_kernel_serv:
  s_setprio 3
  s_mov_b32 s24, s44
  s_mov_b32 s25, s45
  s_mov_b32 s26, 0x200000
  s_mov_b32 s27, 0x00020000
  v_lshrrev_b32 v8, 3, v2
  v_and_b32 v9, 7, v2
  v_bfe_u32 v10, v2, 4, 1
  v_lshlrev_b32 v10, 2, v10
  v_xor_b32 v9, v9, v10
  v_lshlrev_b32 v9, 4, v9
  v_lshl_add_u32 v10, v8, 11, v9
  s_cmp_eq_u32 s16, 5
  s_cbranch_scc1 .fz_kernel_sv1
  s_barrier
  v_lshlrev_b32 v7, 7, v2
  s_lshl_b32 s31, s18, 11
  s_lshl_b32 s33, 1, s17
  s_add_u32 s31, s31, s67
  s_add_u32 s31, s31, 0x1800000
  v_mov_b32 v8, s33
  s_mov_b64 exec, 0xffff
  s_mov_b32 s38, 0
.fz_kernel_cw33:
  s_sleep 1
  ds_read_u8 v9, v6 offset:256
  s_add_u32 s38, s38, 1
  s_waitcnt lgkmcnt(0)
  v_cmp_gt_u32 vcc, 4, v9
  s_cbranch_vccz .fz_kernel_cw33d
  s_cmp_lt_u32 s38, 8388608
  s_cbranch_scc1 .fz_kernel_cw33
.fz_kernel_cw33d:
  buffer_atomic_or v8, v7, s[4:7], s31 offen sc1
  s_mov_b64 exec, -1
  s_setprio 0
  s_mov_b32 s38, 0
.fz_kernel_kw34:
  s_sleep 2
  ds_read_b32 v7, v6 offset:0
  s_add_u32 s38, s38, 1
  s_waitcnt lgkmcnt(0)
  v_readfirstlane_b32 s31, v7
  s_bcnt1_i32_b32 s31, s31
  s_cmp_ge_u32 s31, 16
  s_cbranch_scc1 .fz_kernel_kw34d
  s_cmp_lt_u32 s38, 1048576
  s_cbranch_scc1 .fz_kernel_kw34
.fz_kernel_kw34d:
  s_branch .fz_kernel_sv2
.fz_kernel_sv1:
  s_add_u32 s37, s19, s67
  s_mov_b64 exec, 1
  buffer_load_dword v7, v4, s[4:7], s37 offen sc1
  s_waitcnt vmcnt(0)
  ds_or_b32 v6, v7
  buffer_load_dword v9, v4, s[4:7], s37 offen sc1
  s_barrier
  s_waitcnt vmcnt(0)
  ds_or_b32 v6, v9
  s_add_u32 s37, s19, s67
  s_mov_b64 exec, 1
  s_mov_b32 s38, 0
.fz_kernel_po35:
  buffer_load_dword v7, v4, s[4:7], s37 offen offset:0 sc1
  s_add_u32 s38, s38, 1
  s_waitcnt vmcnt(0)
  ds_or_b32 v6, v7 offset:0
  v_cmp_ne_u32 vcc, 0xffff, v7
  s_cbranch_vccz .fz_kernel_po35d
  s_sleep 12
  s_cmp_lt_u32 s38, 131072
  s_cbranch_scc1 .fz_kernel_po35
.fz_kernel_po35d:
  s_mov_b64 exec, -1
  s_setprio 0
  s_mov_b32 s38, 0
.fz_kernel_kw36:
  s_sleep 2
  ds_read_b32 v7, v6 offset:0
  s_add_u32 s38, s38, 1
  s_waitcnt lgkmcnt(0)
  v_readfirstlane_b32 s31, v7
  s_bcnt1_i32_b32 s31, s31
  s_cmp_ge_u32 s31, 16
  s_cbranch_scc1 .fz_kernel_kw36d
  s_cmp_lt_u32 s38, 1048576
  s_cbranch_scc1 .fz_kernel_kw36
.fz_kernel_kw36d:
.fz_kernel_sv2:
  s_and_b32 s30, s16, 1
  s_lshl_b32 s30, s30, 16
  s_add_u32 s32, s30, 65536
  s_lshl_b32 s31, s18, 7
  v_add_u32 v10, s31, v10
.fz_kernel_sv3:
  s_mov_b32 m0, s30
  s_lshl_b32 s31, s30, 4
  s_add_u32 s30, s30, 1024
  buffer_load_dwordx4 v10, s[24:27], s31 offen  lds
  s_cmp_lg_u32 s30, s32
  s_waitcnt vmcnt(3)
  s_cbranch_scc1 .fz_kernel_sv3
  s_cmp_lg_u32 s62, 0
  s_cbranch_scc1 .fz_kernel_wt37
  s_mov_b32 s12, s42
  s_mov_b32 s13, s43
  s_mov_b32 s14, 0x600000
  s_mov_b32 s15, 0x00020000
  s_and_b32 s30, s16, 1
  s_lshl1_add_u32 s30, s17, s30
  s_and_b32 s30, s30, 15
  s_mul_i32 s30, s30, 393216
  s_lshl_b32 s31, s18, 7
  s_add_u32 s30, s30, s31
  v_mul_u32_u24 v11, 6144, v2
  buffer_load_dword v1, v11, s[12:15], s30 offen
  s_add_u32 s30, s30, 2048
  s_waitcnt vmcnt(0)
  buffer_load_dword v1, v11, s[12:15], s30 offen
  s_add_u32 s30, s30, 2048
  s_waitcnt vmcnt(0)
  buffer_load_dword v1, v11, s[12:15], s30 offen
  s_add_u32 s30, s30, 2048
  s_waitcnt vmcnt(0)
.fz_kernel_wt37:
  s_cmp_lg_u32 s16, 4
  s_cbranch_scc1 .fz_kernel_ct38e
  s_getpc_b64 s[0:1]
.fz_kernel_ct38:
  s_sub_u32 s0, s0, .fz_kernel_ct38-fz_kernel
  s_subb_u32 s1, s1, 0
  s_lshr_b32 s31, s2, 3
  s_mulk_i32 s31, 0x500
  v_lshl_add_u32 v1, v2, 7, s31
  v_min_u32 v1, .fz_kernel_last-fz_kernel, v1
  s_mov_b64 exec, 0x3ff
  global_load_dword v1, v1, s[0:1]
  s_mov_b64 exec, -1
.fz_kernel_ct38e:
  s_waitcnt vmcnt(0)
  s_cmp_lg_u32 s16, 5
  s_cbranch_scc1 .fz_kernel_sv35
  s_mov_b64 exec, 1
  s_mov_b32 s38, 0
.fz_kernel_sv34:
  s_sleep 4
  buffer_load_dword v7, v4, s[4:7], s37 offen offset:4 sc1
  ds_read_b32 v8, v6 offset:0x104
  s_add_u32 s38, s38, 1
  s_waitcnt vmcnt(0) lgkmcnt(0)
  ds_or_b32 v6, v7 offset:8
  v_cmp_ne_u32 vcc, 0, v8
  s_cbranch_vccnz .fz_kernel_sv35
  s_cmp_lt_u32 s38, 131072
  s_cbranch_scc1 .fz_kernel_sv34
.fz_kernel_sv35:
  s_mov_b64 exec, -1
  s_setprio 3
  s_barrier
  s_cmp_eq_u32 s16, 5
  s_cbranch_scc1 .fz_kernel_sv4
  v_lshlrev_b32 v7, 11, v2
  s_lshl_b32 s31, s17, 7
  s_lshl_b32 s33, 1, s18
  s_add_u32 s31, s31, s67
  s_add_u32 s31, s31, 0x1800004
  v_mov_b32 v8, s33
  s_mov_b64 exec, 0xffff
  s_mov_b32 s38, 0
.fz_kernel_cw39:
  s_sleep 1
  ds_read_u8 v9, v6 offset:264
  s_add_u32 s38, s38, 1
  s_waitcnt lgkmcnt(0)
  v_cmp_gt_u32 vcc, 4, v9
  s_cbranch_vccz .fz_kernel_cw39d
  s_cmp_lt_u32 s38, 8388608
  s_cbranch_scc1 .fz_kernel_cw39
.fz_kernel_cw39d:
  buffer_atomic_or v8, v7, s[4:7], s31 offen sc1
  s_mov_b64 exec, -1
  s_mov_b64 exec, 1
  ds_or_b32 v6, v8 offset:8
  s_mov_b64 exec, -1
  s_branch .fz_kernel_sv5
.fz_kernel_sv4:
  s_add_u32 s37, s19, s67
  s_mov_b64 exec, 1
  s_mov_b32 s38, 0
.fz_kernel_po40:
  buffer_load_dword v7, v4, s[4:7], s37 offen offset:4 sc1
  s_add_u32 s38, s38, 1
  s_waitcnt vmcnt(0)
  ds_or_b32 v6, v7 offset:8
  v_cmp_ne_u32 vcc, 0xffff, v7
  s_cbranch_vccz .fz_kernel_po40d
  s_sleep 12
  s_cmp_lt_u32 s38, 131072
  s_cbranch_scc1 .fz_kernel_po40
.fz_kernel_po40d:
  s_mov_b64 exec, -1
.fz_kernel_sv5:
  s_mov_b32 s72, s66
  s_mov_b32 s73, s65
  s_mov_b32 s74, s67
  s_mov_b32 s75, s62
  s_cmp_lg_u32 s62, 0
  s_cbranch_scc1 .fz_kernel_w_lt
  s_mov_b32 s62, 1
  s_mov_b32 s63, 0x2000000
  s_mov_b32 s64, 0x2800000
  s_mov_b32 s65, 0x1400000
  s_mov_b32 s66, 0x1c42000
  s_mov_b32 s67, 12
  s_mov_b32 s71, 159776
  v_mov_b32 v6, 159832
  s_branch .fz_kernel_q_prod2
.fz_kernel_w_lt:
  s_barrier
  s_barrier
  s_branch .fz_kernel_fin
.fz_kernel_pk41c:
  s_call_b64 s[68:69], .fz_kernel_pick
  s_branch .fz_kernel_pk41
.fz_kernel_pk42c:
  s_call_b64 s[68:69], .fz_kernel_pick
  s_branch .fz_kernel_pk42
.fz_kernel_w_pt:
  v_lshlrev_b32 v44, 5, v17
  v_add_u32 v44, 155648, v44
  s_mov_b64 exec, vcc
  ds_read_b128 v[232:235], v44 offset:7424
  ds_read_b128 v[236:239], v44 offset:7440
  ds_read_b128 v[240:243], v44 offset:7488
  ds_read_b128 v[244:247], v44 offset:7504
  s_waitcnt lgkmcnt(0)
  v_pk_add_f32 v[64:65], v[64:65], v[232:233]
  v_pk_add_f32 v[66:67], v[66:67], v[234:235]
  v_pk_add_f32 v[68:69], v[68:69], v[236:237]
  v_pk_add_f32 v[70:71], v[70:71], v[238:239]
  v_pk_add_f32 v[72:73], v[72:73], v[240:241]
  v_pk_add_f32 v[74:75], v[74:75], v[242:243]
  v_pk_add_f32 v[76:77], v[76:77], v[244:245]
  v_pk_add_f32 v[78:79], v[78:79], v[246:247]
  ds_read_b128 v[232:235], v44 offset:7552
  ds_read_b128 v[236:239], v44 offset:7568
  ds_read_b128 v[240:243], v44 offset:7616
  ds_read_b128 v[244:247], v44 offset:7632
  s_waitcnt lgkmcnt(0)
  v_pk_add_f32 v[80:81], v[80:81], v[232:233]
  v_pk_add_f32 v[82:83], v[82:83], v[234:235]
  v_pk_add_f32 v[84:85], v[84:85], v[236:237]
  v_pk_add_f32 v[86:87], v[86:87], v[238:239]
  v_pk_add_f32 v[88:89], v[88:89], v[240:241]
  v_pk_add_f32 v[90:91], v[90:91], v[242:243]
  v_pk_add_f32 v[92:93], v[92:93], v[244:245]
  v_pk_add_f32 v[94:95], v[94:95], v[246:247]
  s_mov_b64 exec, -1
  s_branch .fz_kernel_w_pb
.fz_kernel_pk43c:
  s_call_b64 s[68:69], .fz_kernel_pick
  s_branch .fz_kernel_pk43
.fz_kernel_pk44c:
  s_call_b64 s[68:69], .fz_kernel_pick
  s_branch .fz_kernel_pk44
.fz_kernel_pk45c:
  s_call_b64 s[68:69], .fz_kernel_pick
  s_branch .fz_kernel_pk45
.fz_kernel_pk46c:
  s_call_b64 s[68:69], .fz_kernel_pick
  s_branch .fz_kernel_pk46
.fz_kernel_pk47c:
  s_call_b64 s[68:69], .fz_kernel_pick
  s_branch .fz_kernel_pk47
.fz_kernel_pk48c:
  s_call_b64 s[68:69], .fz_kernel_pick
  s_branch .fz_kernel_pk48
.fz_kernel_pk49c:
  s_call_b64 s[68:69], .fz_kernel_pick
  s_branch .fz_kernel_pk49
.fz_kernel_pk50c:
  s_call_b64 s[68:69], .fz_kernel_pick
  s_branch .fz_kernel_pk50
.fz_kernel_pk51c:
  s_call_b64 s[68:69], .fz_kernel_pick
  s_branch .fz_kernel_pk51
.fz_kernel_pk52c:
  s_call_b64 s[68:69], .fz_kernel_pick
  s_branch .fz_kernel_pk52
.fz_kernel_pk53c:
  s_call_b64 s[68:69], .fz_kernel_pick
  s_branch .fz_kernel_pk53
.fz_kernel_pk54c:
  s_call_b64 s[68:69], .fz_kernel_pick
  s_branch .fz_kernel_pk54
.fz_kernel_pk55c:
  s_call_b64 s[68:69], .fz_kernel_pick
  s_branch .fz_kernel_pk55
.fz_kernel_pk56c:
  s_call_b64 s[68:69], .fz_kernel_pick
  s_branch .fz_kernel_pk56
.fz_kernel_pk57c:
  s_call_b64 s[68:69], .fz_kernel_pick
  s_branch .fz_kernel_pk57
.fz_kernel_pk58c:
  s_call_b64 s[68:69], .fz_kernel_pick
  s_branch .fz_kernel_pk58
.fz_kernel_c_nl:
  s_barrier
  s_branch .fz_kernel_c_np
.fz_kernel_c_c7:
  s_mov_b32 s38, 0
.fz_kernel_cw63:
  s_sleep 1
  ds_read_u8 v22, v6 offset:272
  s_add_u32 s38, s38, 1
  s_waitcnt lgkmcnt(0)
  v_cmp_gt_u32 vcc, 2, v22
  s_cbranch_vccz .fz_kernel_cw63d
  s_cmp_lt_u32 s38, 8388608
  s_cbranch_scc1 .fz_kernel_cw63
.fz_kernel_cw63d:
  ds_read_b64_tr_b16 v[32:33], v7 offset:0
  ds_read_b64_tr_b16 v[34:35], v7 offset:512
  ds_read_b64_tr_b16 v[36:37], v13 offset:0
  ds_read_b64_tr_b16 v[38:39], v13 offset:512
  ds_read_b64_tr_b16 v[40:41], v7 offset:4096
  ds_read_b64_tr_b16 v[42:43], v7 offset:4608
  ds_read_b64_tr_b16 v[44:45], v13 offset:4096
  ds_read_b64_tr_b16 v[46:47], v13 offset:4608
  ds_read_b64_tr_b16 v[48:49], v7 offset:8192
  ds_read_b64_tr_b16 v[50:51], v7 offset:8704
  ds_read_b64_tr_b16 v[52:53], v13 offset:8192
  ds_read_b64_tr_b16 v[54:55], v13 offset:8704
  s_waitcnt lgkmcnt(0)
  ds_read_b64_tr_b16 v[56:57], v7 offset:12288
  ds_read_b64_tr_b16 v[58:59], v7 offset:12800
  ds_read_b64_tr_b16 v[60:61], v13 offset:12288
  ds_read_b64_tr_b16 v[62:63], v13 offset:12800
  ds_read_b64_tr_b16 v[64:65], v7 offset:16384
  ds_read_b64_tr_b16 v[66:67], v7 offset:16896
  ds_read_b64_tr_b16 v[68:69], v13 offset:16384
  ds_read_b64_tr_b16 v[70:71], v13 offset:16896
  ds_read_b64_tr_b16 v[72:73], v7 offset:20480
  ds_read_b64_tr_b16 v[74:75], v7 offset:20992
  ds_read_b64_tr_b16 v[76:77], v13 offset:20480
  ds_read_b64_tr_b16 v[78:79], v13 offset:20992
  s_waitcnt lgkmcnt(0)
  s_branch .fz_kernel_c_c2
.fz_kernel_c_coef:
  v_fma_f32 v242, -v240, v240, v242
  v_fma_f32 v243, -v241, v241, v243
  v_rsq_f32 v248, abs(v242)
  v_rsq_f32 v249, abs(v243)
  v_mul_f32 v254, v240, v248
  v_sub_f32 v254, 0, v254
  v_mov_b32 v252, 1.0
  v_fmac_f32 v252, 0x44800000, v248
  v_fma_f32 v242, v242, v24, -v25
  v_max_f32 v242, 0, v242
  v_mul_f32 v248, v252, v252
  v_fma_f32 v248, v248, v242, v25
  v_rsq_f32 v248, v248
  v_mul_f32 v240, v23, v240
  v_mul_f32 v248, v248, v252
  v_mul_f32 v250, v248, v240
  v_sub_f32 v250, 0, v250
  v_mul_f32 v255, v241, v249
  v_sub_f32 v255, 0, v255
  v_mov_b32 v253, 1.0
  v_fmac_f32 v253, 0x44800000, v249
  s_cmp_eq_u32 s3, 0
  s_cbranch_scc1 .fz_kernel_hb68
  s_barrier
  s_sub_u32 s3, s3, 1
.fz_kernel_hb68:
  v_fma_f32 v243, v243, v24, -v25
  v_max_f32 v243, 0, v243
  v_mul_f32 v249, v253, v253
  v_fma_f32 v249, v249, v243, v25
  v_rsq_f32 v249, v249
  v_mul_f32 v241, v23, v241
  v_mul_f32 v249, v249, v253
  v_mul_f32 v251, v249, v241
  v_sub_f32 v251, 0, v251
  s_setpc_b64 s[68:69]
.fz_kernel_c_gur:
  v_min_u32 v9, v144, v146
  v_cmp_eq_u32 s[8:9], 0, v9
  v_min_u32 v9, v148, v150
  v_cmp_eq_u32 s[10:11], 0, v9
  v_min_u32 v9, v152, v154
  v_cmp_eq_u32 s[12:13], 0, v9
  v_min_u32 v9, v156, v158
  v_cmp_eq_u32 s[14:15], 0, v9
  s_add_u32 s38, s38, 1
  s_cmp_ge_u32 s38, 131072
  s_cbranch_scc1 .fz_kernel_c_gud
  s_or_b64 exec, s[8:9], 1
  buffer_load_dwordx4 v[144:147], v21, s[4:7], s21 offen offset:0 sc1
  s_or_b64 exec, s[10:11], 1
  buffer_load_dwordx4 v[148:151], v21, s[4:7], s21 offen offset:512 sc1
  s_or_b64 exec, s[12:13], 1
  buffer_load_dwordx4 v[152:155], v21, s[4:7], s21 offen offset:1024 sc1
  s_or_b64 exec, s[14:15], 1
  buffer_load_dwordx4 v[156:159], v21, s[4:7], s21 offen offset:1536 sc1
  s_mov_b64 exec, -1
  s_branch .fz_kernel_c_gu
.fz_kernel_c_pur:
  v_min3_u32 v9, v144, v146, v148
  v_min_u32 v9, v9, v150
  v_cmp_eq_u32 s[8:9], 0, v9
  v_min3_u32 v9, v152, v154, v156
  v_min_u32 v9, v9, v158
  v_cmp_eq_u32 s[10:11], 0, v9
  v_min3_u32 v9, v160, v162, v164
  v_min_u32 v9, v9, v166
  v_cmp_eq_u32 s[12:13], 0, v9
  v_min3_u32 v9, v168, v170, v172
  v_min_u32 v9, v9, v174
  v_cmp_eq_u32 s[14:15], 0, v9
  s_cmp_eq_u32 s3, 0
  s_cbranch_scc1 .fz_kernel_hb72
  s_barrier
  s_sub_u32 s3, s3, 1
.fz_kernel_hb72:
  s_add_u32 s38, s38, 1
  s_cmp_ge_u32 s38, 131072
  s_cbranch_scc1 .fz_kernel_c_pud
  s_and_b64 exec, s[8:9], -1
  s_cbranch_scc0 .fz_kernel_c_ps0
  buffer_load_dwordx4 v[144:147], v10, s[4:7], s21 offen offset:0 sc1
  buffer_load_dwordx4 v[148:151], v10, s[4:7], s21 offen offset:16 sc1
.fz_kernel_c_ps0:
  s_and_b64 exec, s[10:11], -1
  s_cbranch_scc0 .fz_kernel_c_ps1
  buffer_load_dwordx4 v[152:155], v10, s[4:7], s21 offen offset:2048 sc1
  buffer_load_dwordx4 v[156:159], v10, s[4:7], s21 offen offset:2064 sc1
.fz_kernel_c_ps1:
  s_and_b64 exec, s[12:13], -1
  s_cbranch_scc0 .fz_kernel_c_ps2
  buffer_load_dwordx4 v[160:163], v10, s[4:7], s22 offen offset:0 sc1
  buffer_load_dwordx4 v[164:167], v10, s[4:7], s22 offen offset:16 sc1
.fz_kernel_c_ps2:
  s_and_b64 exec, s[14:15], -1
  s_cbranch_scc0 .fz_kernel_c_ps3
  buffer_load_dwordx4 v[168:171], v10, s[4:7], s22 offen offset:2048 sc1
  buffer_load_dwordx4 v[172:175], v10, s[4:7], s22 offen offset:2064 sc1
.fz_kernel_c_ps3:
  s_mov_b64 exec, -1
  s_branch .fz_kernel_c_pu
.fz_kernel_last:
  s_endpgm

.section .rodata,"a"
.p2align 6
.amdhsa_kernel fz_kernel
  .amdhsa_next_free_vgpr 256
  .amdhsa_next_free_sgpr 102
  .amdhsa_accum_offset 256
  .amdhsa_group_segment_fixed_size 0
  .amdhsa_kernarg_size 88
  .amdhsa_user_sgpr_count 2
  .amdhsa_user_sgpr_kernarg_segment_ptr 1
  .amdhsa_system_sgpr_workgroup_id_x 1
.end_amdhsa_kernel
```

```asm
; @launch kernel=fz_kernel grid=(256,1,1) block=(512,1,1) lds=163840
.amdgcn_target "amdgcn-amd-amdhsa--gfx950"
.text
.globl fz_kernel
.p2align 8
.type fz_kernel,@function
fz_kernel:
  s_cmp_ge_u32 s2, 256
  s_cbranch_scc1 .fz_kernel_end
  s_load_dwordx2 s[8:9], s[0:1], 0
  s_load_dwordx2 s[12:13], s[0:1], 8
  s_load_dwordx2 s[4:5], s[0:1], 80
  s_load_dwordx16 s[40:55], s[0:1], 0
  s_load_dwordx4 s[56:59], s[0:1], 64
  v_lshrrev_b32 v1, 6, v0
  v_and_b32 v2, 63, v0
  v_readfirstlane_b32 s16, v1
  s_and_b32 s21, s2, 7
  s_lshr_b32 s22, s2, 3
  s_and_b32 s23, s21, 3
  s_lshl_b32 s23, s23, 2
  s_and_b32 s24, s22, 3
  s_add_u32 s18, s23, s24
  s_lshr_b32 s24, s21, 2
  s_lshl_b32 s24, s24, 3
  s_lshr_b32 s25, s22, 2
  s_add_u32 s17, s24, s25
  s_lshl_b32 s19, s18, 4
  s_add_u32 s19, s19, s17
  s_lshl_b32 s19, s19, 7
  s_add_u32 s19, s19, 0x1800000
  v_lshlrev_b32 v3, 4, v2
  v_mov_b32 v4, 0
  v_mov_b32 v5, 1
  s_mov_b32 s6, 0x2c00000
  s_mov_b32 s7, 0x00020000
  s_mov_b32 s62, 0
  s_mov_b32 s63, 0x400000
  s_mov_b32 s64, 0xc00000
  s_mov_b32 s65, 0x1000000
  s_mov_b32 s66, 0x1c00000
  s_mov_b32 s67, 0
  s_mov_b32 s71, 159744
  v_mov_b32 v6, 159808
  s_cmp_lt_u32 s16, 4
  s_cbranch_scc1 .fz_kernel_q_cons1
  s_cmp_ge_u32 s16, 6
  s_cbranch_scc1 .fz_kernel_q_help1
  s_mov_b32 s10, 0x400000
  s_mov_b32 s11, 0x00020000
  v_lshrrev_b32 v20, 3, v2
  v_and_b32 v21, 7, v2
  v_lshrrev_b32 v22, 4, v2
  v_xor_b32 v23, v21, v22
  v_lshlrev_b32 v23, 4, v23
  v_lshl_add_u32 v24, v20, 11, v23
  v_xor_b32 v25, 64, v24
  s_lshl_b32 s35, s17, 2
  s_and_b32 s31, s16, 1
  s_add_u32 s35, s35, s31
  s_lshl_b32 s35, s35, 16
  s_and_b32 s29, s18, 12
  s_lshr_b32 s33, s17, 3
  s_lshl1_add_u32 s29, s33, s29
  s_lshl2_add_u32 s29, s17, s29
  s_and_b32 s29, s29, 15
  s_mov_b32 s22, 128
  s_mov_b32 s23, 131072
  s_mov_b32 s36, -1
  v_add_u32 v40, 0, v24
  v_add_u32 v41, 15360, v25
  v_add_u32 v42, 30720, v24
  v_add_u32 v43, 46080, v25
.fz_kernel_q_pc:
  s_mov_b32 s14, 0x600000
  s_mov_b32 s15, 0x00020000
  v_lshrrev_b32 v28, 3, v2
  v_and_b32 v29, 7, v2
  v_bfe_u32 v30, v2, 4, 1
  v_lshlrev_b32 v30, 1, v30
  v_xor_b32 v31, v29, v30
  v_lshlrev_b32 v31, 4, v31
  v_mul_u32_u24 v28, 6144, v28
  v_add_u32 v28, v28, v31
  v_xor_b32 v29, 64, v28
  s_lshl_b32 s32, s18, 7
  s_add_u32 s39, s32, 6291456
  s_mul_i32 s33, s29, 393216
  s_add_u32 s33, s33, s32
  s_lshl_b32 s29, s29, 1
  s_mul_i32 s25, s31, 6144
  s_add_u32 s25, s25, 65536
  s_mov_b32 s30, s25
  s_add_u32 s26, s25, 49152
  s_lshl_b32 s21, s31, 12
  s_cmp_eq_u32 s31, 0
  s_mov_b32 s24, 100352
  s_cselect_b32 s24, 0, s24
  v_add_u32 v32, s24, v28
  s_mov_b32 s24, 148480
  s_cselect_b32 s24, 48128, s24
  v_add_u32 v33, s24, v29
  s_mov_b32 s24, 2048
  s_cselect_b32 s24, 96256, s24
  v_add_u32 v34, s24, v28
  s_mov_b32 s24, 50176
  s_cselect_b32 s24, 144384, s24
  v_add_u32 v35, s24, v29
  s_mov_b32 s24, 102400
  s_cselect_b32 s24, 2048, s24
  v_add_u32 v36, s24, v28
  s_mov_b32 s24, 150528
  s_cselect_b32 s24, 50176, s24
  v_add_u32 v37, s24, v29
  s_cmp_lg_u32 s62, 0
  s_cbranch_scc1 .fz_kernel_q_st2
  s_waitcnt lgkmcnt(0)
  s_mov_b32 s34, 32
  s_call_b64 s[0:1], .fz_kernel_q_ix
  s_call_b64 s[0:1], .fz_kernel_q_iu
  s_call_b64 s[0:1], .fz_kernel_q_iu
  s_call_b64 s[0:1], .fz_kernel_q_iu
  s_waitcnt vmcnt(20)
  s_barrier
  s_call_b64 s[0:1], .fz_kernel_q_iu
  s_waitcnt vmcnt(24)
  s_barrier
  s_call_b64 s[0:1], .fz_kernel_q_iu
  s_branch .fz_kernel_q_pl
.fz_kernel_q_ix:
  s_bfe_u32 s24, s29, 0x40001
  s_mul_i32 s20, s24, s22
  s_bitcmp1_b32 s29, 0
  s_cselect_b32 s31, s23, 0
  s_add_u32 s20, s20, s35
  s_add_u32 s20, s20, s31
  s_bitcmp1_b32 s36, s24
  s_cbranch_scc0 .fz_kernel_xok1w
.fz_kernel_xok1:
  s_mov_b32 m0, s21
  s_add_u32 s21, s21, 8192
  s_and_b32 s21, s21, 0xffff
  s_add_u32 s29, s29, 1
  buffer_load_dwordx4 v40, s[8:11], s20 offen offset:0 lds
  buffer_load_dwordx4 v41, s[8:11], s20 offen offset:1024 lds
  buffer_load_dwordx4 v42, s[8:11], s20 offen offset:2048 lds
  buffer_load_dwordx4 v43, s[8:11], s20 offen offset:3072 lds
  s_setpc_b64 s[0:1]
.fz_kernel_q_iu:
  s_mov_b32 m0, s30
  s_add_u32 s30, s30, 12288
  buffer_load_dwordx4 v32, s[12:15], s33 offen offset:0 lds
  s_bfe_u32 s24, s29, 0x40001
  buffer_load_dwordx4 v33, s[12:15], s33 offen offset:1024 lds
  s_mul_i32 s20, s24, s22
  buffer_load_dwordx4 v34, s[12:15], s33 offen offset:2048 lds
  s_bitcmp1_b32 s29, 0
  s_cselect_b32 s31, s23, 0
  buffer_load_dwordx4 v35, s[12:15], s33 offen offset:3072 lds
  s_add_u32 m0, m0, 4096
  s_add_u32 s20, s20, s35
  buffer_load_dwordx4 v36, s[12:15], s33 offen offset:0 lds
  s_add_u32 s20, s20, s31
  buffer_load_dwordx4 v37, s[12:15], s33 offen offset:1024 lds
  s_bitcmp1_b32 s36, s24
  s_cbranch_scc0 .fz_kernel_xok2w
.fz_kernel_xok2:
  s_mov_b32 m0, s21
  s_add_u32 s21, s21, 8192
  s_and_b32 s21, s21, 0xffff
  s_add_u32 s29, s29, 1
  buffer_load_dwordx4 v40, s[8:11], s20 offen offset:0 lds
  s_add_u32 s33, s33, 196608
  s_cmp_eq_u32 s33, s39
  s_cselect_b32 s33, s32, s33
  buffer_load_dwordx4 v41, s[8:11], s20 offen offset:1024 lds
  s_cmp_eq_u32 s30, s26
  s_cselect_b32 s30, s25, s30
  buffer_load_dwordx4 v42, s[8:11], s20 offen offset:2048 lds
  s_sub_u32 s34, s34, 1
  s_cmp_lg_u32 s34, 0
  buffer_load_dwordx4 v43, s[8:11], s20 offen offset:3072 lds
  s_setpc_b64 s[0:1]
.fz_kernel_q_iw:
  s_mov_b32 m0, s30
  s_add_u32 s30, s30, 12288
  buffer_load_dwordx4 v32, s[12:15], s33 offen offset:0 lds
  s_nop 0
  buffer_load_dwordx4 v33, s[12:15], s33 offen offset:1024 lds
  s_nop 0
  buffer_load_dwordx4 v34, s[12:15], s33 offen offset:2048 lds
  s_nop 0
  buffer_load_dwordx4 v35, s[12:15], s33 offen offset:3072 lds
  s_add_u32 m0, m0, 4096
  s_nop 0
  buffer_load_dwordx4 v36, s[12:15], s33 offen offset:0 lds
  buffer_load_dwordx4 v37, s[12:15], s33 offen offset:1024 lds
  s_add_u32 s33, s33, 196608
  s_cmp_eq_u32 s33, s39
  s_cselect_b32 s33, s32, s33
  s_cmp_eq_u32 s30, s26
  s_cselect_b32 s30, s25, s30
  s_sub_u32 s34, s34, 1
  s_cmp_lg_u32 s34, 0
  s_setpc_b64 s[0:1]
.fz_kernel_q_st2:
  s_mov_b32 s34, 32
  s_waitcnt vmcnt(0)
  s_barrier
  s_call_b64 s[0:1], .fz_kernel_q_iw
  s_call_b64 s[0:1], .fz_kernel_q_iw
  s_call_b64 s[0:1], .fz_kernel_q_iw
  s_call_b64 s[0:1], .fz_kernel_q_iw
  s_call_b64 s[0:1], .fz_kernel_q_ix
  s_call_b64 s[0:1], .fz_kernel_q_ix
  s_mov_b64 exec, 1
  s_waitcnt vmcnt(20)
  ds_add_u32 v6, v5 offset:0x110
  s_mov_b64 exec, -1
  v_mov_b32 v12, 0x100
  s_call_b64 s[0:1], .fz_kernel_q_ix
  s_call_b64 s[0:1], .fz_kernel_q_ix
  s_waitcnt vmcnt(8)
  s_mov_b64 exec, 1
  ds_add_u32 v6, v12 offset:0x110
  s_mov_b64 exec, -1
  s_barrier
  s_waitcnt vmcnt(8)
  s_barrier
  s_call_b64 s[0:1], .fz_kernel_q_ix
  s_call_b64 s[0:1], .fz_kernel_q_iu
  s_waitcnt vmcnt(14)
  s_barrier
  s_call_b64 s[0:1], .fz_kernel_q_iu
  s_waitcnt vmcnt(20)
  s_barrier
  s_call_b64 s[0:1], .fz_kernel_q_iu
.fz_kernel_q_pl:
  s_waitcnt vmcnt(20)
  s_barrier
  s_mov_b32 m0, s30
  s_add_u32 s30, s30, 12288
  buffer_load_dwordx4 v32, s[12:15], s33 offen offset:0 lds
  s_bfe_u32 s24, s29, 0x40001
  buffer_load_dwordx4 v33, s[12:15], s33 offen offset:1024 lds
  s_mul_i32 s20, s24, s22
  buffer_load_dwordx4 v34, s[12:15], s33 offen offset:2048 lds
  s_bitcmp1_b32 s29, 0
  s_cselect_b32 s31, s23, 0
  buffer_load_dwordx4 v35, s[12:15], s33 offen offset:3072 lds
  s_add_u32 m0, m0, 4096
  s_add_u32 s20, s20, s35
  buffer_load_dwordx4 v36, s[12:15], s33 offen offset:0 lds
  s_add_u32 s20, s20, s31
  buffer_load_dwordx4 v37, s[12:15], s33 offen offset:1024 lds
  s_bitcmp1_b32 s36, s24
  s_cbranch_scc0 .fz_kernel_xok3w
.fz_kernel_xok3:
  s_mov_b32 m0, s21
  s_add_u32 s21, s21, 8192
  s_and_b32 s21, s21, 0xffff
  s_add_u32 s29, s29, 1
  buffer_load_dwordx4 v40, s[8:11], s20 offen offset:0 lds
  s_add_u32 s33, s33, 196608
  s_cmp_eq_u32 s33, s39
  s_cselect_b32 s33, s32, s33
  buffer_load_dwordx4 v41, s[8:11], s20 offen offset:1024 lds
  s_cmp_eq_u32 s30, s26
  s_cselect_b32 s30, s25, s30
  buffer_load_dwordx4 v42, s[8:11], s20 offen offset:2048 lds
  s_sub_u32 s34, s34, 1
  s_cmp_lg_u32 s34, 0
  buffer_load_dwordx4 v43, s[8:11], s20 offen offset:3072 lds
  s_cbranch_scc1 .fz_kernel_q_pl
  s_waitcnt vmcnt(20)
  s_barrier
  s_waitcnt vmcnt(10)
  s_barrier
  s_waitcnt vmcnt(0)
  s_barrier
  s_barrier
  s_branch .fz_kernel_serv
.fz_kernel_q_cons1:
  s_waitcnt lgkmcnt(0)
  s_mov_b32 s12, s42
  s_mov_b32 s13, s43
  s_mov_b32 s14, 0x600000
  s_mov_b32 s15, 0x00020000
  s_and_b32 s20, s18, 4
  s_add_u32 s20, s20, s16
  s_cmp_ge_u32 s20, 3
  s_cbranch_scc1 .fz_kernel_q_nsp
  s_and_b32 s20, s17, 7
  s_and_b32 s21, s18, 3
  s_lshl2_add_u32 s20, s20, s21
  s_mul_i32 s20, s20, 196608
  s_or_b32 s21, s18, 3
  s_lshl4_add_u32 s21, s16, s21
  s_lshl_b32 s21, s21, 7
  s_add_u32 s20, s20, s21
  v_mul_u32_u24 v20, 6144, v2
  s_mov_b32 exec_hi, 0
  buffer_load_dword v231, v20, s[12:15], s20 offen
  s_mov_b32 exec_hi, -1
.fz_kernel_q_nsp:
  v_lshlrev_b32 v20, 2, v0
  v_add_u32 v20, 159744, v20
  s_cmp_ge_u32 s16, 2
  s_cbranch_scc1 .fz_kernel_q_nz
  ds_write_b32 v20, v4
.fz_kernel_q_nz:
  s_lshr_b32 s26, s16, 1
  s_lshl_b32 s28, s26, 13
  v_and_b32 v20, 15, v2
  v_lshrrev_b32 v21, 4, v2
  v_bfe_u32 v22, v2, 1, 3
  v_xor_b32 v22, v22, v21
  v_lshlrev_b32 v20, 7, v20
  v_lshl_add_u32 v20, v22, 4, v20
  v_add_u32 v8, s28, v20
  v_xor_b32 v9, 64, v8
.fz_kernel_q_cs:
  s_and_b32 s27, s16, 1
  s_lshl_b32 s28, s27, 1
  v_lshrrev_b32 v14, 4, v2
  v_bfe_u32 v15, v2, 2, 2
  v_lshl_add_u32 v16, v14, 3, v15
  v_lshlrev_b32 v16, 7, v16
  v_and_b32 v14, 1, v14
  v_lshrrev_b32 v15, 1, v15
  v_lshl_add_u32 v14, v14, 1, v15
  v_xor_b32 v14, s28, v14
  v_lshl_add_u32 v16, v14, 5, v16
  v_and_b32 v14, 3, v2
  v_lshl_add_u32 v16, v14, 3, v16
  v_add_u32 v12, 65536, v16
  v_xor_b32 v13, 32, v12
  v_mov_b32 v10, v12
  v_mov_b32 v11, v13
  s_mov_b32 s29, 16
  s_mov_b32 s30, 0
  v_mov_b32 v128, 0
  v_mov_b32 v129, 0
  v_mov_b32 v130, 0
  v_mov_b32 v131, 0
  v_mov_b32 v132, 0
  v_mov_b32 v133, 0
  v_mov_b32 v134, 0
  v_mov_b32 v135, 0
  v_mov_b32 v136, 0
  v_mov_b32 v137, 0
  v_mov_b32 v138, 0
  v_mov_b32 v139, 0
  v_mov_b32 v140, 0
  v_mov_b32 v141, 0
  v_mov_b32 v142, 0
  v_mov_b32 v143, 0
  v_mov_b32 v144, 0
  v_mov_b32 v145, 0
  v_mov_b32 v146, 0
  v_mov_b32 v147, 0
  v_mov_b32 v148, 0
  v_mov_b32 v149, 0
  v_mov_b32 v150, 0
  v_mov_b32 v151, 0
  v_mov_b32 v152, 0
  v_mov_b32 v153, 0
  v_mov_b32 v154, 0
  v_mov_b32 v155, 0
  v_mov_b32 v156, 0
  v_mov_b32 v157, 0
  v_mov_b32 v158, 0
  v_mov_b32 v159, 0
  v_mov_b32 v160, 0
  v_mov_b32 v161, 0
  v_mov_b32 v162, 0
  v_mov_b32 v163, 0
  v_mov_b32 v164, 0
  v_mov_b32 v165, 0
  v_mov_b32 v166, 0
  v_mov_b32 v167, 0
  v_mov_b32 v168, 0
  v_mov_b32 v169, 0
  v_mov_b32 v170, 0
  v_mov_b32 v171, 0
  v_mov_b32 v172, 0
  v_mov_b32 v173, 0
  v_mov_b32 v174, 0
  v_mov_b32 v175, 0
  s_cmp_eq_u32 s62, 0
  s_cbranch_scc1 .fz_kernel_q_i1
  s_mov_b64 exec, 1
  s_waitcnt vmcnt(0)
  ds_add_u32 v1, v5 offset:0x100
  s_mov_b64 exec, -1
.fz_kernel_q_i1:
  v_mov_b32 v176, 0
  v_mov_b32 v177, 0
  v_mov_b32 v178, 0
  v_mov_b32 v179, 0
  v_mov_b32 v180, 0
  v_mov_b32 v181, 0
  v_mov_b32 v182, 0
  v_mov_b32 v183, 0
  v_mov_b32 v184, 0
  v_mov_b32 v185, 0
  v_mov_b32 v186, 0
  v_mov_b32 v187, 0
  v_mov_b32 v188, 0
  v_mov_b32 v189, 0
  v_mov_b32 v190, 0
  v_mov_b32 v191, 0
  v_mov_b32 v192, 0
  v_mov_b32 v193, 0
  v_mov_b32 v194, 0
  v_mov_b32 v195, 0
  v_mov_b32 v196, 0
  v_mov_b32 v197, 0
  v_mov_b32 v198, 0
  v_mov_b32 v199, 0
  v_mov_b32 v200, 0
  v_mov_b32 v201, 0
  v_mov_b32 v202, 0
  v_mov_b32 v203, 0
  v_mov_b32 v204, 0
  v_mov_b32 v205, 0
  v_mov_b32 v206, 0
  v_mov_b32 v207, 0
  v_mov_b32 v208, 0
  v_mov_b32 v209, 0
  v_mov_b32 v210, 0
  v_mov_b32 v211, 0
  v_mov_b32 v212, 0
  v_mov_b32 v213, 0
  v_mov_b32 v214, 0
  v_mov_b32 v215, 0
  v_mov_b32 v216, 0
  v_mov_b32 v217, 0
  v_mov_b32 v218, 0
  v_mov_b32 v219, 0
  v_mov_b32 v220, 0
  v_mov_b32 v221, 0
  v_mov_b32 v222, 0
  v_mov_b32 v223, 0
  v_and_b32 v14, 1, v2
  v_lshlrev_b32 v14, 4, v14
  v_mov_b32 v15, 0x3f80
  v_lshlrev_b32 v14, v14, v15
  v_mov_b32 v248, 0
  v_mov_b32 v249, 0
  v_mov_b32 v250, 0
  v_mov_b32 v251, 0
  v_mov_b32 v252, 0
  v_mov_b32 v253, 0
  v_mov_b32 v254, 0
  v_mov_b32 v255, 0
  s_mov_b32 exec_lo, 0x3
  s_mov_b32 exec_hi, 0x30
  v_mov_b32 v248, v14
  s_mov_b32 exec_lo, 0xc
  s_mov_b32 exec_hi, 0xc0
  v_mov_b32 v249, v14
  s_mov_b32 exec_lo, 0x300
  s_mov_b32 exec_hi, 0x3000
  v_mov_b32 v250, v14
  s_mov_b32 exec_lo, 0xc00
  s_mov_b32 exec_hi, 0xc000
  v_mov_b32 v251, v14
  s_mov_b32 exec_lo, 0x30000
  s_mov_b32 exec_hi, 0x300000
  v_mov_b32 v252, v14
  s_mov_b32 exec_lo, 0xc0000
  s_mov_b32 exec_hi, 0xc00000
  v_mov_b32 v253, v14
  s_mov_b32 exec_lo, 0x3000000
  s_mov_b32 exec_hi, 0x30000000
  v_mov_b32 v254, v14
  s_mov_b32 exec_lo, 0xc000000
  s_mov_b32 exec_hi, 0xc0000000
  v_mov_b32 v255, v14
  s_mov_b64 exec, -1
  s_mov_b32 s12, s40
  s_mov_b32 s13, s41
  s_mov_b32 s14, 0x400000
  s_mov_b32 s15, 0x00020000
  v_lshrrev_b32 v14, 5, v2
  v_and_b32 v15, 31, v2
  v_lshlrev_b32 v14, 4, v14
  v_lshl_add_u32 v15, v15, 11, v14
  s_lshl2_add_u32 s23, s17, s16
  s_lshl_b32 s23, s23, 16
  s_lshl_b32 s22, s18, 7
  s_add_u32 s23, s22, s23
  s_waitcnt lgkmcnt(0)
  s_barrier
  ds_read_b64_tr_b16 v[56:57], v10 offset:4096
  ds_read_b64_tr_b16 v[58:59], v10 offset:4608
  ds_read_b128 v[32:35], v8 offset:0
  ds_read_b128 v[36:39], v8 offset:2048
  ds_read_b128 v[40:43], v8 offset:4096
  ds_read_b128 v[44:47], v8 offset:6144
  ds_read_b64_tr_b16 v[60:61], v11 offset:4096
  ds_read_b64_tr_b16 v[62:63], v11 offset:4608
  ds_read_b64_tr_b16 v[64:65], v10 offset:8192
  ds_read_b64_tr_b16 v[66:67], v10 offset:8704
  ds_read_b64_tr_b16 v[68:69], v11 offset:8192
  ds_read_b64_tr_b16 v[70:71], v11 offset:8704
  ds_read_b64_tr_b16 v[48:49], v10 offset:0
  ds_read_b64_tr_b16 v[50:51], v10 offset:512
  ds_read_b64_tr_b16 v[52:53], v11 offset:0
  ds_read_b64_tr_b16 v[54:55], v11 offset:512
  s_add_u32 s30, s30, 12288
  s_cmp_eq_u32 s30, 49152
  s_cselect_b32 s30, 0, s30
  v_add_u32 v8, 0x4000, v8
  v_add_u32 v10, s30, v12
  v_add_u32 v11, s30, v13
  v_and_b32 v8, 0xffff, v8
  s_waitcnt lgkmcnt(0)
  s_branch .fz_kernel_q_l0
  .p2align 6
.fz_kernel_q_loop:
  v_mfma_f32_16x16x32_bf16 v[148:151], v[52:55], v[36:39], v[148:151]
  v_mfma_f32_16x16x32_bf16 v[152:155], v[52:55], v[40:43], v[152:155]
  s_waitcnt lgkmcnt(0)
  v_mfma_f32_16x16x32_bf16 v[156:159], v[52:55], v[44:47], v[156:159]
  s_barrier
  v_mfma_f32_16x16x32_bf16 v[160:163], v[96:99], v[72:75], v[160:163]
  ds_read_b64_tr_b16 v[56:57], v10 offset:4096
  v_mfma_f32_16x16x32_bf16 v[164:167], v[96:99], v[76:79], v[164:167]
  ds_read_b64_tr_b16 v[58:59], v10 offset:4608
  v_mfma_f32_16x16x32_bf16 v[168:171], v[96:99], v[80:83], v[168:171]
  ds_read_b128 v[32:35], v8 offset:0
  v_mfma_f32_16x16x32_bf16 v[172:175], v[96:99], v[84:87], v[172:175]
  ds_read_b128 v[36:39], v8 offset:2048
  v_mfma_f32_16x16x32_bf16 v[176:179], v[100:103], v[72:75], v[176:179]
  ds_read_b128 v[40:43], v8 offset:4096
  v_mfma_f32_16x16x32_bf16 v[180:183], v[100:103], v[76:79], v[180:183]
  ds_read_b128 v[44:47], v8 offset:6144
  v_mfma_f32_16x16x32_bf16 v[184:187], v[100:103], v[80:83], v[184:187]
  ds_read_b64_tr_b16 v[60:61], v11 offset:4096
  v_mfma_f32_16x16x32_bf16 v[188:191], v[100:103], v[84:87], v[188:191]
  ds_read_b64_tr_b16 v[62:63], v11 offset:4608
  v_mfma_f32_16x16x32_bf16 v[192:195], v[72:75], v[104:107], v[192:195]
  ds_read_b64_tr_b16 v[64:65], v10 offset:8192
  s_add_u32 s30, s30, 12288
  v_mfma_f32_16x16x32_bf16 v[196:199], v[76:79], v[104:107], v[196:199]
  ds_read_b64_tr_b16 v[66:67], v10 offset:8704
  s_cmp_eq_u32 s30, 49152
  v_mfma_f32_16x16x32_bf16 v[200:203], v[80:83], v[104:107], v[200:203]
  ds_read_b64_tr_b16 v[68:69], v11 offset:8192
  s_cselect_b32 s30, 0, s30
  v_mfma_f32_16x16x32_bf16 v[204:207], v[84:87], v[104:107], v[204:207]
  ds_read_b64_tr_b16 v[70:71], v11 offset:8704
  v_mfma_f32_16x16x32_bf16 v[208:211], v[72:75], v[108:111], v[208:211]
  ds_read_b64_tr_b16 v[48:49], v10 offset:0
  v_mfma_f32_16x16x32_bf16 v[212:215], v[76:79], v[108:111], v[212:215]
  ds_read_b64_tr_b16 v[50:51], v10 offset:512
  v_mfma_f32_16x16x32_bf16 v[216:219], v[80:83], v[108:111], v[216:219]
  ds_read_b64_tr_b16 v[52:53], v11 offset:0
  v_mfma_f32_16x16x32_bf16 v[220:223], v[84:87], v[108:111], v[220:223]
  ds_read_b64_tr_b16 v[54:55], v11 offset:512
  v_mfma_f32_16x16x32_bf16 v[128:131], v[88:91], v[72:75], v[128:131]
  v_add_u32 v8, 0x4000, v8
  v_mfma_f32_16x16x32_bf16 v[132:135], v[88:91], v[76:79], v[132:135]
  v_add_u32 v10, s30, v12
  v_mfma_f32_16x16x32_bf16 v[136:139], v[88:91], v[80:83], v[136:139]
  v_add_u32 v11, s30, v13
  v_mfma_f32_16x16x32_bf16 v[140:143], v[88:91], v[84:87], v[140:143]
  v_and_b32 v8, 0xffff, v8
  v_mfma_f32_16x16x32_bf16 v[144:147], v[92:95], v[72:75], v[144:147]
  v_mfma_f32_16x16x32_bf16 v[148:151], v[92:95], v[76:79], v[148:151]
  v_mfma_f32_16x16x32_bf16 v[152:155], v[92:95], v[80:83], v[152:155]
  s_waitcnt lgkmcnt(0)
  v_mfma_f32_16x16x32_bf16 v[156:159], v[92:95], v[84:87], v[156:159]
.fz_kernel_q_l0:
  s_barrier
  v_mfma_f32_16x16x32_bf16 v[160:163], v[56:59], v[32:35], v[160:163]
  ds_read_b64_tr_b16 v[96:97], v10 offset:4096
  v_mfma_f32_16x16x32_bf16 v[164:167], v[56:59], v[36:39], v[164:167]
  ds_read_b64_tr_b16 v[98:99], v10 offset:4608
  v_mfma_f32_16x16x32_bf16 v[168:171], v[56:59], v[40:43], v[168:171]
  ds_read_b128 v[72:75], v9 offset:0
  v_mfma_f32_16x16x32_bf16 v[172:175], v[56:59], v[44:47], v[172:175]
  ds_read_b128 v[76:79], v9 offset:2048
  v_mfma_f32_16x16x32_bf16 v[176:179], v[60:63], v[32:35], v[176:179]
  ds_read_b128 v[80:83], v9 offset:4096
  v_mfma_f32_16x16x32_bf16 v[180:183], v[60:63], v[36:39], v[180:183]
  ds_read_b128 v[84:87], v9 offset:6144
  v_mfma_f32_16x16x32_bf16 v[184:187], v[60:63], v[40:43], v[184:187]
  ds_read_b64_tr_b16 v[100:101], v11 offset:4096
  v_mfma_f32_16x16x32_bf16 v[188:191], v[60:63], v[44:47], v[188:191]
  ds_read_b64_tr_b16 v[102:103], v11 offset:4608
  v_mfma_f32_16x16x32_bf16 v[192:195], v[32:35], v[64:67], v[192:195]
  ds_read_b64_tr_b16 v[104:105], v10 offset:8192
  s_add_u32 s30, s30, 12288
  v_mfma_f32_16x16x32_bf16 v[196:199], v[36:39], v[64:67], v[196:199]
  ds_read_b64_tr_b16 v[106:107], v10 offset:8704
  s_cmp_eq_u32 s30, 49152
  v_mfma_f32_16x16x32_bf16 v[200:203], v[40:43], v[64:67], v[200:203]
  ds_read_b64_tr_b16 v[108:109], v11 offset:8192
  s_cselect_b32 s30, 0, s30
  v_mfma_f32_16x16x32_bf16 v[204:207], v[44:47], v[64:67], v[204:207]
  ds_read_b64_tr_b16 v[110:111], v11 offset:8704
  s_sub_u32 s29, s29, 1
  v_mfma_f32_16x16x32_bf16 v[208:211], v[32:35], v[68:71], v[208:211]
  ds_read_b64_tr_b16 v[88:89], v10 offset:0
  s_cmp_lg_u32 s29, 0
  v_mfma_f32_16x16x32_bf16 v[212:215], v[36:39], v[68:71], v[212:215]
  ds_read_b64_tr_b16 v[90:91], v10 offset:512
  v_mfma_f32_16x16x32_bf16 v[216:219], v[40:43], v[68:71], v[216:219]
  ds_read_b64_tr_b16 v[92:93], v11 offset:0
  v_mfma_f32_16x16x32_bf16 v[220:223], v[44:47], v[68:71], v[220:223]
  ds_read_b64_tr_b16 v[94:95], v11 offset:512
  v_mfma_f32_16x16x32_bf16 v[128:131], v[48:51], v[32:35], v[128:131]
  v_add_u32 v9, 0x4000, v9
  v_mfma_f32_16x16x32_bf16 v[132:135], v[48:51], v[36:39], v[132:135]
  v_add_u32 v10, s30, v12
  v_mfma_f32_16x16x32_bf16 v[136:139], v[48:51], v[40:43], v[136:139]
  v_add_u32 v11, s30, v13
  v_mfma_f32_16x16x32_bf16 v[140:143], v[48:51], v[44:47], v[140:143]
  v_and_b32 v9, 0xffff, v9
  v_mfma_f32_16x16x32_bf16 v[144:147], v[52:55], v[32:35], v[144:147]
  s_cbranch_scc1 .fz_kernel_q_loop
  v_mfma_f32_16x16x32_bf16 v[148:151], v[52:55], v[36:39], v[148:151]
  v_mfma_f32_16x16x32_bf16 v[152:155], v[52:55], v[40:43], v[152:155]
  s_waitcnt lgkmcnt(0)
  v_mfma_f32_16x16x32_bf16 v[156:159], v[52:55], v[44:47], v[156:159]
  s_cmp_lg_u32 s62, 0
  s_cbranch_scc1 .fz_kernel_q_nr
  buffer_load_dwordx4 v[232:235], v15, s[12:15], s23 offen offset:0
  buffer_load_dwordx4 v[236:239], v15, s[12:15], s23 offen offset:32
  buffer_load_dwordx4 v[240:243], v15, s[12:15], s23 offen offset:64
  buffer_load_dwordx4 v[244:247], v15, s[12:15], s23 offen offset:96
.fz_kernel_q_nr:
  s_barrier
  v_mfma_f32_16x16x32_bf16 v[160:163], v[96:99], v[72:75], v[160:163]
  s_lshl_b32 s31, s26, 8
  s_add_u32 s31, s31, 155648
  v_and_b32 v14, 15, v2
  v_and_b32 v15, 48, v2
  v_mfma_f32_16x16x32_bf16 v[164:167], v[96:99], v[76:79], v[164:167]
  s_lshl_b32 s33, s27, 7
  s_add_u32 s33, s33, 155648
  v_lshlrev_b32 v14, 2, v14
  v_mov_b32 v1, 159952
  v_mfma_f32_16x16x32_bf16 v[168:171], v[96:99], v[80:83], v[168:171]
  v_add_u32 v29, s33, v14
  v_add_u32 v14, s31, v14
  v_mfma_f32_16x16x32_bf16 v[172:175], v[96:99], v[84:87], v[172:175]
  v_add_u32 v28, s33, v15
  v_add_u32 v15, s31, v15
  v_mfma_f32_16x16x32_bf16 v[176:179], v[100:103], v[72:75], v[176:179]
  ds_read_b32 v1, v1
  v_add_u32 v64, 4608, v14
  v_mfma_f32_16x16x32_bf16 v[180:183], v[100:103], v[76:79], v[180:183]
  ds_read_b128 v[120:123], v28 offset:5888
  v_mfma_f32_16x16x32_bf16 v[184:187], v[100:103], v[80:83], v[184:187]
  ds_read_b128 v[124:127], v28 offset:5952
  v_mfma_f32_16x16x32_bf16 v[188:191], v[100:103], v[84:87], v[188:191]
  ds_read2_b32 v[224:225], v64 offset0:0 offset1:128
  v_mfma_f32_16x16x32_bf16 v[192:195], v[72:75], v[104:107], v[192:195]
  ds_read2_b32 v[226:227], v64 offset0:16 offset1:144
  v_mfma_f32_16x16x32_bf16 v[196:199], v[76:79], v[104:107], v[196:199]
  ds_read2_b32 v[228:229], v64 offset0:32 offset1:160
  v_mfma_f32_16x16x32_bf16 v[200:203], v[80:83], v[104:107], v[200:203]
  ds_read2_b32 v[230:231], v64 offset0:48 offset1:176
  v_mfma_f32_16x16x32_bf16 v[204:207], v[84:87], v[104:107], v[204:207]
  ds_read_b32 v24, v29 offset:6144
  v_mfma_f32_16x16x32_bf16 v[208:211], v[72:75], v[108:111], v[208:211]
  ds_read_b32 v26, v29 offset:6208
  v_mfma_f32_16x16x32_bf16 v[212:215], v[76:79], v[108:111], v[212:215]
  ds_read_b128 v[32:35], v15 offset:4608
  ds_read_b128 v[48:51], v15 offset:5120
  v_mfma_f32_16x16x32_bf16 v[216:219], v[80:83], v[108:111], v[216:219]
  ds_read_b128 v[36:39], v15 offset:4672
  ds_read_b128 v[52:55], v15 offset:5184
  v_mfma_f32_16x16x32_bf16 v[220:223], v[84:87], v[108:111], v[220:223]
  ds_read_b128 v[40:43], v15 offset:4736
  ds_read_b128 v[56:59], v15 offset:5248
  v_mfma_f32_16x16x32_bf16 v[128:131], v[88:91], v[72:75], v[128:131]
  ds_read_b128 v[44:47], v15 offset:4800
  ds_read_b128 v[60:63], v15 offset:5312
  v_mfma_f32_16x16x32_bf16 v[132:135], v[88:91], v[76:79], v[132:135]
  ds_read_b128 v[112:115], v28 offset:5632
  ds_read_b128 v[116:119], v28 offset:5696
  v_mfma_f32_16x16x32_bf16 v[136:139], v[88:91], v[80:83], v[136:139]
  s_lshl1_add_u32 s34, s18, s27
  s_lshl4_add_u32 s34, s34, s17
  s_lshl1_add_u32 s34, s34, s26
  v_mfma_f32_16x16x32_bf16 v[140:143], v[88:91], v[84:87], v[140:143]
  s_lshl_b32 s36, s34, 13
  s_add_u32 s36, s36, s63
  s_add_u32 s37, s36, 4096
  v_mfma_f32_16x16x32_bf16 v[144:147], v[92:95], v[72:75], v[144:147]
  s_lshl_b32 s34, s16, 12
  s_add_u32 s34, s34, 131072
  v_add_u32 v9, s34, v3
  v_mfma_f32_16x16x32_bf16 v[148:151], v[92:95], v[76:79], v[148:151]
  v_xor_b32 v8, 8192, v9
  v_mfma_f32_16x16x32_bf16 v[152:155], v[92:95], v[80:83], v[152:155]
  v_mfma_f32_16x16x32_bf16 v[156:159], v[92:95], v[84:87], v[156:159]
  s_waitcnt lgkmcnt(12)
  v_add_u32 v1, -1, v1
  v_lshrrev_b32 v1, 6, v1
  v_cmp_eq_u32 vcc, s26, v1
  s_cbranch_vccnz .fz_kernel_q_patch
.fz_kernel_q_pback:
  v_pk_mul_f32 v[64:65], v[120:121], v[224:225] op_sel:[0,1] op_sel_hi:[1,1]
  v_pk_fma_f32 v[160:161], v[160:161], v[224:225], v[64:65] op_sel_hi:[1,0,1]
  v_pk_mul_f32 v[66:67], v[122:123], v[224:225] op_sel:[0,1] op_sel_hi:[1,1]
  v_pk_fma_f32 v[162:163], v[162:163], v[224:225], v[66:67] op_sel_hi:[1,0,1]
  v_pk_mul_f32 v[68:69], v[124:125], v[224:225] op_sel:[0,1] op_sel_hi:[1,1]
  v_pk_fma_f32 v[176:177], v[176:177], v[224:225], v[68:69] op_sel_hi:[1,0,1]
  v_pk_mul_f32 v[70:71], v[126:127], v[224:225] op_sel:[0,1] op_sel_hi:[1,1]
  v_pk_fma_f32 v[178:179], v[178:179], v[224:225], v[70:71] op_sel_hi:[1,0,1]
  v_cvt_pk_bf16_f32 v80, v160, v161
  v_cvt_pk_bf16_f32 v81, v162, v163
  v_cvt_pk_bf16_f32 v82, v176, v177
  v_cvt_pk_bf16_f32 v83, v178, v179
  v_pk_mul_f32 v[64:65], v[120:121], v[226:227] op_sel:[0,1] op_sel_hi:[1,1]
  v_pk_fma_f32 v[164:165], v[164:165], v[226:227], v[64:65] op_sel_hi:[1,0,1]
  v_pk_mul_f32 v[66:67], v[122:123], v[226:227] op_sel:[0,1] op_sel_hi:[1,1]
  v_pk_fma_f32 v[166:167], v[166:167], v[226:227], v[66:67] op_sel_hi:[1,0,1]
  v_pk_mul_f32 v[68:69], v[124:125], v[226:227] op_sel:[0,1] op_sel_hi:[1,1]
  v_pk_fma_f32 v[180:181], v[180:181], v[226:227], v[68:69] op_sel_hi:[1,0,1]
  v_pk_mul_f32 v[70:71], v[126:127], v[226:227] op_sel:[0,1] op_sel_hi:[1,1]
  v_pk_fma_f32 v[182:183], v[182:183], v[226:227], v[70:71] op_sel_hi:[1,0,1]
  v_cvt_pk_bf16_f32 v84, v164, v165
  v_cvt_pk_bf16_f32 v85, v166, v167
  v_cvt_pk_bf16_f32 v86, v180, v181
  v_cvt_pk_bf16_f32 v87, v182, v183
  v_permlane16_swap_b32 v80, v84
  v_permlane16_swap_b32 v81, v85
  v_permlane16_swap_b32 v82, v86
  v_permlane16_swap_b32 v83, v87
  buffer_store_dwordx4 v[80:83], v3, s[4:7], s36 offen offset:0 sc1
  buffer_store_dwordx4 v[84:87], v3, s[4:7], s36 offen offset:1024 sc1
  v_pk_mul_f32 v[64:65], v[120:121], v[228:229] op_sel:[0,1] op_sel_hi:[1,1]
  v_pk_fma_f32 v[168:169], v[168:169], v[228:229], v[64:65] op_sel_hi:[1,0,1]
  v_pk_mul_f32 v[66:67], v[122:123], v[228:229] op_sel:[0,1] op_sel_hi:[1,1]
  v_pk_fma_f32 v[170:171], v[170:171], v[228:229], v[66:67] op_sel_hi:[1,0,1]
  v_pk_mul_f32 v[68:69], v[124:125], v[228:229] op_sel:[0,1] op_sel_hi:[1,1]
  v_pk_fma_f32 v[184:185], v[184:185], v[228:229], v[68:69] op_sel_hi:[1,0,1]
  v_pk_mul_f32 v[70:71], v[126:127], v[228:229] op_sel:[0,1] op_sel_hi:[1,1]
  v_pk_fma_f32 v[186:187], v[186:187], v[228:229], v[70:71] op_sel_hi:[1,0,1]
  v_cvt_pk_bf16_f32 v96, v168, v169
  v_cvt_pk_bf16_f32 v97, v170, v171
  v_cvt_pk_bf16_f32 v98, v184, v185
  v_cvt_pk_bf16_f32 v99, v186, v187
  v_pk_mul_f32 v[64:65], v[120:121], v[230:231] op_sel:[0,1] op_sel_hi:[1,1]
  v_pk_fma_f32 v[172:173], v[172:173], v[230:231], v[64:65] op_sel_hi:[1,0,1]
  v_pk_mul_f32 v[66:67], v[122:123], v[230:231] op_sel:[0,1] op_sel_hi:[1,1]
  v_pk_fma_f32 v[174:175], v[174:175], v[230:231], v[66:67] op_sel_hi:[1,0,1]
  v_pk_mul_f32 v[68:69], v[124:125], v[230:231] op_sel:[0,1] op_sel_hi:[1,1]
  v_pk_fma_f32 v[188:189], v[188:189], v[230:231], v[68:69] op_sel_hi:[1,0,1]
  v_pk_mul_f32 v[70:71], v[126:127], v[230:231] op_sel:[0,1] op_sel_hi:[1,1]
  v_pk_fma_f32 v[190:191], v[190:191], v[230:231], v[70:71] op_sel_hi:[1,0,1]
  v_cvt_pk_bf16_f32 v100, v172, v173
  v_cvt_pk_bf16_f32 v101, v174, v175
  v_cvt_pk_bf16_f32 v102, v188, v189
  v_cvt_pk_bf16_f32 v103, v190, v191
  v_permlane16_swap_b32 v96, v100
  v_permlane16_swap_b32 v97, v101
  v_permlane16_swap_b32 v98, v102
  v_permlane16_swap_b32 v99, v103
  buffer_store_dwordx4 v[96:99], v3, s[4:7], s37 offen offset:0 sc1
  buffer_store_dwordx4 v[100:103], v3, s[4:7], s37 offen offset:1024 sc1
  s_waitcnt lgkmcnt(0)
  v_pk_mul_f32 v[64:65], v[48:49], v[24:25] op_sel_hi:[1,0]
  v_pk_fma_f32 v[192:193], v[192:193], v[32:33], v[64:65]
  v_pk_mul_f32 v[66:67], v[50:51], v[24:25] op_sel_hi:[1,0]
  v_pk_fma_f32 v[194:195], v[194:195], v[34:35], v[66:67]
  v_pk_mul_f32 v[68:69], v[48:49], v[26:27] op_sel_hi:[1,0]
  v_pk_fma_f32 v[208:209], v[208:209], v[32:33], v[68:69]
  v_pk_mul_f32 v[70:71], v[50:51], v[26:27] op_sel_hi:[1,0]
  v_pk_fma_f32 v[210:211], v[210:211], v[34:35], v[70:71]
  v_cvt_pk_bf16_f32 v88, v192, v193
  v_cvt_pk_bf16_f32 v90, v208, v209
  v_cvt_pk_bf16_f32 v89, v194, v195
  v_cvt_pk_bf16_f32 v91, v210, v211
  v_pk_mul_f32 v[64:65], v[52:53], v[24:25] op_sel_hi:[1,0]
  v_pk_fma_f32 v[196:197], v[196:197], v[36:37], v[64:65]
  v_pk_mul_f32 v[66:67], v[54:55], v[24:25] op_sel_hi:[1,0]
  v_pk_fma_f32 v[198:199], v[198:199], v[38:39], v[66:67]
  v_pk_mul_f32 v[68:69], v[52:53], v[26:27] op_sel_hi:[1,0]
  v_pk_fma_f32 v[212:213], v[212:213], v[36:37], v[68:69]
  v_pk_mul_f32 v[70:71], v[54:55], v[26:27] op_sel_hi:[1,0]
  v_pk_fma_f32 v[214:215], v[214:215], v[38:39], v[70:71]
  v_cvt_pk_bf16_f32 v92, v196, v197
  v_cvt_pk_bf16_f32 v94, v212, v213
  v_cvt_pk_bf16_f32 v93, v198, v199
  v_cvt_pk_bf16_f32 v95, v214, v215
  v_permlane16_swap_b32 v88, v90
  v_permlane16_swap_b32 v89, v91
  v_permlane16_swap_b32 v92, v94
  v_permlane16_swap_b32 v93, v95
  v_permlane32_swap_b32 v88, v90
  v_permlane32_swap_b32 v89, v91
  v_permlane32_swap_b32 v92, v94
  v_permlane32_swap_b32 v93, v95
  buffer_store_dwordx4 v[88:91], v3, s[4:7], s36 offen offset:2048 sc1
  buffer_store_dwordx4 v[92:95], v3, s[4:7], s36 offen offset:3072 sc1
  v_pk_mul_f32 v[64:65], v[56:57], v[24:25] op_sel_hi:[1,0]
  v_pk_fma_f32 v[200:201], v[200:201], v[40:41], v[64:65]
  v_pk_mul_f32 v[66:67], v[58:59], v[24:25] op_sel_hi:[1,0]
  v_pk_fma_f32 v[202:203], v[202:203], v[42:43], v[66:67]
  v_pk_mul_f32 v[68:69], v[56:57], v[26:27] op_sel_hi:[1,0]
  v_pk_fma_f32 v[216:217], v[216:217], v[40:41], v[68:69]
  v_pk_mul_f32 v[70:71], v[58:59], v[26:27] op_sel_hi:[1,0]
  v_pk_fma_f32 v[218:219], v[218:219], v[42:43], v[70:71]
  v_cvt_pk_bf16_f32 v104, v200, v201
  v_cvt_pk_bf16_f32 v106, v216, v217
  v_cvt_pk_bf16_f32 v105, v202, v203
  v_cvt_pk_bf16_f32 v107, v218, v219
  v_pk_mul_f32 v[64:65], v[60:61], v[24:25] op_sel_hi:[1,0]
  v_pk_fma_f32 v[204:205], v[204:205], v[44:45], v[64:65]
  v_pk_mul_f32 v[66:67], v[62:63], v[24:25] op_sel_hi:[1,0]
  v_pk_fma_f32 v[206:207], v[206:207], v[46:47], v[66:67]
  v_pk_mul_f32 v[68:69], v[60:61], v[26:27] op_sel_hi:[1,0]
  v_pk_fma_f32 v[220:221], v[220:221], v[44:45], v[68:69]
  v_pk_mul_f32 v[70:71], v[62:63], v[26:27] op_sel_hi:[1,0]
  v_pk_fma_f32 v[222:223], v[222:223], v[46:47], v[70:71]
  v_cvt_pk_bf16_f32 v108, v204, v205
  v_cvt_pk_bf16_f32 v110, v220, v221
  v_cvt_pk_bf16_f32 v109, v206, v207
  v_cvt_pk_bf16_f32 v111, v222, v223
  v_permlane16_swap_b32 v104, v106
  v_permlane16_swap_b32 v105, v107
  v_permlane16_swap_b32 v108, v110
  v_permlane16_swap_b32 v109, v111
  v_permlane32_swap_b32 v104, v106
  v_permlane32_swap_b32 v105, v107
  v_permlane32_swap_b32 v108, v110
  v_permlane32_swap_b32 v109, v111
  buffer_store_dwordx4 v[104:107], v3, s[4:7], s37 offen offset:2048 sc1
  buffer_store_dwordx4 v[108:111], v3, s[4:7], s37 offen offset:3072 sc1
  v_mul_f32 v224, 0.25503486164919736, v224
  v_mul_f32 v225, 0.25503486164919736, v225
  v_mul_f32 v226, 0.25503486164919736, v226
  v_mul_f32 v227, 0.25503486164919736, v227
  v_mul_f32 v228, 0.25503486164919736, v228
  v_mul_f32 v229, 0.25503486164919736, v229
  v_mul_f32 v230, 0.25503486164919736, v230
  v_mul_f32 v231, 0.25503486164919736, v231
  v_pk_mul_f32 v[64:65], v[112:113], v[224:225] op_sel:[0,1] op_sel_hi:[1,1]
  v_pk_fma_f32 v[128:129], v[128:129], v[224:225], v[64:65] op_sel_hi:[1,0,1]
  v_pk_mul_f32 v[66:67], v[114:115], v[224:225] op_sel:[0,1] op_sel_hi:[1,1]
  v_pk_fma_f32 v[130:131], v[130:131], v[224:225], v[66:67] op_sel_hi:[1,0,1]
  v_pk_mul_f32 v[68:69], v[116:117], v[224:225] op_sel:[0,1] op_sel_hi:[1,1]
  v_pk_fma_f32 v[144:145], v[144:145], v[224:225], v[68:69] op_sel_hi:[1,0,1]
  v_pk_mul_f32 v[70:71], v[118:119], v[224:225] op_sel:[0,1] op_sel_hi:[1,1]
  v_pk_fma_f32 v[146:147], v[146:147], v[224:225], v[70:71] op_sel_hi:[1,0,1]
  v_cvt_pk_bf16_f32 v16, v128, v129
  v_cvt_pk_bf16_f32 v17, v130, v131
  v_cvt_pk_bf16_f32 v18, v144, v145
  v_cvt_pk_bf16_f32 v19, v146, v147
  v_pk_mul_f32 v[64:65], v[112:113], v[226:227] op_sel:[0,1] op_sel_hi:[1,1]
  v_pk_fma_f32 v[132:133], v[132:133], v[226:227], v[64:65] op_sel_hi:[1,0,1]
  v_pk_mul_f32 v[66:67], v[114:115], v[226:227] op_sel:[0,1] op_sel_hi:[1,1]
  v_pk_fma_f32 v[134:135], v[134:135], v[226:227], v[66:67] op_sel_hi:[1,0,1]
  v_pk_mul_f32 v[68:69], v[116:117], v[226:227] op_sel:[0,1] op_sel_hi:[1,1]
  v_pk_fma_f32 v[148:149], v[148:149], v[226:227], v[68:69] op_sel_hi:[1,0,1]
  v_pk_mul_f32 v[70:71], v[118:119], v[226:227] op_sel:[0,1] op_sel_hi:[1,1]
  v_pk_fma_f32 v[150:151], v[150:151], v[226:227], v[70:71] op_sel_hi:[1,0,1]
  v_cvt_pk_bf16_f32 v20, v132, v133
  v_cvt_pk_bf16_f32 v21, v134, v135
  v_cvt_pk_bf16_f32 v22, v148, v149
  v_cvt_pk_bf16_f32 v23, v150, v151
  v_permlane16_swap_b32 v16, v20
  v_permlane16_swap_b32 v17, v21
  v_permlane16_swap_b32 v18, v22
  v_permlane16_swap_b32 v19, v23
  ds_write_b128 v8, v[16:19] offset:0
  ds_write_b128 v8, v[20:23] offset:1024
  v_pk_mul_f32 v[64:65], v[112:113], v[228:229] op_sel:[0,1] op_sel_hi:[1,1]
  v_pk_fma_f32 v[136:137], v[136:137], v[228:229], v[64:65] op_sel_hi:[1,0,1]
  v_pk_mul_f32 v[66:67], v[114:115], v[228:229] op_sel:[0,1] op_sel_hi:[1,1]
  v_pk_fma_f32 v[138:139], v[138:139], v[228:229], v[66:67] op_sel_hi:[1,0,1]
  v_pk_mul_f32 v[68:69], v[116:117], v[228:229] op_sel:[0,1] op_sel_hi:[1,1]
  v_pk_fma_f32 v[152:153], v[152:153], v[228:229], v[68:69] op_sel_hi:[1,0,1]
  v_pk_mul_f32 v[70:71], v[118:119], v[228:229] op_sel:[0,1] op_sel_hi:[1,1]
  v_pk_fma_f32 v[154:155], v[154:155], v[228:229], v[70:71] op_sel_hi:[1,0,1]
  v_cvt_pk_bf16_f32 v24, v136, v137
  v_cvt_pk_bf16_f32 v25, v138, v139
  v_cvt_pk_bf16_f32 v26, v152, v153
  v_cvt_pk_bf16_f32 v27, v154, v155
  v_pk_mul_f32 v[64:65], v[112:113], v[230:231] op_sel:[0,1] op_sel_hi:[1,1]
  v_pk_fma_f32 v[140:141], v[140:141], v[230:231], v[64:65] op_sel_hi:[1,0,1]
  v_pk_mul_f32 v[66:67], v[114:115], v[230:231] op_sel:[0,1] op_sel_hi:[1,1]
  v_pk_fma_f32 v[142:143], v[142:143], v[230:231], v[66:67] op_sel_hi:[1,0,1]
  v_pk_mul_f32 v[68:69], v[116:117], v[230:231] op_sel:[0,1] op_sel_hi:[1,1]
  v_pk_fma_f32 v[156:157], v[156:157], v[230:231], v[68:69] op_sel_hi:[1,0,1]
  v_pk_mul_f32 v[70:71], v[118:119], v[230:231] op_sel:[0,1] op_sel_hi:[1,1]
  v_pk_fma_f32 v[158:159], v[158:159], v[230:231], v[70:71] op_sel_hi:[1,0,1]
  v_cvt_pk_bf16_f32 v28, v140, v141
  v_cvt_pk_bf16_f32 v29, v142, v143
  v_cvt_pk_bf16_f32 v30, v156, v157
  v_cvt_pk_bf16_f32 v31, v158, v159
  v_permlane16_swap_b32 v24, v28
  v_permlane16_swap_b32 v25, v29
  v_permlane16_swap_b32 v26, v30
  v_permlane16_swap_b32 v27, v31
  ds_write_b128 v8, v[24:27] offset:2048
  ds_write_b128 v8, v[28:31] offset:3072
  s_branch .fz_kernel_att
.fz_kernel_q_help1:
  s_waitcnt lgkmcnt(0)
  s_mov_b32 s3, 32
  s_cmp_eq_u32 s16, 7
  s_cbranch_scc1 .fz_kernel_q_h7
  s_getpc_b64 s[0:1]
.fz_kernel_ct4:
  s_sub_u32 s0, s0, .fz_kernel_ct4-fz_kernel
  s_subb_u32 s1, s1, 0
  s_lshr_b32 s31, s2, 3
  s_mulk_i32 s31, 0x500
  v_lshl_add_u32 v1, v2, 7, s31
  v_min_u32 v1, .fz_kernel_last-fz_kernel, v1
  s_mov_b64 exec, 0x3ff
  global_load_dword v1, v1, s[0:1]
  s_mov_b64 exec, -1
.fz_kernel_ct4e:
  s_mov_b32 s12, s58
  s_mov_b32 s13, s59
  s_mov_b32 s14, 0x100
  s_mov_b32 s15, 0x00020000
  s_mov_b32 s30, 0
  s_and_b32 s31, s18, 3
  s_sub_u32 s31, s31, s30
  s_and_b32 s30, s31, 3
  s_lshl_b32 s30, s30, 14
  v_and_b32 v20, 15, v2
  v_lshrrev_b32 v21, 4, v2
  v_bfe_u32 v22, v2, 1, 3
  v_xor_b32 v22, v22, v21
  v_lshlrev_b32 v21, 7, v20
  v_lshl_add_u32 v21, v22, 4, v21
  v_add_u32 v21, s30, v21
  v_xor_b32 v22, 64, v21
  v_lshlrev_b32 v20, 3, v20
  s_lshl_b32 s30, s17, 10
  s_add_u32 s30, s30, 0x1808000
  s_mov_b32 exec_lo, 0x00f0000f
  s_mov_b32 exec_hi, 0xf0000f00
  v_add_u32 v20, 4, v20
  s_mov_b64 exec, -1
  v_mov_b32 v24, 0x3f803f80
  v_mov_b32 v25, v24
  v_mov_b32 v26, v24
  v_mov_b32 v27, v24
  s_lshl_b32 s31, s31, 1
  s_sub_u32 s31, 31, s31
  v_lshlrev_b32 v52, 3, v2
  v_add_u32 v52, 155648, v52
  v_mov_b32 v54, 1.0
  v_mov_b32 v55, 1.0
  v_mov_b32 v56, 0
  v_mov_b32 v57, 0
  ds_write_b64 v52, v[54:55] offset:6400
  ds_write_b64 v52, v[56:57] offset:6912
  s_mov_b32 s20, s48
  s_mov_b32 s21, s49
  s_mov_b32 s22, 0x800
  s_mov_b32 s23, 0x00020000
  v_lshlrev_b32 v40, 5, v2
  buffer_load_dwordx4 v[44:47], v40, s[20:23], 0 offen
  buffer_load_dwordx4 v[48:51], v40, s[20:23], 0 offen offset:16
  v_mov_b32 v40, 0
  s_waitcnt vmcnt(0)
  v_lshlrev_b32 v41, 16, v44
  v_and_b32 v42, 0xffff0000, v44
  v_add_f32 v40, v40, v41
  v_add_f32 v40, v40, v42
  v_lshlrev_b32 v41, 16, v45
  v_and_b32 v42, 0xffff0000, v45
  v_add_f32 v40, v40, v41
  v_add_f32 v40, v40, v42
  v_lshlrev_b32 v41, 16, v46
  v_and_b32 v42, 0xffff0000, v46
  v_add_f32 v40, v40, v41
  v_add_f32 v40, v40, v42
  v_lshlrev_b32 v41, 16, v47
  v_and_b32 v42, 0xffff0000, v47
  v_add_f32 v40, v40, v41
  v_add_f32 v40, v40, v42
  v_lshlrev_b32 v41, 16, v48
  v_and_b32 v42, 0xffff0000, v48
  v_add_f32 v40, v40, v41
  v_add_f32 v40, v40, v42
  v_lshlrev_b32 v41, 16, v49
  v_and_b32 v42, 0xffff0000, v49
  v_add_f32 v40, v40, v41
  v_add_f32 v40, v40, v42
  v_lshlrev_b32 v41, 16, v50
  v_and_b32 v42, 0xffff0000, v50
  v_add_f32 v40, v40, v41
  v_add_f32 v40, v40, v42
  v_lshlrev_b32 v41, 16, v51
  v_and_b32 v42, 0xffff0000, v51
  v_add_f32 v40, v40, v41
  v_add_f32 v40, v40, v42
  s_nop 1
  v_add_f32 v40, v40, v40 quad_perm:[1,0,3,2] row_mask:0xf bank_mask:0xf
  s_nop 1
  v_add_f32 v40, v40, v40 quad_perm:[2,3,0,1] row_mask:0xf bank_mask:0xf
  s_nop 1
  v_add_f32 v40, v40, v40 row_half_mirror row_mask:0xf bank_mask:0xf
  s_nop 1
  v_add_f32 v40, v40, v40 row_mirror row_mask:0xf bank_mask:0xf
  s_nop 0
  v_readlane_b32 s20, v40, 16
  v_readlane_b32 s21, v40, 32
  v_readlane_b32 s22, v40, 48
  v_add_f32 v40, s20, v40
  v_add_f32 v40, s21, v40
  v_add_f32 v40, s22, v40
  v_mul_f32 v40, 0x3a800000, v40
  s_nop 0
  v_readfirstlane_b32 s76, v40
.fz_kernel_xs5:
  s_barrier
  s_sub_u32 s3, s3, 1
  s_cmp_lg_u32 s3, s31
  s_cbranch_scc1 .fz_kernel_xs5
  ds_read_b128 v[64:67], v21 offset:0
  ds_read_b128 v[72:75], v21 offset:2048
  ds_read_b128 v[80:83], v21 offset:4096
  ds_read_b128 v[88:91], v21 offset:6144
  ds_read_b128 v[96:99], v21 offset:8192
  ds_read_b128 v[104:107], v21 offset:10240
  ds_read_b128 v[112:115], v21 offset:12288
  ds_read_b128 v[120:123], v21 offset:14336
  ds_read_b128 v[68:71], v22 offset:0
  ds_read_b128 v[76:79], v22 offset:2048
  ds_read_b128 v[84:87], v22 offset:4096
  ds_read_b128 v[92:95], v22 offset:6144
  ds_read_b128 v[100:103], v22 offset:8192
  ds_read_b128 v[108:111], v22 offset:10240
  ds_read_b128 v[116:119], v22 offset:12288
  ds_read_b128 v[124:127], v22 offset:14336
  s_waitcnt lgkmcnt(0)
  s_cmp_eq_u32 s3, 0
  s_cbranch_scc1 .fz_kernel_hb6
  s_barrier
  s_sub_u32 s3, s3, 1
.fz_kernel_hb6:
  s_setprio 2
  v_mfma_f32_16x16x32_bf16 v[128:131], v[24:27], v[64:67], 0
  v_mfma_f32_16x16x32_bf16 v[160:163], v[64:67], v[64:67], 0
  v_mfma_f32_16x16x32_bf16 v[132:135], v[24:27], v[72:75], 0
  v_mfma_f32_16x16x32_bf16 v[164:167], v[72:75], v[72:75], 0
  v_mfma_f32_16x16x32_bf16 v[136:139], v[24:27], v[80:83], 0
  v_mfma_f32_16x16x32_bf16 v[168:171], v[80:83], v[80:83], 0
  v_mfma_f32_16x16x32_bf16 v[140:143], v[24:27], v[88:91], 0
  v_mfma_f32_16x16x32_bf16 v[172:175], v[88:91], v[88:91], 0
  v_mfma_f32_16x16x32_bf16 v[144:147], v[24:27], v[96:99], 0
  v_mfma_f32_16x16x32_bf16 v[176:179], v[96:99], v[96:99], 0
  v_mfma_f32_16x16x32_bf16 v[148:151], v[24:27], v[104:107], 0
  v_mfma_f32_16x16x32_bf16 v[180:183], v[104:107], v[104:107], 0
  v_mfma_f32_16x16x32_bf16 v[152:155], v[24:27], v[112:115], 0
  v_mfma_f32_16x16x32_bf16 v[184:187], v[112:115], v[112:115], 0
  v_mfma_f32_16x16x32_bf16 v[156:159], v[24:27], v[120:123], 0
  v_mfma_f32_16x16x32_bf16 v[188:191], v[120:123], v[120:123], 0
  v_mfma_f32_16x16x32_bf16 v[128:131], v[24:27], v[68:71], v[128:131]
  v_mfma_f32_16x16x32_bf16 v[160:163], v[68:71], v[68:71], v[160:163]
  v_mfma_f32_16x16x32_bf16 v[132:135], v[24:27], v[76:79], v[132:135]
  v_mfma_f32_16x16x32_bf16 v[164:167], v[76:79], v[76:79], v[164:167]
  v_mfma_f32_16x16x32_bf16 v[136:139], v[24:27], v[84:87], v[136:139]
  v_mfma_f32_16x16x32_bf16 v[168:171], v[84:87], v[84:87], v[168:171]
  v_mfma_f32_16x16x32_bf16 v[140:143], v[24:27], v[92:95], v[140:143]
  v_mfma_f32_16x16x32_bf16 v[172:175], v[92:95], v[92:95], v[172:175]
  v_mfma_f32_16x16x32_bf16 v[144:147], v[24:27], v[100:103], v[144:147]
  v_mfma_f32_16x16x32_bf16 v[176:179], v[100:103], v[100:103], v[176:179]
  v_mfma_f32_16x16x32_bf16 v[148:151], v[24:27], v[108:111], v[148:151]
  v_mfma_f32_16x16x32_bf16 v[180:183], v[108:111], v[108:111], v[180:183]
  v_mfma_f32_16x16x32_bf16 v[152:155], v[24:27], v[116:119], v[152:155]
  v_mfma_f32_16x16x32_bf16 v[184:187], v[116:119], v[116:119], v[184:187]
  v_mfma_f32_16x16x32_bf16 v[156:159], v[24:27], v[124:127], v[156:159]
  v_mfma_f32_16x16x32_bf16 v[188:191], v[124:127], v[124:127], v[188:191]
  s_setprio 0
  s_cmp_eq_u32 s3, 0
  s_cbranch_scc1 .fz_kernel_hb7
  s_barrier
  s_sub_u32 s3, s3, 1
.fz_kernel_hb7:
  s_mov_b32 exec_lo, 0x100001
  s_mov_b32 exec_hi, 0x10000100
  buffer_load_dword v9, v4, s[12:15], 0 offen sc1
  v_mov_b32 v128, v160
  v_mov_b32 v132, v164
  v_mov_b32 v136, v168
  v_mov_b32 v140, v172
  v_mov_b32 v144, v176
  v_mov_b32 v148, v180
  v_mov_b32 v152, v184
  v_mov_b32 v156, v188
  s_mov_b32 exec_lo, 0x200002
  s_mov_b32 exec_hi, 0x20000200
  v_mov_b32 v128, v161
  v_mov_b32 v132, v165
  v_mov_b32 v136, v169
  v_mov_b32 v140, v173
  v_mov_b32 v144, v177
  v_mov_b32 v148, v181
  v_mov_b32 v152, v185
  v_mov_b32 v156, v189
  s_mov_b32 exec_lo, 0x400004
  s_mov_b32 exec_hi, 0x40000400
  v_mov_b32 v128, v162
  v_mov_b32 v132, v166
  v_mov_b32 v136, v170
  v_mov_b32 v140, v174
  v_mov_b32 v144, v178
  v_mov_b32 v148, v182
  v_mov_b32 v152, v186
  v_mov_b32 v156, v190
  s_cmp_eq_u32 s3, 0
  s_cbranch_scc1 .fz_kernel_hb8
  s_barrier
  s_sub_u32 s3, s3, 1
.fz_kernel_hb8:
  s_mov_b32 exec_lo, 0x800008
  s_mov_b32 exec_hi, 0x80000800
  v_mov_b32 v128, v163
  v_mov_b32 v132, v167
  v_mov_b32 v136, v171
  v_mov_b32 v140, v175
  v_mov_b32 v144, v179
  v_mov_b32 v148, v183
  v_mov_b32 v152, v187
  v_mov_b32 v156, v191
  s_mov_b64 exec, 1
  s_mov_b32 s38, 0
.fz_kernel_pw9:
  s_mov_b32 s46, 0
  s_call_b64 s[0:1], .fz_kernel_hw
  s_waitcnt vmcnt(0)
  v_readfirstlane_b32 s31, v9
  s_cmp_eq_u32 s31, 64
  s_cbranch_scc1 .fz_kernel_pw9d
  s_cmp_eq_u32 s3, 0
  s_cbranch_scc1 .fz_kernel_hb10
  s_barrier
  s_sub_u32 s3, s3, 1
.fz_kernel_hb10:
  s_cmp_eq_u32 s3, 0
  s_cbranch_scc1 .fz_kernel_hb11
  s_barrier
  s_sub_u32 s3, s3, 1
.fz_kernel_hb11:
  buffer_load_dword v9, v4, s[12:15], 0 offen sc1
  s_add_u32 s38, s38, 1
  s_cmp_lt_u32 s38, 131072
  s_cbranch_scc1 .fz_kernel_pw9
  s_waitcnt vmcnt(0)
.fz_kernel_pw9d:
  s_mov_b64 exec, -1
  s_cmp_eq_u32 s3, 0
  s_cbranch_scc1 .fz_kernel_hb12
  s_barrier
  s_sub_u32 s3, s3, 1
.fz_kernel_hb12:
  s_mov_b32 exec_lo, 0x00fff00f
  s_mov_b32 exec_hi, 0xff000ff0
  buffer_atomic_add_f32 v128, v20, s[4:7], s30 offen offset:0 sc1
  buffer_atomic_add_f32 v132, v20, s[4:7], s30 offen offset:128 sc1
  buffer_atomic_add_f32 v136, v20, s[4:7], s30 offen offset:256 sc1
  buffer_atomic_add_f32 v140, v20, s[4:7], s30 offen offset:384 sc1
  buffer_atomic_add_f32 v144, v20, s[4:7], s30 offen offset:512 sc1
  buffer_atomic_add_f32 v148, v20, s[4:7], s30 offen offset:640 sc1
  buffer_atomic_add_f32 v152, v20, s[4:7], s30 offen offset:768 sc1
  buffer_atomic_add_f32 v156, v20, s[4:7], s30 offen offset:896 sc1
  s_mov_b64 exec, -1
  s_mov_b32 s46, 0
  s_call_b64 s[0:1], .fz_kernel_hw
  s_waitcnt vmcnt(0)
  v_lshlrev_b32 v7, 11, v2
  s_lshl_b32 s31, s17, 7
  s_lshl_b32 s33, 1, s18
  s_add_u32 s31, s31, s67
  s_add_u32 s31, s31, 0x1800018
  v_mov_b32 v8, s33
  s_mov_b64 exec, 0xffff
  buffer_atomic_or v8, v7, s[4:7], s31 offen sc1
  s_mov_b64 exec, -1
  s_add_u32 s37, s19, 24
.fz_kernel_f113:
  s_cmp_le_u32 s3, 9
  s_cbranch_scc1 .fz_kernel_f113d
  s_barrier
  s_sub_u32 s3, s3, 1
  s_branch .fz_kernel_f113
.fz_kernel_f113d:
  s_mov_b64 exec, 1
  buffer_load_dword v9, v4, s[4:7], s37 offen sc1
  s_mov_b64 exec, 1
  s_mov_b32 s38, 0
.fz_kernel_pw14:
  s_mov_b32 s46, 0
  s_call_b64 s[0:1], .fz_kernel_hw
  s_waitcnt vmcnt(0)
  v_readfirstlane_b32 s31, v9
  s_cmp_eq_u32 s31, 65535
  s_cbranch_scc1 .fz_kernel_pw14d
  s_cmp_eq_u32 s3, 0
  s_cbranch_scc1 .fz_kernel_hb15
  s_barrier
  s_sub_u32 s3, s3, 1
.fz_kernel_hb15:
  s_cmp_eq_u32 s3, 0
  s_cbranch_scc1 .fz_kernel_hb16
  s_barrier
  s_sub_u32 s3, s3, 1
.fz_kernel_hb16:
  buffer_load_dword v9, v4, s[4:7], s37 offen sc1
  s_add_u32 s38, s38, 1
  s_cmp_lt_u32 s38, 131072
  s_cbranch_scc1 .fz_kernel_pw14
  s_waitcnt vmcnt(0)
.fz_kernel_pw14d:
  s_mov_b64 exec, -1
  buffer_load_dwordx4 v[64:67], v3, s[4:7], s30 offen sc1
  s_mov_b32 s46, 0
  s_call_b64 s[0:1], .fz_kernel_hw
  s_waitcnt vmcnt(0)
  s_cmp_eq_u32 s3, 0
  s_cbranch_scc1 .fz_kernel_hb17
  s_barrier
  s_sub_u32 s3, s3, 1
.fz_kernel_hb17:
  v_mov_b32 v26, 0.0009765625
  v_mul_f32 v20, v26, v64
  v_mul_f32 v27, v20, v20
  v_fma_f32 v22, v65, v26, -v27
  v_max_f32 v22, 0, v22
  v_add_f32 v22, 1e-05, v22
  v_rsq_f32 v22, v22
  s_nop 0
  v_mul_f32 v20, v20, v22
  v_sub_f32 v20, 0, v20
  v_mul_f32 v21, v26, v66
  v_mul_f32 v27, v21, v21
  v_fma_f32 v23, v67, v26, -v27
  v_max_f32 v23, 0, v23
  v_add_f32 v23, 1e-05, v23
  v_rsq_f32 v23, v23
  s_nop 0
  v_mul_f32 v21, v21, v23
  v_sub_f32 v21, 0, v21
  ds_write_b64 v52, v[22:23] offset:4608
  ds_write_b64 v52, v[20:21] offset:5120
  v_mov_b32 v24, 159952
  v_mov_b32 v25, s76
  ds_write_b32 v24, v25 offset:8
  s_waitcnt lgkmcnt(0)
.fz_kernel_q_hw2:
  s_add_u32 s3, s3, 2
.fz_kernel_q_he:
  s_cmp_eq_u32 s3, 0
  s_cbranch_scc1 .fz_kernel_chain
  s_barrier
  s_sub_u32 s3, s3, 1
  s_branch .fz_kernel_q_he
.fz_kernel_q_h7:
  s_mov_b32 s8, s58
  s_mov_b32 s9, s59
  s_mov_b32 s10, 0x100
  s_mov_b32 s11, 0x00020000
  v_mov_b32 v12, 0
  v_mov_b32 v13, 0
  v_mov_b32 v14, 0
  v_mov_b32 v15, 0
  s_cmp_ge_u32 s2, 64
  s_cbranch_scc1 .fz_kernel_q_nzero
  s_lshl_b32 s36, s2, 10
  s_add_u32 s36, s36, 0x1800000
  buffer_store_dwordx4 v[12:15], v3, s[4:7], s36 offen sc1
.fz_kernel_q_nzero:
  v_and_b32 v21, 7, v2
  v_and_b32 v20, 16, v2
  v_lshlrev_b32 v20, 1, v20
  v_xor_b32 v20, v20, v3
  s_bfe_u32 s33, s17, 0x10002
  s_lshl_b32 s33, s33, 1
  s_and_b32 s31, s33, 3
  s_mul_i32 s31, s31, 12288
  s_add_u32 s31, s31, 65536
  v_add_u32 v16, s31, v20
  v_xor_b32 v17, 64, v16
  s_add_u32 s31, s31, 12288
  v_add_u32 v18, s31, v20
  v_xor_b32 v19, 64, v18
  s_sub_u32 s33, 31, s33
  v_lshlrev_b32 v21, 5, v21
  v_and_b32 v22, 24, v2
  v_add_u32 v21, v22, v21
  v_lshrrev_b32 v22, 5, v2
  v_lshl_add_u32 v21, v22, 2, v21
  s_lshl_b32 s30, s18, 10
  s_add_u32 s30, s30, 0x180c000
  v_and_b32 v22, 1, v2
  v_lshlrev_b32 v22, 4, v22
  v_mov_b32 v23, 0x3f80
  v_lshlrev_b32 v22, v22, v23
  v_mov_b32 v24, 0
  v_mov_b32 v25, 0
  v_mov_b32 v26, 0
  v_mov_b32 v27, 0
  s_mov_b32 exec_lo, 0x3030303
  s_mov_b32 exec_hi, 0x3030303
  v_mov_b32 v24, v22
  s_mov_b32 exec_lo, 0xc0c0c0c
  s_mov_b32 exec_hi, 0xc0c0c0c
  v_mov_b32 v25, v22
  s_mov_b32 exec_lo, 0x30303030
  s_mov_b32 exec_hi, 0x30303030
  v_mov_b32 v26, v22
  s_mov_b32 exec_lo, 0xc0c0c0c0
  s_mov_b32 exec_hi, 0xc0c0c0c0
  v_mov_b32 v27, v22
  s_mov_b64 exec, -1
  s_cmp_ge_u32 s2, 64
  s_cbranch_scc1 .fz_kernel_nz2
  s_mov_b64 exec, 1
  s_waitcnt vmcnt(0)
  buffer_atomic_add v5, v4, s[8:11], 0 offen sc1
  s_mov_b64 exec, -1
.fz_kernel_nz2:
  s_barrier
  s_sub_u32 s3, s3, 1
  s_cmp_lg_u32 s3, s33
  s_cbranch_scc1 .fz_kernel_nz2
  ds_read_b128 v[64:67], v16 offset:0
  ds_read_b128 v[68:71], v16 offset:4096
  ds_read_b128 v[72:75], v16 offset:8192
  ds_read_b128 v[76:79], v17 offset:1024
  ds_read_b128 v[80:83], v17 offset:5120
  ds_read_b128 v[84:87], v17 offset:9216
  ds_read_b128 v[88:91], v16 offset:2048
  ds_read_b128 v[92:95], v16 offset:6144
  ds_read_b128 v[96:99], v16 offset:10240
  ds_read_b128 v[100:103], v17 offset:3072
  ds_read_b128 v[104:107], v17 offset:7168
  ds_read_b128 v[108:111], v17 offset:11264
  s_waitcnt lgkmcnt(0)
  s_cmp_eq_u32 s3, 0
  s_cbranch_scc1 .fz_kernel_hb18
  s_barrier
  s_sub_u32 s3, s3, 1
.fz_kernel_hb18:
  ds_read_b128 v[112:115], v18 offset:0
  ds_read_b128 v[116:119], v18 offset:4096
  ds_read_b128 v[120:123], v18 offset:8192
  ds_read_b128 v[124:127], v19 offset:1024
  ds_read_b128 v[128:131], v19 offset:5120
  ds_read_b128 v[132:135], v19 offset:9216
  ds_read_b128 v[136:139], v18 offset:2048
  ds_read_b128 v[140:143], v18 offset:6144
  ds_read_b128 v[144:147], v18 offset:10240
  ds_read_b128 v[148:151], v19 offset:3072
  ds_read_b128 v[152:155], v19 offset:7168
  ds_read_b128 v[156:159], v19 offset:11264
  s_waitcnt lgkmcnt(0)
  s_cmp_eq_u32 s3, 0
  s_cbranch_scc1 .fz_kernel_hb19
  s_barrier
  s_sub_u32 s3, s3, 1
.fz_kernel_hb19:
  s_setprio 2
  v_mfma_f32_16x16x32_bf16 v[160:163], v[24:27], v[64:67], 0
  v_mfma_f32_16x16x32_bf16 v[164:167], v[24:27], v[68:71], 0
  v_mfma_f32_16x16x32_bf16 v[168:171], v[24:27], v[72:75], 0
  v_mfma_f32_16x16x32_bf16 v[160:163], v[24:27], v[76:79], v[160:163]
  v_mfma_f32_16x16x32_bf16 v[164:167], v[24:27], v[80:83], v[164:167]
  v_mfma_f32_16x16x32_bf16 v[168:171], v[24:27], v[84:87], v[168:171]
  v_mfma_f32_16x16x32_bf16 v[160:163], v[24:27], v[88:91], v[160:163]
  v_mfma_f32_16x16x32_bf16 v[164:167], v[24:27], v[92:95], v[164:167]
  v_mfma_f32_16x16x32_bf16 v[168:171], v[24:27], v[96:99], v[168:171]
  v_mfma_f32_16x16x32_bf16 v[160:163], v[24:27], v[100:103], v[160:163]
  v_mfma_f32_16x16x32_bf16 v[164:167], v[24:27], v[104:107], v[164:167]
  v_mfma_f32_16x16x32_bf16 v[168:171], v[24:27], v[108:111], v[168:171]
  v_mfma_f32_16x16x32_bf16 v[160:163], v[24:27], v[112:115], v[160:163]
  v_mfma_f32_16x16x32_bf16 v[164:167], v[24:27], v[116:119], v[164:167]
  v_mfma_f32_16x16x32_bf16 v[168:171], v[24:27], v[120:123], v[168:171]
  v_mfma_f32_16x16x32_bf16 v[160:163], v[24:27], v[124:127], v[160:163]
  v_mfma_f32_16x16x32_bf16 v[164:167], v[24:27], v[128:131], v[164:167]
  v_mfma_f32_16x16x32_bf16 v[168:171], v[24:27], v[132:135], v[168:171]
  v_mfma_f32_16x16x32_bf16 v[160:163], v[24:27], v[136:139], v[160:163]
  v_mfma_f32_16x16x32_bf16 v[164:167], v[24:27], v[140:143], v[164:167]
  v_mfma_f32_16x16x32_bf16 v[168:171], v[24:27], v[144:147], v[168:171]
  v_mfma_f32_16x16x32_bf16 v[160:163], v[24:27], v[148:151], v[160:163]
  v_mfma_f32_16x16x32_bf16 v[164:167], v[24:27], v[152:155], v[164:167]
  v_mfma_f32_16x16x32_bf16 v[168:171], v[24:27], v[156:159], v[168:171]
  s_setprio 0
  s_mov_b64 exec, 1
  buffer_load_dword v9, v4, s[8:11], 0 offen sc1
  s_mov_b64 exec, -1
  s_cmp_eq_u32 s3, 0
  s_cbranch_scc1 .fz_kernel_hb20
  s_barrier
  s_sub_u32 s3, s3, 1
.fz_kernel_hb20:
  v_add_f32 v160, v160, v160 row_ror:8 row_mask:0xf bank_mask:0xf
  v_add_f32 v161, v161, v161 row_ror:8 row_mask:0xf bank_mask:0xf
  v_add_f32 v162, v162, v162 row_ror:8 row_mask:0xf bank_mask:0xf
  v_add_f32 v163, v163, v163 row_ror:8 row_mask:0xf bank_mask:0xf
  v_add_f32 v164, v164, v164 row_ror:8 row_mask:0xf bank_mask:0xf
  v_add_f32 v165, v165, v165 row_ror:8 row_mask:0xf bank_mask:0xf
  v_add_f32 v166, v166, v166 row_ror:8 row_mask:0xf bank_mask:0xf
  v_add_f32 v167, v167, v167 row_ror:8 row_mask:0xf bank_mask:0xf
  v_add_f32 v168, v168, v168 row_ror:8 row_mask:0xf bank_mask:0xf
  v_add_f32 v169, v169, v169 row_ror:8 row_mask:0xf bank_mask:0xf
  v_add_f32 v170, v170, v170 row_ror:8 row_mask:0xf bank_mask:0xf
  v_add_f32 v171, v171, v171 row_ror:8 row_mask:0xf bank_mask:0xf
  s_mov_b32 exec_lo, 0x0
  s_mov_b32 exec_hi, 0xff00ff
  v_mov_b32 v160, v161
  v_mov_b32 v164, v165
  v_mov_b32 v168, v169
  s_mov_b32 exec_lo, 0xff00ff00
  s_mov_b32 exec_hi, 0x0
  v_mov_b32 v160, v162
  v_mov_b32 v164, v166
  v_mov_b32 v168, v170
  s_mov_b32 exec_lo, 0x0
  s_mov_b32 exec_hi, 0xff00ff00
  v_mov_b32 v160, v163
  v_mov_b32 v164, v167
  v_mov_b32 v168, v171
  s_cmp_eq_u32 s3, 0
  s_cbranch_scc1 .fz_kernel_hb21
  s_barrier
  s_sub_u32 s3, s3, 1
.fz_kernel_hb21:
  s_mov_b64 exec, 1
  s_mov_b32 s38, 0
.fz_kernel_pw22:
  s_mov_b32 s46, 0
  s_call_b64 s[0:1], .fz_kernel_hw
  s_waitcnt vmcnt(0)
  v_readfirstlane_b32 s31, v9
  s_cmp_eq_u32 s31, 64
  s_cbranch_scc1 .fz_kernel_pw22d
  s_cmp_eq_u32 s3, 0
  s_cbranch_scc1 .fz_kernel_hb23
  s_barrier
  s_sub_u32 s3, s3, 1
.fz_kernel_hb23:
  s_cmp_eq_u32 s3, 0
  s_cbranch_scc1 .fz_kernel_hb24
  s_barrier
  s_sub_u32 s3, s3, 1
.fz_kernel_hb24:
  buffer_load_dword v9, v4, s[8:11], 0 offen sc1
  s_add_u32 s38, s38, 1
  s_cmp_lt_u32 s38, 131072
  s_cbranch_scc1 .fz_kernel_pw22
  s_waitcnt vmcnt(0)
.fz_kernel_pw22d:
  s_mov_b64 exec, -1
  buffer_atomic_add_f32 v160, v21, s[4:7], s30 offen offset:0 sc1
  buffer_atomic_add_f32 v164, v21, s[4:7], s30 offen offset:256 sc1
  buffer_atomic_add_f32 v168, v21, s[4:7], s30 offen offset:512 sc1
  s_mov_b32 s46, 0
  s_call_b64 s[0:1], .fz_kernel_hw
  s_waitcnt vmcnt(0)
  v_lshlrev_b32 v7, 7, v2
  s_lshl_b32 s31, s18, 11
  s_lshl_b32 s33, 1, s17
  s_add_u32 s31, s31, s67
  s_add_u32 s31, s31, 0x180001c
  v_mov_b32 v8, s33
  s_mov_b64 exec, 0xffff
  buffer_atomic_or v8, v7, s[4:7], s31 offen sc1
  s_mov_b64 exec, -1
  s_cmp_eq_u32 s3, 0
  s_cbranch_scc1 .fz_kernel_hb25
  s_barrier
  s_sub_u32 s3, s3, 1
.fz_kernel_hb25:
  s_cmp_ge_u32 s2, 196
  s_cbranch_scc1 .fz_kernel_lz26
  s_lshl_b32 s36, s2, 12
  s_add_u32 s36, s36, 0x1c00000
  s_sub_u32 s31, s2, 66
  s_min_u32 s31, s31, s2
  s_sub_u32 s31, s31, 4
  s_cmp_lt_u32 s31, 6
  s_cbranch_scc1 .fz_kernel_lz26a
  buffer_store_dwordx4 v[12:15], v3, s[4:7], s36 offen sc1
  buffer_store_dwordx4 v[12:15], v3, s[4:7], s36 offen offset:1024 sc1
  buffer_store_dwordx4 v[12:15], v3, s[4:7], s36 offen offset:2048 sc1
  buffer_store_dwordx4 v[12:15], v3, s[4:7], s36 offen offset:3072 sc1
.fz_kernel_lz26:
  s_add_u32 s37, s19, 28
.fz_kernel_f127:
  s_cmp_le_u32 s3, 9
  s_cbranch_scc1 .fz_kernel_f127d
  s_barrier
  s_sub_u32 s3, s3, 1
  s_branch .fz_kernel_f127
.fz_kernel_f127d:
  s_mov_b64 exec, 1
  buffer_load_dword v9, v4, s[4:7], s37 offen sc1
  s_mov_b64 exec, 1
  s_mov_b32 s38, 0
.fz_kernel_pw28:
  s_mov_b32 s46, 0
  s_call_b64 s[0:1], .fz_kernel_hw
  s_waitcnt vmcnt(0)
  v_readfirstlane_b32 s31, v9
  s_cmp_eq_u32 s31, 65535
  s_cbranch_scc1 .fz_kernel_pw28d
  s_cmp_eq_u32 s3, 0
  s_cbranch_scc1 .fz_kernel_hb29
  s_barrier
  s_sub_u32 s3, s3, 1
.fz_kernel_hb29:
  s_cmp_eq_u32 s3, 0
  s_cbranch_scc1 .fz_kernel_hb30
  s_barrier
  s_sub_u32 s3, s3, 1
.fz_kernel_hb30:
  buffer_load_dword v9, v4, s[4:7], s37 offen sc1
  s_add_u32 s38, s38, 1
  s_cmp_lt_u32 s38, 131072
  s_cbranch_scc1 .fz_kernel_pw28
  s_waitcnt vmcnt(0)
.fz_kernel_pw28d:
  s_mov_b64 exec, -1
  buffer_load_dwordx4 v[64:67], v3, s[4:7], s30 offen sc1
  s_mov_b32 s46, 0
  s_call_b64 s[0:1], .fz_kernel_hw
  s_waitcnt vmcnt(0)
  v_add_u32 v24, 155648, v3
  s_mov_b32 exec_hi, 0xffff
  ds_write_b128 v24, v[64:67] offset:5632
  s_mov_b64 exec, -1
  s_waitcnt lgkmcnt(0)
  s_cmp_eq_u32 s3, 0
  s_cbranch_scc1 .fz_kernel_hb31
  s_barrier
  s_sub_u32 s3, s3, 1
.fz_kernel_hb31:
  s_getpc_b64 s[0:1]
.fz_kernel_ct32:
  s_sub_u32 s0, s0, .fz_kernel_ct32-fz_kernel
  s_subb_u32 s1, s1, 0
  s_lshr_b32 s31, s2, 3
  s_mulk_i32 s31, 0x500
  v_lshl_add_u32 v1, v2, 7, s31
  v_min_u32 v1, .fz_kernel_last-fz_kernel, v1
  s_mov_b64 exec, 0x3ff
  global_load_dword v1, v1, s[0:1]
  s_mov_b64 exec, -1
.fz_kernel_ct32e:
  s_branch .fz_kernel_q_hw2
.fz_kernel_att:
  s_setprio 1
  s_and_b32 s39, s16, 1
  s_lshr_b32 s32, s16, 1
  s_lshl1_add_u32 s35, s18, s39
  s_lshl_b32 s35, s35, 5
  s_add_u32 s35, s35, s32
  s_lshl_b32 s35, s35, 13
  s_add_u32 s35, s35, s63
  s_lshl_b32 s34, 1, s17
  s_mov_b32 s36, 0
  v_add_u32 v10, 4096, v3
  v_mfma_f32_32x32x16_bf16 v[48:63], v[80:83], v[16:19], 0
  v_mfma_f32_32x32x16_bf16 v[48:63], v[84:87], v[20:23], v[48:63]
  v_mov_b32 v1, 0x3f803f80
  v_mov_b32 v11, 0x4444
  v_mov_b32 v12, v1
  v_mov_b32 v14, 0
  s_mov_b32 exec_lo, 0xaaaaaaaa
  s_mov_b32 exec_hi, 0xaaaaaaaa
  v_mov_b32 v12, 0
  v_mov_b32 v14, v1
  s_mov_b32 exec_lo, 0xcccccccc
  s_mov_b32 exec_hi, 0xcccccccc
  v_mov_b32 v11, 0xeeee
  s_mov_b64 exec, -1
  v_mov_b32 v13, v12
  v_mov_b32 v15, v14
  s_lshl_b32 s31, s16, 8
  s_add_u32 s31, s31, 147456
  v_and_b32 v1, 31, v2
  v_lshl_add_u32 v1, v1, 3, s31
  s_mov_b32 s26, 0xffff0000
  s_mov_b32 s27, 0xffff0000
  s_mov_b32 s24, 0x21800000
  s_mov_b32 s25, 0x5d800000
  s_andn2_b32 s31, 2, s16
  s_lshl2_add_u32 s31, s17, s31
  s_lshl4_add_u32 s31, s31, s18
  s_lshl1_add_u32 s31, s31, s39
  s_lshl_b32 s31, s31, 11
  s_add_u32 s28, s31, s64
  s_add_u32 s29, s28, 65536
  s_mov_b32 s73, 0
  v_mov_b32 v208, 0
  v_mov_b32 v209, 0
  v_mov_b32 v210, 0
  v_mov_b32 v211, 0
  v_mov_b32 v212, 0
  v_mov_b32 v213, 0
  v_mov_b32 v214, 0
  v_mov_b32 v215, 0
  v_mov_b32 v216, 0
  v_mov_b32 v217, 0
  v_mov_b32 v218, 0
  v_mov_b32 v219, 0
  v_mov_b32 v220, 0
  v_mov_b32 v221, 0
  v_mov_b32 v222, 0
  v_mov_b32 v223, 0
  s_mov_b32 s32, 7
  s_waitcnt lgkmcnt(0)
  s_barrier
  ds_read_b128 v[32:35], v9 offset:0
  ds_read_b128 v[36:39], v9 offset:1024
  ds_read_b128 v[40:43], v9 offset:2048
  ds_read_b128 v[44:47], v9 offset:3072
  v_mfma_f32_32x32x16_bf16 v[64:79], v[80:83], v[24:27], 0
  v_exp_f32 v48, v48
  v_exp_f32 v49, v49
  v_exp_f32 v50, v50
  v_exp_f32 v51, v51
  v_exp_f32 v52, v52
  v_exp_f32 v53, v53
  v_exp_f32 v54, v54
  v_exp_f32 v55, v55
  v_mfma_f32_32x32x16_bf16 v[64:79], v[84:87], v[28:31], v[64:79]
  v_cvt_pk_bf16_f32 v224, v48, v49
  v_cvt_pk_bf16_f32 v225, v50, v51
  v_cvt_pk_bf16_f32 v226, v52, v53
  v_cvt_pk_bf16_f32 v227, v54, v55
  v_exp_f32 v56, v56
  v_exp_f32 v57, v57
  v_exp_f32 v58, v58
  v_exp_f32 v59, v59
  v_mfma_f32_32x32x16_bf16 v[144:159], v[88:91], v[224:227], 0
  v_exp_f32 v60, v60
  v_exp_f32 v61, v61
  v_exp_f32 v62, v62
  v_exp_f32 v63, v63
  v_cvt_pk_bf16_f32 v228, v56, v57
  v_cvt_pk_bf16_f32 v229, v58, v59
  v_cvt_pk_bf16_f32 v230, v60, v61
  v_cvt_pk_bf16_f32 v231, v62, v63
  s_waitcnt lgkmcnt(0)
  v_mfma_f32_32x32x16_bf16 v[48:63], v[80:83], v[32:35], 0
  v_exp_f32 v64, v64
  v_exp_f32 v65, v65
  v_exp_f32 v66, v66
  v_exp_f32 v67, v67
  v_mfma_f32_32x32x16_bf16 v[144:159], v[92:95], v[228:231], v[144:159]
  v_exp_f32 v68, v68
  v_exp_f32 v69, v69
  v_exp_f32 v70, v70
  v_smfmac_f32_16x16x64_bf16 v[208:211], v[12:15], v[224:231], v11
  v_exp_f32 v71, v71
  v_mfma_f32_32x32x16_bf16 v[48:63], v[84:87], v[36:39], v[48:63]
  v_cvt_pk_bf16_f32 v224, v64, v65
  v_cvt_pk_bf16_f32 v225, v66, v67
  v_cvt_pk_bf16_f32 v226, v68, v69
  v_cvt_pk_bf16_f32 v227, v70, v71
  v_exp_f32 v72, v72
  v_exp_f32 v73, v73
  v_exp_f32 v74, v74
  v_exp_f32 v75, v75
  v_mfma_f32_32x32x16_bf16 v[160:175], v[88:91], v[224:227], 0
  v_exp_f32 v76, v76
  v_exp_f32 v77, v77
  v_exp_f32 v78, v78
  v_exp_f32 v79, v79
  v_cvt_pk_bf16_f32 v228, v72, v73
  v_cvt_pk_bf16_f32 v229, v74, v75
  v_cvt_pk_bf16_f32 v230, v76, v77
  v_cvt_pk_bf16_f32 v231, v78, v79
  s_mov_b64 exec, 1
  s_waitcnt vmcnt(0)
  ds_add_u32 v6, v5 offset:0x100
  s_mov_b64 exec, -1
  v_mfma_f32_32x32x16_bf16 v[64:79], v[80:83], v[40:43], 0
  v_exp_f32 v48, v48
  v_exp_f32 v49, v49
  v_exp_f32 v50, v50
  v_exp_f32 v51, v51
  v_mfma_f32_32x32x16_bf16 v[160:175], v[92:95], v[228:231], v[160:175]
  v_exp_f32 v52, v52
  v_exp_f32 v53, v53
  v_exp_f32 v54, v54
  v_smfmac_f32_16x16x64_bf16 v[212:215], v[12:15], v[224:231], v11
  v_exp_f32 v55, v55
  v_mfma_f32_32x32x16_bf16 v[64:79], v[84:87], v[44:47], v[64:79]
  v_cvt_pk_bf16_f32 v224, v48, v49
  v_cvt_pk_bf16_f32 v225, v50, v51
  v_cvt_pk_bf16_f32 v226, v52, v53
  v_cvt_pk_bf16_f32 v227, v54, v55
  v_exp_f32 v56, v56
  v_exp_f32 v57, v57
  v_exp_f32 v58, v58
  v_exp_f32 v59, v59
  v_mfma_f32_32x32x16_bf16 v[176:191], v[88:91], v[224:227], 0
  ds_read_b32 v7, v6
  v_exp_f32 v60, v60
  v_exp_f32 v61, v61
  v_exp_f32 v62, v62
  v_exp_f32 v63, v63
  v_cvt_pk_bf16_f32 v228, v56, v57
  v_cvt_pk_bf16_f32 v229, v58, v59
  v_cvt_pk_bf16_f32 v230, v60, v61
  v_cvt_pk_bf16_f32 v231, v62, v63
  s_waitcnt lgkmcnt(0)
  v_readfirstlane_b32 s39, v7
  s_andn2_b32 s33, s39, s34
  s_bcnt1_i32_b32 s31, s33
  s_cmp_ge_u32 s31, 2
  s_cbranch_scc1 .fz_kernel_a_e
  v_mfma_f32_32x32x16_bf16 v[48:63], v[96:99], v[16:19], 0
  v_exp_f32 v64, v64
  v_exp_f32 v65, v65
  v_exp_f32 v66, v66
  v_exp_f32 v67, v67
  v_mfma_f32_32x32x16_bf16 v[176:191], v[92:95], v[228:231], v[176:191]
  v_exp_f32 v68, v68
  v_exp_f32 v69, v69
  v_exp_f32 v70, v70
  v_smfmac_f32_16x16x64_bf16 v[216:219], v[12:15], v[224:231], v11
  v_exp_f32 v71, v71
  v_mfma_f32_32x32x16_bf16 v[48:63], v[100:103], v[20:23], v[48:63]
  v_cvt_pk_bf16_f32 v224, v64, v65
  v_cvt_pk_bf16_f32 v225, v66, v67
  v_cvt_pk_bf16_f32 v226, v68, v69
  v_cvt_pk_bf16_f32 v227, v70, v71
  v_exp_f32 v72, v72
  v_exp_f32 v73, v73
  v_exp_f32 v74, v74
  v_exp_f32 v75, v75
  v_mfma_f32_32x32x16_bf16 v[192:207], v[88:91], v[224:227], 0
  v_exp_f32 v76, v76
  v_exp_f32 v77, v77
  v_exp_f32 v78, v78
  v_exp_f32 v79, v79
  v_cvt_pk_bf16_f32 v228, v72, v73
  v_cvt_pk_bf16_f32 v229, v74, v75
  v_cvt_pk_bf16_f32 v230, v76, v77
  v_cvt_pk_bf16_f32 v231, v78, v79
  v_mfma_f32_32x32x16_bf16 v[64:79], v[96:99], v[24:27], 0
  v_exp_f32 v48, v48
  v_exp_f32 v49, v49
  v_exp_f32 v50, v50
  v_exp_f32 v51, v51
  v_mfma_f32_32x32x16_bf16 v[192:207], v[92:95], v[228:231], v[192:207]
  v_exp_f32 v52, v52
  v_exp_f32 v53, v53
  v_exp_f32 v54, v54
  v_smfmac_f32_16x16x64_bf16 v[220:223], v[12:15], v[224:231], v11
  v_exp_f32 v55, v55
  v_mfma_f32_32x32x16_bf16 v[64:79], v[100:103], v[28:31], v[64:79]
  v_cvt_pk_bf16_f32 v224, v48, v49
  v_cvt_pk_bf16_f32 v225, v50, v51
  v_cvt_pk_bf16_f32 v226, v52, v53
  v_cvt_pk_bf16_f32 v227, v54, v55
  v_exp_f32 v56, v56
  v_exp_f32 v57, v57
  v_exp_f32 v58, v58
  v_exp_f32 v59, v59
  v_mfma_f32_32x32x16_bf16 v[144:159], v[104:107], v[224:227], v[144:159]
  v_exp_f32 v60, v60
  v_exp_f32 v61, v61
  v_exp_f32 v62, v62
  v_exp_f32 v63, v63
  v_cvt_pk_bf16_f32 v228, v56, v57
  v_cvt_pk_bf16_f32 v229, v58, v59
  v_cvt_pk_bf16_f32 v230, v60, v61
  v_cvt_pk_bf16_f32 v231, v62, v63
  v_mfma_f32_32x32x16_bf16 v[48:63], v[96:99], v[32:35], 0
  v_exp_f32 v64, v64
  v_exp_f32 v65, v65
  v_exp_f32 v66, v66
  v_exp_f32 v67, v67
  v_mfma_f32_32x32x16_bf16 v[144:159], v[108:111], v[228:231], v[144:159]
  v_exp_f32 v68, v68
  v_exp_f32 v69, v69
  v_exp_f32 v70, v70
  v_smfmac_f32_16x16x64_bf16 v[208:211], v[12:15], v[224:231], v11
  v_exp_f32 v71, v71
  v_mfma_f32_32x32x16_bf16 v[48:63], v[100:103], v[36:39], v[48:63]
  v_cvt_pk_bf16_f32 v224, v64, v65
  v_cvt_pk_bf16_f32 v225, v66, v67
  v_cvt_pk_bf16_f32 v226, v68, v69
  v_cvt_pk_bf16_f32 v227, v70, v71
  v_exp_f32 v72, v72
  v_exp_f32 v73, v73
  v_exp_f32 v74, v74
  v_exp_f32 v75, v75
  v_mfma_f32_32x32x16_bf16 v[160:175], v[104:107], v[224:227], v[160:175]
  ds_read_b32 v7, v6
  v_exp_f32 v76, v76
  v_exp_f32 v77, v77
  v_exp_f32 v78, v78
  v_exp_f32 v79, v79
  v_cvt_pk_bf16_f32 v228, v72, v73
  v_cvt_pk_bf16_f32 v229, v74, v75
  v_cvt_pk_bf16_f32 v230, v76, v77
  v_cvt_pk_bf16_f32 v231, v78, v79
  s_waitcnt lgkmcnt(0)
  v_readfirstlane_b32 s39, v7
  s_andn2_b32 s39, s39, s34
  s_cbranch_scc0 .fz_kernel_a_p0
  s_ff1_i32_b32 s33, s36
  s_bitset0_b32 s36, s33
  s_lshl_b32 s33, s33, 14
  s_add_u32 s30, s33, s35
  s_cbranch_scc1 .fz_kernel_pk33c
.fz_kernel_pk33:
  buffer_load_dwordx4 v[112:115], v3, s[4:7], s30 offen offset:0
  buffer_load_dwordx4 v[116:119], v3, s[4:7], s30 offen offset:1024
  buffer_load_dwordx4 v[120:123], v3, s[4:7], s30 offen offset:2048
  buffer_load_dwordx4 v[124:127], v3, s[4:7], s30 offen offset:3072
  buffer_load_dwordx4 v[128:131], v10, s[4:7], s30 offen offset:0
  buffer_load_dwordx4 v[132:135], v10, s[4:7], s30 offen offset:1024
  buffer_load_dwordx4 v[136:139], v10, s[4:7], s30 offen offset:2048
  buffer_load_dwordx4 v[140:143], v10, s[4:7], s30 offen offset:3072
.fz_kernel_a_p0:
  v_mfma_f32_32x32x16_bf16 v[64:79], v[96:99], v[40:43], 0
  v_exp_f32 v48, v48
  v_exp_f32 v49, v49
  v_exp_f32 v50, v50
  v_exp_f32 v51, v51
  v_mfma_f32_32x32x16_bf16 v[160:175], v[108:111], v[228:231], v[160:175]
  v_exp_f32 v52, v52
  v_exp_f32 v53, v53
  v_exp_f32 v54, v54
  v_smfmac_f32_16x16x64_bf16 v[212:215], v[12:15], v[224:231], v11
  v_exp_f32 v55, v55
  v_mfma_f32_32x32x16_bf16 v[64:79], v[100:103], v[44:47], v[64:79]
  v_cvt_pk_bf16_f32 v224, v48, v49
  v_cvt_pk_bf16_f32 v225, v50, v51
  v_cvt_pk_bf16_f32 v226, v52, v53
  v_cvt_pk_bf16_f32 v227, v54, v55
  v_exp_f32 v56, v56
  v_exp_f32 v57, v57
  v_exp_f32 v58, v58
  v_exp_f32 v59, v59
  v_mfma_f32_32x32x16_bf16 v[176:191], v[104:107], v[224:227], v[176:191]
  v_exp_f32 v60, v60
  v_exp_f32 v61, v61
  v_exp_f32 v62, v62
  v_exp_f32 v63, v63
  v_cvt_pk_bf16_f32 v228, v56, v57
  v_cvt_pk_bf16_f32 v229, v58, v59
  v_cvt_pk_bf16_f32 v230, v60, v61
  v_cvt_pk_bf16_f32 v231, v62, v63
  v_exp_f32 v64, v64
  v_exp_f32 v65, v65
  v_exp_f32 v66, v66
  v_exp_f32 v67, v67
  v_mfma_f32_32x32x16_bf16 v[176:191], v[108:111], v[228:231], v[176:191]
  v_exp_f32 v68, v68
  v_exp_f32 v69, v69
  v_exp_f32 v70, v70
  v_smfmac_f32_16x16x64_bf16 v[216:219], v[12:15], v[224:231], v11
  v_exp_f32 v71, v71
  v_cvt_pk_bf16_f32 v224, v64, v65
  v_cvt_pk_bf16_f32 v225, v66, v67
  v_cvt_pk_bf16_f32 v226, v68, v69
  v_cvt_pk_bf16_f32 v227, v70, v71
  v_exp_f32 v72, v72
  v_exp_f32 v73, v73
  v_exp_f32 v74, v74
  v_exp_f32 v75, v75
  v_mfma_f32_32x32x16_bf16 v[192:207], v[104:107], v[224:227], v[192:207]
  v_exp_f32 v76, v76
  v_exp_f32 v77, v77
  v_exp_f32 v78, v78
  v_exp_f32 v79, v79
  v_cvt_pk_bf16_f32 v228, v72, v73
  v_cvt_pk_bf16_f32 v229, v74, v75
  v_cvt_pk_bf16_f32 v230, v76, v77
  v_cvt_pk_bf16_f32 v231, v78, v79
  s_cmp_lg_u32 s39, 0
  s_cbranch_scc1 .fz_kernel_a_p1
  s_ff1_i32_b32 s33, s36
  s_bitset0_b32 s36, s33
  s_lshl_b32 s33, s33, 14
  s_add_u32 s30, s33, s35
  s_cbranch_scc1 .fz_kernel_pk34c
.fz_kernel_pk34:
  buffer_load_dwordx4 v[112:115], v3, s[4:7], s30 offen offset:0
  buffer_load_dwordx4 v[116:119], v3, s[4:7], s30 offen offset:1024
  buffer_load_dwordx4 v[120:123], v3, s[4:7], s30 offen offset:2048
  buffer_load_dwordx4 v[124:127], v3, s[4:7], s30 offen offset:3072
  buffer_load_dwordx4 v[128:131], v10, s[4:7], s30 offen offset:0
  buffer_load_dwordx4 v[132:135], v10, s[4:7], s30 offen offset:1024
  buffer_load_dwordx4 v[136:139], v10, s[4:7], s30 offen offset:2048
  buffer_load_dwordx4 v[140:143], v10, s[4:7], s30 offen offset:3072
.fz_kernel_a_p1:
  s_ff1_i32_b32 s33, s36
  s_bitset0_b32 s36, s33
  s_lshl_b32 s33, s33, 14
  s_add_u32 s30, s33, s35
  s_cbranch_scc1 .fz_kernel_pk35c
.fz_kernel_pk35:
  buffer_load_dwordx4 v[80:83], v3, s[4:7], s30 offen offset:0
  buffer_load_dwordx4 v[84:87], v3, s[4:7], s30 offen offset:1024
  buffer_load_dwordx4 v[88:91], v3, s[4:7], s30 offen offset:2048
  buffer_load_dwordx4 v[92:95], v3, s[4:7], s30 offen offset:3072
  buffer_load_dwordx4 v[96:99], v10, s[4:7], s30 offen offset:0
  s_waitcnt vmcnt(11)
  v_mfma_f32_32x32x16_bf16 v[48:63], v[112:115], v[16:19], 0
  v_mfma_f32_32x32x16_bf16 v[48:63], v[116:119], v[20:23], v[48:63]
  s_nop 9
  s_branch .fz_kernel_a_b2
.fz_kernel_a_e:
  s_mov_b32 s36, s33
  s_or_b32 s34, s34, s39
  s_ff1_i32_b32 s33, s36
  s_bitset0_b32 s36, s33
  s_lshl_b32 s33, s33, 14
  s_add_u32 s30, s33, s35
  v_mfma_f32_32x32x16_bf16 v[48:63], v[96:99], v[16:19], 0
  buffer_load_dwordx4 v[112:115], v3, s[4:7], s30 offen offset:0
  v_exp_f32 v64, v64
  v_exp_f32 v65, v65
  v_exp_f32 v66, v66
  v_exp_f32 v67, v67
  v_mfma_f32_32x32x16_bf16 v[176:191], v[92:95], v[228:231], v[176:191]
  buffer_load_dwordx4 v[116:119], v3, s[4:7], s30 offen offset:1024
  v_exp_f32 v68, v68
  v_exp_f32 v69, v69
  v_exp_f32 v70, v70
  v_smfmac_f32_16x16x64_bf16 v[216:219], v[12:15], v[224:231], v11
  buffer_load_dwordx4 v[120:123], v3, s[4:7], s30 offen offset:2048
  v_exp_f32 v71, v71
  v_mfma_f32_32x32x16_bf16 v[48:63], v[100:103], v[20:23], v[48:63]
  buffer_load_dwordx4 v[124:127], v3, s[4:7], s30 offen offset:3072
  v_cvt_pk_bf16_f32 v224, v64, v65
  v_cvt_pk_bf16_f32 v225, v66, v67
  v_cvt_pk_bf16_f32 v226, v68, v69
  v_cvt_pk_bf16_f32 v227, v70, v71
  v_exp_f32 v72, v72
  v_exp_f32 v73, v73
  v_exp_f32 v74, v74
  v_exp_f32 v75, v75
  v_mfma_f32_32x32x16_bf16 v[192:207], v[88:91], v[224:227], 0
  buffer_load_dwordx4 v[128:131], v10, s[4:7], s30 offen offset:0
  v_exp_f32 v76, v76
  v_exp_f32 v77, v77
  v_exp_f32 v78, v78
  v_exp_f32 v79, v79
  v_cvt_pk_bf16_f32 v228, v72, v73
  v_cvt_pk_bf16_f32 v229, v74, v75
  v_cvt_pk_bf16_f32 v230, v76, v77
  v_cvt_pk_bf16_f32 v231, v78, v79
  v_mfma_f32_32x32x16_bf16 v[64:79], v[96:99], v[24:27], 0
  buffer_load_dwordx4 v[132:135], v10, s[4:7], s30 offen offset:1024
  v_exp_f32 v48, v48
  v_exp_f32 v49, v49
  v_exp_f32 v50, v50
  v_exp_f32 v51, v51
  v_mfma_f32_32x32x16_bf16 v[192:207], v[92:95], v[228:231], v[192:207]
  buffer_load_dwordx4 v[136:139], v10, s[4:7], s30 offen offset:2048
  v_exp_f32 v52, v52
  v_exp_f32 v53, v53
  v_exp_f32 v54, v54
  v_smfmac_f32_16x16x64_bf16 v[220:223], v[12:15], v[224:231], v11
  buffer_load_dwordx4 v[140:143], v10, s[4:7], s30 offen offset:3072
  v_exp_f32 v55, v55
  v_mfma_f32_32x32x16_bf16 v[64:79], v[100:103], v[28:31], v[64:79]
  s_ff1_i32_b32 s33, s36
  v_cvt_pk_bf16_f32 v224, v48, v49
  v_cvt_pk_bf16_f32 v225, v50, v51
  v_cvt_pk_bf16_f32 v226, v52, v53
  v_cvt_pk_bf16_f32 v227, v54, v55
  v_exp_f32 v56, v56
  v_exp_f32 v57, v57
  v_exp_f32 v58, v58
  v_exp_f32 v59, v59
  v_mfma_f32_32x32x16_bf16 v[144:159], v[104:107], v[224:227], v[144:159]
  s_bitset0_b32 s36, s33
  v_exp_f32 v60, v60
  v_exp_f32 v61, v61
  v_exp_f32 v62, v62
  v_exp_f32 v63, v63
  v_cvt_pk_bf16_f32 v228, v56, v57
  v_cvt_pk_bf16_f32 v229, v58, v59
  v_cvt_pk_bf16_f32 v230, v60, v61
  v_cvt_pk_bf16_f32 v231, v62, v63
  v_mfma_f32_32x32x16_bf16 v[48:63], v[96:99], v[32:35], 0
  s_lshl_b32 s33, s33, 14
  v_exp_f32 v64, v64
  v_exp_f32 v65, v65
  v_exp_f32 v66, v66
  v_exp_f32 v67, v67
  v_mfma_f32_32x32x16_bf16 v[144:159], v[108:111], v[228:231], v[144:159]
  s_add_u32 s30, s33, s35
  v_exp_f32 v68, v68
  v_exp_f32 v69, v69
  v_exp_f32 v70, v70
  v_smfmac_f32_16x16x64_bf16 v[208:211], v[12:15], v[224:231], v11
  buffer_load_dwordx4 v[80:83], v3, s[4:7], s30 offen offset:0
  v_exp_f32 v71, v71
  v_mfma_f32_32x32x16_bf16 v[48:63], v[100:103], v[36:39], v[48:63]
  buffer_load_dwordx4 v[84:87], v3, s[4:7], s30 offen offset:1024
  v_cvt_pk_bf16_f32 v224, v64, v65
  v_cvt_pk_bf16_f32 v225, v66, v67
  v_cvt_pk_bf16_f32 v226, v68, v69
  v_cvt_pk_bf16_f32 v227, v70, v71
  v_exp_f32 v72, v72
  v_exp_f32 v73, v73
  v_exp_f32 v74, v74
  v_exp_f32 v75, v75
  v_mfma_f32_32x32x16_bf16 v[160:175], v[104:107], v[224:227], v[160:175]
  buffer_load_dwordx4 v[88:91], v3, s[4:7], s30 offen offset:2048
  v_exp_f32 v76, v76
  v_exp_f32 v77, v77
  v_exp_f32 v78, v78
  v_exp_f32 v79, v79
  v_cvt_pk_bf16_f32 v228, v72, v73
  v_cvt_pk_bf16_f32 v229, v74, v75
  v_cvt_pk_bf16_f32 v230, v76, v77
  v_cvt_pk_bf16_f32 v231, v78, v79
  v_mfma_f32_32x32x16_bf16 v[64:79], v[96:99], v[40:43], 0
  buffer_load_dwordx4 v[92:95], v3, s[4:7], s30 offen offset:3072
  v_exp_f32 v48, v48
  v_exp_f32 v49, v49
  v_exp_f32 v50, v50
  v_exp_f32 v51, v51
  v_mfma_f32_32x32x16_bf16 v[160:175], v[108:111], v[228:231], v[160:175]
  v_exp_f32 v52, v52
  v_exp_f32 v53, v53
  v_exp_f32 v54, v54
  v_smfmac_f32_16x16x64_bf16 v[212:215], v[12:15], v[224:231], v11
  v_exp_f32 v55, v55
  v_mfma_f32_32x32x16_bf16 v[64:79], v[100:103], v[44:47], v[64:79]
  v_cvt_pk_bf16_f32 v224, v48, v49
  v_cvt_pk_bf16_f32 v225, v50, v51
  v_cvt_pk_bf16_f32 v226, v52, v53
  v_cvt_pk_bf16_f32 v227, v54, v55
  v_exp_f32 v56, v56
  v_exp_f32 v57, v57
  v_exp_f32 v58, v58
  v_exp_f32 v59, v59
  v_mfma_f32_32x32x16_bf16 v[176:191], v[104:107], v[224:227], v[176:191]
  s_waitcnt vmcnt(10)
  v_exp_f32 v60, v60
  v_exp_f32 v61, v61
  v_exp_f32 v62, v62
  v_exp_f32 v63, v63
  v_cvt_pk_bf16_f32 v228, v56, v57
  v_cvt_pk_bf16_f32 v229, v58, v59
  v_cvt_pk_bf16_f32 v230, v60, v61
  v_cvt_pk_bf16_f32 v231, v62, v63
  v_mfma_f32_32x32x16_bf16 v[48:63], v[112:115], v[16:19], 0
  v_exp_f32 v64, v64
  v_exp_f32 v65, v65
  v_exp_f32 v66, v66
  v_exp_f32 v67, v67
  v_mfma_f32_32x32x16_bf16 v[176:191], v[108:111], v[228:231], v[176:191]
  buffer_load_dwordx4 v[96:99], v10, s[4:7], s30 offen offset:0
  v_exp_f32 v68, v68
  v_exp_f32 v69, v69
  v_exp_f32 v70, v70
  v_smfmac_f32_16x16x64_bf16 v[216:219], v[12:15], v[224:231], v11
  v_exp_f32 v71, v71
  v_mfma_f32_32x32x16_bf16 v[48:63], v[116:119], v[20:23], v[48:63]
  v_cvt_pk_bf16_f32 v224, v64, v65
  v_cvt_pk_bf16_f32 v225, v66, v67
  v_cvt_pk_bf16_f32 v226, v68, v69
  v_cvt_pk_bf16_f32 v227, v70, v71
  v_exp_f32 v72, v72
  v_exp_f32 v73, v73
  v_exp_f32 v74, v74
  v_exp_f32 v75, v75
  v_mfma_f32_32x32x16_bf16 v[192:207], v[104:107], v[224:227], v[192:207]
  v_exp_f32 v76, v76
  v_exp_f32 v77, v77
  v_exp_f32 v78, v78
  v_exp_f32 v79, v79
  v_cvt_pk_bf16_f32 v228, v72, v73
  v_cvt_pk_bf16_f32 v229, v74, v75
  v_cvt_pk_bf16_f32 v230, v76, v77
  v_cvt_pk_bf16_f32 v231, v78, v79
  s_branch .fz_kernel_a_b2
  .p2align 6
.fz_kernel_a_loop:
  v_mfma_f32_32x32x16_bf16 v[64:79], v[80:83], v[24:27], 0
  v_exp_f32 v48, v48
  v_exp_f32 v49, v49
  v_exp_f32 v50, v50
  v_exp_f32 v51, v51
  v_mfma_f32_32x32x16_bf16 v[192:207], v[140:143], v[228:231], v[192:207]
  v_exp_f32 v52, v52
  v_exp_f32 v53, v53
  v_exp_f32 v54, v54
  v_smfmac_f32_16x16x64_bf16 v[220:223], v[12:15], v[224:231], v11
  buffer_load_dwordx4 v[132:135], v10, s[4:7], s30 offen offset:1024
  v_exp_f32 v55, v55
  v_mfma_f32_32x32x16_bf16 v[64:79], v[84:87], v[28:31], v[64:79]
  s_waitcnt vmcnt(10)
  v_cvt_pk_bf16_f32 v224, v48, v49
  v_cvt_pk_bf16_f32 v225, v50, v51
  v_cvt_pk_bf16_f32 v226, v52, v53
  v_cvt_pk_bf16_f32 v227, v54, v55
  v_exp_f32 v56, v56
  v_exp_f32 v57, v57
  v_exp_f32 v58, v58
  v_exp_f32 v59, v59
  v_mfma_f32_32x32x16_bf16 v[144:159], v[88:91], v[224:227], v[144:159]
  v_exp_f32 v60, v60
  v_exp_f32 v61, v61
  v_exp_f32 v62, v62
  v_exp_f32 v63, v63
  v_cvt_pk_bf16_f32 v228, v56, v57
  v_cvt_pk_bf16_f32 v229, v58, v59
  v_cvt_pk_bf16_f32 v230, v60, v61
  v_cvt_pk_bf16_f32 v231, v62, v63
  v_mfma_f32_32x32x16_bf16 v[48:63], v[80:83], v[32:35], 0
  v_exp_f32 v64, v64
  v_exp_f32 v65, v65
  v_exp_f32 v66, v66
  v_exp_f32 v67, v67
  v_mfma_f32_32x32x16_bf16 v[144:159], v[92:95], v[228:231], v[144:159]
  v_exp_f32 v68, v68
  v_exp_f32 v69, v69
  v_exp_f32 v70, v70
  v_smfmac_f32_16x16x64_bf16 v[208:211], v[12:15], v[224:231], v11
  buffer_load_dwordx4 v[136:139], v10, s[4:7], s30 offen offset:2048
  v_exp_f32 v71, v71
  v_mfma_f32_32x32x16_bf16 v[48:63], v[84:87], v[36:39], v[48:63]
  s_ff1_i32_b32 s33, s36
  v_cvt_pk_bf16_f32 v224, v64, v65
  v_cvt_pk_bf16_f32 v225, v66, v67
  v_cvt_pk_bf16_f32 v226, v68, v69
  v_cvt_pk_bf16_f32 v227, v70, v71
  v_exp_f32 v72, v72
  v_exp_f32 v73, v73
  v_exp_f32 v74, v74
  v_exp_f32 v75, v75
  v_mfma_f32_32x32x16_bf16 v[160:175], v[88:91], v[224:227], v[160:175]
  s_bitset0_b32 s36, s33
  v_exp_f32 v76, v76
  v_exp_f32 v77, v77
  v_exp_f32 v78, v78
  v_exp_f32 v79, v79
  v_cvt_pk_bf16_f32 v228, v72, v73
  v_cvt_pk_bf16_f32 v229, v74, v75
  v_cvt_pk_bf16_f32 v230, v76, v77
  v_cvt_pk_bf16_f32 v231, v78, v79
  v_mfma_f32_32x32x16_bf16 v[64:79], v[80:83], v[40:43], 0
  s_lshl_b32 s33, s33, 14
  v_exp_f32 v48, v48
  v_exp_f32 v49, v49
  v_exp_f32 v50, v50
  v_exp_f32 v51, v51
  v_mfma_f32_32x32x16_bf16 v[160:175], v[92:95], v[228:231], v[160:175]
  v_exp_f32 v52, v52
  v_exp_f32 v53, v53
  v_exp_f32 v54, v54
  v_smfmac_f32_16x16x64_bf16 v[212:215], v[12:15], v[224:231], v11
  buffer_load_dwordx4 v[140:143], v10, s[4:7], s30 offen offset:3072
  v_exp_f32 v55, v55
  v_mfma_f32_32x32x16_bf16 v[64:79], v[84:87], v[44:47], v[64:79]
  s_add_u32 s30, s33, s35
  v_cvt_pk_bf16_f32 v224, v48, v49
  v_cvt_pk_bf16_f32 v225, v50, v51
  v_cvt_pk_bf16_f32 v226, v52, v53
  v_cvt_pk_bf16_f32 v227, v54, v55
  v_exp_f32 v56, v56
  v_exp_f32 v57, v57
  v_exp_f32 v58, v58
  v_exp_f32 v59, v59
  v_mfma_f32_32x32x16_bf16 v[176:191], v[88:91], v[224:227], v[176:191]
  s_waitcnt vmcnt(10)
  v_exp_f32 v60, v60
  v_exp_f32 v61, v61
  v_exp_f32 v62, v62
  v_exp_f32 v63, v63
  v_cvt_pk_bf16_f32 v228, v56, v57
  v_cvt_pk_bf16_f32 v229, v58, v59
  v_cvt_pk_bf16_f32 v230, v60, v61
  v_cvt_pk_bf16_f32 v231, v62, v63
  v_mfma_f32_32x32x16_bf16 v[48:63], v[96:99], v[16:19], 0
  s_cbranch_scc1 .fz_kernel_pk38c
.fz_kernel_pk38:
  v_exp_f32 v64, v64
  v_exp_f32 v65, v65
  v_exp_f32 v66, v66
  v_exp_f32 v67, v67
  v_mfma_f32_32x32x16_bf16 v[176:191], v[92:95], v[228:231], v[176:191]
  v_exp_f32 v68, v68
  v_exp_f32 v69, v69
  v_exp_f32 v70, v70
  v_smfmac_f32_16x16x64_bf16 v[216:219], v[12:15], v[224:231], v11
  buffer_load_dwordx4 v[80:83], v3, s[4:7], s30 offen offset:0
  v_exp_f32 v71, v71
  v_mfma_f32_32x32x16_bf16 v[48:63], v[100:103], v[20:23], v[48:63]
  v_cvt_pk_bf16_f32 v224, v64, v65
  v_cvt_pk_bf16_f32 v225, v66, v67
  v_cvt_pk_bf16_f32 v226, v68, v69
  v_cvt_pk_bf16_f32 v227, v70, v71
  v_exp_f32 v72, v72
  v_exp_f32 v73, v73
  v_exp_f32 v74, v74
  v_exp_f32 v75, v75
  v_mfma_f32_32x32x16_bf16 v[192:207], v[88:91], v[224:227], v[192:207]
  v_exp_f32 v76, v76
  v_exp_f32 v77, v77
  v_exp_f32 v78, v78
  v_exp_f32 v79, v79
  v_cvt_pk_bf16_f32 v228, v72, v73
  v_cvt_pk_bf16_f32 v229, v74, v75
  v_cvt_pk_bf16_f32 v230, v76, v77
  v_cvt_pk_bf16_f32 v231, v78, v79
  v_mfma_f32_32x32x16_bf16 v[64:79], v[96:99], v[24:27], 0
  v_exp_f32 v48, v48
  v_exp_f32 v49, v49
  v_exp_f32 v50, v50
  v_exp_f32 v51, v51
  v_mfma_f32_32x32x16_bf16 v[192:207], v[92:95], v[228:231], v[192:207]
  v_exp_f32 v52, v52
  v_exp_f32 v53, v53
  v_exp_f32 v54, v54
  v_smfmac_f32_16x16x64_bf16 v[220:223], v[12:15], v[224:231], v11
  buffer_load_dwordx4 v[84:87], v3, s[4:7], s30 offen offset:1024
  v_exp_f32 v55, v55
  v_mfma_f32_32x32x16_bf16 v[64:79], v[100:103], v[28:31], v[64:79]
  s_waitcnt vmcnt(10)
  v_cvt_pk_bf16_f32 v224, v48, v49
  v_cvt_pk_bf16_f32 v225, v50, v51
  v_cvt_pk_bf16_f32 v226, v52, v53
  v_cvt_pk_bf16_f32 v227, v54, v55
  v_exp_f32 v56, v56
  v_exp_f32 v57, v57
  v_exp_f32 v58, v58
  v_exp_f32 v59, v59
  v_mfma_f32_32x32x16_bf16 v[144:159], v[104:107], v[224:227], v[144:159]
  v_exp_f32 v60, v60
  v_exp_f32 v61, v61
  v_exp_f32 v62, v62
  v_exp_f32 v63, v63
  v_cvt_pk_bf16_f32 v228, v56, v57
  v_cvt_pk_bf16_f32 v229, v58, v59
  v_cvt_pk_bf16_f32 v230, v60, v61
  v_cvt_pk_bf16_f32 v231, v62, v63
  v_mfma_f32_32x32x16_bf16 v[48:63], v[96:99], v[32:35], 0
  v_exp_f32 v64, v64
  v_exp_f32 v65, v65
  v_exp_f32 v66, v66
  v_exp_f32 v67, v67
  v_mfma_f32_32x32x16_bf16 v[144:159], v[108:111], v[228:231], v[144:159]
  v_exp_f32 v68, v68
  v_exp_f32 v69, v69
  v_exp_f32 v70, v70
  v_smfmac_f32_16x16x64_bf16 v[208:211], v[12:15], v[224:231], v11
  buffer_load_dwordx4 v[88:91], v3, s[4:7], s30 offen offset:2048
  v_exp_f32 v71, v71
  v_mfma_f32_32x32x16_bf16 v[48:63], v[100:103], v[36:39], v[48:63]
  v_cvt_pk_bf16_f32 v224, v64, v65
  v_cvt_pk_bf16_f32 v225, v66, v67
  v_cvt_pk_bf16_f32 v226, v68, v69
  v_cvt_pk_bf16_f32 v227, v70, v71
  v_exp_f32 v72, v72
  v_exp_f32 v73, v73
  v_exp_f32 v74, v74
  v_exp_f32 v75, v75
  v_mfma_f32_32x32x16_bf16 v[160:175], v[104:107], v[224:227], v[160:175]
  v_exp_f32 v76, v76
  v_exp_f32 v77, v77
  v_exp_f32 v78, v78
  v_exp_f32 v79, v79
  v_cvt_pk_bf16_f32 v228, v72, v73
  v_cvt_pk_bf16_f32 v229, v74, v75
  v_cvt_pk_bf16_f32 v230, v76, v77
  v_cvt_pk_bf16_f32 v231, v78, v79
  v_mfma_f32_32x32x16_bf16 v[64:79], v[96:99], v[40:43], 0
  v_exp_f32 v48, v48
  v_exp_f32 v49, v49
  v_exp_f32 v50, v50
  v_exp_f32 v51, v51
  v_mfma_f32_32x32x16_bf16 v[160:175], v[108:111], v[228:231], v[160:175]
  v_exp_f32 v52, v52
  v_exp_f32 v53, v53
  v_exp_f32 v54, v54
  v_smfmac_f32_16x16x64_bf16 v[212:215], v[12:15], v[224:231], v11
  buffer_load_dwordx4 v[92:95], v3, s[4:7], s30 offen offset:3072
  v_exp_f32 v55, v55
  v_mfma_f32_32x32x16_bf16 v[64:79], v[100:103], v[44:47], v[64:79]
  v_cvt_pk_bf16_f32 v224, v48, v49
  v_cvt_pk_bf16_f32 v225, v50, v51
  v_cvt_pk_bf16_f32 v226, v52, v53
  v_cvt_pk_bf16_f32 v227, v54, v55
  v_exp_f32 v56, v56
  v_exp_f32 v57, v57
  v_exp_f32 v58, v58
  v_exp_f32 v59, v59
  v_mfma_f32_32x32x16_bf16 v[176:191], v[104:107], v[224:227], v[176:191]
  s_waitcnt vmcnt(10)
  v_exp_f32 v60, v60
  v_exp_f32 v61, v61
  v_exp_f32 v62, v62
  v_exp_f32 v63, v63
  v_cvt_pk_bf16_f32 v228, v56, v57
  v_cvt_pk_bf16_f32 v229, v58, v59
  v_cvt_pk_bf16_f32 v230, v60, v61
  v_cvt_pk_bf16_f32 v231, v62, v63
  v_mfma_f32_32x32x16_bf16 v[48:63], v[112:115], v[16:19], 0
  v_exp_f32 v64, v64
  v_exp_f32 v65, v65
  v_exp_f32 v66, v66
  v_exp_f32 v67, v67
  v_mfma_f32_32x32x16_bf16 v[176:191], v[108:111], v[228:231], v[176:191]
  v_exp_f32 v68, v68
  v_exp_f32 v69, v69
  v_exp_f32 v70, v70
  v_smfmac_f32_16x16x64_bf16 v[216:219], v[12:15], v[224:231], v11
  buffer_load_dwordx4 v[96:99], v10, s[4:7], s30 offen offset:0
  v_exp_f32 v71, v71
  v_mfma_f32_32x32x16_bf16 v[48:63], v[116:119], v[20:23], v[48:63]
  s_sub_u32 s32, s32, 1
  v_cvt_pk_bf16_f32 v224, v64, v65
  v_cvt_pk_bf16_f32 v225, v66, v67
  v_cvt_pk_bf16_f32 v226, v68, v69
  v_cvt_pk_bf16_f32 v227, v70, v71
  v_exp_f32 v72, v72
  v_exp_f32 v73, v73
  v_exp_f32 v74, v74
  v_exp_f32 v75, v75
  v_mfma_f32_32x32x16_bf16 v[192:207], v[104:107], v[224:227], v[192:207]
  s_cmp_eq_u32 s32, 0
  v_exp_f32 v76, v76
  v_exp_f32 v77, v77
  v_exp_f32 v78, v78
  v_exp_f32 v79, v79
  v_cvt_pk_bf16_f32 v228, v72, v73
  v_cvt_pk_bf16_f32 v229, v74, v75
  v_cvt_pk_bf16_f32 v230, v76, v77
  v_cvt_pk_bf16_f32 v231, v78, v79
  s_cbranch_scc1 .fz_kernel_a_x
.fz_kernel_a_b2:
  v_mfma_f32_32x32x16_bf16 v[64:79], v[112:115], v[24:27], 0
  v_exp_f32 v48, v48
  v_exp_f32 v49, v49
  v_exp_f32 v50, v50
  v_exp_f32 v51, v51
  v_mfma_f32_32x32x16_bf16 v[192:207], v[108:111], v[228:231], v[192:207]
  v_exp_f32 v52, v52
  v_exp_f32 v53, v53
  v_exp_f32 v54, v54
  v_smfmac_f32_16x16x64_bf16 v[220:223], v[12:15], v[224:231], v11
  buffer_load_dwordx4 v[100:103], v10, s[4:7], s30 offen offset:1024
  v_exp_f32 v55, v55
  v_mfma_f32_32x32x16_bf16 v[64:79], v[116:119], v[28:31], v[64:79]
  s_waitcnt vmcnt(10)
  v_cvt_pk_bf16_f32 v224, v48, v49
  v_cvt_pk_bf16_f32 v225, v50, v51
  v_cvt_pk_bf16_f32 v226, v52, v53
  v_cvt_pk_bf16_f32 v227, v54, v55
  v_exp_f32 v56, v56
  v_exp_f32 v57, v57
  v_exp_f32 v58, v58
  v_exp_f32 v59, v59
  v_mfma_f32_32x32x16_bf16 v[144:159], v[120:123], v[224:227], v[144:159]
  v_exp_f32 v60, v60
  v_exp_f32 v61, v61
  v_exp_f32 v62, v62
  v_exp_f32 v63, v63
  v_cvt_pk_bf16_f32 v228, v56, v57
  v_cvt_pk_bf16_f32 v229, v58, v59
  v_cvt_pk_bf16_f32 v230, v60, v61
  v_cvt_pk_bf16_f32 v231, v62, v63
  v_mfma_f32_32x32x16_bf16 v[48:63], v[112:115], v[32:35], 0
  v_exp_f32 v64, v64
  v_exp_f32 v65, v65
  v_exp_f32 v66, v66
  v_exp_f32 v67, v67
  v_mfma_f32_32x32x16_bf16 v[144:159], v[124:127], v[228:231], v[144:159]
  v_exp_f32 v68, v68
  v_exp_f32 v69, v69
  v_exp_f32 v70, v70
  v_smfmac_f32_16x16x64_bf16 v[208:211], v[12:15], v[224:231], v11
  buffer_load_dwordx4 v[104:107], v10, s[4:7], s30 offen offset:2048
  v_exp_f32 v71, v71
  v_mfma_f32_32x32x16_bf16 v[48:63], v[116:119], v[36:39], v[48:63]
  s_ff1_i32_b32 s33, s36
  v_cvt_pk_bf16_f32 v224, v64, v65
  v_cvt_pk_bf16_f32 v225, v66, v67
  v_cvt_pk_bf16_f32 v226, v68, v69
  v_cvt_pk_bf16_f32 v227, v70, v71
  v_exp_f32 v72, v72
  v_exp_f32 v73, v73
  v_exp_f32 v74, v74
  v_exp_f32 v75, v75
  v_mfma_f32_32x32x16_bf16 v[160:175], v[120:123], v[224:227], v[160:175]
  s_bitset0_b32 s36, s33
  v_exp_f32 v76, v76
  v_exp_f32 v77, v77
  v_exp_f32 v78, v78
  v_exp_f32 v79, v79
  v_cvt_pk_bf16_f32 v228, v72, v73
  v_cvt_pk_bf16_f32 v229, v74, v75
  v_cvt_pk_bf16_f32 v230, v76, v77
  v_cvt_pk_bf16_f32 v231, v78, v79
  v_mfma_f32_32x32x16_bf16 v[64:79], v[112:115], v[40:43], 0
  s_lshl_b32 s33, s33, 14
  v_exp_f32 v48, v48
  v_exp_f32 v49, v49
  v_exp_f32 v50, v50
  v_exp_f32 v51, v51
  v_mfma_f32_32x32x16_bf16 v[160:175], v[124:127], v[228:231], v[160:175]
  v_exp_f32 v52, v52
  v_exp_f32 v53, v53
  v_exp_f32 v54, v54
  v_smfmac_f32_16x16x64_bf16 v[212:215], v[12:15], v[224:231], v11
  buffer_load_dwordx4 v[108:111], v10, s[4:7], s30 offen offset:3072
  v_exp_f32 v55, v55
  v_mfma_f32_32x32x16_bf16 v[64:79], v[116:119], v[44:47], v[64:79]
  s_add_u32 s30, s33, s35
  v_cvt_pk_bf16_f32 v224, v48, v49
  v_cvt_pk_bf16_f32 v225, v50, v51
  v_cvt_pk_bf16_f32 v226, v52, v53
  v_cvt_pk_bf16_f32 v227, v54, v55
  v_exp_f32 v56, v56
  v_exp_f32 v57, v57
  v_exp_f32 v58, v58
  v_exp_f32 v59, v59
  v_mfma_f32_32x32x16_bf16 v[176:191], v[120:123], v[224:227], v[176:191]
  s_waitcnt vmcnt(10)
  v_exp_f32 v60, v60
  v_exp_f32 v61, v61
  v_exp_f32 v62, v62
  v_exp_f32 v63, v63
  v_cvt_pk_bf16_f32 v228, v56, v57
  v_cvt_pk_bf16_f32 v229, v58, v59
  v_cvt_pk_bf16_f32 v230, v60, v61
  v_cvt_pk_bf16_f32 v231, v62, v63
  v_mfma_f32_32x32x16_bf16 v[48:63], v[128:131], v[16:19], 0
  s_cbranch_scc1 .fz_kernel_pk39c
.fz_kernel_pk39:
  v_exp_f32 v64, v64
  v_exp_f32 v65, v65
  v_exp_f32 v66, v66
  v_exp_f32 v67, v67
  v_mfma_f32_32x32x16_bf16 v[176:191], v[124:127], v[228:231], v[176:191]
  v_exp_f32 v68, v68
  v_exp_f32 v69, v69
  v_exp_f32 v70, v70
  v_smfmac_f32_16x16x64_bf16 v[216:219], v[12:15], v[224:231], v11
  buffer_load_dwordx4 v[112:115], v3, s[4:7], s30 offen offset:0
  v_exp_f32 v71, v71
  v_mfma_f32_32x32x16_bf16 v[48:63], v[132:135], v[20:23], v[48:63]
  v_cvt_pk_bf16_f32 v224, v64, v65
  v_cvt_pk_bf16_f32 v225, v66, v67
  v_cvt_pk_bf16_f32 v226, v68, v69
  v_cvt_pk_bf16_f32 v227, v70, v71
  v_exp_f32 v72, v72
  v_exp_f32 v73, v73
  v_exp_f32 v74, v74
  v_exp_f32 v75, v75
  v_mfma_f32_32x32x16_bf16 v[192:207], v[120:123], v[224:227], v[192:207]
  v_exp_f32 v76, v76
  v_exp_f32 v77, v77
  v_exp_f32 v78, v78
  v_exp_f32 v79, v79
  v_cvt_pk_bf16_f32 v228, v72, v73
  v_cvt_pk_bf16_f32 v229, v74, v75
  v_cvt_pk_bf16_f32 v230, v76, v77
  v_cvt_pk_bf16_f32 v231, v78, v79
  v_mfma_f32_32x32x16_bf16 v[64:79], v[128:131], v[24:27], 0
  v_exp_f32 v48, v48
  v_exp_f32 v49, v49
  v_exp_f32 v50, v50
  v_exp_f32 v51, v51
  v_mfma_f32_32x32x16_bf16 v[192:207], v[124:127], v[228:231], v[192:207]
  v_exp_f32 v52, v52
  v_exp_f32 v53, v53
  v_exp_f32 v54, v54
  v_smfmac_f32_16x16x64_bf16 v[220:223], v[12:15], v[224:231], v11
  buffer_load_dwordx4 v[116:119], v3, s[4:7], s30 offen offset:1024
  v_exp_f32 v55, v55
  v_mfma_f32_32x32x16_bf16 v[64:79], v[132:135], v[28:31], v[64:79]
  s_waitcnt vmcnt(10)
  v_cvt_pk_bf16_f32 v224, v48, v49
  v_cvt_pk_bf16_f32 v225, v50, v51
  v_cvt_pk_bf16_f32 v226, v52, v53
  v_cvt_pk_bf16_f32 v227, v54, v55
  v_exp_f32 v56, v56
  v_exp_f32 v57, v57
  v_exp_f32 v58, v58
  v_exp_f32 v59, v59
  v_mfma_f32_32x32x16_bf16 v[144:159], v[136:139], v[224:227], v[144:159]
  v_exp_f32 v60, v60
  v_exp_f32 v61, v61
  v_exp_f32 v62, v62
  v_exp_f32 v63, v63
  v_cvt_pk_bf16_f32 v228, v56, v57
  v_cvt_pk_bf16_f32 v229, v58, v59
  v_cvt_pk_bf16_f32 v230, v60, v61
  v_cvt_pk_bf16_f32 v231, v62, v63
  v_mfma_f32_32x32x16_bf16 v[48:63], v[128:131], v[32:35], 0
  v_exp_f32 v64, v64
  v_exp_f32 v65, v65
  v_exp_f32 v66, v66
  v_exp_f32 v67, v67
  v_mfma_f32_32x32x16_bf16 v[144:159], v[140:143], v[228:231], v[144:159]
  v_exp_f32 v68, v68
  v_exp_f32 v69, v69
  v_exp_f32 v70, v70
  v_smfmac_f32_16x16x64_bf16 v[208:211], v[12:15], v[224:231], v11
  buffer_load_dwordx4 v[120:123], v3, s[4:7], s30 offen offset:2048
  v_exp_f32 v71, v71
  v_mfma_f32_32x32x16_bf16 v[48:63], v[132:135], v[36:39], v[48:63]
  v_cvt_pk_bf16_f32 v224, v64, v65
  v_cvt_pk_bf16_f32 v225, v66, v67
  v_cvt_pk_bf16_f32 v226, v68, v69
  v_cvt_pk_bf16_f32 v227, v70, v71
  v_exp_f32 v72, v72
  v_exp_f32 v73, v73
  v_exp_f32 v74, v74
  v_exp_f32 v75, v75
  v_mfma_f32_32x32x16_bf16 v[160:175], v[136:139], v[224:227], v[160:175]
  v_exp_f32 v76, v76
  v_exp_f32 v77, v77
  v_exp_f32 v78, v78
  v_exp_f32 v79, v79
  v_cvt_pk_bf16_f32 v228, v72, v73
  v_cvt_pk_bf16_f32 v229, v74, v75
  v_cvt_pk_bf16_f32 v230, v76, v77
  v_cvt_pk_bf16_f32 v231, v78, v79
  v_mfma_f32_32x32x16_bf16 v[64:79], v[128:131], v[40:43], 0
  v_exp_f32 v48, v48
  v_exp_f32 v49, v49
  v_exp_f32 v50, v50
  v_exp_f32 v51, v51
  v_mfma_f32_32x32x16_bf16 v[160:175], v[140:143], v[228:231], v[160:175]
  v_exp_f32 v52, v52
  v_exp_f32 v53, v53
  v_exp_f32 v54, v54
  v_smfmac_f32_16x16x64_bf16 v[212:215], v[12:15], v[224:231], v11
  buffer_load_dwordx4 v[124:127], v3, s[4:7], s30 offen offset:3072
  v_exp_f32 v55, v55
  v_mfma_f32_32x32x16_bf16 v[64:79], v[132:135], v[44:47], v[64:79]
  v_cvt_pk_bf16_f32 v224, v48, v49
  v_cvt_pk_bf16_f32 v225, v50, v51
  v_cvt_pk_bf16_f32 v226, v52, v53
  v_cvt_pk_bf16_f32 v227, v54, v55
  v_exp_f32 v56, v56
  v_exp_f32 v57, v57
  v_exp_f32 v58, v58
  v_exp_f32 v59, v59
  v_mfma_f32_32x32x16_bf16 v[176:191], v[136:139], v[224:227], v[176:191]
  s_waitcnt vmcnt(10)
  v_exp_f32 v60, v60
  v_exp_f32 v61, v61
  v_exp_f32 v62, v62
  v_exp_f32 v63, v63
  v_cvt_pk_bf16_f32 v228, v56, v57
  v_cvt_pk_bf16_f32 v229, v58, v59
  v_cvt_pk_bf16_f32 v230, v60, v61
  v_cvt_pk_bf16_f32 v231, v62, v63
  v_mfma_f32_32x32x16_bf16 v[48:63], v[80:83], v[16:19], 0
  v_exp_f32 v64, v64
  v_exp_f32 v65, v65
  v_exp_f32 v66, v66
  v_exp_f32 v67, v67
  v_mfma_f32_32x32x16_bf16 v[176:191], v[140:143], v[228:231], v[176:191]
  v_exp_f32 v68, v68
  v_exp_f32 v69, v69
  v_exp_f32 v70, v70
  v_smfmac_f32_16x16x64_bf16 v[216:219], v[12:15], v[224:231], v11
  buffer_load_dwordx4 v[128:131], v10, s[4:7], s30 offen offset:0
  v_exp_f32 v71, v71
  v_mfma_f32_32x32x16_bf16 v[48:63], v[84:87], v[20:23], v[48:63]
  v_cvt_pk_bf16_f32 v224, v64, v65
  v_cvt_pk_bf16_f32 v225, v66, v67
  v_cvt_pk_bf16_f32 v226, v68, v69
  v_cvt_pk_bf16_f32 v227, v70, v71
  v_exp_f32 v72, v72
  v_exp_f32 v73, v73
  v_exp_f32 v74, v74
  v_exp_f32 v75, v75
  v_mfma_f32_32x32x16_bf16 v[192:207], v[136:139], v[224:227], v[192:207]
  v_exp_f32 v76, v76
  v_exp_f32 v77, v77
  v_exp_f32 v78, v78
  v_exp_f32 v79, v79
  v_cvt_pk_bf16_f32 v228, v72, v73
  v_cvt_pk_bf16_f32 v229, v74, v75
  v_cvt_pk_bf16_f32 v230, v76, v77
  v_cvt_pk_bf16_f32 v231, v78, v79
  s_branch .fz_kernel_a_loop
.fz_kernel_a_x:
  s_waitcnt vmcnt(7)
  v_mfma_f32_32x32x16_bf16 v[64:79], v[128:131], v[16:19], 0
  v_exp_f32 v48, v48
  v_exp_f32 v49, v49
  v_exp_f32 v50, v50
  v_exp_f32 v51, v51
  v_mfma_f32_32x32x16_bf16 v[192:207], v[108:111], v[228:231], v[192:207]
  v_exp_f32 v52, v52
  v_exp_f32 v53, v53
  v_exp_f32 v54, v54
  v_smfmac_f32_16x16x64_bf16 v[220:223], v[12:15], v[224:231], v11
  v_exp_f32 v55, v55
  v_mfma_f32_32x32x16_bf16 v[64:79], v[132:135], v[20:23], v[64:79]
  s_waitcnt vmcnt(5)
  v_cvt_pk_bf16_f32 v224, v48, v49
  v_cvt_pk_bf16_f32 v225, v50, v51
  v_cvt_pk_bf16_f32 v226, v52, v53
  v_cvt_pk_bf16_f32 v227, v54, v55
  v_exp_f32 v56, v56
  v_exp_f32 v57, v57
  v_exp_f32 v58, v58
  v_exp_f32 v59, v59
  v_mfma_f32_32x32x16_bf16 v[144:159], v[120:123], v[224:227], v[144:159]
  v_exp_f32 v60, v60
  v_exp_f32 v61, v61
  v_exp_f32 v62, v62
  v_exp_f32 v63, v63
  v_cvt_pk_bf16_f32 v228, v56, v57
  v_cvt_pk_bf16_f32 v229, v58, v59
  v_cvt_pk_bf16_f32 v230, v60, v61
  v_cvt_pk_bf16_f32 v231, v62, v63
  v_mfma_f32_32x32x16_bf16 v[48:63], v[112:115], v[24:27], 0
  v_exp_f32 v64, v64
  v_exp_f32 v65, v65
  v_exp_f32 v66, v66
  v_exp_f32 v67, v67
  v_mfma_f32_32x32x16_bf16 v[144:159], v[124:127], v[228:231], v[144:159]
  v_exp_f32 v68, v68
  v_exp_f32 v69, v69
  v_exp_f32 v70, v70
  v_smfmac_f32_16x16x64_bf16 v[208:211], v[12:15], v[224:231], v11
  v_exp_f32 v71, v71
  v_mfma_f32_32x32x16_bf16 v[48:63], v[116:119], v[28:31], v[48:63]
  v_cvt_pk_bf16_f32 v224, v64, v65
  v_cvt_pk_bf16_f32 v225, v66, v67
  v_cvt_pk_bf16_f32 v226, v68, v69
  v_cvt_pk_bf16_f32 v227, v70, v71
  v_exp_f32 v72, v72
  v_exp_f32 v73, v73
  v_exp_f32 v74, v74
  v_exp_f32 v75, v75
  v_mfma_f32_32x32x16_bf16 v[144:159], v[136:139], v[224:227], v[144:159]
  v_exp_f32 v76, v76
  v_exp_f32 v77, v77
  v_exp_f32 v78, v78
  v_exp_f32 v79, v79
  v_cvt_pk_bf16_f32 v228, v72, v73
  v_cvt_pk_bf16_f32 v229, v74, v75
  v_cvt_pk_bf16_f32 v230, v76, v77
  v_cvt_pk_bf16_f32 v231, v78, v79
  v_mfma_f32_32x32x16_bf16 v[64:79], v[128:131], v[24:27], 0
  v_exp_f32 v48, v48
  v_exp_f32 v49, v49
  v_exp_f32 v50, v50
  v_exp_f32 v51, v51
  v_mfma_f32_32x32x16_bf16 v[144:159], v[140:143], v[228:231], v[144:159]
  v_exp_f32 v52, v52
  v_exp_f32 v53, v53
  v_exp_f32 v54, v54
  v_smfmac_f32_16x16x64_bf16 v[208:211], v[12:15], v[224:231], v11
  v_exp_f32 v55, v55
  v_mfma_f32_32x32x16_bf16 v[64:79], v[132:135], v[28:31], v[64:79]
  v_cvt_pk_bf16_f32 v224, v48, v49
  v_cvt_pk_bf16_f32 v225, v50, v51
  v_cvt_pk_bf16_f32 v226, v52, v53
  v_cvt_pk_bf16_f32 v227, v54, v55
  v_exp_f32 v56, v56
  v_exp_f32 v57, v57
  v_exp_f32 v58, v58
  v_exp_f32 v59, v59
  v_mfma_f32_32x32x16_bf16 v[160:175], v[120:123], v[224:227], v[160:175]
  v_exp_f32 v60, v60
  v_exp_f32 v61, v61
  v_exp_f32 v62, v62
  v_exp_f32 v63, v63
  v_cvt_pk_bf16_f32 v228, v56, v57
  v_cvt_pk_bf16_f32 v229, v58, v59
  v_cvt_pk_bf16_f32 v230, v60, v61
  v_cvt_pk_bf16_f32 v231, v62, v63
  v_cvt_pk_bf16_f32 v144, v144, v145
  v_cvt_pk_bf16_f32 v145, v146, v147
  v_cvt_pk_bf16_f32 v146, v148, v149
  v_cvt_pk_bf16_f32 v147, v150, v151
  ds_write_b128 v9, v[144:147] offset:0
  v_cvt_pk_bf16_f32 v148, v152, v153
  v_cvt_pk_bf16_f32 v149, v154, v155
  v_cvt_pk_bf16_f32 v150, v156, v157
  v_cvt_pk_bf16_f32 v151, v158, v159
  ds_write_b128 v9, v[148:151] offset:1024
  v_add_f32 v208, v208, v210
  v_add_f32 v209, v209, v211
  v_cndmask_b32 v30, v208, v209, s[26:27]
  v_mfma_f32_32x32x16_bf16 v[48:63], v[112:115], v[32:35], 0
  v_exp_f32 v64, v64
  v_exp_f32 v65, v65
  v_exp_f32 v66, v66
  v_exp_f32 v67, v67
  v_mfma_f32_32x32x16_bf16 v[160:175], v[124:127], v[228:231], v[160:175]
  v_exp_f32 v68, v68
  v_exp_f32 v69, v69
  v_exp_f32 v70, v70
  v_smfmac_f32_16x16x64_bf16 v[212:215], v[12:15], v[224:231], v11
  v_exp_f32 v71, v71
  v_mfma_f32_32x32x16_bf16 v[48:63], v[116:119], v[36:39], v[48:63]
  v_cvt_pk_bf16_f32 v224, v64, v65
  v_cvt_pk_bf16_f32 v225, v66, v67
  v_cvt_pk_bf16_f32 v226, v68, v69
  v_cvt_pk_bf16_f32 v227, v70, v71
  v_exp_f32 v72, v72
  v_exp_f32 v73, v73
  v_exp_f32 v74, v74
  v_exp_f32 v75, v75
  v_mfma_f32_32x32x16_bf16 v[160:175], v[136:139], v[224:227], v[160:175]
  v_exp_f32 v76, v76
  v_exp_f32 v77, v77
  v_exp_f32 v78, v78
  v_exp_f32 v79, v79
  v_cvt_pk_bf16_f32 v228, v72, v73
  v_cvt_pk_bf16_f32 v229, v74, v75
  v_cvt_pk_bf16_f32 v230, v76, v77
  v_cvt_pk_bf16_f32 v231, v78, v79
  v_mfma_f32_32x32x16_bf16 v[64:79], v[128:131], v[32:35], 0
  v_exp_f32 v48, v48
  v_exp_f32 v49, v49
  v_exp_f32 v50, v50
  v_exp_f32 v51, v51
  v_mfma_f32_32x32x16_bf16 v[160:175], v[140:143], v[228:231], v[160:175]
  v_exp_f32 v52, v52
  v_exp_f32 v53, v53
  v_exp_f32 v54, v54
  v_smfmac_f32_16x16x64_bf16 v[212:215], v[12:15], v[224:231], v11
  v_exp_f32 v55, v55
  v_mfma_f32_32x32x16_bf16 v[64:79], v[132:135], v[36:39], v[64:79]
  v_cvt_pk_bf16_f32 v224, v48, v49
  v_cvt_pk_bf16_f32 v225, v50, v51
  v_cvt_pk_bf16_f32 v226, v52, v53
  v_cvt_pk_bf16_f32 v227, v54, v55
  v_exp_f32 v56, v56
  v_exp_f32 v57, v57
  v_exp_f32 v58, v58
  v_exp_f32 v59, v59
  v_mfma_f32_32x32x16_bf16 v[176:191], v[120:123], v[224:227], v[176:191]
  v_exp_f32 v60, v60
  v_exp_f32 v61, v61
  v_exp_f32 v62, v62
  v_exp_f32 v63, v63
  v_cvt_pk_bf16_f32 v228, v56, v57
  v_cvt_pk_bf16_f32 v229, v58, v59
  v_cvt_pk_bf16_f32 v230, v60, v61
  v_cvt_pk_bf16_f32 v231, v62, v63
  v_cvt_pk_bf16_f32 v160, v160, v161
  v_cvt_pk_bf16_f32 v161, v162, v163
  v_cvt_pk_bf16_f32 v162, v164, v165
  v_cvt_pk_bf16_f32 v163, v166, v167
  ds_write_b128 v9, v[160:163] offset:2048
  v_cvt_pk_bf16_f32 v164, v168, v169
  v_cvt_pk_bf16_f32 v165, v170, v171
  v_cvt_pk_bf16_f32 v166, v172, v173
  v_cvt_pk_bf16_f32 v167, v174, v175
  ds_write_b128 v9, v[164:167] offset:3072
  v_add_f32 v212, v212, v214
  v_add_f32 v213, v213, v215
  v_cndmask_b32 v31, v212, v213, s[26:27]
  ds_write_b64 v1, v[30:31]
  v_xor_b32 v1, 512, v1
  v_mfma_f32_32x32x16_bf16 v[48:63], v[112:115], v[40:43], 0
  v_exp_f32 v64, v64
  v_exp_f32 v65, v65
  v_exp_f32 v66, v66
  v_exp_f32 v67, v67
  v_mfma_f32_32x32x16_bf16 v[176:191], v[124:127], v[228:231], v[176:191]
  v_exp_f32 v68, v68
  v_exp_f32 v69, v69
  v_exp_f32 v70, v70
  v_smfmac_f32_16x16x64_bf16 v[216:219], v[12:15], v[224:231], v11
  s_waitcnt vmcnt(0) lgkmcnt(0)
  s_barrier
  ds_read_b128 v[80:83], v8 offset:0
  ds_read_b128 v[84:87], v8 offset:1024
  ds_read_b128 v[88:91], v8 offset:2048
  ds_read_b128 v[92:95], v8 offset:3072
  ds_read_b64 v[30:31], v1
  v_exp_f32 v71, v71
  v_mfma_f32_32x32x16_bf16 v[48:63], v[116:119], v[44:47], v[48:63]
  v_cvt_pk_bf16_f32 v224, v64, v65
  v_cvt_pk_bf16_f32 v225, v66, v67
  v_cvt_pk_bf16_f32 v226, v68, v69
  v_cvt_pk_bf16_f32 v227, v70, v71
  v_exp_f32 v72, v72
  v_exp_f32 v73, v73
  v_exp_f32 v74, v74
  v_exp_f32 v75, v75
  v_mfma_f32_32x32x16_bf16 v[176:191], v[136:139], v[224:227], v[176:191]
  v_exp_f32 v76, v76
  v_exp_f32 v77, v77
  s_waitcnt lgkmcnt(0)
  v_mfma_f32_32x32x16_bf16 v[176:191], v[248:251], v[80:83], v[176:191]
  v_exp_f32 v78, v78
  v_exp_f32 v79, v79
  v_mfma_f32_32x32x16_bf16 v[176:191], v[252:255], v[84:87], v[176:191]
  v_cvt_pk_bf16_f32 v228, v72, v73
  v_cvt_pk_bf16_f32 v229, v74, v75
  v_cvt_pk_bf16_f32 v230, v76, v77
  v_cvt_pk_bf16_f32 v231, v78, v79
  v_mfma_f32_32x32x16_bf16 v[64:79], v[128:131], v[40:43], 0
  v_exp_f32 v48, v48
  v_exp_f32 v49, v49
  v_exp_f32 v50, v50
  v_exp_f32 v51, v51
  v_mfma_f32_32x32x16_bf16 v[176:191], v[140:143], v[228:231], v[176:191]
  v_exp_f32 v52, v52
  v_exp_f32 v53, v53
  v_exp_f32 v54, v54
  v_smfmac_f32_16x16x64_bf16 v[216:219], v[12:15], v[224:231], v11
  v_exp_f32 v55, v55
  v_mfma_f32_32x32x16_bf16 v[64:79], v[132:135], v[44:47], v[64:79]
  v_cvt_pk_bf16_f32 v224, v48, v49
  v_cvt_pk_bf16_f32 v225, v50, v51
  v_cvt_pk_bf16_f32 v226, v52, v53
  v_cvt_pk_bf16_f32 v227, v54, v55
  v_exp_f32 v56, v56
  v_exp_f32 v57, v57
  v_exp_f32 v58, v58
  v_exp_f32 v59, v59
  s_nop 1
  v_add_f32 v216, v216, v218
  v_add_f32 v217, v217, v219
  v_cndmask_b32 v24, v216, v217, s[26:27]
  v_add_f32 v24, v24, v30
  s_mov_b64 s[36:37], -1
  v_rcp_f32 v26, v24
  v_cmp_le_f32 vcc, s24, v24
  s_and_b64 s[36:37], s[36:37], vcc
  v_cmp_ge_f32 vcc, s25, v24
  s_and_b64 s[36:37], s[36:37], vcc
  v_pk_mul_f32 v[176:177], v[176:177], v[26:27] op_sel_hi:[1,0]
  v_pk_mul_f32 v[178:179], v[178:179], v[26:27] op_sel_hi:[1,0]
  v_pk_mul_f32 v[180:181], v[180:181], v[26:27] op_sel_hi:[1,0]
  v_pk_mul_f32 v[182:183], v[182:183], v[26:27] op_sel_hi:[1,0]
  v_cvt_pk_bf16_f32 v80, v176, v177
  v_cvt_pk_bf16_f32 v81, v178, v179
  v_cvt_pk_bf16_f32 v82, v180, v181
  v_cvt_pk_bf16_f32 v83, v182, v183
  buffer_store_dwordx4 v[80:83], v3, s[4:7], s28 offen offset:0 sc1
  v_pk_mul_f32 v[184:185], v[184:185], v[26:27] op_sel_hi:[1,0]
  v_pk_mul_f32 v[186:187], v[186:187], v[26:27] op_sel_hi:[1,0]
  v_pk_mul_f32 v[188:189], v[188:189], v[26:27] op_sel_hi:[1,0]
  v_pk_mul_f32 v[190:191], v[190:191], v[26:27] op_sel_hi:[1,0]
  v_cvt_pk_bf16_f32 v84, v184, v185
  v_cvt_pk_bf16_f32 v85, v186, v187
  v_cvt_pk_bf16_f32 v86, v188, v189
  v_cvt_pk_bf16_f32 v87, v190, v191
  buffer_store_dwordx4 v[84:87], v3, s[4:7], s28 offen offset:1024 sc1
  v_mfma_f32_32x32x16_bf16 v[192:207], v[120:123], v[224:227], v[192:207]
  v_exp_f32 v60, v60
  v_exp_f32 v61, v61
  v_exp_f32 v62, v62
  v_exp_f32 v63, v63
  v_cvt_pk_bf16_f32 v228, v56, v57
  v_cvt_pk_bf16_f32 v229, v58, v59
  v_cvt_pk_bf16_f32 v230, v60, v61
  v_cvt_pk_bf16_f32 v231, v62, v63
  v_mfma_f32_32x32x16_bf16 v[192:207], v[248:251], v[88:91], v[192:207]
  v_exp_f32 v64, v64
  v_exp_f32 v65, v65
  v_exp_f32 v66, v66
  v_exp_f32 v67, v67
  v_mfma_f32_32x32x16_bf16 v[192:207], v[124:127], v[228:231], v[192:207]
  v_exp_f32 v68, v68
  v_exp_f32 v69, v69
  v_exp_f32 v70, v70
  v_smfmac_f32_16x16x64_bf16 v[220:223], v[12:15], v[224:231], v11
  v_exp_f32 v71, v71
  v_mfma_f32_32x32x16_bf16 v[192:207], v[252:255], v[92:95], v[192:207]
  v_cvt_pk_bf16_f32 v224, v64, v65
  v_cvt_pk_bf16_f32 v225, v66, v67
  v_cvt_pk_bf16_f32 v226, v68, v69
  v_cvt_pk_bf16_f32 v227, v70, v71
  v_exp_f32 v72, v72
  v_exp_f32 v73, v73
  v_exp_f32 v74, v74
  v_exp_f32 v75, v75
  v_mfma_f32_32x32x16_bf16 v[192:207], v[136:139], v[224:227], v[192:207]
  v_exp_f32 v76, v76
  v_exp_f32 v77, v77
  v_exp_f32 v78, v78
  v_exp_f32 v79, v79
  v_cvt_pk_bf16_f32 v228, v72, v73
  v_cvt_pk_bf16_f32 v229, v74, v75
  v_cvt_pk_bf16_f32 v230, v76, v77
  v_cvt_pk_bf16_f32 v231, v78, v79
  s_nop 1
  v_smfmac_f32_16x16x64_bf16 v[220:223], v[12:15], v[224:231], v11
  v_mfma_f32_32x32x16_bf16 v[192:207], v[140:143], v[228:231], v[192:207]
  s_nop 10
  v_add_f32 v220, v220, v222
  v_add_f32 v221, v221, v223
  v_cndmask_b32 v25, v220, v221, s[26:27]
  v_add_f32 v25, v25, v31
.fz_kernel_a_fin:
  v_rcp_f32 v28, v25
  v_cmp_le_f32 vcc, s24, v25
  s_and_b64 s[36:37], s[36:37], vcc
  v_cmp_ge_f32 vcc, s25, v25
  s_and_b64 s[36:37], s[36:37], vcc
  v_pk_mul_f32 v[192:193], v[192:193], v[28:29] op_sel_hi:[1,0]
  v_pk_mul_f32 v[194:195], v[194:195], v[28:29] op_sel_hi:[1,0]
  v_pk_mul_f32 v[196:197], v[196:197], v[28:29] op_sel_hi:[1,0]
  v_pk_mul_f32 v[198:199], v[198:199], v[28:29] op_sel_hi:[1,0]
  v_cvt_pk_bf16_f32 v88, v192, v193
  v_cvt_pk_bf16_f32 v89, v194, v195
  v_cvt_pk_bf16_f32 v90, v196, v197
  v_cvt_pk_bf16_f32 v91, v198, v199
  buffer_store_dwordx4 v[88:91], v3, s[4:7], s29 offen offset:0 sc1
  v_pk_mul_f32 v[200:201], v[200:201], v[28:29] op_sel_hi:[1,0]
  v_pk_mul_f32 v[202:203], v[202:203], v[28:29] op_sel_hi:[1,0]
  v_pk_mul_f32 v[204:205], v[204:205], v[28:29] op_sel_hi:[1,0]
  v_pk_mul_f32 v[206:207], v[206:207], v[28:29] op_sel_hi:[1,0]
  v_cvt_pk_bf16_f32 v92, v200, v201
  v_cvt_pk_bf16_f32 v93, v202, v203
  v_cvt_pk_bf16_f32 v94, v204, v205
  v_cvt_pk_bf16_f32 v95, v206, v207
  buffer_store_dwordx4 v[92:95], v3, s[4:7], s29 offen offset:1024 sc1
  ds_read_b32 v7, v6 offset:8
  v_pk_fma_f32 v[64:65], v[176:177], 0, 0 op_sel_hi:[1,0,0]
  v_pk_fma_f32 v[66:67], v[178:179], 0, 0 op_sel_hi:[1,0,0]
  v_pk_fma_f32 v[64:65], v[180:181], 0, v[64:65] op_sel_hi:[1,0,1]
  v_pk_fma_f32 v[66:67], v[182:183], 0, v[66:67] op_sel_hi:[1,0,1]
  v_pk_fma_f32 v[64:65], v[184:185], 0, v[64:65] op_sel_hi:[1,0,1]
  v_pk_fma_f32 v[66:67], v[186:187], 0, v[66:67] op_sel_hi:[1,0,1]
  v_pk_fma_f32 v[64:65], v[188:189], 0, v[64:65] op_sel_hi:[1,0,1]
  v_pk_fma_f32 v[66:67], v[190:191], 0, v[66:67] op_sel_hi:[1,0,1]
  v_pk_fma_f32 v[64:65], v[192:193], 0, v[64:65] op_sel_hi:[1,0,1]
  v_pk_fma_f32 v[66:67], v[194:195], 0, v[66:67] op_sel_hi:[1,0,1]
  v_pk_fma_f32 v[64:65], v[196:197], 0, v[64:65] op_sel_hi:[1,0,1]
  v_pk_fma_f32 v[66:67], v[198:199], 0, v[66:67] op_sel_hi:[1,0,1]
  v_pk_fma_f32 v[64:65], v[200:201], 0, v[64:65] op_sel_hi:[1,0,1]
  v_pk_fma_f32 v[66:67], v[202:203], 0, v[66:67] op_sel_hi:[1,0,1]
  v_pk_fma_f32 v[64:65], v[204:205], 0, v[64:65] op_sel_hi:[1,0,1]
  v_pk_fma_f32 v[66:67], v[206:207], 0, v[66:67] op_sel_hi:[1,0,1]
  v_pk_add_f32 v[64:65], v[64:65], v[66:67]
  v_cmp_o_f32 vcc, v64, v65
  s_and_b64 s[36:37], s[36:37], vcc
  s_cmp_eq_u64 s[36:37], -1
  s_cbranch_scc0 .fz_kernel_a_slow
.fz_kernel_a_ok:
  s_mov_b32 s8, s48
  s_mov_b32 s9, s49
  s_mov_b32 s10, 0x800
  s_mov_b32 s11, 0x00020000
  v_lshrrev_b32 v17, 5, v2
  v_lshlrev_b32 v19, 4, v17
  s_lshl_b32 s22, s18, 7
  s_lshl2_add_u32 s32, s17, s16
  s_lshl_b32 s35, s32, 16
  s_add_u32 s35, s35, s64
  s_mov_b32 s34, 0
  s_and_b32 s28, s18, 3
  s_mul_i32 s28, s28, 0
  v_add_u32 v6, 8, v6
  buffer_load_dwordx4 v[48:51], v19, s[8:11], s22 offen offset:0
  buffer_load_dwordx4 v[52:55], v19, s[8:11], s22 offen offset:32
  buffer_load_dwordx4 v[56:59], v19, s[8:11], s22 offen offset:64
  buffer_load_dwordx4 v[60:63], v19, s[8:11], s22 offen offset:96
  s_waitcnt lgkmcnt(0)
  v_readfirstlane_b32 s36, v7
  s_bcnt1_i32_b32 s29, s36
  s_cmp_lt_u32 s29, 2
  s_cbranch_scc1 .fz_kernel_w_e0
  s_andn2_b32 s33, s36, s34
  s_cbranch_scc0 .fz_kernel_pk48c
.fz_kernel_pk48:
  s_ff1_i32_b32 s33, s33
  s_bitset1_b32 s34, s33
  s_lshl_b32 s20, s33, 13
  s_lshl_b32 s33, s33, 12
  s_add_u32 s30, s33, s35
  buffer_load_dwordx4 v[96:99], v3, s[4:7], s30 offen offset:0
  buffer_load_dwordx4 v[100:103], v3, s[4:7], s30 offen offset:1024
  buffer_load_dwordx4 v[104:107], v3, s[4:7], s30 offen offset:2048
  buffer_load_dwordx4 v[108:111], v3, s[4:7], s30 offen offset:3072
  s_andn2_b32 s33, s36, s34
  s_cbranch_scc0 .fz_kernel_pk49c
.fz_kernel_pk49:
  s_ff1_i32_b32 s33, s33
  s_bitset1_b32 s34, s33
  s_lshl_b32 s21, s33, 13
  s_lshl_b32 s33, s33, 12
  s_add_u32 s30, s33, s35
  buffer_load_dwordx4 v[112:115], v3, s[4:7], s30 offen offset:0
  buffer_load_dwordx4 v[116:119], v3, s[4:7], s30 offen offset:1024
  buffer_load_dwordx4 v[120:123], v3, s[4:7], s30 offen offset:2048
  buffer_load_dwordx4 v[124:127], v3, s[4:7], s30 offen offset:3072
.fz_kernel_w_e0:
  v_and_b32 v18, 31, v2
  s_lshl_b32 s39, s17, 4
  s_add_u32 s39, s39, s18
  s_lshl_b32 s39, s39, 2
  s_add_u32 s39, s39, s16
  s_lshl_b32 s39, s39, 12
  v_and_b32 v16, 16, v2
  v_lshlrev_b32 v16, 7, v16
  v_lshl_add_u32 v16, v17, 8, v16
  v_and_b32 v1, 0xf0, v3
  v_add_u32 v16, v16, v1
  s_add_u32 s39, s39, s65
  s_lshl_b32 s31, s16, 5
  v_add_u32 v45, s31, v18
  v_lshlrev_b32 v11, 2, v45
  v_add_u32 v11, 155648, v11
  v_mov_b32 v44, 159952
  ds_read_b32 v40, v11 offset:6400
  ds_read_b32 v42, v11 offset:6912
  ds_read_b32 v46, v44 offset:8
  ds_read_b32 v44, v44
  v_mov_b32 v47, 0.32768
  v_add_u32 v45, 1, v45
  v_bfe_u32 v11, v2, 2, 2
  v_lshl_add_u32 v12, v17, 2, v11
  v_lshlrev_b32 v12, 7, v12
  v_lshrrev_b32 v13, 1, v11
  v_lshl_add_u32 v12, v13, 6, v12
  v_bfe_u32 v13, v2, 4, 1
  v_lshl_add_u32 v12, v13, 5, v12
  v_and_b32 v13, 1, v2
  v_lshl_add_u32 v12, v13, 4, v12
  v_bfe_u32 v13, v2, 1, 1
  v_lshl_add_u32 v14, v13, 3, v12
  v_xor_b32 v15, 64, v14
  s_mov_b64 exec, 1
  s_cmp_lt_u32 s29, 2
  s_cbranch_scc1 .fz_kernel_w_e1
  s_waitcnt vmcnt(12)
  s_branch .fz_kernel_w_e3
.fz_kernel_w_e1:
  s_waitcnt vmcnt(4)
.fz_kernel_w_e3:
  ds_add_u32 v6, v5 offset:0x100
  s_mov_b64 exec, -1
  v_lshlrev_b32 v64, 16, v232
  v_and_b32 v65, 0xffff0000, v232
  v_lshlrev_b32 v66, 16, v233
  v_and_b32 v67, 0xffff0000, v233
  v_lshlrev_b32 v68, 16, v234
  v_and_b32 v69, 0xffff0000, v234
  v_lshlrev_b32 v70, 16, v235
  v_and_b32 v71, 0xffff0000, v235
  v_lshlrev_b32 v72, 16, v236
  v_and_b32 v73, 0xffff0000, v236
  v_lshlrev_b32 v74, 16, v237
  v_and_b32 v75, 0xffff0000, v237
  v_lshlrev_b32 v76, 16, v238
  v_and_b32 v77, 0xffff0000, v238
  v_lshlrev_b32 v78, 16, v239
  v_and_b32 v79, 0xffff0000, v239
  v_lshlrev_b32 v80, 16, v240
  v_and_b32 v81, 0xffff0000, v240
  v_lshlrev_b32 v82, 16, v241
  v_and_b32 v83, 0xffff0000, v241
  v_lshlrev_b32 v84, 16, v242
  v_and_b32 v85, 0xffff0000, v242
  v_lshlrev_b32 v86, 16, v243
  v_and_b32 v87, 0xffff0000, v243
  v_lshlrev_b32 v88, 16, v244
  v_and_b32 v89, 0xffff0000, v244
  v_lshlrev_b32 v90, 16, v245
  v_and_b32 v91, 0xffff0000, v245
  v_lshlrev_b32 v92, 16, v246
  v_and_b32 v93, 0xffff0000, v246
  v_lshlrev_b32 v94, 16, v247
  v_and_b32 v95, 0xffff0000, v247
  s_waitcnt lgkmcnt(0)
  v_pk_fma_f32 v[64:65], v[64:65], v[40:41], v[42:43] op_sel_hi:[1,0,0]
  v_pk_fma_f32 v[66:67], v[66:67], v[40:41], v[42:43] op_sel_hi:[1,0,0]
  v_pk_fma_f32 v[68:69], v[68:69], v[40:41], v[42:43] op_sel_hi:[1,0,0]
  v_pk_fma_f32 v[70:71], v[70:71], v[40:41], v[42:43] op_sel_hi:[1,0,0]
  v_pk_fma_f32 v[72:73], v[72:73], v[40:41], v[42:43] op_sel_hi:[1,0,0]
  v_pk_fma_f32 v[74:75], v[74:75], v[40:41], v[42:43] op_sel_hi:[1,0,0]
  v_pk_fma_f32 v[76:77], v[76:77], v[40:41], v[42:43] op_sel_hi:[1,0,0]
  v_pk_fma_f32 v[78:79], v[78:79], v[40:41], v[42:43] op_sel_hi:[1,0,0]
  v_pk_fma_f32 v[80:81], v[80:81], v[40:41], v[42:43] op_sel_hi:[1,0,0]
  v_pk_fma_f32 v[82:83], v[82:83], v[40:41], v[42:43] op_sel_hi:[1,0,0]
  v_pk_fma_f32 v[84:85], v[84:85], v[40:41], v[42:43] op_sel_hi:[1,0,0]
  v_pk_fma_f32 v[86:87], v[86:87], v[40:41], v[42:43] op_sel_hi:[1,0,0]
  v_pk_fma_f32 v[88:89], v[88:89], v[40:41], v[42:43] op_sel_hi:[1,0,0]
  v_pk_fma_f32 v[90:91], v[90:91], v[40:41], v[42:43] op_sel_hi:[1,0,0]
  v_pk_fma_f32 v[92:93], v[92:93], v[40:41], v[42:43] op_sel_hi:[1,0,0]
  v_pk_fma_f32 v[94:95], v[94:95], v[40:41], v[42:43] op_sel_hi:[1,0,0]
  v_cmp_eq_u32 vcc, v44, v45
  s_cbranch_vccnz .fz_kernel_w_pt
.fz_kernel_w_pb:
  s_cmp_ge_u32 s29, 2
  s_cbranch_scc1 .fz_kernel_w_e2
  s_andn2_b32 s33, s36, s34
  s_cbranch_scc0 .fz_kernel_pk50c
.fz_kernel_pk50:
  s_ff1_i32_b32 s33, s33
  s_bitset1_b32 s34, s33
  s_lshl_b32 s20, s33, 13
  s_lshl_b32 s33, s33, 12
  s_add_u32 s30, s33, s35
  buffer_load_dwordx4 v[96:99], v3, s[4:7], s30 offen offset:0
  buffer_load_dwordx4 v[100:103], v3, s[4:7], s30 offen offset:1024
  buffer_load_dwordx4 v[104:107], v3, s[4:7], s30 offen offset:2048
  buffer_load_dwordx4 v[108:111], v3, s[4:7], s30 offen offset:3072
  s_andn2_b32 s33, s36, s34
  s_cbranch_scc0 .fz_kernel_pk51c
.fz_kernel_pk51:
  s_ff1_i32_b32 s33, s33
  s_bitset1_b32 s34, s33
  s_lshl_b32 s21, s33, 13
  s_lshl_b32 s33, s33, 12
  s_add_u32 s30, s33, s35
  buffer_load_dwordx4 v[112:115], v3, s[4:7], s30 offen offset:0
  buffer_load_dwordx4 v[116:119], v3, s[4:7], s30 offen offset:1024
  buffer_load_dwordx4 v[120:123], v3, s[4:7], s30 offen offset:2048
  buffer_load_dwordx4 v[124:127], v3, s[4:7], s30 offen offset:3072
.fz_kernel_w_e2:
  s_andn2_b32 s33, s36, s34
  s_cbranch_scc0 .fz_kernel_pk52c
.fz_kernel_pk52:
  s_ff1_i32_b32 s33, s33
  s_bitset1_b32 s34, s33
  s_lshl_b32 s22, s33, 13
  s_lshl_b32 s33, s33, 12
  s_add_u32 s30, s33, s35
  buffer_load_dwordx4 v[128:131], v3, s[4:7], s30 offen offset:0
  buffer_load_dwordx4 v[132:135], v3, s[4:7], s30 offen offset:1024
  buffer_load_dwordx4 v[136:139], v3, s[4:7], s30 offen offset:2048
  buffer_load_dwordx4 v[140:143], v3, s[4:7], s30 offen offset:3072
  v_add_u32 v10, s20, v14
  v_add_u32 v11, s20, v15
  ds_read_b64_tr_b16 v[224:225], v10 offset:0
  ds_read_b64_tr_b16 v[226:227], v10 offset:1024
  ds_read_b64_tr_b16 v[228:229], v11 offset:0
  ds_read_b64_tr_b16 v[230:231], v11 offset:1024
  ds_read_b64_tr_b16 v[232:233], v10 offset:2048
  ds_read_b64_tr_b16 v[234:235], v10 offset:3072
  ds_read_b64_tr_b16 v[236:237], v11 offset:2048
  ds_read_b64_tr_b16 v[238:239], v11 offset:3072
  s_andn2_b32 s33, s36, s34
  s_cbranch_scc0 .fz_kernel_pk53c
.fz_kernel_pk53:
  s_ff1_i32_b32 s33, s33
  s_bitset1_b32 s34, s33
  s_lshl_b32 s23, s33, 13
  s_lshl_b32 s33, s33, 12
  s_add_u32 s30, s33, s35
  s_waitcnt vmcnt(11) lgkmcnt(6)
  v_mfma_f32_32x32x16_bf16 v[64:79], v[224:227], v[96:99], v[64:79]
  v_add_u32 v12, s21, v14
  v_add_u32 v13, s21, v15
  buffer_load_dwordx4 v[144:147], v3, s[4:7], s30 offen offset:0
  ds_read_b64_tr_b16 v[240:241], v10 offset:4096
  s_waitcnt lgkmcnt(5)
  v_mfma_f32_32x32x16_bf16 v[80:95], v[228:231], v[96:99], v[80:95]
  ds_read_b64_tr_b16 v[242:243], v10 offset:5120
  ds_read_b64_tr_b16 v[244:245], v11 offset:4096
  ds_read_b64_tr_b16 v[246:247], v11 offset:5120
  s_waitcnt vmcnt(11) lgkmcnt(6)
  v_mfma_f32_32x32x16_bf16 v[64:79], v[232:235], v[100:103], v[64:79]
  buffer_load_dwordx4 v[148:151], v3, s[4:7], s30 offen offset:1024
  ds_read_b64_tr_b16 v[248:249], v10 offset:6144
  s_waitcnt lgkmcnt(5)
  v_mfma_f32_32x32x16_bf16 v[80:95], v[236:239], v[100:103], v[80:95]
  ds_read_b64_tr_b16 v[250:251], v10 offset:7168
  ds_read_b64_tr_b16 v[252:253], v11 offset:6144
  ds_read_b64_tr_b16 v[254:255], v11 offset:7168
  s_waitcnt vmcnt(11) lgkmcnt(6)
  v_mfma_f32_32x32x16_bf16 v[64:79], v[240:243], v[104:107], v[64:79]
  buffer_load_dwordx4 v[152:155], v3, s[4:7], s30 offen offset:2048
  ds_read_b64_tr_b16 v[224:225], v12 offset:0
  s_waitcnt lgkmcnt(5)
  v_mfma_f32_32x32x16_bf16 v[80:95], v[244:247], v[104:107], v[80:95]
  ds_read_b64_tr_b16 v[226:227], v12 offset:1024
  ds_read_b64_tr_b16 v[228:229], v13 offset:0
  ds_read_b64_tr_b16 v[230:231], v13 offset:1024
  s_waitcnt vmcnt(11) lgkmcnt(6)
  v_mfma_f32_32x32x16_bf16 v[64:79], v[248:251], v[108:111], v[64:79]
  buffer_load_dwordx4 v[156:159], v3, s[4:7], s30 offen offset:3072
  ds_read_b64_tr_b16 v[232:233], v12 offset:2048
  s_waitcnt lgkmcnt(5)
  v_mfma_f32_32x32x16_bf16 v[80:95], v[252:255], v[108:111], v[80:95]
  ds_read_b64_tr_b16 v[234:235], v12 offset:3072
  ds_read_b64_tr_b16 v[236:237], v13 offset:2048
  ds_read_b64_tr_b16 v[238:239], v13 offset:3072
  s_andn2_b32 s33, s36, s34
  s_cbranch_scc0 .fz_kernel_pk54c
.fz_kernel_pk54:
  s_ff1_i32_b32 s33, s33
  s_bitset1_b32 s34, s33
  s_lshl_b32 s24, s33, 13
  s_lshl_b32 s33, s33, 12
  s_add_u32 s30, s33, s35
  s_waitcnt vmcnt(11) lgkmcnt(6)
  v_mfma_f32_32x32x16_bf16 v[64:79], v[224:227], v[112:115], v[64:79]
  v_add_u32 v10, s22, v14
  v_add_u32 v11, s22, v15
  buffer_load_dwordx4 v[160:163], v3, s[4:7], s30 offen offset:0
  ds_read_b64_tr_b16 v[240:241], v12 offset:4096
  s_waitcnt lgkmcnt(5)
  v_mfma_f32_32x32x16_bf16 v[80:95], v[228:231], v[112:115], v[80:95]
  ds_read_b64_tr_b16 v[242:243], v12 offset:5120
  ds_read_b64_tr_b16 v[244:245], v13 offset:4096
  ds_read_b64_tr_b16 v[246:247], v13 offset:5120
  s_waitcnt vmcnt(11) lgkmcnt(6)
  v_mfma_f32_32x32x16_bf16 v[64:79], v[232:235], v[116:119], v[64:79]
  buffer_load_dwordx4 v[164:167], v3, s[4:7], s30 offen offset:1024
  ds_read_b64_tr_b16 v[248:249], v12 offset:6144
  s_waitcnt lgkmcnt(5)
  v_mfma_f32_32x32x16_bf16 v[80:95], v[236:239], v[116:119], v[80:95]
  ds_read_b64_tr_b16 v[250:251], v12 offset:7168
  ds_read_b64_tr_b16 v[252:253], v13 offset:6144
  ds_read_b64_tr_b16 v[254:255], v13 offset:7168
  s_waitcnt vmcnt(11) lgkmcnt(6)
  v_mfma_f32_32x32x16_bf16 v[64:79], v[240:243], v[120:123], v[64:79]
  buffer_load_dwordx4 v[168:171], v3, s[4:7], s30 offen offset:2048
  ds_read_b64_tr_b16 v[224:225], v10 offset:0
  s_waitcnt lgkmcnt(5)
  v_mfma_f32_32x32x16_bf16 v[80:95], v[244:247], v[120:123], v[80:95]
  ds_read_b64_tr_b16 v[226:227], v10 offset:1024
  ds_read_b64_tr_b16 v[228:229], v11 offset:0
  ds_read_b64_tr_b16 v[230:231], v11 offset:1024
  s_waitcnt vmcnt(11) lgkmcnt(6)
  v_mfma_f32_32x32x16_bf16 v[64:79], v[248:251], v[124:127], v[64:79]
  buffer_load_dwordx4 v[172:175], v3, s[4:7], s30 offen offset:3072
  ds_read_b64_tr_b16 v[232:233], v10 offset:2048
  s_waitcnt lgkmcnt(5)
  v_mfma_f32_32x32x16_bf16 v[80:95], v[252:255], v[124:127], v[80:95]
  ds_read_b64_tr_b16 v[234:235], v10 offset:3072
  ds_read_b64_tr_b16 v[236:237], v11 offset:2048
  ds_read_b64_tr_b16 v[238:239], v11 offset:3072
  s_andn2_b32 s33, s36, s34
  s_cbranch_scc0 .fz_kernel_pk55c
.fz_kernel_pk55:
  s_ff1_i32_b32 s33, s33
  s_bitset1_b32 s34, s33
  s_lshl_b32 s25, s33, 13
  s_lshl_b32 s33, s33, 12
  s_add_u32 s30, s33, s35
  s_waitcnt vmcnt(11) lgkmcnt(6)
  v_mfma_f32_32x32x16_bf16 v[64:79], v[224:227], v[128:131], v[64:79]
  v_add_u32 v12, s23, v14
  v_add_u32 v13, s23, v15
  buffer_load_dwordx4 v[176:179], v3, s[4:7], s30 offen offset:0
  ds_read_b64_tr_b16 v[240:241], v10 offset:4096
  s_waitcnt lgkmcnt(5)
  v_mfma_f32_32x32x16_bf16 v[80:95], v[228:231], v[128:131], v[80:95]
  ds_read_b64_tr_b16 v[242:243], v10 offset:5120
  ds_read_b64_tr_b16 v[244:245], v11 offset:4096
  ds_read_b64_tr_b16 v[246:247], v11 offset:5120
  s_waitcnt vmcnt(11) lgkmcnt(6)
  v_mfma_f32_32x32x16_bf16 v[64:79], v[232:235], v[132:135], v[64:79]
  buffer_load_dwordx4 v[180:183], v3, s[4:7], s30 offen offset:1024
  ds_read_b64_tr_b16 v[248:249], v10 offset:6144
  s_waitcnt lgkmcnt(5)
  v_mfma_f32_32x32x16_bf16 v[80:95], v[236:239], v[132:135], v[80:95]
  ds_read_b64_tr_b16 v[250:251], v10 offset:7168
  ds_read_b64_tr_b16 v[252:253], v11 offset:6144
  ds_read_b64_tr_b16 v[254:255], v11 offset:7168
  s_waitcnt vmcnt(11) lgkmcnt(6)
  v_mfma_f32_32x32x16_bf16 v[64:79], v[240:243], v[136:139], v[64:79]
  buffer_load_dwordx4 v[184:187], v3, s[4:7], s30 offen offset:2048
  ds_read_b64_tr_b16 v[224:225], v12 offset:0
  s_waitcnt lgkmcnt(5)
  v_mfma_f32_32x32x16_bf16 v[80:95], v[244:247], v[136:139], v[80:95]
  ds_read_b64_tr_b16 v[226:227], v12 offset:1024
  ds_read_b64_tr_b16 v[228:229], v13 offset:0
  ds_read_b64_tr_b16 v[230:231], v13 offset:1024
  s_waitcnt vmcnt(11) lgkmcnt(6)
  v_mfma_f32_32x32x16_bf16 v[64:79], v[248:251], v[140:143], v[64:79]
  buffer_load_dwordx4 v[188:191], v3, s[4:7], s30 offen offset:3072
  ds_read_b64_tr_b16 v[232:233], v12 offset:2048
  s_waitcnt lgkmcnt(5)
  v_mfma_f32_32x32x16_bf16 v[80:95], v[252:255], v[140:143], v[80:95]
  ds_read_b64_tr_b16 v[234:235], v12 offset:3072
  ds_read_b64_tr_b16 v[236:237], v13 offset:2048
  ds_read_b64_tr_b16 v[238:239], v13 offset:3072
  s_andn2_b32 s33, s36, s34
  s_cbranch_scc0 .fz_kernel_pk56c
.fz_kernel_pk56:
  s_ff1_i32_b32 s33, s33
  s_bitset1_b32 s34, s33
  s_lshl_b32 s26, s33, 13
  s_lshl_b32 s33, s33, 12
  s_add_u32 s30, s33, s35
  s_waitcnt vmcnt(11) lgkmcnt(6)
  v_mfma_f32_32x32x16_bf16 v[64:79], v[224:227], v[144:147], v[64:79]
  v_add_u32 v10, s24, v14
  v_add_u32 v11, s24, v15
  buffer_load_dwordx4 v[192:195], v3, s[4:7], s30 offen offset:0
  ds_read_b64_tr_b16 v[240:241], v12 offset:4096
  s_waitcnt lgkmcnt(5)
  v_mfma_f32_32x32x16_bf16 v[80:95], v[228:231], v[144:147], v[80:95]
  ds_read_b64_tr_b16 v[242:243], v12 offset:5120
  ds_read_b64_tr_b16 v[244:245], v13 offset:4096
  ds_read_b64_tr_b16 v[246:247], v13 offset:5120
  s_waitcnt vmcnt(11) lgkmcnt(6)
  v_mfma_f32_32x32x16_bf16 v[64:79], v[232:235], v[148:151], v[64:79]
  buffer_load_dwordx4 v[196:199], v3, s[4:7], s30 offen offset:1024
  ds_read_b64_tr_b16 v[248:249], v12 offset:6144
  s_waitcnt lgkmcnt(5)
  v_mfma_f32_32x32x16_bf16 v[80:95], v[236:239], v[148:151], v[80:95]
  ds_read_b64_tr_b16 v[250:251], v12 offset:7168
  ds_read_b64_tr_b16 v[252:253], v13 offset:6144
  ds_read_b64_tr_b16 v[254:255], v13 offset:7168
  s_waitcnt vmcnt(11) lgkmcnt(6)
  v_mfma_f32_32x32x16_bf16 v[64:79], v[240:243], v[152:155], v[64:79]
  buffer_load_dwordx4 v[200:203], v3, s[4:7], s30 offen offset:2048
  ds_read_b64_tr_b16 v[224:225], v10 offset:0
  s_waitcnt lgkmcnt(5)
  v_mfma_f32_32x32x16_bf16 v[80:95], v[244:247], v[152:155], v[80:95]
  ds_read_b64_tr_b16 v[226:227], v10 offset:1024
  ds_read_b64_tr_b16 v[228:229], v11 offset:0
  ds_read_b64_tr_b16 v[230:231], v11 offset:1024
  s_waitcnt vmcnt(11) lgkmcnt(6)
  v_mfma_f32_32x32x16_bf16 v[64:79], v[248:251], v[156:159], v[64:79]
  buffer_load_dwordx4 v[204:207], v3, s[4:7], s30 offen offset:3072
  ds_read_b64_tr_b16 v[232:233], v10 offset:2048
  s_waitcnt lgkmcnt(5)
  v_mfma_f32_32x32x16_bf16 v[80:95], v[252:255], v[156:159], v[80:95]
  ds_read_b64_tr_b16 v[234:235], v10 offset:3072
  ds_read_b64_tr_b16 v[236:237], v11 offset:2048
  ds_read_b64_tr_b16 v[238:239], v11 offset:3072
  s_andn2_b32 s33, s36, s34
  s_cbranch_scc0 .fz_kernel_pk57c
.fz_kernel_pk57:
  s_ff1_i32_b32 s33, s33
  s_bitset1_b32 s34, s33
  s_lshl_b32 s27, s33, 13
  s_lshl_b32 s33, s33, 12
  s_add_u32 s30, s33, s35
  s_waitcnt vmcnt(11) lgkmcnt(6)
  v_mfma_f32_32x32x16_bf16 v[64:79], v[224:227], v[160:163], v[64:79]
  v_add_u32 v12, s25, v14
  v_add_u32 v13, s25, v15
  buffer_load_dwordx4 v[208:211], v3, s[4:7], s30 offen offset:0
  ds_read_b64_tr_b16 v[240:241], v10 offset:4096
  s_waitcnt lgkmcnt(5)
  v_mfma_f32_32x32x16_bf16 v[80:95], v[228:231], v[160:163], v[80:95]
  ds_read_b64_tr_b16 v[242:243], v10 offset:5120
  ds_read_b64_tr_b16 v[244:245], v11 offset:4096
  ds_read_b64_tr_b16 v[246:247], v11 offset:5120
  s_waitcnt vmcnt(11) lgkmcnt(6)
  v_mfma_f32_32x32x16_bf16 v[64:79], v[232:235], v[164:167], v[64:79]
  buffer_load_dwordx4 v[212:215], v3, s[4:7], s30 offen offset:1024
  ds_read_b64_tr_b16 v[248:249], v10 offset:6144
  s_waitcnt lgkmcnt(5)
  v_mfma_f32_32x32x16_bf16 v[80:95], v[236:239], v[164:167], v[80:95]
  ds_read_b64_tr_b16 v[250:251], v10 offset:7168
  ds_read_b64_tr_b16 v[252:253], v11 offset:6144
  ds_read_b64_tr_b16 v[254:255], v11 offset:7168
  s_waitcnt vmcnt(11) lgkmcnt(6)
  v_mfma_f32_32x32x16_bf16 v[64:79], v[240:243], v[168:171], v[64:79]
  buffer_load_dwordx4 v[216:219], v3, s[4:7], s30 offen offset:2048
  ds_read_b64_tr_b16 v[224:225], v12 offset:0
  s_waitcnt lgkmcnt(5)
  v_mfma_f32_32x32x16_bf16 v[80:95], v[244:247], v[168:171], v[80:95]
  ds_read_b64_tr_b16 v[226:227], v12 offset:1024
  ds_read_b64_tr_b16 v[228:229], v13 offset:0
  ds_read_b64_tr_b16 v[230:231], v13 offset:1024
  s_waitcnt vmcnt(11) lgkmcnt(6)
  v_mfma_f32_32x32x16_bf16 v[64:79], v[248:251], v[172:175], v[64:79]
  buffer_load_dwordx4 v[220:223], v3, s[4:7], s30 offen offset:3072
  ds_read_b64_tr_b16 v[232:233], v12 offset:2048
  s_waitcnt lgkmcnt(5)
  v_mfma_f32_32x32x16_bf16 v[80:95], v[252:255], v[172:175], v[80:95]
  ds_read_b64_tr_b16 v[234:235], v12 offset:3072
  ds_read_b64_tr_b16 v[236:237], v13 offset:2048
  ds_read_b64_tr_b16 v[238:239], v13 offset:3072
  s_andn2_b32 s33, s36, s34
  s_cbranch_scc0 .fz_kernel_pk58c
.fz_kernel_pk58:
  s_ff1_i32_b32 s33, s33
  s_bitset1_b32 s34, s33
  s_lshl_b32 s20, s33, 13
  s_lshl_b32 s33, s33, 12
  s_add_u32 s30, s33, s35
  s_waitcnt vmcnt(11) lgkmcnt(6)
  v_mfma_f32_32x32x16_bf16 v[64:79], v[224:227], v[176:179], v[64:79]
  v_add_u32 v10, s26, v14
  v_add_u32 v11, s26, v15
  buffer_load_dwordx4 v[96:99], v3, s[4:7], s30 offen offset:0
  ds_read_b64_tr_b16 v[240:241], v12 offset:4096
  s_waitcnt lgkmcnt(5)
  v_mfma_f32_32x32x16_bf16 v[80:95], v[228:231], v[176:179], v[80:95]
  ds_read_b64_tr_b16 v[242:243], v12 offset:5120
  ds_read_b64_tr_b16 v[244:245], v13 offset:4096
  ds_read_b64_tr_b16 v[246:247], v13 offset:5120
  s_waitcnt vmcnt(11) lgkmcnt(6)
  v_mfma_f32_32x32x16_bf16 v[64:79], v[232:235], v[180:183], v[64:79]
  buffer_load_dwordx4 v[100:103], v3, s[4:7], s30 offen offset:1024
  ds_read_b64_tr_b16 v[248:249], v12 offset:6144
  s_waitcnt lgkmcnt(5)
  v_mfma_f32_32x32x16_bf16 v[80:95], v[236:239], v[180:183], v[80:95]
  ds_read_b64_tr_b16 v[250:251], v12 offset:7168
  ds_read_b64_tr_b16 v[252:253], v13 offset:6144
  ds_read_b64_tr_b16 v[254:255], v13 offset:7168
  s_waitcnt vmcnt(11) lgkmcnt(6)
  v_mfma_f32_32x32x16_bf16 v[64:79], v[240:243], v[184:187], v[64:79]
  buffer_load_dwordx4 v[104:107], v3, s[4:7], s30 offen offset:2048
  ds_read_b64_tr_b16 v[224:225], v10 offset:0
  s_waitcnt lgkmcnt(5)
  v_mfma_f32_32x32x16_bf16 v[80:95], v[244:247], v[184:187], v[80:95]
  ds_read_b64_tr_b16 v[226:227], v10 offset:1024
  ds_read_b64_tr_b16 v[228:229], v11 offset:0
  ds_read_b64_tr_b16 v[230:231], v11 offset:1024
  s_waitcnt vmcnt(11) lgkmcnt(6)
  v_mfma_f32_32x32x16_bf16 v[64:79], v[248:251], v[188:191], v[64:79]
  buffer_load_dwordx4 v[108:111], v3, s[4:7], s30 offen offset:3072
  ds_read_b64_tr_b16 v[232:233], v10 offset:2048
  s_waitcnt lgkmcnt(5)
  v_mfma_f32_32x32x16_bf16 v[80:95], v[252:255], v[188:191], v[80:95]
  ds_read_b64_tr_b16 v[234:235], v10 offset:3072
  ds_read_b64_tr_b16 v[236:237], v11 offset:2048
  ds_read_b64_tr_b16 v[238:239], v11 offset:3072
  s_andn2_b32 s33, s36, s34
  s_cbranch_scc0 .fz_kernel_pk59c
.fz_kernel_pk59:
  s_ff1_i32_b32 s33, s33
  s_bitset1_b32 s34, s33
  s_lshl_b32 s21, s33, 13
  s_lshl_b32 s33, s33, 12
  s_add_u32 s30, s33, s35
  s_waitcnt vmcnt(11) lgkmcnt(6)
  v_mfma_f32_32x32x16_bf16 v[64:79], v[224:227], v[192:195], v[64:79]
  v_add_u32 v12, s27, v14
  v_add_u32 v13, s27, v15
  buffer_load_dwordx4 v[112:115], v3, s[4:7], s30 offen offset:0
  ds_read_b64_tr_b16 v[240:241], v10 offset:4096
  s_waitcnt lgkmcnt(5)
  v_mfma_f32_32x32x16_bf16 v[80:95], v[228:231], v[192:195], v[80:95]
  ds_read_b64_tr_b16 v[242:243], v10 offset:5120
  ds_read_b64_tr_b16 v[244:245], v11 offset:4096
  ds_read_b64_tr_b16 v[246:247], v11 offset:5120
  s_waitcnt vmcnt(11) lgkmcnt(6)
  v_mfma_f32_32x32x16_bf16 v[64:79], v[232:235], v[196:199], v[64:79]
  buffer_load_dwordx4 v[116:119], v3, s[4:7], s30 offen offset:1024
  ds_read_b64_tr_b16 v[248:249], v10 offset:6144
  s_waitcnt lgkmcnt(5)
  v_mfma_f32_32x32x16_bf16 v[80:95], v[236:239], v[196:199], v[80:95]
  ds_read_b64_tr_b16 v[250:251], v10 offset:7168
  ds_read_b64_tr_b16 v[252:253], v11 offset:6144
  ds_read_b64_tr_b16 v[254:255], v11 offset:7168
  s_waitcnt vmcnt(11) lgkmcnt(6)
  v_mfma_f32_32x32x16_bf16 v[64:79], v[240:243], v[200:203], v[64:79]
  buffer_load_dwordx4 v[120:123], v3, s[4:7], s30 offen offset:2048
  ds_read_b64_tr_b16 v[224:225], v12 offset:0
  s_waitcnt lgkmcnt(5)
  v_mfma_f32_32x32x16_bf16 v[80:95], v[244:247], v[200:203], v[80:95]
  ds_read_b64_tr_b16 v[226:227], v12 offset:1024
  ds_read_b64_tr_b16 v[228:229], v13 offset:0
  ds_read_b64_tr_b16 v[230:231], v13 offset:1024
  s_waitcnt vmcnt(11) lgkmcnt(6)
  v_mfma_f32_32x32x16_bf16 v[64:79], v[248:251], v[204:207], v[64:79]
  buffer_load_dwordx4 v[124:127], v3, s[4:7], s30 offen offset:3072
  ds_read_b64_tr_b16 v[232:233], v12 offset:2048
  s_waitcnt lgkmcnt(5)
  v_mfma_f32_32x32x16_bf16 v[80:95], v[252:255], v[204:207], v[80:95]
  ds_read_b64_tr_b16 v[234:235], v12 offset:3072
  ds_read_b64_tr_b16 v[236:237], v13 offset:2048
  ds_read_b64_tr_b16 v[238:239], v13 offset:3072
  s_andn2_b32 s33, s36, s34
  s_cbranch_scc0 .fz_kernel_pk60c
.fz_kernel_pk60:
  s_ff1_i32_b32 s33, s33
  s_bitset1_b32 s34, s33
  s_lshl_b32 s22, s33, 13
  s_lshl_b32 s33, s33, 12
  s_add_u32 s30, s33, s35
  s_waitcnt vmcnt(11) lgkmcnt(6)
  v_mfma_f32_32x32x16_bf16 v[64:79], v[224:227], v[208:211], v[64:79]
  v_add_u32 v10, s20, v14
  v_add_u32 v11, s20, v15
  buffer_load_dwordx4 v[128:131], v3, s[4:7], s30 offen offset:0
  ds_read_b64_tr_b16 v[240:241], v12 offset:4096
  s_waitcnt lgkmcnt(5)
  v_mfma_f32_32x32x16_bf16 v[80:95], v[228:231], v[208:211], v[80:95]
  ds_read_b64_tr_b16 v[242:243], v12 offset:5120
  ds_read_b64_tr_b16 v[244:245], v13 offset:4096
  ds_read_b64_tr_b16 v[246:247], v13 offset:5120
  s_waitcnt vmcnt(11) lgkmcnt(6)
  v_mfma_f32_32x32x16_bf16 v[64:79], v[232:235], v[212:215], v[64:79]
  buffer_load_dwordx4 v[132:135], v3, s[4:7], s30 offen offset:1024
  ds_read_b64_tr_b16 v[248:249], v12 offset:6144
  s_waitcnt lgkmcnt(5)
  v_mfma_f32_32x32x16_bf16 v[80:95], v[236:239], v[212:215], v[80:95]
  ds_read_b64_tr_b16 v[250:251], v12 offset:7168
  ds_read_b64_tr_b16 v[252:253], v13 offset:6144
  ds_read_b64_tr_b16 v[254:255], v13 offset:7168
  s_waitcnt vmcnt(11) lgkmcnt(6)
  v_mfma_f32_32x32x16_bf16 v[64:79], v[240:243], v[216:219], v[64:79]
  buffer_load_dwordx4 v[136:139], v3, s[4:7], s30 offen offset:2048
  ds_read_b64_tr_b16 v[224:225], v10 offset:0
  s_waitcnt lgkmcnt(5)
  v_mfma_f32_32x32x16_bf16 v[80:95], v[244:247], v[216:219], v[80:95]
  ds_read_b64_tr_b16 v[226:227], v10 offset:1024
  ds_read_b64_tr_b16 v[228:229], v11 offset:0
  ds_read_b64_tr_b16 v[230:231], v11 offset:1024
  s_waitcnt vmcnt(11) lgkmcnt(6)
  v_mfma_f32_32x32x16_bf16 v[64:79], v[248:251], v[220:223], v[64:79]
  buffer_load_dwordx4 v[140:143], v3, s[4:7], s30 offen offset:3072
  ds_read_b64_tr_b16 v[232:233], v10 offset:2048
  s_waitcnt lgkmcnt(5)
  v_mfma_f32_32x32x16_bf16 v[80:95], v[252:255], v[220:223], v[80:95]
  ds_read_b64_tr_b16 v[234:235], v10 offset:3072
  ds_read_b64_tr_b16 v[236:237], v11 offset:2048
  ds_read_b64_tr_b16 v[238:239], v11 offset:3072
  s_andn2_b32 s33, s36, s34
  s_cbranch_scc0 .fz_kernel_pk61c
.fz_kernel_pk61:
  s_ff1_i32_b32 s33, s33
  s_bitset1_b32 s34, s33
  s_lshl_b32 s23, s33, 13
  s_lshl_b32 s33, s33, 12
  s_add_u32 s30, s33, s35
  s_waitcnt vmcnt(11) lgkmcnt(6)
  v_mfma_f32_32x32x16_bf16 v[64:79], v[224:227], v[96:99], v[64:79]
  v_add_u32 v12, s21, v14
  v_add_u32 v13, s21, v15
  buffer_load_dwordx4 v[144:147], v3, s[4:7], s30 offen offset:0
  ds_read_b64_tr_b16 v[240:241], v10 offset:4096
  s_waitcnt lgkmcnt(5)
  v_mfma_f32_32x32x16_bf16 v[80:95], v[228:231], v[96:99], v[80:95]
  ds_read_b64_tr_b16 v[242:243], v10 offset:5120
  ds_read_b64_tr_b16 v[244:245], v11 offset:4096
  ds_read_b64_tr_b16 v[246:247], v11 offset:5120
  s_waitcnt vmcnt(11) lgkmcnt(6)
  v_mfma_f32_32x32x16_bf16 v[64:79], v[232:235], v[100:103], v[64:79]
  buffer_load_dwordx4 v[148:151], v3, s[4:7], s30 offen offset:1024
  ds_read_b64_tr_b16 v[248:249], v10 offset:6144
  s_waitcnt lgkmcnt(5)
  v_mfma_f32_32x32x16_bf16 v[80:95], v[236:239], v[100:103], v[80:95]
  ds_read_b64_tr_b16 v[250:251], v10 offset:7168
  ds_read_b64_tr_b16 v[252:253], v11 offset:6144
  ds_read_b64_tr_b16 v[254:255], v11 offset:7168
  s_waitcnt vmcnt(11) lgkmcnt(6)
  v_mfma_f32_32x32x16_bf16 v[64:79], v[240:243], v[104:107], v[64:79]
  buffer_load_dwordx4 v[152:155], v3, s[4:7], s30 offen offset:2048
  ds_read_b64_tr_b16 v[224:225], v12 offset:0
  s_waitcnt lgkmcnt(5)
  v_mfma_f32_32x32x16_bf16 v[80:95], v[244:247], v[104:107], v[80:95]
  ds_read_b64_tr_b16 v[226:227], v12 offset:1024
  ds_read_b64_tr_b16 v[228:229], v13 offset:0
  ds_read_b64_tr_b16 v[230:231], v13 offset:1024
  s_waitcnt vmcnt(11) lgkmcnt(6)
  v_mfma_f32_32x32x16_bf16 v[64:79], v[248:251], v[108:111], v[64:79]
  buffer_load_dwordx4 v[156:159], v3, s[4:7], s30 offen offset:3072
  ds_read_b64_tr_b16 v[232:233], v12 offset:2048
  s_waitcnt lgkmcnt(5)
  v_mfma_f32_32x32x16_bf16 v[80:95], v[252:255], v[108:111], v[80:95]
  ds_read_b64_tr_b16 v[234:235], v12 offset:3072
  ds_read_b64_tr_b16 v[236:237], v13 offset:2048
  ds_read_b64_tr_b16 v[238:239], v13 offset:3072
  s_andn2_b32 s33, s36, s34
  s_cbranch_scc0 .fz_kernel_pk62c
.fz_kernel_pk62:
  s_ff1_i32_b32 s33, s33
  s_bitset1_b32 s34, s33
  s_lshl_b32 s24, s33, 13
  s_lshl_b32 s33, s33, 12
  s_add_u32 s30, s33, s35
  s_waitcnt vmcnt(11) lgkmcnt(6)
  v_mfma_f32_32x32x16_bf16 v[64:79], v[224:227], v[112:115], v[64:79]
  v_add_u32 v10, s22, v14
  v_add_u32 v11, s22, v15
  buffer_load_dwordx4 v[160:163], v3, s[4:7], s30 offen offset:0
  ds_read_b64_tr_b16 v[240:241], v12 offset:4096
  s_waitcnt lgkmcnt(5)
  v_mfma_f32_32x32x16_bf16 v[80:95], v[228:231], v[112:115], v[80:95]
  ds_read_b64_tr_b16 v[242:243], v12 offset:5120
  ds_read_b64_tr_b16 v[244:245], v13 offset:4096
  ds_read_b64_tr_b16 v[246:247], v13 offset:5120
  s_waitcnt vmcnt(11) lgkmcnt(6)
  v_mfma_f32_32x32x16_bf16 v[64:79], v[232:235], v[116:119], v[64:79]
  buffer_load_dwordx4 v[164:167], v3, s[4:7], s30 offen offset:1024
  ds_read_b64_tr_b16 v[248:249], v12 offset:6144
  s_waitcnt lgkmcnt(5)
  v_mfma_f32_32x32x16_bf16 v[80:95], v[236:239], v[116:119], v[80:95]
  ds_read_b64_tr_b16 v[250:251], v12 offset:7168
  ds_read_b64_tr_b16 v[252:253], v13 offset:6144
  ds_read_b64_tr_b16 v[254:255], v13 offset:7168
  s_waitcnt vmcnt(11) lgkmcnt(6)
  v_mfma_f32_32x32x16_bf16 v[64:79], v[240:243], v[120:123], v[64:79]
  buffer_load_dwordx4 v[168:171], v3, s[4:7], s30 offen offset:2048
  ds_read_b64_tr_b16 v[224:225], v10 offset:0
  s_waitcnt lgkmcnt(5)
  v_mfma_f32_32x32x16_bf16 v[80:95], v[244:247], v[120:123], v[80:95]
  ds_read_b64_tr_b16 v[226:227], v10 offset:1024
  ds_read_b64_tr_b16 v[228:229], v11 offset:0
  ds_read_b64_tr_b16 v[230:231], v11 offset:1024
  s_waitcnt vmcnt(11) lgkmcnt(6)
  v_mfma_f32_32x32x16_bf16 v[64:79], v[248:251], v[124:127], v[64:79]
  buffer_load_dwordx4 v[172:175], v3, s[4:7], s30 offen offset:3072
  ds_read_b64_tr_b16 v[232:233], v10 offset:2048
  s_waitcnt lgkmcnt(5)
  v_mfma_f32_32x32x16_bf16 v[80:95], v[252:255], v[124:127], v[80:95]
  ds_read_b64_tr_b16 v[234:235], v10 offset:3072
  ds_read_b64_tr_b16 v[236:237], v11 offset:2048
  ds_read_b64_tr_b16 v[238:239], v11 offset:3072
  s_andn2_b32 s33, s36, s34
  s_cbranch_scc0 .fz_kernel_pk63c
.fz_kernel_pk63:
  s_ff1_i32_b32 s33, s33
  s_bitset1_b32 s34, s33
  s_lshl_b32 s25, s33, 13
  s_lshl_b32 s33, s33, 12
  s_add_u32 s30, s33, s35
  s_waitcnt vmcnt(11) lgkmcnt(6)
  v_mfma_f32_32x32x16_bf16 v[64:79], v[224:227], v[128:131], v[64:79]
  v_add_u32 v12, s23, v14
  v_add_u32 v13, s23, v15
  buffer_load_dwordx4 v[176:179], v3, s[4:7], s30 offen offset:0
  ds_read_b64_tr_b16 v[240:241], v10 offset:4096
  s_waitcnt lgkmcnt(5)
  v_mfma_f32_32x32x16_bf16 v[80:95], v[228:231], v[128:131], v[80:95]
  ds_read_b64_tr_b16 v[242:243], v10 offset:5120
  ds_read_b64_tr_b16 v[244:245], v11 offset:4096
  ds_read_b64_tr_b16 v[246:247], v11 offset:5120
  s_waitcnt vmcnt(11) lgkmcnt(6)
  v_mfma_f32_32x32x16_bf16 v[64:79], v[232:235], v[132:135], v[64:79]
  buffer_load_dwordx4 v[180:183], v3, s[4:7], s30 offen offset:1024
  ds_read_b64_tr_b16 v[248:249], v10 offset:6144
  s_waitcnt lgkmcnt(5)
  v_mfma_f32_32x32x16_bf16 v[80:95], v[236:239], v[132:135], v[80:95]
  ds_read_b64_tr_b16 v[250:251], v10 offset:7168
  ds_read_b64_tr_b16 v[252:253], v11 offset:6144
  ds_read_b64_tr_b16 v[254:255], v11 offset:7168
  s_waitcnt vmcnt(11) lgkmcnt(6)
  v_mfma_f32_32x32x16_bf16 v[64:79], v[240:243], v[136:139], v[64:79]
  buffer_load_dwordx4 v[184:187], v3, s[4:7], s30 offen offset:2048
  ds_read_b64_tr_b16 v[224:225], v12 offset:0
  s_waitcnt lgkmcnt(5)
  v_mfma_f32_32x32x16_bf16 v[80:95], v[244:247], v[136:139], v[80:95]
  ds_read_b64_tr_b16 v[226:227], v12 offset:1024
  ds_read_b64_tr_b16 v[228:229], v13 offset:0
  ds_read_b64_tr_b16 v[230:231], v13 offset:1024
  s_waitcnt vmcnt(11) lgkmcnt(6)
  v_mfma_f32_32x32x16_bf16 v[64:79], v[248:251], v[140:143], v[64:79]
  buffer_load_dwordx4 v[188:191], v3, s[4:7], s30 offen offset:3072
  ds_read_b64_tr_b16 v[232:233], v12 offset:2048
  s_waitcnt lgkmcnt(5)
  v_mfma_f32_32x32x16_bf16 v[80:95], v[252:255], v[140:143], v[80:95]
  ds_read_b64_tr_b16 v[234:235], v12 offset:3072
  ds_read_b64_tr_b16 v[236:237], v13 offset:2048
  ds_read_b64_tr_b16 v[238:239], v13 offset:3072
  s_andn2_b32 s33, s36, s34
  s_cbranch_scc0 .fz_kernel_pk64c
.fz_kernel_pk64:
  s_ff1_i32_b32 s33, s33
  s_bitset1_b32 s34, s33
  s_lshl_b32 s26, s33, 13
  s_lshl_b32 s33, s33, 12
  s_add_u32 s30, s33, s35
  s_waitcnt vmcnt(11) lgkmcnt(6)
  v_mfma_f32_32x32x16_bf16 v[64:79], v[224:227], v[144:147], v[64:79]
  v_add_u32 v10, s24, v14
  v_add_u32 v11, s24, v15
  buffer_load_dwordx4 v[192:195], v3, s[4:7], s30 offen offset:0
  ds_read_b64_tr_b16 v[240:241], v12 offset:4096
  s_waitcnt lgkmcnt(5)
  v_mfma_f32_32x32x16_bf16 v[80:95], v[228:231], v[144:147], v[80:95]
  ds_read_b64_tr_b16 v[242:243], v12 offset:5120
  ds_read_b64_tr_b16 v[244:245], v13 offset:4096
  ds_read_b64_tr_b16 v[246:247], v13 offset:5120
  s_waitcnt vmcnt(11) lgkmcnt(6)
  v_mfma_f32_32x32x16_bf16 v[64:79], v[232:235], v[148:151], v[64:79]
  buffer_load_dwordx4 v[196:199], v3, s[4:7], s30 offen offset:1024
  ds_read_b64_tr_b16 v[248:249], v12 offset:6144
  s_waitcnt lgkmcnt(5)
  v_mfma_f32_32x32x16_bf16 v[80:95], v[236:239], v[148:151], v[80:95]
  ds_read_b64_tr_b16 v[250:251], v12 offset:7168
  ds_read_b64_tr_b16 v[252:253], v13 offset:6144
  ds_read_b64_tr_b16 v[254:255], v13 offset:7168
  s_waitcnt vmcnt(11) lgkmcnt(6)
  v_mfma_f32_32x32x16_bf16 v[64:79], v[240:243], v[152:155], v[64:79]
  buffer_load_dwordx4 v[200:203], v3, s[4:7], s30 offen offset:2048
  ds_read_b64_tr_b16 v[224:225], v10 offset:0
  s_waitcnt lgkmcnt(5)
  v_mfma_f32_32x32x16_bf16 v[80:95], v[244:247], v[152:155], v[80:95]
  ds_read_b64_tr_b16 v[226:227], v10 offset:1024
  ds_read_b64_tr_b16 v[228:229], v11 offset:0
  ds_read_b64_tr_b16 v[230:231], v11 offset:1024
  s_waitcnt vmcnt(11) lgkmcnt(6)
  v_mfma_f32_32x32x16_bf16 v[64:79], v[248:251], v[156:159], v[64:79]
  buffer_load_dwordx4 v[204:207], v3, s[4:7], s30 offen offset:3072
  ds_read_b64_tr_b16 v[232:233], v10 offset:2048
  s_waitcnt lgkmcnt(5)
  v_mfma_f32_32x32x16_bf16 v[80:95], v[252:255], v[156:159], v[80:95]
  ds_read_b64_tr_b16 v[234:235], v10 offset:3072
  ds_read_b64_tr_b16 v[236:237], v11 offset:2048
  ds_read_b64_tr_b16 v[238:239], v11 offset:3072
  s_andn2_b32 s33, s36, s34
  s_cbranch_scc0 .fz_kernel_pk65c
.fz_kernel_pk65:
  s_ff1_i32_b32 s33, s33
  s_bitset1_b32 s34, s33
  s_lshl_b32 s27, s33, 13
  s_lshl_b32 s33, s33, 12
  s_add_u32 s30, s33, s35
  s_waitcnt vmcnt(11) lgkmcnt(6)
  v_mfma_f32_32x32x16_bf16 v[64:79], v[224:227], v[160:163], v[64:79]
  v_add_u32 v12, s25, v14
  v_add_u32 v13, s25, v15
  buffer_load_dwordx4 v[208:211], v3, s[4:7], s30 offen offset:0
  ds_read_b64_tr_b16 v[240:241], v10 offset:4096
  s_waitcnt lgkmcnt(5)
  v_mfma_f32_32x32x16_bf16 v[80:95], v[228:231], v[160:163], v[80:95]
  ds_read_b64_tr_b16 v[242:243], v10 offset:5120
  ds_read_b64_tr_b16 v[244:245], v11 offset:4096
  ds_read_b64_tr_b16 v[246:247], v11 offset:5120
  s_waitcnt vmcnt(11) lgkmcnt(6)
  v_mfma_f32_32x32x16_bf16 v[64:79], v[232:235], v[164:167], v[64:79]
  buffer_load_dwordx4 v[212:215], v3, s[4:7], s30 offen offset:1024
  ds_read_b64_tr_b16 v[248:249], v10 offset:6144
  s_waitcnt lgkmcnt(5)
  v_mfma_f32_32x32x16_bf16 v[80:95], v[236:239], v[164:167], v[80:95]
  ds_read_b64_tr_b16 v[250:251], v10 offset:7168
  ds_read_b64_tr_b16 v[252:253], v11 offset:6144
  ds_read_b64_tr_b16 v[254:255], v11 offset:7168
  s_waitcnt vmcnt(11) lgkmcnt(6)
  v_mfma_f32_32x32x16_bf16 v[64:79], v[240:243], v[168:171], v[64:79]
  buffer_load_dwordx4 v[216:219], v3, s[4:7], s30 offen offset:2048
  ds_read_b64_tr_b16 v[224:225], v12 offset:0
  s_waitcnt lgkmcnt(5)
  v_mfma_f32_32x32x16_bf16 v[80:95], v[244:247], v[168:171], v[80:95]
  ds_read_b64_tr_b16 v[226:227], v12 offset:1024
  ds_read_b64_tr_b16 v[228:229], v13 offset:0
  ds_read_b64_tr_b16 v[230:231], v13 offset:1024
  s_waitcnt vmcnt(11) lgkmcnt(6)
  v_mfma_f32_32x32x16_bf16 v[64:79], v[248:251], v[172:175], v[64:79]
  buffer_load_dwordx4 v[220:223], v3, s[4:7], s30 offen offset:3072
  ds_read_b64_tr_b16 v[232:233], v12 offset:2048
  s_waitcnt lgkmcnt(5)
  v_mfma_f32_32x32x16_bf16 v[80:95], v[252:255], v[172:175], v[80:95]
  ds_read_b64_tr_b16 v[234:235], v12 offset:3072
  ds_read_b64_tr_b16 v[236:237], v13 offset:2048
  ds_read_b64_tr_b16 v[238:239], v13 offset:3072
  s_waitcnt vmcnt(11) lgkmcnt(6)
  v_mfma_f32_32x32x16_bf16 v[64:79], v[224:227], v[176:179], v[64:79]
  v_add_u32 v10, s26, v14
  v_add_u32 v11, s26, v15
  ds_read_b64_tr_b16 v[240:241], v12 offset:4096
  s_waitcnt lgkmcnt(5)
  v_mfma_f32_32x32x16_bf16 v[80:95], v[228:231], v[176:179], v[80:95]
  ds_read_b64_tr_b16 v[242:243], v12 offset:5120
  ds_read_b64_tr_b16 v[244:245], v13 offset:4096
  ds_read_b64_tr_b16 v[246:247], v13 offset:5120
  s_waitcnt vmcnt(10) lgkmcnt(6)
  v_mfma_f32_32x32x16_bf16 v[64:79], v[232:235], v[180:183], v[64:79]
  ds_read_b64_tr_b16 v[248:249], v12 offset:6144
  s_waitcnt lgkmcnt(5)
  v_mfma_f32_32x32x16_bf16 v[80:95], v[236:239], v[180:183], v[80:95]
  ds_read_b64_tr_b16 v[250:251], v12 offset:7168
  ds_read_b64_tr_b16 v[252:253], v13 offset:6144
  ds_read_b64_tr_b16 v[254:255], v13 offset:7168
  s_waitcnt vmcnt(9) lgkmcnt(6)
  v_mfma_f32_32x32x16_bf16 v[64:79], v[240:243], v[184:187], v[64:79]
  ds_read_b64_tr_b16 v[224:225], v10 offset:0
  s_waitcnt lgkmcnt(5)
  v_mfma_f32_32x32x16_bf16 v[80:95], v[244:247], v[184:187], v[80:95]
  ds_read_b64_tr_b16 v[226:227], v10 offset:1024
  ds_read_b64_tr_b16 v[228:229], v11 offset:0
  ds_read_b64_tr_b16 v[230:231], v11 offset:1024
  s_waitcnt vmcnt(8) lgkmcnt(6)
  v_mfma_f32_32x32x16_bf16 v[64:79], v[248:251], v[188:191], v[64:79]
  ds_read_b64_tr_b16 v[232:233], v10 offset:2048
  s_waitcnt lgkmcnt(5)
  v_mfma_f32_32x32x16_bf16 v[80:95], v[252:255], v[188:191], v[80:95]
  ds_read_b64_tr_b16 v[234:235], v10 offset:3072
  ds_read_b64_tr_b16 v[236:237], v11 offset:2048
  ds_read_b64_tr_b16 v[238:239], v11 offset:3072
  s_waitcnt vmcnt(7) lgkmcnt(6)
  v_mfma_f32_32x32x16_bf16 v[64:79], v[224:227], v[192:195], v[64:79]
  v_add_u32 v12, s27, v14
  v_add_u32 v13, s27, v15
  ds_read_b64_tr_b16 v[240:241], v10 offset:4096
  s_waitcnt lgkmcnt(5)
  v_mfma_f32_32x32x16_bf16 v[80:95], v[228:231], v[192:195], v[80:95]
  ds_read_b64_tr_b16 v[242:243], v10 offset:5120
  ds_read_b64_tr_b16 v[244:245], v11 offset:4096
  ds_read_b64_tr_b16 v[246:247], v11 offset:5120
  s_waitcnt vmcnt(6) lgkmcnt(6)
  v_mfma_f32_32x32x16_bf16 v[64:79], v[232:235], v[196:199], v[64:79]
  ds_read_b64_tr_b16 v[248:249], v10 offset:6144
  s_waitcnt lgkmcnt(5)
  v_mfma_f32_32x32x16_bf16 v[80:95], v[236:239], v[196:199], v[80:95]
  ds_read_b64_tr_b16 v[250:251], v10 offset:7168
  ds_read_b64_tr_b16 v[252:253], v11 offset:6144
  ds_read_b64_tr_b16 v[254:255], v11 offset:7168
  s_waitcnt vmcnt(5) lgkmcnt(6)
  v_mfma_f32_32x32x16_bf16 v[64:79], v[240:243], v[200:203], v[64:79]
  ds_read_b64_tr_b16 v[224:225], v12 offset:0
  s_waitcnt lgkmcnt(5)
  v_mfma_f32_32x32x16_bf16 v[80:95], v[244:247], v[200:203], v[80:95]
  ds_read_b64_tr_b16 v[226:227], v12 offset:1024
  ds_read_b64_tr_b16 v[228:229], v13 offset:0
  ds_read_b64_tr_b16 v[230:231], v13 offset:1024
  s_waitcnt vmcnt(4) lgkmcnt(6)
  v_mfma_f32_32x32x16_bf16 v[64:79], v[248:251], v[204:207], v[64:79]
  ds_read_b64_tr_b16 v[232:233], v12 offset:2048
  s_waitcnt lgkmcnt(5)
  v_mfma_f32_32x32x16_bf16 v[80:95], v[252:255], v[204:207], v[80:95]
  ds_read_b64_tr_b16 v[234:235], v12 offset:3072
  ds_read_b64_tr_b16 v[236:237], v13 offset:2048
  ds_read_b64_tr_b16 v[238:239], v13 offset:3072
  s_waitcnt vmcnt(3) lgkmcnt(6)
  v_mfma_f32_32x32x16_bf16 v[64:79], v[224:227], v[208:211], v[64:79]
  ds_read_b64_tr_b16 v[240:241], v12 offset:4096
  s_waitcnt lgkmcnt(5)
  v_mfma_f32_32x32x16_bf16 v[80:95], v[228:231], v[208:211], v[80:95]
  ds_read_b64_tr_b16 v[242:243], v12 offset:5120
  ds_read_b64_tr_b16 v[244:245], v13 offset:4096
  ds_read_b64_tr_b16 v[246:247], v13 offset:5120
  s_waitcnt vmcnt(2) lgkmcnt(6)
  v_mfma_f32_32x32x16_bf16 v[64:79], v[232:235], v[212:215], v[64:79]
  ds_read_b64_tr_b16 v[248:249], v12 offset:6144
  s_waitcnt lgkmcnt(5)
  v_mfma_f32_32x32x16_bf16 v[80:95], v[236:239], v[212:215], v[80:95]
  ds_read_b64_tr_b16 v[250:251], v12 offset:7168
  ds_read_b64_tr_b16 v[252:253], v13 offset:6144
  ds_read_b64_tr_b16 v[254:255], v13 offset:7168
  s_waitcnt vmcnt(1) lgkmcnt(6)
  v_mfma_f32_32x32x16_bf16 v[64:79], v[240:243], v[216:219], v[64:79]
  s_waitcnt lgkmcnt(4)
  v_mfma_f32_32x32x16_bf16 v[80:95], v[244:247], v[216:219], v[80:95]
  s_waitcnt vmcnt(0) lgkmcnt(0)
  v_mfma_f32_32x32x16_bf16 v[64:79], v[248:251], v[220:223], v[64:79]
  v_mfma_f32_32x32x16_bf16 v[80:95], v[252:255], v[220:223], v[80:95]
  s_mov_b32 s36, 0x3f803f80
  v_mov_b32 v8, 0
  v_mov_b32 v9, 0
  v_mov_b32 v10, 0
  v_mov_b32 v11, 0
  v_mov_b32 v12, 0
  v_mov_b32 v13, 0
  v_lshlrev_b32 v19, 2, v18
  v_lshl_add_u32 v19, v17, 13, v19
  s_lshl_b32 s34, s32, 7
  s_add_u32 s34, s34, s66
  s_add_u32 s34, s34, 16384
  s_add_u32 s37, s34, 16384
  v_cvt_pk_bf16_f32 v20, v64, v65
  v_cvt_pk_bf16_f32 v21, v66, v67
  v_cvt_pk_bf16_f32 v22, v68, v69
  v_cvt_pk_bf16_f32 v23, v70, v71
  buffer_store_dwordx4 v[20:23], v16, s[4:7], s39 offen offset:0 sc1
  v_cvt_pk_bf16_f32 v24, v72, v73
  v_cvt_pk_bf16_f32 v25, v74, v75
  v_cvt_pk_bf16_f32 v26, v76, v77
  v_cvt_pk_bf16_f32 v27, v78, v79
  buffer_store_dwordx4 v[24:27], v16, s[4:7], s39 offen offset:512 sc1
  v_cvt_pk_bf16_f32 v28, v80, v81
  v_cvt_pk_bf16_f32 v29, v82, v83
  v_cvt_pk_bf16_f32 v30, v84, v85
  v_cvt_pk_bf16_f32 v31, v86, v87
  buffer_store_dwordx4 v[28:31], v16, s[4:7], s39 offen offset:1024 sc1
  v_cvt_pk_bf16_f32 v32, v88, v89
  v_cvt_pk_bf16_f32 v33, v90, v91
  v_cvt_pk_bf16_f32 v34, v92, v93
  v_cvt_pk_bf16_f32 v35, v94, v95
  buffer_store_dwordx4 v[32:35], v16, s[4:7], s39 offen offset:1536 sc1
  v_dot2c_f32_bf16 v8, s36, v20
  v_dot2c_f32_bf16 v9, v20, v20
  v_dot2c_f32_bf16 v10, v20, v48
  v_dot2c_f32_bf16 v11, s36, v21
  v_dot2c_f32_bf16 v12, v21, v21
  v_dot2c_f32_bf16 v13, v21, v49
  v_dot2c_f32_bf16 v8, s36, v22
  v_dot2c_f32_bf16 v9, v22, v22
  v_dot2c_f32_bf16 v10, v22, v50
  v_dot2c_f32_bf16 v11, s36, v23
  v_dot2c_f32_bf16 v12, v23, v23
  v_dot2c_f32_bf16 v13, v23, v51
  v_dot2c_f32_bf16 v8, s36, v24
  v_dot2c_f32_bf16 v9, v24, v24
  v_dot2c_f32_bf16 v10, v24, v52
  v_dot2c_f32_bf16 v11, s36, v25
  v_dot2c_f32_bf16 v12, v25, v25
  v_dot2c_f32_bf16 v13, v25, v53
  v_dot2c_f32_bf16 v8, s36, v26
  v_dot2c_f32_bf16 v9, v26, v26
  v_dot2c_f32_bf16 v10, v26, v54
  v_dot2c_f32_bf16 v11, s36, v27
  v_dot2c_f32_bf16 v12, v27, v27
  v_dot2c_f32_bf16 v13, v27, v55
  v_dot2c_f32_bf16 v8, s36, v28
  v_dot2c_f32_bf16 v9, v28, v28
  v_dot2c_f32_bf16 v10, v28, v56
  v_dot2c_f32_bf16 v11, s36, v29
  v_dot2c_f32_bf16 v12, v29, v29
  v_dot2c_f32_bf16 v13, v29, v57
  v_dot2c_f32_bf16 v8, s36, v30
  v_dot2c_f32_bf16 v9, v30, v30
  v_dot2c_f32_bf16 v10, v30, v58
  v_dot2c_f32_bf16 v11, s36, v31
  v_dot2c_f32_bf16 v12, v31, v31
  v_dot2c_f32_bf16 v13, v31, v59
  v_dot2c_f32_bf16 v8, s36, v32
  v_dot2c_f32_bf16 v9, v32, v32
  v_dot2c_f32_bf16 v10, v32, v60
  v_dot2c_f32_bf16 v11, s36, v33
  v_dot2c_f32_bf16 v12, v33, v33
  v_dot2c_f32_bf16 v13, v33, v61
  v_dot2c_f32_bf16 v8, s36, v34
  v_dot2c_f32_bf16 v9, v34, v34
  v_dot2c_f32_bf16 v10, v34, v62
  v_dot2c_f32_bf16 v11, s36, v35
  v_dot2c_f32_bf16 v12, v35, v35
  v_dot2c_f32_bf16 v13, v35, v63
  s_nop 0
  v_add_f32 v36, v8, v11
  v_add_f32 v37, v9, v12
  v_add_f32 v38, v10, v13
  v_fma_f32 v38, -v36, v46, v38
  v_fmac_f32 v47, 0x44800000, v37
  v_mov_b32 v39, v38
  s_nop 0
  v_permlane32_swap_b32 v36, v47
  v_permlane32_swap_b32 v38, v39
  v_add_f32 v36, v36, v47
  v_add_f32 v38, v38, v39
  buffer_atomic_add_f32 v36, v19, s[4:7], s34 offen sc1
  s_mov_b32 exec_hi, 0
  buffer_atomic_add_f32 v38, v19, s[4:7], s37 offen sc1
  s_mov_b64 exec, -1
  s_barrier
  v_add_u32 v1, 4, v6
  s_mov_b32 s72, s66
  s_mov_b32 s73, s65
  s_mov_b32 s74, s67
  s_mov_b32 s75, s62
  s_cmp_lg_u32 s62, 0
  s_cbranch_scc1 .fz_kernel_tail
  s_mov_b32 s62, 1
  s_mov_b32 s63, 0x2000000
  s_mov_b32 s64, 0x2800000
  s_mov_b32 s65, 0x1400000
  s_mov_b32 s66, 0x1c42000
  s_mov_b32 s67, 12
  s_mov_b32 s71, 159776
  v_mov_b32 v6, 159832
  s_branch .fz_kernel_q_cons2
.fz_kernel_tail:
  s_mov_b32 s28, s56
  s_mov_b32 s29, s57
  s_mov_b32 s30, 0x400000
  s_mov_b32 s31, 0x00020000
  v_lshlrev_b32 v37, 2, v45
  v_add_u32 v37, 155644, v37
  v_mov_b32 v36, 159952
  v_lshlrev_b32 v38, 11, v18
  v_lshl_add_u32 v38, v17, 4, v38
  s_lshl_b32 s32, s32, 16
  s_lshl_b32 s33, s18, 7
  s_add_u32 s32, s32, s33
  v_lshlrev_b32 v64, 16, v20
  v_and_b32 v65, 0xffff0000, v20
  v_lshlrev_b32 v66, 16, v21
  v_and_b32 v67, 0xffff0000, v21
  v_lshlrev_b32 v68, 16, v22
  v_and_b32 v69, 0xffff0000, v22
  v_lshlrev_b32 v70, 16, v23
  v_and_b32 v71, 0xffff0000, v23
  v_lshlrev_b32 v72, 16, v24
  v_and_b32 v73, 0xffff0000, v24
  v_lshlrev_b32 v74, 16, v25
  v_and_b32 v75, 0xffff0000, v25
  v_lshlrev_b32 v76, 16, v26
  v_and_b32 v77, 0xffff0000, v26
  v_lshlrev_b32 v78, 16, v27
  v_and_b32 v79, 0xffff0000, v27
  v_lshlrev_b32 v80, 16, v28
  v_and_b32 v81, 0xffff0000, v28
  v_lshlrev_b32 v82, 16, v29
  v_and_b32 v83, 0xffff0000, v29
  v_lshlrev_b32 v84, 16, v30
  v_and_b32 v85, 0xffff0000, v30
  v_lshlrev_b32 v86, 16, v31
  v_and_b32 v87, 0xffff0000, v31
  v_lshlrev_b32 v88, 16, v32
  v_and_b32 v89, 0xffff0000, v32
  v_lshlrev_b32 v90, 16, v33
  v_and_b32 v91, 0xffff0000, v33
  v_lshlrev_b32 v92, 16, v34
  v_and_b32 v93, 0xffff0000, v34
  v_lshlrev_b32 v94, 16, v35
  v_and_b32 v95, 0xffff0000, v35
  s_mov_b64 exec, 1
  s_waitcnt vmcnt(0)
  ds_add_u32 v1, v5 offset:0x100
  s_mov_b64 exec, -1
  s_barrier
  ds_read_b32 v40, v37 offset:6400
  ds_read_b32 v42, v37 offset:6912
  ds_read_b32 v36, v36
  s_waitcnt lgkmcnt(0)
  v_cmp_ne_u32 vcc, v36, v45
  s_mov_b64 exec, vcc
  v_pk_fma_f32 v[64:65], v[64:65], v[40:41], v[42:43] op_sel_hi:[1,0,0]
  v_pk_fma_f32 v[66:67], v[66:67], v[40:41], v[42:43] op_sel_hi:[1,0,0]
  v_pk_fma_f32 v[68:69], v[68:69], v[40:41], v[42:43] op_sel_hi:[1,0,0]
  v_pk_fma_f32 v[70:71], v[70:71], v[40:41], v[42:43] op_sel_hi:[1,0,0]
  v_cvt_pk_bf16_f32 v20, v64, v65
  v_cvt_pk_bf16_f32 v21, v66, v67
  v_cvt_pk_bf16_f32 v22, v68, v69
  v_cvt_pk_bf16_f32 v23, v70, v71
  buffer_store_dwordx4 v[20:23], v38, s[28:31], s32 offen offset:0
  v_pk_fma_f32 v[72:73], v[72:73], v[40:41], v[42:43] op_sel_hi:[1,0,0]
  v_pk_fma_f32 v[74:75], v[74:75], v[40:41], v[42:43] op_sel_hi:[1,0,0]
  v_pk_fma_f32 v[76:77], v[76:77], v[40:41], v[42:43] op_sel_hi:[1,0,0]
  v_pk_fma_f32 v[78:79], v[78:79], v[40:41], v[42:43] op_sel_hi:[1,0,0]
  v_cvt_pk_bf16_f32 v24, v72, v73
  v_cvt_pk_bf16_f32 v25, v74, v75
  v_cvt_pk_bf16_f32 v26, v76, v77
  v_cvt_pk_bf16_f32 v27, v78, v79
  buffer_store_dwordx4 v[24:27], v38, s[28:31], s32 offen offset:32
  v_pk_fma_f32 v[80:81], v[80:81], v[40:41], v[42:43] op_sel_hi:[1,0,0]
  v_pk_fma_f32 v[82:83], v[82:83], v[40:41], v[42:43] op_sel_hi:[1,0,0]
  v_pk_fma_f32 v[84:85], v[84:85], v[40:41], v[42:43] op_sel_hi:[1,0,0]
  v_pk_fma_f32 v[86:87], v[86:87], v[40:41], v[42:43] op_sel_hi:[1,0,0]
  v_cvt_pk_bf16_f32 v28, v80, v81
  v_cvt_pk_bf16_f32 v29, v82, v83
  v_cvt_pk_bf16_f32 v30, v84, v85
  v_cvt_pk_bf16_f32 v31, v86, v87
  buffer_store_dwordx4 v[28:31], v38, s[28:31], s32 offen offset:64
  v_pk_fma_f32 v[88:89], v[88:89], v[40:41], v[42:43] op_sel_hi:[1,0,0]
  v_pk_fma_f32 v[90:91], v[90:91], v[40:41], v[42:43] op_sel_hi:[1,0,0]
  v_pk_fma_f32 v[92:93], v[92:93], v[40:41], v[42:43] op_sel_hi:[1,0,0]
  v_pk_fma_f32 v[94:95], v[94:95], v[40:41], v[42:43] op_sel_hi:[1,0,0]
  v_cvt_pk_bf16_f32 v32, v88, v89
  v_cvt_pk_bf16_f32 v33, v90, v91
  v_cvt_pk_bf16_f32 v34, v92, v93
  v_cvt_pk_bf16_f32 v35, v94, v95
  buffer_store_dwordx4 v[32:35], v38, s[28:31], s32 offen offset:96
  s_mov_b64 exec, -1
  s_branch .fz_kernel_fin
.fz_kernel_chain:
  s_setprio 0
  s_bitcmp1_b32 s18, 0
  s_cselect_b32 s8, s52, s50
  s_cselect_b32 s9, s53, s51
  s_mov_b32 s10, 0x700000
  s_mov_b32 s11, 0x00020000
  s_lshl_b32 s12, s16, 8
  s_and_b32 s12, s12, 511
  s_and_b32 s31, s18, 2
  s_lshl_b32 s31, s31, 8
  s_add_u32 s12, s12, s31
  s_mul_i32 s12, s12, 7168
  s_lshl_b32 s31, s17, 2
  s_lshr_b32 s33, s18, 2
  s_add_u32 s31, s31, s33
  s_lshl_b32 s31, s31, 7
  s_add_u32 s12, s12, s31
  v_lshrrev_b32 v13, 3, v2
  v_mul_u32_u24 v13, 229376, v13
  v_and_b32 v11, 7, v2
  v_lshl_add_u32 v13, v11, 4, v13
  s_mov_b32 s24, s44
  s_mov_b32 s25, s45
  s_mov_b32 s26, 0x200000
  s_mov_b32 s27, 0x00020000
  v_lshrrev_b32 v8, 3, v2
  v_and_b32 v9, 7, v2
  v_bfe_u32 v10, v2, 4, 1
  v_lshlrev_b32 v10, 2, v10
  v_xor_b32 v9, v9, v10
  v_lshlrev_b32 v9, 4, v9
  v_lshl_add_u32 v10, v8, 11, v9
  s_mov_b32 s24, s54
  s_mov_b32 s25, s55
  s_mov_b32 s26, 0x700000
  s_mov_b32 s27, 0x00020000
  s_mov_b32 s36, 0x05040100
  s_mov_b32 s37, 0x07060302
  s_and_b32 s20, s16, 1
  s_lshl1_add_u32 s13, s17, s20
  s_lshl_b32 s13, s13, 18
  s_lshl_b32 s14, s18, 7
  s_add_u32 s13, s13, s14
  s_cmp_ge_u32 s17, 14
  s_cbranch_scc1 .fz_kernel_c_nl
  s_mov_b32 s38, 0
.fz_kernel_kw66:
  s_sleep 2
  ds_read_b32 v7, v6 offset:0
  s_add_u32 s38, s38, 1
  s_waitcnt lgkmcnt(0)
  v_readfirstlane_b32 s31, v7
  s_bcnt1_i32_b32 s31, s31
  s_cmp_ge_u32 s31, 16
  s_cbranch_scc1 .fz_kernel_kw66d
  s_cmp_lt_u32 s38, 1048576
  s_cbranch_scc1 .fz_kernel_kw66
.fz_kernel_kw66d:
  buffer_load_dwordx4 v[112:115], v13, s[8:11], s12 offen nt
  s_add_u32 s12, s12, 7168
  s_waitcnt vmcnt(2)
  buffer_load_dwordx4 v[116:119], v13, s[8:11], s12 offen nt
  s_add_u32 s12, s12, 7168
  s_waitcnt vmcnt(2)
  buffer_load_dwordx4 v[120:123], v13, s[8:11], s12 offen nt
  s_add_u32 s12, s12, 7168
  s_waitcnt vmcnt(2)
  buffer_load_dwordx4 v[124:127], v13, s[8:11], s12 offen nt
  s_add_u32 s12, s12, 7168
  s_waitcnt vmcnt(2)
  buffer_load_dwordx4 v[128:131], v13, s[8:11], s12 offen nt
  s_add_u32 s12, s12, 7168
  s_waitcnt vmcnt(2)
  buffer_load_dwordx4 v[132:135], v13, s[8:11], s12 offen nt
  s_add_u32 s12, s12, 7168
  s_waitcnt vmcnt(2)
  buffer_load_dwordx4 v[136:139], v13, s[8:11], s12 offen nt
  s_add_u32 s12, s12, 7168
  s_waitcnt vmcnt(2)
  buffer_load_dwordx4 v[140:143], v13, s[8:11], s12 offen nt
  s_add_u32 s12, s12, 7168
  s_waitcnt vmcnt(2)
  buffer_load_dwordx4 v[144:147], v13, s[8:11], s12 offen nt
  s_add_u32 s12, s12, 7168
  s_waitcnt vmcnt(2)
  buffer_load_dwordx4 v[148:151], v13, s[8:11], s12 offen nt
  s_add_u32 s12, s12, 7168
  s_waitcnt vmcnt(2)
  buffer_load_dwordx4 v[152:155], v13, s[8:11], s12 offen nt
  s_add_u32 s12, s12, 7168
  s_waitcnt vmcnt(2)
  buffer_load_dwordx4 v[156:159], v13, s[8:11], s12 offen nt
  s_add_u32 s12, s12, 7168
  s_waitcnt vmcnt(2)
  buffer_load_dwordx4 v[160:163], v13, s[8:11], s12 offen nt
  s_add_u32 s12, s12, 7168
  s_waitcnt vmcnt(2)
  buffer_load_dwordx4 v[164:167], v13, s[8:11], s12 offen nt
  s_add_u32 s12, s12, 7168
  s_waitcnt vmcnt(2)
  buffer_load_dwordx4 v[168:171], v13, s[8:11], s12 offen nt
  s_add_u32 s12, s12, 7168
  s_waitcnt vmcnt(2)
  buffer_load_dwordx4 v[172:175], v13, s[8:11], s12 offen nt
  s_add_u32 s12, s12, 7168
  s_waitcnt vmcnt(2)
  buffer_load_dwordx4 v[176:179], v13, s[8:11], s12 offen nt
  s_add_u32 s12, s12, 7168
  s_waitcnt vmcnt(2)
  buffer_load_dwordx4 v[180:183], v13, s[8:11], s12 offen nt
  s_add_u32 s12, s12, 7168
  s_waitcnt vmcnt(2)
  buffer_load_dwordx4 v[184:187], v13, s[8:11], s12 offen nt
  s_add_u32 s12, s12, 7168
  s_waitcnt vmcnt(2)
  buffer_load_dwordx4 v[188:191], v13, s[8:11], s12 offen nt
  s_add_u32 s12, s12, 7168
  s_waitcnt vmcnt(2)
  buffer_load_dwordx4 v[192:195], v13, s[8:11], s12 offen nt
  s_add_u32 s12, s12, 7168
  s_waitcnt vmcnt(2)
  buffer_load_dwordx4 v[196:199], v13, s[8:11], s12 offen nt
  s_add_u32 s12, s12, 7168
  s_waitcnt vmcnt(2)
  buffer_load_dwordx4 v[200:203], v13, s[8:11], s12 offen nt
  s_add_u32 s12, s12, 7168
  s_waitcnt vmcnt(2)
  buffer_load_dwordx4 v[204:207], v13, s[8:11], s12 offen nt
  s_add_u32 s12, s12, 7168
  s_waitcnt vmcnt(2)
  buffer_load_dwordx4 v[208:211], v13, s[8:11], s12 offen nt
  s_add_u32 s12, s12, 7168
  s_waitcnt vmcnt(2)
  buffer_load_dwordx4 v[212:215], v13, s[8:11], s12 offen nt
  s_add_u32 s12, s12, 7168
  s_waitcnt vmcnt(2)
  buffer_load_dwordx4 v[216:219], v13, s[8:11], s12 offen nt
  s_add_u32 s12, s12, 7168
  s_waitcnt vmcnt(2)
  buffer_load_dwordx4 v[220:223], v13, s[8:11], s12 offen nt
  s_add_u32 s12, s12, 7168
  s_waitcnt vmcnt(2)
  buffer_load_dwordx4 v[224:227], v13, s[8:11], s12 offen nt
  s_add_u32 s12, s12, 7168
  s_waitcnt vmcnt(2)
  buffer_load_dwordx4 v[228:231], v13, s[8:11], s12 offen nt
  s_add_u32 s12, s12, 7168
  s_waitcnt vmcnt(2)
  buffer_load_dwordx4 v[232:235], v13, s[8:11], s12 offen nt
  s_add_u32 s12, s12, 7168
  s_waitcnt vmcnt(2)
  buffer_load_dwordx4 v[236:239], v13, s[8:11], s12 offen nt
  s_add_u32 s12, s12, 7168
  s_waitcnt vmcnt(2)
  buffer_load_dwordx4 v[32:35], v10, s[24:27], s13 offen nt
  s_add_u32 s13, s13, 16384
  s_waitcnt vmcnt(2)
  buffer_load_dwordx4 v[36:39], v10, s[24:27], s13 offen nt
  s_add_u32 s13, s13, 16384
  s_waitcnt vmcnt(2)
  buffer_load_dwordx4 v[40:43], v10, s[24:27], s13 offen nt
  s_add_u32 s13, s13, 16384
  s_waitcnt vmcnt(2)
  buffer_load_dwordx4 v[44:47], v10, s[24:27], s13 offen nt
  s_add_u32 s13, s13, 16384
  s_waitcnt vmcnt(2)
  buffer_load_dwordx4 v[48:51], v10, s[24:27], s13 offen nt
  s_add_u32 s13, s13, 16384
  s_waitcnt vmcnt(2)
  buffer_load_dwordx4 v[52:55], v10, s[24:27], s13 offen nt
  s_add_u32 s13, s13, 16384
  s_waitcnt vmcnt(2)
  buffer_load_dwordx4 v[56:59], v10, s[24:27], s13 offen nt
  s_add_u32 s13, s13, 16384
  s_waitcnt vmcnt(2)
  buffer_load_dwordx4 v[60:63], v10, s[24:27], s13 offen nt
  s_add_u32 s13, s13, 16384
  s_waitcnt vmcnt(2)
  buffer_load_dwordx4 v[64:67], v10, s[24:27], s13 offen nt
  s_add_u32 s13, s13, 16384
  s_waitcnt vmcnt(2)
  buffer_load_dwordx4 v[68:71], v10, s[24:27], s13 offen nt
  s_add_u32 s13, s13, 16384
  s_waitcnt vmcnt(2)
  buffer_load_dwordx4 v[72:75], v10, s[24:27], s13 offen nt
  s_add_u32 s13, s13, 16384
  s_waitcnt vmcnt(2)
  buffer_load_dwordx4 v[76:79], v10, s[24:27], s13 offen nt
  s_add_u32 s13, s13, 16384
  s_waitcnt vmcnt(2)
  buffer_load_dwordx4 v[240:243], v10, s[24:27], s13 offen nt
  s_add_u32 s13, s13, 16384
  s_waitcnt vmcnt(2)
  buffer_load_dwordx4 v[244:247], v10, s[24:27], s13 offen nt
  s_add_u32 s13, s13, 16384
  s_waitcnt vmcnt(2)
  buffer_load_dwordx4 v[248:251], v10, s[24:27], s13 offen nt
  s_add_u32 s13, s13, 16384
  s_waitcnt vmcnt(2)
  buffer_load_dwordx4 v[252:255], v10, s[24:27], s13 offen nt
  s_add_u32 s13, s13, 16384
  s_waitcnt vmcnt(2)
  v_mov_b32 v16, 0x3f803f80
  v_mov_b32 v17, 0x3f803f80
  v_mov_b32 v18, 0x3f803f80
  v_mov_b32 v19, 0x3f803f80
  s_waitcnt vmcnt(0)
  s_barrier
  v_perm_b32 v80, v116, v112, s36
  v_perm_b32 v84, v116, v112, s37
  v_perm_b32 v88, v117, v113, s36
  v_perm_b32 v92, v117, v113, s37
  v_perm_b32 v96, v118, v114, s36
  v_perm_b32 v100, v118, v114, s37
  v_perm_b32 v104, v119, v115, s36
  v_perm_b32 v108, v119, v115, s37
  v_perm_b32 v81, v124, v120, s36
  v_perm_b32 v85, v124, v120, s37
  v_perm_b32 v89, v125, v121, s36
  v_perm_b32 v93, v125, v121, s37
  v_perm_b32 v97, v126, v122, s36
  v_perm_b32 v101, v126, v122, s37
  v_perm_b32 v105, v127, v123, s36
  v_perm_b32 v109, v127, v123, s37
  v_perm_b32 v82, v132, v128, s36
  v_perm_b32 v86, v132, v128, s37
  v_perm_b32 v90, v133, v129, s36
  v_perm_b32 v94, v133, v129, s37
  v_perm_b32 v98, v134, v130, s36
  v_perm_b32 v102, v134, v130, s37
  v_perm_b32 v106, v135, v131, s36
  v_perm_b32 v110, v135, v131, s37
  v_perm_b32 v83, v140, v136, s36
  v_perm_b32 v87, v140, v136, s37
  v_perm_b32 v91, v141, v137, s36
  v_perm_b32 v95, v141, v137, s37
  v_perm_b32 v99, v142, v138, s36
  v_perm_b32 v103, v142, v138, s37
  v_perm_b32 v107, v143, v139, s36
  v_perm_b32 v111, v143, v139, s37
  v_perm_b32 v112, v148, v144, s36
  v_perm_b32 v116, v148, v144, s37
  v_perm_b32 v120, v149, v145, s36
  v_perm_b32 v124, v149, v145, s37
  v_perm_b32 v128, v150, v146, s36
  v_perm_b32 v132, v150, v146, s37
  v_perm_b32 v136, v151, v147, s36
  v_perm_b32 v140, v151, v147, s37
  v_perm_b32 v113, v156, v152, s36
  v_perm_b32 v117, v156, v152, s37
  v_perm_b32 v121, v157, v153, s36
  v_perm_b32 v125, v157, v153, s37
  v_perm_b32 v129, v158, v154, s36
  v_perm_b32 v133, v158, v154, s37
  v_perm_b32 v137, v159, v155, s36
  v_perm_b32 v141, v159, v155, s37
  v_perm_b32 v114, v164, v160, s36
  v_perm_b32 v118, v164, v160, s37
  v_perm_b32 v122, v165, v161, s36
  v_perm_b32 v126, v165, v161, s37
  v_perm_b32 v130, v166, v162, s36
  v_perm_b32 v134, v166, v162, s37
  v_perm_b32 v138, v167, v163, s36
  v_perm_b32 v142, v167, v163, s37
  v_perm_b32 v115, v172, v168, s36
  v_perm_b32 v119, v172, v168, s37
  v_perm_b32 v123, v173, v169, s36
  v_perm_b32 v127, v173, v169, s37
  v_perm_b32 v131, v174, v170, s36
  v_perm_b32 v135, v174, v170, s37
  v_perm_b32 v139, v175, v171, s36
  v_perm_b32 v143, v175, v171, s37
  v_perm_b32 v144, v180, v176, s36
  v_perm_b32 v148, v180, v176, s37
  v_perm_b32 v152, v181, v177, s36
  v_perm_b32 v156, v181, v177, s37
  v_perm_b32 v160, v182, v178, s36
  v_perm_b32 v164, v182, v178, s37
  v_perm_b32 v168, v183, v179, s36
  v_perm_b32 v172, v183, v179, s37
  v_perm_b32 v145, v188, v184, s36
  v_perm_b32 v149, v188, v184, s37
  v_perm_b32 v153, v189, v185, s36
  v_perm_b32 v157, v189, v185, s37
  v_perm_b32 v161, v190, v186, s36
  v_perm_b32 v165, v190, v186, s37
  v_perm_b32 v169, v191, v187, s36
  v_perm_b32 v173, v191, v187, s37
  v_perm_b32 v146, v196, v192, s36
  v_perm_b32 v150, v196, v192, s37
  v_perm_b32 v154, v197, v193, s36
  v_perm_b32 v158, v197, v193, s37
  v_perm_b32 v162, v198, v194, s36
  v_perm_b32 v166, v198, v194, s37
  v_perm_b32 v170, v199, v195, s36
  v_perm_b32 v174, v199, v195, s37
  v_perm_b32 v147, v204, v200, s36
  v_perm_b32 v151, v204, v200, s37
  v_perm_b32 v155, v205, v201, s36
  v_perm_b32 v159, v205, v201, s37
  v_perm_b32 v163, v206, v202, s36
  v_perm_b32 v167, v206, v202, s37
  v_perm_b32 v171, v207, v203, s36
  v_perm_b32 v175, v207, v203, s37
  v_perm_b32 v176, v212, v208, s36
  v_perm_b32 v180, v212, v208, s37
  v_perm_b32 v184, v213, v209, s36
  v_perm_b32 v188, v213, v209, s37
  v_perm_b32 v192, v214, v210, s36
  v_perm_b32 v196, v214, v210, s37
  v_perm_b32 v200, v215, v211, s36
  v_perm_b32 v204, v215, v211, s37
  v_perm_b32 v177, v220, v216, s36
  v_perm_b32 v181, v220, v216, s37
  v_perm_b32 v185, v221, v217, s36
  v_perm_b32 v189, v221, v217, s37
  v_perm_b32 v193, v222, v218, s36
  v_perm_b32 v197, v222, v218, s37
  v_perm_b32 v201, v223, v219, s36
  v_perm_b32 v205, v223, v219, s37
  v_perm_b32 v178, v228, v224, s36
  v_perm_b32 v182, v228, v224, s37
  v_perm_b32 v186, v229, v225, s36
  v_perm_b32 v190, v229, v225, s37
  v_perm_b32 v194, v230, v226, s36
  v_perm_b32 v198, v230, v226, s37
  v_perm_b32 v202, v231, v227, s36
  v_perm_b32 v206, v231, v227, s37
  v_perm_b32 v179, v236, v232, s36
  v_perm_b32 v183, v236, v232, s37
  v_perm_b32 v187, v237, v233, s36
  v_perm_b32 v191, v237, v233, s37
  v_perm_b32 v195, v238, v234, s36
  v_perm_b32 v199, v238, v234, s37
  v_perm_b32 v203, v239, v235, s36
  v_perm_b32 v207, v239, v235, s37
  v_mfma_f32_16x16x32_bf16 v[208:211], v[16:19], v[80:83], 0
  v_mfma_f32_16x16x32_bf16 v[212:215], v[16:19], v[84:87], 0
  v_mfma_f32_16x16x32_bf16 v[216:219], v[16:19], v[88:91], 0
  v_mfma_f32_16x16x32_bf16 v[220:223], v[16:19], v[92:95], 0
  v_mfma_f32_16x16x32_bf16 v[224:227], v[16:19], v[96:99], 0
  v_mfma_f32_16x16x32_bf16 v[228:231], v[16:19], v[100:103], 0
  v_mfma_f32_16x16x32_bf16 v[232:235], v[16:19], v[104:107], 0
  v_mfma_f32_16x16x32_bf16 v[236:239], v[16:19], v[108:111], 0
  v_mfma_f32_16x16x32_bf16 v[208:211], v[16:19], v[112:115], v[208:211]
  v_mfma_f32_16x16x32_bf16 v[212:215], v[16:19], v[116:119], v[212:215]
  v_mfma_f32_16x16x32_bf16 v[216:219], v[16:19], v[120:123], v[216:219]
  v_mfma_f32_16x16x32_bf16 v[220:223], v[16:19], v[124:127], v[220:223]
  v_mfma_f32_16x16x32_bf16 v[224:227], v[16:19], v[128:131], v[224:227]
  v_mfma_f32_16x16x32_bf16 v[228:231], v[16:19], v[132:135], v[228:231]
  v_mfma_f32_16x16x32_bf16 v[232:235], v[16:19], v[136:139], v[232:235]
  v_mfma_f32_16x16x32_bf16 v[236:239], v[16:19], v[140:143], v[236:239]
  v_mfma_f32_16x16x32_bf16 v[208:211], v[16:19], v[144:147], v[208:211]
  v_mfma_f32_16x16x32_bf16 v[212:215], v[16:19], v[148:151], v[212:215]
  v_mfma_f32_16x16x32_bf16 v[216:219], v[16:19], v[152:155], v[216:219]
  v_mfma_f32_16x16x32_bf16 v[220:223], v[16:19], v[156:159], v[220:223]
  v_mfma_f32_16x16x32_bf16 v[224:227], v[16:19], v[160:163], v[224:227]
  v_mfma_f32_16x16x32_bf16 v[228:231], v[16:19], v[164:167], v[228:231]
  v_mfma_f32_16x16x32_bf16 v[232:235], v[16:19], v[168:171], v[232:235]
  v_mfma_f32_16x16x32_bf16 v[236:239], v[16:19], v[172:175], v[236:239]
  v_mfma_f32_16x16x32_bf16 v[208:211], v[16:19], v[176:179], v[208:211]
  v_mfma_f32_16x16x32_bf16 v[212:215], v[16:19], v[180:183], v[212:215]
  v_mfma_f32_16x16x32_bf16 v[216:219], v[16:19], v[184:187], v[216:219]
  v_mfma_f32_16x16x32_bf16 v[220:223], v[16:19], v[188:191], v[220:223]
  v_mfma_f32_16x16x32_bf16 v[224:227], v[16:19], v[192:195], v[224:227]
  v_mfma_f32_16x16x32_bf16 v[228:231], v[16:19], v[196:199], v[228:231]
  v_mfma_f32_16x16x32_bf16 v[232:235], v[16:19], v[200:203], v[232:235]
  v_mfma_f32_16x16x32_bf16 v[236:239], v[16:19], v[204:207], v[236:239]
  s_nop 0
  v_add_f32 v28, v209, v208 row_ror:8 row_mask:0xf bank_mask:0x3
  v_add_f32 v29, v213, v212 row_ror:8 row_mask:0xf bank_mask:0x3
  v_add_f32 v30, v217, v216 row_ror:8 row_mask:0xf bank_mask:0x3
  v_add_f32 v31, v221, v220 row_ror:8 row_mask:0xf bank_mask:0x3
  v_add_f32 v28, v224, v225 row_ror:8 row_mask:0xf bank_mask:0xc
  v_add_f32 v29, v228, v229 row_ror:8 row_mask:0xf bank_mask:0xc
  v_add_f32 v30, v232, v233 row_ror:8 row_mask:0xf bank_mask:0xc
  v_add_f32 v31, v236, v237 row_ror:8 row_mask:0xf bank_mask:0xc
  v_mul_f32 v28, 0.0009765625, v28
  v_mul_f32 v29, 0.0009765625, v29
  v_mul_f32 v30, 0.0009765625, v30
  v_mul_f32 v31, 0.0009765625, v31
.fz_kernel_c_np:
  v_mov_b32 v27, v6
  s_mov_b32 s72, s66
  s_mov_b32 s73, s65
  s_mov_b32 s74, s67
  s_mov_b32 s75, s62
  s_cmp_lg_u32 s62, 0
  s_cbranch_scc1 .fz_kernel_c_n2
  s_mov_b32 s62, 1
  s_mov_b32 s63, 0x2000000
  s_mov_b32 s64, 0x2800000
  s_mov_b32 s65, 0x1400000
  s_mov_b32 s66, 0x1c42000
  s_mov_b32 s67, 12
  s_mov_b32 s71, 159776
  v_mov_b32 v6, 159832
.fz_kernel_c_n2:
  s_lshr_b32 s21, s17, 3
  s_add_u32 s70, s18, s21
  s_lshl1_add_u32 s70, s17, s70
  s_and_b32 s70, s70, 15
  s_cmp_eq_u32 s75, 0
  s_cselect_b32 s3, 32, 0
  s_cselect_b32 s70, s70, s18
  s_and_b32 s20, s16, 1
  s_mov_b32 s34, 0x00030003
  s_mov_b32 s35, 0x00030003
  s_mov_b32 s71, 0
  s_lshl1_add_u32 s26, s17, s20
  v_lshrrev_b32 v8, 4, v2
  v_lshrrev_b32 v12, 5, v2
  v_lshlrev_b32 v12, 10, v12
  v_bfe_u32 v14, v2, 3, 2
  v_lshl_add_u32 v12, v14, 8, v12
  v_and_b32 v14, 7, v2
  v_lshl_add_u32 v12, v14, 1, v12
  v_lshlrev_b32 v10, 7, v2
  v_lshrrev_b32 v14, 1, v8
  v_mul_u32_u24 v7, 12288, v14
  v_and_b32 v14, 1, v8
  v_lshl_add_u32 v7, v14, 11, v7
  v_bfe_u32 v14, v2, 2, 2
  v_lshl_add_u32 v7, v14, 7, v7
  v_lshrrev_b32 v14, 1, v14
  v_lshl_add_u32 v14, s20, 1, v14
  v_lshl_add_u32 v7, v14, 5, v7
  v_and_b32 v14, 3, v2
  v_lshl_add_u32 v7, v14, 3, v7
  v_add_u32 v7, 65536, v7
  v_xor_b32 v9, 32, v7
  s_and_b32 s61, s18, 2
  s_add_u32 s61, s61, s20
  s_and_b32 s32, s18, 1
  s_lshl2_add_u32 s32, s32, s61
  s_lshl_b32 s32, s32, 9
  s_lshl_b32 s22, s17, 13
  s_add_u32 s32, s32, s22
  s_and_b32 s22, s18, 8
  s_lshl_b32 s22, s22, 9
  s_add_u32 s32, s32, s22
  s_and_b32 s22, s18, 4
  s_lshl_b32 s22, s22, 6
  s_add_u32 s32, s32, s22
  s_add_u32 s32, s32, s72
  s_add_u32 s32, s32, 40960
  s_lshl_b32 s61, s61, 16
  s_lshl_b32 s33, s26, 12
  s_add_u32 s33, s33, s72
  s_add_u32 s33, s33, 40960
  s_mul_i32 s39, s18, 28
  s_add_u32 s39, s39, s26
  s_lshl_b32 s39, s39, 8
  s_add_u32 s39, s39, s72
  s_add_u32 s39, s39, 155648
  s_lshl4_add_u32 s60, s18, s17
  s_lshl_b32 s60, s60, 10
  s_add_u32 s60, s60, 0x1c84000
  s_add_u32 s21, s74, 0x1800008
  s_sub_u32 s22, s72, 32768
  v_mov_b32 v14, s21
  v_mov_b32 v15, s22
  v_cmp_gt_u32 vcc, 16, v2
  s_nop 1
  v_cndmask_b32 v14, v15, v14, vcc
  v_lshl_add_u32 v14, v2, 11, v14
  s_lshl_b32 s25, s17, 7
  s_lshl_b32 s22, 1, s18
  v_mov_b32 v15, s22
  v_lshlrev_b32 v16, 3, v2
  s_and_b32 s21, s2, 7
  s_lshl_b32 s21, s21, 11
  s_lshl_b32 s22, s20, 10
  s_add_u32 s21, s21, s22
  s_add_u32 s21, s21, s72
  s_lshl_b32 s22, s20, 12
  s_add_u32 s22, s22, s72
  s_add_u32 s22, s22, 16384
  s_add_u32 s23, s22, 8192
  s_add_u32 s24, s22, 16384
  v_and_b32 v17, 1, v8
  v_lshlrev_b32 v17, 13, v17
  v_lshrrev_b32 v18, 1, v8
  v_mul_u32_u24 v18, 320, v18
  v_add_u32 v17, v17, v18
  v_bfe_u32 v18, v2, 3, 1
  v_lshl_add_u32 v17, v18, 9, v17
  v_bfe_u32 v18, v2, 2, 1
  v_lshl_add_u32 v17, v18, 7, v17
  v_and_b32 v18, 3, v2
  v_lshl_add_u32 v17, v18, 3, v17
  s_lshl_b32 s27, s20, 14
  s_add_u32 s27, s27, 114688
  v_add_u32 v17, s27, v17
  v_xor_b32 v18, 64, v17
  v_and_b32 v20, 7, v2
  v_lshlrev_b32 v20, 5, v20
  v_and_b32 v21, 8, v2
  v_lshl_add_u32 v20, v21, 1, v20
  v_and_b32 v21, 31, v2
  v_lshlrev_b32 v21, 4, v21
  v_lshrrev_b32 v22, 5, v2
  v_lshl_add_u32 v21, v22, 11, v21
  v_mov_b32 v23, 0.0009765625
  v_mov_b32 v24, 9.5367431640625e-07
  v_mov_b32 v25, 1e-05
  v_add_u32 v26, 155648, v16
  s_lshl_b32 s14, s17, 9
  s_add_u32 s14, s14, s72
  s_add_u32 s14, s14, 16384
  s_add_u32 s15, s14, 8192
  v_add_u32 v13, s27, v3
  s_barrier
.fz_kernel_c_n3:
  s_mov_b32 s13, 0xff0000
  s_cmp_eq_u32 s20, 0
  s_cbranch_scc1 .fz_kernel_c_nf
  s_cmp_eq_u32 s75, 0
  s_cselect_b32 exec_lo, 0xffff, s13
  s_mov_b32 exec_hi, 0
  s_mov_b32 s38, 0
.fz_kernel_cw67:
  s_sleep 1
  ds_read_u8 v22, v27 offset:268
  s_add_u32 s38, s38, 1
  s_waitcnt lgkmcnt(0)
  v_cmp_gt_u32 vcc, 4, v22
  s_cbranch_vccz .fz_kernel_cw67d
  s_cmp_lt_u32 s38, 8388608
  s_cbranch_scc1 .fz_kernel_cw67
.fz_kernel_cw67d:
  buffer_atomic_or v15, v14, s[4:7], s25 offen sc1
  s_mov_b64 exec, -1
.fz_kernel_c_nf:
  s_add_u32 s13, s19, s74
  s_mov_b64 exec, 1
  buffer_load_dword v11, v4, s[4:7], s13 offen offset:8 sc1
  s_mov_b64 exec, -1
  ds_write_b128 v13, v[32:35] offset:0
  ds_write_b128 v13, v[36:39] offset:1024
  ds_write_b128 v13, v[40:43] offset:2048
  ds_write_b128 v13, v[44:47] offset:3072
  ds_write_b128 v13, v[48:51] offset:4096
  ds_write_b128 v13, v[52:55] offset:5120
  ds_write_b128 v13, v[56:59] offset:6144
  ds_write_b128 v13, v[60:63] offset:7168
  ds_write_b128 v13, v[64:67] offset:8192
  ds_write_b128 v13, v[68:71] offset:9216
  ds_write_b128 v13, v[72:75] offset:10240
  ds_write_b128 v13, v[76:79] offset:11264
  ds_write_b128 v13, v[240:243] offset:12288
  ds_write_b128 v13, v[244:247] offset:13312
  ds_write_b128 v13, v[248:251] offset:14336
  ds_write_b128 v13, v[252:255] offset:15360
  v_and_b32 v14, 1, v2
  v_lshlrev_b32 v14, 10, v14
  v_lshl_add_u32 v14, v8, 14, v14
  v_add_u32 v14, s61, v14
  s_waitcnt lgkmcnt(0)
  s_cmp_lg_u32 s75, 0
  s_cbranch_scc1 .fz_kernel_c_nw
  v_mov_b32 v13, v9
  s_lshl_b32 s21, s18, 10
  s_add_u32 s21, s21, s72
  s_cmp_lg_u32 s20, 0
  s_cbranch_scc1 .fz_kernel_c_c7
  s_add_u32 s22, s19, s74
  s_add_u32 s23, s14, 16384
  s_mov_b64 exec, 1
  s_mov_b32 s38, 0
  s_branch .fz_kernel_c_c00
.fz_kernel_c_c0:
  s_sleep 6
  buffer_load_dword v11, v4, s[4:7], s22 offen offset:8 sc1
.fz_kernel_c_c00:
  s_add_u32 s38, s38, 1
  s_waitcnt vmcnt(0)
  ds_or_b32 v6, v11 offset:0x114
  v_or_b32 v11, v11, v15
  v_cmp_ne_u32 vcc, 0xffff, v11
  s_cbranch_vccz .fz_kernel_c_c1
  s_cmp_lt_u32 s38, 131072
  s_cbranch_scc1 .fz_kernel_c_c0
.fz_kernel_c_c1:
  s_mov_b32 s38, 0
.fz_kernel_cw68:
  s_sleep 1
  ds_read_u8 v22, v27 offset:268
  s_add_u32 s38, s38, 1
  s_waitcnt lgkmcnt(0)
  v_cmp_gt_u32 vcc, 4, v22
  s_cbranch_vccz .fz_kernel_cw68d
  s_cmp_lt_u32 s38, 8388608
  s_cbranch_scc1 .fz_kernel_cw68
.fz_kernel_cw68d:
  ds_or_b32 v6, v11 offset:0x114
  s_mov_b64 exec, -1
  buffer_load_dwordx2 v[240:241], v16, s[4:7], s14 offen
  buffer_load_dwordx2 v[242:243], v16, s[4:7], s15 offen
  buffer_load_dwordx2 v[244:245], v16, s[4:7], s23 offen
  s_lshl_b32 s23, s17, 6
  s_add_u32 s23, s23, s21
  s_lshl_b32 s24, s17, 7
  s_add_u32 s24, s24, 1
  s_mov_b32 s38, 0
.fz_kernel_cw69:
  s_sleep 1
  ds_read_u8 v22, v6 offset:272
  s_add_u32 s38, s38, 1
  s_waitcnt lgkmcnt(0)
  v_cmp_gt_u32 vcc, 2, v22
  s_cbranch_vccz .fz_kernel_cw69d
  s_cmp_lt_u32 s38, 8388608
  s_cbranch_scc1 .fz_kernel_cw69
.fz_kernel_cw69d:
  ds_read_b64_tr_b16 v[32:33], v7 offset:0
  ds_read_b64_tr_b16 v[34:35], v7 offset:512
  ds_read_b64_tr_b16 v[36:37], v13 offset:0
  ds_read_b64_tr_b16 v[38:39], v13 offset:512
  ds_read_b64_tr_b16 v[40:41], v7 offset:4096
  ds_read_b64_tr_b16 v[42:43], v7 offset:4608
  ds_read_b64_tr_b16 v[44:45], v13 offset:4096
  ds_read_b64_tr_b16 v[46:47], v13 offset:4608
  ds_read_b64_tr_b16 v[48:49], v7 offset:8192
  ds_read_b64_tr_b16 v[50:51], v7 offset:8704
  ds_read_b64_tr_b16 v[52:53], v13 offset:8192
  ds_read_b64_tr_b16 v[54:55], v13 offset:8704
  s_waitcnt lgkmcnt(0)
  v_xor_b32 v7, 64, v7
  v_xor_b32 v13, 64, v13
  ds_read_b64_tr_b16 v[56:57], v7 offset:1024
  ds_read_b64_tr_b16 v[58:59], v7 offset:1536
  ds_read_b64_tr_b16 v[60:61], v13 offset:1024
  ds_read_b64_tr_b16 v[62:63], v13 offset:1536
  ds_read_b64_tr_b16 v[64:65], v7 offset:5120
  ds_read_b64_tr_b16 v[66:67], v7 offset:5632
  ds_read_b64_tr_b16 v[68:69], v13 offset:5120
  ds_read_b64_tr_b16 v[70:71], v13 offset:5632
  ds_read_b64_tr_b16 v[72:73], v7 offset:9216
  ds_read_b64_tr_b16 v[74:75], v7 offset:9728
  ds_read_b64_tr_b16 v[76:77], v13 offset:9216
  ds_read_b64_tr_b16 v[78:79], v13 offset:9728
  s_waitcnt lgkmcnt(0)
  s_waitcnt vmcnt(0)
  v_fma_f32 v208, -v240, v240, v242
  v_fma_f32 v209, -v241, v241, v243
  v_rsq_f32 v208, abs(v208)
  v_rsq_f32 v209, abs(v209)
  v_mul_f32 v208, v208, v244
  v_mul_f32 v209, v209, v245
  v_and_b32 v208, -2, v208
  v_or_b32 v209, 1, v209
  v_cmp_gt_f32 vcc, v209, v208
  v_max_f32 v9, v208, v209
  s_nop 0
  v_cndmask_b32 v210, v240, v241, vcc
  v_max_f32 v7, v9, v9 row_ror:8 row_mask:0xf bank_mask:0xf
  v_cndmask_b32 v211, v242, v243, vcc
  s_nop 0
  v_max_f32 v7, v7, v7 row_ror:4 row_mask:0xf bank_mask:0xf
  s_nop 1
  v_max_f32 v7, v7, v7 row_ror:2 row_mask:0xf bank_mask:0xf
  s_nop 1
  v_max_f32 v7, v7, v7 row_ror:1 row_mask:0xf bank_mask:0xf
  s_nop 1
  v_max_f32 v7, v7, v7 row_bcast:15 row_mask:0xa bank_mask:0xf
  s_nop 1
  v_max_f32 v7, v7, v7 row_bcast:31 row_mask:0xc bank_mask:0xf
  v_and_b32 v209, 1, v9
  v_lshl_add_u32 v209, v2, 1, v209
  v_readlane_b32 s22, v7, 63
  v_add_u32 v209, s24, v209
  v_mov_b32 v208, v9
  v_cmp_eq_u32 vcc, s22, v9
  s_ff1_i32_b64 s22, vcc
  s_lshl_b64 exec, 1, s22
  buffer_store_dwordx4 v[208:211], v4, s[4:7], s23 offen sc1
  s_mov_b64 exec, -1
.fz_kernel_c_c2:
  s_cmp_lg_u32 s20, 0
  s_cbranch_scc1 .fz_kernel_c_c21
  s_call_b64 s[68:69], .fz_kernel_c_coef
  ds_write_b64 v26, v[248:249] offset:4608
  ds_write_b64 v26, v[250:251] offset:5120
  ds_write_b64 v26, v[252:253] offset:6400
  ds_write_b64 v26, v[254:255] offset:6912
.fz_kernel_c_c21:
  s_cmp_eq_u32 s3, 0
  s_cbranch_scc1 .fz_kernel_hb71
  s_barrier
  s_sub_u32 s3, s3, 1
.fz_kernel_hb71:
  s_cmp_eq_u32 s3, 0
  s_cbranch_scc1 .fz_kernel_hb72
  s_barrier
  s_sub_u32 s3, s3, 1
.fz_kernel_hb72:
  s_cmp_eq_u32 s3, 0
  s_cbranch_scc1 .fz_kernel_hb73
  s_barrier
  s_sub_u32 s3, s3, 1
.fz_kernel_hb73:
.fz_kernel_c_c3:
  v_lshlrev_b32 v22, 6, v2
  s_mov_b64 exec, 0xffff
  s_mov_b32 s38, 0
.fz_kernel_c_c4:
  buffer_load_dwordx4 v[224:227], v22, s[4:7], s21 offen sc1
  s_add_u32 s38, s38, 1
  s_mov_b32 s46, 0
  s_call_b64 s[0:1], .fz_kernel_hw
  s_waitcnt vmcnt(0)
  v_min_u32 v9, v225, v227
  v_max_f32 v7, v224, v224 row_ror:8 row_mask:0xf bank_mask:0xf
  v_cmp_eq_u32 vcc, 0, v9
  s_cbranch_vccz .fz_kernel_c_c5
  s_cmp_lt_u32 s38, 131072
  s_cbranch_scc1 .fz_kernel_c_c4
.fz_kernel_c_c5:
  s_waitcnt lgkmcnt(0)
  v_max_f32 v7, v7, v7 row_ror:4 row_mask:0xf bank_mask:0xf
  s_nop 1
  v_max_f32 v7, v7, v7 row_ror:2 row_mask:0xf bank_mask:0xf
  s_nop 1
  v_max_f32 v7, v7, v7 row_ror:1 row_mask:0xf bank_mask:0xf
  v_cmp_eq_u32 vcc, v7, v224
  s_or_b32 s22, vcc_lo, 0x8000
  s_ff1_i32_b32 s22, s22
  v_readlane_b32 s77, v225, s22
  v_readlane_b32 s27, v224, s22
  v_readlane_b32 s23, v226, s22
  v_readlane_b32 s24, v227, s22
  s_mov_b64 exec, -1
  v_mov_b32 v11, s23
  v_mov_b32 v15, s24
  s_branch .fz_kernel_c_idx
.fz_kernel_c_nw:
  s_mov_b64 exec, 0xff
  s_mov_b32 s38, 0
.fz_kernel_c_gm:
  buffer_load_dword v9, v10, s[4:7], s21 offen sc1
  s_add_u32 s38, s38, 1
  s_waitcnt vmcnt(0)
  v_cmp_ne_u32 vcc, 0xffff, v9
  s_cbranch_vccz .fz_kernel_c_gmd
  s_sleep 10
  s_cmp_lt_u32 s38, 131072
  s_cbranch_scc1 .fz_kernel_c_gm
.fz_kernel_c_gmd:
  s_mov_b64 exec, -1
  buffer_load_dwordx4 v[208:211], v3, s[4:7], s22 offen offset:0
  buffer_load_dwordx4 v[212:215], v3, s[4:7], s23 offen offset:0
  buffer_load_dwordx4 v[216:219], v3, s[4:7], s24 offen offset:0
  buffer_load_dwordx4 v[220:223], v3, s[4:7], s22 offen offset:1024
  buffer_load_dwordx4 v[224:227], v3, s[4:7], s23 offen offset:1024
  buffer_load_dwordx4 v[228:231], v3, s[4:7], s24 offen offset:1024
  buffer_load_dwordx4 v[232:235], v3, s[4:7], s22 offen offset:2048
  buffer_load_dwordx4 v[236:239], v3, s[4:7], s23 offen offset:2048
  buffer_load_dwordx4 v[240:243], v3, s[4:7], s24 offen offset:2048
  buffer_load_dwordx4 v[244:247], v3, s[4:7], s22 offen offset:3072
  buffer_load_dwordx4 v[248:251], v3, s[4:7], s23 offen offset:3072
  buffer_load_dwordx4 v[252:255], v3, s[4:7], s24 offen offset:3072
  s_lshl_b32 s21, s75, 4
  s_add_u32 s21, s21, 159968
  v_mov_b32 v10, s21
  s_lshl_b32 s22, s20, 3
  v_add_u32 v13, s22, v10
  s_waitcnt vmcnt(10)
  v_fma_f32 v212, -v208, v208, v212
  v_fma_f32 v213, -v209, v209, v213
  v_fma_f32 v214, -v210, v210, v214
  v_fma_f32 v215, -v211, v211, v215
  v_rsq_f32 v212, abs(v212)
  v_rsq_f32 v213, abs(v213)
  v_rsq_f32 v214, abs(v214)
  v_rsq_f32 v215, abs(v215)
  s_waitcnt vmcnt(9)
  v_mul_f32 v216, v216, v212
  v_mul_f32 v217, v217, v213
  v_mul_f32 v218, v218, v214
  v_mul_f32 v219, v219, v215
  v_and_or_b32 v216, v216, -16, 0
  v_and_or_b32 v217, v217, -16, 1
  v_and_or_b32 v218, v218, -16, 2
  v_and_or_b32 v219, v219, -16, 3
  v_max3_f32 v9, v216, v217, v218
  v_max_f32 v9, v9, v219
  s_waitcnt vmcnt(7)
  v_fma_f32 v224, -v220, v220, v224
  v_fma_f32 v225, -v221, v221, v225
  v_fma_f32 v226, -v222, v222, v226
  v_fma_f32 v227, -v223, v223, v227
  v_rsq_f32 v224, abs(v224)
  v_rsq_f32 v225, abs(v225)
  v_rsq_f32 v226, abs(v226)
  v_rsq_f32 v227, abs(v227)
  s_waitcnt vmcnt(6)
  v_mul_f32 v228, v228, v224
  v_mul_f32 v229, v229, v225
  v_mul_f32 v230, v230, v226
  v_mul_f32 v231, v231, v227
  v_and_or_b32 v228, v228, -16, 4
  v_and_or_b32 v229, v229, -16, 5
  v_and_or_b32 v230, v230, -16, 6
  v_and_or_b32 v231, v231, -16, 7
  v_max3_f32 v9, v9, v228, v229
  v_max3_f32 v9, v9, v230, v231
  s_waitcnt vmcnt(4)
  v_fma_f32 v236, -v232, v232, v236
  v_fma_f32 v237, -v233, v233, v237
  v_fma_f32 v238, -v234, v234, v238
  v_fma_f32 v239, -v235, v235, v239
  v_rsq_f32 v236, abs(v236)
  v_rsq_f32 v237, abs(v237)
  v_rsq_f32 v238, abs(v238)
  v_rsq_f32 v239, abs(v239)
  s_waitcnt vmcnt(3)
  v_mul_f32 v240, v240, v236
  v_mul_f32 v241, v241, v237
  v_mul_f32 v242, v242, v238
  v_mul_f32 v243, v243, v239
  v_and_or_b32 v240, v240, -16, 8
  v_and_or_b32 v241, v241, -16, 9
  v_and_or_b32 v242, v242, -16, 10
  v_and_or_b32 v243, v243, -16, 11
  v_max3_f32 v9, v9, v240, v241
  v_max3_f32 v9, v9, v242, v243
  s_waitcnt vmcnt(1)
  v_fma_f32 v248, -v244, v244, v248
  v_fma_f32 v249, -v245, v245, v249
  v_fma_f32 v250, -v246, v246, v250
  v_fma_f32 v251, -v247, v247, v251
  v_rsq_f32 v248, abs(v248)
  v_rsq_f32 v249, abs(v249)
  v_rsq_f32 v250, abs(v250)
  v_rsq_f32 v251, abs(v251)
  s_waitcnt vmcnt(0)
  v_mul_f32 v252, v252, v248
  v_mul_f32 v253, v253, v249
  v_mul_f32 v254, v254, v250
  v_mul_f32 v255, v255, v251
  v_and_or_b32 v252, v252, -16, 12
  v_and_or_b32 v253, v253, -16, 13
  v_and_or_b32 v254, v254, -16, 14
  v_and_or_b32 v255, v255, -16, 15
  v_max3_f32 v9, v9, v252, v253
  v_max3_f32 v9, v9, v254, v255
  s_nop 1
  v_max_f32 v7, v9, v9 row_ror:8 row_mask:0xf bank_mask:0xf
  s_nop 1
  v_max_f32 v7, v7, v7 row_ror:4 row_mask:0xf bank_mask:0xf
  s_nop 1
  v_max_f32 v7, v7, v7 row_ror:2 row_mask:0xf bank_mask:0xf
  s_nop 1
  v_max_f32 v7, v7, v7 row_ror:1 row_mask:0xf bank_mask:0xf
  s_nop 1
  v_max_f32 v7, v7, v7 row_bcast:15 row_mask:0xa bank_mask:0xf
  s_nop 1
  v_max_f32 v7, v7, v7 row_bcast:31 row_mask:0xc bank_mask:0xf
  s_nop 0
  v_readlane_b32 s21, v7, 63
  s_nop 1
  v_cmp_eq_u32 vcc, s21, v9
  s_ff1_i32_b64 s22, vcc
  s_lshl_b32 s22, s22, 2
  s_and_b32 s23, s21, 3
  s_add_u32 s22, s22, s23
  s_and_b32 s23, s21, 12
  s_lshl_b32 s23, s23, 6
  s_add_u32 s22, s22, s23
  s_and_b32 s22, s22, 1023
  s_lshl_b32 s23, s20, 10
  s_add_u32 s22, s22, s23
  s_add_u32 s22, s22, 1
  v_mov_b32 v224, s21
  v_mov_b32 v225, s22
  s_mov_b64 exec, 1
  ds_write_b64 v13, v[224:225]
  s_mov_b32 s38, 0
.fz_kernel_c_am:
  ds_read_b128 v[224:227], v10
  s_add_u32 s38, s38, 1
  s_waitcnt lgkmcnt(0)
  v_min_u32 v9, v225, v227
  v_cmp_eq_u32 vcc, 0, v9
  s_cbranch_vccz .fz_kernel_c_amd
  s_cmp_lt_u32 s38, 524288
  s_cbranch_scc1 .fz_kernel_c_am
.fz_kernel_c_amd:
  v_cmp_gt_f32 vcc, v226, v224
  s_nop 1
  v_cndmask_b32 v225, v225, v227, vcc
  v_cndmask_b32 v224, v224, v226, vcc
  v_readfirstlane_b32 s77, v225
  v_readfirstlane_b32 s27, v224
  s_mov_b64 exec, -1
  s_sub_u32 s21, s77, 1
  s_and_b32 s21, s21, 2047
  s_lshl_b32 s21, s21, 2
  s_add_u32 s21, s21, s72
  s_add_u32 s21, s21, 16384
  s_add_u32 s22, s21, 8192
  buffer_load_dword v11, v4, s[4:7], s21 offen
  buffer_load_dword v15, v4, s[4:7], s22 offen
.fz_kernel_c_idx:
  s_mov_b64 exec, s[34:35]
  s_sub_u32 s77, s77, 1
  s_and_b32 s77, s77, 2047
  s_lshr_b32 s78, s77, 7
  s_lshl_b32 s78, s78, 18
  s_and_b32 s21, s77, 0x70
  s_lshl_b32 s21, s21, 7
  s_add_u32 s78, s78, s21
  s_and_b32 s21, s77, 15
  s_lshl_b32 s21, s21, 4
  s_add_u32 s78, s78, s21
  s_add_u32 s78, s78, s73
  buffer_load_dwordx4 v[208:211], v14, s[4:7], s78 offen offset:0
  buffer_load_dwordx4 v[212:215], v14, s[4:7], s78 offen offset:256
  buffer_load_dwordx4 v[216:219], v14, s[4:7], s78 offen offset:512
  buffer_load_dwordx4 v[220:223], v14, s[4:7], s78 offen offset:768
  s_mov_b64 exec, -1
  s_cmp_eq_u32 s3, 0
  s_cbranch_scc1 .fz_kernel_hb74
  s_barrier
  s_sub_u32 s3, s3, 1
.fz_kernel_hb74:
  s_lshr_b32 s21, s77, 7
  s_and_b32 s79, s77, 127
  s_add_u32 s79, s79, 1
  s_cmp_eq_u32 s21, s17
  s_cselect_b32 s79, s79, 0
  v_mov_b32 v1, -1477.3197218702985
  v_mul_f32 v1, s27, v1
  v_exp_f32 v1, v1
  s_nop 0
  v_add_f32 v1, 1.0, v1
  v_rcp_f32 v1, v1
  s_lshl_b32 s23, s70, 14
  s_add_u32 s23, s23, s78
  s_mov_b32 s46, 0
  s_call_b64 s[0:1], .fz_kernel_hw
  s_waitcnt vmcnt(0)
  s_cmp_ge_u32 s17, 14
  s_cbranch_scc1 .fz_kernel_c_ng
  s_setprio 2
  v_mfma_f32_16x16x32_bf16 v[224:227], v[208:211], v[80:83], 0
  v_mfma_f32_16x16x32_bf16 v[228:231], v[208:211], v[84:87], 0
  v_mfma_f32_16x16x32_bf16 v[232:235], v[208:211], v[88:91], 0
  v_mfma_f32_16x16x32_bf16 v[236:239], v[208:211], v[92:95], 0
  v_mfma_f32_16x16x32_bf16 v[240:243], v[208:211], v[96:99], 0
  v_mfma_f32_16x16x32_bf16 v[244:247], v[208:211], v[100:103], 0
  v_mfma_f32_16x16x32_bf16 v[248:251], v[208:211], v[104:107], 0
  v_mfma_f32_16x16x32_bf16 v[252:255], v[208:211], v[108:111], 0
  v_mfma_f32_16x16x32_bf16 v[224:227], v[212:215], v[112:115], v[224:227]
  v_mfma_f32_16x16x32_bf16 v[228:231], v[212:215], v[116:119], v[228:231]
  v_mfma_f32_16x16x32_bf16 v[232:235], v[212:215], v[120:123], v[232:235]
  v_mfma_f32_16x16x32_bf16 v[236:239], v[212:215], v[124:127], v[236:239]
  v_mfma_f32_16x16x32_bf16 v[240:243], v[212:215], v[128:131], v[240:243]
  v_mfma_f32_16x16x32_bf16 v[244:247], v[212:215], v[132:135], v[244:247]
  v_mfma_f32_16x16x32_bf16 v[248:251], v[212:215], v[136:139], v[248:251]
  v_mfma_f32_16x16x32_bf16 v[252:255], v[212:215], v[140:143], v[252:255]
  v_mfma_f32_16x16x32_bf16 v[224:227], v[216:219], v[144:147], v[224:227]
  v_mfma_f32_16x16x32_bf16 v[228:231], v[216:219], v[148:151], v[228:231]
  v_mfma_f32_16x16x32_bf16 v[232:235], v[216:219], v[152:155], v[232:235]
  v_mfma_f32_16x16x32_bf16 v[236:239], v[216:219], v[156:159], v[236:239]
  v_mfma_f32_16x16x32_bf16 v[240:243], v[216:219], v[160:163], v[240:243]
  v_mfma_f32_16x16x32_bf16 v[244:247], v[216:219], v[164:167], v[244:247]
  v_mfma_f32_16x16x32_bf16 v[248:251], v[216:219], v[168:171], v[248:251]
  v_mfma_f32_16x16x32_bf16 v[252:255], v[216:219], v[172:175], v[252:255]
  v_mfma_f32_16x16x32_bf16 v[224:227], v[220:223], v[176:179], v[224:227]
  v_mfma_f32_16x16x32_bf16 v[228:231], v[220:223], v[180:183], v[228:231]
  v_mfma_f32_16x16x32_bf16 v[232:235], v[220:223], v[184:187], v[232:235]
  v_mfma_f32_16x16x32_bf16 v[236:239], v[220:223], v[188:191], v[236:239]
  v_mfma_f32_16x16x32_bf16 v[240:243], v[220:223], v[192:195], v[240:243]
  v_mfma_f32_16x16x32_bf16 v[244:247], v[220:223], v[196:199], v[244:247]
  v_mfma_f32_16x16x32_bf16 v[248:251], v[220:223], v[200:203], v[248:251]
  v_mfma_f32_16x16x32_bf16 v[252:255], v[220:223], v[204:207], v[252:255]
  s_nop 0
  v_add_f32 v208, v225, v224 row_ror:8 row_mask:0xf bank_mask:0x3
  v_add_f32 v209, v229, v228 row_ror:8 row_mask:0xf bank_mask:0x3
  v_add_f32 v210, v233, v232 row_ror:8 row_mask:0xf bank_mask:0x3
  v_add_f32 v211, v237, v236 row_ror:8 row_mask:0xf bank_mask:0x3
  v_add_f32 v208, v240, v241 row_ror:8 row_mask:0xf bank_mask:0xc
  v_add_f32 v209, v244, v245 row_ror:8 row_mask:0xf bank_mask:0xc
  v_add_f32 v210, v248, v249 row_ror:8 row_mask:0xf bank_mask:0xc
  v_add_f32 v211, v252, v253 row_ror:8 row_mask:0xf bank_mask:0xc
  v_fma_f32 v208, -v11, v28, v208
  v_fma_f32 v209, -v11, v29, v209
  v_or_b32 v208, 1, v208
  v_fma_f32 v210, -v11, v30, v210
  v_fma_f32 v211, -v11, v31, v211
  v_or_b32 v210, 1, v210
  s_mov_b64 exec, 0xffff
  buffer_store_dwordx4 v[208:211], v20, s[4:7], s32 offen offset:0 sc1
  s_mov_b64 exec, -1
  s_setprio 0
  s_cmp_eq_u32 s3, 0
  s_cbranch_scc1 .fz_kernel_hb75
  s_barrier
  s_sub_u32 s3, s3, 1
.fz_kernel_hb75:
.fz_kernel_c_ng:
  s_cmp_eq_u32 s20, 0
  s_cbranch_scc1 .fz_kernel_c_ng1
  buffer_load_ushort v184, v12, s[4:7], s23 offen
  s_branch .fz_kernel_c_ng2
.fz_kernel_c_ng1:
  s_cmp_eq_u32 s75, 0
  s_cbranch_scc1 .fz_kernel_c_ng2
  buffer_load_dwordx2 v[240:241], v16, s[4:7], s14 offen
  buffer_load_dwordx2 v[242:243], v16, s[4:7], s15 offen
.fz_kernel_c_ng2:
  s_cmp_ge_u32 s17, 14
  s_cbranch_scc1 .fz_kernel_c_g1
  ds_read_b64_tr_b16 v[80:81], v17 offset:0
  ds_read_b64_tr_b16 v[82:83], v17 offset:1024
  ds_read_b64_tr_b16 v[84:85], v17 offset:32
  ds_read_b64_tr_b16 v[86:87], v17 offset:1056
  ds_read_b64_tr_b16 v[88:89], v18 offset:0
  ds_read_b64_tr_b16 v[90:91], v18 offset:1024
  ds_read_b64_tr_b16 v[92:93], v18 offset:32
  ds_read_b64_tr_b16 v[94:95], v18 offset:1056
  ds_read_b64_tr_b16 v[96:97], v17 offset:2048
  ds_read_b64_tr_b16 v[98:99], v17 offset:3072
  ds_read_b64_tr_b16 v[100:101], v17 offset:2080
  ds_read_b64_tr_b16 v[102:103], v17 offset:3104
  ds_read_b64_tr_b16 v[104:105], v18 offset:2048
  s_cmp_eq_u32 s3, 0
  s_cbranch_scc1 .fz_kernel_hb85
  s_barrier
  s_sub_u32 s3, s3, 1
.fz_kernel_hb85:
  ds_read_b64_tr_b16 v[106:107], v18 offset:3072
  ds_read_b64_tr_b16 v[108:109], v18 offset:2080
  ds_read_b64_tr_b16 v[110:111], v18 offset:3104
  s_waitcnt lgkmcnt(4)
  ds_read_b64_tr_b16 v[112:113], v17 offset:4096
  ds_read_b64_tr_b16 v[114:115], v17 offset:5120
  ds_read_b64_tr_b16 v[116:117], v17 offset:4128
  ds_read_b64_tr_b16 v[118:119], v17 offset:5152
  ds_read_b64_tr_b16 v[120:121], v18 offset:4096
  ds_read_b64_tr_b16 v[122:123], v18 offset:5120
  ds_read_b64_tr_b16 v[124:125], v18 offset:4128
  ds_read_b64_tr_b16 v[126:127], v18 offset:5152
  ds_read_b64_tr_b16 v[128:129], v17 offset:6144
  ds_read_b64_tr_b16 v[130:131], v17 offset:7168
  ds_read_b64_tr_b16 v[132:133], v17 offset:6176
  ds_read_b64_tr_b16 v[134:135], v17 offset:7200
  ds_read_b64_tr_b16 v[136:137], v18 offset:6144
  ds_read_b64_tr_b16 v[138:139], v18 offset:7168
  s_cmp_eq_u32 s3, 0
  s_cbranch_scc1 .fz_kernel_hb86
  s_barrier
  s_sub_u32 s3, s3, 1
.fz_kernel_hb86:
  ds_read_b64_tr_b16 v[140:141], v18 offset:6176
  ds_read_b64_tr_b16 v[142:143], v18 offset:7200
.fz_kernel_c_g1:
  v_fma_f32 v15, -v11, v11, v15
  v_rsq_f32 v15, abs(v15)
  s_nop 0
  v_mul_f32 v179, v11, v15
  v_mul_f32 v15, 0x44800000, v15
  v_sub_f32 v179, 0, v179
  v_add_f32 v178, 1.0, v15
  v_mul_f32 v177, -1.4426950408889634, v15
  v_mul_f32 v15, v15, v15
  v_mul_f32 v1, v1, v15
  s_cmp_eq_u32 s75, 0
  s_cbranch_scc1 .fz_kernel_c_d0
  s_cmp_lg_u32 s20, 0
  s_cbranch_scc1 .fz_kernel_c_t2
  s_waitcnt vmcnt(0)
  s_call_b64 s[68:69], .fz_kernel_c_coef
  v_mov_b32 v9, 159952
  v_mov_b32 v7, s79
  ds_write_b64 v26, v[252:253] offset:6400
  ds_write_b64 v26, v[254:255] offset:6912
  ds_write_b32 v9, v7
  s_waitcnt lgkmcnt(0)
.fz_kernel_c_t2:
  s_barrier
.fz_kernel_c_d0:
  s_cmp_ge_u32 s17, 14
  s_cbranch_scc1 .fz_kernel_c_nd
  s_cmp_eq_u32 s3, 0
  s_cbranch_scc1 .fz_kernel_hb77
  s_barrier
  s_sub_u32 s3, s3, 1
.fz_kernel_hb77:
  buffer_load_dwordx4 v[144:147], v21, s[4:7], s33 offen offset:0 sc1
  buffer_load_dwordx4 v[148:151], v21, s[4:7], s33 offen offset:512 sc1
  buffer_load_dwordx4 v[152:155], v21, s[4:7], s33 offen offset:1024 sc1
  buffer_load_dwordx4 v[156:159], v21, s[4:7], s33 offen offset:1536 sc1
  s_mov_b32 s38, 0
.fz_kernel_c_gu:
  s_mov_b32 s46, 0
  s_call_b64 s[0:1], .fz_kernel_hw
  s_waitcnt vmcnt(0)
  v_min3_u32 v9, v144, v146, v148
  v_min3_u32 v9, v9, v150, v152
  v_min3_u32 v9, v9, v154, v156
  v_min_u32 v9, v9, v158
  v_cmp_eq_u32 vcc, 0, v9
  v_add_f32 v160, v144, v148
  v_add_f32 v161, v145, v149
  v_add_f32 v162, v146, v150
  v_add_f32 v163, v147, v151
  s_cbranch_vccnz .fz_kernel_c_gur
.fz_kernel_c_gud:
  v_add_f32 v152, v152, v156
  v_add_f32 v153, v153, v157
  v_add_f32 v154, v154, v158
  v_add_f32 v155, v155, v159
  v_add_f32 v144, v152, v160
  v_add_f32 v145, v153, v161
  v_add_f32 v146, v154, v162
  v_add_f32 v147, v155, v163
  s_nop 0
  v_permlane32_swap_b32 v144, v146
  v_permlane32_swap_b32 v145, v147
  v_mul_f32 v148, v144, v177
  v_mul_f32 v149, v145, v177
  v_exp_f32 v148, v148
  s_cmp_eq_u32 s3, 0
  s_cbranch_scc1 .fz_kernel_hb87
  s_barrier
  s_sub_u32 s3, s3, 1
.fz_kernel_hb87:
  v_exp_f32 v149, v149
  v_mul_f32 v144, v144, v146
  v_add_f32 v148, 1.0, v148
  v_add_f32 v149, 1.0, v149
  v_rcp_f32 v148, v148
  v_rcp_f32 v149, v149
  v_mul_f32 v145, v145, v147
  v_mul_f32 v144, v144, v148
  v_mul_f32 v145, v145, v149
  v_cvt_pk_bf16_f32 v144, v144, v145
  s_waitcnt lgkmcnt(0)
  s_setprio 2
  v_mov_b32 v160, v144 row_newbcast:0 row_mask:0xf bank_mask:0xf
  v_mov_b32 v161, v144 row_newbcast:1 row_mask:0xf bank_mask:0xf
  v_mov_b32 v162, v144 row_newbcast:2 row_mask:0xf bank_mask:0xf
  v_mov_b32 v163, v144 row_newbcast:3 row_mask:0xf bank_mask:0xf
  v_mov_b32 v164, v144 row_newbcast:4 row_mask:0xf bank_mask:0xf
  v_mov_b32 v165, v144 row_newbcast:5 row_mask:0xf bank_mask:0xf
  v_mov_b32 v166, v144 row_newbcast:6 row_mask:0xf bank_mask:0xf
  v_mov_b32 v167, v144 row_newbcast:7 row_mask:0xf bank_mask:0xf
  v_mfma_f32_16x16x32_bf16 v[208:211], v[160:163], v[80:83], 0
  v_mfma_f32_16x16x32_bf16 v[212:215], v[160:163], v[84:87], 0
  v_mfma_f32_16x16x32_bf16 v[216:219], v[160:163], v[88:91], 0
  v_mfma_f32_16x16x32_bf16 v[220:223], v[160:163], v[92:95], 0
  v_mov_b32 v168, v144 row_newbcast:8 row_mask:0xf bank_mask:0xf
  v_mov_b32 v169, v144 row_newbcast:9 row_mask:0xf bank_mask:0xf
  v_mov_b32 v170, v144 row_newbcast:10 row_mask:0xf bank_mask:0xf
  v_mov_b32 v171, v144 row_newbcast:11 row_mask:0xf bank_mask:0xf
  v_mfma_f32_16x16x32_bf16 v[208:211], v[164:167], v[96:99], v[208:211]
  v_mfma_f32_16x16x32_bf16 v[212:215], v[164:167], v[100:103], v[212:215]
  v_mfma_f32_16x16x32_bf16 v[216:219], v[164:167], v[104:107], v[216:219]
  v_mfma_f32_16x16x32_bf16 v[220:223], v[164:167], v[108:111], v[220:223]
  v_mov_b32 v172, v144 row_newbcast:12 row_mask:0xf bank_mask:0xf
  v_mov_b32 v173, v144 row_newbcast:13 row_mask:0xf bank_mask:0xf
  v_mov_b32 v174, v144 row_newbcast:14 row_mask:0xf bank_mask:0xf
  v_mov_b32 v175, v144 row_newbcast:15 row_mask:0xf bank_mask:0xf
  v_mfma_f32_16x16x32_bf16 v[208:211], v[168:171], v[112:115], v[208:211]
  v_mfma_f32_16x16x32_bf16 v[212:215], v[168:171], v[116:119], v[212:215]
  v_mfma_f32_16x16x32_bf16 v[216:219], v[168:171], v[120:123], v[216:219]
  v_mfma_f32_16x16x32_bf16 v[220:223], v[168:171], v[124:127], v[220:223]
  v_mfma_f32_16x16x32_bf16 v[208:211], v[172:175], v[128:131], v[208:211]
  v_mfma_f32_16x16x32_bf16 v[212:215], v[172:175], v[132:135], v[212:215]
  v_mfma_f32_16x16x32_bf16 v[216:219], v[172:175], v[136:139], v[216:219]
  v_mfma_f32_16x16x32_bf16 v[220:223], v[172:175], v[140:143], v[220:223]
  s_nop 4
  v_or_b32 v208, 1, v208
  v_mov_b32 v209, v212
  v_or_b32 v210, 1, v216
  v_mov_b32 v211, v220
  s_mov_b64 exec, 0xffff
  buffer_store_dwordx4 v[208:211], v3, s[4:7], s39 offen offset:0 sc1
  s_mov_b64 exec, -1
  s_setprio 0
.fz_kernel_c_nd:
  s_cmp_eq_u32 s75, 0
  s_cbranch_scc1 .fz_kernel_c_m0
  s_lshl_b32 s21, s17, 1
  s_add_u32 s21, s21, s20
  s_cmp_lg_u32 s21, 31
  s_cbranch_scc1 .fz_kernel_fin
  s_branch .fz_kernel_c_pp
.fz_kernel_c_m0:
  s_cmp_eq_u32 s79, 0
  s_cselect_b32 s21, 2, 0
  s_add_u32 s3, s3, s21
.fz_kernel_c_pp:
  s_mul_i32 s21, s70, 7168
  s_add_u32 s21, s21, s72
  s_add_u32 s21, s21, 155648
  s_add_u32 s22, s21, 4096
  s_cmp_eq_u32 s3, 0
  s_cbranch_scc1 .fz_kernel_hb78
  s_barrier
  s_sub_u32 s3, s3, 1
.fz_kernel_hb78:
  s_cmp_eq_u32 s3, 0
  s_cbranch_scc1 .fz_kernel_hb79
  s_barrier
  s_sub_u32 s3, s3, 1
.fz_kernel_hb79:
  s_cmp_eq_u32 s3, 0
  s_cbranch_scc1 .fz_kernel_hb80
  s_barrier
  s_sub_u32 s3, s3, 1
.fz_kernel_hb80:
  buffer_load_dwordx4 v[144:147], v3, s[4:7], s21 offen offset:0 sc1
  buffer_load_dwordx4 v[148:151], v3, s[4:7], s21 offen offset:1024 sc1
  buffer_load_dwordx4 v[152:155], v3, s[4:7], s21 offen offset:2048 sc1
  buffer_load_dwordx4 v[156:159], v3, s[4:7], s21 offen offset:3072 sc1
  buffer_load_dwordx4 v[160:163], v3, s[4:7], s22 offen offset:0 sc1
  buffer_load_dwordx4 v[164:167], v3, s[4:7], s22 offen offset:1024 sc1
  buffer_load_dwordx4 v[168:171], v3, s[4:7], s22 offen offset:2048 sc1
  s_mov_b32 s38, 0
.fz_kernel_c_pu:
  s_mov_b32 s46, 0
  s_call_b64 s[0:1], .fz_kernel_hw
  s_waitcnt vmcnt(0)
  v_min3_u32 v9, v144, v146, v148
  v_min3_u32 v9, v9, v150, v152
  v_min3_u32 v9, v9, v154, v156
  v_min3_u32 v9, v9, v158, v160
  v_min3_u32 v9, v9, v162, v164
  v_min3_u32 v9, v9, v166, v168
  v_min_u32 v9, v9, v170
  v_cmp_eq_u32 vcc, 0, v9
  v_add_f32 v236, v144, v148
  v_add_f32 v237, v145, v149
  v_add_f32 v238, v146, v150
  v_add_f32 v239, v147, v151
  s_cbranch_vccnz .fz_kernel_c_pur
.fz_kernel_c_pud:
  v_add_f32 v152, v152, v156
  v_add_f32 v153, v153, v157
  v_add_f32 v154, v154, v158
  v_add_f32 v155, v155, v159
  v_add_f32 v160, v160, v164
  v_add_f32 v161, v161, v165
  v_add_f32 v162, v162, v166
  s_cmp_eq_u32 s3, 0
  s_cbranch_scc1 .fz_kernel_hb88
  s_barrier
  s_sub_u32 s3, s3, 1
.fz_kernel_hb88:
  v_add_f32 v163, v163, v167
  v_add_f32 v236, v236, v168
  v_add_f32 v237, v237, v169
  v_add_f32 v238, v238, v170
  v_add_f32 v239, v239, v171
  v_add_f32 v152, v152, v160
  v_add_f32 v153, v153, v161
  v_add_f32 v154, v154, v162
  v_add_f32 v155, v155, v163
  v_add_f32 v144, v236, v152
  v_add_f32 v146, v238, v154
  v_add_f32 v145, v237, v153
  v_add_f32 v147, v239, v155
  v_permlane32_swap_b32 v144, v146
  s_nop 0
  v_permlane32_swap_b32 v145, v147
  v_add_f32 v144, v144, v146
  v_add_f32 v145, v145, v147
  v_lshlrev_b32 v184, 16, v184
  s_nop 0
  v_permlane16_swap_b32 v144, v145
  v_add_f32 v144, v144, v145
  v_mul_f32 v144, v144, v1
  v_fma_f32 v184, v184, v178, v179
  s_nop 0
  v_mov_b32 v145, v144 quad_perm:[1,0,3,2] row_mask:0xf bank_mask:0xf
  v_cvt_pk_bf16_f32 v144, v144, v145
  s_or_b32 s21, s75, s71
  s_cbranch_scc1 .fz_kernel_c_w7
  s_mul_i32 s21, s20, 384
  s_add_u32 s21, s21, s60
  v_mov_b32 v180, v144 row_newbcast:0 row_mask:0xf bank_mask:0xf
  v_mov_b32 v181, v144 row_newbcast:2 row_mask:0xf bank_mask:0xf
  v_mov_b32 v182, v144 row_newbcast:4 row_mask:0xf bank_mask:0xf
  v_mov_b32 v183, v144 row_newbcast:6 row_mask:0xf bank_mask:0xf
  s_cmp_eq_u32 s3, 0
  s_cbranch_scc1 .fz_kernel_hb82
  s_barrier
  s_sub_u32 s3, s3, 1
.fz_kernel_hb82:
  s_setprio 2
  v_mfma_f32_16x16x32_bf16 v[208:211], v[180:183], v[32:35], 0
  v_mov_b32 v232, v144 row_newbcast:8 row_mask:0xf bank_mask:0xf
  v_mfma_f32_16x16x32_bf16 v[212:215], v[180:183], v[36:39], 0
  v_mov_b32 v233, v144 row_newbcast:10 row_mask:0xf bank_mask:0xf
  v_mfma_f32_16x16x32_bf16 v[216:219], v[180:183], v[40:43], 0
  v_mov_b32 v234, v144 row_newbcast:12 row_mask:0xf bank_mask:0xf
  v_mfma_f32_16x16x32_bf16 v[220:223], v[180:183], v[44:47], 0
  v_mov_b32 v235, v144 row_newbcast:14 row_mask:0xf bank_mask:0xf
  v_mfma_f32_16x16x32_bf16 v[224:227], v[180:183], v[48:51], 0
  v_mfma_f32_16x16x32_bf16 v[228:231], v[180:183], v[52:55], 0
  v_mfma_f32_16x16x32_bf16 v[208:211], v[232:235], v[56:59], v[208:211]
  v_mfma_f32_16x16x32_bf16 v[212:215], v[232:235], v[60:63], v[212:215]
  v_mfma_f32_16x16x32_bf16 v[216:219], v[232:235], v[64:67], v[216:219]
  v_mfma_f32_16x16x32_bf16 v[220:223], v[232:235], v[68:71], v[220:223]
  v_mfma_f32_16x16x32_bf16 v[224:227], v[232:235], v[72:75], v[224:227]
  v_mfma_f32_16x16x32_bf16 v[228:231], v[232:235], v[76:79], v[228:231]
  s_nop 2
  v_or_b32 v208, 1, v208
  v_mov_b32 v209, v212
  v_or_b32 v210, 1, v216
  v_mov_b32 v211, v220
  s_mov_b64 exec, 0xffff
  buffer_store_dwordx4 v[208:211], v3, s[4:7], s21 offen offset:0 sc1
  v_or_b32 v224, 1, v224
  v_mov_b32 v225, v228
  buffer_store_dwordx2 v[224:225], v16, s[4:7], s21 offen offset:256 sc1
  s_mov_b64 exec, -1
  s_setprio 0
  s_cmp_lg_u32 s20, 0
  s_cbranch_scc1 .fz_kernel_c_w7
  s_cmp_eq_u32 s79, 0
  s_cbranch_scc1 .fz_kernel_c_no2
  v_add_u32 v13, 155648, v3
  s_lshl_b32 s21, s18, 14
  s_add_u32 s21, s21, 0x1c84000
  s_add_u32 s22, s21, 4096
  s_add_u32 s23, s21, 8192
  s_add_u32 s24, s21, 12288
  v_rcp_f32 v144, v178
  v_lshlrev_b32 v146, 1, v2
  v_sub_u32 v146, s79, v146
  v_cmp_eq_u32 s[28:29], 1, v146
  v_cmp_eq_u32 s[30:31], 2, v146
  s_nop 0
  v_cndmask_b32 v148, 0, v144, s[28:29]
  v_cndmask_b32 v149, 0, v144, s[30:31]
  v_mov_b32 v9, 159952
  v_mov_b32 v7, s79
  ds_write_b32 v9, v7
  ds_write_b64 v26, v[148:149] offset:512
  s_lshl_b32 s25, s79, 2
  s_add_u32 s25, s25, 155644
  s_cmp_eq_u32 s3, 0
  s_cbranch_scc1 .fz_kernel_hb89
  s_barrier
  s_sub_u32 s3, s3, 1
.fz_kernel_hb89:
  v_mov_b32 v7, s25
  v_mov_b32 v152, 0
  v_mov_b32 v153, 0
  v_mov_b32 v154, 0
  v_mov_b32 v155, 0
  s_bfm_b64 exec, 49, 0
  s_mov_b32 s38, 0
  s_mov_b32 s25, 15
  s_cmp_eq_u32 s3, 0
  s_cbranch_scc1 .fz_kernel_hb83
  s_barrier
  s_sub_u32 s3, s3, 1
.fz_kernel_hb83:
  s_cmp_eq_u32 s3, 0
  s_cbranch_scc1 .fz_kernel_hb84
  s_barrier
  s_sub_u32 s3, s3, 1
.fz_kernel_hb84:
  s_setprio 2
.fz_kernel_c_pd:
  s_bitcmp1_b32 s25, 0
  s_cbranch_scc0 .fz_kernel_c_pl0
  buffer_load_dwordx4 v[80:83], v3, s[4:7], s21 offen offset:0 sc1
  buffer_load_dwordx4 v[84:87], v3, s[4:7], s21 offen offset:1024 sc1
  buffer_load_dwordx4 v[88:91], v3, s[4:7], s21 offen offset:2048 sc1
  buffer_load_dwordx4 v[92:95], v3, s[4:7], s21 offen offset:3072 sc1
.fz_kernel_c_pl0:
  s_bitcmp1_b32 s25, 1
  s_cbranch_scc0 .fz_kernel_c_pl1
  buffer_load_dwordx4 v[96:99], v3, s[4:7], s22 offen offset:0 sc1
  buffer_load_dwordx4 v[100:103], v3, s[4:7], s22 offen offset:1024 sc1
  buffer_load_dwordx4 v[104:107], v3, s[4:7], s22 offen offset:2048 sc1
  buffer_load_dwordx4 v[108:111], v3, s[4:7], s22 offen offset:3072 sc1
.fz_kernel_c_pl1:
  s_bitcmp1_b32 s25, 2
  s_cbranch_scc0 .fz_kernel_c_pl2
  buffer_load_dwordx4 v[112:115], v3, s[4:7], s23 offen offset:0 sc1
  buffer_load_dwordx4 v[116:119], v3, s[4:7], s23 offen offset:1024 sc1
  buffer_load_dwordx4 v[120:123], v3, s[4:7], s23 offen offset:2048 sc1
  buffer_load_dwordx4 v[124:127], v3, s[4:7], s23 offen offset:3072 sc1
.fz_kernel_c_pl2:
  s_bitcmp1_b32 s25, 3
  s_cbranch_scc0 .fz_kernel_c_pl3
  buffer_load_dwordx4 v[128:131], v3, s[4:7], s24 offen offset:0 sc1
  buffer_load_dwordx4 v[132:135], v3, s[4:7], s24 offen offset:1024 sc1
  buffer_load_dwordx4 v[136:139], v3, s[4:7], s24 offen offset:2048 sc1
  buffer_load_dwordx4 v[140:143], v3, s[4:7], s24 offen offset:3072 sc1
.fz_kernel_c_pl3:
  s_add_u32 s38, s38, 1
  s_mov_b32 s46, 0
  s_call_b64 s[0:1], .fz_kernel_hw
  s_waitcnt vmcnt(0)
  s_bitcmp1_b32 s25, 0
  s_cbranch_scc0 .fz_kernel_c_pa0
  v_min3_u32 v9, v80, v82, v84
  v_min3_u32 v9, v9, v86, v88
  v_min3_u32 v9, v9, v90, v92
  v_min_u32 v9, v9, v94
  v_cmp_eq_u32 vcc, 0, v9
  v_add_f32 v80, v80, v84
  v_add_f32 v81, v81, v85
  v_add_f32 v82, v82, v86
  v_add_f32 v83, v83, v87
  s_cbranch_vccnz .fz_kernel_c_pa0
  v_add_f32 v88, v88, v92
  v_add_f32 v89, v89, v93
  v_add_f32 v90, v90, v94
  v_add_f32 v91, v91, v95
  v_add_f32 v152, v152, v80
  v_add_f32 v153, v153, v81
  v_add_f32 v154, v154, v82
  v_add_f32 v155, v155, v83
  v_add_f32 v152, v152, v88
  v_add_f32 v153, v153, v89
  v_add_f32 v154, v154, v90
  v_add_f32 v155, v155, v91
  s_bitset0_b32 s25, 0
.fz_kernel_c_pa0:
  s_bitcmp1_b32 s25, 1
  s_cbranch_scc0 .fz_kernel_c_pa1
  v_min3_u32 v9, v96, v98, v100
  v_min3_u32 v9, v9, v102, v104
  v_min3_u32 v9, v9, v106, v108
  v_min_u32 v9, v9, v110
  v_cmp_eq_u32 vcc, 0, v9
  v_add_f32 v96, v96, v100
  v_add_f32 v97, v97, v101
  v_add_f32 v98, v98, v102
  v_add_f32 v99, v99, v103
  s_cbranch_vccnz .fz_kernel_c_pa1
  v_add_f32 v104, v104, v108
  v_add_f32 v105, v105, v109
  v_add_f32 v106, v106, v110
  v_add_f32 v107, v107, v111
  v_add_f32 v152, v152, v96
  v_add_f32 v153, v153, v97
  v_add_f32 v154, v154, v98
  v_add_f32 v155, v155, v99
  v_add_f32 v152, v152, v104
  v_add_f32 v153, v153, v105
  v_add_f32 v154, v154, v106
  v_add_f32 v155, v155, v107
  s_bitset0_b32 s25, 1
.fz_kernel_c_pa1:
  s_bitcmp1_b32 s25, 2
  s_cbranch_scc0 .fz_kernel_c_pa2
  v_min3_u32 v9, v112, v114, v116
  v_min3_u32 v9, v9, v118, v120
  v_min3_u32 v9, v9, v122, v124
  v_min_u32 v9, v9, v126
  v_cmp_eq_u32 vcc, 0, v9
  v_add_f32 v112, v112, v116
  v_add_f32 v113, v113, v117
  v_add_f32 v114, v114, v118
  v_add_f32 v115, v115, v119
  s_cbranch_vccnz .fz_kernel_c_pa2
  v_add_f32 v120, v120, v124
  v_add_f32 v121, v121, v125
  v_add_f32 v122, v122, v126
  v_add_f32 v123, v123, v127
  v_add_f32 v152, v152, v112
  v_add_f32 v153, v153, v113
  v_add_f32 v154, v154, v114
  v_add_f32 v155, v155, v115
  v_add_f32 v152, v152, v120
  v_add_f32 v153, v153, v121
  v_add_f32 v154, v154, v122
  v_add_f32 v155, v155, v123
  s_bitset0_b32 s25, 2
.fz_kernel_c_pa2:
  s_bitcmp1_b32 s25, 3
  s_cbranch_scc0 .fz_kernel_c_pa3
  v_min3_u32 v9, v128, v130, v132
  v_min3_u32 v9, v9, v134, v136
  v_min3_u32 v9, v9, v138, v140
  v_min_u32 v9, v9, v142
  v_cmp_eq_u32 vcc, 0, v9
  v_add_f32 v128, v128, v132
  v_add_f32 v129, v129, v133
  v_add_f32 v130, v130, v134
  v_add_f32 v131, v131, v135
  s_cbranch_vccnz .fz_kernel_c_pa3
  v_add_f32 v136, v136, v140
  v_add_f32 v137, v137, v141
  v_add_f32 v138, v138, v142
  v_add_f32 v139, v139, v143
  v_add_f32 v152, v152, v128
  v_add_f32 v153, v153, v129
  v_add_f32 v154, v154, v130
  v_add_f32 v155, v155, v131
  v_add_f32 v152, v152, v136
  v_add_f32 v153, v153, v137
  v_add_f32 v154, v154, v138
  v_add_f32 v155, v155, v139
  s_bitset0_b32 s25, 3
.fz_kernel_c_pa3:
  s_cmp_eq_u32 s25, 0
  s_cbranch_scc1 .fz_kernel_c_pdd
  s_cmp_lt_u32 s38, 131072
  s_cbranch_scc1 .fz_kernel_c_pd
.fz_kernel_c_pdd:
  s_mov_b32 exec_hi, 0xffff
  ds_write_b128 v13, v[152:155] offset:1536
  s_mov_b64 exec, -1
  v_readlane_b32 s21, v152, 48
  v_readlane_b32 s22, v154, 48
  s_nop 0
  v_mul_f32 v144, s21, v23
  v_fma_f32 v145, s22, v23, v25
  v_fma_f32 v145, -v144, v144, v145
  v_rsq_f32 v145, abs(v145)
  v_sub_f32 v144, v179, v144
  v_mul_f32 v146, v145, v178
  v_mul_f32 v147, v145, v144
  ds_write_b32 v7, v146 offset:4608
  ds_write_b32 v7, v147 offset:5120
  s_waitcnt lgkmcnt(0)
  s_add_u32 s3, s3, 2
  s_setprio 0
.fz_kernel_c_no2:
  s_branch .fz_kernel_q_he
.fz_kernel_c_w7:
  s_setprio 2
  v_lshlrev_b32 v144, 16, v144
  s_cmp_lg_u32 s71, 0
  s_cbranch_scc1 .fz_kernel_c_eu
  v_add_f32 v184, v184, v144
  s_cmp_lg_u32 s75, 0
  s_cbranch_scc1 .fz_kernel_c_t3
  v_mul_f32 v146, v184, v184
  v_lshrrev_b32 v9, 5, v2
  v_lshlrev_b32 v9, 3, v9
  v_permlane32_swap_b32 v184, v146
  v_add_f32 v184, v184, v146
  s_nop 1
  v_add_f32 v184, v184, v184 row_ror:8 row_mask:0xf bank_mask:0xf
  s_nop 1
  v_add_f32 v184, v184, v184 row_ror:4 row_mask:0xf bank_mask:0xf
  s_nop 1
  v_add_f32 v184, v184, v184 row_ror:2 row_mask:0xf bank_mask:0xf
  s_nop 1
  v_add_f32 v184, v184, v184 row_ror:1 row_mask:0xf bank_mask:0xf
  s_nop 1
  v_add_f32 v184, v184, v184 row_bcast:15 row_mask:0xa bank_mask:0xf
  v_or_b32 v184, 1, v184
  s_mov_b32 exec_lo, 0x10000
  s_mov_b32 exec_hi, 0x10000
  buffer_store_dword v184, v9, s[4:7], s60 offen offset:768 sc1
  s_mov_b64 exec, -1
  s_setprio 0
  s_cmp_eq_u32 s79, 0
  s_cbranch_scc1 .fz_kernel_q_he
  s_add_u32 s3, s3, 2
  s_mov_b32 s71, 1
  s_mov_b32 s70, s18
  s_branch .fz_kernel_c_pp
.fz_kernel_c_eu:
  s_cmp_eq_u32 s3, 0
  s_cbranch_scc1 .fz_kernel_hb90
  s_barrier
  s_sub_u32 s3, s3, 1
.fz_kernel_hb90:
  v_lshlrev_b32 v9, 2, v2
  v_add_u32 v9, 155648, v9
  ds_write_b32 v9, v144 offset:7424
  s_waitcnt lgkmcnt(0)
  s_branch .fz_kernel_q_he
.fz_kernel_c_t3:
  s_mov_b32 s28, s56
  s_mov_b32 s29, s57
  s_mov_b32 s30, 0x400000
  s_mov_b32 s31, 0x00020000
  v_cvt_pk_bf16_f32 v144, v184, v184
  v_lshlrev_b32 v9, 1, v2
  s_lshl_b32 s21, s77, 11
  s_lshl_b32 s22, s18, 7
  s_add_u32 s21, s21, s22
  buffer_store_short v144, v9, s[28:31], s21 offen
.fz_kernel_fin:
.fz_kernel_end:
  s_endpgm
.fz_kernel_pick:
  s_mov_b32 s33, 1
  s_cmp_eq_u32 s34, 0xffff
  s_cselect_b32 s35, 0x40000000, s35
  s_cbranch_scc1 .fz_kernel_pick_ret
  s_mov_b32 s38, 0
.fz_kernel_pick_l:
  ds_read_b32 v7, v6
  s_add_u32 s38, s38, 1
  s_waitcnt lgkmcnt(0)
  v_readfirstlane_b32 s36, v7
  s_andn2_b32 s33, s36, s34
  s_cbranch_scc1 .fz_kernel_pick_ret
  s_cmp_lt_u32 s38, 1048576
  s_cbranch_scc1 .fz_kernel_pick_l
  s_mov_b32 s36, 0xffff
  s_andn2_b32 s33, s36, s34
.fz_kernel_pick_ret:
  s_nop 4
  s_setpc_b64 s[68:69]
.fz_kernel_hw:
  s_mov_b32 s47, 0
.fz_kernel_hwl:
  s_getreg_b32 s100, hwreg(HW_REG_IB_STS)
  s_bfe_u32 s101, s100, 0x20016
  s_and_b32 s100, s100, 15
  s_lshl4_add_u32 s100, s101, s100
  s_cmp_le_u32 s100, s46
  s_cbranch_scc1 .fz_kernel_hwr
  s_sub_u32 s47, s47, 1
  s_cbranch_scc0 .fz_kernel_hwl
  s_cmp_eq_u32 s3, 0
  s_cbranch_scc1 .fz_kernel_hwr
  s_cmp_eq_u32 s3, 32
  s_cbranch_scc1 .fz_kernel_hwp
.fz_kernel_hwb:
  s_barrier
  s_sub_u32 s3, s3, 1
  s_mov_b32 s47, 2
  s_branch .fz_kernel_hwl
.fz_kernel_hwr:
  s_setpc_b64 s[0:1]
  .fz_kernel_hwp:
  ds_read_b32 v27, v6 offset:0x110
  s_mov_b32 s47, 0
  s_waitcnt lgkmcnt(0)
  v_readfirstlane_b32 s100, v27
  s_cmp_ge_u32 s100, 0x200
  s_cbranch_scc1 .fz_kernel_hwb
  s_branch .fz_kernel_hwl
.fz_kernel_q_cons2:
  s_setprio 0
  s_lshr_b32 s26, s16, 1
  s_lshl_b32 s28, s26, 13
  v_add_u32 v8, s28, v3
  v_add_u32 v9, 1024, v8
  v_mov_b32 v232, v20
  v_mov_b32 v233, v21
  v_mov_b32 v234, v22
  v_mov_b32 v235, v23
  v_mov_b32 v236, v24
  v_mov_b32 v237, v25
  v_mov_b32 v238, v26
  v_mov_b32 v239, v27
  v_mov_b32 v240, v28
  v_mov_b32 v241, v29
  v_mov_b32 v242, v30
  v_mov_b32 v243, v31
  v_mov_b32 v244, v32
  v_mov_b32 v245, v33
  v_mov_b32 v246, v34
  v_mov_b32 v247, v35
  s_branch .fz_kernel_q_cs
.fz_kernel_q_patch:
  s_mul_i32 s31, s27, 384
  s_add_u32 s31, s31, 155648
  v_and_b32 v73, 48, v2
  v_lshlrev_b32 v73, 2, v73
  v_add_u32 v73, s31, v73
  v_and_b32 v75, 15, v2
  v_lshlrev_b32 v75, 3, v75
  v_add_u32 v75, s31, v75
  ds_read_b32 v72, v14 offset:512
  ds_read_b32 v74, v14 offset:576
  ds_read_b32 v76, v14 offset:640
  ds_read_b32 v78, v14 offset:704
  ds_read_b128 v[80:83], v73 offset:1536
  ds_read_b128 v[84:87], v73 offset:1552
  ds_read_b128 v[88:91], v73 offset:1568
  ds_read_b128 v[92:95], v73 offset:1584
  s_waitcnt lgkmcnt(0)
  v_fmac_f32 v160, v82, v72
  v_fmac_f32 v161, v86, v72
  v_fmac_f32 v162, v90, v72
  v_fmac_f32 v163, v94, v72
  v_fmac_f32 v164, v82, v74
  v_fmac_f32 v165, v86, v74
  v_fmac_f32 v166, v90, v74
  v_fmac_f32 v167, v94, v74
  v_fmac_f32 v168, v82, v76
  v_fmac_f32 v169, v86, v76
  v_fmac_f32 v170, v90, v76
  v_fmac_f32 v171, v94, v76
  v_fmac_f32 v172, v82, v78
  v_fmac_f32 v173, v86, v78
  v_fmac_f32 v174, v90, v78
  v_fmac_f32 v175, v94, v78
  v_fmac_f32 v176, v83, v72
  v_fmac_f32 v177, v87, v72
  v_fmac_f32 v178, v91, v72
  v_fmac_f32 v179, v95, v72
  v_fmac_f32 v180, v83, v74
  v_fmac_f32 v181, v87, v74
  v_fmac_f32 v182, v91, v74
  v_fmac_f32 v183, v95, v74
  v_fmac_f32 v184, v83, v76
  v_fmac_f32 v185, v87, v76
  v_fmac_f32 v186, v91, v76
  v_fmac_f32 v187, v95, v76
  v_fmac_f32 v188, v83, v78
  v_fmac_f32 v189, v87, v78
  v_fmac_f32 v190, v91, v78
  v_fmac_f32 v191, v95, v78
  v_fmac_f32 v128, v80, v72
  v_fmac_f32 v129, v84, v72
  v_fmac_f32 v130, v88, v72
  v_fmac_f32 v131, v92, v72
  v_fmac_f32 v132, v80, v74
  v_fmac_f32 v133, v84, v74
  v_fmac_f32 v134, v88, v74
  v_fmac_f32 v135, v92, v74
  v_fmac_f32 v136, v80, v76
  v_fmac_f32 v137, v84, v76
  v_fmac_f32 v138, v88, v76
  v_fmac_f32 v139, v92, v76
  v_fmac_f32 v140, v80, v78
  v_fmac_f32 v141, v84, v78
  v_fmac_f32 v142, v88, v78
  v_fmac_f32 v143, v92, v78
  v_fmac_f32 v144, v81, v72
  v_fmac_f32 v145, v85, v72
  v_fmac_f32 v146, v89, v72
  v_fmac_f32 v147, v93, v72
  v_fmac_f32 v148, v81, v74
  v_fmac_f32 v149, v85, v74
  v_fmac_f32 v150, v89, v74
  v_fmac_f32 v151, v93, v74
  v_fmac_f32 v152, v81, v76
  v_fmac_f32 v153, v85, v76
  v_fmac_f32 v154, v89, v76
  v_fmac_f32 v155, v93, v76
  v_fmac_f32 v156, v81, v78
  v_fmac_f32 v157, v85, v78
  v_fmac_f32 v158, v89, v78
  v_fmac_f32 v159, v93, v78
  ds_read_b128 v[80:83], v15 offset:512
  ds_read_b128 v[84:87], v15 offset:576
  ds_read_b128 v[88:91], v15 offset:640
  ds_read_b128 v[92:95], v15 offset:704
  ds_read_b64 v[72:73], v75 offset:1792
  s_waitcnt lgkmcnt(0)
  v_fmac_f32 v192, v80, v72
  v_fmac_f32 v193, v81, v72
  v_fmac_f32 v194, v82, v72
  v_fmac_f32 v195, v83, v72
  v_fmac_f32 v196, v84, v72
  v_fmac_f32 v197, v85, v72
  v_fmac_f32 v198, v86, v72
  v_fmac_f32 v199, v87, v72
  v_fmac_f32 v200, v88, v72
  v_fmac_f32 v201, v89, v72
  v_fmac_f32 v202, v90, v72
  v_fmac_f32 v203, v91, v72
  v_fmac_f32 v204, v92, v72
  v_fmac_f32 v205, v93, v72
  v_fmac_f32 v206, v94, v72
  v_fmac_f32 v207, v95, v72
  v_fmac_f32 v208, v80, v73
  v_fmac_f32 v209, v81, v73
  v_fmac_f32 v210, v82, v73
  v_fmac_f32 v211, v83, v73
  v_fmac_f32 v212, v84, v73
  v_fmac_f32 v213, v85, v73
  v_fmac_f32 v214, v86, v73
  v_fmac_f32 v215, v87, v73
  v_fmac_f32 v216, v88, v73
  v_fmac_f32 v217, v89, v73
  v_fmac_f32 v218, v90, v73
  v_fmac_f32 v219, v91, v73
  v_fmac_f32 v220, v92, v73
  v_fmac_f32 v221, v93, v73
  v_fmac_f32 v222, v94, v73
  v_fmac_f32 v223, v95, v73
  s_branch .fz_kernel_q_pback
.fz_kernel_q_prod2:
  s_setprio 0
  s_mov_b64 s[8:9], s[4:5]
  s_mov_b64 s[10:11], s[6:7]
  s_mov_b64 s[12:13], s[42:43]
  s_lshl_b32 s35, s17, 6
  s_and_b32 s31, s16, 1
  s_add_u32 s35, s35, s31
  s_lshl_b32 s35, s35, 12
  s_add_u32 s35, s35, s73
  s_lshr_b32 s33, s17, 3
  s_add_u32 s29, s18, s33
  s_lshl1_add_u32 s29, s17, s29
  s_and_b32 s29, s29, 15
  s_mov_b32 s22, 16384
  s_mov_b32 s23, 8192
  s_mov_b32 s36, 0
  s_add_u32 s37, s19, s74
  s_add_u32 s37, s37, 8
  v_mov_b32 v40, v3
  v_mov_b32 v41, v3
  v_mov_b32 v42, v3
  v_mov_b32 v43, v3
  s_branch .fz_kernel_q_pc
.fz_kernel_xok1w:
  s_call_b64 s[68:69], .fz_kernel_q_xw
  s_branch .fz_kernel_xok1
.fz_kernel_xok2w:
  s_call_b64 s[68:69], .fz_kernel_q_xw
  s_branch .fz_kernel_xok2
.fz_kernel_q_xw:
  s_mov_b64 exec, 1
  s_mov_b32 s38, 0
.fz_kernel_q_xwl:
  ds_read_b32 v11, v6 offset:0x114
  s_add_u32 s38, s38, 1
  s_waitcnt lgkmcnt(0)
  v_readfirstlane_b32 s36, v11
  s_bitcmp1_b32 s36, s24
  s_cbranch_scc1 .fz_kernel_q_xwd
  s_cmp_lt_u32 s38, 1048576
  s_cbranch_scc1 .fz_kernel_q_xwl
  s_mov_b32 s36, -1
.fz_kernel_q_xwd:
  s_mov_b64 exec, -1
  s_nop 4
  s_setpc_b64 s[68:69]
.fz_kernel_xok3w:
  s_call_b64 s[68:69], .fz_kernel_q_xw
  s_branch .fz_kernel_xok3
.fz_kernel_lz26a:
  v_lshlrev_b32 v16, 3, v2
  buffer_atomic_and_x2 v[12:13], v16, s[4:7], s36 offen offset:0 sc1
  buffer_atomic_and_x2 v[12:13], v16, s[4:7], s36 offen offset:512 sc1
  buffer_atomic_and_x2 v[12:13], v16, s[4:7], s36 offen offset:1024 sc1
  buffer_atomic_and_x2 v[12:13], v16, s[4:7], s36 offen offset:1536 sc1
  buffer_atomic_and_x2 v[12:13], v16, s[4:7], s36 offen offset:2048 sc1
  buffer_atomic_and_x2 v[12:13], v16, s[4:7], s36 offen offset:2560 sc1
  buffer_atomic_and_x2 v[12:13], v16, s[4:7], s36 offen offset:3072 sc1
  buffer_atomic_and_x2 v[12:13], v16, s[4:7], s36 offen offset:3584 sc1
  s_branch .fz_kernel_lz26
.fz_kernel_a_pick:
  s_cmp_eq_u32 s34, 0xffff
  s_cbranch_scc1 .fz_kernel_a_picke
  s_mov_b32 s38, 0
.fz_kernel_a_pickl:
  ds_read_b32 v7, v6
  s_add_u32 s38, s38, 1
  s_waitcnt lgkmcnt(0)
  v_readfirstlane_b32 s33, v7
  s_cmp_lt_u32 s38, 1048576
  s_cselect_b32 s33, s33, 0xffff
  s_andn2_b32 s36, s33, s34
  s_cbranch_scc0 .fz_kernel_a_pickl
  s_or_b32 s34, s34, s33
  s_ff1_i32_b32 s33, s36
  s_bitset0_b32 s36, s33
  s_lshl_b32 s33, s33, 14
  s_add_u32 s30, s33, s35
  s_setpc_b64 s[68:69]
.fz_kernel_a_picke:
  s_mov_b32 s30, 0x40000000
  ds_write_b32 v6, v5 offset:0x104
  s_setpc_b64 s[68:69]
.fz_kernel_pk33c:
  s_call_b64 s[68:69], .fz_kernel_a_pick
  s_branch .fz_kernel_pk33
.fz_kernel_pk34c:
  s_call_b64 s[68:69], .fz_kernel_a_pick
  s_branch .fz_kernel_pk34
.fz_kernel_pk35c:
  s_call_b64 s[68:69], .fz_kernel_a_pick
  s_branch .fz_kernel_pk35
.fz_kernel_pk38c:
  s_call_b64 s[68:69], .fz_kernel_a_pick
  s_branch .fz_kernel_pk38
.fz_kernel_pk39c:
  s_call_b64 s[68:69], .fz_kernel_a_pick
  s_branch .fz_kernel_pk39
.fz_kernel_a_slow:
  s_cmp_lg_u32 s73, 0
  s_cbranch_scc1 .fz_kernel_a_ok
  s_mov_b32 s73, 1
  s_and_b32 s39, s16, 1
  v_mov_b32 v16, v32
  v_mov_b32 v17, v33
  v_mov_b32 v18, v34
  v_mov_b32 v19, v35
  v_mov_b32 v20, v36
  v_mov_b32 v21, v37
  v_mov_b32 v22, v38
  v_mov_b32 v23, v39
  s_call_b64 s[68:69], .fz_kernel_a_sl
  v_mov_b32 v176, v144
  v_mov_b32 v177, v145
  v_mov_b32 v178, v146
  v_mov_b32 v179, v147
  v_mov_b32 v180, v148
  v_mov_b32 v181, v149
  v_mov_b32 v182, v150
  v_mov_b32 v183, v151
  v_mov_b32 v184, v152
  v_mov_b32 v185, v153
  v_mov_b32 v186, v154
  v_mov_b32 v187, v155
  v_mov_b32 v188, v156
  v_mov_b32 v189, v157
  v_mov_b32 v190, v158
  v_mov_b32 v191, v159
  v_mov_b32 v24, v25
  v_mov_b32 v16, v40
  v_mov_b32 v17, v41
  v_mov_b32 v18, v42
  v_mov_b32 v19, v43
  v_mov_b32 v20, v44
  v_mov_b32 v21, v45
  v_mov_b32 v22, v46
  v_mov_b32 v23, v47
  s_call_b64 s[68:69], .fz_kernel_a_sl
  v_mov_b32 v192, v144
  v_mov_b32 v193, v145
  v_mov_b32 v194, v146
  v_mov_b32 v195, v147
  v_mov_b32 v196, v148
  v_mov_b32 v197, v149
  v_mov_b32 v198, v150
  v_mov_b32 v199, v151
  v_mov_b32 v200, v152
  v_mov_b32 v201, v153
  v_mov_b32 v202, v154
  v_mov_b32 v203, v155
  v_mov_b32 v204, v156
  v_mov_b32 v205, v157
  v_mov_b32 v206, v158
  v_mov_b32 v207, v159
  v_rcp_f32 v26, v24
  v_cmp_le_f32 vcc, s24, v24
  s_and_b64 s[36:37], s[36:37], vcc
  v_cmp_ge_f32 vcc, s25, v24
  s_and_b64 s[36:37], s[36:37], vcc
  v_pk_mul_f32 v[176:177], v[176:177], v[26:27] op_sel_hi:[1,0]
  v_pk_mul_f32 v[178:179], v[178:179], v[26:27] op_sel_hi:[1,0]
  v_pk_mul_f32 v[180:181], v[180:181], v[26:27] op_sel_hi:[1,0]
  v_pk_mul_f32 v[182:183], v[182:183], v[26:27] op_sel_hi:[1,0]
  v_cvt_pk_bf16_f32 v80, v176, v177
  v_cvt_pk_bf16_f32 v81, v178, v179
  v_cvt_pk_bf16_f32 v82, v180, v181
  v_cvt_pk_bf16_f32 v83, v182, v183
  buffer_store_dwordx4 v[80:83], v3, s[4:7], s28 offen offset:0 sc1
  v_pk_mul_f32 v[184:185], v[184:185], v[26:27] op_sel_hi:[1,0]
  v_pk_mul_f32 v[186:187], v[186:187], v[26:27] op_sel_hi:[1,0]
  v_pk_mul_f32 v[188:189], v[188:189], v[26:27] op_sel_hi:[1,0]
  v_pk_mul_f32 v[190:191], v[190:191], v[26:27] op_sel_hi:[1,0]
  v_cvt_pk_bf16_f32 v84, v184, v185
  v_cvt_pk_bf16_f32 v85, v186, v187
  v_cvt_pk_bf16_f32 v86, v188, v189
  v_cvt_pk_bf16_f32 v87, v190, v191
  buffer_store_dwordx4 v[84:87], v3, s[4:7], s28 offen offset:1024 sc1
  s_branch .fz_kernel_a_fin
.fz_kernel_a_sl:
  s_waitcnt vmcnt(0)
  s_lshl_b32 s23, s18, 1
  s_add_u32 s23, s23, s39
  s_lshl_b32 s23, s23, 18
  s_add_u32 s23, s23, s63
  s_mov_b32 s30, s23
  s_mov_b32 s33, 64
  v_mov_b32 v27, 0xff800000
.fz_kernel_a_s1:
  buffer_load_dwordx4 v[80:83], v3, s[4:7], s30 offen offset:0
  buffer_load_dwordx4 v[84:87], v3, s[4:7], s30 offen offset:1024
  s_waitcnt vmcnt(0)
  v_mfma_f32_32x32x16_bf16 v[48:63], v[80:83], v[16:19], 0
  v_mfma_f32_32x32x16_bf16 v[48:63], v[84:87], v[20:23], v[48:63]
  s_nop 11
  v_max3_f32 v27, v27, v48, v49
  v_max3_f32 v27, v27, v50, v51
  v_max3_f32 v27, v27, v52, v53
  v_max3_f32 v27, v27, v54, v55
  v_max3_f32 v27, v27, v56, v57
  v_max3_f32 v27, v27, v58, v59
  v_max3_f32 v27, v27, v60, v61
  v_max3_f32 v27, v27, v62, v63
  s_add_u32 s30, s30, 4096
  s_sub_u32 s33, s33, 1
  s_cmp_lg_u32 s33, 0
  s_cbranch_scc1 .fz_kernel_a_s1
  v_mov_b32 v29, v27
  s_nop 1
  v_permlane32_swap_b32 v29, v27
  v_max_f32 v27, v27, v29
  v_sub_f32 v27, 0, v27
  v_mov_b32 v64, v27
  v_mov_b32 v144, 0
  v_mov_b32 v65, v27
  v_mov_b32 v145, 0
  v_mov_b32 v66, v27
  v_mov_b32 v146, 0
  v_mov_b32 v67, v27
  v_mov_b32 v147, 0
  v_mov_b32 v68, v27
  v_mov_b32 v148, 0
  v_mov_b32 v69, v27
  v_mov_b32 v149, 0
  v_mov_b32 v70, v27
  v_mov_b32 v150, 0
  v_mov_b32 v71, v27
  v_mov_b32 v151, 0
  v_mov_b32 v72, v27
  v_mov_b32 v152, 0
  v_mov_b32 v73, v27
  v_mov_b32 v153, 0
  v_mov_b32 v74, v27
  v_mov_b32 v154, 0
  v_mov_b32 v75, v27
  v_mov_b32 v155, 0
  v_mov_b32 v76, v27
  v_mov_b32 v156, 0
  v_mov_b32 v77, v27
  v_mov_b32 v157, 0
  v_mov_b32 v78, v27
  v_mov_b32 v158, 0
  v_mov_b32 v79, v27
  v_mov_b32 v159, 0
  v_mov_b32 v208, 0
  v_mov_b32 v209, 0
  v_mov_b32 v210, 0
  v_mov_b32 v211, 0
  s_mov_b32 s30, s23
  s_mov_b32 s33, 64
.fz_kernel_a_s2:
  buffer_load_dwordx4 v[80:83], v3, s[4:7], s30 offen offset:0
  buffer_load_dwordx4 v[84:87], v3, s[4:7], s30 offen offset:1024
  buffer_load_dwordx4 v[88:91], v3, s[4:7], s30 offen offset:2048
  buffer_load_dwordx4 v[92:95], v3, s[4:7], s30 offen offset:3072
  s_waitcnt vmcnt(0)
  v_mfma_f32_32x32x16_bf16 v[48:63], v[80:83], v[16:19], v[64:79]
  v_mfma_f32_32x32x16_bf16 v[48:63], v[84:87], v[20:23], v[48:63]
  s_nop 11
  v_exp_f32 v48, v48
  v_exp_f32 v49, v49
  v_exp_f32 v50, v50
  v_exp_f32 v51, v51
  v_exp_f32 v52, v52
  v_exp_f32 v53, v53
  v_exp_f32 v54, v54
  v_exp_f32 v55, v55
  v_exp_f32 v56, v56
  v_exp_f32 v57, v57
  v_exp_f32 v58, v58
  v_exp_f32 v59, v59
  v_exp_f32 v60, v60
  v_exp_f32 v61, v61
  v_exp_f32 v62, v62
  v_exp_f32 v63, v63
  v_cvt_pk_bf16_f32 v224, v48, v49
  v_cvt_pk_bf16_f32 v225, v50, v51
  v_cvt_pk_bf16_f32 v226, v52, v53
  v_cvt_pk_bf16_f32 v227, v54, v55
  v_cvt_pk_bf16_f32 v228, v56, v57
  v_cvt_pk_bf16_f32 v229, v58, v59
  v_cvt_pk_bf16_f32 v230, v60, v61
  v_cvt_pk_bf16_f32 v231, v62, v63
  v_mfma_f32_32x32x16_bf16 v[144:159], v[88:91], v[224:227], v[144:159]
  s_nop 0
  v_mfma_f32_32x32x16_bf16 v[144:159], v[92:95], v[228:231], v[144:159]
  v_smfmac_f32_16x16x64_bf16 v[208:211], v[12:15], v[224:231], v11
  s_add_u32 s30, s30, 4096
  s_sub_u32 s33, s33, 1
  s_cmp_lg_u32 s33, 0
  s_cbranch_scc1 .fz_kernel_a_s2
  s_nop 7
  v_add_f32 v208, v208, v210
  v_add_f32 v209, v209, v211
  v_cndmask_b32 v25, v208, v209, s[26:27]
  s_nop 7
  s_setpc_b64 s[68:69]
.fz_kernel_serv:
  s_setprio 3
  s_mov_b32 s24, s44
  s_mov_b32 s25, s45
  s_mov_b32 s26, 0x200000
  s_mov_b32 s27, 0x00020000
  v_lshrrev_b32 v8, 3, v2
  v_and_b32 v9, 7, v2
  v_bfe_u32 v10, v2, 4, 1
  v_lshlrev_b32 v10, 2, v10
  v_xor_b32 v9, v9, v10
  v_lshlrev_b32 v9, 4, v9
  v_lshl_add_u32 v10, v8, 11, v9
  s_cmp_eq_u32 s16, 5
  s_cbranch_scc1 .fz_kernel_sv1
  s_barrier
  v_lshlrev_b32 v7, 7, v2
  s_lshl_b32 s31, s18, 11
  s_lshl_b32 s33, 1, s17
  s_add_u32 s31, s31, s67
  s_add_u32 s31, s31, 0x1800000
  v_mov_b32 v8, s33
  s_mov_b64 exec, 0xffff
  s_mov_b32 s38, 0
.fz_kernel_cw40:
  s_sleep 1
  ds_read_u8 v9, v6 offset:256
  s_add_u32 s38, s38, 1
  s_waitcnt lgkmcnt(0)
  v_cmp_gt_u32 vcc, 4, v9
  s_cbranch_vccz .fz_kernel_cw40d
  s_cmp_lt_u32 s38, 8388608
  s_cbranch_scc1 .fz_kernel_cw40
.fz_kernel_cw40d:
  buffer_atomic_or v8, v7, s[4:7], s31 offen sc1
  s_mov_b64 exec, -1
  s_setprio 0
  s_mov_b32 s38, 0
.fz_kernel_kw41:
  s_sleep 2
  ds_read_b32 v7, v6 offset:0
  s_add_u32 s38, s38, 1
  s_waitcnt lgkmcnt(0)
  v_readfirstlane_b32 s31, v7
  s_bcnt1_i32_b32 s31, s31
  s_cmp_ge_u32 s31, 16
  s_cbranch_scc1 .fz_kernel_kw41d
  s_cmp_lt_u32 s38, 1048576
  s_cbranch_scc1 .fz_kernel_kw41
.fz_kernel_kw41d:
  s_branch .fz_kernel_sv2
.fz_kernel_sv1:
  s_add_u32 s37, s19, s67
  s_mov_b64 exec, 1
  buffer_load_dword v7, v4, s[4:7], s37 offen sc1
  s_waitcnt vmcnt(0)
  ds_or_b32 v6, v7
  buffer_load_dword v9, v4, s[4:7], s37 offen sc1
  s_barrier
  s_waitcnt vmcnt(0)
  ds_or_b32 v6, v9
  s_add_u32 s37, s19, s67
  s_mov_b64 exec, 1
  s_mov_b32 s38, 0
.fz_kernel_po42:
  buffer_load_dword v7, v4, s[4:7], s37 offen offset:0 sc1
  s_add_u32 s38, s38, 1
  s_waitcnt vmcnt(0)
  ds_or_b32 v6, v7 offset:0
  v_cmp_ne_u32 vcc, 0xffff, v7
  s_cbranch_vccz .fz_kernel_po42d
  s_sleep 12
  s_cmp_lt_u32 s38, 131072
  s_cbranch_scc1 .fz_kernel_po42
.fz_kernel_po42d:
  s_mov_b64 exec, -1
  s_setprio 0
  s_mov_b32 s38, 0
.fz_kernel_kw43:
  s_sleep 2
  ds_read_b32 v7, v6 offset:0
  s_add_u32 s38, s38, 1
  s_waitcnt lgkmcnt(0)
  v_readfirstlane_b32 s31, v7
  s_bcnt1_i32_b32 s31, s31
  s_cmp_ge_u32 s31, 16
  s_cbranch_scc1 .fz_kernel_kw43d
  s_cmp_lt_u32 s38, 1048576
  s_cbranch_scc1 .fz_kernel_kw43
.fz_kernel_kw43d:
.fz_kernel_sv2:
  s_and_b32 s30, s16, 1
  s_lshl_b32 s30, s30, 16
  s_add_u32 s32, s30, 65536
  s_lshl_b32 s31, s18, 7
  v_add_u32 v10, s31, v10
.fz_kernel_sv3:
  s_mov_b32 m0, s30
  s_lshl_b32 s31, s30, 4
  s_add_u32 s30, s30, 1024
  buffer_load_dwordx4 v10, s[24:27], s31 offen  lds
  s_cmp_lg_u32 s30, s32
  s_waitcnt vmcnt(3)
  s_cbranch_scc1 .fz_kernel_sv3
  s_cmp_lg_u32 s62, 0
  s_cbranch_scc1 .fz_kernel_wt44
  s_mov_b32 s12, s42
  s_mov_b32 s13, s43
  s_mov_b32 s14, 0x600000
  s_mov_b32 s15, 0x00020000
  s_and_b32 s30, s16, 1
  s_lshl1_add_u32 s30, s17, s30
  s_and_b32 s30, s30, 15
  s_mul_i32 s30, s30, 393216
  s_lshl_b32 s31, s18, 7
  s_add_u32 s30, s30, s31
  v_mul_u32_u24 v11, 6144, v2
  buffer_load_dword v1, v11, s[12:15], s30 offen
  s_add_u32 s30, s30, 2048
  s_waitcnt vmcnt(0)
  buffer_load_dword v1, v11, s[12:15], s30 offen
  s_add_u32 s30, s30, 2048
  s_waitcnt vmcnt(0)
  buffer_load_dword v1, v11, s[12:15], s30 offen
  s_add_u32 s30, s30, 2048
  s_waitcnt vmcnt(0)
.fz_kernel_wt44:
  s_cmp_lg_u32 s16, 4
  s_cbranch_scc1 .fz_kernel_ct45e
  s_getpc_b64 s[0:1]
.fz_kernel_ct45:
  s_sub_u32 s0, s0, .fz_kernel_ct45-fz_kernel
  s_subb_u32 s1, s1, 0
  s_lshr_b32 s31, s2, 3
  s_mulk_i32 s31, 0x500
  v_lshl_add_u32 v1, v2, 7, s31
  v_min_u32 v1, .fz_kernel_last-fz_kernel, v1
  s_mov_b64 exec, 0x3ff
  global_load_dword v1, v1, s[0:1]
  s_mov_b64 exec, -1
.fz_kernel_ct45e:
  s_waitcnt vmcnt(0)
  s_cmp_lg_u32 s16, 5
  s_cbranch_scc1 .fz_kernel_sv35
  s_mov_b64 exec, 1
  s_mov_b32 s38, 0
.fz_kernel_sv34:
  s_sleep 4
  buffer_load_dword v7, v4, s[4:7], s37 offen offset:4 sc1
  ds_read_b32 v8, v6 offset:0x104
  s_add_u32 s38, s38, 1
  s_waitcnt vmcnt(0) lgkmcnt(0)
  ds_or_b32 v6, v7 offset:8
  v_cmp_ne_u32 vcc, 0, v8
  s_cbranch_vccnz .fz_kernel_sv35
  s_cmp_lt_u32 s38, 131072
  s_cbranch_scc1 .fz_kernel_sv34
.fz_kernel_sv35:
  s_mov_b64 exec, -1
  s_setprio 3
  s_barrier
  s_cmp_eq_u32 s16, 5
  s_cbranch_scc1 .fz_kernel_sv4
  v_lshlrev_b32 v7, 11, v2
  s_lshl_b32 s31, s17, 7
  s_lshl_b32 s33, 1, s18
  s_add_u32 s31, s31, s67
  s_add_u32 s31, s31, 0x1800004
  v_mov_b32 v8, s33
  s_mov_b64 exec, 0xffff
  s_mov_b32 s38, 0
.fz_kernel_cw46:
  s_sleep 1
  ds_read_u8 v9, v6 offset:264
  s_add_u32 s38, s38, 1
  s_waitcnt lgkmcnt(0)
  v_cmp_gt_u32 vcc, 4, v9
  s_cbranch_vccz .fz_kernel_cw46d
  s_cmp_lt_u32 s38, 8388608
  s_cbranch_scc1 .fz_kernel_cw46
.fz_kernel_cw46d:
  buffer_atomic_or v8, v7, s[4:7], s31 offen sc1
  s_mov_b64 exec, -1
  s_mov_b64 exec, 1
  ds_or_b32 v6, v8 offset:8
  s_mov_b64 exec, -1
  s_branch .fz_kernel_sv5
.fz_kernel_sv4:
  s_add_u32 s37, s19, s67
  s_mov_b64 exec, 1
  s_mov_b32 s38, 0
.fz_kernel_po47:
  buffer_load_dword v7, v4, s[4:7], s37 offen offset:4 sc1
  s_add_u32 s38, s38, 1
  s_waitcnt vmcnt(0)
  ds_or_b32 v6, v7 offset:8
  v_cmp_ne_u32 vcc, 0xffff, v7
  s_cbranch_vccz .fz_kernel_po47d
  s_sleep 12
  s_cmp_lt_u32 s38, 131072
  s_cbranch_scc1 .fz_kernel_po47
.fz_kernel_po47d:
  s_mov_b64 exec, -1
.fz_kernel_sv5:
  s_mov_b32 s72, s66
  s_mov_b32 s73, s65
  s_mov_b32 s74, s67
  s_mov_b32 s75, s62
  s_cmp_lg_u32 s62, 0
  s_cbranch_scc1 .fz_kernel_w_lt
  s_mov_b32 s62, 1
  s_mov_b32 s63, 0x2000000
  s_mov_b32 s64, 0x2800000
  s_mov_b32 s65, 0x1400000
  s_mov_b32 s66, 0x1c42000
  s_mov_b32 s67, 12
  s_mov_b32 s71, 159776
  v_mov_b32 v6, 159832
  s_branch .fz_kernel_q_prod2
.fz_kernel_w_lt:
  s_barrier
  s_barrier
  s_branch .fz_kernel_fin
.fz_kernel_pk48c:
  s_call_b64 s[68:69], .fz_kernel_pick
  s_branch .fz_kernel_pk48
.fz_kernel_pk49c:
  s_call_b64 s[68:69], .fz_kernel_pick
  s_branch .fz_kernel_pk49
.fz_kernel_w_pt:
  v_lshlrev_b32 v44, 5, v17
  v_add_u32 v44, 155648, v44
  s_mov_b64 exec, vcc
  ds_read_b128 v[232:235], v44 offset:7424
  ds_read_b128 v[236:239], v44 offset:7440
  ds_read_b128 v[240:243], v44 offset:7488
  ds_read_b128 v[244:247], v44 offset:7504
  s_waitcnt lgkmcnt(0)
  v_pk_add_f32 v[64:65], v[64:65], v[232:233]
  v_pk_add_f32 v[66:67], v[66:67], v[234:235]
  v_pk_add_f32 v[68:69], v[68:69], v[236:237]
  v_pk_add_f32 v[70:71], v[70:71], v[238:239]
  v_pk_add_f32 v[72:73], v[72:73], v[240:241]
  v_pk_add_f32 v[74:75], v[74:75], v[242:243]
  v_pk_add_f32 v[76:77], v[76:77], v[244:245]
  v_pk_add_f32 v[78:79], v[78:79], v[246:247]
  ds_read_b128 v[232:235], v44 offset:7552
  ds_read_b128 v[236:239], v44 offset:7568
  ds_read_b128 v[240:243], v44 offset:7616
  ds_read_b128 v[244:247], v44 offset:7632
  s_waitcnt lgkmcnt(0)
  v_pk_add_f32 v[80:81], v[80:81], v[232:233]
  v_pk_add_f32 v[82:83], v[82:83], v[234:235]
  v_pk_add_f32 v[84:85], v[84:85], v[236:237]
  v_pk_add_f32 v[86:87], v[86:87], v[238:239]
  v_pk_add_f32 v[88:89], v[88:89], v[240:241]
  v_pk_add_f32 v[90:91], v[90:91], v[242:243]
  v_pk_add_f32 v[92:93], v[92:93], v[244:245]
  v_pk_add_f32 v[94:95], v[94:95], v[246:247]
  s_mov_b64 exec, -1
  s_branch .fz_kernel_w_pb
.fz_kernel_pk50c:
  s_call_b64 s[68:69], .fz_kernel_pick
  s_branch .fz_kernel_pk50
.fz_kernel_pk51c:
  s_call_b64 s[68:69], .fz_kernel_pick
  s_branch .fz_kernel_pk51
.fz_kernel_pk52c:
  s_call_b64 s[68:69], .fz_kernel_pick
  s_branch .fz_kernel_pk52
.fz_kernel_pk53c:
  s_call_b64 s[68:69], .fz_kernel_pick
  s_branch .fz_kernel_pk53
.fz_kernel_pk54c:
  s_call_b64 s[68:69], .fz_kernel_pick
  s_branch .fz_kernel_pk54
.fz_kernel_pk55c:
  s_call_b64 s[68:69], .fz_kernel_pick
  s_branch .fz_kernel_pk55
.fz_kernel_pk56c:
  s_call_b64 s[68:69], .fz_kernel_pick
  s_branch .fz_kernel_pk56
.fz_kernel_pk57c:
  s_call_b64 s[68:69], .fz_kernel_pick
  s_branch .fz_kernel_pk57
.fz_kernel_pk58c:
  s_call_b64 s[68:69], .fz_kernel_pick
  s_branch .fz_kernel_pk58
.fz_kernel_pk59c:
  s_call_b64 s[68:69], .fz_kernel_pick
  s_branch .fz_kernel_pk59
.fz_kernel_pk60c:
  s_call_b64 s[68:69], .fz_kernel_pick
  s_branch .fz_kernel_pk60
.fz_kernel_pk61c:
  s_call_b64 s[68:69], .fz_kernel_pick
  s_branch .fz_kernel_pk61
.fz_kernel_pk62c:
  s_call_b64 s[68:69], .fz_kernel_pick
  s_branch .fz_kernel_pk62
.fz_kernel_pk63c:
  s_call_b64 s[68:69], .fz_kernel_pick
  s_branch .fz_kernel_pk63
.fz_kernel_pk64c:
  s_call_b64 s[68:69], .fz_kernel_pick
  s_branch .fz_kernel_pk64
.fz_kernel_pk65c:
  s_call_b64 s[68:69], .fz_kernel_pick
  s_branch .fz_kernel_pk65
.fz_kernel_c_nl:
  s_barrier
  s_branch .fz_kernel_c_np
.fz_kernel_c_c7:
  s_mov_b32 s38, 0
.fz_kernel_cw70:
  s_sleep 1
  ds_read_u8 v22, v6 offset:272
  s_add_u32 s38, s38, 1
  s_waitcnt lgkmcnt(0)
  v_cmp_gt_u32 vcc, 2, v22
  s_cbranch_vccz .fz_kernel_cw70d
  s_cmp_lt_u32 s38, 8388608
  s_cbranch_scc1 .fz_kernel_cw70
.fz_kernel_cw70d:
  ds_read_b64_tr_b16 v[32:33], v7 offset:0
  ds_read_b64_tr_b16 v[34:35], v7 offset:512
  ds_read_b64_tr_b16 v[36:37], v13 offset:0
  ds_read_b64_tr_b16 v[38:39], v13 offset:512
  ds_read_b64_tr_b16 v[40:41], v7 offset:4096
  ds_read_b64_tr_b16 v[42:43], v7 offset:4608
  ds_read_b64_tr_b16 v[44:45], v13 offset:4096
  ds_read_b64_tr_b16 v[46:47], v13 offset:4608
  ds_read_b64_tr_b16 v[48:49], v7 offset:8192
  ds_read_b64_tr_b16 v[50:51], v7 offset:8704
  ds_read_b64_tr_b16 v[52:53], v13 offset:8192
  ds_read_b64_tr_b16 v[54:55], v13 offset:8704
  s_waitcnt lgkmcnt(0)
  v_xor_b32 v7, 64, v7
  v_xor_b32 v13, 64, v13
  ds_read_b64_tr_b16 v[56:57], v7 offset:1024
  ds_read_b64_tr_b16 v[58:59], v7 offset:1536
  ds_read_b64_tr_b16 v[60:61], v13 offset:1024
  ds_read_b64_tr_b16 v[62:63], v13 offset:1536
  ds_read_b64_tr_b16 v[64:65], v7 offset:5120
  ds_read_b64_tr_b16 v[66:67], v7 offset:5632
  ds_read_b64_tr_b16 v[68:69], v13 offset:5120
  ds_read_b64_tr_b16 v[70:71], v13 offset:5632
  ds_read_b64_tr_b16 v[72:73], v7 offset:9216
  ds_read_b64_tr_b16 v[74:75], v7 offset:9728
  ds_read_b64_tr_b16 v[76:77], v13 offset:9216
  ds_read_b64_tr_b16 v[78:79], v13 offset:9728
  s_waitcnt lgkmcnt(0)
  s_branch .fz_kernel_c_c2
.fz_kernel_c_coef:
  v_fma_f32 v242, -v240, v240, v242
  v_fma_f32 v243, -v241, v241, v243
  v_rsq_f32 v248, abs(v242)
  v_rsq_f32 v249, abs(v243)
  v_mul_f32 v254, v240, v248
  v_sub_f32 v254, 0, v254
  v_mov_b32 v252, 1.0
  v_fmac_f32 v252, 0x44800000, v248
  v_fma_f32 v242, v242, v24, -v25
  v_max_f32 v242, 0, v242
  v_mul_f32 v248, v252, v252
  v_fma_f32 v248, v248, v242, v25
  v_rsq_f32 v248, v248
  v_mul_f32 v240, v23, v240
  v_mul_f32 v248, v248, v252
  v_mul_f32 v250, v248, v240
  v_sub_f32 v250, 0, v250
  v_mul_f32 v255, v241, v249
  v_sub_f32 v255, 0, v255
  v_mov_b32 v253, 1.0
  v_fmac_f32 v253, 0x44800000, v249
  s_cmp_eq_u32 s3, 0
  s_cbranch_scc1 .fz_kernel_hb76
  s_barrier
  s_sub_u32 s3, s3, 1
.fz_kernel_hb76:
  v_fma_f32 v243, v243, v24, -v25
  v_max_f32 v243, 0, v243
  v_mul_f32 v249, v253, v253
  v_fma_f32 v249, v249, v243, v25
  v_rsq_f32 v249, v249
  v_mul_f32 v241, v23, v241
  v_mul_f32 v249, v249, v253
  v_mul_f32 v251, v249, v241
  v_sub_f32 v251, 0, v251
  s_setpc_b64 s[68:69]
.fz_kernel_c_gur:
  v_min_u32 v9, v144, v146
  v_cmp_eq_u32 s[8:9], 0, v9
  v_min_u32 v9, v148, v150
  v_cmp_eq_u32 s[10:11], 0, v9
  v_min_u32 v9, v152, v154
  v_cmp_eq_u32 s[12:13], 0, v9
  v_min_u32 v9, v156, v158
  v_cmp_eq_u32 s[14:15], 0, v9
  s_add_u32 s38, s38, 1
  s_cmp_ge_u32 s38, 131072
  s_cbranch_scc1 .fz_kernel_c_gud
  s_or_b64 exec, s[8:9], 1
  buffer_load_dwordx4 v[144:147], v21, s[4:7], s33 offen offset:0 sc1
  s_or_b64 exec, s[10:11], 1
  buffer_load_dwordx4 v[148:151], v21, s[4:7], s33 offen offset:512 sc1
  s_or_b64 exec, s[12:13], 1
  buffer_load_dwordx4 v[152:155], v21, s[4:7], s33 offen offset:1024 sc1
  s_or_b64 exec, s[14:15], 1
  buffer_load_dwordx4 v[156:159], v21, s[4:7], s33 offen offset:1536 sc1
  s_mov_b64 exec, -1
  s_branch .fz_kernel_c_gu
.fz_kernel_c_pur:
  s_cmp_eq_u32 s3, 0
  s_cbranch_scc1 .fz_kernel_hb81
  s_barrier
  s_sub_u32 s3, s3, 1
.fz_kernel_hb81:
  s_add_u32 s38, s38, 1
  s_cmp_ge_u32 s38, 131072
  s_cbranch_scc1 .fz_kernel_c_pud
  v_min_u32 v9, v144, v146
  v_cmp_eq_u32 vcc, 0, v9
  s_cbranch_vccz .fz_kernel_c_ps0
  buffer_load_dwordx4 v[144:147], v3, s[4:7], s21 offen offset:0 sc1
.fz_kernel_c_ps0:
  v_min_u32 v9, v148, v150
  v_cmp_eq_u32 vcc, 0, v9
  s_cbranch_vccz .fz_kernel_c_ps1
  buffer_load_dwordx4 v[148:151], v3, s[4:7], s21 offen offset:1024 sc1
.fz_kernel_c_ps1:
  v_min_u32 v9, v152, v154
  v_cmp_eq_u32 vcc, 0, v9
  s_cbranch_vccz .fz_kernel_c_ps2
  buffer_load_dwordx4 v[152:155], v3, s[4:7], s21 offen offset:2048 sc1
.fz_kernel_c_ps2:
  v_min_u32 v9, v156, v158
  v_cmp_eq_u32 vcc, 0, v9
  s_cbranch_vccz .fz_kernel_c_ps3
  buffer_load_dwordx4 v[156:159], v3, s[4:7], s21 offen offset:3072 sc1
.fz_kernel_c_ps3:
  v_min_u32 v9, v160, v162
  v_cmp_eq_u32 vcc, 0, v9
  s_cbranch_vccz .fz_kernel_c_ps4
  buffer_load_dwordx4 v[160:163], v3, s[4:7], s22 offen offset:0 sc1
.fz_kernel_c_ps4:
  v_min_u32 v9, v164, v166
  v_cmp_eq_u32 vcc, 0, v9
  s_cbranch_vccz .fz_kernel_c_ps5
  buffer_load_dwordx4 v[164:167], v3, s[4:7], s22 offen offset:1024 sc1
.fz_kernel_c_ps5:
  v_min_u32 v9, v168, v170
  v_cmp_eq_u32 vcc, 0, v9
  s_cbranch_vccz .fz_kernel_c_ps6
  buffer_load_dwordx4 v[168:171], v3, s[4:7], s22 offen offset:2048 sc1
.fz_kernel_c_ps6:
  s_branch .fz_kernel_c_pu
.fz_kernel_last:
  s_endpgm

.section .rodata,"a"
.p2align 6
.amdhsa_kernel fz_kernel
  .amdhsa_next_free_vgpr 256
  .amdhsa_next_free_sgpr 102
  .amdhsa_accum_offset 256
  .amdhsa_group_segment_fixed_size 0
  .amdhsa_kernarg_size 88
  .amdhsa_user_sgpr_count 2
  .amdhsa_user_sgpr_kernarg_segment_ptr 1
  .amdhsa_system_sgpr_workgroup_id_x 1
.end_amdhsa_kernel
```

```asm
; @launch kernel=fz_kernel grid=(256,1,1) block=(512,1,1) lds=163840
.amdgcn_target "amdgcn-amd-amdhsa--gfx950"
.text
.globl fz_kernel
.p2align 8
.type fz_kernel,@function
fz_kernel:
  s_cmp_ge_u32 s2, 256
  s_cbranch_scc1 .fz_kernel_end
  s_load_dwordx2 s[8:9], s[0:1], 0
  s_load_dwordx2 s[12:13], s[0:1], 8
  s_load_dwordx2 s[4:5], s[0:1], 80
  s_load_dwordx16 s[40:55], s[0:1], 0
  s_load_dwordx4 s[56:59], s[0:1], 64
  v_lshrrev_b32 v1, 6, v0
  v_and_b32 v2, 63, v0
  v_readfirstlane_b32 s16, v1
  s_and_b32 s21, s2, 7
  s_lshr_b32 s22, s2, 3
  s_and_b32 s23, s21, 3
  s_lshl_b32 s23, s23, 2
  s_and_b32 s24, s22, 3
  s_add_u32 s18, s23, s24
  s_lshr_b32 s24, s21, 2
  s_lshl_b32 s24, s24, 3
  s_lshr_b32 s25, s22, 2
  s_add_u32 s17, s24, s25
  s_lshl_b32 s19, s18, 4
  s_add_u32 s19, s19, s17
  s_lshl_b32 s19, s19, 7
  s_add_u32 s19, s19, 0x1800000
  v_lshlrev_b32 v3, 4, v2
  v_mov_b32 v4, 0
  v_mov_b32 v5, 1
  s_mov_b32 s6, 0x2c00000
  s_mov_b32 s7, 0x00020000
  s_mov_b32 s62, 0
  s_mov_b32 s63, 0x400000
  s_mov_b32 s64, 0xc00000
  s_mov_b32 s65, 0x1000000
  s_mov_b32 s66, 0x1c00000
  s_mov_b32 s67, 0
  s_mov_b32 s71, 159744
  v_mov_b32 v6, 159808
  s_cmp_lt_u32 s16, 4
  s_cbranch_scc1 .fz_kernel_q_cons1
  s_cmp_ge_u32 s16, 6
  s_cbranch_scc1 .fz_kernel_q_help1
  s_mov_b32 s10, 0x400000
  s_mov_b32 s11, 0x00020000
  v_lshrrev_b32 v20, 3, v2
  v_and_b32 v21, 7, v2
  v_lshrrev_b32 v22, 4, v2
  v_xor_b32 v23, v21, v22
  v_lshlrev_b32 v23, 4, v23
  v_lshl_add_u32 v24, v20, 11, v23
  v_xor_b32 v25, 64, v24
  s_lshl_b32 s35, s17, 2
  s_and_b32 s31, s16, 1
  s_add_u32 s35, s35, s31
  s_lshl_b32 s35, s35, 16
  s_and_b32 s29, s18, 12
  s_lshr_b32 s33, s17, 3
  s_lshl1_add_u32 s29, s33, s29
  s_lshl2_add_u32 s29, s17, s29
  s_and_b32 s29, s29, 15
  s_mov_b32 s22, 128
  s_mov_b32 s23, 131072
  s_mov_b32 s36, -1
  v_add_u32 v40, 0, v24
  v_add_u32 v41, 15360, v25
  v_add_u32 v42, 30720, v24
  v_add_u32 v43, 46080, v25
.fz_kernel_q_pc:
  s_mov_b32 s14, 0x600000
  s_mov_b32 s15, 0x00020000
  v_lshrrev_b32 v28, 3, v2
  v_and_b32 v29, 7, v2
  v_bfe_u32 v30, v2, 4, 1
  v_lshlrev_b32 v30, 1, v30
  v_xor_b32 v31, v29, v30
  v_lshlrev_b32 v31, 4, v31
  v_mul_u32_u24 v28, 6144, v28
  v_add_u32 v28, v28, v31
  v_xor_b32 v29, 64, v28
  s_lshl_b32 s32, s18, 7
  s_add_u32 s39, s32, 6291456
  s_mul_i32 s33, s29, 393216
  s_add_u32 s33, s33, s32
  s_lshl_b32 s29, s29, 1
  s_mul_i32 s25, s31, 6144
  s_add_u32 s25, s25, 65536
  s_mov_b32 s30, s25
  s_add_u32 s26, s25, 49152
  s_lshl_b32 s21, s31, 12
  s_cmp_eq_u32 s31, 0
  s_mov_b32 s24, 100352
  s_cselect_b32 s24, 0, s24
  v_add_u32 v32, s24, v28
  s_mov_b32 s24, 148480
  s_cselect_b32 s24, 48128, s24
  v_add_u32 v33, s24, v29
  s_mov_b32 s24, 2048
  s_cselect_b32 s24, 96256, s24
  v_add_u32 v34, s24, v28
  s_mov_b32 s24, 50176
  s_cselect_b32 s24, 144384, s24
  v_add_u32 v35, s24, v29
  s_mov_b32 s24, 102400
  s_cselect_b32 s24, 2048, s24
  v_add_u32 v36, s24, v28
  s_mov_b32 s24, 150528
  s_cselect_b32 s24, 50176, s24
  v_add_u32 v37, s24, v29
  s_cmp_lg_u32 s62, 0
  s_cbranch_scc1 .fz_kernel_q_st2
  s_waitcnt lgkmcnt(0)
  s_mov_b32 s34, 32
  s_call_b64 s[0:1], .fz_kernel_q_ix
  s_call_b64 s[0:1], .fz_kernel_q_iu
  s_call_b64 s[0:1], .fz_kernel_q_iu
  s_call_b64 s[0:1], .fz_kernel_q_iu
  s_waitcnt vmcnt(20)
  s_barrier
  s_call_b64 s[0:1], .fz_kernel_q_iu
  s_waitcnt vmcnt(24)
  s_barrier
  s_call_b64 s[0:1], .fz_kernel_q_iu
  s_branch .fz_kernel_q_pl
.fz_kernel_q_ix:
  s_bfe_u32 s24, s29, 0x40001
  s_mul_i32 s20, s24, s22
  s_bitcmp1_b32 s29, 0
  s_cselect_b32 s31, s23, 0
  s_add_u32 s20, s20, s35
  s_add_u32 s20, s20, s31
  s_bitcmp1_b32 s36, s24
  s_cbranch_scc0 .fz_kernel_xok1w
.fz_kernel_xok1:
  s_mov_b32 m0, s21
  s_add_u32 s21, s21, 8192
  s_and_b32 s21, s21, 0xffff
  s_add_u32 s29, s29, 1
  buffer_load_dwordx4 v40, s[8:11], s20 offen offset:0 lds
  buffer_load_dwordx4 v41, s[8:11], s20 offen offset:1024 lds
  buffer_load_dwordx4 v42, s[8:11], s20 offen offset:2048 lds
  buffer_load_dwordx4 v43, s[8:11], s20 offen offset:3072 lds
  s_setpc_b64 s[0:1]
.fz_kernel_q_iu:
  s_mov_b32 m0, s30
  s_add_u32 s30, s30, 12288
  buffer_load_dwordx4 v32, s[12:15], s33 offen offset:0 lds
  s_bfe_u32 s24, s29, 0x40001
  buffer_load_dwordx4 v33, s[12:15], s33 offen offset:1024 lds
  s_mul_i32 s20, s24, s22
  buffer_load_dwordx4 v34, s[12:15], s33 offen offset:2048 lds
  s_bitcmp1_b32 s29, 0
  s_cselect_b32 s31, s23, 0
  buffer_load_dwordx4 v35, s[12:15], s33 offen offset:3072 lds
  s_add_u32 m0, m0, 4096
  s_add_u32 s20, s20, s35
  buffer_load_dwordx4 v36, s[12:15], s33 offen offset:0 lds
  s_add_u32 s20, s20, s31
  buffer_load_dwordx4 v37, s[12:15], s33 offen offset:1024 lds
  s_bitcmp1_b32 s36, s24
  s_cbranch_scc0 .fz_kernel_xok2w
.fz_kernel_xok2:
  s_mov_b32 m0, s21
  s_add_u32 s21, s21, 8192
  s_and_b32 s21, s21, 0xffff
  s_add_u32 s29, s29, 1
  buffer_load_dwordx4 v40, s[8:11], s20 offen offset:0 lds
  s_add_u32 s33, s33, 196608
  s_cmp_eq_u32 s33, s39
  s_cselect_b32 s33, s32, s33
  buffer_load_dwordx4 v41, s[8:11], s20 offen offset:1024 lds
  s_cmp_eq_u32 s30, s26
  s_cselect_b32 s30, s25, s30
  buffer_load_dwordx4 v42, s[8:11], s20 offen offset:2048 lds
  s_sub_u32 s34, s34, 1
  s_cmp_lg_u32 s34, 0
  buffer_load_dwordx4 v43, s[8:11], s20 offen offset:3072 lds
  s_setpc_b64 s[0:1]
.fz_kernel_q_iw:
  s_mov_b32 m0, s30
  s_add_u32 s30, s30, 12288
  buffer_load_dwordx4 v32, s[12:15], s33 offen offset:0 lds
  s_nop 0
  buffer_load_dwordx4 v33, s[12:15], s33 offen offset:1024 lds
  s_nop 0
  buffer_load_dwordx4 v34, s[12:15], s33 offen offset:2048 lds
  s_nop 0
  buffer_load_dwordx4 v35, s[12:15], s33 offen offset:3072 lds
  s_add_u32 m0, m0, 4096
  s_nop 0
  buffer_load_dwordx4 v36, s[12:15], s33 offen offset:0 lds
  buffer_load_dwordx4 v37, s[12:15], s33 offen offset:1024 lds
  s_add_u32 s33, s33, 196608
  s_cmp_eq_u32 s33, s39
  s_cselect_b32 s33, s32, s33
  s_cmp_eq_u32 s30, s26
  s_cselect_b32 s30, s25, s30
  s_sub_u32 s34, s34, 1
  s_cmp_lg_u32 s34, 0
  s_setpc_b64 s[0:1]
.fz_kernel_q_st2:
  s_mov_b32 s34, 32
  s_waitcnt vmcnt(0)
  s_barrier
  s_call_b64 s[0:1], .fz_kernel_q_iw
  s_call_b64 s[0:1], .fz_kernel_q_iw
  s_call_b64 s[0:1], .fz_kernel_q_iw
  s_call_b64 s[0:1], .fz_kernel_q_iw
  s_call_b64 s[0:1], .fz_kernel_q_ix
  s_call_b64 s[0:1], .fz_kernel_q_ix
  s_mov_b64 exec, 1
  s_waitcnt vmcnt(20)
  ds_add_u32 v6, v5 offset:0x110
  s_mov_b64 exec, -1
  v_mov_b32 v12, 0x100
  s_call_b64 s[0:1], .fz_kernel_q_ix
  s_call_b64 s[0:1], .fz_kernel_q_ix
  s_waitcnt vmcnt(8)
  s_mov_b64 exec, 1
  ds_add_u32 v6, v12 offset:0x110
  s_mov_b64 exec, -1
  s_barrier
  s_waitcnt vmcnt(8)
  s_barrier
  s_call_b64 s[0:1], .fz_kernel_q_ix
  s_call_b64 s[0:1], .fz_kernel_q_iu
  s_waitcnt vmcnt(14)
  s_barrier
  s_call_b64 s[0:1], .fz_kernel_q_iu
  s_waitcnt vmcnt(20)
  s_barrier
  s_call_b64 s[0:1], .fz_kernel_q_iu
.fz_kernel_q_pl:
  s_waitcnt vmcnt(20)
  s_barrier
  s_mov_b32 m0, s30
  s_add_u32 s30, s30, 12288
  buffer_load_dwordx4 v32, s[12:15], s33 offen offset:0 lds
  s_bfe_u32 s24, s29, 0x40001
  buffer_load_dwordx4 v33, s[12:15], s33 offen offset:1024 lds
  s_mul_i32 s20, s24, s22
  buffer_load_dwordx4 v34, s[12:15], s33 offen offset:2048 lds
  s_bitcmp1_b32 s29, 0
  s_cselect_b32 s31, s23, 0
  buffer_load_dwordx4 v35, s[12:15], s33 offen offset:3072 lds
  s_add_u32 m0, m0, 4096
  s_add_u32 s20, s20, s35
  buffer_load_dwordx4 v36, s[12:15], s33 offen offset:0 lds
  s_add_u32 s20, s20, s31
  buffer_load_dwordx4 v37, s[12:15], s33 offen offset:1024 lds
  s_bitcmp1_b32 s36, s24
  s_cbranch_scc0 .fz_kernel_xok3w
.fz_kernel_xok3:
  s_mov_b32 m0, s21
  s_add_u32 s21, s21, 8192
  s_and_b32 s21, s21, 0xffff
  s_add_u32 s29, s29, 1
  buffer_load_dwordx4 v40, s[8:11], s20 offen offset:0 lds
  s_add_u32 s33, s33, 196608
  s_cmp_eq_u32 s33, s39
  s_cselect_b32 s33, s32, s33
  buffer_load_dwordx4 v41, s[8:11], s20 offen offset:1024 lds
  s_cmp_eq_u32 s30, s26
  s_cselect_b32 s30, s25, s30
  buffer_load_dwordx4 v42, s[8:11], s20 offen offset:2048 lds
  s_sub_u32 s34, s34, 1
  s_cmp_lg_u32 s34, 0
  buffer_load_dwordx4 v43, s[8:11], s20 offen offset:3072 lds
  s_cbranch_scc1 .fz_kernel_q_pl
  s_waitcnt vmcnt(20)
  s_barrier
  s_waitcnt vmcnt(10)
  s_barrier
  s_waitcnt vmcnt(0)
  s_barrier
  s_barrier
  s_branch .fz_kernel_serv
.fz_kernel_q_cons1:
  s_waitcnt lgkmcnt(0)
  s_mov_b32 s12, s42
  s_mov_b32 s13, s43
  s_mov_b32 s14, 0x600000
  s_mov_b32 s15, 0x00020000
  s_and_b32 s20, s18, 4
  s_add_u32 s20, s20, s16
  s_cmp_ge_u32 s20, 3
  s_cbranch_scc1 .fz_kernel_q_nsp
  s_and_b32 s20, s17, 7
  s_and_b32 s21, s18, 3
  s_lshl2_add_u32 s20, s20, s21
  s_mul_i32 s20, s20, 196608
  s_or_b32 s21, s18, 3
  s_lshl4_add_u32 s21, s16, s21
  s_lshl_b32 s21, s21, 7
  s_add_u32 s20, s20, s21
  v_mul_u32_u24 v20, 6144, v2
  s_mov_b32 exec_hi, 0
  buffer_load_dword v231, v20, s[12:15], s20 offen
  s_mov_b32 exec_hi, -1
.fz_kernel_q_nsp:
  v_lshlrev_b32 v20, 2, v0
  v_add_u32 v20, 159744, v20
  s_cmp_ge_u32 s16, 2
  s_cbranch_scc1 .fz_kernel_q_nz
  ds_write_b32 v20, v4
.fz_kernel_q_nz:
  s_lshr_b32 s26, s16, 1
  s_lshl_b32 s28, s26, 13
  v_and_b32 v20, 15, v2
  v_lshrrev_b32 v21, 4, v2
  v_bfe_u32 v22, v2, 1, 3
  v_xor_b32 v22, v22, v21
  v_lshlrev_b32 v20, 7, v20
  v_lshl_add_u32 v20, v22, 4, v20
  v_add_u32 v8, s28, v20
  v_xor_b32 v9, 64, v8
.fz_kernel_q_cs:
  s_and_b32 s27, s16, 1
  s_lshl_b32 s28, s27, 1
  v_lshrrev_b32 v14, 4, v2
  v_bfe_u32 v15, v2, 2, 2
  v_lshl_add_u32 v16, v14, 3, v15
  v_lshlrev_b32 v16, 7, v16
  v_and_b32 v14, 1, v14
  v_lshrrev_b32 v15, 1, v15
  v_lshl_add_u32 v14, v14, 1, v15
  v_xor_b32 v14, s28, v14
  v_lshl_add_u32 v16, v14, 5, v16
  v_and_b32 v14, 3, v2
  v_lshl_add_u32 v16, v14, 3, v16
  v_add_u32 v12, 65536, v16
  v_xor_b32 v13, 32, v12
  v_mov_b32 v10, v12
  v_mov_b32 v11, v13
  s_mov_b32 s29, 16
  s_mov_b32 s30, 0
  v_mov_b32 v128, 0
  v_mov_b32 v129, 0
  v_mov_b32 v130, 0
  v_mov_b32 v131, 0
  v_mov_b32 v132, 0
  v_mov_b32 v133, 0
  v_mov_b32 v134, 0
  v_mov_b32 v135, 0
  v_mov_b32 v136, 0
  v_mov_b32 v137, 0
  v_mov_b32 v138, 0
  v_mov_b32 v139, 0
  v_mov_b32 v140, 0
  v_mov_b32 v141, 0
  v_mov_b32 v142, 0
  v_mov_b32 v143, 0
  v_mov_b32 v144, 0
  v_mov_b32 v145, 0
  v_mov_b32 v146, 0
  v_mov_b32 v147, 0
  v_mov_b32 v148, 0
  v_mov_b32 v149, 0
  v_mov_b32 v150, 0
  v_mov_b32 v151, 0
  v_mov_b32 v152, 0
  v_mov_b32 v153, 0
  v_mov_b32 v154, 0
  v_mov_b32 v155, 0
  v_mov_b32 v156, 0
  v_mov_b32 v157, 0
  v_mov_b32 v158, 0
  v_mov_b32 v159, 0
  v_mov_b32 v160, 0
  v_mov_b32 v161, 0
  v_mov_b32 v162, 0
  v_mov_b32 v163, 0
  v_mov_b32 v164, 0
  v_mov_b32 v165, 0
  v_mov_b32 v166, 0
  v_mov_b32 v167, 0
  v_mov_b32 v168, 0
  v_mov_b32 v169, 0
  v_mov_b32 v170, 0
  v_mov_b32 v171, 0
  v_mov_b32 v172, 0
  v_mov_b32 v173, 0
  v_mov_b32 v174, 0
  v_mov_b32 v175, 0
  s_cmp_eq_u32 s62, 0
  s_cbranch_scc1 .fz_kernel_q_i1
  s_mov_b64 exec, 1
  s_waitcnt vmcnt(0)
  ds_add_u32 v1, v5 offset:0x100
  s_mov_b64 exec, -1
.fz_kernel_q_i1:
  v_mov_b32 v176, 0
  v_mov_b32 v177, 0
  v_mov_b32 v178, 0
  v_mov_b32 v179, 0
  v_mov_b32 v180, 0
  v_mov_b32 v181, 0
  v_mov_b32 v182, 0
  v_mov_b32 v183, 0
  v_mov_b32 v184, 0
  v_mov_b32 v185, 0
  v_mov_b32 v186, 0
  v_mov_b32 v187, 0
  v_mov_b32 v188, 0
  v_mov_b32 v189, 0
  v_mov_b32 v190, 0
  v_mov_b32 v191, 0
  v_mov_b32 v192, 0
  v_mov_b32 v193, 0
  v_mov_b32 v194, 0
  v_mov_b32 v195, 0
  v_mov_b32 v196, 0
  v_mov_b32 v197, 0
  v_mov_b32 v198, 0
  v_mov_b32 v199, 0
  v_mov_b32 v200, 0
  v_mov_b32 v201, 0
  v_mov_b32 v202, 0
  v_mov_b32 v203, 0
  v_mov_b32 v204, 0
  v_mov_b32 v205, 0
  v_mov_b32 v206, 0
  v_mov_b32 v207, 0
  v_mov_b32 v208, 0
  v_mov_b32 v209, 0
  v_mov_b32 v210, 0
  v_mov_b32 v211, 0
  v_mov_b32 v212, 0
  v_mov_b32 v213, 0
  v_mov_b32 v214, 0
  v_mov_b32 v215, 0
  v_mov_b32 v216, 0
  v_mov_b32 v217, 0
  v_mov_b32 v218, 0
  v_mov_b32 v219, 0
  v_mov_b32 v220, 0
  v_mov_b32 v221, 0
  v_mov_b32 v222, 0
  v_mov_b32 v223, 0
  v_and_b32 v14, 1, v2
  v_lshlrev_b32 v14, 4, v14
  v_mov_b32 v15, 0x3f80
  v_lshlrev_b32 v14, v14, v15
  v_mov_b32 v248, 0
  v_mov_b32 v249, 0
  v_mov_b32 v250, 0
  v_mov_b32 v251, 0
  v_mov_b32 v252, 0
  v_mov_b32 v253, 0
  v_mov_b32 v254, 0
  v_mov_b32 v255, 0
  s_mov_b32 exec_lo, 0x3
  s_mov_b32 exec_hi, 0x30
  v_mov_b32 v248, v14
  s_mov_b32 exec_lo, 0xc
  s_mov_b32 exec_hi, 0xc0
  v_mov_b32 v249, v14
  s_mov_b32 exec_lo, 0x300
  s_mov_b32 exec_hi, 0x3000
  v_mov_b32 v250, v14
  s_mov_b32 exec_lo, 0xc00
  s_mov_b32 exec_hi, 0xc000
  v_mov_b32 v251, v14
  s_mov_b32 exec_lo, 0x30000
  s_mov_b32 exec_hi, 0x300000
  v_mov_b32 v252, v14
  s_mov_b32 exec_lo, 0xc0000
  s_mov_b32 exec_hi, 0xc00000
  v_mov_b32 v253, v14
  s_mov_b32 exec_lo, 0x3000000
  s_mov_b32 exec_hi, 0x30000000
  v_mov_b32 v254, v14
  s_mov_b32 exec_lo, 0xc000000
  s_mov_b32 exec_hi, 0xc0000000
  v_mov_b32 v255, v14
  s_mov_b64 exec, -1
  s_lshl1_add_u32 s35, s18, s27
  s_lshl_b32 s35, s35, 5
  s_add_u32 s35, s35, s26
  s_lshl_b32 s35, s35, 13
  s_add_u32 s35, s35, s63
  s_lshl_b32 s11, s16, 8
  s_add_u32 s11, s11, 147456
  s_mov_b32 s20, 0xffff0000
  s_mov_b32 s21, 0xffff0000
  s_mov_b32 s24, 0x21800000
  s_mov_b32 s25, 0x5d800000
  s_andn2_b32 s8, 2, s16
  s_lshl2_add_u32 s8, s17, s8
  s_lshl4_add_u32 s8, s8, s18
  s_lshl1_add_u32 s8, s8, s27
  s_lshl_b32 s8, s8, 11
  s_add_u32 s8, s8, s64
  s_add_u32 s9, s8, 65536
  s_mov_b32 s73, 0
  s_mov_b32 s32, 7
  s_mov_b32 s12, s40
  s_mov_b32 s13, s41
  s_mov_b32 s14, 0x400000
  s_mov_b32 s15, 0x00020000
  v_lshrrev_b32 v14, 5, v2
  v_and_b32 v15, 31, v2
  v_lshlrev_b32 v14, 4, v14
  v_lshl_add_u32 v15, v15, 11, v14
  s_lshl2_add_u32 s23, s17, s16
  s_lshl_b32 s23, s23, 16
  s_lshl_b32 s22, s18, 7
  s_add_u32 s23, s22, s23
  s_waitcnt lgkmcnt(0)
  s_barrier
  ds_read_b64_tr_b16 v[56:57], v10 offset:4096
  ds_read_b64_tr_b16 v[58:59], v10 offset:4608
  ds_read_b128 v[32:35], v8 offset:0
  ds_read_b128 v[36:39], v8 offset:2048
  ds_read_b128 v[40:43], v8 offset:4096
  ds_read_b128 v[44:47], v8 offset:6144
  ds_read_b64_tr_b16 v[60:61], v11 offset:4096
  ds_read_b64_tr_b16 v[62:63], v11 offset:4608
  ds_read_b64_tr_b16 v[64:65], v10 offset:8192
  ds_read_b64_tr_b16 v[66:67], v10 offset:8704
  ds_read_b64_tr_b16 v[68:69], v11 offset:8192
  ds_read_b64_tr_b16 v[70:71], v11 offset:8704
  ds_read_b64_tr_b16 v[48:49], v10 offset:0
  ds_read_b64_tr_b16 v[50:51], v10 offset:512
  ds_read_b64_tr_b16 v[52:53], v11 offset:0
  ds_read_b64_tr_b16 v[54:55], v11 offset:512
  s_add_u32 s30, s30, 12288
  s_cmp_eq_u32 s30, 49152
  s_cselect_b32 s30, 0, s30
  v_add_u32 v8, 0x4000, v8
  v_add_u32 v10, s30, v12
  v_add_u32 v11, s30, v13
  v_and_b32 v8, 0xffff, v8
  s_waitcnt lgkmcnt(0)
  s_branch .fz_kernel_q_l0
  .p2align 6
.fz_kernel_q_loop:
  v_mfma_f32_16x16x32_bf16 v[148:151], v[52:55], v[36:39], v[148:151]
  v_mfma_f32_16x16x32_bf16 v[152:155], v[52:55], v[40:43], v[152:155]
  s_waitcnt lgkmcnt(0)
  v_mfma_f32_16x16x32_bf16 v[156:159], v[52:55], v[44:47], v[156:159]
  s_barrier
  v_mfma_f32_16x16x32_bf16 v[160:163], v[96:99], v[72:75], v[160:163]
  ds_read_b64_tr_b16 v[56:57], v10 offset:4096
  v_mfma_f32_16x16x32_bf16 v[164:167], v[96:99], v[76:79], v[164:167]
  ds_read_b64_tr_b16 v[58:59], v10 offset:4608
  v_mfma_f32_16x16x32_bf16 v[168:171], v[96:99], v[80:83], v[168:171]
  ds_read_b128 v[32:35], v8 offset:0
  v_mfma_f32_16x16x32_bf16 v[172:175], v[96:99], v[84:87], v[172:175]
  ds_read_b128 v[36:39], v8 offset:2048
  v_mfma_f32_16x16x32_bf16 v[176:179], v[100:103], v[72:75], v[176:179]
  ds_read_b128 v[40:43], v8 offset:4096
  v_mfma_f32_16x16x32_bf16 v[180:183], v[100:103], v[76:79], v[180:183]
  ds_read_b128 v[44:47], v8 offset:6144
  v_mfma_f32_16x16x32_bf16 v[184:187], v[100:103], v[80:83], v[184:187]
  ds_read_b64_tr_b16 v[60:61], v11 offset:4096
  v_mfma_f32_16x16x32_bf16 v[188:191], v[100:103], v[84:87], v[188:191]
  ds_read_b64_tr_b16 v[62:63], v11 offset:4608
  v_mfma_f32_16x16x32_bf16 v[192:195], v[72:75], v[104:107], v[192:195]
  ds_read_b64_tr_b16 v[64:65], v10 offset:8192
  s_add_u32 s30, s30, 12288
  v_mfma_f32_16x16x32_bf16 v[196:199], v[76:79], v[104:107], v[196:199]
  ds_read_b64_tr_b16 v[66:67], v10 offset:8704
  s_cmp_eq_u32 s30, 49152
  v_mfma_f32_16x16x32_bf16 v[200:203], v[80:83], v[104:107], v[200:203]
  ds_read_b64_tr_b16 v[68:69], v11 offset:8192
  s_cselect_b32 s30, 0, s30
  v_mfma_f32_16x16x32_bf16 v[204:207], v[84:87], v[104:107], v[204:207]
  ds_read_b64_tr_b16 v[70:71], v11 offset:8704
  v_mfma_f32_16x16x32_bf16 v[208:211], v[72:75], v[108:111], v[208:211]
  ds_read_b64_tr_b16 v[48:49], v10 offset:0
  v_mfma_f32_16x16x32_bf16 v[212:215], v[76:79], v[108:111], v[212:215]
  ds_read_b64_tr_b16 v[50:51], v10 offset:512
  v_mfma_f32_16x16x32_bf16 v[216:219], v[80:83], v[108:111], v[216:219]
  ds_read_b64_tr_b16 v[52:53], v11 offset:0
  v_mfma_f32_16x16x32_bf16 v[220:223], v[84:87], v[108:111], v[220:223]
  ds_read_b64_tr_b16 v[54:55], v11 offset:512
  v_mfma_f32_16x16x32_bf16 v[128:131], v[88:91], v[72:75], v[128:131]
  v_add_u32 v8, 0x4000, v8
  v_mfma_f32_16x16x32_bf16 v[132:135], v[88:91], v[76:79], v[132:135]
  v_add_u32 v10, s30, v12
  v_mfma_f32_16x16x32_bf16 v[136:139], v[88:91], v[80:83], v[136:139]
  v_add_u32 v11, s30, v13
  v_mfma_f32_16x16x32_bf16 v[140:143], v[88:91], v[84:87], v[140:143]
  v_and_b32 v8, 0xffff, v8
  v_mfma_f32_16x16x32_bf16 v[144:147], v[92:95], v[72:75], v[144:147]
  v_mfma_f32_16x16x32_bf16 v[148:151], v[92:95], v[76:79], v[148:151]
  v_mfma_f32_16x16x32_bf16 v[152:155], v[92:95], v[80:83], v[152:155]
  s_waitcnt lgkmcnt(0)
  v_mfma_f32_16x16x32_bf16 v[156:159], v[92:95], v[84:87], v[156:159]
.fz_kernel_q_l0:
  s_barrier
  v_mfma_f32_16x16x32_bf16 v[160:163], v[56:59], v[32:35], v[160:163]
  ds_read_b64_tr_b16 v[96:97], v10 offset:4096
  v_mfma_f32_16x16x32_bf16 v[164:167], v[56:59], v[36:39], v[164:167]
  ds_read_b64_tr_b16 v[98:99], v10 offset:4608
  v_mfma_f32_16x16x32_bf16 v[168:171], v[56:59], v[40:43], v[168:171]
  ds_read_b128 v[72:75], v9 offset:0
  v_mfma_f32_16x16x32_bf16 v[172:175], v[56:59], v[44:47], v[172:175]
  ds_read_b128 v[76:79], v9 offset:2048
  v_mfma_f32_16x16x32_bf16 v[176:179], v[60:63], v[32:35], v[176:179]
  ds_read_b128 v[80:83], v9 offset:4096
  v_mfma_f32_16x16x32_bf16 v[180:183], v[60:63], v[36:39], v[180:183]
  ds_read_b128 v[84:87], v9 offset:6144
  v_mfma_f32_16x16x32_bf16 v[184:187], v[60:63], v[40:43], v[184:187]
  ds_read_b64_tr_b16 v[100:101], v11 offset:4096
  v_mfma_f32_16x16x32_bf16 v[188:191], v[60:63], v[44:47], v[188:191]
  ds_read_b64_tr_b16 v[102:103], v11 offset:4608
  v_mfma_f32_16x16x32_bf16 v[192:195], v[32:35], v[64:67], v[192:195]
  ds_read_b64_tr_b16 v[104:105], v10 offset:8192
  s_add_u32 s30, s30, 12288
  v_mfma_f32_16x16x32_bf16 v[196:199], v[36:39], v[64:67], v[196:199]
  ds_read_b64_tr_b16 v[106:107], v10 offset:8704
  s_cmp_eq_u32 s30, 49152
  v_mfma_f32_16x16x32_bf16 v[200:203], v[40:43], v[64:67], v[200:203]
  ds_read_b64_tr_b16 v[108:109], v11 offset:8192
  s_cselect_b32 s30, 0, s30
  v_mfma_f32_16x16x32_bf16 v[204:207], v[44:47], v[64:67], v[204:207]
  ds_read_b64_tr_b16 v[110:111], v11 offset:8704
  s_sub_u32 s29, s29, 1
  v_mfma_f32_16x16x32_bf16 v[208:211], v[32:35], v[68:71], v[208:211]
  ds_read_b64_tr_b16 v[88:89], v10 offset:0
  s_cmp_lg_u32 s29, 0
  v_mfma_f32_16x16x32_bf16 v[212:215], v[36:39], v[68:71], v[212:215]
  ds_read_b64_tr_b16 v[90:91], v10 offset:512
  v_mfma_f32_16x16x32_bf16 v[216:219], v[40:43], v[68:71], v[216:219]
  ds_read_b64_tr_b16 v[92:93], v11 offset:0
  v_mfma_f32_16x16x32_bf16 v[220:223], v[44:47], v[68:71], v[220:223]
  ds_read_b64_tr_b16 v[94:95], v11 offset:512
  v_mfma_f32_16x16x32_bf16 v[128:131], v[48:51], v[32:35], v[128:131]
  v_add_u32 v9, 0x4000, v9
  v_mfma_f32_16x16x32_bf16 v[132:135], v[48:51], v[36:39], v[132:135]
  v_add_u32 v10, s30, v12
  v_mfma_f32_16x16x32_bf16 v[136:139], v[48:51], v[40:43], v[136:139]
  v_add_u32 v11, s30, v13
  v_mfma_f32_16x16x32_bf16 v[140:143], v[48:51], v[44:47], v[140:143]
  v_and_b32 v9, 0xffff, v9
  v_mfma_f32_16x16x32_bf16 v[144:147], v[52:55], v[32:35], v[144:147]
  s_cbranch_scc1 .fz_kernel_q_loop
  v_mfma_f32_16x16x32_bf16 v[148:151], v[52:55], v[36:39], v[148:151]
  v_mfma_f32_16x16x32_bf16 v[152:155], v[52:55], v[40:43], v[152:155]
  s_waitcnt lgkmcnt(0)
  v_mfma_f32_16x16x32_bf16 v[156:159], v[52:55], v[44:47], v[156:159]
  s_cmp_lg_u32 s62, 0
  s_cbranch_scc1 .fz_kernel_q_nr
  buffer_load_dwordx4 v[232:235], v15, s[12:15], s23 offen offset:0
  buffer_load_dwordx4 v[236:239], v15, s[12:15], s23 offen offset:32
  buffer_load_dwordx4 v[240:243], v15, s[12:15], s23 offen offset:64
  buffer_load_dwordx4 v[244:247], v15, s[12:15], s23 offen offset:96
.fz_kernel_q_nr:
  s_barrier
  v_mfma_f32_16x16x32_bf16 v[160:163], v[96:99], v[72:75], v[160:163]
  s_lshl_b32 s31, s26, 8
  s_add_u32 s31, s31, 155648
  v_and_b32 v22, 15, v2
  v_and_b32 v23, 48, v2
  v_mfma_f32_16x16x32_bf16 v[164:167], v[96:99], v[76:79], v[164:167]
  s_lshl_b32 s33, s27, 7
  s_add_u32 s33, s33, 155648
  v_lshlrev_b32 v22, 2, v22
  v_mov_b32 v1, 159952
  v_mfma_f32_16x16x32_bf16 v[168:171], v[96:99], v[80:83], v[168:171]
  v_add_u32 v29, s33, v22
  v_add_u32 v22, s31, v22
  v_mfma_f32_16x16x32_bf16 v[172:175], v[96:99], v[84:87], v[172:175]
  v_add_u32 v28, s33, v23
  v_add_u32 v23, s31, v23
  v_mfma_f32_16x16x32_bf16 v[176:179], v[100:103], v[72:75], v[176:179]
  ds_read_b32 v1, v1
  v_add_u32 v64, 4608, v22
  v_mfma_f32_16x16x32_bf16 v[180:183], v[100:103], v[76:79], v[180:183]
  ds_read_b128 v[120:123], v28 offset:5888
  v_and_b32 v12, 1, v2
  v_mfma_f32_16x16x32_bf16 v[184:187], v[100:103], v[80:83], v[184:187]
  ds_read_b128 v[124:127], v28 offset:5952
  v_add_u32 v12, -1, v12
  v_mfma_f32_16x16x32_bf16 v[188:191], v[100:103], v[84:87], v[188:191]
  ds_read2_b32 v[224:225], v64 offset0:0 offset1:128
  v_and_b32 v12, 0x3f803f80, v12
  v_mfma_f32_16x16x32_bf16 v[192:195], v[72:75], v[104:107], v[192:195]
  ds_read2_b32 v[226:227], v64 offset0:16 offset1:144
  v_and_b32 v11, 2, v2
  v_mfma_f32_16x16x32_bf16 v[196:199], v[76:79], v[104:107], v[196:199]
  ds_read2_b32 v[228:229], v64 offset0:32 offset1:160
  v_xor_b32 v14, 0x3f803f80, v12
  v_mfma_f32_16x16x32_bf16 v[200:203], v[80:83], v[104:107], v[200:203]
  ds_read2_b32 v[230:231], v64 offset0:48 offset1:176
  v_mul_u32_u24 v11, 0x5555, v11
  v_mfma_f32_16x16x32_bf16 v[204:207], v[84:87], v[104:107], v[204:207]
  ds_read_b32 v24, v29 offset:6144
  v_mov_b32 v13, v12
  v_mfma_f32_16x16x32_bf16 v[208:211], v[72:75], v[108:111], v[208:211]
  ds_read_b32 v26, v29 offset:6208
  v_mov_b32 v15, v14
  v_mfma_f32_16x16x32_bf16 v[212:215], v[76:79], v[108:111], v[212:215]
  ds_read_b128 v[32:35], v23 offset:4608
  ds_read_b128 v[48:51], v23 offset:5120
  v_mfma_f32_16x16x32_bf16 v[216:219], v[80:83], v[108:111], v[216:219]
  ds_read_b128 v[36:39], v23 offset:4672
  ds_read_b128 v[52:55], v23 offset:5184
  v_mfma_f32_16x16x32_bf16 v[220:223], v[84:87], v[108:111], v[220:223]
  ds_read_b128 v[40:43], v23 offset:4736
  ds_read_b128 v[56:59], v23 offset:5248
  v_mfma_f32_16x16x32_bf16 v[128:131], v[88:91], v[72:75], v[128:131]
  ds_read_b128 v[44:47], v23 offset:4800
  ds_read_b128 v[60:63], v23 offset:5312
  v_mfma_f32_16x16x32_bf16 v[132:135], v[88:91], v[76:79], v[132:135]
  ds_read_b128 v[112:115], v28 offset:5632
  ds_read_b128 v[116:119], v28 offset:5696
  v_mfma_f32_16x16x32_bf16 v[136:139], v[88:91], v[80:83], v[136:139]
  s_lshl1_add_u32 s34, s18, s27
  s_lshl4_add_u32 s34, s34, s17
  s_lshl1_add_u32 s34, s34, s26
  v_mfma_f32_16x16x32_bf16 v[140:143], v[88:91], v[84:87], v[140:143]
  s_lshl_b32 s36, s34, 13
  s_add_u32 s36, s36, s63
  s_add_u32 s37, s36, 4096
  v_mfma_f32_16x16x32_bf16 v[144:147], v[92:95], v[72:75], v[144:147]
  s_lshl_b32 s34, s16, 12
  s_add_u32 s34, s34, 131072
  v_add_u32 v9, s34, v3
  v_mfma_f32_16x16x32_bf16 v[148:151], v[92:95], v[76:79], v[148:151]
  v_xor_b32 v8, 8192, v9
  v_mfma_f32_16x16x32_bf16 v[152:155], v[92:95], v[80:83], v[152:155]
  v_add_u32 v11, 0x4444, v11
  v_mfma_f32_16x16x32_bf16 v[156:159], v[92:95], v[84:87], v[156:159]
  v_add_u32 v10, 4096, v3
  s_waitcnt lgkmcnt(12)
  v_add_u32 v1, -1, v1
  v_lshrrev_b32 v1, 6, v1
  v_cmp_eq_u32 vcc, s26, v1
  s_cbranch_vccnz .fz_kernel_q_patch
.fz_kernel_q_pback:
  v_pk_mul_f32 v[64:65], v[120:121], v[224:225] op_sel:[0,1] op_sel_hi:[1,1]
  v_pk_fma_f32 v[160:161], v[160:161], v[224:225], v[64:65] op_sel_hi:[1,0,1]
  v_pk_mul_f32 v[66:67], v[122:123], v[224:225] op_sel:[0,1] op_sel_hi:[1,1]
  v_pk_fma_f32 v[162:163], v[162:163], v[224:225], v[66:67] op_sel_hi:[1,0,1]
  v_pk_mul_f32 v[68:69], v[124:125], v[224:225] op_sel:[0,1] op_sel_hi:[1,1]
  v_pk_fma_f32 v[176:177], v[176:177], v[224:225], v[68:69] op_sel_hi:[1,0,1]
  v_pk_mul_f32 v[70:71], v[126:127], v[224:225] op_sel:[0,1] op_sel_hi:[1,1]
  v_pk_fma_f32 v[178:179], v[178:179], v[224:225], v[70:71] op_sel_hi:[1,0,1]
  v_cvt_pk_bf16_f32 v80, v160, v161
  v_cvt_pk_bf16_f32 v81, v162, v163
  v_cvt_pk_bf16_f32 v82, v176, v177
  v_cvt_pk_bf16_f32 v83, v178, v179
  v_pk_mul_f32 v[64:65], v[120:121], v[226:227] op_sel:[0,1] op_sel_hi:[1,1]
  v_pk_fma_f32 v[164:165], v[164:165], v[226:227], v[64:65] op_sel_hi:[1,0,1]
  v_pk_mul_f32 v[66:67], v[122:123], v[226:227] op_sel:[0,1] op_sel_hi:[1,1]
  v_pk_fma_f32 v[166:167], v[166:167], v[226:227], v[66:67] op_sel_hi:[1,0,1]
  v_pk_mul_f32 v[68:69], v[124:125], v[226:227] op_sel:[0,1] op_sel_hi:[1,1]
  v_pk_fma_f32 v[180:181], v[180:181], v[226:227], v[68:69] op_sel_hi:[1,0,1]
  v_pk_mul_f32 v[70:71], v[126:127], v[226:227] op_sel:[0,1] op_sel_hi:[1,1]
  v_pk_fma_f32 v[182:183], v[182:183], v[226:227], v[70:71] op_sel_hi:[1,0,1]
  v_cvt_pk_bf16_f32 v84, v164, v165
  v_cvt_pk_bf16_f32 v85, v166, v167
  v_cvt_pk_bf16_f32 v86, v180, v181
  v_cvt_pk_bf16_f32 v87, v182, v183
  v_permlane16_swap_b32 v80, v84
  v_permlane16_swap_b32 v81, v85
  v_permlane16_swap_b32 v82, v86
  v_permlane16_swap_b32 v83, v87
  buffer_store_dwordx4 v[80:83], v3, s[4:7], s36 offen offset:0 sc1
  buffer_store_dwordx4 v[84:87], v3, s[4:7], s36 offen offset:1024 sc1
  v_pk_mul_f32 v[64:65], v[120:121], v[228:229] op_sel:[0,1] op_sel_hi:[1,1]
  v_pk_fma_f32 v[168:169], v[168:169], v[228:229], v[64:65] op_sel_hi:[1,0,1]
  v_pk_mul_f32 v[66:67], v[122:123], v[228:229] op_sel:[0,1] op_sel_hi:[1,1]
  v_pk_fma_f32 v[170:171], v[170:171], v[228:229], v[66:67] op_sel_hi:[1,0,1]
  v_pk_mul_f32 v[68:69], v[124:125], v[228:229] op_sel:[0,1] op_sel_hi:[1,1]
  v_pk_fma_f32 v[184:185], v[184:185], v[228:229], v[68:69] op_sel_hi:[1,0,1]
  v_pk_mul_f32 v[70:71], v[126:127], v[228:229] op_sel:[0,1] op_sel_hi:[1,1]
  v_pk_fma_f32 v[186:187], v[186:187], v[228:229], v[70:71] op_sel_hi:[1,0,1]
  v_cvt_pk_bf16_f32 v96, v168, v169
  v_cvt_pk_bf16_f32 v97, v170, v171
  v_cvt_pk_bf16_f32 v98, v184, v185
  v_cvt_pk_bf16_f32 v99, v186, v187
  v_pk_mul_f32 v[64:65], v[120:121], v[230:231] op_sel:[0,1] op_sel_hi:[1,1]
  v_pk_fma_f32 v[172:173], v[172:173], v[230:231], v[64:65] op_sel_hi:[1,0,1]
  v_pk_mul_f32 v[66:67], v[122:123], v[230:231] op_sel:[0,1] op_sel_hi:[1,1]
  v_pk_fma_f32 v[174:175], v[174:175], v[230:231], v[66:67] op_sel_hi:[1,0,1]
  v_pk_mul_f32 v[68:69], v[124:125], v[230:231] op_sel:[0,1] op_sel_hi:[1,1]
  v_pk_fma_f32 v[188:189], v[188:189], v[230:231], v[68:69] op_sel_hi:[1,0,1]
  v_pk_mul_f32 v[70:71], v[126:127], v[230:231] op_sel:[0,1] op_sel_hi:[1,1]
  v_pk_fma_f32 v[190:191], v[190:191], v[230:231], v[70:71] op_sel_hi:[1,0,1]
  v_cvt_pk_bf16_f32 v100, v172, v173
  v_cvt_pk_bf16_f32 v101, v174, v175
  v_cvt_pk_bf16_f32 v102, v188, v189
  v_cvt_pk_bf16_f32 v103, v190, v191
  v_permlane16_swap_b32 v96, v100
  v_permlane16_swap_b32 v97, v101
  v_permlane16_swap_b32 v98, v102
  v_permlane16_swap_b32 v99, v103
  buffer_store_dwordx4 v[96:99], v3, s[4:7], s37 offen offset:0 sc1
  buffer_store_dwordx4 v[100:103], v3, s[4:7], s37 offen offset:1024 sc1
  s_waitcnt lgkmcnt(0)
  v_pk_mul_f32 v[64:65], v[48:49], v[24:25] op_sel_hi:[1,0]
  v_pk_fma_f32 v[192:193], v[192:193], v[32:33], v[64:65]
  v_pk_mul_f32 v[66:67], v[50:51], v[24:25] op_sel_hi:[1,0]
  v_pk_fma_f32 v[194:195], v[194:195], v[34:35], v[66:67]
  v_pk_mul_f32 v[68:69], v[48:49], v[26:27] op_sel_hi:[1,0]
  v_pk_fma_f32 v[208:209], v[208:209], v[32:33], v[68:69]
  v_pk_mul_f32 v[70:71], v[50:51], v[26:27] op_sel_hi:[1,0]
  v_pk_fma_f32 v[210:211], v[210:211], v[34:35], v[70:71]
  v_cvt_pk_bf16_f32 v88, v192, v193
  v_cvt_pk_bf16_f32 v90, v208, v209
  v_cvt_pk_bf16_f32 v89, v194, v195
  v_cvt_pk_bf16_f32 v91, v210, v211
  v_pk_mul_f32 v[64:65], v[52:53], v[24:25] op_sel_hi:[1,0]
  v_pk_fma_f32 v[196:197], v[196:197], v[36:37], v[64:65]
  v_pk_mul_f32 v[66:67], v[54:55], v[24:25] op_sel_hi:[1,0]
  v_pk_fma_f32 v[198:199], v[198:199], v[38:39], v[66:67]
  v_pk_mul_f32 v[68:69], v[52:53], v[26:27] op_sel_hi:[1,0]
  v_pk_fma_f32 v[212:213], v[212:213], v[36:37], v[68:69]
  v_pk_mul_f32 v[70:71], v[54:55], v[26:27] op_sel_hi:[1,0]
  v_pk_fma_f32 v[214:215], v[214:215], v[38:39], v[70:71]
  v_cvt_pk_bf16_f32 v92, v196, v197
  v_cvt_pk_bf16_f32 v94, v212, v213
  v_cvt_pk_bf16_f32 v93, v198, v199
  v_cvt_pk_bf16_f32 v95, v214, v215
  v_permlane16_swap_b32 v88, v90
  v_permlane16_swap_b32 v89, v91
  v_permlane16_swap_b32 v92, v94
  v_permlane16_swap_b32 v93, v95
  v_permlane32_swap_b32 v88, v90
  v_permlane32_swap_b32 v89, v91
  v_permlane32_swap_b32 v92, v94
  v_permlane32_swap_b32 v93, v95
  buffer_store_dwordx4 v[88:91], v3, s[4:7], s36 offen offset:2048 sc1
  buffer_store_dwordx4 v[92:95], v3, s[4:7], s36 offen offset:3072 sc1
  v_pk_mul_f32 v[64:65], v[56:57], v[24:25] op_sel_hi:[1,0]
  v_pk_fma_f32 v[200:201], v[200:201], v[40:41], v[64:65]
  v_pk_mul_f32 v[66:67], v[58:59], v[24:25] op_sel_hi:[1,0]
  v_pk_fma_f32 v[202:203], v[202:203], v[42:43], v[66:67]
  v_pk_mul_f32 v[68:69], v[56:57], v[26:27] op_sel_hi:[1,0]
  v_pk_fma_f32 v[216:217], v[216:217], v[40:41], v[68:69]
  v_pk_mul_f32 v[70:71], v[58:59], v[26:27] op_sel_hi:[1,0]
  v_pk_fma_f32 v[218:219], v[218:219], v[42:43], v[70:71]
  v_cvt_pk_bf16_f32 v104, v200, v201
  v_cvt_pk_bf16_f32 v106, v216, v217
  v_cvt_pk_bf16_f32 v105, v202, v203
  v_cvt_pk_bf16_f32 v107, v218, v219
  v_pk_mul_f32 v[64:65], v[60:61], v[24:25] op_sel_hi:[1,0]
  v_pk_fma_f32 v[204:205], v[204:205], v[44:45], v[64:65]
  v_pk_mul_f32 v[66:67], v[62:63], v[24:25] op_sel_hi:[1,0]
  v_pk_fma_f32 v[206:207], v[206:207], v[46:47], v[66:67]
  v_pk_mul_f32 v[68:69], v[60:61], v[26:27] op_sel_hi:[1,0]
  v_pk_fma_f32 v[220:221], v[220:221], v[44:45], v[68:69]
  v_pk_mul_f32 v[70:71], v[62:63], v[26:27] op_sel_hi:[1,0]
  v_pk_fma_f32 v[222:223], v[222:223], v[46:47], v[70:71]
  v_cvt_pk_bf16_f32 v108, v204, v205
  v_cvt_pk_bf16_f32 v110, v220, v221
  v_cvt_pk_bf16_f32 v109, v206, v207
  v_cvt_pk_bf16_f32 v111, v222, v223
  v_permlane16_swap_b32 v104, v106
  v_permlane16_swap_b32 v105, v107
  v_permlane16_swap_b32 v108, v110
  v_permlane16_swap_b32 v109, v111
  v_permlane32_swap_b32 v104, v106
  v_permlane32_swap_b32 v105, v107
  v_permlane32_swap_b32 v108, v110
  v_permlane32_swap_b32 v109, v111
  buffer_store_dwordx4 v[104:107], v3, s[4:7], s37 offen offset:2048 sc1
  buffer_store_dwordx4 v[108:111], v3, s[4:7], s37 offen offset:3072 sc1
  v_mul_f32 v224, 0.25503486164919736, v224
  v_mul_f32 v225, 0.25503486164919736, v225
  v_mul_f32 v226, 0.25503486164919736, v226
  v_mul_f32 v227, 0.25503486164919736, v227
  v_mul_f32 v228, 0.25503486164919736, v228
  v_mul_f32 v229, 0.25503486164919736, v229
  v_mul_f32 v230, 0.25503486164919736, v230
  v_mul_f32 v231, 0.25503486164919736, v231
  v_pk_mul_f32 v[64:65], v[112:113], v[224:225] op_sel:[0,1] op_sel_hi:[1,1]
  v_pk_fma_f32 v[128:129], v[128:129], v[224:225], v[64:65] op_sel_hi:[1,0,1]
  v_pk_mul_f32 v[66:67], v[114:115], v[224:225] op_sel:[0,1] op_sel_hi:[1,1]
  v_pk_fma_f32 v[130:131], v[130:131], v[224:225], v[66:67] op_sel_hi:[1,0,1]
  v_pk_mul_f32 v[68:69], v[116:117], v[224:225] op_sel:[0,1] op_sel_hi:[1,1]
  v_pk_fma_f32 v[144:145], v[144:145], v[224:225], v[68:69] op_sel_hi:[1,0,1]
  v_pk_mul_f32 v[70:71], v[118:119], v[224:225] op_sel:[0,1] op_sel_hi:[1,1]
  v_pk_fma_f32 v[146:147], v[146:147], v[224:225], v[70:71] op_sel_hi:[1,0,1]
  v_cvt_pk_bf16_f32 v16, v128, v129
  v_cvt_pk_bf16_f32 v17, v130, v131
  v_cvt_pk_bf16_f32 v18, v144, v145
  v_cvt_pk_bf16_f32 v19, v146, v147
  v_pk_mul_f32 v[64:65], v[112:113], v[226:227] op_sel:[0,1] op_sel_hi:[1,1]
  v_pk_fma_f32 v[132:133], v[132:133], v[226:227], v[64:65] op_sel_hi:[1,0,1]
  v_pk_mul_f32 v[66:67], v[114:115], v[226:227] op_sel:[0,1] op_sel_hi:[1,1]
  v_pk_fma_f32 v[134:135], v[134:135], v[226:227], v[66:67] op_sel_hi:[1,0,1]
  v_pk_mul_f32 v[68:69], v[116:117], v[226:227] op_sel:[0,1] op_sel_hi:[1,1]
  v_pk_fma_f32 v[148:149], v[148:149], v[226:227], v[68:69] op_sel_hi:[1,0,1]
  v_pk_mul_f32 v[70:71], v[118:119], v[226:227] op_sel:[0,1] op_sel_hi:[1,1]
  v_pk_fma_f32 v[150:151], v[150:151], v[226:227], v[70:71] op_sel_hi:[1,0,1]
  v_cvt_pk_bf16_f32 v20, v132, v133
  v_cvt_pk_bf16_f32 v21, v134, v135
  v_cvt_pk_bf16_f32 v22, v148, v149
  v_cvt_pk_bf16_f32 v23, v150, v151
  v_permlane16_swap_b32 v16, v20
  v_permlane16_swap_b32 v17, v21
  v_permlane16_swap_b32 v18, v22
  v_permlane16_swap_b32 v19, v23
  ds_write_b128 v8, v[16:19] offset:0
  ds_write_b128 v8, v[20:23] offset:1024
  v_pk_mul_f32 v[64:65], v[112:113], v[228:229] op_sel:[0,1] op_sel_hi:[1,1]
  v_pk_fma_f32 v[136:137], v[136:137], v[228:229], v[64:65] op_sel_hi:[1,0,1]
  v_pk_mul_f32 v[66:67], v[114:115], v[228:229] op_sel:[0,1] op_sel_hi:[1,1]
  v_pk_fma_f32 v[138:139], v[138:139], v[228:229], v[66:67] op_sel_hi:[1,0,1]
  v_pk_mul_f32 v[68:69], v[116:117], v[228:229] op_sel:[0,1] op_sel_hi:[1,1]
  v_pk_fma_f32 v[152:153], v[152:153], v[228:229], v[68:69] op_sel_hi:[1,0,1]
  v_pk_mul_f32 v[70:71], v[118:119], v[228:229] op_sel:[0,1] op_sel_hi:[1,1]
  v_pk_fma_f32 v[154:155], v[154:155], v[228:229], v[70:71] op_sel_hi:[1,0,1]
  v_cvt_pk_bf16_f32 v24, v136, v137
  v_cvt_pk_bf16_f32 v25, v138, v139
  v_cvt_pk_bf16_f32 v26, v152, v153
  v_cvt_pk_bf16_f32 v27, v154, v155
  v_pk_mul_f32 v[64:65], v[112:113], v[230:231] op_sel:[0,1] op_sel_hi:[1,1]
  v_pk_fma_f32 v[140:141], v[140:141], v[230:231], v[64:65] op_sel_hi:[1,0,1]
  v_pk_mul_f32 v[66:67], v[114:115], v[230:231] op_sel:[0,1] op_sel_hi:[1,1]
  v_pk_fma_f32 v[142:143], v[142:143], v[230:231], v[66:67] op_sel_hi:[1,0,1]
  v_pk_mul_f32 v[68:69], v[116:117], v[230:231] op_sel:[0,1] op_sel_hi:[1,1]
  v_pk_fma_f32 v[156:157], v[156:157], v[230:231], v[68:69] op_sel_hi:[1,0,1]
  v_pk_mul_f32 v[70:71], v[118:119], v[230:231] op_sel:[0,1] op_sel_hi:[1,1]
  v_pk_fma_f32 v[158:159], v[158:159], v[230:231], v[70:71] op_sel_hi:[1,0,1]
  v_cvt_pk_bf16_f32 v28, v140, v141
  v_cvt_pk_bf16_f32 v29, v142, v143
  v_cvt_pk_bf16_f32 v30, v156, v157
  v_cvt_pk_bf16_f32 v31, v158, v159
  v_permlane16_swap_b32 v24, v28
  v_permlane16_swap_b32 v25, v29
  v_permlane16_swap_b32 v26, v30
  v_permlane16_swap_b32 v27, v31
  ds_write_b128 v8, v[24:27] offset:2048
  ds_write_b128 v8, v[28:31] offset:3072
  s_branch .fz_kernel_att
.fz_kernel_q_help1:
  s_waitcnt lgkmcnt(0)
  s_mov_b32 s3, 32
  s_cmp_eq_u32 s16, 7
  s_cbranch_scc1 .fz_kernel_q_h7
  s_getpc_b64 s[0:1]
.fz_kernel_ct4:
  s_sub_u32 s0, s0, .fz_kernel_ct4-fz_kernel
  s_subb_u32 s1, s1, 0
  s_lshr_b32 s31, s2, 3
  s_mulk_i32 s31, 0x500
  v_lshl_add_u32 v1, v2, 7, s31
  v_min_u32 v1, .fz_kernel_last-fz_kernel, v1
  s_mov_b64 exec, 0x3ff
  global_load_dword v1, v1, s[0:1]
  s_mov_b64 exec, -1
.fz_kernel_ct4e:
  s_mov_b32 s12, s58
  s_mov_b32 s13, s59
  s_mov_b32 s14, 0x100
  s_mov_b32 s15, 0x00020000
  s_mov_b32 s30, 0
  s_and_b32 s31, s18, 3
  s_sub_u32 s31, s31, s30
  s_and_b32 s30, s31, 3
  s_lshl_b32 s30, s30, 14
  v_and_b32 v20, 15, v2
  v_lshrrev_b32 v21, 4, v2
  v_bfe_u32 v22, v2, 1, 3
  v_xor_b32 v22, v22, v21
  v_lshlrev_b32 v21, 7, v20
  v_lshl_add_u32 v21, v22, 4, v21
  v_add_u32 v21, s30, v21
  v_xor_b32 v22, 64, v21
  v_lshlrev_b32 v20, 3, v20
  s_lshl_b32 s30, s17, 10
  s_add_u32 s30, s30, 0x1808000
  s_mov_b32 exec_lo, 0x00f0000f
  s_mov_b32 exec_hi, 0xf0000f00
  v_add_u32 v20, 4, v20
  s_mov_b64 exec, -1
  v_mov_b32 v24, 0x3f803f80
  v_mov_b32 v25, v24
  v_mov_b32 v26, v24
  v_mov_b32 v27, v24
  s_lshl_b32 s31, s31, 1
  s_sub_u32 s31, 31, s31
  v_lshlrev_b32 v52, 3, v2
  v_add_u32 v52, 155648, v52
  v_mov_b32 v54, 1.0
  v_mov_b32 v55, 1.0
  v_mov_b32 v56, 0
  v_mov_b32 v57, 0
  ds_write_b64 v52, v[54:55] offset:6400
  ds_write_b64 v52, v[56:57] offset:6912
  s_mov_b32 s20, s48
  s_mov_b32 s21, s49
  s_mov_b32 s22, 0x800
  s_mov_b32 s23, 0x00020000
  v_lshlrev_b32 v40, 5, v2
  buffer_load_dwordx4 v[44:47], v40, s[20:23], 0 offen
  buffer_load_dwordx4 v[48:51], v40, s[20:23], 0 offen offset:16
  v_mov_b32 v40, 0
  s_waitcnt vmcnt(0)
  v_lshlrev_b32 v41, 16, v44
  v_and_b32 v42, 0xffff0000, v44
  v_add_f32 v40, v40, v41
  v_add_f32 v40, v40, v42
  v_lshlrev_b32 v41, 16, v45
  v_and_b32 v42, 0xffff0000, v45
  v_add_f32 v40, v40, v41
  v_add_f32 v40, v40, v42
  v_lshlrev_b32 v41, 16, v46
  v_and_b32 v42, 0xffff0000, v46
  v_add_f32 v40, v40, v41
  v_add_f32 v40, v40, v42
  v_lshlrev_b32 v41, 16, v47
  v_and_b32 v42, 0xffff0000, v47
  v_add_f32 v40, v40, v41
  v_add_f32 v40, v40, v42
  v_lshlrev_b32 v41, 16, v48
  v_and_b32 v42, 0xffff0000, v48
  v_add_f32 v40, v40, v41
  v_add_f32 v40, v40, v42
  v_lshlrev_b32 v41, 16, v49
  v_and_b32 v42, 0xffff0000, v49
  v_add_f32 v40, v40, v41
  v_add_f32 v40, v40, v42
  v_lshlrev_b32 v41, 16, v50
  v_and_b32 v42, 0xffff0000, v50
  v_add_f32 v40, v40, v41
  v_add_f32 v40, v40, v42
  v_lshlrev_b32 v41, 16, v51
  v_and_b32 v42, 0xffff0000, v51
  v_add_f32 v40, v40, v41
  v_add_f32 v40, v40, v42
  s_nop 1
  v_add_f32 v40, v40, v40 quad_perm:[1,0,3,2] row_mask:0xf bank_mask:0xf
  s_nop 1
  v_add_f32 v40, v40, v40 quad_perm:[2,3,0,1] row_mask:0xf bank_mask:0xf
  s_nop 1
  v_add_f32 v40, v40, v40 row_half_mirror row_mask:0xf bank_mask:0xf
  s_nop 1
  v_add_f32 v40, v40, v40 row_mirror row_mask:0xf bank_mask:0xf
  s_nop 0
  v_readlane_b32 s20, v40, 16
  v_readlane_b32 s21, v40, 32
  v_readlane_b32 s22, v40, 48
  v_add_f32 v40, s20, v40
  v_add_f32 v40, s21, v40
  v_add_f32 v40, s22, v40
  v_mul_f32 v40, 0x3a800000, v40
  s_nop 0
  v_readfirstlane_b32 s76, v40
.fz_kernel_xs5:
  s_barrier
  s_sub_u32 s3, s3, 1
  s_cmp_lg_u32 s3, s31
  s_cbranch_scc1 .fz_kernel_xs5
  ds_read_b128 v[64:67], v21 offset:0
  ds_read_b128 v[72:75], v21 offset:2048
  ds_read_b128 v[80:83], v21 offset:4096
  ds_read_b128 v[88:91], v21 offset:6144
  ds_read_b128 v[96:99], v21 offset:8192
  ds_read_b128 v[104:107], v21 offset:10240
  ds_read_b128 v[112:115], v21 offset:12288
  ds_read_b128 v[120:123], v21 offset:14336
  ds_read_b128 v[68:71], v22 offset:0
  ds_read_b128 v[76:79], v22 offset:2048
  ds_read_b128 v[84:87], v22 offset:4096
  ds_read_b128 v[92:95], v22 offset:6144
  ds_read_b128 v[100:103], v22 offset:8192
  ds_read_b128 v[108:111], v22 offset:10240
  ds_read_b128 v[116:119], v22 offset:12288
  ds_read_b128 v[124:127], v22 offset:14336
  s_waitcnt lgkmcnt(0)
  s_cmp_eq_u32 s3, 0
  s_cbranch_scc1 .fz_kernel_hb6
  s_barrier
  s_sub_u32 s3, s3, 1
.fz_kernel_hb6:
  s_setprio 2
  v_mfma_f32_16x16x32_bf16 v[128:131], v[24:27], v[64:67], 0
  v_mfma_f32_16x16x32_bf16 v[160:163], v[64:67], v[64:67], 0
  v_mfma_f32_16x16x32_bf16 v[132:135], v[24:27], v[72:75], 0
  v_mfma_f32_16x16x32_bf16 v[164:167], v[72:75], v[72:75], 0
  v_mfma_f32_16x16x32_bf16 v[136:139], v[24:27], v[80:83], 0
  v_mfma_f32_16x16x32_bf16 v[168:171], v[80:83], v[80:83], 0
  v_mfma_f32_16x16x32_bf16 v[140:143], v[24:27], v[88:91], 0
  v_mfma_f32_16x16x32_bf16 v[172:175], v[88:91], v[88:91], 0
  v_mfma_f32_16x16x32_bf16 v[144:147], v[24:27], v[96:99], 0
  v_mfma_f32_16x16x32_bf16 v[176:179], v[96:99], v[96:99], 0
  v_mfma_f32_16x16x32_bf16 v[148:151], v[24:27], v[104:107], 0
  v_mfma_f32_16x16x32_bf16 v[180:183], v[104:107], v[104:107], 0
  v_mfma_f32_16x16x32_bf16 v[152:155], v[24:27], v[112:115], 0
  v_mfma_f32_16x16x32_bf16 v[184:187], v[112:115], v[112:115], 0
  v_mfma_f32_16x16x32_bf16 v[156:159], v[24:27], v[120:123], 0
  v_mfma_f32_16x16x32_bf16 v[188:191], v[120:123], v[120:123], 0
  v_mfma_f32_16x16x32_bf16 v[128:131], v[24:27], v[68:71], v[128:131]
  v_mfma_f32_16x16x32_bf16 v[160:163], v[68:71], v[68:71], v[160:163]
  v_mfma_f32_16x16x32_bf16 v[132:135], v[24:27], v[76:79], v[132:135]
  v_mfma_f32_16x16x32_bf16 v[164:167], v[76:79], v[76:79], v[164:167]
  v_mfma_f32_16x16x32_bf16 v[136:139], v[24:27], v[84:87], v[136:139]
  v_mfma_f32_16x16x32_bf16 v[168:171], v[84:87], v[84:87], v[168:171]
  v_mfma_f32_16x16x32_bf16 v[140:143], v[24:27], v[92:95], v[140:143]
  v_mfma_f32_16x16x32_bf16 v[172:175], v[92:95], v[92:95], v[172:175]
  v_mfma_f32_16x16x32_bf16 v[144:147], v[24:27], v[100:103], v[144:147]
  v_mfma_f32_16x16x32_bf16 v[176:179], v[100:103], v[100:103], v[176:179]
  v_mfma_f32_16x16x32_bf16 v[148:151], v[24:27], v[108:111], v[148:151]
  v_mfma_f32_16x16x32_bf16 v[180:183], v[108:111], v[108:111], v[180:183]
  v_mfma_f32_16x16x32_bf16 v[152:155], v[24:27], v[116:119], v[152:155]
  v_mfma_f32_16x16x32_bf16 v[184:187], v[116:119], v[116:119], v[184:187]
  v_mfma_f32_16x16x32_bf16 v[156:159], v[24:27], v[124:127], v[156:159]
  v_mfma_f32_16x16x32_bf16 v[188:191], v[124:127], v[124:127], v[188:191]
  s_setprio 0
  s_cmp_eq_u32 s3, 0
  s_cbranch_scc1 .fz_kernel_hb7
  s_barrier
  s_sub_u32 s3, s3, 1
.fz_kernel_hb7:
  s_mov_b32 exec_lo, 0x100001
  s_mov_b32 exec_hi, 0x10000100
  buffer_load_dword v9, v4, s[12:15], 0 offen sc1
  v_mov_b32 v128, v160
  v_mov_b32 v132, v164
  v_mov_b32 v136, v168
  v_mov_b32 v140, v172
  v_mov_b32 v144, v176
  v_mov_b32 v148, v180
  v_mov_b32 v152, v184
  v_mov_b32 v156, v188
  s_mov_b32 exec_lo, 0x200002
  s_mov_b32 exec_hi, 0x20000200
  v_mov_b32 v128, v161
  v_mov_b32 v132, v165
  v_mov_b32 v136, v169
  v_mov_b32 v140, v173
  v_mov_b32 v144, v177
  v_mov_b32 v148, v181
  v_mov_b32 v152, v185
  v_mov_b32 v156, v189
  s_mov_b32 exec_lo, 0x400004
  s_mov_b32 exec_hi, 0x40000400
  v_mov_b32 v128, v162
  v_mov_b32 v132, v166
  v_mov_b32 v136, v170
  v_mov_b32 v140, v174
  v_mov_b32 v144, v178
  v_mov_b32 v148, v182
  v_mov_b32 v152, v186
  v_mov_b32 v156, v190
  s_cmp_eq_u32 s3, 0
  s_cbranch_scc1 .fz_kernel_hb8
  s_barrier
  s_sub_u32 s3, s3, 1
.fz_kernel_hb8:
  s_mov_b32 exec_lo, 0x800008
  s_mov_b32 exec_hi, 0x80000800
  v_mov_b32 v128, v163
  v_mov_b32 v132, v167
  v_mov_b32 v136, v171
  v_mov_b32 v140, v175
  v_mov_b32 v144, v179
  v_mov_b32 v148, v183
  v_mov_b32 v152, v187
  v_mov_b32 v156, v191
  s_mov_b64 exec, 1
  s_mov_b32 s38, 0
.fz_kernel_pw9:
  s_mov_b32 s46, 0
  s_call_b64 s[0:1], .fz_kernel_hw
  s_waitcnt vmcnt(0)
  v_readfirstlane_b32 s31, v9
  s_cmp_eq_u32 s31, 64
  s_cbranch_scc1 .fz_kernel_pw9d
  s_cmp_eq_u32 s3, 0
  s_cbranch_scc1 .fz_kernel_hb10
  s_barrier
  s_sub_u32 s3, s3, 1
.fz_kernel_hb10:
  s_cmp_eq_u32 s3, 0
  s_cbranch_scc1 .fz_kernel_hb11
  s_barrier
  s_sub_u32 s3, s3, 1
.fz_kernel_hb11:
  buffer_load_dword v9, v4, s[12:15], 0 offen sc1
  s_add_u32 s38, s38, 1
  s_cmp_lt_u32 s38, 131072
  s_cbranch_scc1 .fz_kernel_pw9
  s_waitcnt vmcnt(0)
.fz_kernel_pw9d:
  s_mov_b64 exec, -1
  s_cmp_eq_u32 s3, 0
  s_cbranch_scc1 .fz_kernel_hb12
  s_barrier
  s_sub_u32 s3, s3, 1
.fz_kernel_hb12:
  s_mov_b32 exec_lo, 0x00fff00f
  s_mov_b32 exec_hi, 0xff000ff0
  buffer_atomic_add_f32 v128, v20, s[4:7], s30 offen offset:0 sc1
  buffer_atomic_add_f32 v132, v20, s[4:7], s30 offen offset:128 sc1
  buffer_atomic_add_f32 v136, v20, s[4:7], s30 offen offset:256 sc1
  buffer_atomic_add_f32 v140, v20, s[4:7], s30 offen offset:384 sc1
  buffer_atomic_add_f32 v144, v20, s[4:7], s30 offen offset:512 sc1
  buffer_atomic_add_f32 v148, v20, s[4:7], s30 offen offset:640 sc1
  buffer_atomic_add_f32 v152, v20, s[4:7], s30 offen offset:768 sc1
  buffer_atomic_add_f32 v156, v20, s[4:7], s30 offen offset:896 sc1
  s_mov_b64 exec, -1
  s_mov_b32 s46, 0
  s_call_b64 s[0:1], .fz_kernel_hw
  s_waitcnt vmcnt(0)
  v_lshlrev_b32 v7, 11, v2
  s_lshl_b32 s31, s17, 7
  s_lshl_b32 s33, 1, s18
  s_add_u32 s31, s31, s67
  s_add_u32 s31, s31, 0x1800018
  v_mov_b32 v8, s33
  s_mov_b64 exec, 0xffff
  buffer_atomic_or v8, v7, s[4:7], s31 offen sc1
  s_mov_b64 exec, -1
  s_add_u32 s37, s19, 24
.fz_kernel_f113:
  s_cmp_le_u32 s3, 9
  s_cbranch_scc1 .fz_kernel_f113d
  s_barrier
  s_sub_u32 s3, s3, 1
  s_branch .fz_kernel_f113
.fz_kernel_f113d:
  s_mov_b64 exec, 1
  buffer_load_dword v9, v4, s[4:7], s37 offen sc1
  s_mov_b64 exec, 1
  s_mov_b32 s38, 0
.fz_kernel_pw14:
  s_mov_b32 s46, 0
  s_call_b64 s[0:1], .fz_kernel_hw
  s_waitcnt vmcnt(0)
  v_readfirstlane_b32 s31, v9
  s_cmp_eq_u32 s31, 65535
  s_cbranch_scc1 .fz_kernel_pw14d
  s_cmp_eq_u32 s3, 0
  s_cbranch_scc1 .fz_kernel_hb15
  s_barrier
  s_sub_u32 s3, s3, 1
.fz_kernel_hb15:
  s_cmp_eq_u32 s3, 0
  s_cbranch_scc1 .fz_kernel_hb16
  s_barrier
  s_sub_u32 s3, s3, 1
.fz_kernel_hb16:
  buffer_load_dword v9, v4, s[4:7], s37 offen sc1
  s_add_u32 s38, s38, 1
  s_cmp_lt_u32 s38, 131072
  s_cbranch_scc1 .fz_kernel_pw14
  s_waitcnt vmcnt(0)
.fz_kernel_pw14d:
  s_mov_b64 exec, -1
  buffer_load_dwordx4 v[64:67], v3, s[4:7], s30 offen sc1
  s_mov_b32 s46, 0
  s_call_b64 s[0:1], .fz_kernel_hw
  s_waitcnt vmcnt(0)
  s_cmp_eq_u32 s3, 0
  s_cbranch_scc1 .fz_kernel_hb17
  s_barrier
  s_sub_u32 s3, s3, 1
.fz_kernel_hb17:
  v_mov_b32 v26, 0.0009765625
  v_mul_f32 v20, v26, v64
  v_mul_f32 v27, v20, v20
  v_fma_f32 v22, v65, v26, -v27
  v_max_f32 v22, 0, v22
  v_add_f32 v22, 1e-05, v22
  v_rsq_f32 v22, v22
  s_nop 0
  v_mul_f32 v20, v20, v22
  v_sub_f32 v20, 0, v20
  v_mul_f32 v21, v26, v66
  v_mul_f32 v27, v21, v21
  v_fma_f32 v23, v67, v26, -v27
  v_max_f32 v23, 0, v23
  v_add_f32 v23, 1e-05, v23
  v_rsq_f32 v23, v23
  s_nop 0
  v_mul_f32 v21, v21, v23
  v_sub_f32 v21, 0, v21
  ds_write_b64 v52, v[22:23] offset:4608
  ds_write_b64 v52, v[20:21] offset:5120
  v_mov_b32 v24, 159952
  v_mov_b32 v25, s76
  ds_write_b32 v24, v25 offset:8
  s_waitcnt lgkmcnt(0)
.fz_kernel_q_hw2:
  s_add_u32 s3, s3, 2
.fz_kernel_q_he:
  s_cmp_eq_u32 s3, 0
  s_cbranch_scc1 .fz_kernel_chain
  s_barrier
  s_sub_u32 s3, s3, 1
  s_branch .fz_kernel_q_he
.fz_kernel_q_h7:
  s_mov_b32 s8, s58
  s_mov_b32 s9, s59
  s_mov_b32 s10, 0x100
  s_mov_b32 s11, 0x00020000
  v_mov_b32 v12, 0
  v_mov_b32 v13, 0
  v_mov_b32 v14, 0
  v_mov_b32 v15, 0
  s_cmp_ge_u32 s2, 64
  s_cbranch_scc1 .fz_kernel_q_nzero
  s_lshl_b32 s36, s2, 10
  s_add_u32 s36, s36, 0x1800000
  buffer_store_dwordx4 v[12:15], v3, s[4:7], s36 offen sc1
.fz_kernel_q_nzero:
  v_and_b32 v21, 7, v2
  v_and_b32 v20, 16, v2
  v_lshlrev_b32 v20, 1, v20
  v_xor_b32 v20, v20, v3
  s_bfe_u32 s33, s17, 0x10002
  s_lshl_b32 s33, s33, 1
  s_and_b32 s31, s33, 3
  s_mul_i32 s31, s31, 12288
  s_add_u32 s31, s31, 65536
  v_add_u32 v16, s31, v20
  v_xor_b32 v17, 64, v16
  s_add_u32 s31, s31, 12288
  v_add_u32 v18, s31, v20
  v_xor_b32 v19, 64, v18
  s_sub_u32 s33, 31, s33
  v_lshlrev_b32 v21, 5, v21
  v_and_b32 v22, 24, v2
  v_add_u32 v21, v22, v21
  v_lshrrev_b32 v22, 5, v2
  v_lshl_add_u32 v21, v22, 2, v21
  s_lshl_b32 s30, s18, 10
  s_add_u32 s30, s30, 0x180c000
  v_and_b32 v22, 1, v2
  v_lshlrev_b32 v22, 4, v22
  v_mov_b32 v23, 0x3f80
  v_lshlrev_b32 v22, v22, v23
  v_mov_b32 v24, 0
  v_mov_b32 v25, 0
  v_mov_b32 v26, 0
  v_mov_b32 v27, 0
  s_mov_b32 exec_lo, 0x3030303
  s_mov_b32 exec_hi, 0x3030303
  v_mov_b32 v24, v22
  s_mov_b32 exec_lo, 0xc0c0c0c
  s_mov_b32 exec_hi, 0xc0c0c0c
  v_mov_b32 v25, v22
  s_mov_b32 exec_lo, 0x30303030
  s_mov_b32 exec_hi, 0x30303030
  v_mov_b32 v26, v22
  s_mov_b32 exec_lo, 0xc0c0c0c0
  s_mov_b32 exec_hi, 0xc0c0c0c0
  v_mov_b32 v27, v22
  s_mov_b64 exec, -1
  s_cmp_ge_u32 s2, 64
  s_cbranch_scc1 .fz_kernel_nz2
  s_mov_b64 exec, 1
  s_waitcnt vmcnt(0)
  buffer_atomic_add v5, v4, s[8:11], 0 offen sc1
  s_mov_b64 exec, -1
.fz_kernel_nz2:
  s_barrier
  s_sub_u32 s3, s3, 1
  s_cmp_lg_u32 s3, s33
  s_cbranch_scc1 .fz_kernel_nz2
  ds_read_b128 v[64:67], v16 offset:0
  ds_read_b128 v[68:71], v16 offset:4096
  ds_read_b128 v[72:75], v16 offset:8192
  ds_read_b128 v[76:79], v17 offset:1024
  ds_read_b128 v[80:83], v17 offset:5120
  ds_read_b128 v[84:87], v17 offset:9216
  ds_read_b128 v[88:91], v16 offset:2048
  ds_read_b128 v[92:95], v16 offset:6144
  ds_read_b128 v[96:99], v16 offset:10240
  ds_read_b128 v[100:103], v17 offset:3072
  ds_read_b128 v[104:107], v17 offset:7168
  ds_read_b128 v[108:111], v17 offset:11264
  s_waitcnt lgkmcnt(0)
  s_cmp_eq_u32 s3, 0
  s_cbranch_scc1 .fz_kernel_hb18
  s_barrier
  s_sub_u32 s3, s3, 1
.fz_kernel_hb18:
  ds_read_b128 v[112:115], v18 offset:0
  ds_read_b128 v[116:119], v18 offset:4096
  ds_read_b128 v[120:123], v18 offset:8192
  ds_read_b128 v[124:127], v19 offset:1024
  ds_read_b128 v[128:131], v19 offset:5120
  ds_read_b128 v[132:135], v19 offset:9216
  ds_read_b128 v[136:139], v18 offset:2048
  ds_read_b128 v[140:143], v18 offset:6144
  ds_read_b128 v[144:147], v18 offset:10240
  ds_read_b128 v[148:151], v19 offset:3072
  ds_read_b128 v[152:155], v19 offset:7168
  ds_read_b128 v[156:159], v19 offset:11264
  s_waitcnt lgkmcnt(0)
  s_cmp_eq_u32 s3, 0
  s_cbranch_scc1 .fz_kernel_hb19
  s_barrier
  s_sub_u32 s3, s3, 1
.fz_kernel_hb19:
  s_setprio 2
  v_mfma_f32_16x16x32_bf16 v[160:163], v[24:27], v[64:67], 0
  v_mfma_f32_16x16x32_bf16 v[164:167], v[24:27], v[68:71], 0
  v_mfma_f32_16x16x32_bf16 v[168:171], v[24:27], v[72:75], 0
  v_mfma_f32_16x16x32_bf16 v[160:163], v[24:27], v[76:79], v[160:163]
  v_mfma_f32_16x16x32_bf16 v[164:167], v[24:27], v[80:83], v[164:167]
  v_mfma_f32_16x16x32_bf16 v[168:171], v[24:27], v[84:87], v[168:171]
  v_mfma_f32_16x16x32_bf16 v[160:163], v[24:27], v[88:91], v[160:163]
  v_mfma_f32_16x16x32_bf16 v[164:167], v[24:27], v[92:95], v[164:167]
  v_mfma_f32_16x16x32_bf16 v[168:171], v[24:27], v[96:99], v[168:171]
  v_mfma_f32_16x16x32_bf16 v[160:163], v[24:27], v[100:103], v[160:163]
  v_mfma_f32_16x16x32_bf16 v[164:167], v[24:27], v[104:107], v[164:167]
  v_mfma_f32_16x16x32_bf16 v[168:171], v[24:27], v[108:111], v[168:171]
  v_mfma_f32_16x16x32_bf16 v[160:163], v[24:27], v[112:115], v[160:163]
  v_mfma_f32_16x16x32_bf16 v[164:167], v[24:27], v[116:119], v[164:167]
  v_mfma_f32_16x16x32_bf16 v[168:171], v[24:27], v[120:123], v[168:171]
  v_mfma_f32_16x16x32_bf16 v[160:163], v[24:27], v[124:127], v[160:163]
  v_mfma_f32_16x16x32_bf16 v[164:167], v[24:27], v[128:131], v[164:167]
  v_mfma_f32_16x16x32_bf16 v[168:171], v[24:27], v[132:135], v[168:171]
  v_mfma_f32_16x16x32_bf16 v[160:163], v[24:27], v[136:139], v[160:163]
  v_mfma_f32_16x16x32_bf16 v[164:167], v[24:27], v[140:143], v[164:167]
  v_mfma_f32_16x16x32_bf16 v[168:171], v[24:27], v[144:147], v[168:171]
  v_mfma_f32_16x16x32_bf16 v[160:163], v[24:27], v[148:151], v[160:163]
  v_mfma_f32_16x16x32_bf16 v[164:167], v[24:27], v[152:155], v[164:167]
  v_mfma_f32_16x16x32_bf16 v[168:171], v[24:27], v[156:159], v[168:171]
  s_setprio 0
  s_mov_b64 exec, 1
  buffer_load_dword v9, v4, s[8:11], 0 offen sc1
  s_mov_b64 exec, -1
  s_cmp_eq_u32 s3, 0
  s_cbranch_scc1 .fz_kernel_hb20
  s_barrier
  s_sub_u32 s3, s3, 1
.fz_kernel_hb20:
  v_add_f32 v160, v160, v160 row_ror:8 row_mask:0xf bank_mask:0xf
  v_add_f32 v161, v161, v161 row_ror:8 row_mask:0xf bank_mask:0xf
  v_add_f32 v162, v162, v162 row_ror:8 row_mask:0xf bank_mask:0xf
  v_add_f32 v163, v163, v163 row_ror:8 row_mask:0xf bank_mask:0xf
  v_add_f32 v164, v164, v164 row_ror:8 row_mask:0xf bank_mask:0xf
  v_add_f32 v165, v165, v165 row_ror:8 row_mask:0xf bank_mask:0xf
  v_add_f32 v166, v166, v166 row_ror:8 row_mask:0xf bank_mask:0xf
  v_add_f32 v167, v167, v167 row_ror:8 row_mask:0xf bank_mask:0xf
  v_add_f32 v168, v168, v168 row_ror:8 row_mask:0xf bank_mask:0xf
  v_add_f32 v169, v169, v169 row_ror:8 row_mask:0xf bank_mask:0xf
  v_add_f32 v170, v170, v170 row_ror:8 row_mask:0xf bank_mask:0xf
  v_add_f32 v171, v171, v171 row_ror:8 row_mask:0xf bank_mask:0xf
  s_mov_b32 exec_lo, 0x0
  s_mov_b32 exec_hi, 0xff00ff
  v_mov_b32 v160, v161
  v_mov_b32 v164, v165
  v_mov_b32 v168, v169
  s_mov_b32 exec_lo, 0xff00ff00
  s_mov_b32 exec_hi, 0x0
  v_mov_b32 v160, v162
  v_mov_b32 v164, v166
  v_mov_b32 v168, v170
  s_mov_b32 exec_lo, 0x0
  s_mov_b32 exec_hi, 0xff00ff00
  v_mov_b32 v160, v163
  v_mov_b32 v164, v167
  v_mov_b32 v168, v171
  s_cmp_eq_u32 s3, 0
  s_cbranch_scc1 .fz_kernel_hb21
  s_barrier
  s_sub_u32 s3, s3, 1
.fz_kernel_hb21:
  s_mov_b64 exec, 1
  s_mov_b32 s38, 0
.fz_kernel_pw22:
  s_mov_b32 s46, 0
  s_call_b64 s[0:1], .fz_kernel_hw
  s_waitcnt vmcnt(0)
  v_readfirstlane_b32 s31, v9
  s_cmp_eq_u32 s31, 64
  s_cbranch_scc1 .fz_kernel_pw22d
  s_cmp_eq_u32 s3, 0
  s_cbranch_scc1 .fz_kernel_hb23
  s_barrier
  s_sub_u32 s3, s3, 1
.fz_kernel_hb23:
  s_cmp_eq_u32 s3, 0
  s_cbranch_scc1 .fz_kernel_hb24
  s_barrier
  s_sub_u32 s3, s3, 1
.fz_kernel_hb24:
  buffer_load_dword v9, v4, s[8:11], 0 offen sc1
  s_add_u32 s38, s38, 1
  s_cmp_lt_u32 s38, 131072
  s_cbranch_scc1 .fz_kernel_pw22
  s_waitcnt vmcnt(0)
.fz_kernel_pw22d:
  s_mov_b64 exec, -1
  buffer_atomic_add_f32 v160, v21, s[4:7], s30 offen offset:0 sc1
  buffer_atomic_add_f32 v164, v21, s[4:7], s30 offen offset:256 sc1
  buffer_atomic_add_f32 v168, v21, s[4:7], s30 offen offset:512 sc1
  s_mov_b32 s46, 0
  s_call_b64 s[0:1], .fz_kernel_hw
  s_waitcnt vmcnt(0)
  v_lshlrev_b32 v7, 7, v2
  s_lshl_b32 s31, s18, 11
  s_lshl_b32 s33, 1, s17
  s_add_u32 s31, s31, s67
  s_add_u32 s31, s31, 0x180001c
  v_mov_b32 v8, s33
  s_mov_b64 exec, 0xffff
  buffer_atomic_or v8, v7, s[4:7], s31 offen sc1
  s_mov_b64 exec, -1
  s_cmp_eq_u32 s3, 0
  s_cbranch_scc1 .fz_kernel_hb25
  s_barrier
  s_sub_u32 s3, s3, 1
.fz_kernel_hb25:
  s_cmp_ge_u32 s2, 196
  s_cbranch_scc1 .fz_kernel_lz26
  s_lshl_b32 s36, s2, 12
  s_add_u32 s36, s36, 0x1c00000
  s_sub_u32 s31, s2, 66
  s_min_u32 s31, s31, s2
  s_sub_u32 s31, s31, 4
  s_cmp_lt_u32 s31, 6
  s_cbranch_scc1 .fz_kernel_lz26a
  buffer_store_dwordx4 v[12:15], v3, s[4:7], s36 offen sc1
  buffer_store_dwordx4 v[12:15], v3, s[4:7], s36 offen offset:1024 sc1
  buffer_store_dwordx4 v[12:15], v3, s[4:7], s36 offen offset:2048 sc1
  buffer_store_dwordx4 v[12:15], v3, s[4:7], s36 offen offset:3072 sc1
.fz_kernel_lz26:
  s_add_u32 s37, s19, 28
.fz_kernel_f127:
  s_cmp_le_u32 s3, 9
  s_cbranch_scc1 .fz_kernel_f127d
  s_barrier
  s_sub_u32 s3, s3, 1
  s_branch .fz_kernel_f127
.fz_kernel_f127d:
  s_mov_b64 exec, 1
  buffer_load_dword v9, v4, s[4:7], s37 offen sc1
  s_mov_b64 exec, 1
  s_mov_b32 s38, 0
.fz_kernel_pw28:
  s_mov_b32 s46, 0
  s_call_b64 s[0:1], .fz_kernel_hw
  s_waitcnt vmcnt(0)
  v_readfirstlane_b32 s31, v9
  s_cmp_eq_u32 s31, 65535
  s_cbranch_scc1 .fz_kernel_pw28d
  s_cmp_eq_u32 s3, 0
  s_cbranch_scc1 .fz_kernel_hb29
  s_barrier
  s_sub_u32 s3, s3, 1
.fz_kernel_hb29:
  s_cmp_eq_u32 s3, 0
  s_cbranch_scc1 .fz_kernel_hb30
  s_barrier
  s_sub_u32 s3, s3, 1
.fz_kernel_hb30:
  buffer_load_dword v9, v4, s[4:7], s37 offen sc1
  s_add_u32 s38, s38, 1
  s_cmp_lt_u32 s38, 131072
  s_cbranch_scc1 .fz_kernel_pw28
  s_waitcnt vmcnt(0)
.fz_kernel_pw28d:
  s_mov_b64 exec, -1
  buffer_load_dwordx4 v[64:67], v3, s[4:7], s30 offen sc1
  s_mov_b32 s46, 0
  s_call_b64 s[0:1], .fz_kernel_hw
  s_waitcnt vmcnt(0)
  v_add_u32 v24, 155648, v3
  s_mov_b32 exec_hi, 0xffff
  ds_write_b128 v24, v[64:67] offset:5632
  s_mov_b64 exec, -1
  s_waitcnt lgkmcnt(0)
  s_cmp_eq_u32 s3, 0
  s_cbranch_scc1 .fz_kernel_hb31
  s_barrier
  s_sub_u32 s3, s3, 1
.fz_kernel_hb31:
  s_getpc_b64 s[0:1]
.fz_kernel_ct32:
  s_sub_u32 s0, s0, .fz_kernel_ct32-fz_kernel
  s_subb_u32 s1, s1, 0
  s_lshr_b32 s31, s2, 3
  s_mulk_i32 s31, 0x500
  v_lshl_add_u32 v1, v2, 7, s31
  v_min_u32 v1, .fz_kernel_last-fz_kernel, v1
  s_mov_b64 exec, 0x3ff
  global_load_dword v1, v1, s[0:1]
  s_mov_b64 exec, -1
.fz_kernel_ct32e:
  s_branch .fz_kernel_q_hw2
.fz_kernel_att:
  s_setprio 1
  s_lshl_b32 s34, 1, s17
  s_mov_b32 s36, 0
  v_mfma_f32_32x32x16_bf16 v[48:63], v[80:83], v[16:19], 0
  v_mfma_f32_32x32x16_bf16 v[48:63], v[84:87], v[20:23], v[48:63]
  v_and_b32 v1, 31, v2
  v_lshl_add_u32 v1, v1, 3, s11
  v_mov_b32 v208, 0
  v_mov_b32 v209, 0
  v_mov_b32 v210, 0
  v_mov_b32 v211, 0
  v_mov_b32 v212, 0
  v_mov_b32 v213, 0
  v_mov_b32 v214, 0
  v_mov_b32 v215, 0
  v_mov_b32 v216, 0
  v_mov_b32 v217, 0
  v_mov_b32 v218, 0
  v_mov_b32 v219, 0
  v_mov_b32 v220, 0
  v_mov_b32 v221, 0
  v_mov_b32 v222, 0
  v_mov_b32 v223, 0
  s_waitcnt lgkmcnt(0)
  s_barrier
  ds_read_b128 v[32:35], v9 offset:0
  ds_read_b128 v[36:39], v9 offset:1024
  ds_read_b128 v[40:43], v9 offset:2048
  ds_read_b128 v[44:47], v9 offset:3072
  v_mfma_f32_32x32x16_bf16 v[64:79], v[80:83], v[24:27], 0
  v_exp_f32 v48, v48
  v_exp_f32 v49, v49
  v_exp_f32 v50, v50
  v_exp_f32 v51, v51
  v_exp_f32 v52, v52
  v_exp_f32 v53, v53
  v_exp_f32 v54, v54
  v_exp_f32 v55, v55
  v_mfma_f32_32x32x16_bf16 v[64:79], v[84:87], v[28:31], v[64:79]
  v_cvt_pk_bf16_f32 v224, v48, v49
  v_cvt_pk_bf16_f32 v225, v50, v51
  v_cvt_pk_bf16_f32 v226, v52, v53
  v_cvt_pk_bf16_f32 v227, v54, v55
  v_exp_f32 v56, v56
  v_exp_f32 v57, v57
  v_exp_f32 v58, v58
  v_exp_f32 v59, v59
  v_mfma_f32_32x32x16_bf16 v[144:159], v[88:91], v[224:227], 0
  v_exp_f32 v60, v60
  v_exp_f32 v61, v61
  v_exp_f32 v62, v62
  v_exp_f32 v63, v63
  v_cvt_pk_bf16_f32 v228, v56, v57
  v_cvt_pk_bf16_f32 v229, v58, v59
  v_cvt_pk_bf16_f32 v230, v60, v61
  v_cvt_pk_bf16_f32 v231, v62, v63
  s_waitcnt lgkmcnt(0)
  v_mfma_f32_32x32x16_bf16 v[48:63], v[80:83], v[32:35], 0
  v_exp_f32 v64, v64
  v_exp_f32 v65, v65
  v_exp_f32 v66, v66
  v_exp_f32 v67, v67
  v_mfma_f32_32x32x16_bf16 v[144:159], v[92:95], v[228:231], v[144:159]
  v_exp_f32 v68, v68
  v_exp_f32 v69, v69
  v_exp_f32 v70, v70
  v_smfmac_f32_16x16x64_bf16 v[208:211], v[12:15], v[224:231], v11
  v_exp_f32 v71, v71
  v_mfma_f32_32x32x16_bf16 v[48:63], v[84:87], v[36:39], v[48:63]
  v_cvt_pk_bf16_f32 v224, v64, v65
  v_cvt_pk_bf16_f32 v225, v66, v67
  v_cvt_pk_bf16_f32 v226, v68, v69
  v_cvt_pk_bf16_f32 v227, v70, v71
  v_exp_f32 v72, v72
  v_exp_f32 v73, v73
  v_exp_f32 v74, v74
  v_exp_f32 v75, v75
  v_mfma_f32_32x32x16_bf16 v[160:175], v[88:91], v[224:227], 0
  v_exp_f32 v76, v76
  v_exp_f32 v77, v77
  v_exp_f32 v78, v78
  v_exp_f32 v79, v79
  v_cvt_pk_bf16_f32 v228, v72, v73
  v_cvt_pk_bf16_f32 v229, v74, v75
  v_cvt_pk_bf16_f32 v230, v76, v77
  v_cvt_pk_bf16_f32 v231, v78, v79
  s_mov_b64 exec, 1
  s_waitcnt vmcnt(0)
  ds_add_u32 v6, v5 offset:0x100
  s_mov_b64 exec, -1
  v_mfma_f32_32x32x16_bf16 v[64:79], v[80:83], v[40:43], 0
  v_exp_f32 v48, v48
  v_exp_f32 v49, v49
  v_exp_f32 v50, v50
  v_exp_f32 v51, v51
  v_mfma_f32_32x32x16_bf16 v[160:175], v[92:95], v[228:231], v[160:175]
  v_exp_f32 v52, v52
  v_exp_f32 v53, v53
  v_exp_f32 v54, v54
  v_smfmac_f32_16x16x64_bf16 v[212:215], v[12:15], v[224:231], v11
  v_exp_f32 v55, v55
  v_mfma_f32_32x32x16_bf16 v[64:79], v[84:87], v[44:47], v[64:79]
  v_cvt_pk_bf16_f32 v224, v48, v49
  v_cvt_pk_bf16_f32 v225, v50, v51
  v_cvt_pk_bf16_f32 v226, v52, v53
  v_cvt_pk_bf16_f32 v227, v54, v55
  v_exp_f32 v56, v56
  v_exp_f32 v57, v57
  v_exp_f32 v58, v58
  v_exp_f32 v59, v59
  v_mfma_f32_32x32x16_bf16 v[176:191], v[88:91], v[224:227], 0
  ds_read_b32 v7, v6
  v_exp_f32 v60, v60
  v_exp_f32 v61, v61
  v_exp_f32 v62, v62
  v_exp_f32 v63, v63
  v_cvt_pk_bf16_f32 v228, v56, v57
  v_cvt_pk_bf16_f32 v229, v58, v59
  v_cvt_pk_bf16_f32 v230, v60, v61
  v_cvt_pk_bf16_f32 v231, v62, v63
  s_waitcnt lgkmcnt(0)
  v_readfirstlane_b32 s39, v7
  s_andn2_b32 s33, s39, s34
  s_bcnt1_i32_b32 s31, s33
  s_cmp_ge_u32 s31, 2
  s_cbranch_scc1 .fz_kernel_a_e
  v_mfma_f32_32x32x16_bf16 v[48:63], v[96:99], v[16:19], 0
  v_exp_f32 v64, v64
  v_exp_f32 v65, v65
  v_exp_f32 v66, v66
  v_exp_f32 v67, v67
  v_mfma_f32_32x32x16_bf16 v[176:191], v[92:95], v[228:231], v[176:191]
  v_exp_f32 v68, v68
  v_exp_f32 v69, v69
  v_exp_f32 v70, v70
  v_smfmac_f32_16x16x64_bf16 v[216:219], v[12:15], v[224:231], v11
  v_exp_f32 v71, v71
  v_mfma_f32_32x32x16_bf16 v[48:63], v[100:103], v[20:23], v[48:63]
  v_cvt_pk_bf16_f32 v224, v64, v65
  v_cvt_pk_bf16_f32 v225, v66, v67
  v_cvt_pk_bf16_f32 v226, v68, v69
  v_cvt_pk_bf16_f32 v227, v70, v71
  v_exp_f32 v72, v72
  v_exp_f32 v73, v73
  v_exp_f32 v74, v74
  v_exp_f32 v75, v75
  v_mfma_f32_32x32x16_bf16 v[192:207], v[88:91], v[224:227], 0
  v_exp_f32 v76, v76
  v_exp_f32 v77, v77
  v_exp_f32 v78, v78
  v_exp_f32 v79, v79
  v_cvt_pk_bf16_f32 v228, v72, v73
  v_cvt_pk_bf16_f32 v229, v74, v75
  v_cvt_pk_bf16_f32 v230, v76, v77
  v_cvt_pk_bf16_f32 v231, v78, v79
  v_mfma_f32_32x32x16_bf16 v[64:79], v[96:99], v[24:27], 0
  v_exp_f32 v48, v48
  v_exp_f32 v49, v49
  v_exp_f32 v50, v50
  v_exp_f32 v51, v51
  v_mfma_f32_32x32x16_bf16 v[192:207], v[92:95], v[228:231], v[192:207]
  v_exp_f32 v52, v52
  v_exp_f32 v53, v53
  v_exp_f32 v54, v54
  v_smfmac_f32_16x16x64_bf16 v[220:223], v[12:15], v[224:231], v11
  v_exp_f32 v55, v55
  v_mfma_f32_32x32x16_bf16 v[64:79], v[100:103], v[28:31], v[64:79]
  v_cvt_pk_bf16_f32 v224, v48, v49
  v_cvt_pk_bf16_f32 v225, v50, v51
  v_cvt_pk_bf16_f32 v226, v52, v53
  v_cvt_pk_bf16_f32 v227, v54, v55
  v_exp_f32 v56, v56
  v_exp_f32 v57, v57
  v_exp_f32 v58, v58
  v_exp_f32 v59, v59
  v_mfma_f32_32x32x16_bf16 v[144:159], v[104:107], v[224:227], v[144:159]
  v_exp_f32 v60, v60
  v_exp_f32 v61, v61
  v_exp_f32 v62, v62
  v_exp_f32 v63, v63
  v_cvt_pk_bf16_f32 v228, v56, v57
  v_cvt_pk_bf16_f32 v229, v58, v59
  v_cvt_pk_bf16_f32 v230, v60, v61
  v_cvt_pk_bf16_f32 v231, v62, v63
  v_mfma_f32_32x32x16_bf16 v[48:63], v[96:99], v[32:35], 0
  v_exp_f32 v64, v64
  v_exp_f32 v65, v65
  v_exp_f32 v66, v66
  v_exp_f32 v67, v67
  v_mfma_f32_32x32x16_bf16 v[144:159], v[108:111], v[228:231], v[144:159]
  v_exp_f32 v68, v68
  v_exp_f32 v69, v69
  v_exp_f32 v70, v70
  v_smfmac_f32_16x16x64_bf16 v[208:211], v[12:15], v[224:231], v11
  v_exp_f32 v71, v71
  v_mfma_f32_32x32x16_bf16 v[48:63], v[100:103], v[36:39], v[48:63]
  v_cvt_pk_bf16_f32 v224, v64, v65
  v_cvt_pk_bf16_f32 v225, v66, v67
  v_cvt_pk_bf16_f32 v226, v68, v69
  v_cvt_pk_bf16_f32 v227, v70, v71
  v_exp_f32 v72, v72
  v_exp_f32 v73, v73
  v_exp_f32 v74, v74
  v_exp_f32 v75, v75
  v_mfma_f32_32x32x16_bf16 v[160:175], v[104:107], v[224:227], v[160:175]
  ds_read_b32 v7, v6
  v_exp_f32 v76, v76
  v_exp_f32 v77, v77
  v_exp_f32 v78, v78
  v_exp_f32 v79, v79
  v_cvt_pk_bf16_f32 v228, v72, v73
  v_cvt_pk_bf16_f32 v229, v74, v75
  v_cvt_pk_bf16_f32 v230, v76, v77
  v_cvt_pk_bf16_f32 v231, v78, v79
  s_waitcnt lgkmcnt(0)
  v_readfirstlane_b32 s39, v7
  s_andn2_b32 s39, s39, s34
  s_cbranch_scc0 .fz_kernel_a_p0
  s_ff1_i32_b32 s33, s36
  s_bitset0_b32 s36, s33
  s_lshl_b32 s33, s33, 14
  s_add_u32 s30, s33, s35
  s_cbranch_scc1 .fz_kernel_pk33c
.fz_kernel_pk33:
  buffer_load_dwordx4 v[112:115], v3, s[4:7], s30 offen offset:0
  buffer_load_dwordx4 v[116:119], v3, s[4:7], s30 offen offset:1024
  buffer_load_dwordx4 v[120:123], v3, s[4:7], s30 offen offset:2048
  buffer_load_dwordx4 v[124:127], v3, s[4:7], s30 offen offset:3072
  buffer_load_dwordx4 v[128:131], v10, s[4:7], s30 offen offset:0
  buffer_load_dwordx4 v[132:135], v10, s[4:7], s30 offen offset:1024
  buffer_load_dwordx4 v[136:139], v10, s[4:7], s30 offen offset:2048
  buffer_load_dwordx4 v[140:143], v10, s[4:7], s30 offen offset:3072
.fz_kernel_a_p0:
  v_mfma_f32_32x32x16_bf16 v[64:79], v[96:99], v[40:43], 0
  v_exp_f32 v48, v48
  v_exp_f32 v49, v49
  v_exp_f32 v50, v50
  v_exp_f32 v51, v51
  v_mfma_f32_32x32x16_bf16 v[160:175], v[108:111], v[228:231], v[160:175]
  v_exp_f32 v52, v52
  v_exp_f32 v53, v53
  v_exp_f32 v54, v54
  v_smfmac_f32_16x16x64_bf16 v[212:215], v[12:15], v[224:231], v11
  v_exp_f32 v55, v55
  v_mfma_f32_32x32x16_bf16 v[64:79], v[100:103], v[44:47], v[64:79]
  v_cvt_pk_bf16_f32 v224, v48, v49
  v_cvt_pk_bf16_f32 v225, v50, v51
  v_cvt_pk_bf16_f32 v226, v52, v53
  v_cvt_pk_bf16_f32 v227, v54, v55
  v_exp_f32 v56, v56
  v_exp_f32 v57, v57
  v_exp_f32 v58, v58
  v_exp_f32 v59, v59
  v_mfma_f32_32x32x16_bf16 v[176:191], v[104:107], v[224:227], v[176:191]
  v_exp_f32 v60, v60
  v_exp_f32 v61, v61
  v_exp_f32 v62, v62
  v_exp_f32 v63, v63
  v_cvt_pk_bf16_f32 v228, v56, v57
  v_cvt_pk_bf16_f32 v229, v58, v59
  v_cvt_pk_bf16_f32 v230, v60, v61
  v_cvt_pk_bf16_f32 v231, v62, v63
  v_exp_f32 v64, v64
  v_exp_f32 v65, v65
  v_exp_f32 v66, v66
  v_exp_f32 v67, v67
  v_mfma_f32_32x32x16_bf16 v[176:191], v[108:111], v[228:231], v[176:191]
  v_exp_f32 v68, v68
  v_exp_f32 v69, v69
  v_exp_f32 v70, v70
  v_smfmac_f32_16x16x64_bf16 v[216:219], v[12:15], v[224:231], v11
  v_exp_f32 v71, v71
  v_cvt_pk_bf16_f32 v224, v64, v65
  v_cvt_pk_bf16_f32 v225, v66, v67
  v_cvt_pk_bf16_f32 v226, v68, v69
  v_cvt_pk_bf16_f32 v227, v70, v71
  v_exp_f32 v72, v72
  v_exp_f32 v73, v73
  v_exp_f32 v74, v74
  v_exp_f32 v75, v75
  v_mfma_f32_32x32x16_bf16 v[192:207], v[104:107], v[224:227], v[192:207]
  v_exp_f32 v76, v76
  v_exp_f32 v77, v77
  v_exp_f32 v78, v78
  v_exp_f32 v79, v79
  v_cvt_pk_bf16_f32 v228, v72, v73
  v_cvt_pk_bf16_f32 v229, v74, v75
  v_cvt_pk_bf16_f32 v230, v76, v77
  v_cvt_pk_bf16_f32 v231, v78, v79
  s_cmp_lg_u32 s39, 0
  s_cbranch_scc1 .fz_kernel_a_p1
  s_ff1_i32_b32 s33, s36
  s_bitset0_b32 s36, s33
  s_lshl_b32 s33, s33, 14
  s_add_u32 s30, s33, s35
  s_cbranch_scc1 .fz_kernel_pk34c
.fz_kernel_pk34:
  buffer_load_dwordx4 v[112:115], v3, s[4:7], s30 offen offset:0
  buffer_load_dwordx4 v[116:119], v3, s[4:7], s30 offen offset:1024
  buffer_load_dwordx4 v[120:123], v3, s[4:7], s30 offen offset:2048
  buffer_load_dwordx4 v[124:127], v3, s[4:7], s30 offen offset:3072
  buffer_load_dwordx4 v[128:131], v10, s[4:7], s30 offen offset:0
  buffer_load_dwordx4 v[132:135], v10, s[4:7], s30 offen offset:1024
  buffer_load_dwordx4 v[136:139], v10, s[4:7], s30 offen offset:2048
  buffer_load_dwordx4 v[140:143], v10, s[4:7], s30 offen offset:3072
.fz_kernel_a_p1:
  s_ff1_i32_b32 s33, s36
  s_bitset0_b32 s36, s33
  s_lshl_b32 s33, s33, 14
  s_add_u32 s30, s33, s35
  s_cbranch_scc1 .fz_kernel_pk35c
.fz_kernel_pk35:
  buffer_load_dwordx4 v[80:83], v3, s[4:7], s30 offen offset:0
  buffer_load_dwordx4 v[84:87], v3, s[4:7], s30 offen offset:1024
  buffer_load_dwordx4 v[88:91], v3, s[4:7], s30 offen offset:2048
  buffer_load_dwordx4 v[92:95], v3, s[4:7], s30 offen offset:3072
  buffer_load_dwordx4 v[96:99], v10, s[4:7], s30 offen offset:0
  s_waitcnt vmcnt(11)
  v_mfma_f32_32x32x16_bf16 v[48:63], v[112:115], v[16:19], 0
  v_mfma_f32_32x32x16_bf16 v[48:63], v[116:119], v[20:23], v[48:63]
  s_nop 9
  s_branch .fz_kernel_a_b2
.fz_kernel_a_e:
  s_mov_b32 s36, s33
  s_or_b32 s34, s34, s39
  s_ff1_i32_b32 s33, s36
  s_bitset0_b32 s36, s33
  s_lshl_b32 s33, s33, 14
  s_add_u32 s30, s33, s35
  v_mfma_f32_32x32x16_bf16 v[48:63], v[96:99], v[16:19], 0
  buffer_load_dwordx4 v[112:115], v3, s[4:7], s30 offen offset:0
  v_exp_f32 v64, v64
  v_exp_f32 v65, v65
  v_exp_f32 v66, v66
  v_exp_f32 v67, v67
  v_mfma_f32_32x32x16_bf16 v[176:191], v[92:95], v[228:231], v[176:191]
  buffer_load_dwordx4 v[116:119], v3, s[4:7], s30 offen offset:1024
  v_exp_f32 v68, v68
  v_exp_f32 v69, v69
  v_exp_f32 v70, v70
  v_smfmac_f32_16x16x64_bf16 v[216:219], v[12:15], v[224:231], v11
  buffer_load_dwordx4 v[120:123], v3, s[4:7], s30 offen offset:2048
  v_exp_f32 v71, v71
  v_mfma_f32_32x32x16_bf16 v[48:63], v[100:103], v[20:23], v[48:63]
  buffer_load_dwordx4 v[124:127], v3, s[4:7], s30 offen offset:3072
  v_cvt_pk_bf16_f32 v224, v64, v65
  v_cvt_pk_bf16_f32 v225, v66, v67
  v_cvt_pk_bf16_f32 v226, v68, v69
  v_cvt_pk_bf16_f32 v227, v70, v71
  v_exp_f32 v72, v72
  v_exp_f32 v73, v73
  v_exp_f32 v74, v74
  v_exp_f32 v75, v75
  v_mfma_f32_32x32x16_bf16 v[192:207], v[88:91], v[224:227], 0
  buffer_load_dwordx4 v[128:131], v10, s[4:7], s30 offen offset:0
  v_exp_f32 v76, v76
  v_exp_f32 v77, v77
  v_exp_f32 v78, v78
  v_exp_f32 v79, v79
  v_cvt_pk_bf16_f32 v228, v72, v73
  v_cvt_pk_bf16_f32 v229, v74, v75
  v_cvt_pk_bf16_f32 v230, v76, v77
  v_cvt_pk_bf16_f32 v231, v78, v79
  v_mfma_f32_32x32x16_bf16 v[64:79], v[96:99], v[24:27], 0
  buffer_load_dwordx4 v[132:135], v10, s[4:7], s30 offen offset:1024
  v_exp_f32 v48, v48
  v_exp_f32 v49, v49
  v_exp_f32 v50, v50
  v_exp_f32 v51, v51
  v_mfma_f32_32x32x16_bf16 v[192:207], v[92:95], v[228:231], v[192:207]
  buffer_load_dwordx4 v[136:139], v10, s[4:7], s30 offen offset:2048
  v_exp_f32 v52, v52
  v_exp_f32 v53, v53
  v_exp_f32 v54, v54
  v_smfmac_f32_16x16x64_bf16 v[220:223], v[12:15], v[224:231], v11
  buffer_load_dwordx4 v[140:143], v10, s[4:7], s30 offen offset:3072
  v_exp_f32 v55, v55
  v_mfma_f32_32x32x16_bf16 v[64:79], v[100:103], v[28:31], v[64:79]
  s_ff1_i32_b32 s33, s36
  v_cvt_pk_bf16_f32 v224, v48, v49
  v_cvt_pk_bf16_f32 v225, v50, v51
  v_cvt_pk_bf16_f32 v226, v52, v53
  v_cvt_pk_bf16_f32 v227, v54, v55
  v_exp_f32 v56, v56
  v_exp_f32 v57, v57
  v_exp_f32 v58, v58
  v_exp_f32 v59, v59
  v_mfma_f32_32x32x16_bf16 v[144:159], v[104:107], v[224:227], v[144:159]
  s_bitset0_b32 s36, s33
  v_exp_f32 v60, v60
  v_exp_f32 v61, v61
  v_exp_f32 v62, v62
  v_exp_f32 v63, v63
  v_cvt_pk_bf16_f32 v228, v56, v57
  v_cvt_pk_bf16_f32 v229, v58, v59
  v_cvt_pk_bf16_f32 v230, v60, v61
  v_cvt_pk_bf16_f32 v231, v62, v63
  v_mfma_f32_32x32x16_bf16 v[48:63], v[96:99], v[32:35], 0
  s_lshl_b32 s33, s33, 14
  v_exp_f32 v64, v64
  v_exp_f32 v65, v65
  v_exp_f32 v66, v66
  v_exp_f32 v67, v67
  v_mfma_f32_32x32x16_bf16 v[144:159], v[108:111], v[228:231], v[144:159]
  s_add_u32 s30, s33, s35
  v_exp_f32 v68, v68
  v_exp_f32 v69, v69
  v_exp_f32 v70, v70
  v_smfmac_f32_16x16x64_bf16 v[208:211], v[12:15], v[224:231], v11
  buffer_load_dwordx4 v[80:83], v3, s[4:7], s30 offen offset:0
  v_exp_f32 v71, v71
  v_mfma_f32_32x32x16_bf16 v[48:63], v[100:103], v[36:39], v[48:63]
  buffer_load_dwordx4 v[84:87], v3, s[4:7], s30 offen offset:1024
  v_cvt_pk_bf16_f32 v224, v64, v65
  v_cvt_pk_bf16_f32 v225, v66, v67
  v_cvt_pk_bf16_f32 v226, v68, v69
  v_cvt_pk_bf16_f32 v227, v70, v71
  v_exp_f32 v72, v72
  v_exp_f32 v73, v73
  v_exp_f32 v74, v74
  v_exp_f32 v75, v75
  v_mfma_f32_32x32x16_bf16 v[160:175], v[104:107], v[224:227], v[160:175]
  buffer_load_dwordx4 v[88:91], v3, s[4:7], s30 offen offset:2048
  v_exp_f32 v76, v76
  v_exp_f32 v77, v77
  v_exp_f32 v78, v78
  v_exp_f32 v79, v79
  v_cvt_pk_bf16_f32 v228, v72, v73
  v_cvt_pk_bf16_f32 v229, v74, v75
  v_cvt_pk_bf16_f32 v230, v76, v77
  v_cvt_pk_bf16_f32 v231, v78, v79
  v_mfma_f32_32x32x16_bf16 v[64:79], v[96:99], v[40:43], 0
  buffer_load_dwordx4 v[92:95], v3, s[4:7], s30 offen offset:3072
  v_exp_f32 v48, v48
  v_exp_f32 v49, v49
  v_exp_f32 v50, v50
  v_exp_f32 v51, v51
  v_mfma_f32_32x32x16_bf16 v[160:175], v[108:111], v[228:231], v[160:175]
  v_exp_f32 v52, v52
  v_exp_f32 v53, v53
  v_exp_f32 v54, v54
  v_smfmac_f32_16x16x64_bf16 v[212:215], v[12:15], v[224:231], v11
  v_exp_f32 v55, v55
  v_mfma_f32_32x32x16_bf16 v[64:79], v[100:103], v[44:47], v[64:79]
  v_cvt_pk_bf16_f32 v224, v48, v49
  v_cvt_pk_bf16_f32 v225, v50, v51
  v_cvt_pk_bf16_f32 v226, v52, v53
  v_cvt_pk_bf16_f32 v227, v54, v55
  v_exp_f32 v56, v56
  v_exp_f32 v57, v57
  v_exp_f32 v58, v58
  v_exp_f32 v59, v59
  v_mfma_f32_32x32x16_bf16 v[176:191], v[104:107], v[224:227], v[176:191]
  s_waitcnt vmcnt(10)
  v_exp_f32 v60, v60
  v_exp_f32 v61, v61
  v_exp_f32 v62, v62
  v_exp_f32 v63, v63
  v_cvt_pk_bf16_f32 v228, v56, v57
  v_cvt_pk_bf16_f32 v229, v58, v59
  v_cvt_pk_bf16_f32 v230, v60, v61
  v_cvt_pk_bf16_f32 v231, v62, v63
  v_mfma_f32_32x32x16_bf16 v[48:63], v[112:115], v[16:19], 0
  v_exp_f32 v64, v64
  v_exp_f32 v65, v65
  v_exp_f32 v66, v66
  v_exp_f32 v67, v67
  v_mfma_f32_32x32x16_bf16 v[176:191], v[108:111], v[228:231], v[176:191]
  buffer_load_dwordx4 v[96:99], v10, s[4:7], s30 offen offset:0
  v_exp_f32 v68, v68
  v_exp_f32 v69, v69
  v_exp_f32 v70, v70
  v_smfmac_f32_16x16x64_bf16 v[216:219], v[12:15], v[224:231], v11
  v_exp_f32 v71, v71
  v_mfma_f32_32x32x16_bf16 v[48:63], v[116:119], v[20:23], v[48:63]
  v_cvt_pk_bf16_f32 v224, v64, v65
  v_cvt_pk_bf16_f32 v225, v66, v67
  v_cvt_pk_bf16_f32 v226, v68, v69
  v_cvt_pk_bf16_f32 v227, v70, v71
  v_exp_f32 v72, v72
  v_exp_f32 v73, v73
  v_exp_f32 v74, v74
  v_exp_f32 v75, v75
  v_mfma_f32_32x32x16_bf16 v[192:207], v[104:107], v[224:227], v[192:207]
  v_exp_f32 v76, v76
  v_exp_f32 v77, v77
  v_exp_f32 v78, v78
  v_exp_f32 v79, v79
  v_cvt_pk_bf16_f32 v228, v72, v73
  v_cvt_pk_bf16_f32 v229, v74, v75
  v_cvt_pk_bf16_f32 v230, v76, v77
  v_cvt_pk_bf16_f32 v231, v78, v79
  s_branch .fz_kernel_a_b2
  .p2align 6
.fz_kernel_a_loop:
  v_mfma_f32_32x32x16_bf16 v[64:79], v[80:83], v[24:27], 0
  v_exp_f32 v48, v48
  v_exp_f32 v49, v49
  v_exp_f32 v50, v50
  v_exp_f32 v51, v51
  v_mfma_f32_32x32x16_bf16 v[192:207], v[140:143], v[228:231], v[192:207]
  v_exp_f32 v52, v52
  v_exp_f32 v53, v53
  v_exp_f32 v54, v54
  v_smfmac_f32_16x16x64_bf16 v[220:223], v[12:15], v[224:231], v11
  buffer_load_dwordx4 v[132:135], v10, s[4:7], s30 offen offset:1024
  v_exp_f32 v55, v55
  v_mfma_f32_32x32x16_bf16 v[64:79], v[84:87], v[28:31], v[64:79]
  s_waitcnt vmcnt(10)
  v_cvt_pk_bf16_f32 v224, v48, v49
  v_cvt_pk_bf16_f32 v225, v50, v51
  v_cvt_pk_bf16_f32 v226, v52, v53
  v_cvt_pk_bf16_f32 v227, v54, v55
  v_exp_f32 v56, v56
  v_exp_f32 v57, v57
  v_exp_f32 v58, v58
  v_exp_f32 v59, v59
  v_mfma_f32_32x32x16_bf16 v[144:159], v[88:91], v[224:227], v[144:159]
  v_exp_f32 v60, v60
  v_exp_f32 v61, v61
  v_exp_f32 v62, v62
  v_exp_f32 v63, v63
  v_cvt_pk_bf16_f32 v228, v56, v57
  v_cvt_pk_bf16_f32 v229, v58, v59
  v_cvt_pk_bf16_f32 v230, v60, v61
  v_cvt_pk_bf16_f32 v231, v62, v63
  v_mfma_f32_32x32x16_bf16 v[48:63], v[80:83], v[32:35], 0
  v_exp_f32 v64, v64
  v_exp_f32 v65, v65
  v_exp_f32 v66, v66
  v_exp_f32 v67, v67
  v_mfma_f32_32x32x16_bf16 v[144:159], v[92:95], v[228:231], v[144:159]
  v_exp_f32 v68, v68
  v_exp_f32 v69, v69
  v_exp_f32 v70, v70
  v_smfmac_f32_16x16x64_bf16 v[208:211], v[12:15], v[224:231], v11
  buffer_load_dwordx4 v[136:139], v10, s[4:7], s30 offen offset:2048
  v_exp_f32 v71, v71
  v_mfma_f32_32x32x16_bf16 v[48:63], v[84:87], v[36:39], v[48:63]
  s_ff1_i32_b32 s33, s36
  v_cvt_pk_bf16_f32 v224, v64, v65
  v_cvt_pk_bf16_f32 v225, v66, v67
  v_cvt_pk_bf16_f32 v226, v68, v69
  v_cvt_pk_bf16_f32 v227, v70, v71
  v_exp_f32 v72, v72
  v_exp_f32 v73, v73
  v_exp_f32 v74, v74
  v_exp_f32 v75, v75
  v_mfma_f32_32x32x16_bf16 v[160:175], v[88:91], v[224:227], v[160:175]
  s_bitset0_b32 s36, s33
  v_exp_f32 v76, v76
  v_exp_f32 v77, v77
  v_exp_f32 v78, v78
  v_exp_f32 v79, v79
  v_cvt_pk_bf16_f32 v228, v72, v73
  v_cvt_pk_bf16_f32 v229, v74, v75
  v_cvt_pk_bf16_f32 v230, v76, v77
  v_cvt_pk_bf16_f32 v231, v78, v79
  v_mfma_f32_32x32x16_bf16 v[64:79], v[80:83], v[40:43], 0
  s_lshl_b32 s33, s33, 14
  v_exp_f32 v48, v48
  v_exp_f32 v49, v49
  v_exp_f32 v50, v50
  v_exp_f32 v51, v51
  v_mfma_f32_32x32x16_bf16 v[160:175], v[92:95], v[228:231], v[160:175]
  v_exp_f32 v52, v52
  v_exp_f32 v53, v53
  v_exp_f32 v54, v54
  v_smfmac_f32_16x16x64_bf16 v[212:215], v[12:15], v[224:231], v11
  buffer_load_dwordx4 v[140:143], v10, s[4:7], s30 offen offset:3072
  v_exp_f32 v55, v55
  v_mfma_f32_32x32x16_bf16 v[64:79], v[84:87], v[44:47], v[64:79]
  s_add_u32 s30, s33, s35
  v_cvt_pk_bf16_f32 v224, v48, v49
  v_cvt_pk_bf16_f32 v225, v50, v51
  v_cvt_pk_bf16_f32 v226, v52, v53
  v_cvt_pk_bf16_f32 v227, v54, v55
  v_exp_f32 v56, v56
  v_exp_f32 v57, v57
  v_exp_f32 v58, v58
  v_exp_f32 v59, v59
  v_mfma_f32_32x32x16_bf16 v[176:191], v[88:91], v[224:227], v[176:191]
  s_waitcnt vmcnt(10)
  v_exp_f32 v60, v60
  v_exp_f32 v61, v61
  v_exp_f32 v62, v62
  v_exp_f32 v63, v63
  v_cvt_pk_bf16_f32 v228, v56, v57
  v_cvt_pk_bf16_f32 v229, v58, v59
  v_cvt_pk_bf16_f32 v230, v60, v61
  v_cvt_pk_bf16_f32 v231, v62, v63
  v_mfma_f32_32x32x16_bf16 v[48:63], v[96:99], v[16:19], 0
  s_cbranch_scc1 .fz_kernel_pk38c
.fz_kernel_pk38:
  v_exp_f32 v64, v64
  v_exp_f32 v65, v65
  v_exp_f32 v66, v66
  v_exp_f32 v67, v67
  v_mfma_f32_32x32x16_bf16 v[176:191], v[92:95], v[228:231], v[176:191]
  v_exp_f32 v68, v68
  v_exp_f32 v69, v69
  v_exp_f32 v70, v70
  v_smfmac_f32_16x16x64_bf16 v[216:219], v[12:15], v[224:231], v11
  buffer_load_dwordx4 v[80:83], v3, s[4:7], s30 offen offset:0
  v_exp_f32 v71, v71
  v_mfma_f32_32x32x16_bf16 v[48:63], v[100:103], v[20:23], v[48:63]
  v_cvt_pk_bf16_f32 v224, v64, v65
  v_cvt_pk_bf16_f32 v225, v66, v67
  v_cvt_pk_bf16_f32 v226, v68, v69
  v_cvt_pk_bf16_f32 v227, v70, v71
  v_exp_f32 v72, v72
  v_exp_f32 v73, v73
  v_exp_f32 v74, v74
  v_exp_f32 v75, v75
  v_mfma_f32_32x32x16_bf16 v[192:207], v[88:91], v[224:227], v[192:207]
  v_exp_f32 v76, v76
  v_exp_f32 v77, v77
  v_exp_f32 v78, v78
  v_exp_f32 v79, v79
  v_cvt_pk_bf16_f32 v228, v72, v73
  v_cvt_pk_bf16_f32 v229, v74, v75
  v_cvt_pk_bf16_f32 v230, v76, v77
  v_cvt_pk_bf16_f32 v231, v78, v79
  v_mfma_f32_32x32x16_bf16 v[64:79], v[96:99], v[24:27], 0
  v_exp_f32 v48, v48
  v_exp_f32 v49, v49
  v_exp_f32 v50, v50
  v_exp_f32 v51, v51
  v_mfma_f32_32x32x16_bf16 v[192:207], v[92:95], v[228:231], v[192:207]
  v_exp_f32 v52, v52
  v_exp_f32 v53, v53
  v_exp_f32 v54, v54
  v_smfmac_f32_16x16x64_bf16 v[220:223], v[12:15], v[224:231], v11
  buffer_load_dwordx4 v[84:87], v3, s[4:7], s30 offen offset:1024
  v_exp_f32 v55, v55
  v_mfma_f32_32x32x16_bf16 v[64:79], v[100:103], v[28:31], v[64:79]
  s_waitcnt vmcnt(10)
  v_cvt_pk_bf16_f32 v224, v48, v49
  v_cvt_pk_bf16_f32 v225, v50, v51
  v_cvt_pk_bf16_f32 v226, v52, v53
  v_cvt_pk_bf16_f32 v227, v54, v55
  v_exp_f32 v56, v56
  v_exp_f32 v57, v57
  v_exp_f32 v58, v58
  v_exp_f32 v59, v59
  v_mfma_f32_32x32x16_bf16 v[144:159], v[104:107], v[224:227], v[144:159]
  v_exp_f32 v60, v60
  v_exp_f32 v61, v61
  v_exp_f32 v62, v62
  v_exp_f32 v63, v63
  v_cvt_pk_bf16_f32 v228, v56, v57
  v_cvt_pk_bf16_f32 v229, v58, v59
  v_cvt_pk_bf16_f32 v230, v60, v61
  v_cvt_pk_bf16_f32 v231, v62, v63
  v_mfma_f32_32x32x16_bf16 v[48:63], v[96:99], v[32:35], 0
  v_exp_f32 v64, v64
  v_exp_f32 v65, v65
  v_exp_f32 v66, v66
  v_exp_f32 v67, v67
  v_mfma_f32_32x32x16_bf16 v[144:159], v[108:111], v[228:231], v[144:159]
  v_exp_f32 v68, v68
  v_exp_f32 v69, v69
  v_exp_f32 v70, v70
  v_smfmac_f32_16x16x64_bf16 v[208:211], v[12:15], v[224:231], v11
  buffer_load_dwordx4 v[88:91], v3, s[4:7], s30 offen offset:2048
  v_exp_f32 v71, v71
  v_mfma_f32_32x32x16_bf16 v[48:63], v[100:103], v[36:39], v[48:63]
  v_cvt_pk_bf16_f32 v224, v64, v65
  v_cvt_pk_bf16_f32 v225, v66, v67
  v_cvt_pk_bf16_f32 v226, v68, v69
  v_cvt_pk_bf16_f32 v227, v70, v71
  v_exp_f32 v72, v72
  v_exp_f32 v73, v73
  v_exp_f32 v74, v74
  v_exp_f32 v75, v75
  v_mfma_f32_32x32x16_bf16 v[160:175], v[104:107], v[224:227], v[160:175]
  v_exp_f32 v76, v76
  v_exp_f32 v77, v77
  v_exp_f32 v78, v78
  v_exp_f32 v79, v79
  v_cvt_pk_bf16_f32 v228, v72, v73
  v_cvt_pk_bf16_f32 v229, v74, v75
  v_cvt_pk_bf16_f32 v230, v76, v77
  v_cvt_pk_bf16_f32 v231, v78, v79
  v_mfma_f32_32x32x16_bf16 v[64:79], v[96:99], v[40:43], 0
  v_exp_f32 v48, v48
  v_exp_f32 v49, v49
  v_exp_f32 v50, v50
  v_exp_f32 v51, v51
  v_mfma_f32_32x32x16_bf16 v[160:175], v[108:111], v[228:231], v[160:175]
  v_exp_f32 v52, v52
  v_exp_f32 v53, v53
  v_exp_f32 v54, v54
  v_smfmac_f32_16x16x64_bf16 v[212:215], v[12:15], v[224:231], v11
  buffer_load_dwordx4 v[92:95], v3, s[4:7], s30 offen offset:3072
  v_exp_f32 v55, v55
  v_mfma_f32_32x32x16_bf16 v[64:79], v[100:103], v[44:47], v[64:79]
  v_cvt_pk_bf16_f32 v224, v48, v49
  v_cvt_pk_bf16_f32 v225, v50, v51
  v_cvt_pk_bf16_f32 v226, v52, v53
  v_cvt_pk_bf16_f32 v227, v54, v55
  v_exp_f32 v56, v56
  v_exp_f32 v57, v57
  v_exp_f32 v58, v58
  v_exp_f32 v59, v59
  v_mfma_f32_32x32x16_bf16 v[176:191], v[104:107], v[224:227], v[176:191]
  s_waitcnt vmcnt(10)
  v_exp_f32 v60, v60
  v_exp_f32 v61, v61
  v_exp_f32 v62, v62
  v_exp_f32 v63, v63
  v_cvt_pk_bf16_f32 v228, v56, v57
  v_cvt_pk_bf16_f32 v229, v58, v59
  v_cvt_pk_bf16_f32 v230, v60, v61
  v_cvt_pk_bf16_f32 v231, v62, v63
  v_mfma_f32_32x32x16_bf16 v[48:63], v[112:115], v[16:19], 0
  v_exp_f32 v64, v64
  v_exp_f32 v65, v65
  v_exp_f32 v66, v66
  v_exp_f32 v67, v67
  v_mfma_f32_32x32x16_bf16 v[176:191], v[108:111], v[228:231], v[176:191]
  v_exp_f32 v68, v68
  v_exp_f32 v69, v69
  v_exp_f32 v70, v70
  v_smfmac_f32_16x16x64_bf16 v[216:219], v[12:15], v[224:231], v11
  buffer_load_dwordx4 v[96:99], v10, s[4:7], s30 offen offset:0
  v_exp_f32 v71, v71
  v_mfma_f32_32x32x16_bf16 v[48:63], v[116:119], v[20:23], v[48:63]
  s_sub_u32 s32, s32, 1
  v_cvt_pk_bf16_f32 v224, v64, v65
  v_cvt_pk_bf16_f32 v225, v66, v67
  v_cvt_pk_bf16_f32 v226, v68, v69
  v_cvt_pk_bf16_f32 v227, v70, v71
  v_exp_f32 v72, v72
  v_exp_f32 v73, v73
  v_exp_f32 v74, v74
  v_exp_f32 v75, v75
  v_mfma_f32_32x32x16_bf16 v[192:207], v[104:107], v[224:227], v[192:207]
  s_cmp_eq_u32 s32, 0
  v_exp_f32 v76, v76
  v_exp_f32 v77, v77
  v_exp_f32 v78, v78
  v_exp_f32 v79, v79
  v_cvt_pk_bf16_f32 v228, v72, v73
  v_cvt_pk_bf16_f32 v229, v74, v75
  v_cvt_pk_bf16_f32 v230, v76, v77
  v_cvt_pk_bf16_f32 v231, v78, v79
  s_cbranch_scc1 .fz_kernel_a_x
.fz_kernel_a_b2:
  v_mfma_f32_32x32x16_bf16 v[64:79], v[112:115], v[24:27], 0
  v_exp_f32 v48, v48
  v_exp_f32 v49, v49
  v_exp_f32 v50, v50
  v_exp_f32 v51, v51
  v_mfma_f32_32x32x16_bf16 v[192:207], v[108:111], v[228:231], v[192:207]
  v_exp_f32 v52, v52
  v_exp_f32 v53, v53
  v_exp_f32 v54, v54
  v_smfmac_f32_16x16x64_bf16 v[220:223], v[12:15], v[224:231], v11
  buffer_load_dwordx4 v[100:103], v10, s[4:7], s30 offen offset:1024
  v_exp_f32 v55, v55
  v_mfma_f32_32x32x16_bf16 v[64:79], v[116:119], v[28:31], v[64:79]
  s_waitcnt vmcnt(10)
  v_cvt_pk_bf16_f32 v224, v48, v49
  v_cvt_pk_bf16_f32 v225, v50, v51
  v_cvt_pk_bf16_f32 v226, v52, v53
  v_cvt_pk_bf16_f32 v227, v54, v55
  v_exp_f32 v56, v56
  v_exp_f32 v57, v57
  v_exp_f32 v58, v58
  v_exp_f32 v59, v59
  v_mfma_f32_32x32x16_bf16 v[144:159], v[120:123], v[224:227], v[144:159]
  v_exp_f32 v60, v60
  v_exp_f32 v61, v61
  v_exp_f32 v62, v62
  v_exp_f32 v63, v63
  v_cvt_pk_bf16_f32 v228, v56, v57
  v_cvt_pk_bf16_f32 v229, v58, v59
  v_cvt_pk_bf16_f32 v230, v60, v61
  v_cvt_pk_bf16_f32 v231, v62, v63
  v_mfma_f32_32x32x16_bf16 v[48:63], v[112:115], v[32:35], 0
  v_exp_f32 v64, v64
  v_exp_f32 v65, v65
  v_exp_f32 v66, v66
  v_exp_f32 v67, v67
  v_mfma_f32_32x32x16_bf16 v[144:159], v[124:127], v[228:231], v[144:159]
  v_exp_f32 v68, v68
  v_exp_f32 v69, v69
  v_exp_f32 v70, v70
  v_smfmac_f32_16x16x64_bf16 v[208:211], v[12:15], v[224:231], v11
  buffer_load_dwordx4 v[104:107], v10, s[4:7], s30 offen offset:2048
  v_exp_f32 v71, v71
  v_mfma_f32_32x32x16_bf16 v[48:63], v[116:119], v[36:39], v[48:63]
  s_ff1_i32_b32 s33, s36
  v_cvt_pk_bf16_f32 v224, v64, v65
  v_cvt_pk_bf16_f32 v225, v66, v67
  v_cvt_pk_bf16_f32 v226, v68, v69
  v_cvt_pk_bf16_f32 v227, v70, v71
  v_exp_f32 v72, v72
  v_exp_f32 v73, v73
  v_exp_f32 v74, v74
  v_exp_f32 v75, v75
  v_mfma_f32_32x32x16_bf16 v[160:175], v[120:123], v[224:227], v[160:175]
  s_bitset0_b32 s36, s33
  v_exp_f32 v76, v76
  v_exp_f32 v77, v77
  v_exp_f32 v78, v78
  v_exp_f32 v79, v79
  v_cvt_pk_bf16_f32 v228, v72, v73
  v_cvt_pk_bf16_f32 v229, v74, v75
  v_cvt_pk_bf16_f32 v230, v76, v77
  v_cvt_pk_bf16_f32 v231, v78, v79
  v_mfma_f32_32x32x16_bf16 v[64:79], v[112:115], v[40:43], 0
  s_lshl_b32 s33, s33, 14
  v_exp_f32 v48, v48
  v_exp_f32 v49, v49
  v_exp_f32 v50, v50
  v_exp_f32 v51, v51
  v_mfma_f32_32x32x16_bf16 v[160:175], v[124:127], v[228:231], v[160:175]
  v_exp_f32 v52, v52
  v_exp_f32 v53, v53
  v_exp_f32 v54, v54
  v_smfmac_f32_16x16x64_bf16 v[212:215], v[12:15], v[224:231], v11
  buffer_load_dwordx4 v[108:111], v10, s[4:7], s30 offen offset:3072
  v_exp_f32 v55, v55
  v_mfma_f32_32x32x16_bf16 v[64:79], v[116:119], v[44:47], v[64:79]
  s_add_u32 s30, s33, s35
  v_cvt_pk_bf16_f32 v224, v48, v49
  v_cvt_pk_bf16_f32 v225, v50, v51
  v_cvt_pk_bf16_f32 v226, v52, v53
  v_cvt_pk_bf16_f32 v227, v54, v55
  v_exp_f32 v56, v56
  v_exp_f32 v57, v57
  v_exp_f32 v58, v58
  v_exp_f32 v59, v59
  v_mfma_f32_32x32x16_bf16 v[176:191], v[120:123], v[224:227], v[176:191]
  s_waitcnt vmcnt(10)
  v_exp_f32 v60, v60
  v_exp_f32 v61, v61
  v_exp_f32 v62, v62
  v_exp_f32 v63, v63
  v_cvt_pk_bf16_f32 v228, v56, v57
  v_cvt_pk_bf16_f32 v229, v58, v59
  v_cvt_pk_bf16_f32 v230, v60, v61
  v_cvt_pk_bf16_f32 v231, v62, v63
  v_mfma_f32_32x32x16_bf16 v[48:63], v[128:131], v[16:19], 0
  s_cbranch_scc1 .fz_kernel_pk39c
.fz_kernel_pk39:
  v_exp_f32 v64, v64
  v_exp_f32 v65, v65
  v_exp_f32 v66, v66
  v_exp_f32 v67, v67
  v_mfma_f32_32x32x16_bf16 v[176:191], v[124:127], v[228:231], v[176:191]
  v_exp_f32 v68, v68
  v_exp_f32 v69, v69
  v_exp_f32 v70, v70
  v_smfmac_f32_16x16x64_bf16 v[216:219], v[12:15], v[224:231], v11
  buffer_load_dwordx4 v[112:115], v3, s[4:7], s30 offen offset:0
  v_exp_f32 v71, v71
  v_mfma_f32_32x32x16_bf16 v[48:63], v[132:135], v[20:23], v[48:63]
  v_cvt_pk_bf16_f32 v224, v64, v65
  v_cvt_pk_bf16_f32 v225, v66, v67
  v_cvt_pk_bf16_f32 v226, v68, v69
  v_cvt_pk_bf16_f32 v227, v70, v71
  v_exp_f32 v72, v72
  v_exp_f32 v73, v73
  v_exp_f32 v74, v74
  v_exp_f32 v75, v75
  v_mfma_f32_32x32x16_bf16 v[192:207], v[120:123], v[224:227], v[192:207]
  v_exp_f32 v76, v76
  v_exp_f32 v77, v77
  v_exp_f32 v78, v78
  v_exp_f32 v79, v79
  v_cvt_pk_bf16_f32 v228, v72, v73
  v_cvt_pk_bf16_f32 v229, v74, v75
  v_cvt_pk_bf16_f32 v230, v76, v77
  v_cvt_pk_bf16_f32 v231, v78, v79
  v_mfma_f32_32x32x16_bf16 v[64:79], v[128:131], v[24:27], 0
  v_exp_f32 v48, v48
  v_exp_f32 v49, v49
  v_exp_f32 v50, v50
  v_exp_f32 v51, v51
  v_mfma_f32_32x32x16_bf16 v[192:207], v[124:127], v[228:231], v[192:207]
  v_exp_f32 v52, v52
  v_exp_f32 v53, v53
  v_exp_f32 v54, v54
  v_smfmac_f32_16x16x64_bf16 v[220:223], v[12:15], v[224:231], v11
  buffer_load_dwordx4 v[116:119], v3, s[4:7], s30 offen offset:1024
  v_exp_f32 v55, v55
  v_mfma_f32_32x32x16_bf16 v[64:79], v[132:135], v[28:31], v[64:79]
  s_waitcnt vmcnt(10)
  v_cvt_pk_bf16_f32 v224, v48, v49
  v_cvt_pk_bf16_f32 v225, v50, v51
  v_cvt_pk_bf16_f32 v226, v52, v53
  v_cvt_pk_bf16_f32 v227, v54, v55
  v_exp_f32 v56, v56
  v_exp_f32 v57, v57
  v_exp_f32 v58, v58
  v_exp_f32 v59, v59
  v_mfma_f32_32x32x16_bf16 v[144:159], v[136:139], v[224:227], v[144:159]
  v_exp_f32 v60, v60
  v_exp_f32 v61, v61
  v_exp_f32 v62, v62
  v_exp_f32 v63, v63
  v_cvt_pk_bf16_f32 v228, v56, v57
  v_cvt_pk_bf16_f32 v229, v58, v59
  v_cvt_pk_bf16_f32 v230, v60, v61
  v_cvt_pk_bf16_f32 v231, v62, v63
  v_mfma_f32_32x32x16_bf16 v[48:63], v[128:131], v[32:35], 0
  v_exp_f32 v64, v64
  v_exp_f32 v65, v65
  v_exp_f32 v66, v66
  v_exp_f32 v67, v67
  v_mfma_f32_32x32x16_bf16 v[144:159], v[140:143], v[228:231], v[144:159]
  v_exp_f32 v68, v68
  v_exp_f32 v69, v69
  v_exp_f32 v70, v70
  v_smfmac_f32_16x16x64_bf16 v[208:211], v[12:15], v[224:231], v11
  buffer_load_dwordx4 v[120:123], v3, s[4:7], s30 offen offset:2048
  v_exp_f32 v71, v71
  v_mfma_f32_32x32x16_bf16 v[48:63], v[132:135], v[36:39], v[48:63]
  v_cvt_pk_bf16_f32 v224, v64, v65
  v_cvt_pk_bf16_f32 v225, v66, v67
  v_cvt_pk_bf16_f32 v226, v68, v69
  v_cvt_pk_bf16_f32 v227, v70, v71
  v_exp_f32 v72, v72
  v_exp_f32 v73, v73
  v_exp_f32 v74, v74
  v_exp_f32 v75, v75
  v_mfma_f32_32x32x16_bf16 v[160:175], v[136:139], v[224:227], v[160:175]
  v_exp_f32 v76, v76
  v_exp_f32 v77, v77
  v_exp_f32 v78, v78
  v_exp_f32 v79, v79
  v_cvt_pk_bf16_f32 v228, v72, v73
  v_cvt_pk_bf16_f32 v229, v74, v75
  v_cvt_pk_bf16_f32 v230, v76, v77
  v_cvt_pk_bf16_f32 v231, v78, v79
  v_mfma_f32_32x32x16_bf16 v[64:79], v[128:131], v[40:43], 0
  v_exp_f32 v48, v48
  v_exp_f32 v49, v49
  v_exp_f32 v50, v50
  v_exp_f32 v51, v51
  v_mfma_f32_32x32x16_bf16 v[160:175], v[140:143], v[228:231], v[160:175]
  v_exp_f32 v52, v52
  v_exp_f32 v53, v53
  v_exp_f32 v54, v54
  v_smfmac_f32_16x16x64_bf16 v[212:215], v[12:15], v[224:231], v11
  buffer_load_dwordx4 v[124:127], v3, s[4:7], s30 offen offset:3072
  v_exp_f32 v55, v55
  v_mfma_f32_32x32x16_bf16 v[64:79], v[132:135], v[44:47], v[64:79]
  v_cvt_pk_bf16_f32 v224, v48, v49
  v_cvt_pk_bf16_f32 v225, v50, v51
  v_cvt_pk_bf16_f32 v226, v52, v53
  v_cvt_pk_bf16_f32 v227, v54, v55
  v_exp_f32 v56, v56
  v_exp_f32 v57, v57
  v_exp_f32 v58, v58
  v_exp_f32 v59, v59
  v_mfma_f32_32x32x16_bf16 v[176:191], v[136:139], v[224:227], v[176:191]
  s_waitcnt vmcnt(10)
  v_exp_f32 v60, v60
  v_exp_f32 v61, v61
  v_exp_f32 v62, v62
  v_exp_f32 v63, v63
  v_cvt_pk_bf16_f32 v228, v56, v57
  v_cvt_pk_bf16_f32 v229, v58, v59
  v_cvt_pk_bf16_f32 v230, v60, v61
  v_cvt_pk_bf16_f32 v231, v62, v63
  v_mfma_f32_32x32x16_bf16 v[48:63], v[80:83], v[16:19], 0
  v_exp_f32 v64, v64
  v_exp_f32 v65, v65
  v_exp_f32 v66, v66
  v_exp_f32 v67, v67
  v_mfma_f32_32x32x16_bf16 v[176:191], v[140:143], v[228:231], v[176:191]
  v_exp_f32 v68, v68
  v_exp_f32 v69, v69
  v_exp_f32 v70, v70
  v_smfmac_f32_16x16x64_bf16 v[216:219], v[12:15], v[224:231], v11
  buffer_load_dwordx4 v[128:131], v10, s[4:7], s30 offen offset:0
  v_exp_f32 v71, v71
  v_mfma_f32_32x32x16_bf16 v[48:63], v[84:87], v[20:23], v[48:63]
  v_cvt_pk_bf16_f32 v224, v64, v65
  v_cvt_pk_bf16_f32 v225, v66, v67
  v_cvt_pk_bf16_f32 v226, v68, v69
  v_cvt_pk_bf16_f32 v227, v70, v71
  v_exp_f32 v72, v72
  v_exp_f32 v73, v73
  v_exp_f32 v74, v74
  v_exp_f32 v75, v75
  v_mfma_f32_32x32x16_bf16 v[192:207], v[136:139], v[224:227], v[192:207]
  v_exp_f32 v76, v76
  v_exp_f32 v77, v77
  v_exp_f32 v78, v78
  v_exp_f32 v79, v79
  v_cvt_pk_bf16_f32 v228, v72, v73
  v_cvt_pk_bf16_f32 v229, v74, v75
  v_cvt_pk_bf16_f32 v230, v76, v77
  v_cvt_pk_bf16_f32 v231, v78, v79
  s_branch .fz_kernel_a_loop
.fz_kernel_a_x:
  s_waitcnt vmcnt(7)
  v_mfma_f32_32x32x16_bf16 v[64:79], v[128:131], v[16:19], 0
  v_exp_f32 v48, v48
  v_exp_f32 v49, v49
  v_exp_f32 v50, v50
  v_exp_f32 v51, v51
  v_mfma_f32_32x32x16_bf16 v[192:207], v[108:111], v[228:231], v[192:207]
  v_exp_f32 v52, v52
  v_exp_f32 v53, v53
  v_exp_f32 v54, v54
  v_smfmac_f32_16x16x64_bf16 v[220:223], v[12:15], v[224:231], v11
  v_exp_f32 v55, v55
  v_mfma_f32_32x32x16_bf16 v[64:79], v[132:135], v[20:23], v[64:79]
  s_waitcnt vmcnt(5)
  v_cvt_pk_bf16_f32 v224, v48, v49
  v_cvt_pk_bf16_f32 v225, v50, v51
  v_cvt_pk_bf16_f32 v226, v52, v53
  v_cvt_pk_bf16_f32 v227, v54, v55
  v_exp_f32 v56, v56
  v_exp_f32 v57, v57
  v_exp_f32 v58, v58
  v_exp_f32 v59, v59
  v_mfma_f32_32x32x16_bf16 v[144:159], v[120:123], v[224:227], v[144:159]
  v_exp_f32 v60, v60
  v_exp_f32 v61, v61
  v_exp_f32 v62, v62
  v_exp_f32 v63, v63
  v_cvt_pk_bf16_f32 v228, v56, v57
  v_cvt_pk_bf16_f32 v229, v58, v59
  v_cvt_pk_bf16_f32 v230, v60, v61
  v_cvt_pk_bf16_f32 v231, v62, v63
  v_mfma_f32_32x32x16_bf16 v[48:63], v[112:115], v[24:27], 0
  v_exp_f32 v64, v64
  v_exp_f32 v65, v65
  v_exp_f32 v66, v66
  v_exp_f32 v67, v67
  v_mfma_f32_32x32x16_bf16 v[144:159], v[124:127], v[228:231], v[144:159]
  v_exp_f32 v68, v68
  v_exp_f32 v69, v69
  v_exp_f32 v70, v70
  v_smfmac_f32_16x16x64_bf16 v[208:211], v[12:15], v[224:231], v11
  v_exp_f32 v71, v71
  v_mfma_f32_32x32x16_bf16 v[48:63], v[116:119], v[28:31], v[48:63]
  v_cvt_pk_bf16_f32 v224, v64, v65
  v_cvt_pk_bf16_f32 v225, v66, v67
  v_cvt_pk_bf16_f32 v226, v68, v69
  v_cvt_pk_bf16_f32 v227, v70, v71
  v_exp_f32 v72, v72
  v_exp_f32 v73, v73
  v_exp_f32 v74, v74
  v_exp_f32 v75, v75
  v_mfma_f32_32x32x16_bf16 v[144:159], v[136:139], v[224:227], v[144:159]
  v_exp_f32 v76, v76
  v_exp_f32 v77, v77
  v_exp_f32 v78, v78
  v_exp_f32 v79, v79
  v_cvt_pk_bf16_f32 v228, v72, v73
  v_cvt_pk_bf16_f32 v229, v74, v75
  v_cvt_pk_bf16_f32 v230, v76, v77
  v_cvt_pk_bf16_f32 v231, v78, v79
  v_mfma_f32_32x32x16_bf16 v[64:79], v[128:131], v[24:27], 0
  v_exp_f32 v48, v48
  v_exp_f32 v49, v49
  v_exp_f32 v50, v50
  v_exp_f32 v51, v51
  v_mfma_f32_32x32x16_bf16 v[144:159], v[140:143], v[228:231], v[144:159]
  v_exp_f32 v52, v52
  v_exp_f32 v53, v53
  v_exp_f32 v54, v54
  v_smfmac_f32_16x16x64_bf16 v[208:211], v[12:15], v[224:231], v11
  v_exp_f32 v55, v55
  v_mfma_f32_32x32x16_bf16 v[64:79], v[132:135], v[28:31], v[64:79]
  v_cvt_pk_bf16_f32 v224, v48, v49
  v_cvt_pk_bf16_f32 v225, v50, v51
  v_cvt_pk_bf16_f32 v226, v52, v53
  v_cvt_pk_bf16_f32 v227, v54, v55
  v_exp_f32 v56, v56
  v_exp_f32 v57, v57
  v_exp_f32 v58, v58
  v_exp_f32 v59, v59
  v_mfma_f32_32x32x16_bf16 v[160:175], v[120:123], v[224:227], v[160:175]
  v_exp_f32 v60, v60
  v_exp_f32 v61, v61
  v_exp_f32 v62, v62
  v_exp_f32 v63, v63
  v_cvt_pk_bf16_f32 v228, v56, v57
  v_cvt_pk_bf16_f32 v229, v58, v59
  v_cvt_pk_bf16_f32 v230, v60, v61
  v_cvt_pk_bf16_f32 v231, v62, v63
  v_cvt_pk_bf16_f32 v144, v144, v145
  v_cvt_pk_bf16_f32 v145, v146, v147
  v_cvt_pk_bf16_f32 v146, v148, v149
  v_cvt_pk_bf16_f32 v147, v150, v151
  ds_write_b128 v9, v[144:147] offset:0
  v_cvt_pk_bf16_f32 v148, v152, v153
  v_cvt_pk_bf16_f32 v149, v154, v155
  v_cvt_pk_bf16_f32 v150, v156, v157
  v_cvt_pk_bf16_f32 v151, v158, v159
  ds_write_b128 v9, v[148:151] offset:1024
  v_add_f32 v208, v208, v210
  v_add_f32 v209, v209, v211
  v_cndmask_b32 v30, v208, v209, s[20:21]
  v_mfma_f32_32x32x16_bf16 v[48:63], v[112:115], v[32:35], 0
  v_exp_f32 v64, v64
  v_exp_f32 v65, v65
  v_exp_f32 v66, v66
  v_exp_f32 v67, v67
  v_mfma_f32_32x32x16_bf16 v[160:175], v[124:127], v[228:231], v[160:175]
  v_exp_f32 v68, v68
  v_exp_f32 v69, v69
  v_exp_f32 v70, v70
  v_smfmac_f32_16x16x64_bf16 v[212:215], v[12:15], v[224:231], v11
  v_exp_f32 v71, v71
  v_mfma_f32_32x32x16_bf16 v[48:63], v[116:119], v[36:39], v[48:63]
  v_cvt_pk_bf16_f32 v224, v64, v65
  v_cvt_pk_bf16_f32 v225, v66, v67
  v_cvt_pk_bf16_f32 v226, v68, v69
  v_cvt_pk_bf16_f32 v227, v70, v71
  v_exp_f32 v72, v72
  v_exp_f32 v73, v73
  v_exp_f32 v74, v74
  v_exp_f32 v75, v75
  v_mfma_f32_32x32x16_bf16 v[160:175], v[136:139], v[224:227], v[160:175]
  v_exp_f32 v76, v76
  v_exp_f32 v77, v77
  v_exp_f32 v78, v78
  v_exp_f32 v79, v79
  v_cvt_pk_bf16_f32 v228, v72, v73
  v_cvt_pk_bf16_f32 v229, v74, v75
  v_cvt_pk_bf16_f32 v230, v76, v77
  v_cvt_pk_bf16_f32 v231, v78, v79
  v_mfma_f32_32x32x16_bf16 v[64:79], v[128:131], v[32:35], 0
  v_exp_f32 v48, v48
  v_exp_f32 v49, v49
  v_exp_f32 v50, v50
  v_exp_f32 v51, v51
  v_mfma_f32_32x32x16_bf16 v[160:175], v[140:143], v[228:231], v[160:175]
  v_exp_f32 v52, v52
  v_exp_f32 v53, v53
  v_exp_f32 v54, v54
  v_smfmac_f32_16x16x64_bf16 v[212:215], v[12:15], v[224:231], v11
  v_exp_f32 v55, v55
  v_mfma_f32_32x32x16_bf16 v[64:79], v[132:135], v[36:39], v[64:79]
  v_cvt_pk_bf16_f32 v224, v48, v49
  v_cvt_pk_bf16_f32 v225, v50, v51
  v_cvt_pk_bf16_f32 v226, v52, v53
  v_cvt_pk_bf16_f32 v227, v54, v55
  v_exp_f32 v56, v56
  v_exp_f32 v57, v57
  v_exp_f32 v58, v58
  v_exp_f32 v59, v59
  v_mfma_f32_32x32x16_bf16 v[176:191], v[120:123], v[224:227], v[176:191]
  v_exp_f32 v60, v60
  v_exp_f32 v61, v61
  v_exp_f32 v62, v62
  v_exp_f32 v63, v63
  v_cvt_pk_bf16_f32 v228, v56, v57
  v_cvt_pk_bf16_f32 v229, v58, v59
  v_cvt_pk_bf16_f32 v230, v60, v61
  v_cvt_pk_bf16_f32 v231, v62, v63
  v_cvt_pk_bf16_f32 v160, v160, v161
  v_cvt_pk_bf16_f32 v161, v162, v163
  v_cvt_pk_bf16_f32 v162, v164, v165
  v_cvt_pk_bf16_f32 v163, v166, v167
  ds_write_b128 v9, v[160:163] offset:2048
  v_cvt_pk_bf16_f32 v164, v168, v169
  v_cvt_pk_bf16_f32 v165, v170, v171
  v_cvt_pk_bf16_f32 v166, v172, v173
  v_cvt_pk_bf16_f32 v167, v174, v175
  ds_write_b128 v9, v[164:167] offset:3072
  v_add_f32 v212, v212, v214
  v_add_f32 v213, v213, v215
  v_cndmask_b32 v31, v212, v213, s[20:21]
  ds_write_b64 v1, v[30:31]
  v_xor_b32 v1, 512, v1
  v_mfma_f32_32x32x16_bf16 v[48:63], v[112:115], v[40:43], 0
  v_exp_f32 v64, v64
  v_exp_f32 v65, v65
  v_exp_f32 v66, v66
  v_exp_f32 v67, v67
  v_mfma_f32_32x32x16_bf16 v[176:191], v[124:127], v[228:231], v[176:191]
  v_exp_f32 v68, v68
  v_exp_f32 v69, v69
  v_exp_f32 v70, v70
  v_smfmac_f32_16x16x64_bf16 v[216:219], v[12:15], v[224:231], v11
  s_waitcnt vmcnt(0) lgkmcnt(0)
  s_barrier
  ds_read_b128 v[80:83], v8 offset:0
  ds_read_b128 v[84:87], v8 offset:1024
  ds_read_b128 v[88:91], v8 offset:2048
  ds_read_b128 v[92:95], v8 offset:3072
  ds_read_b64 v[30:31], v1
  v_exp_f32 v71, v71
  v_mfma_f32_32x32x16_bf16 v[48:63], v[116:119], v[44:47], v[48:63]
  v_cvt_pk_bf16_f32 v224, v64, v65
  v_cvt_pk_bf16_f32 v225, v66, v67
  v_cvt_pk_bf16_f32 v226, v68, v69
  v_cvt_pk_bf16_f32 v227, v70, v71
  v_exp_f32 v72, v72
  v_exp_f32 v73, v73
  v_exp_f32 v74, v74
  v_exp_f32 v75, v75
  v_mfma_f32_32x32x16_bf16 v[176:191], v[136:139], v[224:227], v[176:191]
  v_exp_f32 v76, v76
  v_exp_f32 v77, v77
  s_waitcnt lgkmcnt(0)
  v_mfma_f32_32x32x16_bf16 v[176:191], v[248:251], v[80:83], v[176:191]
  v_exp_f32 v78, v78
  v_exp_f32 v79, v79
  v_mfma_f32_32x32x16_bf16 v[176:191], v[252:255], v[84:87], v[176:191]
  v_cvt_pk_bf16_f32 v228, v72, v73
  v_cvt_pk_bf16_f32 v229, v74, v75
  v_cvt_pk_bf16_f32 v230, v76, v77
  v_cvt_pk_bf16_f32 v231, v78, v79
  v_mfma_f32_32x32x16_bf16 v[64:79], v[128:131], v[40:43], 0
  v_exp_f32 v48, v48
  v_exp_f32 v49, v49
  v_exp_f32 v50, v50
  v_exp_f32 v51, v51
  v_mfma_f32_32x32x16_bf16 v[176:191], v[140:143], v[228:231], v[176:191]
  v_exp_f32 v52, v52
  v_exp_f32 v53, v53
  v_exp_f32 v54, v54
  v_smfmac_f32_16x16x64_bf16 v[216:219], v[12:15], v[224:231], v11
  v_exp_f32 v55, v55
  v_mfma_f32_32x32x16_bf16 v[64:79], v[132:135], v[44:47], v[64:79]
  v_cvt_pk_bf16_f32 v224, v48, v49
  v_cvt_pk_bf16_f32 v225, v50, v51
  v_cvt_pk_bf16_f32 v226, v52, v53
  v_cvt_pk_bf16_f32 v227, v54, v55
  v_exp_f32 v56, v56
  v_exp_f32 v57, v57
  v_exp_f32 v58, v58
  v_exp_f32 v59, v59
  s_nop 1
  v_add_f32 v216, v216, v218
  v_add_f32 v217, v217, v219
  v_cndmask_b32 v24, v216, v217, s[20:21]
  v_add_f32 v24, v24, v30
  s_mov_b64 s[36:37], -1
  v_rcp_f32 v26, v24
  v_cmp_le_f32 vcc, s24, v24
  s_and_b64 s[36:37], s[36:37], vcc
  v_cmp_ge_f32 vcc, s25, v24
  s_and_b64 s[36:37], s[36:37], vcc
  v_pk_mul_f32 v[176:177], v[176:177], v[26:27] op_sel_hi:[1,0]
  v_pk_mul_f32 v[178:179], v[178:179], v[26:27] op_sel_hi:[1,0]
  v_pk_mul_f32 v[180:181], v[180:181], v[26:27] op_sel_hi:[1,0]
  v_pk_mul_f32 v[182:183], v[182:183], v[26:27] op_sel_hi:[1,0]
  v_cvt_pk_bf16_f32 v80, v176, v177
  v_cvt_pk_bf16_f32 v81, v178, v179
  v_cvt_pk_bf16_f32 v82, v180, v181
  v_cvt_pk_bf16_f32 v83, v182, v183
  buffer_store_dwordx4 v[80:83], v3, s[4:7], s8 offen offset:0 sc1
  v_pk_mul_f32 v[184:185], v[184:185], v[26:27] op_sel_hi:[1,0]
  v_pk_mul_f32 v[186:187], v[186:187], v[26:27] op_sel_hi:[1,0]
  v_pk_mul_f32 v[188:189], v[188:189], v[26:27] op_sel_hi:[1,0]
  v_pk_mul_f32 v[190:191], v[190:191], v[26:27] op_sel_hi:[1,0]
  v_cvt_pk_bf16_f32 v84, v184, v185
  v_cvt_pk_bf16_f32 v85, v186, v187
  v_cvt_pk_bf16_f32 v86, v188, v189
  v_cvt_pk_bf16_f32 v87, v190, v191
  buffer_store_dwordx4 v[84:87], v3, s[4:7], s8 offen offset:1024 sc1
  v_mfma_f32_32x32x16_bf16 v[192:207], v[120:123], v[224:227], v[192:207]
  v_exp_f32 v60, v60
  v_exp_f32 v61, v61
  v_exp_f32 v62, v62
  v_exp_f32 v63, v63
  v_cvt_pk_bf16_f32 v228, v56, v57
  v_cvt_pk_bf16_f32 v229, v58, v59
  v_cvt_pk_bf16_f32 v230, v60, v61
  v_cvt_pk_bf16_f32 v231, v62, v63
  v_mfma_f32_32x32x16_bf16 v[192:207], v[248:251], v[88:91], v[192:207]
  v_exp_f32 v64, v64
  v_exp_f32 v65, v65
  v_exp_f32 v66, v66
  v_exp_f32 v67, v67
  v_mfma_f32_32x32x16_bf16 v[192:207], v[124:127], v[228:231], v[192:207]
  v_exp_f32 v68, v68
  v_exp_f32 v69, v69
  v_exp_f32 v70, v70
  v_smfmac_f32_16x16x64_bf16 v[220:223], v[12:15], v[224:231], v11
  v_exp_f32 v71, v71
  v_mfma_f32_32x32x16_bf16 v[192:207], v[252:255], v[92:95], v[192:207]
  v_cvt_pk_bf16_f32 v224, v64, v65
  v_cvt_pk_bf16_f32 v225, v66, v67
  v_cvt_pk_bf16_f32 v226, v68, v69
  v_cvt_pk_bf16_f32 v227, v70, v71
  v_exp_f32 v72, v72
  v_exp_f32 v73, v73
  v_exp_f32 v74, v74
  v_exp_f32 v75, v75
  v_mfma_f32_32x32x16_bf16 v[192:207], v[136:139], v[224:227], v[192:207]
  v_exp_f32 v76, v76
  v_exp_f32 v77, v77
  v_exp_f32 v78, v78
  v_exp_f32 v79, v79
  v_cvt_pk_bf16_f32 v228, v72, v73
  v_cvt_pk_bf16_f32 v229, v74, v75
  v_cvt_pk_bf16_f32 v230, v76, v77
  v_cvt_pk_bf16_f32 v231, v78, v79
  s_nop 1
  v_smfmac_f32_16x16x64_bf16 v[220:223], v[12:15], v[224:231], v11
  v_mfma_f32_32x32x16_bf16 v[192:207], v[140:143], v[228:231], v[192:207]
  s_nop 10
  v_add_f32 v220, v220, v222
  v_add_f32 v221, v221, v223
  v_cndmask_b32 v25, v220, v221, s[20:21]
  v_add_f32 v25, v25, v31
.fz_kernel_a_fin:
  v_rcp_f32 v28, v25
  v_cmp_le_f32 vcc, s24, v25
  s_and_b64 s[36:37], s[36:37], vcc
  v_cmp_ge_f32 vcc, s25, v25
  s_and_b64 s[36:37], s[36:37], vcc
  v_pk_mul_f32 v[192:193], v[192:193], v[28:29] op_sel_hi:[1,0]
  v_pk_mul_f32 v[194:195], v[194:195], v[28:29] op_sel_hi:[1,0]
  v_pk_mul_f32 v[196:197], v[196:197], v[28:29] op_sel_hi:[1,0]
  v_pk_mul_f32 v[198:199], v[198:199], v[28:29] op_sel_hi:[1,0]
  v_cvt_pk_bf16_f32 v88, v192, v193
  v_cvt_pk_bf16_f32 v89, v194, v195
  v_cvt_pk_bf16_f32 v90, v196, v197
  v_cvt_pk_bf16_f32 v91, v198, v199
  buffer_store_dwordx4 v[88:91], v3, s[4:7], s9 offen offset:0 sc1
  v_pk_mul_f32 v[200:201], v[200:201], v[28:29] op_sel_hi:[1,0]
  v_pk_mul_f32 v[202:203], v[202:203], v[28:29] op_sel_hi:[1,0]
  v_pk_mul_f32 v[204:205], v[204:205], v[28:29] op_sel_hi:[1,0]
  v_pk_mul_f32 v[206:207], v[206:207], v[28:29] op_sel_hi:[1,0]
  v_cvt_pk_bf16_f32 v92, v200, v201
  v_cvt_pk_bf16_f32 v93, v202, v203
  v_cvt_pk_bf16_f32 v94, v204, v205
  v_cvt_pk_bf16_f32 v95, v206, v207
  buffer_store_dwordx4 v[92:95], v3, s[4:7], s9 offen offset:1024 sc1
  ds_read_b32 v7, v6 offset:8
  v_pk_fma_f32 v[64:65], v[176:177], 0, 0 op_sel_hi:[1,0,0]
  v_pk_fma_f32 v[66:67], v[178:179], 0, 0 op_sel_hi:[1,0,0]
  v_pk_fma_f32 v[64:65], v[180:181], 0, v[64:65] op_sel_hi:[1,0,1]
  v_pk_fma_f32 v[66:67], v[182:183], 0, v[66:67] op_sel_hi:[1,0,1]
  v_pk_fma_f32 v[64:65], v[184:185], 0, v[64:65] op_sel_hi:[1,0,1]
  v_pk_fma_f32 v[66:67], v[186:187], 0, v[66:67] op_sel_hi:[1,0,1]
  v_pk_fma_f32 v[64:65], v[188:189], 0, v[64:65] op_sel_hi:[1,0,1]
  v_pk_fma_f32 v[66:67], v[190:191], 0, v[66:67] op_sel_hi:[1,0,1]
  v_pk_fma_f32 v[64:65], v[192:193], 0, v[64:65] op_sel_hi:[1,0,1]
  v_pk_fma_f32 v[66:67], v[194:195], 0, v[66:67] op_sel_hi:[1,0,1]
  v_pk_fma_f32 v[64:65], v[196:197], 0, v[64:65] op_sel_hi:[1,0,1]
  v_pk_fma_f32 v[66:67], v[198:199], 0, v[66:67] op_sel_hi:[1,0,1]
  v_pk_fma_f32 v[64:65], v[200:201], 0, v[64:65] op_sel_hi:[1,0,1]
  v_pk_fma_f32 v[66:67], v[202:203], 0, v[66:67] op_sel_hi:[1,0,1]
  v_pk_fma_f32 v[64:65], v[204:205], 0, v[64:65] op_sel_hi:[1,0,1]
  v_pk_fma_f32 v[66:67], v[206:207], 0, v[66:67] op_sel_hi:[1,0,1]
  v_pk_add_f32 v[64:65], v[64:65], v[66:67]
  v_cmp_o_f32 vcc, v64, v65
  s_and_b64 s[36:37], s[36:37], vcc
  s_cmp_eq_u64 s[36:37], -1
  s_cbranch_scc0 .fz_kernel_a_slow
.fz_kernel_a_ok:
  s_mov_b32 s8, s48
  s_mov_b32 s9, s49
  s_mov_b32 s10, 0x800
  s_mov_b32 s11, 0x00020000
  v_lshrrev_b32 v17, 5, v2
  v_lshlrev_b32 v19, 4, v17
  s_lshl_b32 s22, s18, 7
  s_lshl2_add_u32 s32, s17, s16
  s_lshl_b32 s35, s32, 16
  s_add_u32 s35, s35, s64
  s_mov_b32 s34, 0
  s_and_b32 s28, s18, 3
  s_mul_i32 s28, s28, 0
  v_add_u32 v6, 8, v6
  buffer_load_dwordx4 v[48:51], v19, s[8:11], s22 offen offset:0
  buffer_load_dwordx4 v[52:55], v19, s[8:11], s22 offen offset:32
  buffer_load_dwordx4 v[56:59], v19, s[8:11], s22 offen offset:64
  buffer_load_dwordx4 v[60:63], v19, s[8:11], s22 offen offset:96
  s_waitcnt lgkmcnt(0)
  v_readfirstlane_b32 s36, v7
  s_bcnt1_i32_b32 s29, s36
  s_cmp_lt_u32 s29, 2
  s_cbranch_scc1 .fz_kernel_w_e0
  s_andn2_b32 s33, s36, s34
  s_cbranch_scc0 .fz_kernel_pk48c
.fz_kernel_pk48:
  s_ff1_i32_b32 s33, s33
  s_bitset1_b32 s34, s33
  s_lshl_b32 s20, s33, 13
  s_lshl_b32 s33, s33, 12
  s_add_u32 s30, s33, s35
  buffer_load_dwordx4 v[96:99], v3, s[4:7], s30 offen offset:0
  buffer_load_dwordx4 v[100:103], v3, s[4:7], s30 offen offset:1024
  buffer_load_dwordx4 v[104:107], v3, s[4:7], s30 offen offset:2048
  buffer_load_dwordx4 v[108:111], v3, s[4:7], s30 offen offset:3072
  s_andn2_b32 s33, s36, s34
  s_cbranch_scc0 .fz_kernel_pk49c
.fz_kernel_pk49:
  s_ff1_i32_b32 s33, s33
  s_bitset1_b32 s34, s33
  s_lshl_b32 s21, s33, 13
  s_lshl_b32 s33, s33, 12
  s_add_u32 s30, s33, s35
  buffer_load_dwordx4 v[112:115], v3, s[4:7], s30 offen offset:0
  buffer_load_dwordx4 v[116:119], v3, s[4:7], s30 offen offset:1024
  buffer_load_dwordx4 v[120:123], v3, s[4:7], s30 offen offset:2048
  buffer_load_dwordx4 v[124:127], v3, s[4:7], s30 offen offset:3072
.fz_kernel_w_e0:
  v_and_b32 v18, 31, v2
  s_lshl_b32 s39, s17, 4
  s_add_u32 s39, s39, s18
  s_lshl_b32 s39, s39, 2
  s_add_u32 s39, s39, s16
  s_lshl_b32 s39, s39, 12
  v_and_b32 v16, 16, v2
  v_lshlrev_b32 v16, 7, v16
  v_lshl_add_u32 v16, v17, 8, v16
  v_and_b32 v1, 0xf0, v3
  v_add_u32 v16, v16, v1
  s_add_u32 s39, s39, s65
  s_lshl_b32 s31, s16, 5
  v_add_u32 v45, s31, v18
  v_lshlrev_b32 v11, 2, v45
  v_add_u32 v11, 155648, v11
  v_mov_b32 v44, 159952
  ds_read_b32 v40, v11 offset:6400
  ds_read_b32 v42, v11 offset:6912
  ds_read_b32 v46, v44 offset:8
  ds_read_b32 v44, v44
  v_mov_b32 v47, 0.32768
  v_add_u32 v45, 1, v45
  v_bfe_u32 v11, v2, 2, 2
  v_lshl_add_u32 v12, v17, 2, v11
  v_lshlrev_b32 v12, 7, v12
  v_lshrrev_b32 v13, 1, v11
  v_lshl_add_u32 v12, v13, 6, v12
  v_bfe_u32 v13, v2, 4, 1
  v_lshl_add_u32 v12, v13, 5, v12
  v_and_b32 v13, 1, v2
  v_lshl_add_u32 v12, v13, 4, v12
  v_bfe_u32 v13, v2, 1, 1
  v_lshl_add_u32 v14, v13, 3, v12
  v_xor_b32 v15, 64, v14
  s_mov_b64 exec, 1
  s_cmp_lt_u32 s29, 2
  s_cbranch_scc1 .fz_kernel_w_e1
  s_waitcnt vmcnt(12)
  s_branch .fz_kernel_w_e3
.fz_kernel_w_e1:
  s_waitcnt vmcnt(4)
.fz_kernel_w_e3:
  ds_add_u32 v6, v5 offset:0x100
  s_mov_b64 exec, -1
  v_lshlrev_b32 v64, 16, v232
  v_and_b32 v65, 0xffff0000, v232
  v_lshlrev_b32 v66, 16, v233
  v_and_b32 v67, 0xffff0000, v233
  v_lshlrev_b32 v68, 16, v234
  v_and_b32 v69, 0xffff0000, v234
  v_lshlrev_b32 v70, 16, v235
  v_and_b32 v71, 0xffff0000, v235
  v_lshlrev_b32 v72, 16, v236
  v_and_b32 v73, 0xffff0000, v236
  v_lshlrev_b32 v74, 16, v237
  v_and_b32 v75, 0xffff0000, v237
  v_lshlrev_b32 v76, 16, v238
  v_and_b32 v77, 0xffff0000, v238
  v_lshlrev_b32 v78, 16, v239
  v_and_b32 v79, 0xffff0000, v239
  v_lshlrev_b32 v80, 16, v240
  v_and_b32 v81, 0xffff0000, v240
  v_lshlrev_b32 v82, 16, v241
  v_and_b32 v83, 0xffff0000, v241
  v_lshlrev_b32 v84, 16, v242
  v_and_b32 v85, 0xffff0000, v242
  v_lshlrev_b32 v86, 16, v243
  v_and_b32 v87, 0xffff0000, v243
  v_lshlrev_b32 v88, 16, v244
  v_and_b32 v89, 0xffff0000, v244
  v_lshlrev_b32 v90, 16, v245
  v_and_b32 v91, 0xffff0000, v245
  v_lshlrev_b32 v92, 16, v246
  v_and_b32 v93, 0xffff0000, v246
  v_lshlrev_b32 v94, 16, v247
  v_and_b32 v95, 0xffff0000, v247
  s_waitcnt lgkmcnt(0)
  v_pk_fma_f32 v[64:65], v[64:65], v[40:41], v[42:43] op_sel_hi:[1,0,0]
  v_pk_fma_f32 v[66:67], v[66:67], v[40:41], v[42:43] op_sel_hi:[1,0,0]
  v_pk_fma_f32 v[68:69], v[68:69], v[40:41], v[42:43] op_sel_hi:[1,0,0]
  v_pk_fma_f32 v[70:71], v[70:71], v[40:41], v[42:43] op_sel_hi:[1,0,0]
  v_pk_fma_f32 v[72:73], v[72:73], v[40:41], v[42:43] op_sel_hi:[1,0,0]
  v_pk_fma_f32 v[74:75], v[74:75], v[40:41], v[42:43] op_sel_hi:[1,0,0]
  v_pk_fma_f32 v[76:77], v[76:77], v[40:41], v[42:43] op_sel_hi:[1,0,0]
  v_pk_fma_f32 v[78:79], v[78:79], v[40:41], v[42:43] op_sel_hi:[1,0,0]
  v_pk_fma_f32 v[80:81], v[80:81], v[40:41], v[42:43] op_sel_hi:[1,0,0]
  v_pk_fma_f32 v[82:83], v[82:83], v[40:41], v[42:43] op_sel_hi:[1,0,0]
  v_pk_fma_f32 v[84:85], v[84:85], v[40:41], v[42:43] op_sel_hi:[1,0,0]
  v_pk_fma_f32 v[86:87], v[86:87], v[40:41], v[42:43] op_sel_hi:[1,0,0]
  v_pk_fma_f32 v[88:89], v[88:89], v[40:41], v[42:43] op_sel_hi:[1,0,0]
  v_pk_fma_f32 v[90:91], v[90:91], v[40:41], v[42:43] op_sel_hi:[1,0,0]
  v_pk_fma_f32 v[92:93], v[92:93], v[40:41], v[42:43] op_sel_hi:[1,0,0]
  v_pk_fma_f32 v[94:95], v[94:95], v[40:41], v[42:43] op_sel_hi:[1,0,0]
  v_cmp_eq_u32 vcc, v44, v45
  s_cbranch_vccnz .fz_kernel_w_pt
.fz_kernel_w_pb:
  s_cmp_ge_u32 s29, 2
  s_cbranch_scc1 .fz_kernel_w_e2
  s_andn2_b32 s33, s36, s34
  s_cbranch_scc0 .fz_kernel_pk50c
.fz_kernel_pk50:
  s_ff1_i32_b32 s33, s33
  s_bitset1_b32 s34, s33
  s_lshl_b32 s20, s33, 13
  s_lshl_b32 s33, s33, 12
  s_add_u32 s30, s33, s35
  buffer_load_dwordx4 v[96:99], v3, s[4:7], s30 offen offset:0
  buffer_load_dwordx4 v[100:103], v3, s[4:7], s30 offen offset:1024
  buffer_load_dwordx4 v[104:107], v3, s[4:7], s30 offen offset:2048
  buffer_load_dwordx4 v[108:111], v3, s[4:7], s30 offen offset:3072
  s_andn2_b32 s33, s36, s34
  s_cbranch_scc0 .fz_kernel_pk51c
.fz_kernel_pk51:
  s_ff1_i32_b32 s33, s33
  s_bitset1_b32 s34, s33
  s_lshl_b32 s21, s33, 13
  s_lshl_b32 s33, s33, 12
  s_add_u32 s30, s33, s35
  buffer_load_dwordx4 v[112:115], v3, s[4:7], s30 offen offset:0
  buffer_load_dwordx4 v[116:119], v3, s[4:7], s30 offen offset:1024
  buffer_load_dwordx4 v[120:123], v3, s[4:7], s30 offen offset:2048
  buffer_load_dwordx4 v[124:127], v3, s[4:7], s30 offen offset:3072
.fz_kernel_w_e2:
  s_andn2_b32 s33, s36, s34
  s_cbranch_scc0 .fz_kernel_pk52c
.fz_kernel_pk52:
  s_ff1_i32_b32 s33, s33
  s_bitset1_b32 s34, s33
  s_lshl_b32 s22, s33, 13
  s_lshl_b32 s33, s33, 12
  s_add_u32 s30, s33, s35
  buffer_load_dwordx4 v[128:131], v3, s[4:7], s30 offen offset:0
  buffer_load_dwordx4 v[132:135], v3, s[4:7], s30 offen offset:1024
  buffer_load_dwordx4 v[136:139], v3, s[4:7], s30 offen offset:2048
  buffer_load_dwordx4 v[140:143], v3, s[4:7], s30 offen offset:3072
  v_add_u32 v10, s20, v14
  v_add_u32 v11, s20, v15
  ds_read_b64_tr_b16 v[224:225], v10 offset:0
  ds_read_b64_tr_b16 v[226:227], v10 offset:1024
  ds_read_b64_tr_b16 v[228:229], v11 offset:0
  ds_read_b64_tr_b16 v[230:231], v11 offset:1024
  ds_read_b64_tr_b16 v[232:233], v10 offset:2048
  ds_read_b64_tr_b16 v[234:235], v10 offset:3072
  ds_read_b64_tr_b16 v[236:237], v11 offset:2048
  ds_read_b64_tr_b16 v[238:239], v11 offset:3072
  s_andn2_b32 s33, s36, s34
  s_cbranch_scc0 .fz_kernel_pk53c
.fz_kernel_pk53:
  s_ff1_i32_b32 s33, s33
  s_bitset1_b32 s34, s33
  s_lshl_b32 s23, s33, 13
  s_lshl_b32 s33, s33, 12
  s_add_u32 s30, s33, s35
  s_waitcnt vmcnt(11) lgkmcnt(6)
  v_mfma_f32_32x32x16_bf16 v[64:79], v[224:227], v[96:99], v[64:79]
  v_add_u32 v12, s21, v14
  v_add_u32 v13, s21, v15
  buffer_load_dwordx4 v[144:147], v3, s[4:7], s30 offen offset:0
  ds_read_b64_tr_b16 v[240:241], v10 offset:4096
  s_waitcnt lgkmcnt(5)
  v_mfma_f32_32x32x16_bf16 v[80:95], v[228:231], v[96:99], v[80:95]
  ds_read_b64_tr_b16 v[242:243], v10 offset:5120
  ds_read_b64_tr_b16 v[244:245], v11 offset:4096
  ds_read_b64_tr_b16 v[246:247], v11 offset:5120
  s_waitcnt vmcnt(11) lgkmcnt(6)
  v_mfma_f32_32x32x16_bf16 v[64:79], v[232:235], v[100:103], v[64:79]
  buffer_load_dwordx4 v[148:151], v3, s[4:7], s30 offen offset:1024
  ds_read_b64_tr_b16 v[248:249], v10 offset:6144
  s_waitcnt lgkmcnt(5)
  v_mfma_f32_32x32x16_bf16 v[80:95], v[236:239], v[100:103], v[80:95]
  ds_read_b64_tr_b16 v[250:251], v10 offset:7168
  ds_read_b64_tr_b16 v[252:253], v11 offset:6144
  ds_read_b64_tr_b16 v[254:255], v11 offset:7168
  s_waitcnt vmcnt(11) lgkmcnt(6)
  v_mfma_f32_32x32x16_bf16 v[64:79], v[240:243], v[104:107], v[64:79]
  buffer_load_dwordx4 v[152:155], v3, s[4:7], s30 offen offset:2048
  ds_read_b64_tr_b16 v[224:225], v12 offset:0
  s_waitcnt lgkmcnt(5)
  v_mfma_f32_32x32x16_bf16 v[80:95], v[244:247], v[104:107], v[80:95]
  ds_read_b64_tr_b16 v[226:227], v12 offset:1024
  ds_read_b64_tr_b16 v[228:229], v13 offset:0
  ds_read_b64_tr_b16 v[230:231], v13 offset:1024
  s_waitcnt vmcnt(11) lgkmcnt(6)
  v_mfma_f32_32x32x16_bf16 v[64:79], v[248:251], v[108:111], v[64:79]
  buffer_load_dwordx4 v[156:159], v3, s[4:7], s30 offen offset:3072
  ds_read_b64_tr_b16 v[232:233], v12 offset:2048
  s_waitcnt lgkmcnt(5)
  v_mfma_f32_32x32x16_bf16 v[80:95], v[252:255], v[108:111], v[80:95]
  ds_read_b64_tr_b16 v[234:235], v12 offset:3072
  ds_read_b64_tr_b16 v[236:237], v13 offset:2048
  ds_read_b64_tr_b16 v[238:239], v13 offset:3072
  s_andn2_b32 s33, s36, s34
  s_cbranch_scc0 .fz_kernel_pk54c
.fz_kernel_pk54:
  s_ff1_i32_b32 s33, s33
  s_bitset1_b32 s34, s33
  s_lshl_b32 s24, s33, 13
  s_lshl_b32 s33, s33, 12
  s_add_u32 s30, s33, s35
  s_waitcnt vmcnt(11) lgkmcnt(6)
  v_mfma_f32_32x32x16_bf16 v[64:79], v[224:227], v[112:115], v[64:79]
  v_add_u32 v10, s22, v14
  v_add_u32 v11, s22, v15
  buffer_load_dwordx4 v[160:163], v3, s[4:7], s30 offen offset:0
  ds_read_b64_tr_b16 v[240:241], v12 offset:4096
  s_waitcnt lgkmcnt(5)
  v_mfma_f32_32x32x16_bf16 v[80:95], v[228:231], v[112:115], v[80:95]
  ds_read_b64_tr_b16 v[242:243], v12 offset:5120
  ds_read_b64_tr_b16 v[244:245], v13 offset:4096
  ds_read_b64_tr_b16 v[246:247], v13 offset:5120
  s_waitcnt vmcnt(11) lgkmcnt(6)
  v_mfma_f32_32x32x16_bf16 v[64:79], v[232:235], v[116:119], v[64:79]
  buffer_load_dwordx4 v[164:167], v3, s[4:7], s30 offen offset:1024
  ds_read_b64_tr_b16 v[248:249], v12 offset:6144
  s_waitcnt lgkmcnt(5)
  v_mfma_f32_32x32x16_bf16 v[80:95], v[236:239], v[116:119], v[80:95]
  ds_read_b64_tr_b16 v[250:251], v12 offset:7168
  ds_read_b64_tr_b16 v[252:253], v13 offset:6144
  ds_read_b64_tr_b16 v[254:255], v13 offset:7168
  s_waitcnt vmcnt(11) lgkmcnt(6)
  v_mfma_f32_32x32x16_bf16 v[64:79], v[240:243], v[120:123], v[64:79]
  buffer_load_dwordx4 v[168:171], v3, s[4:7], s30 offen offset:2048
  ds_read_b64_tr_b16 v[224:225], v10 offset:0
  s_waitcnt lgkmcnt(5)
  v_mfma_f32_32x32x16_bf16 v[80:95], v[244:247], v[120:123], v[80:95]
  ds_read_b64_tr_b16 v[226:227], v10 offset:1024
  ds_read_b64_tr_b16 v[228:229], v11 offset:0
  ds_read_b64_tr_b16 v[230:231], v11 offset:1024
  s_waitcnt vmcnt(11) lgkmcnt(6)
  v_mfma_f32_32x32x16_bf16 v[64:79], v[248:251], v[124:127], v[64:79]
  buffer_load_dwordx4 v[172:175], v3, s[4:7], s30 offen offset:3072
  ds_read_b64_tr_b16 v[232:233], v10 offset:2048
  s_waitcnt lgkmcnt(5)
  v_mfma_f32_32x32x16_bf16 v[80:95], v[252:255], v[124:127], v[80:95]
  ds_read_b64_tr_b16 v[234:235], v10 offset:3072
  ds_read_b64_tr_b16 v[236:237], v11 offset:2048
  ds_read_b64_tr_b16 v[238:239], v11 offset:3072
  s_andn2_b32 s33, s36, s34
  s_cbranch_scc0 .fz_kernel_pk55c
.fz_kernel_pk55:
  s_ff1_i32_b32 s33, s33
  s_bitset1_b32 s34, s33
  s_lshl_b32 s25, s33, 13
  s_lshl_b32 s33, s33, 12
  s_add_u32 s30, s33, s35
  s_waitcnt vmcnt(11) lgkmcnt(6)
  v_mfma_f32_32x32x16_bf16 v[64:79], v[224:227], v[128:131], v[64:79]
  v_add_u32 v12, s23, v14
  v_add_u32 v13, s23, v15
  buffer_load_dwordx4 v[176:179], v3, s[4:7], s30 offen offset:0
  ds_read_b64_tr_b16 v[240:241], v10 offset:4096
  s_waitcnt lgkmcnt(5)
  v_mfma_f32_32x32x16_bf16 v[80:95], v[228:231], v[128:131], v[80:95]
  ds_read_b64_tr_b16 v[242:243], v10 offset:5120
  ds_read_b64_tr_b16 v[244:245], v11 offset:4096
  ds_read_b64_tr_b16 v[246:247], v11 offset:5120
  s_waitcnt vmcnt(11) lgkmcnt(6)
  v_mfma_f32_32x32x16_bf16 v[64:79], v[232:235], v[132:135], v[64:79]
  buffer_load_dwordx4 v[180:183], v3, s[4:7], s30 offen offset:1024
  ds_read_b64_tr_b16 v[248:249], v10 offset:6144
  s_waitcnt lgkmcnt(5)
  v_mfma_f32_32x32x16_bf16 v[80:95], v[236:239], v[132:135], v[80:95]
  ds_read_b64_tr_b16 v[250:251], v10 offset:7168
  ds_read_b64_tr_b16 v[252:253], v11 offset:6144
  ds_read_b64_tr_b16 v[254:255], v11 offset:7168
  s_waitcnt vmcnt(11) lgkmcnt(6)
  v_mfma_f32_32x32x16_bf16 v[64:79], v[240:243], v[136:139], v[64:79]
  buffer_load_dwordx4 v[184:187], v3, s[4:7], s30 offen offset:2048
  ds_read_b64_tr_b16 v[224:225], v12 offset:0
  s_waitcnt lgkmcnt(5)
  v_mfma_f32_32x32x16_bf16 v[80:95], v[244:247], v[136:139], v[80:95]
  ds_read_b64_tr_b16 v[226:227], v12 offset:1024
  ds_read_b64_tr_b16 v[228:229], v13 offset:0
  ds_read_b64_tr_b16 v[230:231], v13 offset:1024
  s_waitcnt vmcnt(11) lgkmcnt(6)
  v_mfma_f32_32x32x16_bf16 v[64:79], v[248:251], v[140:143], v[64:79]
  buffer_load_dwordx4 v[188:191], v3, s[4:7], s30 offen offset:3072
  ds_read_b64_tr_b16 v[232:233], v12 offset:2048
  s_waitcnt lgkmcnt(5)
  v_mfma_f32_32x32x16_bf16 v[80:95], v[252:255], v[140:143], v[80:95]
  ds_read_b64_tr_b16 v[234:235], v12 offset:3072
  ds_read_b64_tr_b16 v[236:237], v13 offset:2048
  ds_read_b64_tr_b16 v[238:239], v13 offset:3072
  s_andn2_b32 s33, s36, s34
  s_cbranch_scc0 .fz_kernel_pk56c
.fz_kernel_pk56:
  s_ff1_i32_b32 s33, s33
  s_bitset1_b32 s34, s33
  s_lshl_b32 s26, s33, 13
  s_lshl_b32 s33, s33, 12
  s_add_u32 s30, s33, s35
  s_waitcnt vmcnt(11) lgkmcnt(6)
  v_mfma_f32_32x32x16_bf16 v[64:79], v[224:227], v[144:147], v[64:79]
  v_add_u32 v10, s24, v14
  v_add_u32 v11, s24, v15
  buffer_load_dwordx4 v[192:195], v3, s[4:7], s30 offen offset:0
  ds_read_b64_tr_b16 v[240:241], v12 offset:4096
  s_waitcnt lgkmcnt(5)
  v_mfma_f32_32x32x16_bf16 v[80:95], v[228:231], v[144:147], v[80:95]
  ds_read_b64_tr_b16 v[242:243], v12 offset:5120
  ds_read_b64_tr_b16 v[244:245], v13 offset:4096
  ds_read_b64_tr_b16 v[246:247], v13 offset:5120
  s_waitcnt vmcnt(11) lgkmcnt(6)
  v_mfma_f32_32x32x16_bf16 v[64:79], v[232:235], v[148:151], v[64:79]
  buffer_load_dwordx4 v[196:199], v3, s[4:7], s30 offen offset:1024
  ds_read_b64_tr_b16 v[248:249], v12 offset:6144
  s_waitcnt lgkmcnt(5)
  v_mfma_f32_32x32x16_bf16 v[80:95], v[236:239], v[148:151], v[80:95]
  ds_read_b64_tr_b16 v[250:251], v12 offset:7168
  ds_read_b64_tr_b16 v[252:253], v13 offset:6144
  ds_read_b64_tr_b16 v[254:255], v13 offset:7168
  s_waitcnt vmcnt(11) lgkmcnt(6)
  v_mfma_f32_32x32x16_bf16 v[64:79], v[240:243], v[152:155], v[64:79]
  buffer_load_dwordx4 v[200:203], v3, s[4:7], s30 offen offset:2048
  ds_read_b64_tr_b16 v[224:225], v10 offset:0
  s_waitcnt lgkmcnt(5)
  v_mfma_f32_32x32x16_bf16 v[80:95], v[244:247], v[152:155], v[80:95]
  ds_read_b64_tr_b16 v[226:227], v10 offset:1024
  ds_read_b64_tr_b16 v[228:229], v11 offset:0
  ds_read_b64_tr_b16 v[230:231], v11 offset:1024
  s_waitcnt vmcnt(11) lgkmcnt(6)
  v_mfma_f32_32x32x16_bf16 v[64:79], v[248:251], v[156:159], v[64:79]
  buffer_load_dwordx4 v[204:207], v3, s[4:7], s30 offen offset:3072
  ds_read_b64_tr_b16 v[232:233], v10 offset:2048
  s_waitcnt lgkmcnt(5)
  v_mfma_f32_32x32x16_bf16 v[80:95], v[252:255], v[156:159], v[80:95]
  ds_read_b64_tr_b16 v[234:235], v10 offset:3072
  ds_read_b64_tr_b16 v[236:237], v11 offset:2048
  ds_read_b64_tr_b16 v[238:239], v11 offset:3072
  s_andn2_b32 s33, s36, s34
  s_cbranch_scc0 .fz_kernel_pk57c
.fz_kernel_pk57:
  s_ff1_i32_b32 s33, s33
  s_bitset1_b32 s34, s33
  s_lshl_b32 s27, s33, 13
  s_lshl_b32 s33, s33, 12
  s_add_u32 s30, s33, s35
  s_waitcnt vmcnt(11) lgkmcnt(6)
  v_mfma_f32_32x32x16_bf16 v[64:79], v[224:227], v[160:163], v[64:79]
  v_add_u32 v12, s25, v14
  v_add_u32 v13, s25, v15
  buffer_load_dwordx4 v[208:211], v3, s[4:7], s30 offen offset:0
  ds_read_b64_tr_b16 v[240:241], v10 offset:4096
  s_waitcnt lgkmcnt(5)
  v_mfma_f32_32x32x16_bf16 v[80:95], v[228:231], v[160:163], v[80:95]
  ds_read_b64_tr_b16 v[242:243], v10 offset:5120
  ds_read_b64_tr_b16 v[244:245], v11 offset:4096
  ds_read_b64_tr_b16 v[246:247], v11 offset:5120
  s_waitcnt vmcnt(11) lgkmcnt(6)
  v_mfma_f32_32x32x16_bf16 v[64:79], v[232:235], v[164:167], v[64:79]
  buffer_load_dwordx4 v[212:215], v3, s[4:7], s30 offen offset:1024
  ds_read_b64_tr_b16 v[248:249], v10 offset:6144
  s_waitcnt lgkmcnt(5)
  v_mfma_f32_32x32x16_bf16 v[80:95], v[236:239], v[164:167], v[80:95]
  ds_read_b64_tr_b16 v[250:251], v10 offset:7168
  ds_read_b64_tr_b16 v[252:253], v11 offset:6144
  ds_read_b64_tr_b16 v[254:255], v11 offset:7168
  s_waitcnt vmcnt(11) lgkmcnt(6)
  v_mfma_f32_32x32x16_bf16 v[64:79], v[240:243], v[168:171], v[64:79]
  buffer_load_dwordx4 v[216:219], v3, s[4:7], s30 offen offset:2048
  ds_read_b64_tr_b16 v[224:225], v12 offset:0
  s_waitcnt lgkmcnt(5)
  v_mfma_f32_32x32x16_bf16 v[80:95], v[244:247], v[168:171], v[80:95]
  ds_read_b64_tr_b16 v[226:227], v12 offset:1024
  ds_read_b64_tr_b16 v[228:229], v13 offset:0
  ds_read_b64_tr_b16 v[230:231], v13 offset:1024
  s_waitcnt vmcnt(11) lgkmcnt(6)
  v_mfma_f32_32x32x16_bf16 v[64:79], v[248:251], v[172:175], v[64:79]
  buffer_load_dwordx4 v[220:223], v3, s[4:7], s30 offen offset:3072
  ds_read_b64_tr_b16 v[232:233], v12 offset:2048
  s_waitcnt lgkmcnt(5)
  v_mfma_f32_32x32x16_bf16 v[80:95], v[252:255], v[172:175], v[80:95]
  ds_read_b64_tr_b16 v[234:235], v12 offset:3072
  ds_read_b64_tr_b16 v[236:237], v13 offset:2048
  ds_read_b64_tr_b16 v[238:239], v13 offset:3072
  s_andn2_b32 s33, s36, s34
  s_cbranch_scc0 .fz_kernel_pk58c
.fz_kernel_pk58:
  s_ff1_i32_b32 s33, s33
  s_bitset1_b32 s34, s33
  s_lshl_b32 s20, s33, 13
  s_lshl_b32 s33, s33, 12
  s_add_u32 s30, s33, s35
  s_waitcnt vmcnt(11) lgkmcnt(6)
  v_mfma_f32_32x32x16_bf16 v[64:79], v[224:227], v[176:179], v[64:79]
  v_add_u32 v10, s26, v14
  v_add_u32 v11, s26, v15
  buffer_load_dwordx4 v[96:99], v3, s[4:7], s30 offen offset:0
  ds_read_b64_tr_b16 v[240:241], v12 offset:4096
  s_waitcnt lgkmcnt(5)
  v_mfma_f32_32x32x16_bf16 v[80:95], v[228:231], v[176:179], v[80:95]
  ds_read_b64_tr_b16 v[242:243], v12 offset:5120
  ds_read_b64_tr_b16 v[244:245], v13 offset:4096
  ds_read_b64_tr_b16 v[246:247], v13 offset:5120
  s_waitcnt vmcnt(11) lgkmcnt(6)
  v_mfma_f32_32x32x16_bf16 v[64:79], v[232:235], v[180:183], v[64:79]
  buffer_load_dwordx4 v[100:103], v3, s[4:7], s30 offen offset:1024
  ds_read_b64_tr_b16 v[248:249], v12 offset:6144
  s_waitcnt lgkmcnt(5)
  v_mfma_f32_32x32x16_bf16 v[80:95], v[236:239], v[180:183], v[80:95]
  ds_read_b64_tr_b16 v[250:251], v12 offset:7168
  ds_read_b64_tr_b16 v[252:253], v13 offset:6144
  ds_read_b64_tr_b16 v[254:255], v13 offset:7168
  s_waitcnt vmcnt(11) lgkmcnt(6)
  v_mfma_f32_32x32x16_bf16 v[64:79], v[240:243], v[184:187], v[64:79]
  buffer_load_dwordx4 v[104:107], v3, s[4:7], s30 offen offset:2048
  ds_read_b64_tr_b16 v[224:225], v10 offset:0
  s_waitcnt lgkmcnt(5)
  v_mfma_f32_32x32x16_bf16 v[80:95], v[244:247], v[184:187], v[80:95]
  ds_read_b64_tr_b16 v[226:227], v10 offset:1024
  ds_read_b64_tr_b16 v[228:229], v11 offset:0
  ds_read_b64_tr_b16 v[230:231], v11 offset:1024
  s_waitcnt vmcnt(11) lgkmcnt(6)
  v_mfma_f32_32x32x16_bf16 v[64:79], v[248:251], v[188:191], v[64:79]
  buffer_load_dwordx4 v[108:111], v3, s[4:7], s30 offen offset:3072
  ds_read_b64_tr_b16 v[232:233], v10 offset:2048
  s_waitcnt lgkmcnt(5)
  v_mfma_f32_32x32x16_bf16 v[80:95], v[252:255], v[188:191], v[80:95]
  ds_read_b64_tr_b16 v[234:235], v10 offset:3072
  ds_read_b64_tr_b16 v[236:237], v11 offset:2048
  ds_read_b64_tr_b16 v[238:239], v11 offset:3072
  s_andn2_b32 s33, s36, s34
  s_cbranch_scc0 .fz_kernel_pk59c
.fz_kernel_pk59:
  s_ff1_i32_b32 s33, s33
  s_bitset1_b32 s34, s33
  s_lshl_b32 s21, s33, 13
  s_lshl_b32 s33, s33, 12
  s_add_u32 s30, s33, s35
  s_waitcnt vmcnt(11) lgkmcnt(6)
  v_mfma_f32_32x32x16_bf16 v[64:79], v[224:227], v[192:195], v[64:79]
  v_add_u32 v12, s27, v14
  v_add_u32 v13, s27, v15
  buffer_load_dwordx4 v[112:115], v3, s[4:7], s30 offen offset:0
  ds_read_b64_tr_b16 v[240:241], v10 offset:4096
  s_waitcnt lgkmcnt(5)
  v_mfma_f32_32x32x16_bf16 v[80:95], v[228:231], v[192:195], v[80:95]
  ds_read_b64_tr_b16 v[242:243], v10 offset:5120
  ds_read_b64_tr_b16 v[244:245], v11 offset:4096
  ds_read_b64_tr_b16 v[246:247], v11 offset:5120
  s_waitcnt vmcnt(11) lgkmcnt(6)
  v_mfma_f32_32x32x16_bf16 v[64:79], v[232:235], v[196:199], v[64:79]
  buffer_load_dwordx4 v[116:119], v3, s[4:7], s30 offen offset:1024
  ds_read_b64_tr_b16 v[248:249], v10 offset:6144
  s_waitcnt lgkmcnt(5)
  v_mfma_f32_32x32x16_bf16 v[80:95], v[236:239], v[196:199], v[80:95]
  ds_read_b64_tr_b16 v[250:251], v10 offset:7168
  ds_read_b64_tr_b16 v[252:253], v11 offset:6144
  ds_read_b64_tr_b16 v[254:255], v11 offset:7168
  s_waitcnt vmcnt(11) lgkmcnt(6)
  v_mfma_f32_32x32x16_bf16 v[64:79], v[240:243], v[200:203], v[64:79]
  buffer_load_dwordx4 v[120:123], v3, s[4:7], s30 offen offset:2048
  ds_read_b64_tr_b16 v[224:225], v12 offset:0
  s_waitcnt lgkmcnt(5)
  v_mfma_f32_32x32x16_bf16 v[80:95], v[244:247], v[200:203], v[80:95]
  ds_read_b64_tr_b16 v[226:227], v12 offset:1024
  ds_read_b64_tr_b16 v[228:229], v13 offset:0
  ds_read_b64_tr_b16 v[230:231], v13 offset:1024
  s_waitcnt vmcnt(11) lgkmcnt(6)
  v_mfma_f32_32x32x16_bf16 v[64:79], v[248:251], v[204:207], v[64:79]
  buffer_load_dwordx4 v[124:127], v3, s[4:7], s30 offen offset:3072
  ds_read_b64_tr_b16 v[232:233], v12 offset:2048
  s_waitcnt lgkmcnt(5)
  v_mfma_f32_32x32x16_bf16 v[80:95], v[252:255], v[204:207], v[80:95]
  ds_read_b64_tr_b16 v[234:235], v12 offset:3072
  ds_read_b64_tr_b16 v[236:237], v13 offset:2048
  ds_read_b64_tr_b16 v[238:239], v13 offset:3072
  s_andn2_b32 s33, s36, s34
  s_cbranch_scc0 .fz_kernel_pk60c
.fz_kernel_pk60:
  s_ff1_i32_b32 s33, s33
  s_bitset1_b32 s34, s33
  s_lshl_b32 s22, s33, 13
  s_lshl_b32 s33, s33, 12
  s_add_u32 s30, s33, s35
  s_waitcnt vmcnt(11) lgkmcnt(6)
  v_mfma_f32_32x32x16_bf16 v[64:79], v[224:227], v[208:211], v[64:79]
  v_add_u32 v10, s20, v14
  v_add_u32 v11, s20, v15
  buffer_load_dwordx4 v[128:131], v3, s[4:7], s30 offen offset:0
  ds_read_b64_tr_b16 v[240:241], v12 offset:4096
  s_waitcnt lgkmcnt(5)
  v_mfma_f32_32x32x16_bf16 v[80:95], v[228:231], v[208:211], v[80:95]
  ds_read_b64_tr_b16 v[242:243], v12 offset:5120
  ds_read_b64_tr_b16 v[244:245], v13 offset:4096
  ds_read_b64_tr_b16 v[246:247], v13 offset:5120
  s_waitcnt vmcnt(11) lgkmcnt(6)
  v_mfma_f32_32x32x16_bf16 v[64:79], v[232:235], v[212:215], v[64:79]
  buffer_load_dwordx4 v[132:135], v3, s[4:7], s30 offen offset:1024
  ds_read_b64_tr_b16 v[248:249], v12 offset:6144
  s_waitcnt lgkmcnt(5)
  v_mfma_f32_32x32x16_bf16 v[80:95], v[236:239], v[212:215], v[80:95]
  ds_read_b64_tr_b16 v[250:251], v12 offset:7168
  ds_read_b64_tr_b16 v[252:253], v13 offset:6144
  ds_read_b64_tr_b16 v[254:255], v13 offset:7168
  s_waitcnt vmcnt(11) lgkmcnt(6)
  v_mfma_f32_32x32x16_bf16 v[64:79], v[240:243], v[216:219], v[64:79]
  buffer_load_dwordx4 v[136:139], v3, s[4:7], s30 offen offset:2048
  ds_read_b64_tr_b16 v[224:225], v10 offset:0
  s_waitcnt lgkmcnt(5)
  v_mfma_f32_32x32x16_bf16 v[80:95], v[244:247], v[216:219], v[80:95]
  ds_read_b64_tr_b16 v[226:227], v10 offset:1024
  ds_read_b64_tr_b16 v[228:229], v11 offset:0
  ds_read_b64_tr_b16 v[230:231], v11 offset:1024
  s_waitcnt vmcnt(11) lgkmcnt(6)
  v_mfma_f32_32x32x16_bf16 v[64:79], v[248:251], v[220:223], v[64:79]
  buffer_load_dwordx4 v[140:143], v3, s[4:7], s30 offen offset:3072
  ds_read_b64_tr_b16 v[232:233], v10 offset:2048
  s_waitcnt lgkmcnt(5)
  v_mfma_f32_32x32x16_bf16 v[80:95], v[252:255], v[220:223], v[80:95]
  ds_read_b64_tr_b16 v[234:235], v10 offset:3072
  ds_read_b64_tr_b16 v[236:237], v11 offset:2048
  ds_read_b64_tr_b16 v[238:239], v11 offset:3072
  s_andn2_b32 s33, s36, s34
  s_cbranch_scc0 .fz_kernel_pk61c
.fz_kernel_pk61:
  s_ff1_i32_b32 s33, s33
  s_bitset1_b32 s34, s33
  s_lshl_b32 s23, s33, 13
  s_lshl_b32 s33, s33, 12
  s_add_u32 s30, s33, s35
  s_waitcnt vmcnt(11) lgkmcnt(6)
  v_mfma_f32_32x32x16_bf16 v[64:79], v[224:227], v[96:99], v[64:79]
  v_add_u32 v12, s21, v14
  v_add_u32 v13, s21, v15
  buffer_load_dwordx4 v[144:147], v3, s[4:7], s30 offen offset:0
  ds_read_b64_tr_b16 v[240:241], v10 offset:4096
  s_waitcnt lgkmcnt(5)
  v_mfma_f32_32x32x16_bf16 v[80:95], v[228:231], v[96:99], v[80:95]
  ds_read_b64_tr_b16 v[242:243], v10 offset:5120
  ds_read_b64_tr_b16 v[244:245], v11 offset:4096
  ds_read_b64_tr_b16 v[246:247], v11 offset:5120
  s_waitcnt vmcnt(11) lgkmcnt(6)
  v_mfma_f32_32x32x16_bf16 v[64:79], v[232:235], v[100:103], v[64:79]
  buffer_load_dwordx4 v[148:151], v3, s[4:7], s30 offen offset:1024
  ds_read_b64_tr_b16 v[248:249], v10 offset:6144
  s_waitcnt lgkmcnt(5)
  v_mfma_f32_32x32x16_bf16 v[80:95], v[236:239], v[100:103], v[80:95]
  ds_read_b64_tr_b16 v[250:251], v10 offset:7168
  ds_read_b64_tr_b16 v[252:253], v11 offset:6144
  ds_read_b64_tr_b16 v[254:255], v11 offset:7168
  s_waitcnt vmcnt(11) lgkmcnt(6)
  v_mfma_f32_32x32x16_bf16 v[64:79], v[240:243], v[104:107], v[64:79]
  buffer_load_dwordx4 v[152:155], v3, s[4:7], s30 offen offset:2048
  ds_read_b64_tr_b16 v[224:225], v12 offset:0
  s_waitcnt lgkmcnt(5)
  v_mfma_f32_32x32x16_bf16 v[80:95], v[244:247], v[104:107], v[80:95]
  ds_read_b64_tr_b16 v[226:227], v12 offset:1024
  ds_read_b64_tr_b16 v[228:229], v13 offset:0
  ds_read_b64_tr_b16 v[230:231], v13 offset:1024
  s_waitcnt vmcnt(11) lgkmcnt(6)
  v_mfma_f32_32x32x16_bf16 v[64:79], v[248:251], v[108:111], v[64:79]
  buffer_load_dwordx4 v[156:159], v3, s[4:7], s30 offen offset:3072
  ds_read_b64_tr_b16 v[232:233], v12 offset:2048
  s_waitcnt lgkmcnt(5)
  v_mfma_f32_32x32x16_bf16 v[80:95], v[252:255], v[108:111], v[80:95]
  ds_read_b64_tr_b16 v[234:235], v12 offset:3072
  ds_read_b64_tr_b16 v[236:237], v13 offset:2048
  ds_read_b64_tr_b16 v[238:239], v13 offset:3072
  s_andn2_b32 s33, s36, s34
  s_cbranch_scc0 .fz_kernel_pk62c
.fz_kernel_pk62:
  s_ff1_i32_b32 s33, s33
  s_bitset1_b32 s34, s33
  s_lshl_b32 s24, s33, 13
  s_lshl_b32 s33, s33, 12
  s_add_u32 s30, s33, s35
  s_waitcnt vmcnt(11) lgkmcnt(6)
  v_mfma_f32_32x32x16_bf16 v[64:79], v[224:227], v[112:115], v[64:79]
  v_add_u32 v10, s22, v14
  v_add_u32 v11, s22, v15
  buffer_load_dwordx4 v[160:163], v3, s[4:7], s30 offen offset:0
  ds_read_b64_tr_b16 v[240:241], v12 offset:4096
  s_waitcnt lgkmcnt(5)
  v_mfma_f32_32x32x16_bf16 v[80:95], v[228:231], v[112:115], v[80:95]
  ds_read_b64_tr_b16 v[242:243], v12 offset:5120
  ds_read_b64_tr_b16 v[244:245], v13 offset:4096
  ds_read_b64_tr_b16 v[246:247], v13 offset:5120
  s_waitcnt vmcnt(11) lgkmcnt(6)
  v_mfma_f32_32x32x16_bf16 v[64:79], v[232:235], v[116:119], v[64:79]
  buffer_load_dwordx4 v[164:167], v3, s[4:7], s30 offen offset:1024
  ds_read_b64_tr_b16 v[248:249], v12 offset:6144
  s_waitcnt lgkmcnt(5)
  v_mfma_f32_32x32x16_bf16 v[80:95], v[236:239], v[116:119], v[80:95]
  ds_read_b64_tr_b16 v[250:251], v12 offset:7168
  ds_read_b64_tr_b16 v[252:253], v13 offset:6144
  ds_read_b64_tr_b16 v[254:255], v13 offset:7168
  s_waitcnt vmcnt(11) lgkmcnt(6)
  v_mfma_f32_32x32x16_bf16 v[64:79], v[240:243], v[120:123], v[64:79]
  buffer_load_dwordx4 v[168:171], v3, s[4:7], s30 offen offset:2048
  ds_read_b64_tr_b16 v[224:225], v10 offset:0
  s_waitcnt lgkmcnt(5)
  v_mfma_f32_32x32x16_bf16 v[80:95], v[244:247], v[120:123], v[80:95]
  ds_read_b64_tr_b16 v[226:227], v10 offset:1024
  ds_read_b64_tr_b16 v[228:229], v11 offset:0
  ds_read_b64_tr_b16 v[230:231], v11 offset:1024
  s_waitcnt vmcnt(11) lgkmcnt(6)
  v_mfma_f32_32x32x16_bf16 v[64:79], v[248:251], v[124:127], v[64:79]
  buffer_load_dwordx4 v[172:175], v3, s[4:7], s30 offen offset:3072
  ds_read_b64_tr_b16 v[232:233], v10 offset:2048
  s_waitcnt lgkmcnt(5)
  v_mfma_f32_32x32x16_bf16 v[80:95], v[252:255], v[124:127], v[80:95]
  ds_read_b64_tr_b16 v[234:235], v10 offset:3072
  ds_read_b64_tr_b16 v[236:237], v11 offset:2048
  ds_read_b64_tr_b16 v[238:239], v11 offset:3072
  s_andn2_b32 s33, s36, s34
  s_cbranch_scc0 .fz_kernel_pk63c
.fz_kernel_pk63:
  s_ff1_i32_b32 s33, s33
  s_bitset1_b32 s34, s33
  s_lshl_b32 s25, s33, 13
  s_lshl_b32 s33, s33, 12
  s_add_u32 s30, s33, s35
  s_waitcnt vmcnt(11) lgkmcnt(6)
  v_mfma_f32_32x32x16_bf16 v[64:79], v[224:227], v[128:131], v[64:79]
  v_add_u32 v12, s23, v14
  v_add_u32 v13, s23, v15
  buffer_load_dwordx4 v[176:179], v3, s[4:7], s30 offen offset:0
  ds_read_b64_tr_b16 v[240:241], v10 offset:4096
  s_waitcnt lgkmcnt(5)
  v_mfma_f32_32x32x16_bf16 v[80:95], v[228:231], v[128:131], v[80:95]
  ds_read_b64_tr_b16 v[242:243], v10 offset:5120
  ds_read_b64_tr_b16 v[244:245], v11 offset:4096
  ds_read_b64_tr_b16 v[246:247], v11 offset:5120
  s_waitcnt vmcnt(11) lgkmcnt(6)
  v_mfma_f32_32x32x16_bf16 v[64:79], v[232:235], v[132:135], v[64:79]
  buffer_load_dwordx4 v[180:183], v3, s[4:7], s30 offen offset:1024
  ds_read_b64_tr_b16 v[248:249], v10 offset:6144
  s_waitcnt lgkmcnt(5)
  v_mfma_f32_32x32x16_bf16 v[80:95], v[236:239], v[132:135], v[80:95]
  ds_read_b64_tr_b16 v[250:251], v10 offset:7168
  ds_read_b64_tr_b16 v[252:253], v11 offset:6144
  ds_read_b64_tr_b16 v[254:255], v11 offset:7168
  s_waitcnt vmcnt(11) lgkmcnt(6)
  v_mfma_f32_32x32x16_bf16 v[64:79], v[240:243], v[136:139], v[64:79]
  buffer_load_dwordx4 v[184:187], v3, s[4:7], s30 offen offset:2048
  ds_read_b64_tr_b16 v[224:225], v12 offset:0
  s_waitcnt lgkmcnt(5)
  v_mfma_f32_32x32x16_bf16 v[80:95], v[244:247], v[136:139], v[80:95]
  ds_read_b64_tr_b16 v[226:227], v12 offset:1024
  ds_read_b64_tr_b16 v[228:229], v13 offset:0
  ds_read_b64_tr_b16 v[230:231], v13 offset:1024
  s_waitcnt vmcnt(11) lgkmcnt(6)
  v_mfma_f32_32x32x16_bf16 v[64:79], v[248:251], v[140:143], v[64:79]
  buffer_load_dwordx4 v[188:191], v3, s[4:7], s30 offen offset:3072
  ds_read_b64_tr_b16 v[232:233], v12 offset:2048
  s_waitcnt lgkmcnt(5)
  v_mfma_f32_32x32x16_bf16 v[80:95], v[252:255], v[140:143], v[80:95]
  ds_read_b64_tr_b16 v[234:235], v12 offset:3072
  ds_read_b64_tr_b16 v[236:237], v13 offset:2048
  ds_read_b64_tr_b16 v[238:239], v13 offset:3072
  s_andn2_b32 s33, s36, s34
  s_cbranch_scc0 .fz_kernel_pk64c
.fz_kernel_pk64:
  s_ff1_i32_b32 s33, s33
  s_bitset1_b32 s34, s33
  s_lshl_b32 s26, s33, 13
  s_lshl_b32 s33, s33, 12
  s_add_u32 s30, s33, s35
  s_waitcnt vmcnt(11) lgkmcnt(6)
  v_mfma_f32_32x32x16_bf16 v[64:79], v[224:227], v[144:147], v[64:79]
  v_add_u32 v10, s24, v14
  v_add_u32 v11, s24, v15
  buffer_load_dwordx4 v[192:195], v3, s[4:7], s30 offen offset:0
  ds_read_b64_tr_b16 v[240:241], v12 offset:4096
  s_waitcnt lgkmcnt(5)
  v_mfma_f32_32x32x16_bf16 v[80:95], v[228:231], v[144:147], v[80:95]
  ds_read_b64_tr_b16 v[242:243], v12 offset:5120
  ds_read_b64_tr_b16 v[244:245], v13 offset:4096
  ds_read_b64_tr_b16 v[246:247], v13 offset:5120
  s_waitcnt vmcnt(11) lgkmcnt(6)
  v_mfma_f32_32x32x16_bf16 v[64:79], v[232:235], v[148:151], v[64:79]
  buffer_load_dwordx4 v[196:199], v3, s[4:7], s30 offen offset:1024
  ds_read_b64_tr_b16 v[248:249], v12 offset:6144
  s_waitcnt lgkmcnt(5)
  v_mfma_f32_32x32x16_bf16 v[80:95], v[236:239], v[148:151], v[80:95]
  ds_read_b64_tr_b16 v[250:251], v12 offset:7168
  ds_read_b64_tr_b16 v[252:253], v13 offset:6144
  ds_read_b64_tr_b16 v[254:255], v13 offset:7168
  s_waitcnt vmcnt(11) lgkmcnt(6)
  v_mfma_f32_32x32x16_bf16 v[64:79], v[240:243], v[152:155], v[64:79]
  buffer_load_dwordx4 v[200:203], v3, s[4:7], s30 offen offset:2048
  ds_read_b64_tr_b16 v[224:225], v10 offset:0
  s_waitcnt lgkmcnt(5)
  v_mfma_f32_32x32x16_bf16 v[80:95], v[244:247], v[152:155], v[80:95]
  ds_read_b64_tr_b16 v[226:227], v10 offset:1024
  ds_read_b64_tr_b16 v[228:229], v11 offset:0
  ds_read_b64_tr_b16 v[230:231], v11 offset:1024
  s_waitcnt vmcnt(11) lgkmcnt(6)
  v_mfma_f32_32x32x16_bf16 v[64:79], v[248:251], v[156:159], v[64:79]
  buffer_load_dwordx4 v[204:207], v3, s[4:7], s30 offen offset:3072
  ds_read_b64_tr_b16 v[232:233], v10 offset:2048
  s_waitcnt lgkmcnt(5)
  v_mfma_f32_32x32x16_bf16 v[80:95], v[252:255], v[156:159], v[80:95]
  ds_read_b64_tr_b16 v[234:235], v10 offset:3072
  ds_read_b64_tr_b16 v[236:237], v11 offset:2048
  ds_read_b64_tr_b16 v[238:239], v11 offset:3072
  s_andn2_b32 s33, s36, s34
  s_cbranch_scc0 .fz_kernel_pk65c
.fz_kernel_pk65:
  s_ff1_i32_b32 s33, s33
  s_bitset1_b32 s34, s33
  s_lshl_b32 s27, s33, 13
  s_lshl_b32 s33, s33, 12
  s_add_u32 s30, s33, s35
  s_waitcnt vmcnt(11) lgkmcnt(6)
  v_mfma_f32_32x32x16_bf16 v[64:79], v[224:227], v[160:163], v[64:79]
  v_add_u32 v12, s25, v14
  v_add_u32 v13, s25, v15
  buffer_load_dwordx4 v[208:211], v3, s[4:7], s30 offen offset:0
  ds_read_b64_tr_b16 v[240:241], v10 offset:4096
  s_waitcnt lgkmcnt(5)
  v_mfma_f32_32x32x16_bf16 v[80:95], v[228:231], v[160:163], v[80:95]
  ds_read_b64_tr_b16 v[242:243], v10 offset:5120
  ds_read_b64_tr_b16 v[244:245], v11 offset:4096
  ds_read_b64_tr_b16 v[246:247], v11 offset:5120
  s_waitcnt vmcnt(11) lgkmcnt(6)
  v_mfma_f32_32x32x16_bf16 v[64:79], v[232:235], v[164:167], v[64:79]
  buffer_load_dwordx4 v[212:215], v3, s[4:7], s30 offen offset:1024
  ds_read_b64_tr_b16 v[248:249], v10 offset:6144
  s_waitcnt lgkmcnt(5)
  v_mfma_f32_32x32x16_bf16 v[80:95], v[236:239], v[164:167], v[80:95]
  ds_read_b64_tr_b16 v[250:251], v10 offset:7168
  ds_read_b64_tr_b16 v[252:253], v11 offset:6144
  ds_read_b64_tr_b16 v[254:255], v11 offset:7168
  s_waitcnt vmcnt(11) lgkmcnt(6)
  v_mfma_f32_32x32x16_bf16 v[64:79], v[240:243], v[168:171], v[64:79]
  buffer_load_dwordx4 v[216:219], v3, s[4:7], s30 offen offset:2048
  ds_read_b64_tr_b16 v[224:225], v12 offset:0
  s_waitcnt lgkmcnt(5)
  v_mfma_f32_32x32x16_bf16 v[80:95], v[244:247], v[168:171], v[80:95]
  ds_read_b64_tr_b16 v[226:227], v12 offset:1024
  ds_read_b64_tr_b16 v[228:229], v13 offset:0
  ds_read_b64_tr_b16 v[230:231], v13 offset:1024
  s_waitcnt vmcnt(11) lgkmcnt(6)
  v_mfma_f32_32x32x16_bf16 v[64:79], v[248:251], v[172:175], v[64:79]
  buffer_load_dwordx4 v[220:223], v3, s[4:7], s30 offen offset:3072
  ds_read_b64_tr_b16 v[232:233], v12 offset:2048
  s_waitcnt lgkmcnt(5)
  v_mfma_f32_32x32x16_bf16 v[80:95], v[252:255], v[172:175], v[80:95]
  ds_read_b64_tr_b16 v[234:235], v12 offset:3072
  ds_read_b64_tr_b16 v[236:237], v13 offset:2048
  ds_read_b64_tr_b16 v[238:239], v13 offset:3072
  s_waitcnt vmcnt(11) lgkmcnt(6)
  v_mfma_f32_32x32x16_bf16 v[64:79], v[224:227], v[176:179], v[64:79]
  v_add_u32 v10, s26, v14
  v_add_u32 v11, s26, v15
  ds_read_b64_tr_b16 v[240:241], v12 offset:4096
  s_waitcnt lgkmcnt(5)
  v_mfma_f32_32x32x16_bf16 v[80:95], v[228:231], v[176:179], v[80:95]
  ds_read_b64_tr_b16 v[242:243], v12 offset:5120
  ds_read_b64_tr_b16 v[244:245], v13 offset:4096
  ds_read_b64_tr_b16 v[246:247], v13 offset:5120
  s_waitcnt vmcnt(10) lgkmcnt(6)
  v_mfma_f32_32x32x16_bf16 v[64:79], v[232:235], v[180:183], v[64:79]
  ds_read_b64_tr_b16 v[248:249], v12 offset:6144
  s_waitcnt lgkmcnt(5)
  v_mfma_f32_32x32x16_bf16 v[80:95], v[236:239], v[180:183], v[80:95]
  ds_read_b64_tr_b16 v[250:251], v12 offset:7168
  ds_read_b64_tr_b16 v[252:253], v13 offset:6144
  ds_read_b64_tr_b16 v[254:255], v13 offset:7168
  s_waitcnt vmcnt(9) lgkmcnt(6)
  v_mfma_f32_32x32x16_bf16 v[64:79], v[240:243], v[184:187], v[64:79]
  ds_read_b64_tr_b16 v[224:225], v10 offset:0
  s_waitcnt lgkmcnt(5)
  v_mfma_f32_32x32x16_bf16 v[80:95], v[244:247], v[184:187], v[80:95]
  ds_read_b64_tr_b16 v[226:227], v10 offset:1024
  ds_read_b64_tr_b16 v[228:229], v11 offset:0
  ds_read_b64_tr_b16 v[230:231], v11 offset:1024
  s_waitcnt vmcnt(8) lgkmcnt(6)
  v_mfma_f32_32x32x16_bf16 v[64:79], v[248:251], v[188:191], v[64:79]
  ds_read_b64_tr_b16 v[232:233], v10 offset:2048
  s_waitcnt lgkmcnt(5)
  v_mfma_f32_32x32x16_bf16 v[80:95], v[252:255], v[188:191], v[80:95]
  ds_read_b64_tr_b16 v[234:235], v10 offset:3072
  ds_read_b64_tr_b16 v[236:237], v11 offset:2048
  ds_read_b64_tr_b16 v[238:239], v11 offset:3072
  s_waitcnt vmcnt(7) lgkmcnt(6)
  v_mfma_f32_32x32x16_bf16 v[64:79], v[224:227], v[192:195], v[64:79]
  v_add_u32 v12, s27, v14
  v_add_u32 v13, s27, v15
  ds_read_b64_tr_b16 v[240:241], v10 offset:4096
  s_waitcnt lgkmcnt(5)
  v_mfma_f32_32x32x16_bf16 v[80:95], v[228:231], v[192:195], v[80:95]
  ds_read_b64_tr_b16 v[242:243], v10 offset:5120
  ds_read_b64_tr_b16 v[244:245], v11 offset:4096
  ds_read_b64_tr_b16 v[246:247], v11 offset:5120
  s_waitcnt vmcnt(6) lgkmcnt(6)
  v_mfma_f32_32x32x16_bf16 v[64:79], v[232:235], v[196:199], v[64:79]
  ds_read_b64_tr_b16 v[248:249], v10 offset:6144
  s_waitcnt lgkmcnt(5)
  v_mfma_f32_32x32x16_bf16 v[80:95], v[236:239], v[196:199], v[80:95]
  ds_read_b64_tr_b16 v[250:251], v10 offset:7168
  ds_read_b64_tr_b16 v[252:253], v11 offset:6144
  ds_read_b64_tr_b16 v[254:255], v11 offset:7168
  s_waitcnt vmcnt(5) lgkmcnt(6)
  v_mfma_f32_32x32x16_bf16 v[64:79], v[240:243], v[200:203], v[64:79]
  ds_read_b64_tr_b16 v[224:225], v12 offset:0
  s_waitcnt lgkmcnt(5)
  v_mfma_f32_32x32x16_bf16 v[80:95], v[244:247], v[200:203], v[80:95]
  ds_read_b64_tr_b16 v[226:227], v12 offset:1024
  ds_read_b64_tr_b16 v[228:229], v13 offset:0
  ds_read_b64_tr_b16 v[230:231], v13 offset:1024
  s_waitcnt vmcnt(4) lgkmcnt(6)
  v_mfma_f32_32x32x16_bf16 v[64:79], v[248:251], v[204:207], v[64:79]
  ds_read_b64_tr_b16 v[232:233], v12 offset:2048
  s_waitcnt lgkmcnt(5)
  v_mfma_f32_32x32x16_bf16 v[80:95], v[252:255], v[204:207], v[80:95]
  ds_read_b64_tr_b16 v[234:235], v12 offset:3072
  ds_read_b64_tr_b16 v[236:237], v13 offset:2048
  ds_read_b64_tr_b16 v[238:239], v13 offset:3072
  s_waitcnt vmcnt(3) lgkmcnt(6)
  v_mfma_f32_32x32x16_bf16 v[64:79], v[224:227], v[208:211], v[64:79]
  ds_read_b64_tr_b16 v[240:241], v12 offset:4096
  s_waitcnt lgkmcnt(5)
  v_mfma_f32_32x32x16_bf16 v[80:95], v[228:231], v[208:211], v[80:95]
  ds_read_b64_tr_b16 v[242:243], v12 offset:5120
  ds_read_b64_tr_b16 v[244:245], v13 offset:4096
  ds_read_b64_tr_b16 v[246:247], v13 offset:5120
  s_waitcnt vmcnt(2) lgkmcnt(6)
  v_mfma_f32_32x32x16_bf16 v[64:79], v[232:235], v[212:215], v[64:79]
  ds_read_b64_tr_b16 v[248:249], v12 offset:6144
  s_waitcnt lgkmcnt(5)
  v_mfma_f32_32x32x16_bf16 v[80:95], v[236:239], v[212:215], v[80:95]
  ds_read_b64_tr_b16 v[250:251], v12 offset:7168
  ds_read_b64_tr_b16 v[252:253], v13 offset:6144
  ds_read_b64_tr_b16 v[254:255], v13 offset:7168
  s_waitcnt vmcnt(1) lgkmcnt(6)
  v_mfma_f32_32x32x16_bf16 v[64:79], v[240:243], v[216:219], v[64:79]
  s_waitcnt lgkmcnt(4)
  v_mfma_f32_32x32x16_bf16 v[80:95], v[244:247], v[216:219], v[80:95]
  s_waitcnt vmcnt(0) lgkmcnt(0)
  v_mfma_f32_32x32x16_bf16 v[64:79], v[248:251], v[220:223], v[64:79]
  v_mfma_f32_32x32x16_bf16 v[80:95], v[252:255], v[220:223], v[80:95]
  s_mov_b32 s36, 0x3f803f80
  v_mov_b32 v8, 0
  v_mov_b32 v9, 0
  v_mov_b32 v10, 0
  v_mov_b32 v11, 0
  v_mov_b32 v12, 0
  v_mov_b32 v13, 0
  v_lshlrev_b32 v19, 2, v18
  v_lshl_add_u32 v19, v17, 13, v19
  s_lshl_b32 s34, s32, 7
  s_add_u32 s34, s34, s66
  s_add_u32 s34, s34, 16384
  s_add_u32 s37, s34, 16384
  v_cvt_pk_bf16_f32 v20, v64, v65
  v_cvt_pk_bf16_f32 v21, v66, v67
  v_cvt_pk_bf16_f32 v22, v68, v69
  v_cvt_pk_bf16_f32 v23, v70, v71
  buffer_store_dwordx4 v[20:23], v16, s[4:7], s39 offen offset:0 sc1
  v_cvt_pk_bf16_f32 v24, v72, v73
  v_cvt_pk_bf16_f32 v25, v74, v75
  v_cvt_pk_bf16_f32 v26, v76, v77
  v_cvt_pk_bf16_f32 v27, v78, v79
  buffer_store_dwordx4 v[24:27], v16, s[4:7], s39 offen offset:512 sc1
  v_cvt_pk_bf16_f32 v28, v80, v81
  v_cvt_pk_bf16_f32 v29, v82, v83
  v_cvt_pk_bf16_f32 v30, v84, v85
  v_cvt_pk_bf16_f32 v31, v86, v87
  buffer_store_dwordx4 v[28:31], v16, s[4:7], s39 offen offset:1024 sc1
  v_cvt_pk_bf16_f32 v32, v88, v89
  v_cvt_pk_bf16_f32 v33, v90, v91
  v_cvt_pk_bf16_f32 v34, v92, v93
  v_cvt_pk_bf16_f32 v35, v94, v95
  buffer_store_dwordx4 v[32:35], v16, s[4:7], s39 offen offset:1536 sc1
  v_dot2c_f32_bf16 v8, s36, v20
  v_dot2c_f32_bf16 v9, v20, v20
  v_dot2c_f32_bf16 v10, v20, v48
  v_dot2c_f32_bf16 v11, s36, v21
  v_dot2c_f32_bf16 v12, v21, v21
  v_dot2c_f32_bf16 v13, v21, v49
  v_dot2c_f32_bf16 v8, s36, v22
  v_dot2c_f32_bf16 v9, v22, v22
  v_dot2c_f32_bf16 v10, v22, v50
  v_dot2c_f32_bf16 v11, s36, v23
  v_dot2c_f32_bf16 v12, v23, v23
  v_dot2c_f32_bf16 v13, v23, v51
  v_dot2c_f32_bf16 v8, s36, v24
  v_dot2c_f32_bf16 v9, v24, v24
  v_dot2c_f32_bf16 v10, v24, v52
  v_dot2c_f32_bf16 v11, s36, v25
  v_dot2c_f32_bf16 v12, v25, v25
  v_dot2c_f32_bf16 v13, v25, v53
  v_dot2c_f32_bf16 v8, s36, v26
  v_dot2c_f32_bf16 v9, v26, v26
  v_dot2c_f32_bf16 v10, v26, v54
  v_dot2c_f32_bf16 v11, s36, v27
  v_dot2c_f32_bf16 v12, v27, v27
  v_dot2c_f32_bf16 v13, v27, v55
  v_dot2c_f32_bf16 v8, s36, v28
  v_dot2c_f32_bf16 v9, v28, v28
  v_dot2c_f32_bf16 v10, v28, v56
  v_dot2c_f32_bf16 v11, s36, v29
  v_dot2c_f32_bf16 v12, v29, v29
  v_dot2c_f32_bf16 v13, v29, v57
  v_dot2c_f32_bf16 v8, s36, v30
  v_dot2c_f32_bf16 v9, v30, v30
  v_dot2c_f32_bf16 v10, v30, v58
  v_dot2c_f32_bf16 v11, s36, v31
  v_dot2c_f32_bf16 v12, v31, v31
  v_dot2c_f32_bf16 v13, v31, v59
  v_dot2c_f32_bf16 v8, s36, v32
  v_dot2c_f32_bf16 v9, v32, v32
  v_dot2c_f32_bf16 v10, v32, v60
  v_dot2c_f32_bf16 v11, s36, v33
  v_dot2c_f32_bf16 v12, v33, v33
  v_dot2c_f32_bf16 v13, v33, v61
  v_dot2c_f32_bf16 v8, s36, v34
  v_dot2c_f32_bf16 v9, v34, v34
  v_dot2c_f32_bf16 v10, v34, v62
  v_dot2c_f32_bf16 v11, s36, v35
  v_dot2c_f32_bf16 v12, v35, v35
  v_dot2c_f32_bf16 v13, v35, v63
  s_nop 0
  v_add_f32 v36, v8, v11
  v_add_f32 v37, v9, v12
  v_add_f32 v38, v10, v13
  v_fma_f32 v38, -v36, v46, v38
  v_fmac_f32 v47, 0x44800000, v37
  v_mov_b32 v39, v38
  s_nop 0
  v_permlane32_swap_b32 v36, v47
  v_permlane32_swap_b32 v38, v39
  v_add_f32 v36, v36, v47
  v_add_f32 v38, v38, v39
  buffer_atomic_add_f32 v36, v19, s[4:7], s34 offen sc1
  s_mov_b32 exec_hi, 0
  buffer_atomic_add_f32 v38, v19, s[4:7], s37 offen sc1
  s_mov_b64 exec, -1
  s_barrier
  v_add_u32 v1, 4, v6
  s_mov_b32 s72, s66
  s_mov_b32 s73, s65
  s_mov_b32 s74, s67
  s_mov_b32 s75, s62
  s_cmp_lg_u32 s62, 0
  s_cbranch_scc1 .fz_kernel_tail
  s_mov_b32 s62, 1
  s_mov_b32 s63, 0x2000000
  s_mov_b32 s64, 0x2800000
  s_mov_b32 s65, 0x1400000
  s_mov_b32 s66, 0x1c42000
  s_mov_b32 s67, 12
  s_mov_b32 s71, 159776
  v_mov_b32 v6, 159832
  s_branch .fz_kernel_q_cons2
.fz_kernel_tail:
  s_mov_b32 s28, s56
  s_mov_b32 s29, s57
  s_mov_b32 s30, 0x400000
  s_mov_b32 s31, 0x00020000
  v_lshlrev_b32 v37, 2, v45
  v_add_u32 v37, 155644, v37
  v_mov_b32 v36, 159952
  v_lshlrev_b32 v38, 11, v18
  v_lshl_add_u32 v38, v17, 4, v38
  s_lshl_b32 s32, s32, 16
  s_lshl_b32 s33, s18, 7
  s_add_u32 s32, s32, s33
  v_lshlrev_b32 v64, 16, v20
  v_and_b32 v65, 0xffff0000, v20
  v_lshlrev_b32 v66, 16, v21
  v_and_b32 v67, 0xffff0000, v21
  v_lshlrev_b32 v68, 16, v22
  v_and_b32 v69, 0xffff0000, v22
  v_lshlrev_b32 v70, 16, v23
  v_and_b32 v71, 0xffff0000, v23
  v_lshlrev_b32 v72, 16, v24
  v_and_b32 v73, 0xffff0000, v24
  v_lshlrev_b32 v74, 16, v25
  v_and_b32 v75, 0xffff0000, v25
  v_lshlrev_b32 v76, 16, v26
  v_and_b32 v77, 0xffff0000, v26
  v_lshlrev_b32 v78, 16, v27
  v_and_b32 v79, 0xffff0000, v27
  v_lshlrev_b32 v80, 16, v28
  v_and_b32 v81, 0xffff0000, v28
  v_lshlrev_b32 v82, 16, v29
  v_and_b32 v83, 0xffff0000, v29
  v_lshlrev_b32 v84, 16, v30
  v_and_b32 v85, 0xffff0000, v30
  v_lshlrev_b32 v86, 16, v31
  v_and_b32 v87, 0xffff0000, v31
  v_lshlrev_b32 v88, 16, v32
  v_and_b32 v89, 0xffff0000, v32
  v_lshlrev_b32 v90, 16, v33
  v_and_b32 v91, 0xffff0000, v33
  v_lshlrev_b32 v92, 16, v34
  v_and_b32 v93, 0xffff0000, v34
  v_lshlrev_b32 v94, 16, v35
  v_and_b32 v95, 0xffff0000, v35
  s_mov_b64 exec, 1
  s_waitcnt vmcnt(0)
  ds_add_u32 v1, v5 offset:0x100
  s_mov_b64 exec, -1
  s_barrier
  ds_read_b32 v40, v37 offset:6400
  ds_read_b32 v42, v37 offset:6912
  ds_read_b32 v36, v36
  s_waitcnt lgkmcnt(0)
  v_cmp_ne_u32 vcc, v36, v45
  s_mov_b64 exec, vcc
  v_pk_fma_f32 v[64:65], v[64:65], v[40:41], v[42:43] op_sel_hi:[1,0,0]
  v_pk_fma_f32 v[66:67], v[66:67], v[40:41], v[42:43] op_sel_hi:[1,0,0]
  v_pk_fma_f32 v[68:69], v[68:69], v[40:41], v[42:43] op_sel_hi:[1,0,0]
  v_pk_fma_f32 v[70:71], v[70:71], v[40:41], v[42:43] op_sel_hi:[1,0,0]
  v_cvt_pk_bf16_f32 v20, v64, v65
  v_cvt_pk_bf16_f32 v21, v66, v67
  v_cvt_pk_bf16_f32 v22, v68, v69
  v_cvt_pk_bf16_f32 v23, v70, v71
  buffer_store_dwordx4 v[20:23], v38, s[28:31], s32 offen offset:0
  v_pk_fma_f32 v[72:73], v[72:73], v[40:41], v[42:43] op_sel_hi:[1,0,0]
  v_pk_fma_f32 v[74:75], v[74:75], v[40:41], v[42:43] op_sel_hi:[1,0,0]
  v_pk_fma_f32 v[76:77], v[76:77], v[40:41], v[42:43] op_sel_hi:[1,0,0]
  v_pk_fma_f32 v[78:79], v[78:79], v[40:41], v[42:43] op_sel_hi:[1,0,0]
  v_cvt_pk_bf16_f32 v24, v72, v73
  v_cvt_pk_bf16_f32 v25, v74, v75
  v_cvt_pk_bf16_f32 v26, v76, v77
  v_cvt_pk_bf16_f32 v27, v78, v79
  buffer_store_dwordx4 v[24:27], v38, s[28:31], s32 offen offset:32
  v_pk_fma_f32 v[80:81], v[80:81], v[40:41], v[42:43] op_sel_hi:[1,0,0]
  v_pk_fma_f32 v[82:83], v[82:83], v[40:41], v[42:43] op_sel_hi:[1,0,0]
  v_pk_fma_f32 v[84:85], v[84:85], v[40:41], v[42:43] op_sel_hi:[1,0,0]
  v_pk_fma_f32 v[86:87], v[86:87], v[40:41], v[42:43] op_sel_hi:[1,0,0]
  v_cvt_pk_bf16_f32 v28, v80, v81
  v_cvt_pk_bf16_f32 v29, v82, v83
  v_cvt_pk_bf16_f32 v30, v84, v85
  v_cvt_pk_bf16_f32 v31, v86, v87
  buffer_store_dwordx4 v[28:31], v38, s[28:31], s32 offen offset:64
  v_pk_fma_f32 v[88:89], v[88:89], v[40:41], v[42:43] op_sel_hi:[1,0,0]
  v_pk_fma_f32 v[90:91], v[90:91], v[40:41], v[42:43] op_sel_hi:[1,0,0]
  v_pk_fma_f32 v[92:93], v[92:93], v[40:41], v[42:43] op_sel_hi:[1,0,0]
  v_pk_fma_f32 v[94:95], v[94:95], v[40:41], v[42:43] op_sel_hi:[1,0,0]
  v_cvt_pk_bf16_f32 v32, v88, v89
  v_cvt_pk_bf16_f32 v33, v90, v91
  v_cvt_pk_bf16_f32 v34, v92, v93
  v_cvt_pk_bf16_f32 v35, v94, v95
  buffer_store_dwordx4 v[32:35], v38, s[28:31], s32 offen offset:96
  s_mov_b64 exec, -1
  s_branch .fz_kernel_fin
.fz_kernel_chain:
  s_setprio 0
  s_bitcmp1_b32 s18, 0
  s_cselect_b32 s8, s52, s50
  s_cselect_b32 s9, s53, s51
  s_mov_b32 s10, 0x700000
  s_mov_b32 s11, 0x00020000
  s_lshl_b32 s12, s16, 8
  s_and_b32 s12, s12, 511
  s_and_b32 s31, s18, 2
  s_lshl_b32 s31, s31, 8
  s_add_u32 s12, s12, s31
  s_mul_i32 s12, s12, 7168
  s_lshl_b32 s31, s17, 2
  s_lshr_b32 s33, s18, 2
  s_add_u32 s31, s31, s33
  s_lshl_b32 s31, s31, 7
  s_add_u32 s12, s12, s31
  v_lshrrev_b32 v13, 3, v2
  v_mul_u32_u24 v13, 229376, v13
  v_and_b32 v11, 7, v2
  v_lshl_add_u32 v13, v11, 4, v13
  s_mov_b32 s24, s44
  s_mov_b32 s25, s45
  s_mov_b32 s26, 0x200000
  s_mov_b32 s27, 0x00020000
  v_lshrrev_b32 v8, 3, v2
  v_and_b32 v9, 7, v2
  v_bfe_u32 v10, v2, 4, 1
  v_lshlrev_b32 v10, 2, v10
  v_xor_b32 v9, v9, v10
  v_lshlrev_b32 v9, 4, v9
  v_lshl_add_u32 v10, v8, 11, v9
  s_mov_b32 s24, s54
  s_mov_b32 s25, s55
  s_mov_b32 s26, 0x700000
  s_mov_b32 s27, 0x00020000
  s_mov_b32 s36, 0x05040100
  s_mov_b32 s37, 0x07060302
  s_and_b32 s20, s16, 1
  s_lshl1_add_u32 s13, s17, s20
  s_lshl_b32 s13, s13, 18
  s_lshl_b32 s14, s18, 7
  s_add_u32 s13, s13, s14
  s_cmp_ge_u32 s17, 14
  s_cbranch_scc1 .fz_kernel_c_nl
  s_mov_b32 s38, 0
.fz_kernel_kw66:
  s_sleep 2
  ds_read_b32 v7, v6 offset:0
  s_add_u32 s38, s38, 1
  s_waitcnt lgkmcnt(0)
  v_readfirstlane_b32 s31, v7
  s_bcnt1_i32_b32 s31, s31
  s_cmp_ge_u32 s31, 16
  s_cbranch_scc1 .fz_kernel_kw66d
  s_cmp_lt_u32 s38, 1048576
  s_cbranch_scc1 .fz_kernel_kw66
.fz_kernel_kw66d:
  buffer_load_dwordx4 v[112:115], v13, s[8:11], s12 offen nt
  s_add_u32 s12, s12, 7168
  s_waitcnt vmcnt(2)
  buffer_load_dwordx4 v[116:119], v13, s[8:11], s12 offen nt
  s_add_u32 s12, s12, 7168
  s_waitcnt vmcnt(2)
  buffer_load_dwordx4 v[120:123], v13, s[8:11], s12 offen nt
  s_add_u32 s12, s12, 7168
  s_waitcnt vmcnt(2)
  buffer_load_dwordx4 v[124:127], v13, s[8:11], s12 offen nt
  s_add_u32 s12, s12, 7168
  s_waitcnt vmcnt(2)
  buffer_load_dwordx4 v[128:131], v13, s[8:11], s12 offen nt
  s_add_u32 s12, s12, 7168
  s_waitcnt vmcnt(2)
  buffer_load_dwordx4 v[132:135], v13, s[8:11], s12 offen nt
  s_add_u32 s12, s12, 7168
  s_waitcnt vmcnt(2)
  buffer_load_dwordx4 v[136:139], v13, s[8:11], s12 offen nt
  s_add_u32 s12, s12, 7168
  s_waitcnt vmcnt(2)
  buffer_load_dwordx4 v[140:143], v13, s[8:11], s12 offen nt
  s_add_u32 s12, s12, 7168
  s_waitcnt vmcnt(2)
  buffer_load_dwordx4 v[144:147], v13, s[8:11], s12 offen nt
  s_add_u32 s12, s12, 7168
  s_waitcnt vmcnt(2)
  buffer_load_dwordx4 v[148:151], v13, s[8:11], s12 offen nt
  s_add_u32 s12, s12, 7168
  s_waitcnt vmcnt(2)
  buffer_load_dwordx4 v[152:155], v13, s[8:11], s12 offen nt
  s_add_u32 s12, s12, 7168
  s_waitcnt vmcnt(2)
  buffer_load_dwordx4 v[156:159], v13, s[8:11], s12 offen nt
  s_add_u32 s12, s12, 7168
  s_waitcnt vmcnt(2)
  buffer_load_dwordx4 v[160:163], v13, s[8:11], s12 offen nt
  s_add_u32 s12, s12, 7168
  s_waitcnt vmcnt(2)
  buffer_load_dwordx4 v[164:167], v13, s[8:11], s12 offen nt
  s_add_u32 s12, s12, 7168
  s_waitcnt vmcnt(2)
  buffer_load_dwordx4 v[168:171], v13, s[8:11], s12 offen nt
  s_add_u32 s12, s12, 7168
  s_waitcnt vmcnt(2)
  buffer_load_dwordx4 v[172:175], v13, s[8:11], s12 offen nt
  s_add_u32 s12, s12, 7168
  s_waitcnt vmcnt(2)
  buffer_load_dwordx4 v[176:179], v13, s[8:11], s12 offen nt
  s_add_u32 s12, s12, 7168
  s_waitcnt vmcnt(2)
  buffer_load_dwordx4 v[180:183], v13, s[8:11], s12 offen nt
  s_add_u32 s12, s12, 7168
  s_waitcnt vmcnt(2)
  buffer_load_dwordx4 v[184:187], v13, s[8:11], s12 offen nt
  s_add_u32 s12, s12, 7168
  s_waitcnt vmcnt(2)
  buffer_load_dwordx4 v[188:191], v13, s[8:11], s12 offen nt
  s_add_u32 s12, s12, 7168
  s_waitcnt vmcnt(2)
  buffer_load_dwordx4 v[192:195], v13, s[8:11], s12 offen nt
  s_add_u32 s12, s12, 7168
  s_waitcnt vmcnt(2)
  buffer_load_dwordx4 v[196:199], v13, s[8:11], s12 offen nt
  s_add_u32 s12, s12, 7168
  s_waitcnt vmcnt(2)
  buffer_load_dwordx4 v[200:203], v13, s[8:11], s12 offen nt
  s_add_u32 s12, s12, 7168
  s_waitcnt vmcnt(2)
  buffer_load_dwordx4 v[204:207], v13, s[8:11], s12 offen nt
  s_add_u32 s12, s12, 7168
  s_waitcnt vmcnt(2)
  buffer_load_dwordx4 v[208:211], v13, s[8:11], s12 offen nt
  s_add_u32 s12, s12, 7168
  s_waitcnt vmcnt(2)
  buffer_load_dwordx4 v[212:215], v13, s[8:11], s12 offen nt
  s_add_u32 s12, s12, 7168
  s_waitcnt vmcnt(2)
  buffer_load_dwordx4 v[216:219], v13, s[8:11], s12 offen nt
  s_add_u32 s12, s12, 7168
  s_waitcnt vmcnt(2)
  buffer_load_dwordx4 v[220:223], v13, s[8:11], s12 offen nt
  s_add_u32 s12, s12, 7168
  s_waitcnt vmcnt(2)
  buffer_load_dwordx4 v[224:227], v13, s[8:11], s12 offen nt
  s_add_u32 s12, s12, 7168
  s_waitcnt vmcnt(2)
  buffer_load_dwordx4 v[228:231], v13, s[8:11], s12 offen nt
  s_add_u32 s12, s12, 7168
  s_waitcnt vmcnt(2)
  buffer_load_dwordx4 v[232:235], v13, s[8:11], s12 offen nt
  s_add_u32 s12, s12, 7168
  s_waitcnt vmcnt(2)
  buffer_load_dwordx4 v[236:239], v13, s[8:11], s12 offen nt
  s_add_u32 s12, s12, 7168
  s_waitcnt vmcnt(2)
  buffer_load_dwordx4 v[32:35], v10, s[24:27], s13 offen nt
  s_add_u32 s13, s13, 16384
  s_waitcnt vmcnt(2)
  buffer_load_dwordx4 v[36:39], v10, s[24:27], s13 offen nt
  s_add_u32 s13, s13, 16384
  s_waitcnt vmcnt(2)
  buffer_load_dwordx4 v[40:43], v10, s[24:27], s13 offen nt
  s_add_u32 s13, s13, 16384
  s_waitcnt vmcnt(2)
  buffer_load_dwordx4 v[44:47], v10, s[24:27], s13 offen nt
  s_add_u32 s13, s13, 16384
  s_waitcnt vmcnt(2)
  buffer_load_dwordx4 v[48:51], v10, s[24:27], s13 offen nt
  s_add_u32 s13, s13, 16384
  s_waitcnt vmcnt(2)
  buffer_load_dwordx4 v[52:55], v10, s[24:27], s13 offen nt
  s_add_u32 s13, s13, 16384
  s_waitcnt vmcnt(2)
  buffer_load_dwordx4 v[56:59], v10, s[24:27], s13 offen nt
  s_add_u32 s13, s13, 16384
  s_waitcnt vmcnt(2)
  buffer_load_dwordx4 v[60:63], v10, s[24:27], s13 offen nt
  s_add_u32 s13, s13, 16384
  s_waitcnt vmcnt(2)
  buffer_load_dwordx4 v[64:67], v10, s[24:27], s13 offen nt
  s_add_u32 s13, s13, 16384
  s_waitcnt vmcnt(2)
  buffer_load_dwordx4 v[68:71], v10, s[24:27], s13 offen nt
  s_add_u32 s13, s13, 16384
  s_waitcnt vmcnt(2)
  buffer_load_dwordx4 v[72:75], v10, s[24:27], s13 offen nt
  s_add_u32 s13, s13, 16384
  s_waitcnt vmcnt(2)
  buffer_load_dwordx4 v[76:79], v10, s[24:27], s13 offen nt
  s_add_u32 s13, s13, 16384
  s_waitcnt vmcnt(2)
  buffer_load_dwordx4 v[240:243], v10, s[24:27], s13 offen nt
  s_add_u32 s13, s13, 16384
  s_waitcnt vmcnt(2)
  buffer_load_dwordx4 v[244:247], v10, s[24:27], s13 offen nt
  s_add_u32 s13, s13, 16384
  s_waitcnt vmcnt(2)
  buffer_load_dwordx4 v[248:251], v10, s[24:27], s13 offen nt
  s_add_u32 s13, s13, 16384
  s_waitcnt vmcnt(2)
  buffer_load_dwordx4 v[252:255], v10, s[24:27], s13 offen nt
  s_add_u32 s13, s13, 16384
  s_waitcnt vmcnt(2)
  v_mov_b32 v16, 0x3f803f80
  v_mov_b32 v17, 0x3f803f80
  v_mov_b32 v18, 0x3f803f80
  v_mov_b32 v19, 0x3f803f80
  s_waitcnt vmcnt(0)
  s_barrier
  v_perm_b32 v80, v116, v112, s36
  v_perm_b32 v84, v116, v112, s37
  v_perm_b32 v88, v117, v113, s36
  v_perm_b32 v92, v117, v113, s37
  v_perm_b32 v96, v118, v114, s36
  v_perm_b32 v100, v118, v114, s37
  v_perm_b32 v104, v119, v115, s36
  v_perm_b32 v108, v119, v115, s37
  v_perm_b32 v81, v124, v120, s36
  v_perm_b32 v85, v124, v120, s37
  v_perm_b32 v89, v125, v121, s36
  v_perm_b32 v93, v125, v121, s37
  v_perm_b32 v97, v126, v122, s36
  v_perm_b32 v101, v126, v122, s37
  v_perm_b32 v105, v127, v123, s36
  v_perm_b32 v109, v127, v123, s37
  v_perm_b32 v82, v132, v128, s36
  v_perm_b32 v86, v132, v128, s37
  v_perm_b32 v90, v133, v129, s36
  v_perm_b32 v94, v133, v129, s37
  v_perm_b32 v98, v134, v130, s36
  v_perm_b32 v102, v134, v130, s37
  v_perm_b32 v106, v135, v131, s36
  v_perm_b32 v110, v135, v131, s37
  v_perm_b32 v83, v140, v136, s36
  v_perm_b32 v87, v140, v136, s37
  v_perm_b32 v91, v141, v137, s36
  v_perm_b32 v95, v141, v137, s37
  v_perm_b32 v99, v142, v138, s36
  v_perm_b32 v103, v142, v138, s37
  v_perm_b32 v107, v143, v139, s36
  v_perm_b32 v111, v143, v139, s37
  v_perm_b32 v112, v148, v144, s36
  v_perm_b32 v116, v148, v144, s37
  v_perm_b32 v120, v149, v145, s36
  v_perm_b32 v124, v149, v145, s37
  v_perm_b32 v128, v150, v146, s36
  v_perm_b32 v132, v150, v146, s37
  v_perm_b32 v136, v151, v147, s36
  v_perm_b32 v140, v151, v147, s37
  v_perm_b32 v113, v156, v152, s36
  v_perm_b32 v117, v156, v152, s37
  v_perm_b32 v121, v157, v153, s36
  v_perm_b32 v125, v157, v153, s37
  v_perm_b32 v129, v158, v154, s36
  v_perm_b32 v133, v158, v154, s37
  v_perm_b32 v137, v159, v155, s36
  v_perm_b32 v141, v159, v155, s37
  v_perm_b32 v114, v164, v160, s36
  v_perm_b32 v118, v164, v160, s37
  v_perm_b32 v122, v165, v161, s36
  v_perm_b32 v126, v165, v161, s37
  v_perm_b32 v130, v166, v162, s36
  v_perm_b32 v134, v166, v162, s37
  v_perm_b32 v138, v167, v163, s36
  v_perm_b32 v142, v167, v163, s37
  v_perm_b32 v115, v172, v168, s36
  v_perm_b32 v119, v172, v168, s37
  v_perm_b32 v123, v173, v169, s36
  v_perm_b32 v127, v173, v169, s37
  v_perm_b32 v131, v174, v170, s36
  v_perm_b32 v135, v174, v170, s37
  v_perm_b32 v139, v175, v171, s36
  v_perm_b32 v143, v175, v171, s37
  v_perm_b32 v144, v180, v176, s36
  v_perm_b32 v148, v180, v176, s37
  v_perm_b32 v152, v181, v177, s36
  v_perm_b32 v156, v181, v177, s37
  v_perm_b32 v160, v182, v178, s36
  v_perm_b32 v164, v182, v178, s37
  v_perm_b32 v168, v183, v179, s36
  v_perm_b32 v172, v183, v179, s37
  v_perm_b32 v145, v188, v184, s36
  v_perm_b32 v149, v188, v184, s37
  v_perm_b32 v153, v189, v185, s36
  v_perm_b32 v157, v189, v185, s37
  v_perm_b32 v161, v190, v186, s36
  v_perm_b32 v165, v190, v186, s37
  v_perm_b32 v169, v191, v187, s36
  v_perm_b32 v173, v191, v187, s37
  v_perm_b32 v146, v196, v192, s36
  v_perm_b32 v150, v196, v192, s37
  v_perm_b32 v154, v197, v193, s36
  v_perm_b32 v158, v197, v193, s37
  v_perm_b32 v162, v198, v194, s36
  v_perm_b32 v166, v198, v194, s37
  v_perm_b32 v170, v199, v195, s36
  v_perm_b32 v174, v199, v195, s37
  v_perm_b32 v147, v204, v200, s36
  v_perm_b32 v151, v204, v200, s37
  v_perm_b32 v155, v205, v201, s36
  v_perm_b32 v159, v205, v201, s37
  v_perm_b32 v163, v206, v202, s36
  v_perm_b32 v167, v206, v202, s37
  v_perm_b32 v171, v207, v203, s36
  v_perm_b32 v175, v207, v203, s37
  v_perm_b32 v176, v212, v208, s36
  v_perm_b32 v180, v212, v208, s37
  v_perm_b32 v184, v213, v209, s36
  v_perm_b32 v188, v213, v209, s37
  v_perm_b32 v192, v214, v210, s36
  v_perm_b32 v196, v214, v210, s37
  v_perm_b32 v200, v215, v211, s36
  v_perm_b32 v204, v215, v211, s37
  v_perm_b32 v177, v220, v216, s36
  v_perm_b32 v181, v220, v216, s37
  v_perm_b32 v185, v221, v217, s36
  v_perm_b32 v189, v221, v217, s37
  v_perm_b32 v193, v222, v218, s36
  v_perm_b32 v197, v222, v218, s37
  v_perm_b32 v201, v223, v219, s36
  v_perm_b32 v205, v223, v219, s37
  v_perm_b32 v178, v228, v224, s36
  v_perm_b32 v182, v228, v224, s37
  v_perm_b32 v186, v229, v225, s36
  v_perm_b32 v190, v229, v225, s37
  v_perm_b32 v194, v230, v226, s36
  v_perm_b32 v198, v230, v226, s37
  v_perm_b32 v202, v231, v227, s36
  v_perm_b32 v206, v231, v227, s37
  v_perm_b32 v179, v236, v232, s36
  v_perm_b32 v183, v236, v232, s37
  v_perm_b32 v187, v237, v233, s36
  v_perm_b32 v191, v237, v233, s37
  v_perm_b32 v195, v238, v234, s36
  v_perm_b32 v199, v238, v234, s37
  v_perm_b32 v203, v239, v235, s36
  v_perm_b32 v207, v239, v235, s37
  v_mfma_f32_16x16x32_bf16 v[208:211], v[16:19], v[80:83], 0
  v_mfma_f32_16x16x32_bf16 v[212:215], v[16:19], v[84:87], 0
  v_mfma_f32_16x16x32_bf16 v[216:219], v[16:19], v[88:91], 0
  v_mfma_f32_16x16x32_bf16 v[220:223], v[16:19], v[92:95], 0
  v_mfma_f32_16x16x32_bf16 v[224:227], v[16:19], v[96:99], 0
  v_mfma_f32_16x16x32_bf16 v[228:231], v[16:19], v[100:103], 0
  v_mfma_f32_16x16x32_bf16 v[232:235], v[16:19], v[104:107], 0
  v_mfma_f32_16x16x32_bf16 v[236:239], v[16:19], v[108:111], 0
  v_mfma_f32_16x16x32_bf16 v[208:211], v[16:19], v[112:115], v[208:211]
  v_mfma_f32_16x16x32_bf16 v[212:215], v[16:19], v[116:119], v[212:215]
  v_mfma_f32_16x16x32_bf16 v[216:219], v[16:19], v[120:123], v[216:219]
  v_mfma_f32_16x16x32_bf16 v[220:223], v[16:19], v[124:127], v[220:223]
  v_mfma_f32_16x16x32_bf16 v[224:227], v[16:19], v[128:131], v[224:227]
  v_mfma_f32_16x16x32_bf16 v[228:231], v[16:19], v[132:135], v[228:231]
  v_mfma_f32_16x16x32_bf16 v[232:235], v[16:19], v[136:139], v[232:235]
  v_mfma_f32_16x16x32_bf16 v[236:239], v[16:19], v[140:143], v[236:239]
  v_mfma_f32_16x16x32_bf16 v[208:211], v[16:19], v[144:147], v[208:211]
  v_mfma_f32_16x16x32_bf16 v[212:215], v[16:19], v[148:151], v[212:215]
  v_mfma_f32_16x16x32_bf16 v[216:219], v[16:19], v[152:155], v[216:219]
  v_mfma_f32_16x16x32_bf16 v[220:223], v[16:19], v[156:159], v[220:223]
  v_mfma_f32_16x16x32_bf16 v[224:227], v[16:19], v[160:163], v[224:227]
  v_mfma_f32_16x16x32_bf16 v[228:231], v[16:19], v[164:167], v[228:231]
  v_mfma_f32_16x16x32_bf16 v[232:235], v[16:19], v[168:171], v[232:235]
  v_mfma_f32_16x16x32_bf16 v[236:239], v[16:19], v[172:175], v[236:239]
  v_mfma_f32_16x16x32_bf16 v[208:211], v[16:19], v[176:179], v[208:211]
  v_mfma_f32_16x16x32_bf16 v[212:215], v[16:19], v[180:183], v[212:215]
  v_mfma_f32_16x16x32_bf16 v[216:219], v[16:19], v[184:187], v[216:219]
  v_mfma_f32_16x16x32_bf16 v[220:223], v[16:19], v[188:191], v[220:223]
  v_mfma_f32_16x16x32_bf16 v[224:227], v[16:19], v[192:195], v[224:227]
  v_mfma_f32_16x16x32_bf16 v[228:231], v[16:19], v[196:199], v[228:231]
  v_mfma_f32_16x16x32_bf16 v[232:235], v[16:19], v[200:203], v[232:235]
  v_mfma_f32_16x16x32_bf16 v[236:239], v[16:19], v[204:207], v[236:239]
  s_nop 0
  v_add_f32 v28, v209, v208 row_ror:8 row_mask:0xf bank_mask:0x3
  v_add_f32 v29, v213, v212 row_ror:8 row_mask:0xf bank_mask:0x3
  v_add_f32 v30, v217, v216 row_ror:8 row_mask:0xf bank_mask:0x3
  v_add_f32 v31, v221, v220 row_ror:8 row_mask:0xf bank_mask:0x3
  v_add_f32 v28, v224, v225 row_ror:8 row_mask:0xf bank_mask:0xc
  v_add_f32 v29, v228, v229 row_ror:8 row_mask:0xf bank_mask:0xc
  v_add_f32 v30, v232, v233 row_ror:8 row_mask:0xf bank_mask:0xc
  v_add_f32 v31, v236, v237 row_ror:8 row_mask:0xf bank_mask:0xc
  v_mul_f32 v28, 0.0009765625, v28
  v_mul_f32 v29, 0.0009765625, v29
  v_mul_f32 v30, 0.0009765625, v30
  v_mul_f32 v31, 0.0009765625, v31
.fz_kernel_c_np:
  v_mov_b32 v27, v6
  s_mov_b32 s72, s66
  s_mov_b32 s73, s65
  s_mov_b32 s74, s67
  s_mov_b32 s75, s62
  s_cmp_lg_u32 s62, 0
  s_cbranch_scc1 .fz_kernel_c_n2
  s_mov_b32 s62, 1
  s_mov_b32 s63, 0x2000000
  s_mov_b32 s64, 0x2800000
  s_mov_b32 s65, 0x1400000
  s_mov_b32 s66, 0x1c42000
  s_mov_b32 s67, 12
  s_mov_b32 s71, 159776
  v_mov_b32 v6, 159832
.fz_kernel_c_n2:
  s_lshr_b32 s21, s17, 3
  s_add_u32 s70, s18, s21
  s_lshl1_add_u32 s70, s17, s70
  s_and_b32 s70, s70, 15
  s_cmp_eq_u32 s75, 0
  s_cselect_b32 s3, 32, 0
  s_cselect_b32 s70, s70, s18
  s_and_b32 s20, s16, 1
  s_mov_b32 s34, 0x00030003
  s_mov_b32 s35, 0x00030003
  s_mov_b32 s71, 0
  s_lshl1_add_u32 s26, s17, s20
  v_lshrrev_b32 v8, 4, v2
  v_lshrrev_b32 v12, 5, v2
  v_lshlrev_b32 v12, 10, v12
  v_bfe_u32 v14, v2, 3, 2
  v_lshl_add_u32 v12, v14, 8, v12
  v_and_b32 v14, 7, v2
  v_lshl_add_u32 v12, v14, 1, v12
  v_lshlrev_b32 v10, 7, v2
  v_lshrrev_b32 v14, 1, v8
  v_mul_u32_u24 v7, 12288, v14
  v_and_b32 v14, 1, v8
  v_lshl_add_u32 v7, v14, 11, v7
  v_bfe_u32 v14, v2, 2, 2
  v_lshl_add_u32 v7, v14, 7, v7
  v_lshrrev_b32 v14, 1, v14
  v_lshl_add_u32 v14, s20, 1, v14
  v_lshl_add_u32 v7, v14, 5, v7
  v_and_b32 v14, 3, v2
  v_lshl_add_u32 v7, v14, 3, v7
  v_add_u32 v7, 65536, v7
  v_xor_b32 v9, 32, v7
  s_and_b32 s61, s18, 2
  s_add_u32 s61, s61, s20
  s_and_b32 s32, s18, 1
  s_lshl2_add_u32 s32, s32, s61
  s_lshl_b32 s32, s32, 9
  s_lshl_b32 s22, s17, 13
  s_add_u32 s32, s32, s22
  s_and_b32 s22, s18, 8
  s_lshl_b32 s22, s22, 9
  s_add_u32 s32, s32, s22
  s_and_b32 s22, s18, 4
  s_lshl_b32 s22, s22, 6
  s_add_u32 s32, s32, s22
  s_add_u32 s32, s32, s72
  s_add_u32 s32, s32, 40960
  s_lshl_b32 s61, s61, 16
  s_lshl_b32 s33, s26, 12
  s_add_u32 s33, s33, s72
  s_add_u32 s33, s33, 40960
  s_mul_i32 s39, s18, 28
  s_add_u32 s39, s39, s26
  s_lshl_b32 s39, s39, 8
  s_add_u32 s39, s39, s72
  s_add_u32 s39, s39, 155648
  s_lshl4_add_u32 s60, s18, s17
  s_lshl_b32 s60, s60, 10
  s_add_u32 s60, s60, 0x1c84000
  s_add_u32 s21, s74, 0x1800008
  s_sub_u32 s22, s72, 32768
  v_mov_b32 v14, s21
  v_mov_b32 v15, s22
  v_cmp_gt_u32 vcc, 16, v2
  s_nop 1
  v_cndmask_b32 v14, v15, v14, vcc
  v_lshl_add_u32 v14, v2, 11, v14
  s_lshl_b32 s25, s17, 7
  s_lshl_b32 s22, 1, s18
  v_mov_b32 v15, s22
  v_lshlrev_b32 v16, 3, v2
  s_and_b32 s21, s2, 7
  s_lshl_b32 s21, s21, 11
  s_lshl_b32 s22, s20, 10
  s_add_u32 s21, s21, s22
  s_add_u32 s21, s21, s72
  s_lshl_b32 s22, s20, 12
  s_add_u32 s22, s22, s72
  s_add_u32 s22, s22, 16384
  s_add_u32 s23, s22, 8192
  s_add_u32 s24, s22, 16384
  v_and_b32 v17, 1, v8
  v_lshlrev_b32 v17, 13, v17
  v_lshrrev_b32 v18, 1, v8
  v_mul_u32_u24 v18, 320, v18
  v_add_u32 v17, v17, v18
  v_bfe_u32 v18, v2, 3, 1
  v_lshl_add_u32 v17, v18, 9, v17
  v_bfe_u32 v18, v2, 2, 1
  v_lshl_add_u32 v17, v18, 7, v17
  v_and_b32 v18, 3, v2
  v_lshl_add_u32 v17, v18, 3, v17
  s_lshl_b32 s27, s20, 14
  s_add_u32 s27, s27, 114688
  v_add_u32 v17, s27, v17
  v_xor_b32 v18, 64, v17
  v_and_b32 v20, 7, v2
  v_lshlrev_b32 v20, 5, v20
  v_and_b32 v21, 8, v2
  v_lshl_add_u32 v20, v21, 1, v20
  v_and_b32 v21, 31, v2
  v_lshlrev_b32 v21, 4, v21
  v_lshrrev_b32 v22, 5, v2
  v_lshl_add_u32 v21, v22, 11, v21
  v_mov_b32 v23, 0.0009765625
  v_mov_b32 v24, 9.5367431640625e-07
  v_mov_b32 v25, 1e-05
  v_add_u32 v26, 155648, v16
  s_lshl_b32 s14, s17, 9
  s_add_u32 s14, s14, s72
  s_add_u32 s14, s14, 16384
  s_add_u32 s15, s14, 8192
  v_add_u32 v13, s27, v3
  s_barrier
.fz_kernel_c_n3:
  s_mov_b32 s13, 0xff0000
  s_cmp_eq_u32 s20, 0
  s_cbranch_scc1 .fz_kernel_c_nf
  s_cmp_eq_u32 s75, 0
  s_cselect_b32 exec_lo, 0xffff, s13
  s_mov_b32 exec_hi, 0
  s_mov_b32 s38, 0
.fz_kernel_cw67:
  s_sleep 1
  ds_read_u8 v22, v27 offset:268
  s_add_u32 s38, s38, 1
  s_waitcnt lgkmcnt(0)
  v_cmp_gt_u32 vcc, 4, v22
  s_cbranch_vccz .fz_kernel_cw67d
  s_cmp_lt_u32 s38, 8388608
  s_cbranch_scc1 .fz_kernel_cw67
.fz_kernel_cw67d:
  buffer_atomic_or v15, v14, s[4:7], s25 offen sc1
  s_mov_b64 exec, -1
.fz_kernel_c_nf:
  s_add_u32 s13, s19, s74
  s_mov_b64 exec, 1
  buffer_load_dword v11, v4, s[4:7], s13 offen offset:8 sc1
  s_mov_b64 exec, -1
  ds_write_b128 v13, v[32:35] offset:0
  ds_write_b128 v13, v[36:39] offset:1024
  ds_write_b128 v13, v[40:43] offset:2048
  ds_write_b128 v13, v[44:47] offset:3072
  ds_write_b128 v13, v[48:51] offset:4096
  ds_write_b128 v13, v[52:55] offset:5120
  ds_write_b128 v13, v[56:59] offset:6144
  ds_write_b128 v13, v[60:63] offset:7168
  ds_write_b128 v13, v[64:67] offset:8192
  ds_write_b128 v13, v[68:71] offset:9216
  ds_write_b128 v13, v[72:75] offset:10240
  ds_write_b128 v13, v[76:79] offset:11264
  ds_write_b128 v13, v[240:243] offset:12288
  ds_write_b128 v13, v[244:247] offset:13312
  ds_write_b128 v13, v[248:251] offset:14336
  ds_write_b128 v13, v[252:255] offset:15360
  v_and_b32 v14, 1, v2
  v_lshlrev_b32 v14, 10, v14
  v_lshl_add_u32 v14, v8, 14, v14
  v_add_u32 v14, s61, v14
  s_waitcnt lgkmcnt(0)
  s_cmp_lg_u32 s75, 0
  s_cbranch_scc1 .fz_kernel_c_nw
  v_mov_b32 v13, v9
  s_lshl_b32 s21, s18, 10
  s_add_u32 s21, s21, s72
  s_cmp_lg_u32 s20, 0
  s_cbranch_scc1 .fz_kernel_c_c7
  s_add_u32 s22, s19, s74
  s_add_u32 s23, s14, 16384
  s_mov_b64 exec, 1
  s_mov_b32 s38, 0
  s_branch .fz_kernel_c_c00
.fz_kernel_c_c0:
  s_sleep 6
  buffer_load_dword v11, v4, s[4:7], s22 offen offset:8 sc1
.fz_kernel_c_c00:
  s_add_u32 s38, s38, 1
  s_waitcnt vmcnt(0)
  ds_or_b32 v6, v11 offset:0x114
  v_or_b32 v11, v11, v15
  v_cmp_ne_u32 vcc, 0xffff, v11
  s_cbranch_vccz .fz_kernel_c_c1
  s_cmp_lt_u32 s38, 131072
  s_cbranch_scc1 .fz_kernel_c_c0
.fz_kernel_c_c1:
  s_mov_b32 s38, 0
.fz_kernel_cw68:
  s_sleep 1
  ds_read_u8 v22, v27 offset:268
  s_add_u32 s38, s38, 1
  s_waitcnt lgkmcnt(0)
  v_cmp_gt_u32 vcc, 4, v22
  s_cbranch_vccz .fz_kernel_cw68d
  s_cmp_lt_u32 s38, 8388608
  s_cbranch_scc1 .fz_kernel_cw68
.fz_kernel_cw68d:
  ds_or_b32 v6, v11 offset:0x114
  s_mov_b64 exec, -1
  buffer_load_dwordx2 v[240:241], v16, s[4:7], s14 offen
  buffer_load_dwordx2 v[242:243], v16, s[4:7], s15 offen
  buffer_load_dwordx2 v[244:245], v16, s[4:7], s23 offen
  s_lshl_b32 s23, s17, 6
  s_add_u32 s23, s23, s21
  s_lshl_b32 s24, s17, 18
  s_add_u32 s24, s24, 1
  v_and_b32 v19, 0x38, v2
  v_lshl_add_u32 v19, v19, 8, s24
  v_and_b32 v208, 7, v2
  v_lshl_add_u32 v19, v208, 5, v19
  s_mov_b32 s38, 0
.fz_kernel_cw69:
  s_sleep 1
  ds_read_u8 v22, v6 offset:272
  s_add_u32 s38, s38, 1
  s_waitcnt lgkmcnt(0)
  v_cmp_gt_u32 vcc, 2, v22
  s_cbranch_vccz .fz_kernel_cw69d
  s_cmp_lt_u32 s38, 8388608
  s_cbranch_scc1 .fz_kernel_cw69
.fz_kernel_cw69d:
  ds_read_b64_tr_b16 v[32:33], v7 offset:0
  ds_read_b64_tr_b16 v[34:35], v7 offset:512
  ds_read_b64_tr_b16 v[36:37], v13 offset:0
  ds_read_b64_tr_b16 v[38:39], v13 offset:512
  ds_read_b64_tr_b16 v[40:41], v7 offset:4096
  ds_read_b64_tr_b16 v[42:43], v7 offset:4608
  ds_read_b64_tr_b16 v[44:45], v13 offset:4096
  ds_read_b64_tr_b16 v[46:47], v13 offset:4608
  ds_read_b64_tr_b16 v[48:49], v7 offset:8192
  ds_read_b64_tr_b16 v[50:51], v7 offset:8704
  ds_read_b64_tr_b16 v[52:53], v13 offset:8192
  ds_read_b64_tr_b16 v[54:55], v13 offset:8704
  s_waitcnt lgkmcnt(0)
  v_xor_b32 v7, 64, v7
  v_xor_b32 v13, 64, v13
  ds_read_b64_tr_b16 v[56:57], v7 offset:1024
  ds_read_b64_tr_b16 v[58:59], v7 offset:1536
  ds_read_b64_tr_b16 v[60:61], v13 offset:1024
  ds_read_b64_tr_b16 v[62:63], v13 offset:1536
  ds_read_b64_tr_b16 v[64:65], v7 offset:5120
  ds_read_b64_tr_b16 v[66:67], v7 offset:5632
  ds_read_b64_tr_b16 v[68:69], v13 offset:5120
  ds_read_b64_tr_b16 v[70:71], v13 offset:5632
  ds_read_b64_tr_b16 v[72:73], v7 offset:9216
  ds_read_b64_tr_b16 v[74:75], v7 offset:9728
  ds_read_b64_tr_b16 v[76:77], v13 offset:9216
  ds_read_b64_tr_b16 v[78:79], v13 offset:9728
  s_waitcnt lgkmcnt(0)
  s_waitcnt vmcnt(0)
  v_fma_f32 v208, -v240, v240, v242
  v_fma_f32 v209, -v241, v241, v243
  v_rsq_f32 v208, abs(v208)
  v_rsq_f32 v209, abs(v209)
  v_mul_f32 v208, v208, v244
  v_mul_f32 v209, v209, v245
  v_and_b32 v208, -2, v208
  v_or_b32 v209, 1, v209
  v_cmp_gt_f32 vcc, v209, v208
  v_max_f32 v9, v208, v209
  s_nop 0
  v_cndmask_b32 v210, v240, v241, vcc
  v_max_f32 v7, v9, v9 row_ror:8 row_mask:0xf bank_mask:0xf
  v_cndmask_b32 v211, v242, v243, vcc
  s_nop 0
  v_max_f32 v7, v7, v7 row_ror:4 row_mask:0xf bank_mask:0xf
  s_nop 1
  v_max_f32 v7, v7, v7 row_ror:2 row_mask:0xf bank_mask:0xf
  s_nop 1
  v_max_f32 v7, v7, v7 row_ror:1 row_mask:0xf bank_mask:0xf
  s_nop 1
  v_max_f32 v7, v7, v7 row_bcast:15 row_mask:0xa bank_mask:0xf
  s_nop 1
  v_max_f32 v7, v7, v7 row_bcast:31 row_mask:0xc bank_mask:0xf
  v_and_b32 v209, 1, v9
  v_lshl_add_u32 v209, v209, 4, v19
  v_readlane_b32 s22, v7, 63
  v_mov_b32 v208, v9
  s_nop 0
  v_cmp_eq_u32 vcc, s22, v9
  s_ff1_i32_b64 s22, vcc
  s_lshl_b64 exec, 1, s22
  buffer_store_dwordx4 v[208:211], v4, s[4:7], s23 offen sc1
  s_mov_b64 exec, -1
.fz_kernel_c_c2:
  s_cmp_lg_u32 s20, 0
  s_cbranch_scc1 .fz_kernel_c_c21
  s_call_b64 s[68:69], .fz_kernel_c_coef
  ds_write_b64 v26, v[248:249] offset:4608
  ds_write_b64 v26, v[250:251] offset:5120
  ds_write_b64 v26, v[252:253] offset:6400
  ds_write_b64 v26, v[254:255] offset:6912
.fz_kernel_c_c21:
.fz_kernel_c_c22:
  s_cmp_le_u32 s3, 28
  s_cbranch_scc1 .fz_kernel_c_c3
  s_barrier
  s_sub_u32 s3, s3, 1
  s_branch .fz_kernel_c_c22
.fz_kernel_c_c3:
  v_lshlrev_b32 v22, 6, v2
  s_mov_b64 exec, 0xffff
  s_mov_b32 s38, 0
.fz_kernel_c_c4:
  buffer_load_dwordx4 v[224:227], v22, s[4:7], s21 offen sc1
  s_add_u32 s38, s38, 1
  s_mov_b32 s46, 0
  s_call_b64 s[0:1], .fz_kernel_hw
  s_waitcnt vmcnt(0)
  v_min_u32 v9, v225, v227
  v_max_f32 v7, v224, v224 row_ror:8 row_mask:0xf bank_mask:0xf
  v_cmp_eq_u32 vcc, 0, v9
  s_cbranch_vccz .fz_kernel_c_c5
  s_cmp_lt_u32 s38, 131072
  s_cbranch_scc1 .fz_kernel_c_c4
.fz_kernel_c_c5:
  s_waitcnt lgkmcnt(0)
  v_max_f32 v7, v7, v7 row_ror:4 row_mask:0xf bank_mask:0xf
  s_nop 1
  v_max_f32 v7, v7, v7 row_ror:2 row_mask:0xf bank_mask:0xf
  s_nop 1
  v_max_f32 v7, v7, v7 row_ror:1 row_mask:0xf bank_mask:0xf
  v_cmp_eq_u32 vcc, v7, v224
  s_or_b32 s22, vcc_lo, 0x8000
  s_ff1_i32_b32 s22, s22
  v_readlane_b32 s77, v225, s22
  s_mov_b64 exec, s[34:35]
  s_and_b32 s77, s77, 0x3c38f0
  s_add_u32 s78, s77, s73
  buffer_load_dwordx4 v[208:211], v14, s[4:7], s78 offen offset:0
  buffer_load_dwordx4 v[212:215], v14, s[4:7], s78 offen offset:256
  buffer_load_dwordx4 v[216:219], v14, s[4:7], s78 offen offset:512
  buffer_load_dwordx4 v[220:223], v14, s[4:7], s78 offen offset:768
  s_mov_b64 exec, -1
  s_cmp_eq_u32 s3, 0
  s_cbranch_scc1 .fz_kernel_hb71
  s_barrier
  s_sub_u32 s3, s3, 1
.fz_kernel_hb71:
  v_readlane_b32 s27, v224, s22
  v_readlane_b32 s23, v226, s22
  v_readlane_b32 s24, v227, s22
  s_lshr_b32 s21, s77, 11
  s_and_b32 s22, s21, 7
  s_and_b32 s21, s21, 0x780
  s_lshl4_add_u32 s21, s22, s21
  s_bfe_u32 s77, s77, 0x40004
  s_add_u32 s77, s77, s21
  v_mov_b32 v11, s23
  v_mov_b32 v15, s24
  s_branch .fz_kernel_c_idx
.fz_kernel_c_nw:
  s_mov_b64 exec, 0xff
  s_mov_b32 s38, 0
.fz_kernel_c_gm:
  buffer_load_dword v9, v10, s[4:7], s21 offen sc1
  s_add_u32 s38, s38, 1
  s_waitcnt vmcnt(0)
  v_cmp_ne_u32 vcc, 0xffff, v9
  s_cbranch_vccz .fz_kernel_c_gmd
  s_sleep 10
  s_cmp_lt_u32 s38, 131072
  s_cbranch_scc1 .fz_kernel_c_gm
.fz_kernel_c_gmd:
  s_mov_b64 exec, -1
  buffer_load_dwordx4 v[208:211], v3, s[4:7], s22 offen offset:0
  buffer_load_dwordx4 v[212:215], v3, s[4:7], s23 offen offset:0
  buffer_load_dwordx4 v[216:219], v3, s[4:7], s24 offen offset:0
  buffer_load_dwordx4 v[220:223], v3, s[4:7], s22 offen offset:1024
  buffer_load_dwordx4 v[224:227], v3, s[4:7], s23 offen offset:1024
  buffer_load_dwordx4 v[228:231], v3, s[4:7], s24 offen offset:1024
  buffer_load_dwordx4 v[232:235], v3, s[4:7], s22 offen offset:2048
  buffer_load_dwordx4 v[236:239], v3, s[4:7], s23 offen offset:2048
  buffer_load_dwordx4 v[240:243], v3, s[4:7], s24 offen offset:2048
  buffer_load_dwordx4 v[244:247], v3, s[4:7], s22 offen offset:3072
  buffer_load_dwordx4 v[248:251], v3, s[4:7], s23 offen offset:3072
  buffer_load_dwordx4 v[252:255], v3, s[4:7], s24 offen offset:3072
  s_lshl_b32 s21, s75, 4
  s_add_u32 s21, s21, 159968
  v_mov_b32 v10, s21
  s_lshl_b32 s22, s20, 3
  v_add_u32 v13, s22, v10
  s_waitcnt vmcnt(10)
  v_fma_f32 v212, -v208, v208, v212
  v_fma_f32 v213, -v209, v209, v213
  v_fma_f32 v214, -v210, v210, v214
  v_fma_f32 v215, -v211, v211, v215
  v_rsq_f32 v212, abs(v212)
  v_rsq_f32 v213, abs(v213)
  v_rsq_f32 v214, abs(v214)
  v_rsq_f32 v215, abs(v215)
  s_waitcnt vmcnt(9)
  v_mul_f32 v216, v216, v212
  v_mul_f32 v217, v217, v213
  v_mul_f32 v218, v218, v214
  v_mul_f32 v219, v219, v215
  v_and_or_b32 v216, v216, -16, 0
  v_and_or_b32 v217, v217, -16, 1
  v_and_or_b32 v218, v218, -16, 2
  v_and_or_b32 v219, v219, -16, 3
  v_max3_f32 v9, v216, v217, v218
  v_max_f32 v9, v9, v219
  s_waitcnt vmcnt(7)
  v_fma_f32 v224, -v220, v220, v224
  v_fma_f32 v225, -v221, v221, v225
  v_fma_f32 v226, -v222, v222, v226
  v_fma_f32 v227, -v223, v223, v227
  v_rsq_f32 v224, abs(v224)
  v_rsq_f32 v225, abs(v225)
  v_rsq_f32 v226, abs(v226)
  v_rsq_f32 v227, abs(v227)
  s_waitcnt vmcnt(6)
  v_mul_f32 v228, v228, v224
  v_mul_f32 v229, v229, v225
  v_mul_f32 v230, v230, v226
  v_mul_f32 v231, v231, v227
  v_and_or_b32 v228, v228, -16, 4
  v_and_or_b32 v229, v229, -16, 5
  v_and_or_b32 v230, v230, -16, 6
  v_and_or_b32 v231, v231, -16, 7
  v_max3_f32 v9, v9, v228, v229
  v_max3_f32 v9, v9, v230, v231
  s_waitcnt vmcnt(4)
  v_fma_f32 v236, -v232, v232, v236
  v_fma_f32 v237, -v233, v233, v237
  v_fma_f32 v238, -v234, v234, v238
  v_fma_f32 v239, -v235, v235, v239
  v_rsq_f32 v236, abs(v236)
  v_rsq_f32 v237, abs(v237)
  v_rsq_f32 v238, abs(v238)
  v_rsq_f32 v239, abs(v239)
  s_waitcnt vmcnt(3)
  v_mul_f32 v240, v240, v236
  v_mul_f32 v241, v241, v237
  v_mul_f32 v242, v242, v238
  v_mul_f32 v243, v243, v239
  v_and_or_b32 v240, v240, -16, 8
  v_and_or_b32 v241, v241, -16, 9
  v_and_or_b32 v242, v242, -16, 10
  v_and_or_b32 v243, v243, -16, 11
  v_max3_f32 v9, v9, v240, v241
  v_max3_f32 v9, v9, v242, v243
  s_waitcnt vmcnt(1)
  v_fma_f32 v248, -v244, v244, v248
  v_fma_f32 v249, -v245, v245, v249
  v_fma_f32 v250, -v246, v246, v250
  v_fma_f32 v251, -v247, v247, v251
  v_rsq_f32 v248, abs(v248)
  v_rsq_f32 v249, abs(v249)
  v_rsq_f32 v250, abs(v250)
  v_rsq_f32 v251, abs(v251)
  s_waitcnt vmcnt(0)
  v_mul_f32 v252, v252, v248
  v_mul_f32 v253, v253, v249
  v_mul_f32 v254, v254, v250
  v_mul_f32 v255, v255, v251
  v_and_or_b32 v252, v252, -16, 12
  v_and_or_b32 v253, v253, -16, 13
  v_and_or_b32 v254, v254, -16, 14
  v_and_or_b32 v255, v255, -16, 15
  v_max3_f32 v9, v9, v252, v253
  v_max3_f32 v9, v9, v254, v255
  s_nop 1
  v_max_f32 v7, v9, v9 row_ror:8 row_mask:0xf bank_mask:0xf
  s_nop 1
  v_max_f32 v7, v7, v7 row_ror:4 row_mask:0xf bank_mask:0xf
  s_nop 1
  v_max_f32 v7, v7, v7 row_ror:2 row_mask:0xf bank_mask:0xf
  s_nop 1
  v_max_f32 v7, v7, v7 row_ror:1 row_mask:0xf bank_mask:0xf
  s_nop 1
  v_max_f32 v7, v7, v7 row_bcast:15 row_mask:0xa bank_mask:0xf
  s_nop 1
  v_max_f32 v7, v7, v7 row_bcast:31 row_mask:0xc bank_mask:0xf
  s_nop 0
  v_readlane_b32 s21, v7, 63
  s_nop 1
  v_cmp_eq_u32 vcc, s21, v9
  s_ff1_i32_b64 s22, vcc
  s_lshl_b32 s22, s22, 2
  s_and_b32 s23, s21, 3
  s_add_u32 s22, s22, s23
  s_and_b32 s23, s21, 12
  s_lshl_b32 s23, s23, 6
  s_add_u32 s22, s22, s23
  s_and_b32 s22, s22, 1023
  s_lshl_b32 s23, s20, 10
  s_add_u32 s22, s22, s23
  s_add_u32 s22, s22, 1
  v_mov_b32 v224, s21
  v_mov_b32 v225, s22
  s_mov_b64 exec, 1
  ds_write_b64 v13, v[224:225]
  s_mov_b32 s38, 0
.fz_kernel_c_am:
  ds_read_b128 v[224:227], v10
  s_add_u32 s38, s38, 1
  s_waitcnt lgkmcnt(0)
  v_min_u32 v9, v225, v227
  v_cmp_eq_u32 vcc, 0, v9
  s_cbranch_vccz .fz_kernel_c_amd
  s_cmp_lt_u32 s38, 524288
  s_cbranch_scc1 .fz_kernel_c_am
.fz_kernel_c_amd:
  v_cmp_gt_f32 vcc, v226, v224
  s_nop 1
  v_cndmask_b32 v225, v225, v227, vcc
  v_cndmask_b32 v224, v224, v226, vcc
  v_readfirstlane_b32 s77, v225
  v_readfirstlane_b32 s27, v224
  s_mov_b64 exec, -1
  s_sub_u32 s21, s77, 1
  s_and_b32 s21, s21, 2047
  s_lshl_b32 s21, s21, 2
  s_add_u32 s21, s21, s72
  s_add_u32 s21, s21, 16384
  s_add_u32 s22, s21, 8192
  buffer_load_dword v11, v4, s[4:7], s21 offen
  buffer_load_dword v15, v4, s[4:7], s22 offen
  s_mov_b64 exec, s[34:35]
  s_sub_u32 s77, s77, 1
  s_and_b32 s77, s77, 2047
  s_lshr_b32 s78, s77, 7
  s_lshl_b32 s78, s78, 18
  s_and_b32 s21, s77, 0x70
  s_lshl_b32 s21, s21, 7
  s_add_u32 s78, s78, s21
  s_and_b32 s21, s77, 15
  s_lshl_b32 s21, s21, 4
  s_add_u32 s78, s78, s21
  s_add_u32 s78, s78, s73
  buffer_load_dwordx4 v[208:211], v14, s[4:7], s78 offen offset:0
  buffer_load_dwordx4 v[212:215], v14, s[4:7], s78 offen offset:256
  buffer_load_dwordx4 v[216:219], v14, s[4:7], s78 offen offset:512
  buffer_load_dwordx4 v[220:223], v14, s[4:7], s78 offen offset:768
  s_mov_b64 exec, -1
.fz_kernel_c_idx:
  s_lshr_b32 s21, s77, 7
  s_and_b32 s79, s77, 127
  s_add_u32 s79, s79, 1
  s_cmp_eq_u32 s21, s17
  s_cselect_b32 s79, s79, 0
  v_mov_b32 v1, -1477.3197218702985
  v_mul_f32 v1, s27, v1
  v_exp_f32 v1, v1
  s_nop 0
  v_add_f32 v1, 1.0, v1
  v_rcp_f32 v1, v1
  s_lshl_b32 s23, s70, 14
  s_add_u32 s23, s23, s78
  s_mov_b32 s46, 0
  s_call_b64 s[0:1], .fz_kernel_hw
  s_waitcnt vmcnt(0)
  s_cmp_ge_u32 s17, 14
  s_cbranch_scc1 .fz_kernel_c_ng
  s_setprio 2
  v_mfma_f32_16x16x32_bf16 v[224:227], v[208:211], v[80:83], 0
  v_mfma_f32_16x16x32_bf16 v[228:231], v[208:211], v[84:87], 0
  v_mfma_f32_16x16x32_bf16 v[232:235], v[208:211], v[88:91], 0
  v_mfma_f32_16x16x32_bf16 v[236:239], v[208:211], v[92:95], 0
  v_mfma_f32_16x16x32_bf16 v[240:243], v[208:211], v[96:99], 0
  v_mfma_f32_16x16x32_bf16 v[244:247], v[208:211], v[100:103], 0
  v_mfma_f32_16x16x32_bf16 v[248:251], v[208:211], v[104:107], 0
  v_mfma_f32_16x16x32_bf16 v[252:255], v[208:211], v[108:111], 0
  v_mfma_f32_16x16x32_bf16 v[224:227], v[212:215], v[112:115], v[224:227]
  v_mfma_f32_16x16x32_bf16 v[228:231], v[212:215], v[116:119], v[228:231]
  v_mfma_f32_16x16x32_bf16 v[232:235], v[212:215], v[120:123], v[232:235]
  v_mfma_f32_16x16x32_bf16 v[236:239], v[212:215], v[124:127], v[236:239]
  v_mfma_f32_16x16x32_bf16 v[240:243], v[212:215], v[128:131], v[240:243]
  v_mfma_f32_16x16x32_bf16 v[244:247], v[212:215], v[132:135], v[244:247]
  v_mfma_f32_16x16x32_bf16 v[248:251], v[212:215], v[136:139], v[248:251]
  v_mfma_f32_16x16x32_bf16 v[252:255], v[212:215], v[140:143], v[252:255]
  v_mfma_f32_16x16x32_bf16 v[224:227], v[216:219], v[144:147], v[224:227]
  v_mfma_f32_16x16x32_bf16 v[228:231], v[216:219], v[148:151], v[228:231]
  v_mfma_f32_16x16x32_bf16 v[232:235], v[216:219], v[152:155], v[232:235]
  v_mfma_f32_16x16x32_bf16 v[236:239], v[216:219], v[156:159], v[236:239]
  v_mfma_f32_16x16x32_bf16 v[240:243], v[216:219], v[160:163], v[240:243]
  v_mfma_f32_16x16x32_bf16 v[244:247], v[216:219], v[164:167], v[244:247]
  v_mfma_f32_16x16x32_bf16 v[248:251], v[216:219], v[168:171], v[248:251]
  v_mfma_f32_16x16x32_bf16 v[252:255], v[216:219], v[172:175], v[252:255]
  v_mfma_f32_16x16x32_bf16 v[224:227], v[220:223], v[176:179], v[224:227]
  v_mfma_f32_16x16x32_bf16 v[228:231], v[220:223], v[180:183], v[228:231]
  v_mfma_f32_16x16x32_bf16 v[232:235], v[220:223], v[184:187], v[232:235]
  v_mfma_f32_16x16x32_bf16 v[236:239], v[220:223], v[188:191], v[236:239]
  v_mfma_f32_16x16x32_bf16 v[240:243], v[220:223], v[192:195], v[240:243]
  v_mfma_f32_16x16x32_bf16 v[244:247], v[220:223], v[196:199], v[244:247]
  v_mfma_f32_16x16x32_bf16 v[248:251], v[220:223], v[200:203], v[248:251]
  v_mfma_f32_16x16x32_bf16 v[252:255], v[220:223], v[204:207], v[252:255]
  s_nop 0
  v_add_f32 v208, v225, v224 row_ror:8 row_mask:0xf bank_mask:0x3
  v_add_f32 v209, v229, v228 row_ror:8 row_mask:0xf bank_mask:0x3
  v_add_f32 v210, v233, v232 row_ror:8 row_mask:0xf bank_mask:0x3
  v_add_f32 v211, v237, v236 row_ror:8 row_mask:0xf bank_mask:0x3
  v_add_f32 v208, v240, v241 row_ror:8 row_mask:0xf bank_mask:0xc
  v_add_f32 v209, v244, v245 row_ror:8 row_mask:0xf bank_mask:0xc
  v_add_f32 v210, v248, v249 row_ror:8 row_mask:0xf bank_mask:0xc
  v_add_f32 v211, v252, v253 row_ror:8 row_mask:0xf bank_mask:0xc
  v_fma_f32 v208, -v11, v28, v208
  v_fma_f32 v209, -v11, v29, v209
  v_or_b32 v208, 1, v208
  v_fma_f32 v210, -v11, v30, v210
  v_fma_f32 v211, -v11, v31, v211
  v_or_b32 v210, 1, v210
  s_mov_b64 exec, 0xffff
  buffer_store_dwordx4 v[208:211], v20, s[4:7], s32 offen offset:0 sc1
  s_mov_b64 exec, -1
  s_setprio 0
  s_cmp_eq_u32 s3, 0
  s_cbranch_scc1 .fz_kernel_hb72
  s_barrier
  s_sub_u32 s3, s3, 1
.fz_kernel_hb72:
.fz_kernel_c_ng:
  s_cmp_eq_u32 s20, 0
  s_cbranch_scc1 .fz_kernel_c_ng1
  buffer_load_ushort v184, v12, s[4:7], s23 offen
  s_branch .fz_kernel_c_ng2
.fz_kernel_c_ng1:
  s_cmp_eq_u32 s75, 0
  s_cbranch_scc1 .fz_kernel_c_ng2
  buffer_load_dwordx2 v[240:241], v16, s[4:7], s14 offen
  buffer_load_dwordx2 v[242:243], v16, s[4:7], s15 offen
.fz_kernel_c_ng2:
  s_cmp_ge_u32 s17, 14
  s_cbranch_scc1 .fz_kernel_c_g1
  ds_read_b64_tr_b16 v[80:81], v17 offset:0
  ds_read_b64_tr_b16 v[82:83], v17 offset:1024
  ds_read_b64_tr_b16 v[84:85], v17 offset:32
  ds_read_b64_tr_b16 v[86:87], v17 offset:1056
  ds_read_b64_tr_b16 v[88:89], v18 offset:0
  ds_read_b64_tr_b16 v[90:91], v18 offset:1024
  ds_read_b64_tr_b16 v[92:93], v18 offset:32
  ds_read_b64_tr_b16 v[94:95], v18 offset:1056
  ds_read_b64_tr_b16 v[96:97], v17 offset:2048
  ds_read_b64_tr_b16 v[98:99], v17 offset:3072
  ds_read_b64_tr_b16 v[100:101], v17 offset:2080
  ds_read_b64_tr_b16 v[102:103], v17 offset:3104
  ds_read_b64_tr_b16 v[104:105], v18 offset:2048
  s_cmp_eq_u32 s3, 0
  s_cbranch_scc1 .fz_kernel_hb80
  s_barrier
  s_sub_u32 s3, s3, 1
.fz_kernel_hb80:
  ds_read_b64_tr_b16 v[106:107], v18 offset:3072
  ds_read_b64_tr_b16 v[108:109], v18 offset:2080
  ds_read_b64_tr_b16 v[110:111], v18 offset:3104
  s_waitcnt lgkmcnt(4)
  ds_read_b64_tr_b16 v[112:113], v17 offset:4096
  ds_read_b64_tr_b16 v[114:115], v17 offset:5120
  ds_read_b64_tr_b16 v[116:117], v17 offset:4128
  ds_read_b64_tr_b16 v[118:119], v17 offset:5152
  ds_read_b64_tr_b16 v[120:121], v18 offset:4096
  ds_read_b64_tr_b16 v[122:123], v18 offset:5120
  ds_read_b64_tr_b16 v[124:125], v18 offset:4128
  ds_read_b64_tr_b16 v[126:127], v18 offset:5152
  ds_read_b64_tr_b16 v[128:129], v17 offset:6144
  ds_read_b64_tr_b16 v[130:131], v17 offset:7168
  ds_read_b64_tr_b16 v[132:133], v17 offset:6176
  ds_read_b64_tr_b16 v[134:135], v17 offset:7200
  ds_read_b64_tr_b16 v[136:137], v18 offset:6144
  ds_read_b64_tr_b16 v[138:139], v18 offset:7168
  s_cmp_eq_u32 s3, 0
  s_cbranch_scc1 .fz_kernel_hb81
  s_barrier
  s_sub_u32 s3, s3, 1
.fz_kernel_hb81:
  ds_read_b64_tr_b16 v[140:141], v18 offset:6176
  ds_read_b64_tr_b16 v[142:143], v18 offset:7200
.fz_kernel_c_g1:
  v_fma_f32 v15, -v11, v11, v15
  v_rsq_f32 v15, abs(v15)
  s_nop 0
  v_mul_f32 v179, v11, v15
  v_mul_f32 v15, 0x44800000, v15
  v_sub_f32 v179, 0, v179
  v_add_f32 v178, 1.0, v15
  v_mul_f32 v177, -1.4426950408889634, v15
  v_mul_f32 v15, v15, v15
  v_mul_f32 v1, v1, v15
  s_cmp_eq_u32 s75, 0
  s_cbranch_scc1 .fz_kernel_c_d0
  s_cmp_lg_u32 s20, 0
  s_cbranch_scc1 .fz_kernel_c_t2
  s_waitcnt vmcnt(0)
  s_call_b64 s[68:69], .fz_kernel_c_coef
  v_mov_b32 v9, 159952
  v_mov_b32 v7, s79
  ds_write_b64 v26, v[252:253] offset:6400
  ds_write_b64 v26, v[254:255] offset:6912
  ds_write_b32 v9, v7
  s_waitcnt lgkmcnt(0)
.fz_kernel_c_t2:
  s_barrier
.fz_kernel_c_d0:
  s_cmp_ge_u32 s17, 14
  s_cbranch_scc1 .fz_kernel_c_nd
  s_cmp_eq_u32 s3, 0
  s_cbranch_scc1 .fz_kernel_hb74
  s_barrier
  s_sub_u32 s3, s3, 1
.fz_kernel_hb74:
  buffer_load_dwordx4 v[144:147], v21, s[4:7], s33 offen offset:0 sc1
  buffer_load_dwordx4 v[148:151], v21, s[4:7], s33 offen offset:512 sc1
  buffer_load_dwordx4 v[152:155], v21, s[4:7], s33 offen offset:1024 sc1
  buffer_load_dwordx4 v[156:159], v21, s[4:7], s33 offen offset:1536 sc1
  s_mov_b32 s38, 0
.fz_kernel_c_gu:
  s_mov_b32 s46, 0
  s_call_b64 s[0:1], .fz_kernel_hw
  s_waitcnt vmcnt(0)
  v_min3_u32 v9, v144, v146, v148
  v_min3_u32 v9, v9, v150, v152
  v_min3_u32 v9, v9, v154, v156
  v_min_u32 v9, v9, v158
  v_cmp_eq_u32 vcc, 0, v9
  v_add_f32 v160, v144, v148
  v_add_f32 v161, v145, v149
  v_add_f32 v162, v146, v150
  v_add_f32 v163, v147, v151
  s_cbranch_vccnz .fz_kernel_c_gur
.fz_kernel_c_gud:
  v_add_f32 v152, v152, v156
  v_add_f32 v153, v153, v157
  v_add_f32 v154, v154, v158
  v_add_f32 v155, v155, v159
  v_add_f32 v144, v152, v160
  v_add_f32 v145, v153, v161
  v_add_f32 v146, v154, v162
  v_add_f32 v147, v155, v163
  s_nop 0
  v_permlane32_swap_b32 v144, v146
  v_permlane32_swap_b32 v145, v147
  v_mul_f32 v148, v144, v177
  v_mul_f32 v149, v145, v177
  v_exp_f32 v148, v148
  s_cmp_eq_u32 s3, 0
  s_cbranch_scc1 .fz_kernel_hb82
  s_barrier
  s_sub_u32 s3, s3, 1
.fz_kernel_hb82:
  v_exp_f32 v149, v149
  v_mul_f32 v144, v144, v146
  v_add_f32 v148, 1.0, v148
  v_add_f32 v149, 1.0, v149
  v_rcp_f32 v148, v148
  v_rcp_f32 v149, v149
  v_mul_f32 v145, v145, v147
  v_mul_f32 v144, v144, v148
  v_mul_f32 v145, v145, v149
  v_cvt_pk_bf16_f32 v144, v144, v145
  s_waitcnt lgkmcnt(0)
  s_setprio 2
  v_mov_b32 v160, v144 row_newbcast:0 row_mask:0xf bank_mask:0xf
  v_mov_b32 v161, v144 row_newbcast:1 row_mask:0xf bank_mask:0xf
  v_mov_b32 v162, v144 row_newbcast:2 row_mask:0xf bank_mask:0xf
  v_mov_b32 v163, v144 row_newbcast:3 row_mask:0xf bank_mask:0xf
  v_mov_b32 v164, v144 row_newbcast:4 row_mask:0xf bank_mask:0xf
  v_mov_b32 v165, v144 row_newbcast:5 row_mask:0xf bank_mask:0xf
  v_mov_b32 v166, v144 row_newbcast:6 row_mask:0xf bank_mask:0xf
  v_mov_b32 v167, v144 row_newbcast:7 row_mask:0xf bank_mask:0xf
  v_mfma_f32_16x16x32_bf16 v[208:211], v[160:163], v[80:83], 0
  v_mfma_f32_16x16x32_bf16 v[212:215], v[160:163], v[84:87], 0
  v_mfma_f32_16x16x32_bf16 v[216:219], v[160:163], v[88:91], 0
  v_mfma_f32_16x16x32_bf16 v[220:223], v[160:163], v[92:95], 0
  v_mov_b32 v168, v144 row_newbcast:8 row_mask:0xf bank_mask:0xf
  v_mov_b32 v169, v144 row_newbcast:9 row_mask:0xf bank_mask:0xf
  v_mov_b32 v170, v144 row_newbcast:10 row_mask:0xf bank_mask:0xf
  v_mov_b32 v171, v144 row_newbcast:11 row_mask:0xf bank_mask:0xf
  v_mfma_f32_16x16x32_bf16 v[208:211], v[164:167], v[96:99], v[208:211]
  v_mfma_f32_16x16x32_bf16 v[212:215], v[164:167], v[100:103], v[212:215]
  v_mfma_f32_16x16x32_bf16 v[216:219], v[164:167], v[104:107], v[216:219]
  v_mfma_f32_16x16x32_bf16 v[220:223], v[164:167], v[108:111], v[220:223]
  v_mov_b32 v172, v144 row_newbcast:12 row_mask:0xf bank_mask:0xf
  v_mov_b32 v173, v144 row_newbcast:13 row_mask:0xf bank_mask:0xf
  v_mov_b32 v174, v144 row_newbcast:14 row_mask:0xf bank_mask:0xf
  v_mov_b32 v175, v144 row_newbcast:15 row_mask:0xf bank_mask:0xf
  v_mfma_f32_16x16x32_bf16 v[208:211], v[168:171], v[112:115], v[208:211]
  v_mfma_f32_16x16x32_bf16 v[212:215], v[168:171], v[116:119], v[212:215]
  v_mfma_f32_16x16x32_bf16 v[216:219], v[168:171], v[120:123], v[216:219]
  v_mfma_f32_16x16x32_bf16 v[220:223], v[168:171], v[124:127], v[220:223]
  v_mfma_f32_16x16x32_bf16 v[208:211], v[172:175], v[128:131], v[208:211]
  v_mfma_f32_16x16x32_bf16 v[212:215], v[172:175], v[132:135], v[212:215]
  v_mfma_f32_16x16x32_bf16 v[216:219], v[172:175], v[136:139], v[216:219]
  v_mfma_f32_16x16x32_bf16 v[220:223], v[172:175], v[140:143], v[220:223]
  s_nop 4
  v_or_b32 v208, 1, v208
  v_mov_b32 v209, v212
  v_or_b32 v210, 1, v216
  v_mov_b32 v211, v220
  s_mov_b64 exec, 0xffff
  buffer_store_dwordx4 v[208:211], v3, s[4:7], s39 offen offset:0 sc1
  s_mov_b64 exec, -1
  s_setprio 0
.fz_kernel_c_nd:
  s_cmp_eq_u32 s75, 0
  s_cbranch_scc1 .fz_kernel_c_m0
  s_lshl_b32 s21, s17, 1
  s_add_u32 s21, s21, s20
  s_cmp_lg_u32 s21, 31
  s_cbranch_scc1 .fz_kernel_fin
  s_branch .fz_kernel_c_pp
.fz_kernel_c_m0:
  s_cmp_eq_u32 s79, 0
  s_cselect_b32 s21, 2, 0
  s_add_u32 s3, s3, s21
.fz_kernel_c_pp:
  s_mul_i32 s21, s70, 7168
  s_add_u32 s21, s21, s72
  s_add_u32 s21, s21, 155648
  s_add_u32 s22, s21, 4096
  s_cmp_eq_u32 s3, 0
  s_cbranch_scc1 .fz_kernel_hb75
  s_barrier
  s_sub_u32 s3, s3, 1
.fz_kernel_hb75:
  s_cmp_eq_u32 s3, 0
  s_cbranch_scc1 .fz_kernel_hb76
  s_barrier
  s_sub_u32 s3, s3, 1
.fz_kernel_hb76:
  s_cmp_eq_u32 s3, 0
  s_cbranch_scc1 .fz_kernel_hb77
  s_barrier
  s_sub_u32 s3, s3, 1
.fz_kernel_hb77:
  buffer_load_dwordx4 v[144:147], v3, s[4:7], s21 offen offset:0 sc1
  buffer_load_dwordx4 v[148:151], v3, s[4:7], s21 offen offset:1024 sc1
  buffer_load_dwordx4 v[152:155], v3, s[4:7], s21 offen offset:2048 sc1
  buffer_load_dwordx4 v[156:159], v3, s[4:7], s21 offen offset:3072 sc1
  buffer_load_dwordx4 v[160:163], v3, s[4:7], s22 offen offset:0 sc1
  buffer_load_dwordx4 v[164:167], v3, s[4:7], s22 offen offset:1024 sc1
  buffer_load_dwordx4 v[168:171], v3, s[4:7], s22 offen offset:2048 sc1
  s_mov_b32 s38, 0
.fz_kernel_c_pu:
  s_mov_b32 s46, 0
  s_call_b64 s[0:1], .fz_kernel_hw
  s_waitcnt vmcnt(0)
  v_min3_u32 v9, v144, v146, v148
  v_min3_u32 v9, v9, v150, v152
  v_min3_u32 v9, v9, v154, v156
  v_min3_u32 v9, v9, v158, v160
  v_min3_u32 v9, v9, v162, v164
  v_min3_u32 v9, v9, v166, v168
  v_min_u32 v9, v9, v170
  v_cmp_eq_u32 vcc, 0, v9
  v_add_f32 v236, v144, v148
  v_add_f32 v237, v145, v149
  v_add_f32 v238, v146, v150
  v_add_f32 v239, v147, v151
  s_cbranch_vccnz .fz_kernel_c_pur
.fz_kernel_c_pud:
  v_add_f32 v152, v152, v156
  v_add_f32 v153, v153, v157
  v_add_f32 v154, v154, v158
  v_add_f32 v155, v155, v159
  v_add_f32 v160, v160, v164
  v_add_f32 v161, v161, v165
  v_add_f32 v162, v162, v166
  s_cmp_eq_u32 s3, 0
  s_cbranch_scc1 .fz_kernel_hb83
  s_barrier
  s_sub_u32 s3, s3, 1
.fz_kernel_hb83:
  v_add_f32 v163, v163, v167
  v_add_f32 v236, v236, v168
  v_add_f32 v237, v237, v169
  v_add_f32 v238, v238, v170
  v_add_f32 v239, v239, v171
  v_add_f32 v152, v152, v160
  v_add_f32 v153, v153, v161
  v_add_f32 v154, v154, v162
  v_add_f32 v155, v155, v163
  v_add_f32 v144, v236, v152
  v_add_f32 v146, v238, v154
  v_add_f32 v145, v237, v153
  v_add_f32 v147, v239, v155
  v_permlane32_swap_b32 v144, v146
  s_nop 0
  v_permlane32_swap_b32 v145, v147
  v_add_f32 v144, v144, v146
  v_add_f32 v145, v145, v147
  v_lshlrev_b32 v184, 16, v184
  s_nop 0
  v_permlane16_swap_b32 v144, v145
  v_add_f32 v144, v144, v145
  v_mul_f32 v144, v144, v1
  v_fma_f32 v184, v184, v178, v179
  s_nop 0
  v_mov_b32 v145, v144 quad_perm:[1,0,3,2] row_mask:0xf bank_mask:0xf
  v_cvt_pk_bf16_f32 v144, v144, v145
  s_or_b32 s21, s75, s71
  s_cbranch_scc1 .fz_kernel_c_w7
  s_mul_i32 s21, s20, 384
  s_add_u32 s21, s21, s60
  v_mov_b32 v180, v144 row_newbcast:0 row_mask:0xf bank_mask:0xf
  v_mov_b32 v181, v144 row_newbcast:2 row_mask:0xf bank_mask:0xf
  v_mov_b32 v182, v144 row_newbcast:4 row_mask:0xf bank_mask:0xf
  v_mov_b32 v183, v144 row_newbcast:6 row_mask:0xf bank_mask:0xf
  s_cmp_eq_u32 s3, 0
  s_cbranch_scc1 .fz_kernel_hb79
  s_barrier
  s_sub_u32 s3, s3, 1
.fz_kernel_hb79:
  s_setprio 2
  v_mfma_f32_16x16x32_bf16 v[208:211], v[180:183], v[32:35], 0
  v_mov_b32 v232, v144 row_newbcast:8 row_mask:0xf bank_mask:0xf
  v_mfma_f32_16x16x32_bf16 v[212:215], v[180:183], v[36:39], 0
  v_mov_b32 v233, v144 row_newbcast:10 row_mask:0xf bank_mask:0xf
  v_mfma_f32_16x16x32_bf16 v[216:219], v[180:183], v[40:43], 0
  v_mov_b32 v234, v144 row_newbcast:12 row_mask:0xf bank_mask:0xf
  v_mfma_f32_16x16x32_bf16 v[220:223], v[180:183], v[44:47], 0
  v_mov_b32 v235, v144 row_newbcast:14 row_mask:0xf bank_mask:0xf
  v_mfma_f32_16x16x32_bf16 v[224:227], v[180:183], v[48:51], 0
  v_mfma_f32_16x16x32_bf16 v[228:231], v[180:183], v[52:55], 0
  v_mfma_f32_16x16x32_bf16 v[208:211], v[232:235], v[56:59], v[208:211]
  v_mfma_f32_16x16x32_bf16 v[212:215], v[232:235], v[60:63], v[212:215]
  v_mfma_f32_16x16x32_bf16 v[216:219], v[232:235], v[64:67], v[216:219]
  v_mfma_f32_16x16x32_bf16 v[220:223], v[232:235], v[68:71], v[220:223]
  v_mfma_f32_16x16x32_bf16 v[224:227], v[232:235], v[72:75], v[224:227]
  v_mfma_f32_16x16x32_bf16 v[228:231], v[232:235], v[76:79], v[228:231]
  s_nop 2
  v_or_b32 v208, 1, v208
  v_mov_b32 v209, v212
  v_or_b32 v210, 1, v216
  v_mov_b32 v211, v220
  s_mov_b64 exec, 0xffff
  buffer_store_dwordx4 v[208:211], v3, s[4:7], s21 offen offset:0 sc1
  v_or_b32 v224, 1, v224
  v_mov_b32 v225, v228
  buffer_store_dwordx2 v[224:225], v16, s[4:7], s21 offen offset:256 sc1
  s_mov_b64 exec, -1
  s_setprio 0
  s_cmp_lg_u32 s20, 0
  s_cbranch_scc1 .fz_kernel_c_w7
  s_cmp_eq_u32 s79, 0
  s_cbranch_scc1 .fz_kernel_c_no2
  v_add_u32 v13, 155648, v3
  s_lshl_b32 s21, s18, 14
  s_add_u32 s21, s21, 0x1c84000
  s_add_u32 s22, s21, 4096
  s_add_u32 s23, s21, 8192
  s_add_u32 s24, s21, 12288
  v_rcp_f32 v144, v178
  v_lshlrev_b32 v146, 1, v2
  v_sub_u32 v146, s79, v146
  v_cmp_eq_u32 s[28:29], 1, v146
  v_cmp_eq_u32 s[30:31], 2, v146
  s_nop 0
  v_cndmask_b32 v148, 0, v144, s[28:29]
  v_cndmask_b32 v149, 0, v144, s[30:31]
  v_mov_b32 v9, 159952
  v_mov_b32 v7, s79
  ds_write_b32 v9, v7
  ds_write_b64 v26, v[148:149] offset:512
  s_lshl_b32 s25, s79, 2
  s_add_u32 s25, s25, 155644
  s_cmp_eq_u32 s3, 0
  s_cbranch_scc1 .fz_kernel_hb84
  s_barrier
  s_sub_u32 s3, s3, 1
.fz_kernel_hb84:
  v_mov_b32 v7, s25
  v_mov_b32 v152, 0
  v_mov_b32 v153, 0
  v_mov_b32 v154, 0
  v_mov_b32 v155, 0
  s_bfm_b64 exec, 49, 0
  s_mov_b32 s38, 0
  s_mov_b32 s25, 15
.fz_kernel_c_pw:
  s_cmp_le_u32 s3, 3
  s_cbranch_scc1 .fz_kernel_c_pw1
  s_barrier
  s_sub_u32 s3, s3, 1
  s_branch .fz_kernel_c_pw
.fz_kernel_c_pw1:
  s_setprio 2
.fz_kernel_c_pd:
  s_bitcmp1_b32 s25, 0
  s_cbranch_scc0 .fz_kernel_c_pl0
  buffer_load_dwordx4 v[80:83], v3, s[4:7], s21 offen offset:0 sc1
  buffer_load_dwordx4 v[84:87], v3, s[4:7], s21 offen offset:1024 sc1
  buffer_load_dwordx4 v[88:91], v3, s[4:7], s21 offen offset:2048 sc1
  buffer_load_dwordx4 v[92:95], v3, s[4:7], s21 offen offset:3072 sc1
.fz_kernel_c_pl0:
  s_bitcmp1_b32 s25, 1
  s_cbranch_scc0 .fz_kernel_c_pl1
  buffer_load_dwordx4 v[96:99], v3, s[4:7], s22 offen offset:0 sc1
  buffer_load_dwordx4 v[100:103], v3, s[4:7], s22 offen offset:1024 sc1
  buffer_load_dwordx4 v[104:107], v3, s[4:7], s22 offen offset:2048 sc1
  buffer_load_dwordx4 v[108:111], v3, s[4:7], s22 offen offset:3072 sc1
.fz_kernel_c_pl1:
  s_bitcmp1_b32 s25, 2
  s_cbranch_scc0 .fz_kernel_c_pl2
  buffer_load_dwordx4 v[112:115], v3, s[4:7], s23 offen offset:0 sc1
  buffer_load_dwordx4 v[116:119], v3, s[4:7], s23 offen offset:1024 sc1
  buffer_load_dwordx4 v[120:123], v3, s[4:7], s23 offen offset:2048 sc1
  buffer_load_dwordx4 v[124:127], v3, s[4:7], s23 offen offset:3072 sc1
.fz_kernel_c_pl2:
  s_bitcmp1_b32 s25, 3
  s_cbranch_scc0 .fz_kernel_c_pl3
  buffer_load_dwordx4 v[128:131], v3, s[4:7], s24 offen offset:0 sc1
  buffer_load_dwordx4 v[132:135], v3, s[4:7], s24 offen offset:1024 sc1
  buffer_load_dwordx4 v[136:139], v3, s[4:7], s24 offen offset:2048 sc1
  buffer_load_dwordx4 v[140:143], v3, s[4:7], s24 offen offset:3072 sc1
.fz_kernel_c_pl3:
  s_add_u32 s38, s38, 1
  s_mov_b32 s46, 0
  s_call_b64 s[0:1], .fz_kernel_hw
  s_waitcnt vmcnt(0)
  s_bitcmp1_b32 s25, 0
  s_cbranch_scc0 .fz_kernel_c_pa0
  v_min3_u32 v9, v80, v82, v84
  v_min3_u32 v9, v9, v86, v88
  v_min3_u32 v9, v9, v90, v92
  v_min_u32 v9, v9, v94
  v_cmp_eq_u32 vcc, 0, v9
  v_add_f32 v80, v80, v84
  v_add_f32 v81, v81, v85
  v_add_f32 v82, v82, v86
  v_add_f32 v83, v83, v87
  s_cbranch_vccnz .fz_kernel_c_pa0
  v_add_f32 v88, v88, v92
  v_add_f32 v89, v89, v93
  v_add_f32 v90, v90, v94
  v_add_f32 v91, v91, v95
  v_add_f32 v152, v152, v80
  v_add_f32 v153, v153, v81
  v_add_f32 v154, v154, v82
  v_add_f32 v155, v155, v83
  v_add_f32 v152, v152, v88
  v_add_f32 v153, v153, v89
  v_add_f32 v154, v154, v90
  v_add_f32 v155, v155, v91
  s_bitset0_b32 s25, 0
.fz_kernel_c_pa0:
  s_bitcmp1_b32 s25, 1
  s_cbranch_scc0 .fz_kernel_c_pa1
  v_min3_u32 v9, v96, v98, v100
  v_min3_u32 v9, v9, v102, v104
  v_min3_u32 v9, v9, v106, v108
  v_min_u32 v9, v9, v110
  v_cmp_eq_u32 vcc, 0, v9
  v_add_f32 v96, v96, v100
  v_add_f32 v97, v97, v101
  v_add_f32 v98, v98, v102
  v_add_f32 v99, v99, v103
  s_cbranch_vccnz .fz_kernel_c_pa1
  v_add_f32 v104, v104, v108
  v_add_f32 v105, v105, v109
  v_add_f32 v106, v106, v110
  v_add_f32 v107, v107, v111
  v_add_f32 v152, v152, v96
  v_add_f32 v153, v153, v97
  v_add_f32 v154, v154, v98
  v_add_f32 v155, v155, v99
  v_add_f32 v152, v152, v104
  v_add_f32 v153, v153, v105
  v_add_f32 v154, v154, v106
  v_add_f32 v155, v155, v107
  s_bitset0_b32 s25, 1
.fz_kernel_c_pa1:
  s_bitcmp1_b32 s25, 2
  s_cbranch_scc0 .fz_kernel_c_pa2
  v_min3_u32 v9, v112, v114, v116
  v_min3_u32 v9, v9, v118, v120
  v_min3_u32 v9, v9, v122, v124
  v_min_u32 v9, v9, v126
  v_cmp_eq_u32 vcc, 0, v9
  v_add_f32 v112, v112, v116
  v_add_f32 v113, v113, v117
  v_add_f32 v114, v114, v118
  v_add_f32 v115, v115, v119
  s_cbranch_vccnz .fz_kernel_c_pa2
  v_add_f32 v120, v120, v124
  v_add_f32 v121, v121, v125
  v_add_f32 v122, v122, v126
  v_add_f32 v123, v123, v127
  v_add_f32 v152, v152, v112
  v_add_f32 v153, v153, v113
  v_add_f32 v154, v154, v114
  v_add_f32 v155, v155, v115
  v_add_f32 v152, v152, v120
  v_add_f32 v153, v153, v121
  v_add_f32 v154, v154, v122
  v_add_f32 v155, v155, v123
  s_bitset0_b32 s25, 2
.fz_kernel_c_pa2:
  s_bitcmp1_b32 s25, 3
  s_cbranch_scc0 .fz_kernel_c_pa3
  v_min3_u32 v9, v128, v130, v132
  v_min3_u32 v9, v9, v134, v136
  v_min3_u32 v9, v9, v138, v140
  v_min_u32 v9, v9, v142
  v_cmp_eq_u32 vcc, 0, v9
  v_add_f32 v128, v128, v132
  v_add_f32 v129, v129, v133
  v_add_f32 v130, v130, v134
  v_add_f32 v131, v131, v135
  s_cbranch_vccnz .fz_kernel_c_pa3
  v_add_f32 v136, v136, v140
  v_add_f32 v137, v137, v141
  v_add_f32 v138, v138, v142
  v_add_f32 v139, v139, v143
  v_add_f32 v152, v152, v128
  v_add_f32 v153, v153, v129
  v_add_f32 v154, v154, v130
  v_add_f32 v155, v155, v131
  v_add_f32 v152, v152, v136
  v_add_f32 v153, v153, v137
  v_add_f32 v154, v154, v138
  v_add_f32 v155, v155, v139
  s_bitset0_b32 s25, 3
.fz_kernel_c_pa3:
  s_cmp_eq_u32 s25, 0
  s_cbranch_scc1 .fz_kernel_c_pdd
  s_cmp_lt_u32 s38, 131072
  s_cbranch_scc1 .fz_kernel_c_pd
.fz_kernel_c_pdd:
  s_mov_b32 exec_hi, 0xffff
  ds_write_b128 v13, v[152:155] offset:1536
  s_mov_b64 exec, -1
  v_readlane_b32 s21, v152, 48
  v_readlane_b32 s22, v154, 48
  s_nop 0
  v_mul_f32 v144, s21, v23
  v_fma_f32 v145, s22, v23, v25
  v_fma_f32 v145, -v144, v144, v145
  v_rsq_f32 v145, abs(v145)
  v_sub_f32 v144, v179, v144
  v_mul_f32 v146, v145, v178
  v_mul_f32 v147, v145, v144
  ds_write_b32 v7, v146 offset:4608
  ds_write_b32 v7, v147 offset:5120
  s_waitcnt lgkmcnt(0)
  s_add_u32 s3, s3, 2
  s_setprio 0
.fz_kernel_c_no2:
  s_branch .fz_kernel_q_he
.fz_kernel_c_w7:
  s_setprio 2
  v_lshlrev_b32 v144, 16, v144
  s_cmp_lg_u32 s71, 0
  s_cbranch_scc1 .fz_kernel_c_eu
  v_add_f32 v184, v184, v144
  s_cmp_lg_u32 s75, 0
  s_cbranch_scc1 .fz_kernel_c_t3
  v_mul_f32 v146, v184, v184
  v_lshrrev_b32 v9, 5, v2
  v_lshlrev_b32 v9, 3, v9
  v_permlane32_swap_b32 v184, v146
  v_add_f32 v184, v184, v146
  s_nop 1
  v_add_f32 v184, v184, v184 row_ror:8 row_mask:0xf bank_mask:0xf
  s_nop 1
  v_add_f32 v184, v184, v184 row_ror:4 row_mask:0xf bank_mask:0xf
  s_nop 1
  v_add_f32 v184, v184, v184 row_ror:2 row_mask:0xf bank_mask:0xf
  s_nop 1
  v_add_f32 v184, v184, v184 row_ror:1 row_mask:0xf bank_mask:0xf
  s_nop 1
  v_add_f32 v184, v184, v184 row_bcast:15 row_mask:0xa bank_mask:0xf
  v_or_b32 v184, 1, v184
  s_mov_b32 exec_lo, 0x10000
  s_mov_b32 exec_hi, 0x10000
  buffer_store_dword v184, v9, s[4:7], s60 offen offset:768 sc1
  s_mov_b64 exec, -1
  s_setprio 0
  s_cmp_eq_u32 s79, 0
  s_cbranch_scc1 .fz_kernel_q_he
  s_add_u32 s3, s3, 2
  s_mov_b32 s71, 1
  s_mov_b32 s70, s18
.fz_kernel_c_e0:
  s_cmp_eq_u32 s3, 0
  s_cbranch_scc1 .fz_kernel_c_pp
  s_barrier
  s_sub_u32 s3, s3, 1
  s_branch .fz_kernel_c_e0
.fz_kernel_c_eu:
  v_lshlrev_b32 v9, 2, v2
  v_add_u32 v9, 155648, v9
  ds_write_b32 v9, v144 offset:7424
  s_waitcnt lgkmcnt(0)
  s_branch .fz_kernel_q_he
.fz_kernel_c_t3:
  s_mov_b32 s28, s56
  s_mov_b32 s29, s57
  s_mov_b32 s30, 0x400000
  s_mov_b32 s31, 0x00020000
  v_cvt_pk_bf16_f32 v144, v184, v184
  v_lshlrev_b32 v9, 1, v2
  s_lshl_b32 s21, s77, 11
  s_lshl_b32 s22, s18, 7
  s_add_u32 s21, s21, s22
  buffer_store_short v144, v9, s[28:31], s21 offen
.fz_kernel_fin:
.fz_kernel_end:
  s_endpgm
.fz_kernel_pick:
  s_mov_b32 s33, 1
  s_cmp_eq_u32 s34, 0xffff
  s_cselect_b32 s35, 0x40000000, s35
  s_cbranch_scc1 .fz_kernel_pick_ret
  s_mov_b32 s38, 0
.fz_kernel_pick_l:
  ds_read_b32 v7, v6
  s_add_u32 s38, s38, 1
  s_waitcnt lgkmcnt(0)
  v_readfirstlane_b32 s36, v7
  s_andn2_b32 s33, s36, s34
  s_cbranch_scc1 .fz_kernel_pick_ret
  s_cmp_lt_u32 s38, 1048576
  s_cbranch_scc1 .fz_kernel_pick_l
  s_mov_b32 s36, 0xffff
  s_andn2_b32 s33, s36, s34
.fz_kernel_pick_ret:
  s_nop 4
  s_setpc_b64 s[68:69]
.fz_kernel_hw:
  s_mov_b32 s47, 0
.fz_kernel_hwl:
  s_getreg_b32 s100, hwreg(HW_REG_IB_STS)
  s_bfe_u32 s101, s100, 0x20016
  s_and_b32 s100, s100, 15
  s_lshl4_add_u32 s100, s101, s100
  s_cmp_le_u32 s100, s46
  s_cbranch_scc1 .fz_kernel_hwr
  s_sub_u32 s47, s47, 1
  s_cbranch_scc0 .fz_kernel_hwl
  s_cmp_eq_u32 s3, 0
  s_cbranch_scc1 .fz_kernel_hwr
  s_cmp_eq_u32 s3, 32
  s_cbranch_scc1 .fz_kernel_hwp
.fz_kernel_hwb:
  s_barrier
  s_sub_u32 s3, s3, 1
  s_mov_b32 s47, 2
  s_branch .fz_kernel_hwl
.fz_kernel_hwr:
  s_setpc_b64 s[0:1]
  .fz_kernel_hwp:
  ds_read_b32 v27, v6 offset:0x110
  s_mov_b32 s47, 0
  s_waitcnt lgkmcnt(0)
  v_readfirstlane_b32 s100, v27
  s_cmp_ge_u32 s100, 0x200
  s_cbranch_scc1 .fz_kernel_hwb
  s_branch .fz_kernel_hwl
.fz_kernel_q_cons2:
  s_setprio 0
  s_lshr_b32 s26, s16, 1
  s_lshl_b32 s28, s26, 13
  v_add_u32 v8, s28, v3
  v_add_u32 v9, 1024, v8
  v_mov_b32 v232, v20
  v_mov_b32 v233, v21
  v_mov_b32 v234, v22
  v_mov_b32 v235, v23
  v_mov_b32 v236, v24
  v_mov_b32 v237, v25
  v_mov_b32 v238, v26
  v_mov_b32 v239, v27
  v_mov_b32 v240, v28
  v_mov_b32 v241, v29
  v_mov_b32 v242, v30
  v_mov_b32 v243, v31
  v_mov_b32 v244, v32
  v_mov_b32 v245, v33
  v_mov_b32 v246, v34
  v_mov_b32 v247, v35
  s_branch .fz_kernel_q_cs
.fz_kernel_q_patch:
  s_mul_i32 s31, s27, 384
  s_add_u32 s31, s31, 155648
  v_and_b32 v73, 48, v2
  v_lshlrev_b32 v73, 2, v73
  v_add_u32 v73, s31, v73
  v_and_b32 v75, 15, v2
  v_lshlrev_b32 v75, 3, v75
  v_add_u32 v75, s31, v75
  ds_read_b32 v72, v22 offset:512
  ds_read_b32 v74, v22 offset:576
  ds_read_b32 v76, v22 offset:640
  ds_read_b32 v78, v22 offset:704
  ds_read_b128 v[80:83], v73 offset:1536
  ds_read_b128 v[84:87], v73 offset:1552
  ds_read_b128 v[88:91], v73 offset:1568
  ds_read_b128 v[92:95], v73 offset:1584
  s_waitcnt lgkmcnt(0)
  v_fmac_f32 v160, v82, v72
  v_fmac_f32 v161, v86, v72
  v_fmac_f32 v162, v90, v72
  v_fmac_f32 v163, v94, v72
  v_fmac_f32 v164, v82, v74
  v_fmac_f32 v165, v86, v74
  v_fmac_f32 v166, v90, v74
  v_fmac_f32 v167, v94, v74
  v_fmac_f32 v168, v82, v76
  v_fmac_f32 v169, v86, v76
  v_fmac_f32 v170, v90, v76
  v_fmac_f32 v171, v94, v76
  v_fmac_f32 v172, v82, v78
  v_fmac_f32 v173, v86, v78
  v_fmac_f32 v174, v90, v78
  v_fmac_f32 v175, v94, v78
  v_fmac_f32 v176, v83, v72
  v_fmac_f32 v177, v87, v72
  v_fmac_f32 v178, v91, v72
  v_fmac_f32 v179, v95, v72
  v_fmac_f32 v180, v83, v74
  v_fmac_f32 v181, v87, v74
  v_fmac_f32 v182, v91, v74
  v_fmac_f32 v183, v95, v74
  v_fmac_f32 v184, v83, v76
  v_fmac_f32 v185, v87, v76
  v_fmac_f32 v186, v91, v76
  v_fmac_f32 v187, v95, v76
  v_fmac_f32 v188, v83, v78
  v_fmac_f32 v189, v87, v78
  v_fmac_f32 v190, v91, v78
  v_fmac_f32 v191, v95, v78
  v_fmac_f32 v128, v80, v72
  v_fmac_f32 v129, v84, v72
  v_fmac_f32 v130, v88, v72
  v_fmac_f32 v131, v92, v72
  v_fmac_f32 v132, v80, v74
  v_fmac_f32 v133, v84, v74
  v_fmac_f32 v134, v88, v74
  v_fmac_f32 v135, v92, v74
  v_fmac_f32 v136, v80, v76
  v_fmac_f32 v137, v84, v76
  v_fmac_f32 v138, v88, v76
  v_fmac_f32 v139, v92, v76
  v_fmac_f32 v140, v80, v78
  v_fmac_f32 v141, v84, v78
  v_fmac_f32 v142, v88, v78
  v_fmac_f32 v143, v92, v78
  v_fmac_f32 v144, v81, v72
  v_fmac_f32 v145, v85, v72
  v_fmac_f32 v146, v89, v72
  v_fmac_f32 v147, v93, v72
  v_fmac_f32 v148, v81, v74
  v_fmac_f32 v149, v85, v74
  v_fmac_f32 v150, v89, v74
  v_fmac_f32 v151, v93, v74
  v_fmac_f32 v152, v81, v76
  v_fmac_f32 v153, v85, v76
  v_fmac_f32 v154, v89, v76
  v_fmac_f32 v155, v93, v76
  v_fmac_f32 v156, v81, v78
  v_fmac_f32 v157, v85, v78
  v_fmac_f32 v158, v89, v78
  v_fmac_f32 v159, v93, v78
  ds_read_b128 v[80:83], v23 offset:512
  ds_read_b128 v[84:87], v23 offset:576
  ds_read_b128 v[88:91], v23 offset:640
  ds_read_b128 v[92:95], v23 offset:704
  ds_read_b64 v[72:73], v75 offset:1792
  s_waitcnt lgkmcnt(0)
  v_fmac_f32 v192, v80, v72
  v_fmac_f32 v193, v81, v72
  v_fmac_f32 v194, v82, v72
  v_fmac_f32 v195, v83, v72
  v_fmac_f32 v196, v84, v72
  v_fmac_f32 v197, v85, v72
  v_fmac_f32 v198, v86, v72
  v_fmac_f32 v199, v87, v72
  v_fmac_f32 v200, v88, v72
  v_fmac_f32 v201, v89, v72
  v_fmac_f32 v202, v90, v72
  v_fmac_f32 v203, v91, v72
  v_fmac_f32 v204, v92, v72
  v_fmac_f32 v205, v93, v72
  v_fmac_f32 v206, v94, v72
  v_fmac_f32 v207, v95, v72
  v_fmac_f32 v208, v80, v73
  v_fmac_f32 v209, v81, v73
  v_fmac_f32 v210, v82, v73
  v_fmac_f32 v211, v83, v73
  v_fmac_f32 v212, v84, v73
  v_fmac_f32 v213, v85, v73
  v_fmac_f32 v214, v86, v73
  v_fmac_f32 v215, v87, v73
  v_fmac_f32 v216, v88, v73
  v_fmac_f32 v217, v89, v73
  v_fmac_f32 v218, v90, v73
  v_fmac_f32 v219, v91, v73
  v_fmac_f32 v220, v92, v73
  v_fmac_f32 v221, v93, v73
  v_fmac_f32 v222, v94, v73
  v_fmac_f32 v223, v95, v73
  s_branch .fz_kernel_q_pback
.fz_kernel_q_prod2:
  s_setprio 0
  s_mov_b64 s[8:9], s[4:5]
  s_mov_b64 s[10:11], s[6:7]
  s_mov_b64 s[12:13], s[42:43]
  s_lshl_b32 s35, s17, 6
  s_and_b32 s31, s16, 1
  s_add_u32 s35, s35, s31
  s_lshl_b32 s35, s35, 12
  s_add_u32 s35, s35, s73
  s_lshr_b32 s33, s17, 3
  s_add_u32 s29, s18, s33
  s_lshl1_add_u32 s29, s17, s29
  s_and_b32 s29, s29, 15
  s_mov_b32 s22, 16384
  s_mov_b32 s23, 8192
  s_mov_b32 s36, 0
  s_add_u32 s37, s19, s74
  s_add_u32 s37, s37, 8
  v_mov_b32 v40, v3
  v_mov_b32 v41, v3
  v_mov_b32 v42, v3
  v_mov_b32 v43, v3
  s_branch .fz_kernel_q_pc
.fz_kernel_xok1w:
  s_call_b64 s[68:69], .fz_kernel_q_xw
  s_branch .fz_kernel_xok1
.fz_kernel_xok2w:
  s_call_b64 s[68:69], .fz_kernel_q_xw
  s_branch .fz_kernel_xok2
.fz_kernel_q_xw:
  s_mov_b64 exec, 1
  s_mov_b32 s38, 0
.fz_kernel_q_xwl:
  ds_read_b32 v11, v6 offset:0x114
  s_add_u32 s38, s38, 1
  s_waitcnt lgkmcnt(0)
  v_readfirstlane_b32 s36, v11
  s_bitcmp1_b32 s36, s24
  s_cbranch_scc1 .fz_kernel_q_xwd
  s_cmp_lt_u32 s38, 1048576
  s_cbranch_scc1 .fz_kernel_q_xwl
  s_mov_b32 s36, -1
.fz_kernel_q_xwd:
  s_mov_b64 exec, -1
  s_nop 4
  s_setpc_b64 s[68:69]
.fz_kernel_xok3w:
  s_call_b64 s[68:69], .fz_kernel_q_xw
  s_branch .fz_kernel_xok3
.fz_kernel_lz26a:
  v_lshlrev_b32 v16, 3, v2
  buffer_atomic_and_x2 v[12:13], v16, s[4:7], s36 offen offset:0 sc1
  buffer_atomic_and_x2 v[12:13], v16, s[4:7], s36 offen offset:512 sc1
  buffer_atomic_and_x2 v[12:13], v16, s[4:7], s36 offen offset:1024 sc1
  buffer_atomic_and_x2 v[12:13], v16, s[4:7], s36 offen offset:1536 sc1
  buffer_atomic_and_x2 v[12:13], v16, s[4:7], s36 offen offset:2048 sc1
  buffer_atomic_and_x2 v[12:13], v16, s[4:7], s36 offen offset:2560 sc1
  buffer_atomic_and_x2 v[12:13], v16, s[4:7], s36 offen offset:3072 sc1
  buffer_atomic_and_x2 v[12:13], v16, s[4:7], s36 offen offset:3584 sc1
  s_branch .fz_kernel_lz26
.fz_kernel_a_pick:
  s_cmp_eq_u32 s34, 0xffff
  s_cbranch_scc1 .fz_kernel_a_picke
  s_mov_b32 s38, 0
.fz_kernel_a_pickl:
  ds_read_b32 v7, v6
  s_add_u32 s38, s38, 1
  s_waitcnt lgkmcnt(0)
  v_readfirstlane_b32 s33, v7
  s_cmp_lt_u32 s38, 1048576
  s_cselect_b32 s33, s33, 0xffff
  s_andn2_b32 s36, s33, s34
  s_cbranch_scc0 .fz_kernel_a_pickl
  s_or_b32 s34, s34, s33
  s_ff1_i32_b32 s33, s36
  s_bitset0_b32 s36, s33
  s_lshl_b32 s33, s33, 14
  s_add_u32 s30, s33, s35
  s_setpc_b64 s[68:69]
.fz_kernel_a_picke:
  s_mov_b32 s30, 0x40000000
  ds_write_b32 v6, v5 offset:0x104
  s_setpc_b64 s[68:69]
.fz_kernel_pk33c:
  s_call_b64 s[68:69], .fz_kernel_a_pick
  s_branch .fz_kernel_pk33
.fz_kernel_pk34c:
  s_call_b64 s[68:69], .fz_kernel_a_pick
  s_branch .fz_kernel_pk34
.fz_kernel_pk35c:
  s_call_b64 s[68:69], .fz_kernel_a_pick
  s_branch .fz_kernel_pk35
.fz_kernel_pk38c:
  s_call_b64 s[68:69], .fz_kernel_a_pick
  s_branch .fz_kernel_pk38
.fz_kernel_pk39c:
  s_call_b64 s[68:69], .fz_kernel_a_pick
  s_branch .fz_kernel_pk39
.fz_kernel_a_slow:
  s_cmp_lg_u32 s73, 0
  s_cbranch_scc1 .fz_kernel_a_ok
  s_mov_b32 s73, 1
  s_and_b32 s39, s16, 1
  v_mov_b32 v16, v32
  v_mov_b32 v17, v33
  v_mov_b32 v18, v34
  v_mov_b32 v19, v35
  v_mov_b32 v20, v36
  v_mov_b32 v21, v37
  v_mov_b32 v22, v38
  v_mov_b32 v23, v39
  s_call_b64 s[68:69], .fz_kernel_a_sl
  v_mov_b32 v176, v144
  v_mov_b32 v177, v145
  v_mov_b32 v178, v146
  v_mov_b32 v179, v147
  v_mov_b32 v180, v148
  v_mov_b32 v181, v149
  v_mov_b32 v182, v150
  v_mov_b32 v183, v151
  v_mov_b32 v184, v152
  v_mov_b32 v185, v153
  v_mov_b32 v186, v154
  v_mov_b32 v187, v155
  v_mov_b32 v188, v156
  v_mov_b32 v189, v157
  v_mov_b32 v190, v158
  v_mov_b32 v191, v159
  v_mov_b32 v24, v25
  v_mov_b32 v16, v40
  v_mov_b32 v17, v41
  v_mov_b32 v18, v42
  v_mov_b32 v19, v43
  v_mov_b32 v20, v44
  v_mov_b32 v21, v45
  v_mov_b32 v22, v46
  v_mov_b32 v23, v47
  s_call_b64 s[68:69], .fz_kernel_a_sl
  v_mov_b32 v192, v144
  v_mov_b32 v193, v145
  v_mov_b32 v194, v146
  v_mov_b32 v195, v147
  v_mov_b32 v196, v148
  v_mov_b32 v197, v149
  v_mov_b32 v198, v150
  v_mov_b32 v199, v151
  v_mov_b32 v200, v152
  v_mov_b32 v201, v153
  v_mov_b32 v202, v154
  v_mov_b32 v203, v155
  v_mov_b32 v204, v156
  v_mov_b32 v205, v157
  v_mov_b32 v206, v158
  v_mov_b32 v207, v159
  v_rcp_f32 v26, v24
  v_cmp_le_f32 vcc, s24, v24
  s_and_b64 s[36:37], s[36:37], vcc
  v_cmp_ge_f32 vcc, s25, v24
  s_and_b64 s[36:37], s[36:37], vcc
  v_pk_mul_f32 v[176:177], v[176:177], v[26:27] op_sel_hi:[1,0]
  v_pk_mul_f32 v[178:179], v[178:179], v[26:27] op_sel_hi:[1,0]
  v_pk_mul_f32 v[180:181], v[180:181], v[26:27] op_sel_hi:[1,0]
  v_pk_mul_f32 v[182:183], v[182:183], v[26:27] op_sel_hi:[1,0]
  v_cvt_pk_bf16_f32 v80, v176, v177
  v_cvt_pk_bf16_f32 v81, v178, v179
  v_cvt_pk_bf16_f32 v82, v180, v181
  v_cvt_pk_bf16_f32 v83, v182, v183
  buffer_store_dwordx4 v[80:83], v3, s[4:7], s8 offen offset:0 sc1
  v_pk_mul_f32 v[184:185], v[184:185], v[26:27] op_sel_hi:[1,0]
  v_pk_mul_f32 v[186:187], v[186:187], v[26:27] op_sel_hi:[1,0]
  v_pk_mul_f32 v[188:189], v[188:189], v[26:27] op_sel_hi:[1,0]
  v_pk_mul_f32 v[190:191], v[190:191], v[26:27] op_sel_hi:[1,0]
  v_cvt_pk_bf16_f32 v84, v184, v185
  v_cvt_pk_bf16_f32 v85, v186, v187
  v_cvt_pk_bf16_f32 v86, v188, v189
  v_cvt_pk_bf16_f32 v87, v190, v191
  buffer_store_dwordx4 v[84:87], v3, s[4:7], s8 offen offset:1024 sc1
  s_branch .fz_kernel_a_fin
.fz_kernel_a_sl:
  s_waitcnt vmcnt(0)
  s_lshl_b32 s23, s18, 1
  s_add_u32 s23, s23, s39
  s_lshl_b32 s23, s23, 18
  s_add_u32 s23, s23, s63
  s_mov_b32 s30, s23
  s_mov_b32 s33, 64
  v_mov_b32 v27, 0xff800000
.fz_kernel_a_s1:
  buffer_load_dwordx4 v[80:83], v3, s[4:7], s30 offen offset:0
  buffer_load_dwordx4 v[84:87], v3, s[4:7], s30 offen offset:1024
  s_waitcnt vmcnt(0)
  v_mfma_f32_32x32x16_bf16 v[48:63], v[80:83], v[16:19], 0
  v_mfma_f32_32x32x16_bf16 v[48:63], v[84:87], v[20:23], v[48:63]
  s_nop 11
  v_max3_f32 v27, v27, v48, v49
  v_max3_f32 v27, v27, v50, v51
  v_max3_f32 v27, v27, v52, v53
  v_max3_f32 v27, v27, v54, v55
  v_max3_f32 v27, v27, v56, v57
  v_max3_f32 v27, v27, v58, v59
  v_max3_f32 v27, v27, v60, v61
  v_max3_f32 v27, v27, v62, v63
  s_add_u32 s30, s30, 4096
  s_sub_u32 s33, s33, 1
  s_cmp_lg_u32 s33, 0
  s_cbranch_scc1 .fz_kernel_a_s1
  v_mov_b32 v29, v27
  s_nop 1
  v_permlane32_swap_b32 v29, v27
  v_max_f32 v27, v27, v29
  v_sub_f32 v27, 0, v27
  v_mov_b32 v64, v27
  v_mov_b32 v144, 0
  v_mov_b32 v65, v27
  v_mov_b32 v145, 0
  v_mov_b32 v66, v27
  v_mov_b32 v146, 0
  v_mov_b32 v67, v27
  v_mov_b32 v147, 0
  v_mov_b32 v68, v27
  v_mov_b32 v148, 0
  v_mov_b32 v69, v27
  v_mov_b32 v149, 0
  v_mov_b32 v70, v27
  v_mov_b32 v150, 0
  v_mov_b32 v71, v27
  v_mov_b32 v151, 0
  v_mov_b32 v72, v27
  v_mov_b32 v152, 0
  v_mov_b32 v73, v27
  v_mov_b32 v153, 0
  v_mov_b32 v74, v27
  v_mov_b32 v154, 0
  v_mov_b32 v75, v27
  v_mov_b32 v155, 0
  v_mov_b32 v76, v27
  v_mov_b32 v156, 0
  v_mov_b32 v77, v27
  v_mov_b32 v157, 0
  v_mov_b32 v78, v27
  v_mov_b32 v158, 0
  v_mov_b32 v79, v27
  v_mov_b32 v159, 0
  v_mov_b32 v208, 0
  v_mov_b32 v209, 0
  v_mov_b32 v210, 0
  v_mov_b32 v211, 0
  s_mov_b32 s30, s23
  s_mov_b32 s33, 64
.fz_kernel_a_s2:
  buffer_load_dwordx4 v[80:83], v3, s[4:7], s30 offen offset:0
  buffer_load_dwordx4 v[84:87], v3, s[4:7], s30 offen offset:1024
  buffer_load_dwordx4 v[88:91], v3, s[4:7], s30 offen offset:2048
  buffer_load_dwordx4 v[92:95], v3, s[4:7], s30 offen offset:3072
  s_waitcnt vmcnt(0)
  v_mfma_f32_32x32x16_bf16 v[48:63], v[80:83], v[16:19], v[64:79]
  v_mfma_f32_32x32x16_bf16 v[48:63], v[84:87], v[20:23], v[48:63]
  s_nop 11
  v_exp_f32 v48, v48
  v_exp_f32 v49, v49
  v_exp_f32 v50, v50
  v_exp_f32 v51, v51
  v_exp_f32 v52, v52
  v_exp_f32 v53, v53
  v_exp_f32 v54, v54
  v_exp_f32 v55, v55
  v_exp_f32 v56, v56
  v_exp_f32 v57, v57
  v_exp_f32 v58, v58
  v_exp_f32 v59, v59
  v_exp_f32 v60, v60
  v_exp_f32 v61, v61
  v_exp_f32 v62, v62
  v_exp_f32 v63, v63
  v_cvt_pk_bf16_f32 v224, v48, v49
  v_cvt_pk_bf16_f32 v225, v50, v51
  v_cvt_pk_bf16_f32 v226, v52, v53
  v_cvt_pk_bf16_f32 v227, v54, v55
  v_cvt_pk_bf16_f32 v228, v56, v57
  v_cvt_pk_bf16_f32 v229, v58, v59
  v_cvt_pk_bf16_f32 v230, v60, v61
  v_cvt_pk_bf16_f32 v231, v62, v63
  v_mfma_f32_32x32x16_bf16 v[144:159], v[88:91], v[224:227], v[144:159]
  s_nop 0
  v_mfma_f32_32x32x16_bf16 v[144:159], v[92:95], v[228:231], v[144:159]
  v_smfmac_f32_16x16x64_bf16 v[208:211], v[12:15], v[224:231], v11
  s_add_u32 s30, s30, 4096
  s_sub_u32 s33, s33, 1
  s_cmp_lg_u32 s33, 0
  s_cbranch_scc1 .fz_kernel_a_s2
  s_nop 7
  v_add_f32 v208, v208, v210
  v_add_f32 v209, v209, v211
  v_cndmask_b32 v25, v208, v209, s[20:21]
  s_nop 7
  s_setpc_b64 s[68:69]
.fz_kernel_serv:
  s_setprio 3
  s_mov_b32 s24, s44
  s_mov_b32 s25, s45
  s_mov_b32 s26, 0x200000
  s_mov_b32 s27, 0x00020000
  v_lshrrev_b32 v8, 3, v2
  v_and_b32 v9, 7, v2
  v_bfe_u32 v10, v2, 4, 1
  v_lshlrev_b32 v10, 2, v10
  v_xor_b32 v9, v9, v10
  v_lshlrev_b32 v9, 4, v9
  v_lshl_add_u32 v10, v8, 11, v9
  s_cmp_eq_u32 s16, 5
  s_cbranch_scc1 .fz_kernel_sv1
  s_barrier
  v_lshlrev_b32 v7, 7, v2
  s_lshl_b32 s31, s18, 11
  s_lshl_b32 s33, 1, s17
  s_add_u32 s31, s31, s67
  s_add_u32 s31, s31, 0x1800000
  v_mov_b32 v8, s33
  s_mov_b64 exec, 0xffff
  s_mov_b32 s38, 0
.fz_kernel_cw40:
  s_sleep 1
  ds_read_u8 v9, v6 offset:256
  s_add_u32 s38, s38, 1
  s_waitcnt lgkmcnt(0)
  v_cmp_gt_u32 vcc, 4, v9
  s_cbranch_vccz .fz_kernel_cw40d
  s_cmp_lt_u32 s38, 8388608
  s_cbranch_scc1 .fz_kernel_cw40
.fz_kernel_cw40d:
  buffer_atomic_or v8, v7, s[4:7], s31 offen sc1
  s_mov_b64 exec, -1
  s_setprio 0
  s_mov_b32 s38, 0
.fz_kernel_kw41:
  s_sleep 2
  ds_read_b32 v7, v6 offset:0
  s_add_u32 s38, s38, 1
  s_waitcnt lgkmcnt(0)
  v_readfirstlane_b32 s31, v7
  s_bcnt1_i32_b32 s31, s31
  s_cmp_ge_u32 s31, 16
  s_cbranch_scc1 .fz_kernel_kw41d
  s_cmp_lt_u32 s38, 1048576
  s_cbranch_scc1 .fz_kernel_kw41
.fz_kernel_kw41d:
  s_branch .fz_kernel_sv2
.fz_kernel_sv1:
  s_add_u32 s37, s19, s67
  s_mov_b64 exec, 1
  buffer_load_dword v7, v4, s[4:7], s37 offen sc1
  s_waitcnt vmcnt(0)
  ds_or_b32 v6, v7
  buffer_load_dword v9, v4, s[4:7], s37 offen sc1
  s_barrier
  s_waitcnt vmcnt(0)
  ds_or_b32 v6, v9
  s_add_u32 s37, s19, s67
  s_mov_b64 exec, 1
  s_mov_b32 s38, 0
.fz_kernel_po42:
  buffer_load_dword v7, v4, s[4:7], s37 offen offset:0 sc1
  s_add_u32 s38, s38, 1
  s_waitcnt vmcnt(0)
  ds_or_b32 v6, v7 offset:0
  v_cmp_ne_u32 vcc, 0xffff, v7
  s_cbranch_vccz .fz_kernel_po42d
  s_sleep 12
  s_cmp_lt_u32 s38, 131072
  s_cbranch_scc1 .fz_kernel_po42
.fz_kernel_po42d:
  s_mov_b64 exec, -1
  s_setprio 0
  s_mov_b32 s38, 0
.fz_kernel_kw43:
  s_sleep 2
  ds_read_b32 v7, v6 offset:0
  s_add_u32 s38, s38, 1
  s_waitcnt lgkmcnt(0)
  v_readfirstlane_b32 s31, v7
  s_bcnt1_i32_b32 s31, s31
  s_cmp_ge_u32 s31, 16
  s_cbranch_scc1 .fz_kernel_kw43d
  s_cmp_lt_u32 s38, 1048576
  s_cbranch_scc1 .fz_kernel_kw43
.fz_kernel_kw43d:
.fz_kernel_sv2:
  s_and_b32 s30, s16, 1
  s_lshl_b32 s30, s30, 16
  s_add_u32 s32, s30, 65536
  s_lshl_b32 s31, s18, 7
  v_add_u32 v10, s31, v10
.fz_kernel_sv3:
  s_mov_b32 m0, s30
  s_lshl_b32 s31, s30, 4
  s_add_u32 s30, s30, 1024
  buffer_load_dwordx4 v10, s[24:27], s31 offen  lds
  s_cmp_lg_u32 s30, s32
  s_waitcnt vmcnt(3)
  s_cbranch_scc1 .fz_kernel_sv3
  s_cmp_lg_u32 s62, 0
  s_cbranch_scc1 .fz_kernel_wt44
  s_mov_b32 s12, s42
  s_mov_b32 s13, s43
  s_mov_b32 s14, 0x600000
  s_mov_b32 s15, 0x00020000
  s_and_b32 s30, s16, 1
  s_lshl1_add_u32 s30, s17, s30
  s_and_b32 s30, s30, 15
  s_mul_i32 s30, s30, 393216
  s_lshl_b32 s31, s18, 7
  s_add_u32 s30, s30, s31
  v_mul_u32_u24 v11, 6144, v2
  buffer_load_dword v1, v11, s[12:15], s30 offen
  s_add_u32 s30, s30, 2048
  s_waitcnt vmcnt(0)
  buffer_load_dword v1, v11, s[12:15], s30 offen
  s_add_u32 s30, s30, 2048
  s_waitcnt vmcnt(0)
  buffer_load_dword v1, v11, s[12:15], s30 offen
  s_add_u32 s30, s30, 2048
  s_waitcnt vmcnt(0)
.fz_kernel_wt44:
  s_cmp_lg_u32 s16, 4
  s_cbranch_scc1 .fz_kernel_ct45e
  s_getpc_b64 s[0:1]
.fz_kernel_ct45:
  s_sub_u32 s0, s0, .fz_kernel_ct45-fz_kernel
  s_subb_u32 s1, s1, 0
  s_lshr_b32 s31, s2, 3
  s_mulk_i32 s31, 0x500
  v_lshl_add_u32 v1, v2, 7, s31
  v_min_u32 v1, .fz_kernel_last-fz_kernel, v1
  s_mov_b64 exec, 0x3ff
  global_load_dword v1, v1, s[0:1]
  s_mov_b64 exec, -1
.fz_kernel_ct45e:
  s_waitcnt vmcnt(0)
  s_cmp_lg_u32 s16, 5
  s_cbranch_scc1 .fz_kernel_sv35
  s_mov_b64 exec, 1
  s_mov_b32 s38, 0
.fz_kernel_sv34:
  s_sleep 4
  buffer_load_dword v7, v4, s[4:7], s37 offen offset:4 sc1
  ds_read_b32 v8, v6 offset:0x104
  s_add_u32 s38, s38, 1
  s_waitcnt vmcnt(0) lgkmcnt(0)
  ds_or_b32 v6, v7 offset:8
  v_cmp_ne_u32 vcc, 0, v8
  s_cbranch_vccnz .fz_kernel_sv35
  s_cmp_lt_u32 s38, 131072
  s_cbranch_scc1 .fz_kernel_sv34
.fz_kernel_sv35:
  s_mov_b64 exec, -1
  s_setprio 3
  s_barrier
  s_cmp_eq_u32 s16, 5
  s_cbranch_scc1 .fz_kernel_sv4
  v_lshlrev_b32 v7, 11, v2
  s_lshl_b32 s31, s17, 7
  s_lshl_b32 s33, 1, s18
  s_add_u32 s31, s31, s67
  s_add_u32 s31, s31, 0x1800004
  v_mov_b32 v8, s33
  s_mov_b64 exec, 0xffff
  s_mov_b32 s38, 0
.fz_kernel_cw46:
  s_sleep 1
  ds_read_u8 v9, v6 offset:264
  s_add_u32 s38, s38, 1
  s_waitcnt lgkmcnt(0)
  v_cmp_gt_u32 vcc, 4, v9
  s_cbranch_vccz .fz_kernel_cw46d
  s_cmp_lt_u32 s38, 8388608
  s_cbranch_scc1 .fz_kernel_cw46
.fz_kernel_cw46d:
  buffer_atomic_or v8, v7, s[4:7], s31 offen sc1
  s_mov_b64 exec, -1
  s_mov_b64 exec, 1
  ds_or_b32 v6, v8 offset:8
  s_mov_b64 exec, -1
  s_branch .fz_kernel_sv5
.fz_kernel_sv4:
  s_add_u32 s37, s19, s67
  s_mov_b64 exec, 1
  s_mov_b32 s38, 0
.fz_kernel_po47:
  buffer_load_dword v7, v4, s[4:7], s37 offen offset:4 sc1
  s_add_u32 s38, s38, 1
  s_waitcnt vmcnt(0)
  ds_or_b32 v6, v7 offset:8
  v_cmp_ne_u32 vcc, 0xffff, v7
  s_cbranch_vccz .fz_kernel_po47d
  s_sleep 12
  s_cmp_lt_u32 s38, 131072
  s_cbranch_scc1 .fz_kernel_po47
.fz_kernel_po47d:
  s_mov_b64 exec, -1
.fz_kernel_sv5:
  s_mov_b32 s72, s66
  s_mov_b32 s73, s65
  s_mov_b32 s74, s67
  s_mov_b32 s75, s62
  s_cmp_lg_u32 s62, 0
  s_cbranch_scc1 .fz_kernel_w_lt
  s_mov_b32 s62, 1
  s_mov_b32 s63, 0x2000000
  s_mov_b32 s64, 0x2800000
  s_mov_b32 s65, 0x1400000
  s_mov_b32 s66, 0x1c42000
  s_mov_b32 s67, 12
  s_mov_b32 s71, 159776
  v_mov_b32 v6, 159832
  s_branch .fz_kernel_q_prod2
.fz_kernel_w_lt:
  s_barrier
  s_barrier
  s_branch .fz_kernel_fin
.fz_kernel_pk48c:
  s_call_b64 s[68:69], .fz_kernel_pick
  s_branch .fz_kernel_pk48
.fz_kernel_pk49c:
  s_call_b64 s[68:69], .fz_kernel_pick
  s_branch .fz_kernel_pk49
.fz_kernel_w_pt:
  v_lshlrev_b32 v44, 5, v17
  v_add_u32 v44, 155648, v44
  s_mov_b64 exec, vcc
  ds_read_b128 v[232:235], v44 offset:7424
  ds_read_b128 v[236:239], v44 offset:7440
  ds_read_b128 v[240:243], v44 offset:7488
  ds_read_b128 v[244:247], v44 offset:7504
  s_waitcnt lgkmcnt(0)
  v_pk_add_f32 v[64:65], v[64:65], v[232:233]
  v_pk_add_f32 v[66:67], v[66:67], v[234:235]
  v_pk_add_f32 v[68:69], v[68:69], v[236:237]
  v_pk_add_f32 v[70:71], v[70:71], v[238:239]
  v_pk_add_f32 v[72:73], v[72:73], v[240:241]
  v_pk_add_f32 v[74:75], v[74:75], v[242:243]
  v_pk_add_f32 v[76:77], v[76:77], v[244:245]
  v_pk_add_f32 v[78:79], v[78:79], v[246:247]
  ds_read_b128 v[232:235], v44 offset:7552
  ds_read_b128 v[236:239], v44 offset:7568
  ds_read_b128 v[240:243], v44 offset:7616
  ds_read_b128 v[244:247], v44 offset:7632
  s_waitcnt lgkmcnt(0)
  v_pk_add_f32 v[80:81], v[80:81], v[232:233]
  v_pk_add_f32 v[82:83], v[82:83], v[234:235]
  v_pk_add_f32 v[84:85], v[84:85], v[236:237]
  v_pk_add_f32 v[86:87], v[86:87], v[238:239]
  v_pk_add_f32 v[88:89], v[88:89], v[240:241]
  v_pk_add_f32 v[90:91], v[90:91], v[242:243]
  v_pk_add_f32 v[92:93], v[92:93], v[244:245]
  v_pk_add_f32 v[94:95], v[94:95], v[246:247]
  s_mov_b64 exec, -1
  s_branch .fz_kernel_w_pb
.fz_kernel_pk50c:
  s_call_b64 s[68:69], .fz_kernel_pick
  s_branch .fz_kernel_pk50
.fz_kernel_pk51c:
  s_call_b64 s[68:69], .fz_kernel_pick
  s_branch .fz_kernel_pk51
.fz_kernel_pk52c:
  s_call_b64 s[68:69], .fz_kernel_pick
  s_branch .fz_kernel_pk52
.fz_kernel_pk53c:
  s_call_b64 s[68:69], .fz_kernel_pick
  s_branch .fz_kernel_pk53
.fz_kernel_pk54c:
  s_call_b64 s[68:69], .fz_kernel_pick
  s_branch .fz_kernel_pk54
.fz_kernel_pk55c:
  s_call_b64 s[68:69], .fz_kernel_pick
  s_branch .fz_kernel_pk55
.fz_kernel_pk56c:
  s_call_b64 s[68:69], .fz_kernel_pick
  s_branch .fz_kernel_pk56
.fz_kernel_pk57c:
  s_call_b64 s[68:69], .fz_kernel_pick
  s_branch .fz_kernel_pk57
.fz_kernel_pk58c:
  s_call_b64 s[68:69], .fz_kernel_pick
  s_branch .fz_kernel_pk58
.fz_kernel_pk59c:
  s_call_b64 s[68:69], .fz_kernel_pick
  s_branch .fz_kernel_pk59
.fz_kernel_pk60c:
  s_call_b64 s[68:69], .fz_kernel_pick
  s_branch .fz_kernel_pk60
.fz_kernel_pk61c:
  s_call_b64 s[68:69], .fz_kernel_pick
  s_branch .fz_kernel_pk61
.fz_kernel_pk62c:
  s_call_b64 s[68:69], .fz_kernel_pick
  s_branch .fz_kernel_pk62
.fz_kernel_pk63c:
  s_call_b64 s[68:69], .fz_kernel_pick
  s_branch .fz_kernel_pk63
.fz_kernel_pk64c:
  s_call_b64 s[68:69], .fz_kernel_pick
  s_branch .fz_kernel_pk64
.fz_kernel_pk65c:
  s_call_b64 s[68:69], .fz_kernel_pick
  s_branch .fz_kernel_pk65
.fz_kernel_c_nl:
  s_barrier
  s_branch .fz_kernel_c_np
.fz_kernel_c_c7:
  s_mov_b32 s38, 0
.fz_kernel_cw70:
  s_sleep 1
  ds_read_u8 v22, v6 offset:272
  s_add_u32 s38, s38, 1
  s_waitcnt lgkmcnt(0)
  v_cmp_gt_u32 vcc, 2, v22
  s_cbranch_vccz .fz_kernel_cw70d
  s_cmp_lt_u32 s38, 8388608
  s_cbranch_scc1 .fz_kernel_cw70
.fz_kernel_cw70d:
  ds_read_b64_tr_b16 v[32:33], v7 offset:0
  ds_read_b64_tr_b16 v[34:35], v7 offset:512
  ds_read_b64_tr_b16 v[36:37], v13 offset:0
  ds_read_b64_tr_b16 v[38:39], v13 offset:512
  ds_read_b64_tr_b16 v[40:41], v7 offset:4096
  ds_read_b64_tr_b16 v[42:43], v7 offset:4608
  ds_read_b64_tr_b16 v[44:45], v13 offset:4096
  ds_read_b64_tr_b16 v[46:47], v13 offset:4608
  ds_read_b64_tr_b16 v[48:49], v7 offset:8192
  ds_read_b64_tr_b16 v[50:51], v7 offset:8704
  ds_read_b64_tr_b16 v[52:53], v13 offset:8192
  ds_read_b64_tr_b16 v[54:55], v13 offset:8704
  s_waitcnt lgkmcnt(0)
  v_xor_b32 v7, 64, v7
  v_xor_b32 v13, 64, v13
  ds_read_b64_tr_b16 v[56:57], v7 offset:1024
  ds_read_b64_tr_b16 v[58:59], v7 offset:1536
  ds_read_b64_tr_b16 v[60:61], v13 offset:1024
  ds_read_b64_tr_b16 v[62:63], v13 offset:1536
  ds_read_b64_tr_b16 v[64:65], v7 offset:5120
  ds_read_b64_tr_b16 v[66:67], v7 offset:5632
  ds_read_b64_tr_b16 v[68:69], v13 offset:5120
  ds_read_b64_tr_b16 v[70:71], v13 offset:5632
  ds_read_b64_tr_b16 v[72:73], v7 offset:9216
  ds_read_b64_tr_b16 v[74:75], v7 offset:9728
  ds_read_b64_tr_b16 v[76:77], v13 offset:9216
  ds_read_b64_tr_b16 v[78:79], v13 offset:9728
  s_waitcnt lgkmcnt(0)
  s_branch .fz_kernel_c_c2
.fz_kernel_c_coef:
  v_fma_f32 v242, -v240, v240, v242
  v_fma_f32 v243, -v241, v241, v243
  v_rsq_f32 v248, abs(v242)
  v_rsq_f32 v249, abs(v243)
  v_mul_f32 v254, v240, v248
  v_sub_f32 v254, 0, v254
  v_mov_b32 v252, 1.0
  v_fmac_f32 v252, 0x44800000, v248
  v_fma_f32 v242, v242, v24, -v25
  v_max_f32 v242, 0, v242
  v_mul_f32 v248, v252, v252
  v_fma_f32 v248, v248, v242, v25
  v_rsq_f32 v248, v248
  v_mul_f32 v240, v23, v240
  v_mul_f32 v248, v248, v252
  v_mul_f32 v250, v248, v240
  v_sub_f32 v250, 0, v250
  v_mul_f32 v255, v241, v249
  v_sub_f32 v255, 0, v255
  v_mov_b32 v253, 1.0
  v_fmac_f32 v253, 0x44800000, v249
  s_cmp_eq_u32 s3, 0
  s_cbranch_scc1 .fz_kernel_hb73
  s_barrier
  s_sub_u32 s3, s3, 1
.fz_kernel_hb73:
  v_fma_f32 v243, v243, v24, -v25
  v_max_f32 v243, 0, v243
  v_mul_f32 v249, v253, v253
  v_fma_f32 v249, v249, v243, v25
  v_rsq_f32 v249, v249
  v_mul_f32 v241, v23, v241
  v_mul_f32 v249, v249, v253
  v_mul_f32 v251, v249, v241
  v_sub_f32 v251, 0, v251
  s_setpc_b64 s[68:69]
.fz_kernel_c_gur:
  v_min_u32 v9, v144, v146
  v_cmp_eq_u32 s[8:9], 0, v9
  v_min_u32 v9, v148, v150
  v_cmp_eq_u32 s[10:11], 0, v9
  v_min_u32 v9, v152, v154
  v_cmp_eq_u32 s[12:13], 0, v9
  v_min_u32 v9, v156, v158
  v_cmp_eq_u32 s[14:15], 0, v9
  s_add_u32 s38, s38, 1
  s_cmp_ge_u32 s38, 131072
  s_cbranch_scc1 .fz_kernel_c_gud
  s_or_b64 exec, s[8:9], 1
  buffer_load_dwordx4 v[144:147], v21, s[4:7], s33 offen offset:0 sc1
  s_or_b64 exec, s[10:11], 1
  buffer_load_dwordx4 v[148:151], v21, s[4:7], s33 offen offset:512 sc1
  s_or_b64 exec, s[12:13], 1
  buffer_load_dwordx4 v[152:155], v21, s[4:7], s33 offen offset:1024 sc1
  s_or_b64 exec, s[14:15], 1
  buffer_load_dwordx4 v[156:159], v21, s[4:7], s33 offen offset:1536 sc1
  s_mov_b64 exec, -1
  s_branch .fz_kernel_c_gu
.fz_kernel_c_pur:
  s_cmp_eq_u32 s3, 0
  s_cbranch_scc1 .fz_kernel_hb78
  s_barrier
  s_sub_u32 s3, s3, 1
.fz_kernel_hb78:
  s_add_u32 s38, s38, 1
  s_cmp_ge_u32 s38, 131072
  s_cbranch_scc1 .fz_kernel_c_pud
  v_min_u32 v9, v144, v146
  v_cmp_eq_u32 vcc, 0, v9
  s_cbranch_vccz .fz_kernel_c_ps0
  buffer_load_dwordx4 v[144:147], v3, s[4:7], s21 offen offset:0 sc1
.fz_kernel_c_ps0:
  v_min_u32 v9, v148, v150
  v_cmp_eq_u32 vcc, 0, v9
  s_cbranch_vccz .fz_kernel_c_ps1
  buffer_load_dwordx4 v[148:151], v3, s[4:7], s21 offen offset:1024 sc1
.fz_kernel_c_ps1:
  v_min_u32 v9, v152, v154
  v_cmp_eq_u32 vcc, 0, v9
  s_cbranch_vccz .fz_kernel_c_ps2
  buffer_load_dwordx4 v[152:155], v3, s[4:7], s21 offen offset:2048 sc1
.fz_kernel_c_ps2:
  v_min_u32 v9, v156, v158
  v_cmp_eq_u32 vcc, 0, v9
  s_cbranch_vccz .fz_kernel_c_ps3
  buffer_load_dwordx4 v[156:159], v3, s[4:7], s21 offen offset:3072 sc1
.fz_kernel_c_ps3:
  v_min_u32 v9, v160, v162
  v_cmp_eq_u32 vcc, 0, v9
  s_cbranch_vccz .fz_kernel_c_ps4
  buffer_load_dwordx4 v[160:163], v3, s[4:7], s22 offen offset:0 sc1
.fz_kernel_c_ps4:
  v_min_u32 v9, v164, v166
  v_cmp_eq_u32 vcc, 0, v9
  s_cbranch_vccz .fz_kernel_c_ps5
  buffer_load_dwordx4 v[164:167], v3, s[4:7], s22 offen offset:1024 sc1
.fz_kernel_c_ps5:
  v_min_u32 v9, v168, v170
  v_cmp_eq_u32 vcc, 0, v9
  s_cbranch_vccz .fz_kernel_c_ps6
  buffer_load_dwordx4 v[168:171], v3, s[4:7], s22 offen offset:2048 sc1
.fz_kernel_c_ps6:
  s_branch .fz_kernel_c_pu
.fz_kernel_last:
  s_endpgm

.section .rodata,"a"
.p2align 6
.amdhsa_kernel fz_kernel
  .amdhsa_next_free_vgpr 256
  .amdhsa_next_free_sgpr 102
  .amdhsa_accum_offset 256
  .amdhsa_group_segment_fixed_size 0
  .amdhsa_kernarg_size 88
  .amdhsa_user_sgpr_count 2
  .amdhsa_user_sgpr_kernarg_segment_ptr 1
  .amdhsa_system_sgpr_workgroup_id_x 1
.end_amdhsa_kernel
```

```asm
; @launch kernel=fz_kernel grid=(256,1,1) block=(512,1,1) lds=163840
.amdgcn_target "amdgcn-amd-amdhsa--gfx950"
.text
.globl fz_kernel
.p2align 8
.type fz_kernel,@function
fz_kernel:
  s_cmp_ge_u32 s2, 256
  s_cbranch_scc1 .fz_kernel_end
  s_load_dwordx2 s[8:9], s[0:1], 0
  s_load_dwordx2 s[12:13], s[0:1], 8
  s_load_dwordx2 s[4:5], s[0:1], 80
  s_load_dwordx16 s[40:55], s[0:1], 0
  s_load_dwordx4 s[56:59], s[0:1], 64
  v_lshrrev_b32 v1, 6, v0
  v_and_b32 v2, 63, v0
  v_readfirstlane_b32 s16, v1
  s_and_b32 s21, s2, 7
  s_lshr_b32 s22, s2, 3
  s_and_b32 s23, s21, 3
  s_lshl_b32 s23, s23, 2
  s_and_b32 s24, s22, 3
  s_add_u32 s18, s23, s24
  s_lshr_b32 s24, s21, 2
  s_lshl_b32 s24, s24, 3
  s_lshr_b32 s25, s22, 2
  s_add_u32 s17, s24, s25
  s_lshl_b32 s19, s18, 4
  s_add_u32 s19, s19, s17
  s_lshl_b32 s19, s19, 7
  s_add_u32 s19, s19, 0x1800000
  v_lshlrev_b32 v3, 4, v2
  v_mov_b32 v4, 0
  v_mov_b32 v5, 1
  s_mov_b32 s6, 0x2c00000
  s_mov_b32 s7, 0x00020000
  s_mov_b32 s62, 0
  s_mov_b32 s63, 0x400000
  s_mov_b32 s64, 0xc00000
  s_mov_b32 s65, 0x1000000
  s_mov_b32 s66, 0x1c00000
  s_mov_b32 s67, 0
  s_mov_b32 s71, 159744
  v_mov_b32 v6, 159808
  s_cmp_lt_u32 s16, 4
  s_cbranch_scc1 .fz_kernel_q_cons1
  s_cmp_ge_u32 s16, 6
  s_cbranch_scc1 .fz_kernel_q_help1
  s_mov_b32 s10, 0x400000
  s_mov_b32 s11, 0x00020000
  v_lshrrev_b32 v20, 3, v2
  v_and_b32 v21, 7, v2
  v_lshrrev_b32 v22, 4, v2
  v_xor_b32 v23, v21, v22
  v_lshlrev_b32 v23, 4, v23
  v_lshl_add_u32 v24, v20, 11, v23
  v_xor_b32 v25, 64, v24
  s_lshl_b32 s35, s17, 2
  s_and_b32 s31, s16, 1
  s_add_u32 s35, s35, s31
  s_lshl_b32 s35, s35, 16
  s_and_b32 s29, s18, 12
  s_lshr_b32 s33, s17, 3
  s_lshl1_add_u32 s29, s33, s29
  s_lshl2_add_u32 s29, s17, s29
  s_and_b32 s29, s29, 15
  s_mov_b32 s22, 128
  s_mov_b32 s23, 131072
  s_mov_b32 s36, -1
  v_add_u32 v40, 0, v24
  v_add_u32 v41, 15360, v25
  v_add_u32 v42, 30720, v24
  v_add_u32 v43, 46080, v25
.fz_kernel_q_pc:
  s_mov_b32 s14, 0x600000
  s_mov_b32 s15, 0x00020000
  v_lshrrev_b32 v28, 3, v2
  v_and_b32 v29, 7, v2
  v_bfe_u32 v30, v2, 4, 1
  v_lshlrev_b32 v30, 1, v30
  v_xor_b32 v31, v29, v30
  v_lshlrev_b32 v31, 4, v31
  v_mul_u32_u24 v28, 6144, v28
  v_add_u32 v28, v28, v31
  v_xor_b32 v29, 64, v28
  s_lshl_b32 s32, s18, 7
  s_add_u32 s39, s32, 6291456
  s_mul_i32 s33, s29, 393216
  s_add_u32 s33, s33, s32
  s_lshl_b32 s29, s29, 1
  s_mul_i32 s25, s31, 6144
  s_add_u32 s25, s25, 65536
  s_mov_b32 s30, s25
  s_add_u32 s26, s25, 49152
  s_lshl_b32 s21, s31, 12
  s_cmp_eq_u32 s31, 0
  s_mov_b32 s24, 100352
  s_cselect_b32 s24, 0, s24
  v_add_u32 v32, s24, v28
  s_mov_b32 s24, 148480
  s_cselect_b32 s24, 48128, s24
  v_add_u32 v33, s24, v29
  s_mov_b32 s24, 2048
  s_cselect_b32 s24, 96256, s24
  v_add_u32 v34, s24, v28
  s_mov_b32 s24, 50176
  s_cselect_b32 s24, 144384, s24
  v_add_u32 v35, s24, v29
  s_mov_b32 s24, 102400
  s_cselect_b32 s24, 2048, s24
  v_add_u32 v36, s24, v28
  s_mov_b32 s24, 150528
  s_cselect_b32 s24, 50176, s24
  v_add_u32 v37, s24, v29
  s_cmp_lg_u32 s62, 0
  s_cbranch_scc1 .fz_kernel_q_st2
  s_waitcnt lgkmcnt(0)
  s_mov_b32 s34, 32
  s_call_b64 s[0:1], .fz_kernel_q_ix
  s_call_b64 s[0:1], .fz_kernel_q_iu
  s_call_b64 s[0:1], .fz_kernel_q_iu
  s_call_b64 s[0:1], .fz_kernel_q_iu
  s_waitcnt vmcnt(20)
  s_barrier
  s_call_b64 s[0:1], .fz_kernel_q_iu
  s_waitcnt vmcnt(24)
  s_barrier
  s_call_b64 s[0:1], .fz_kernel_q_iu
  s_branch .fz_kernel_q_pl
.fz_kernel_q_ix:
  s_bfe_u32 s24, s29, 0x40001
  s_mul_i32 s20, s24, s22
  s_bitcmp1_b32 s29, 0
  s_cselect_b32 s31, s23, 0
  s_add_u32 s20, s20, s35
  s_add_u32 s20, s20, s31
  s_bitcmp1_b32 s36, s24
  s_cbranch_scc0 .fz_kernel_xok1w
.fz_kernel_xok1:
  s_mov_b32 m0, s21
  s_add_u32 s21, s21, 8192
  s_and_b32 s21, s21, 0xffff
  s_add_u32 s29, s29, 1
  buffer_load_dwordx4 v40, s[8:11], s20 offen offset:0 lds
  buffer_load_dwordx4 v41, s[8:11], s20 offen offset:1024 lds
  buffer_load_dwordx4 v42, s[8:11], s20 offen offset:2048 lds
  buffer_load_dwordx4 v43, s[8:11], s20 offen offset:3072 lds
  s_setpc_b64 s[0:1]
.fz_kernel_q_iu:
  s_mov_b32 m0, s30
  s_add_u32 s30, s30, 12288
  buffer_load_dwordx4 v32, s[12:15], s33 offen offset:0 lds
  s_bfe_u32 s24, s29, 0x40001
  buffer_load_dwordx4 v33, s[12:15], s33 offen offset:1024 lds
  s_mul_i32 s20, s24, s22
  buffer_load_dwordx4 v34, s[12:15], s33 offen offset:2048 lds
  s_bitcmp1_b32 s29, 0
  s_cselect_b32 s31, s23, 0
  buffer_load_dwordx4 v35, s[12:15], s33 offen offset:3072 lds
  s_add_u32 m0, m0, 4096
  s_add_u32 s20, s20, s35
  buffer_load_dwordx4 v36, s[12:15], s33 offen offset:0 lds
  s_add_u32 s20, s20, s31
  buffer_load_dwordx4 v37, s[12:15], s33 offen offset:1024 lds
  s_bitcmp1_b32 s36, s24
  s_cbranch_scc0 .fz_kernel_xok2w
.fz_kernel_xok2:
  s_mov_b32 m0, s21
  s_add_u32 s21, s21, 8192
  s_and_b32 s21, s21, 0xffff
  s_add_u32 s29, s29, 1
  buffer_load_dwordx4 v40, s[8:11], s20 offen offset:0 lds
  s_add_u32 s33, s33, 196608
  s_cmp_eq_u32 s33, s39
  s_cselect_b32 s33, s32, s33
  buffer_load_dwordx4 v41, s[8:11], s20 offen offset:1024 lds
  s_cmp_eq_u32 s30, s26
  s_cselect_b32 s30, s25, s30
  buffer_load_dwordx4 v42, s[8:11], s20 offen offset:2048 lds
  s_sub_u32 s34, s34, 1
  s_cmp_lg_u32 s34, 0
  buffer_load_dwordx4 v43, s[8:11], s20 offen offset:3072 lds
  s_setpc_b64 s[0:1]
.fz_kernel_q_iw:
  s_mov_b32 m0, s30
  s_add_u32 s30, s30, 12288
  buffer_load_dwordx4 v32, s[12:15], s33 offen offset:0 lds
  s_nop 0
  buffer_load_dwordx4 v33, s[12:15], s33 offen offset:1024 lds
  s_nop 0
  buffer_load_dwordx4 v34, s[12:15], s33 offen offset:2048 lds
  s_nop 0
  buffer_load_dwordx4 v35, s[12:15], s33 offen offset:3072 lds
  s_add_u32 m0, m0, 4096
  s_nop 0
  buffer_load_dwordx4 v36, s[12:15], s33 offen offset:0 lds
  buffer_load_dwordx4 v37, s[12:15], s33 offen offset:1024 lds
  s_add_u32 s33, s33, 196608
  s_cmp_eq_u32 s33, s39
  s_cselect_b32 s33, s32, s33
  s_cmp_eq_u32 s30, s26
  s_cselect_b32 s30, s25, s30
  s_sub_u32 s34, s34, 1
  s_cmp_lg_u32 s34, 0
  s_setpc_b64 s[0:1]
.fz_kernel_q_st2:
  s_mov_b32 s34, 32
  s_waitcnt vmcnt(0)
  s_barrier
  s_call_b64 s[0:1], .fz_kernel_q_iw
  s_call_b64 s[0:1], .fz_kernel_q_iw
  s_call_b64 s[0:1], .fz_kernel_q_iw
  s_call_b64 s[0:1], .fz_kernel_q_iw
  s_call_b64 s[0:1], .fz_kernel_q_ix
  s_call_b64 s[0:1], .fz_kernel_q_ix
  s_mov_b64 exec, 1
  s_waitcnt vmcnt(20)
  ds_add_u32 v6, v5 offset:0x110
  s_mov_b64 exec, -1
  v_mov_b32 v12, 0x100
  s_call_b64 s[0:1], .fz_kernel_q_ix
  s_call_b64 s[0:1], .fz_kernel_q_ix
  s_waitcnt vmcnt(8)
  s_mov_b64 exec, 1
  ds_add_u32 v6, v12 offset:0x110
  s_mov_b64 exec, -1
  s_barrier
  s_waitcnt vmcnt(8)
  s_barrier
  s_call_b64 s[0:1], .fz_kernel_q_ix
  s_call_b64 s[0:1], .fz_kernel_q_iu
  s_waitcnt vmcnt(14)
  s_barrier
  s_call_b64 s[0:1], .fz_kernel_q_iu
  s_waitcnt vmcnt(20)
  s_barrier
  s_call_b64 s[0:1], .fz_kernel_q_iu
.fz_kernel_q_pl:
  s_waitcnt vmcnt(20)
  s_barrier
  s_mov_b32 m0, s30
  s_add_u32 s30, s30, 12288
  buffer_load_dwordx4 v32, s[12:15], s33 offen offset:0 lds
  s_bfe_u32 s24, s29, 0x40001
  buffer_load_dwordx4 v33, s[12:15], s33 offen offset:1024 lds
  s_mul_i32 s20, s24, s22
  buffer_load_dwordx4 v34, s[12:15], s33 offen offset:2048 lds
  s_bitcmp1_b32 s29, 0
  s_cselect_b32 s31, s23, 0
  buffer_load_dwordx4 v35, s[12:15], s33 offen offset:3072 lds
  s_add_u32 m0, m0, 4096
  s_add_u32 s20, s20, s35
  buffer_load_dwordx4 v36, s[12:15], s33 offen offset:0 lds
  s_add_u32 s20, s20, s31
  buffer_load_dwordx4 v37, s[12:15], s33 offen offset:1024 lds
  s_bitcmp1_b32 s36, s24
  s_cbranch_scc0 .fz_kernel_xok3w
.fz_kernel_xok3:
  s_mov_b32 m0, s21
  s_add_u32 s21, s21, 8192
  s_and_b32 s21, s21, 0xffff
  s_add_u32 s29, s29, 1
  buffer_load_dwordx4 v40, s[8:11], s20 offen offset:0 lds
  s_add_u32 s33, s33, 196608
  s_cmp_eq_u32 s33, s39
  s_cselect_b32 s33, s32, s33
  buffer_load_dwordx4 v41, s[8:11], s20 offen offset:1024 lds
  s_cmp_eq_u32 s30, s26
  s_cselect_b32 s30, s25, s30
  buffer_load_dwordx4 v42, s[8:11], s20 offen offset:2048 lds
  s_sub_u32 s34, s34, 1
  s_cmp_lg_u32 s34, 0
  buffer_load_dwordx4 v43, s[8:11], s20 offen offset:3072 lds
  s_cbranch_scc1 .fz_kernel_q_pl
  s_waitcnt vmcnt(20)
  s_barrier
  s_waitcnt vmcnt(10)
  s_barrier
  s_waitcnt vmcnt(0)
  s_barrier
  s_barrier
  s_branch .fz_kernel_serv
.fz_kernel_q_cons1:
  s_waitcnt lgkmcnt(0)
  s_mov_b32 s12, s42
  s_mov_b32 s13, s43
  s_mov_b32 s14, 0x600000
  s_mov_b32 s15, 0x00020000
  s_and_b32 s20, s18, 4
  s_add_u32 s20, s20, s16
  s_cmp_ge_u32 s20, 3
  s_cbranch_scc1 .fz_kernel_q_nsp
  s_and_b32 s20, s17, 7
  s_and_b32 s21, s18, 3
  s_lshl2_add_u32 s20, s20, s21
  s_mul_i32 s20, s20, 196608
  s_or_b32 s21, s18, 3
  s_lshl4_add_u32 s21, s16, s21
  s_lshl_b32 s21, s21, 7
  s_add_u32 s20, s20, s21
  v_mul_u32_u24 v20, 6144, v2
  s_mov_b32 exec_hi, 0
  buffer_load_dword v231, v20, s[12:15], s20 offen
  s_mov_b32 exec_hi, -1
.fz_kernel_q_nsp:
  v_lshlrev_b32 v20, 2, v0
  v_add_u32 v20, 159744, v20
  s_cmp_ge_u32 s16, 2
  s_cbranch_scc1 .fz_kernel_q_nz
  ds_write_b32 v20, v4
.fz_kernel_q_nz:
  s_lshr_b32 s26, s16, 1
  s_lshl_b32 s28, s26, 13
  v_and_b32 v20, 15, v2
  v_lshrrev_b32 v21, 4, v2
  v_bfe_u32 v22, v2, 1, 3
  v_xor_b32 v22, v22, v21
  v_lshlrev_b32 v20, 7, v20
  v_lshl_add_u32 v20, v22, 4, v20
  v_add_u32 v8, s28, v20
  v_xor_b32 v9, 64, v8
.fz_kernel_q_cs:
  s_and_b32 s27, s16, 1
  s_lshl_b32 s28, s27, 1
  v_lshrrev_b32 v14, 4, v2
  v_bfe_u32 v15, v2, 2, 2
  v_lshl_add_u32 v16, v14, 3, v15
  v_lshlrev_b32 v16, 7, v16
  v_and_b32 v14, 1, v14
  v_lshrrev_b32 v15, 1, v15
  v_lshl_add_u32 v14, v14, 1, v15
  v_xor_b32 v14, s28, v14
  v_lshl_add_u32 v16, v14, 5, v16
  v_and_b32 v14, 3, v2
  v_lshl_add_u32 v16, v14, 3, v16
  v_add_u32 v12, 65536, v16
  v_xor_b32 v13, 32, v12
  v_mov_b32 v10, v12
  v_mov_b32 v11, v13
  s_mov_b32 s29, 16
  s_mov_b32 s30, 0
  v_mov_b32 v128, 0
  v_mov_b32 v129, 0
  v_mov_b32 v130, 0
  v_mov_b32 v131, 0
  v_mov_b32 v132, 0
  v_mov_b32 v133, 0
  v_mov_b32 v134, 0
  v_mov_b32 v135, 0
  v_mov_b32 v136, 0
  v_mov_b32 v137, 0
  v_mov_b32 v138, 0
  v_mov_b32 v139, 0
  v_mov_b32 v140, 0
  v_mov_b32 v141, 0
  v_mov_b32 v142, 0
  v_mov_b32 v143, 0
  v_mov_b32 v144, 0
  v_mov_b32 v145, 0
  v_mov_b32 v146, 0
  v_mov_b32 v147, 0
  v_mov_b32 v148, 0
  v_mov_b32 v149, 0
  v_mov_b32 v150, 0
  v_mov_b32 v151, 0
  v_mov_b32 v152, 0
  v_mov_b32 v153, 0
  v_mov_b32 v154, 0
  v_mov_b32 v155, 0
  v_mov_b32 v156, 0
  v_mov_b32 v157, 0
  v_mov_b32 v158, 0
  v_mov_b32 v159, 0
  v_mov_b32 v160, 0
  v_mov_b32 v161, 0
  v_mov_b32 v162, 0
  v_mov_b32 v163, 0
  v_mov_b32 v164, 0
  v_mov_b32 v165, 0
  v_mov_b32 v166, 0
  v_mov_b32 v167, 0
  v_mov_b32 v168, 0
  v_mov_b32 v169, 0
  v_mov_b32 v170, 0
  v_mov_b32 v171, 0
  v_mov_b32 v172, 0
  v_mov_b32 v173, 0
  v_mov_b32 v174, 0
  v_mov_b32 v175, 0
  s_cmp_eq_u32 s62, 0
  s_cbranch_scc1 .fz_kernel_q_i1
  s_mov_b64 exec, 1
  s_waitcnt vmcnt(0)
  ds_add_u32 v1, v5 offset:0x100
  s_mov_b64 exec, -1
.fz_kernel_q_i1:
  v_mov_b32 v176, 0
  v_mov_b32 v177, 0
  v_mov_b32 v178, 0
  v_mov_b32 v179, 0
  v_mov_b32 v180, 0
  v_mov_b32 v181, 0
  v_mov_b32 v182, 0
  v_mov_b32 v183, 0
  v_mov_b32 v184, 0
  v_mov_b32 v185, 0
  v_mov_b32 v186, 0
  v_mov_b32 v187, 0
  v_mov_b32 v188, 0
  v_mov_b32 v189, 0
  v_mov_b32 v190, 0
  v_mov_b32 v191, 0
  v_mov_b32 v192, 0
  v_mov_b32 v193, 0
  v_mov_b32 v194, 0
  v_mov_b32 v195, 0
  v_mov_b32 v196, 0
  v_mov_b32 v197, 0
  v_mov_b32 v198, 0
  v_mov_b32 v199, 0
  v_mov_b32 v200, 0
  v_mov_b32 v201, 0
  v_mov_b32 v202, 0
  v_mov_b32 v203, 0
  v_mov_b32 v204, 0
  v_mov_b32 v205, 0
  v_mov_b32 v206, 0
  v_mov_b32 v207, 0
  v_mov_b32 v208, 0
  v_mov_b32 v209, 0
  v_mov_b32 v210, 0
  v_mov_b32 v211, 0
  v_mov_b32 v212, 0
  v_mov_b32 v213, 0
  v_mov_b32 v214, 0
  v_mov_b32 v215, 0
  v_mov_b32 v216, 0
  v_mov_b32 v217, 0
  v_mov_b32 v218, 0
  v_mov_b32 v219, 0
  v_mov_b32 v220, 0
  v_mov_b32 v221, 0
  v_mov_b32 v222, 0
  v_mov_b32 v223, 0
  v_and_b32 v14, 1, v2
  v_lshlrev_b32 v14, 4, v14
  v_mov_b32 v15, 0x3f80
  v_lshlrev_b32 v14, v14, v15
  v_mov_b32 v248, 0
  v_mov_b32 v249, 0
  v_mov_b32 v250, 0
  v_mov_b32 v251, 0
  v_mov_b32 v252, 0
  v_mov_b32 v253, 0
  v_mov_b32 v254, 0
  v_mov_b32 v255, 0
  s_mov_b32 exec_lo, 0x3
  s_mov_b32 exec_hi, 0x30
  v_mov_b32 v248, v14
  s_mov_b32 exec_lo, 0xc
  s_mov_b32 exec_hi, 0xc0
  v_mov_b32 v249, v14
  s_mov_b32 exec_lo, 0x300
  s_mov_b32 exec_hi, 0x3000
  v_mov_b32 v250, v14
  s_mov_b32 exec_lo, 0xc00
  s_mov_b32 exec_hi, 0xc000
  v_mov_b32 v251, v14
  s_mov_b32 exec_lo, 0x30000
  s_mov_b32 exec_hi, 0x300000
  v_mov_b32 v252, v14
  s_mov_b32 exec_lo, 0xc0000
  s_mov_b32 exec_hi, 0xc00000
  v_mov_b32 v253, v14
  s_mov_b32 exec_lo, 0x3000000
  s_mov_b32 exec_hi, 0x30000000
  v_mov_b32 v254, v14
  s_mov_b32 exec_lo, 0xc000000
  s_mov_b32 exec_hi, 0xc0000000
  v_mov_b32 v255, v14
  s_mov_b64 exec, -1
  s_lshl1_add_u32 s35, s18, s27
  s_lshl_b32 s35, s35, 5
  s_add_u32 s35, s35, s26
  s_lshl_b32 s35, s35, 13
  s_add_u32 s35, s35, s63
  s_lshl_b32 s11, s16, 8
  s_add_u32 s11, s11, 147456
  s_mov_b32 s20, 0xffff0000
  s_mov_b32 s21, 0xffff0000
  s_mov_b32 s24, 0x21800000
  s_mov_b32 s25, 0x5d800000
  s_andn2_b32 s8, 2, s16
  s_lshl2_add_u32 s8, s17, s8
  s_lshl4_add_u32 s8, s8, s18
  s_lshl1_add_u32 s8, s8, s27
  s_lshl_b32 s8, s8, 11
  s_add_u32 s8, s8, s64
  s_add_u32 s9, s8, 65536
  s_mov_b32 s73, 0
  s_mov_b32 s32, 7
  s_mov_b32 s12, s40
  s_mov_b32 s13, s41
  s_mov_b32 s14, 0x400000
  s_mov_b32 s15, 0x00020000
  v_lshrrev_b32 v14, 5, v2
  v_and_b32 v15, 31, v2
  v_lshlrev_b32 v14, 4, v14
  v_lshl_add_u32 v15, v15, 11, v14
  s_lshl2_add_u32 s23, s17, s16
  s_lshl_b32 s23, s23, 16
  s_lshl_b32 s22, s18, 7
  s_add_u32 s23, s22, s23
  s_waitcnt lgkmcnt(0)
  s_barrier
  ds_read_b64_tr_b16 v[56:57], v10 offset:4096
  ds_read_b64_tr_b16 v[58:59], v10 offset:4608
  ds_read_b128 v[32:35], v8 offset:0
  ds_read_b128 v[36:39], v8 offset:2048
  ds_read_b128 v[40:43], v8 offset:4096
  ds_read_b128 v[44:47], v8 offset:6144
  ds_read_b64_tr_b16 v[60:61], v11 offset:4096
  ds_read_b64_tr_b16 v[62:63], v11 offset:4608
  ds_read_b64_tr_b16 v[64:65], v10 offset:8192
  ds_read_b64_tr_b16 v[66:67], v10 offset:8704
  ds_read_b64_tr_b16 v[68:69], v11 offset:8192
  ds_read_b64_tr_b16 v[70:71], v11 offset:8704
  ds_read_b64_tr_b16 v[48:49], v10 offset:0
  ds_read_b64_tr_b16 v[50:51], v10 offset:512
  ds_read_b64_tr_b16 v[52:53], v11 offset:0
  ds_read_b64_tr_b16 v[54:55], v11 offset:512
  s_add_u32 s30, s30, 12288
  s_cmp_eq_u32 s30, 49152
  s_cselect_b32 s30, 0, s30
  v_add_u32 v8, 0x4000, v8
  v_add_u32 v10, s30, v12
  v_add_u32 v11, s30, v13
  v_and_b32 v8, 0xffff, v8
  s_waitcnt lgkmcnt(0)
  s_branch .fz_kernel_q_l0
  .p2align 6
.fz_kernel_q_loop:
  v_mfma_f32_16x16x32_bf16 v[148:151], v[52:55], v[36:39], v[148:151]
  v_mfma_f32_16x16x32_bf16 v[152:155], v[52:55], v[40:43], v[152:155]
  s_waitcnt lgkmcnt(0)
  v_mfma_f32_16x16x32_bf16 v[156:159], v[52:55], v[44:47], v[156:159]
  s_barrier
  v_mfma_f32_16x16x32_bf16 v[160:163], v[96:99], v[72:75], v[160:163]
  ds_read_b64_tr_b16 v[56:57], v10 offset:4096
  v_mfma_f32_16x16x32_bf16 v[164:167], v[96:99], v[76:79], v[164:167]
  ds_read_b64_tr_b16 v[58:59], v10 offset:4608
  v_mfma_f32_16x16x32_bf16 v[168:171], v[96:99], v[80:83], v[168:171]
  ds_read_b128 v[32:35], v8 offset:0
  v_mfma_f32_16x16x32_bf16 v[172:175], v[96:99], v[84:87], v[172:175]
  ds_read_b128 v[36:39], v8 offset:2048
  v_mfma_f32_16x16x32_bf16 v[176:179], v[100:103], v[72:75], v[176:179]
  ds_read_b128 v[40:43], v8 offset:4096
  v_mfma_f32_16x16x32_bf16 v[180:183], v[100:103], v[76:79], v[180:183]
  ds_read_b128 v[44:47], v8 offset:6144
  v_mfma_f32_16x16x32_bf16 v[184:187], v[100:103], v[80:83], v[184:187]
  ds_read_b64_tr_b16 v[60:61], v11 offset:4096
  v_mfma_f32_16x16x32_bf16 v[188:191], v[100:103], v[84:87], v[188:191]
  ds_read_b64_tr_b16 v[62:63], v11 offset:4608
  v_mfma_f32_16x16x32_bf16 v[192:195], v[72:75], v[104:107], v[192:195]
  ds_read_b64_tr_b16 v[64:65], v10 offset:8192
  s_add_u32 s30, s30, 12288
  v_mfma_f32_16x16x32_bf16 v[196:199], v[76:79], v[104:107], v[196:199]
  ds_read_b64_tr_b16 v[66:67], v10 offset:8704
  s_cmp_eq_u32 s30, 49152
  v_mfma_f32_16x16x32_bf16 v[200:203], v[80:83], v[104:107], v[200:203]
  ds_read_b64_tr_b16 v[68:69], v11 offset:8192
  s_cselect_b32 s30, 0, s30
  v_mfma_f32_16x16x32_bf16 v[204:207], v[84:87], v[104:107], v[204:207]
  ds_read_b64_tr_b16 v[70:71], v11 offset:8704
  v_mfma_f32_16x16x32_bf16 v[208:211], v[72:75], v[108:111], v[208:211]
  ds_read_b64_tr_b16 v[48:49], v10 offset:0
  v_mfma_f32_16x16x32_bf16 v[212:215], v[76:79], v[108:111], v[212:215]
  ds_read_b64_tr_b16 v[50:51], v10 offset:512
  v_mfma_f32_16x16x32_bf16 v[216:219], v[80:83], v[108:111], v[216:219]
  ds_read_b64_tr_b16 v[52:53], v11 offset:0
  v_mfma_f32_16x16x32_bf16 v[220:223], v[84:87], v[108:111], v[220:223]
  ds_read_b64_tr_b16 v[54:55], v11 offset:512
  v_mfma_f32_16x16x32_bf16 v[128:131], v[88:91], v[72:75], v[128:131]
  v_add_u32 v8, 0x4000, v8
  v_mfma_f32_16x16x32_bf16 v[132:135], v[88:91], v[76:79], v[132:135]
  v_add_u32 v10, s30, v12
  v_mfma_f32_16x16x32_bf16 v[136:139], v[88:91], v[80:83], v[136:139]
  v_add_u32 v11, s30, v13
  v_mfma_f32_16x16x32_bf16 v[140:143], v[88:91], v[84:87], v[140:143]
  v_and_b32 v8, 0xffff, v8
  v_mfma_f32_16x16x32_bf16 v[144:147], v[92:95], v[72:75], v[144:147]
  v_mfma_f32_16x16x32_bf16 v[148:151], v[92:95], v[76:79], v[148:151]
  v_mfma_f32_16x16x32_bf16 v[152:155], v[92:95], v[80:83], v[152:155]
  s_waitcnt lgkmcnt(0)
  v_mfma_f32_16x16x32_bf16 v[156:159], v[92:95], v[84:87], v[156:159]
.fz_kernel_q_l0:
  s_barrier
  v_mfma_f32_16x16x32_bf16 v[160:163], v[56:59], v[32:35], v[160:163]
  ds_read_b64_tr_b16 v[96:97], v10 offset:4096
  v_mfma_f32_16x16x32_bf16 v[164:167], v[56:59], v[36:39], v[164:167]
  ds_read_b64_tr_b16 v[98:99], v10 offset:4608
  v_mfma_f32_16x16x32_bf16 v[168:171], v[56:59], v[40:43], v[168:171]
  ds_read_b128 v[72:75], v9 offset:0
  v_mfma_f32_16x16x32_bf16 v[172:175], v[56:59], v[44:47], v[172:175]
  ds_read_b128 v[76:79], v9 offset:2048
  v_mfma_f32_16x16x32_bf16 v[176:179], v[60:63], v[32:35], v[176:179]
  ds_read_b128 v[80:83], v9 offset:4096
  v_mfma_f32_16x16x32_bf16 v[180:183], v[60:63], v[36:39], v[180:183]
  ds_read_b128 v[84:87], v9 offset:6144
  v_mfma_f32_16x16x32_bf16 v[184:187], v[60:63], v[40:43], v[184:187]
  ds_read_b64_tr_b16 v[100:101], v11 offset:4096
  v_mfma_f32_16x16x32_bf16 v[188:191], v[60:63], v[44:47], v[188:191]
  ds_read_b64_tr_b16 v[102:103], v11 offset:4608
  v_mfma_f32_16x16x32_bf16 v[192:195], v[32:35], v[64:67], v[192:195]
  ds_read_b64_tr_b16 v[104:105], v10 offset:8192
  s_add_u32 s30, s30, 12288
  v_mfma_f32_16x16x32_bf16 v[196:199], v[36:39], v[64:67], v[196:199]
  ds_read_b64_tr_b16 v[106:107], v10 offset:8704
  s_cmp_eq_u32 s30, 49152
  v_mfma_f32_16x16x32_bf16 v[200:203], v[40:43], v[64:67], v[200:203]
  ds_read_b64_tr_b16 v[108:109], v11 offset:8192
  s_cselect_b32 s30, 0, s30
  v_mfma_f32_16x16x32_bf16 v[204:207], v[44:47], v[64:67], v[204:207]
  ds_read_b64_tr_b16 v[110:111], v11 offset:8704
  s_sub_u32 s29, s29, 1
  v_mfma_f32_16x16x32_bf16 v[208:211], v[32:35], v[68:71], v[208:211]
  ds_read_b64_tr_b16 v[88:89], v10 offset:0
  s_cmp_lg_u32 s29, 0
  v_mfma_f32_16x16x32_bf16 v[212:215], v[36:39], v[68:71], v[212:215]
  ds_read_b64_tr_b16 v[90:91], v10 offset:512
  v_mfma_f32_16x16x32_bf16 v[216:219], v[40:43], v[68:71], v[216:219]
  ds_read_b64_tr_b16 v[92:93], v11 offset:0
  v_mfma_f32_16x16x32_bf16 v[220:223], v[44:47], v[68:71], v[220:223]
  ds_read_b64_tr_b16 v[94:95], v11 offset:512
  v_mfma_f32_16x16x32_bf16 v[128:131], v[48:51], v[32:35], v[128:131]
  v_add_u32 v9, 0x4000, v9
  v_mfma_f32_16x16x32_bf16 v[132:135], v[48:51], v[36:39], v[132:135]
  v_add_u32 v10, s30, v12
  v_mfma_f32_16x16x32_bf16 v[136:139], v[48:51], v[40:43], v[136:139]
  v_add_u32 v11, s30, v13
  v_mfma_f32_16x16x32_bf16 v[140:143], v[48:51], v[44:47], v[140:143]
  v_and_b32 v9, 0xffff, v9
  v_mfma_f32_16x16x32_bf16 v[144:147], v[52:55], v[32:35], v[144:147]
  s_cbranch_scc1 .fz_kernel_q_loop
  v_mfma_f32_16x16x32_bf16 v[148:151], v[52:55], v[36:39], v[148:151]
  v_mfma_f32_16x16x32_bf16 v[152:155], v[52:55], v[40:43], v[152:155]
  s_waitcnt lgkmcnt(0)
  v_mfma_f32_16x16x32_bf16 v[156:159], v[52:55], v[44:47], v[156:159]
  s_cmp_lg_u32 s62, 0
  s_cbranch_scc1 .fz_kernel_q_nr
  buffer_load_dwordx4 v[232:235], v15, s[12:15], s23 offen offset:0
  buffer_load_dwordx4 v[236:239], v15, s[12:15], s23 offen offset:32
  buffer_load_dwordx4 v[240:243], v15, s[12:15], s23 offen offset:64
  buffer_load_dwordx4 v[244:247], v15, s[12:15], s23 offen offset:96
.fz_kernel_q_nr:
  s_barrier
  v_mfma_f32_16x16x32_bf16 v[160:163], v[96:99], v[72:75], v[160:163]
  s_lshl_b32 s31, s26, 8
  s_add_u32 s31, s31, 155648
  v_and_b32 v22, 15, v2
  v_and_b32 v23, 48, v2
  v_mfma_f32_16x16x32_bf16 v[164:167], v[96:99], v[76:79], v[164:167]
  s_lshl_b32 s33, s27, 7
  s_add_u32 s33, s33, 155648
  v_lshlrev_b32 v22, 2, v22
  v_mov_b32 v1, 159952
  v_mfma_f32_16x16x32_bf16 v[168:171], v[96:99], v[80:83], v[168:171]
  v_add_u32 v29, s33, v22
  v_add_u32 v22, s31, v22
  v_mfma_f32_16x16x32_bf16 v[172:175], v[96:99], v[84:87], v[172:175]
  v_add_u32 v28, s33, v23
  v_add_u32 v23, s31, v23
  v_mfma_f32_16x16x32_bf16 v[176:179], v[100:103], v[72:75], v[176:179]
  ds_read_b32 v1, v1
  v_add_u32 v64, 4608, v22
  v_mfma_f32_16x16x32_bf16 v[180:183], v[100:103], v[76:79], v[180:183]
  ds_read_b128 v[120:123], v28 offset:5888
  v_and_b32 v12, 1, v2
  v_mfma_f32_16x16x32_bf16 v[184:187], v[100:103], v[80:83], v[184:187]
  ds_read_b128 v[124:127], v28 offset:5952
  v_add_u32 v12, -1, v12
  v_mfma_f32_16x16x32_bf16 v[188:191], v[100:103], v[84:87], v[188:191]
  ds_read2_b32 v[224:225], v64 offset0:0 offset1:128
  v_and_b32 v12, 0x3f803f80, v12
  v_mfma_f32_16x16x32_bf16 v[192:195], v[72:75], v[104:107], v[192:195]
  ds_read2_b32 v[226:227], v64 offset0:16 offset1:144
  v_and_b32 v11, 2, v2
  v_mfma_f32_16x16x32_bf16 v[196:199], v[76:79], v[104:107], v[196:199]
  ds_read2_b32 v[228:229], v64 offset0:32 offset1:160
  v_xor_b32 v14, 0x3f803f80, v12
  v_mfma_f32_16x16x32_bf16 v[200:203], v[80:83], v[104:107], v[200:203]
  ds_read2_b32 v[230:231], v64 offset0:48 offset1:176
  v_mul_u32_u24 v11, 0x5555, v11
  v_mfma_f32_16x16x32_bf16 v[204:207], v[84:87], v[104:107], v[204:207]
  ds_read_b32 v24, v29 offset:6144
  v_mov_b32 v13, v12
  v_mfma_f32_16x16x32_bf16 v[208:211], v[72:75], v[108:111], v[208:211]
  ds_read_b32 v26, v29 offset:6208
  v_mov_b32 v15, v14
  v_mfma_f32_16x16x32_bf16 v[212:215], v[76:79], v[108:111], v[212:215]
  ds_read_b128 v[32:35], v23 offset:4608
  ds_read_b128 v[48:51], v23 offset:5120
  v_mfma_f32_16x16x32_bf16 v[216:219], v[80:83], v[108:111], v[216:219]
  ds_read_b128 v[36:39], v23 offset:4672
  ds_read_b128 v[52:55], v23 offset:5184
  v_mfma_f32_16x16x32_bf16 v[220:223], v[84:87], v[108:111], v[220:223]
  ds_read_b128 v[40:43], v23 offset:4736
  ds_read_b128 v[56:59], v23 offset:5248
  v_mfma_f32_16x16x32_bf16 v[128:131], v[88:91], v[72:75], v[128:131]
  ds_read_b128 v[44:47], v23 offset:4800
  ds_read_b128 v[60:63], v23 offset:5312
  v_mfma_f32_16x16x32_bf16 v[132:135], v[88:91], v[76:79], v[132:135]
  ds_read_b128 v[112:115], v28 offset:5632
  ds_read_b128 v[116:119], v28 offset:5696
  v_mfma_f32_16x16x32_bf16 v[136:139], v[88:91], v[80:83], v[136:139]
  s_lshl1_add_u32 s34, s18, s27
  s_lshl4_add_u32 s34, s34, s17
  s_lshl1_add_u32 s34, s34, s26
  v_mfma_f32_16x16x32_bf16 v[140:143], v[88:91], v[84:87], v[140:143]
  s_lshl_b32 s36, s34, 13
  s_add_u32 s36, s36, s63
  s_add_u32 s37, s36, 4096
  v_mfma_f32_16x16x32_bf16 v[144:147], v[92:95], v[72:75], v[144:147]
  s_lshl_b32 s34, s16, 12
  s_add_u32 s34, s34, 131072
  v_add_u32 v9, s34, v3
  v_mfma_f32_16x16x32_bf16 v[148:151], v[92:95], v[76:79], v[148:151]
  v_xor_b32 v8, 8192, v9
  v_mfma_f32_16x16x32_bf16 v[152:155], v[92:95], v[80:83], v[152:155]
  v_add_u32 v11, 0x4444, v11
  v_mfma_f32_16x16x32_bf16 v[156:159], v[92:95], v[84:87], v[156:159]
  v_add_u32 v10, 4096, v3
  s_waitcnt lgkmcnt(12)
  v_add_u32 v1, -1, v1
  v_lshrrev_b32 v1, 6, v1
  v_cmp_eq_u32 vcc, s26, v1
  s_cbranch_vccnz .fz_kernel_q_patch
.fz_kernel_q_pback:
  v_pk_mul_f32 v[64:65], v[120:121], v[224:225] op_sel:[0,1] op_sel_hi:[1,1]
  v_pk_fma_f32 v[160:161], v[160:161], v[224:225], v[64:65] op_sel_hi:[1,0,1]
  v_pk_mul_f32 v[66:67], v[122:123], v[224:225] op_sel:[0,1] op_sel_hi:[1,1]
  v_pk_fma_f32 v[162:163], v[162:163], v[224:225], v[66:67] op_sel_hi:[1,0,1]
  v_pk_mul_f32 v[68:69], v[124:125], v[224:225] op_sel:[0,1] op_sel_hi:[1,1]
  v_pk_fma_f32 v[176:177], v[176:177], v[224:225], v[68:69] op_sel_hi:[1,0,1]
  v_pk_mul_f32 v[70:71], v[126:127], v[224:225] op_sel:[0,1] op_sel_hi:[1,1]
  v_pk_fma_f32 v[178:179], v[178:179], v[224:225], v[70:71] op_sel_hi:[1,0,1]
  v_cvt_pk_bf16_f32 v80, v160, v161
  v_cvt_pk_bf16_f32 v81, v162, v163
  v_cvt_pk_bf16_f32 v82, v176, v177
  v_cvt_pk_bf16_f32 v83, v178, v179
  v_pk_mul_f32 v[64:65], v[120:121], v[226:227] op_sel:[0,1] op_sel_hi:[1,1]
  v_pk_fma_f32 v[164:165], v[164:165], v[226:227], v[64:65] op_sel_hi:[1,0,1]
  v_pk_mul_f32 v[66:67], v[122:123], v[226:227] op_sel:[0,1] op_sel_hi:[1,1]
  v_pk_fma_f32 v[166:167], v[166:167], v[226:227], v[66:67] op_sel_hi:[1,0,1]
  v_pk_mul_f32 v[68:69], v[124:125], v[226:227] op_sel:[0,1] op_sel_hi:[1,1]
  v_pk_fma_f32 v[180:181], v[180:181], v[226:227], v[68:69] op_sel_hi:[1,0,1]
  v_pk_mul_f32 v[70:71], v[126:127], v[226:227] op_sel:[0,1] op_sel_hi:[1,1]
  v_pk_fma_f32 v[182:183], v[182:183], v[226:227], v[70:71] op_sel_hi:[1,0,1]
  v_cvt_pk_bf16_f32 v84, v164, v165
  v_cvt_pk_bf16_f32 v85, v166, v167
  v_cvt_pk_bf16_f32 v86, v180, v181
  v_cvt_pk_bf16_f32 v87, v182, v183
  v_permlane16_swap_b32 v80, v84
  v_permlane16_swap_b32 v81, v85
  v_permlane16_swap_b32 v82, v86
  v_permlane16_swap_b32 v83, v87
  buffer_store_dwordx4 v[80:83], v3, s[4:7], s36 offen offset:0 sc1
  buffer_store_dwordx4 v[84:87], v3, s[4:7], s36 offen offset:1024 sc1
  v_pk_mul_f32 v[64:65], v[120:121], v[228:229] op_sel:[0,1] op_sel_hi:[1,1]
  v_pk_fma_f32 v[168:169], v[168:169], v[228:229], v[64:65] op_sel_hi:[1,0,1]
  v_pk_mul_f32 v[66:67], v[122:123], v[228:229] op_sel:[0,1] op_sel_hi:[1,1]
  v_pk_fma_f32 v[170:171], v[170:171], v[228:229], v[66:67] op_sel_hi:[1,0,1]
  v_pk_mul_f32 v[68:69], v[124:125], v[228:229] op_sel:[0,1] op_sel_hi:[1,1]
  v_pk_fma_f32 v[184:185], v[184:185], v[228:229], v[68:69] op_sel_hi:[1,0,1]
  v_pk_mul_f32 v[70:71], v[126:127], v[228:229] op_sel:[0,1] op_sel_hi:[1,1]
  v_pk_fma_f32 v[186:187], v[186:187], v[228:229], v[70:71] op_sel_hi:[1,0,1]
  v_cvt_pk_bf16_f32 v96, v168, v169
  v_cvt_pk_bf16_f32 v97, v170, v171
  v_cvt_pk_bf16_f32 v98, v184, v185
  v_cvt_pk_bf16_f32 v99, v186, v187
  v_pk_mul_f32 v[64:65], v[120:121], v[230:231] op_sel:[0,1] op_sel_hi:[1,1]
  v_pk_fma_f32 v[172:173], v[172:173], v[230:231], v[64:65] op_sel_hi:[1,0,1]
  v_pk_mul_f32 v[66:67], v[122:123], v[230:231] op_sel:[0,1] op_sel_hi:[1,1]
  v_pk_fma_f32 v[174:175], v[174:175], v[230:231], v[66:67] op_sel_hi:[1,0,1]
  v_pk_mul_f32 v[68:69], v[124:125], v[230:231] op_sel:[0,1] op_sel_hi:[1,1]
  v_pk_fma_f32 v[188:189], v[188:189], v[230:231], v[68:69] op_sel_hi:[1,0,1]
  v_pk_mul_f32 v[70:71], v[126:127], v[230:231] op_sel:[0,1] op_sel_hi:[1,1]
  v_pk_fma_f32 v[190:191], v[190:191], v[230:231], v[70:71] op_sel_hi:[1,0,1]
  v_cvt_pk_bf16_f32 v100, v172, v173
  v_cvt_pk_bf16_f32 v101, v174, v175
  v_cvt_pk_bf16_f32 v102, v188, v189
  v_cvt_pk_bf16_f32 v103, v190, v191
  v_permlane16_swap_b32 v96, v100
  v_permlane16_swap_b32 v97, v101
  v_permlane16_swap_b32 v98, v102
  v_permlane16_swap_b32 v99, v103
  buffer_store_dwordx4 v[96:99], v3, s[4:7], s37 offen offset:0 sc1
  buffer_store_dwordx4 v[100:103], v3, s[4:7], s37 offen offset:1024 sc1
  s_waitcnt lgkmcnt(0)
  v_pk_mul_f32 v[64:65], v[48:49], v[24:25] op_sel_hi:[1,0]
  v_pk_fma_f32 v[192:193], v[192:193], v[32:33], v[64:65]
  v_pk_mul_f32 v[66:67], v[50:51], v[24:25] op_sel_hi:[1,0]
  v_pk_fma_f32 v[194:195], v[194:195], v[34:35], v[66:67]
  v_pk_mul_f32 v[68:69], v[48:49], v[26:27] op_sel_hi:[1,0]
  v_pk_fma_f32 v[208:209], v[208:209], v[32:33], v[68:69]
  v_pk_mul_f32 v[70:71], v[50:51], v[26:27] op_sel_hi:[1,0]
  v_pk_fma_f32 v[210:211], v[210:211], v[34:35], v[70:71]
  v_cvt_pk_bf16_f32 v88, v192, v193
  v_cvt_pk_bf16_f32 v90, v208, v209
  v_cvt_pk_bf16_f32 v89, v194, v195
  v_cvt_pk_bf16_f32 v91, v210, v211
  v_pk_mul_f32 v[64:65], v[52:53], v[24:25] op_sel_hi:[1,0]
  v_pk_fma_f32 v[196:197], v[196:197], v[36:37], v[64:65]
  v_pk_mul_f32 v[66:67], v[54:55], v[24:25] op_sel_hi:[1,0]
  v_pk_fma_f32 v[198:199], v[198:199], v[38:39], v[66:67]
  v_pk_mul_f32 v[68:69], v[52:53], v[26:27] op_sel_hi:[1,0]
  v_pk_fma_f32 v[212:213], v[212:213], v[36:37], v[68:69]
  v_pk_mul_f32 v[70:71], v[54:55], v[26:27] op_sel_hi:[1,0]
  v_pk_fma_f32 v[214:215], v[214:215], v[38:39], v[70:71]
  v_cvt_pk_bf16_f32 v92, v196, v197
  v_cvt_pk_bf16_f32 v94, v212, v213
  v_cvt_pk_bf16_f32 v93, v198, v199
  v_cvt_pk_bf16_f32 v95, v214, v215
  v_permlane16_swap_b32 v88, v90
  v_permlane16_swap_b32 v89, v91
  v_permlane16_swap_b32 v92, v94
  v_permlane16_swap_b32 v93, v95
  v_permlane32_swap_b32 v88, v90
  v_permlane32_swap_b32 v89, v91
  v_permlane32_swap_b32 v92, v94
  v_permlane32_swap_b32 v93, v95
  buffer_store_dwordx4 v[88:91], v3, s[4:7], s36 offen offset:2048 sc1
  buffer_store_dwordx4 v[92:95], v3, s[4:7], s36 offen offset:3072 sc1
  v_pk_mul_f32 v[64:65], v[56:57], v[24:25] op_sel_hi:[1,0]
  v_pk_fma_f32 v[200:201], v[200:201], v[40:41], v[64:65]
  v_pk_mul_f32 v[66:67], v[58:59], v[24:25] op_sel_hi:[1,0]
  v_pk_fma_f32 v[202:203], v[202:203], v[42:43], v[66:67]
  v_pk_mul_f32 v[68:69], v[56:57], v[26:27] op_sel_hi:[1,0]
  v_pk_fma_f32 v[216:217], v[216:217], v[40:41], v[68:69]
  v_pk_mul_f32 v[70:71], v[58:59], v[26:27] op_sel_hi:[1,0]
  v_pk_fma_f32 v[218:219], v[218:219], v[42:43], v[70:71]
  v_cvt_pk_bf16_f32 v104, v200, v201
  v_cvt_pk_bf16_f32 v106, v216, v217
  v_cvt_pk_bf16_f32 v105, v202, v203
  v_cvt_pk_bf16_f32 v107, v218, v219
  v_pk_mul_f32 v[64:65], v[60:61], v[24:25] op_sel_hi:[1,0]
  v_pk_fma_f32 v[204:205], v[204:205], v[44:45], v[64:65]
  v_pk_mul_f32 v[66:67], v[62:63], v[24:25] op_sel_hi:[1,0]
  v_pk_fma_f32 v[206:207], v[206:207], v[46:47], v[66:67]
  v_pk_mul_f32 v[68:69], v[60:61], v[26:27] op_sel_hi:[1,0]
  v_pk_fma_f32 v[220:221], v[220:221], v[44:45], v[68:69]
  v_pk_mul_f32 v[70:71], v[62:63], v[26:27] op_sel_hi:[1,0]
  v_pk_fma_f32 v[222:223], v[222:223], v[46:47], v[70:71]
  v_cvt_pk_bf16_f32 v108, v204, v205
  v_cvt_pk_bf16_f32 v110, v220, v221
  v_cvt_pk_bf16_f32 v109, v206, v207
  v_cvt_pk_bf16_f32 v111, v222, v223
  v_permlane16_swap_b32 v104, v106
  v_permlane16_swap_b32 v105, v107
  v_permlane16_swap_b32 v108, v110
  v_permlane16_swap_b32 v109, v111
  v_permlane32_swap_b32 v104, v106
  v_permlane32_swap_b32 v105, v107
  v_permlane32_swap_b32 v108, v110
  v_permlane32_swap_b32 v109, v111
  buffer_store_dwordx4 v[104:107], v3, s[4:7], s37 offen offset:2048 sc1
  buffer_store_dwordx4 v[108:111], v3, s[4:7], s37 offen offset:3072 sc1
  v_mul_f32 v224, 0.25503486164919736, v224
  v_mul_f32 v225, 0.25503486164919736, v225
  v_mul_f32 v226, 0.25503486164919736, v226
  v_mul_f32 v227, 0.25503486164919736, v227
  v_mul_f32 v228, 0.25503486164919736, v228
  v_mul_f32 v229, 0.25503486164919736, v229
  v_mul_f32 v230, 0.25503486164919736, v230
  v_mul_f32 v231, 0.25503486164919736, v231
  v_pk_mul_f32 v[64:65], v[112:113], v[224:225] op_sel:[0,1] op_sel_hi:[1,1]
  v_pk_fma_f32 v[128:129], v[128:129], v[224:225], v[64:65] op_sel_hi:[1,0,1]
  v_pk_mul_f32 v[66:67], v[114:115], v[224:225] op_sel:[0,1] op_sel_hi:[1,1]
  v_pk_fma_f32 v[130:131], v[130:131], v[224:225], v[66:67] op_sel_hi:[1,0,1]
  v_pk_mul_f32 v[68:69], v[116:117], v[224:225] op_sel:[0,1] op_sel_hi:[1,1]
  v_pk_fma_f32 v[144:145], v[144:145], v[224:225], v[68:69] op_sel_hi:[1,0,1]
  v_pk_mul_f32 v[70:71], v[118:119], v[224:225] op_sel:[0,1] op_sel_hi:[1,1]
  v_pk_fma_f32 v[146:147], v[146:147], v[224:225], v[70:71] op_sel_hi:[1,0,1]
  v_cvt_pk_bf16_f32 v16, v128, v129
  v_cvt_pk_bf16_f32 v17, v130, v131
  v_cvt_pk_bf16_f32 v18, v144, v145
  v_cvt_pk_bf16_f32 v19, v146, v147
  v_pk_mul_f32 v[64:65], v[112:113], v[226:227] op_sel:[0,1] op_sel_hi:[1,1]
  v_pk_fma_f32 v[132:133], v[132:133], v[226:227], v[64:65] op_sel_hi:[1,0,1]
  v_pk_mul_f32 v[66:67], v[114:115], v[226:227] op_sel:[0,1] op_sel_hi:[1,1]
  v_pk_fma_f32 v[134:135], v[134:135], v[226:227], v[66:67] op_sel_hi:[1,0,1]
  v_pk_mul_f32 v[68:69], v[116:117], v[226:227] op_sel:[0,1] op_sel_hi:[1,1]
  v_pk_fma_f32 v[148:149], v[148:149], v[226:227], v[68:69] op_sel_hi:[1,0,1]
  v_pk_mul_f32 v[70:71], v[118:119], v[226:227] op_sel:[0,1] op_sel_hi:[1,1]
  v_pk_fma_f32 v[150:151], v[150:151], v[226:227], v[70:71] op_sel_hi:[1,0,1]
  v_cvt_pk_bf16_f32 v20, v132, v133
  v_cvt_pk_bf16_f32 v21, v134, v135
  v_cvt_pk_bf16_f32 v22, v148, v149
  v_cvt_pk_bf16_f32 v23, v150, v151
  v_permlane16_swap_b32 v16, v20
  v_permlane16_swap_b32 v17, v21
  v_permlane16_swap_b32 v18, v22
  v_permlane16_swap_b32 v19, v23
  ds_write_b128 v8, v[16:19] offset:0
  ds_write_b128 v8, v[20:23] offset:1024
  v_pk_mul_f32 v[64:65], v[112:113], v[228:229] op_sel:[0,1] op_sel_hi:[1,1]
  v_pk_fma_f32 v[136:137], v[136:137], v[228:229], v[64:65] op_sel_hi:[1,0,1]
  v_pk_mul_f32 v[66:67], v[114:115], v[228:229] op_sel:[0,1] op_sel_hi:[1,1]
  v_pk_fma_f32 v[138:139], v[138:139], v[228:229], v[66:67] op_sel_hi:[1,0,1]
  v_pk_mul_f32 v[68:69], v[116:117], v[228:229] op_sel:[0,1] op_sel_hi:[1,1]
  v_pk_fma_f32 v[152:153], v[152:153], v[228:229], v[68:69] op_sel_hi:[1,0,1]
  v_pk_mul_f32 v[70:71], v[118:119], v[228:229] op_sel:[0,1] op_sel_hi:[1,1]
  v_pk_fma_f32 v[154:155], v[154:155], v[228:229], v[70:71] op_sel_hi:[1,0,1]
  v_cvt_pk_bf16_f32 v24, v136, v137
  v_cvt_pk_bf16_f32 v25, v138, v139
  v_cvt_pk_bf16_f32 v26, v152, v153
  v_cvt_pk_bf16_f32 v27, v154, v155
  v_pk_mul_f32 v[64:65], v[112:113], v[230:231] op_sel:[0,1] op_sel_hi:[1,1]
  v_pk_fma_f32 v[140:141], v[140:141], v[230:231], v[64:65] op_sel_hi:[1,0,1]
  v_pk_mul_f32 v[66:67], v[114:115], v[230:231] op_sel:[0,1] op_sel_hi:[1,1]
  v_pk_fma_f32 v[142:143], v[142:143], v[230:231], v[66:67] op_sel_hi:[1,0,1]
  v_pk_mul_f32 v[68:69], v[116:117], v[230:231] op_sel:[0,1] op_sel_hi:[1,1]
  v_pk_fma_f32 v[156:157], v[156:157], v[230:231], v[68:69] op_sel_hi:[1,0,1]
  v_pk_mul_f32 v[70:71], v[118:119], v[230:231] op_sel:[0,1] op_sel_hi:[1,1]
  v_pk_fma_f32 v[158:159], v[158:159], v[230:231], v[70:71] op_sel_hi:[1,0,1]
  v_cvt_pk_bf16_f32 v28, v140, v141
  v_cvt_pk_bf16_f32 v29, v142, v143
  v_cvt_pk_bf16_f32 v30, v156, v157
  v_cvt_pk_bf16_f32 v31, v158, v159
  v_permlane16_swap_b32 v24, v28
  v_permlane16_swap_b32 v25, v29
  v_permlane16_swap_b32 v26, v30
  v_permlane16_swap_b32 v27, v31
  ds_write_b128 v8, v[24:27] offset:2048
  ds_write_b128 v8, v[28:31] offset:3072
  s_branch .fz_kernel_att
.fz_kernel_q_help1:
  s_waitcnt lgkmcnt(0)
  s_mov_b32 s3, 32
  s_cmp_eq_u32 s16, 7
  s_cbranch_scc1 .fz_kernel_q_h7
  s_getpc_b64 s[0:1]
.fz_kernel_ct4:
  s_sub_u32 s0, s0, .fz_kernel_ct4-fz_kernel
  s_subb_u32 s1, s1, 0
  s_lshr_b32 s31, s2, 3
  s_mulk_i32 s31, 0x500
  v_lshl_add_u32 v1, v2, 7, s31
  v_min_u32 v1, .fz_kernel_last-fz_kernel, v1
  s_mov_b64 exec, 0x3ff
  global_load_dword v1, v1, s[0:1]
  s_mov_b64 exec, -1
.fz_kernel_ct4e:
  s_mov_b32 s12, s58
  s_mov_b32 s13, s59
  s_mov_b32 s14, 0x100
  s_mov_b32 s15, 0x00020000
  s_mov_b32 s30, 0
  s_and_b32 s31, s18, 3
  s_sub_u32 s31, s31, s30
  s_and_b32 s30, s31, 3
  s_lshl_b32 s30, s30, 14
  v_and_b32 v20, 15, v2
  v_lshrrev_b32 v21, 4, v2
  v_bfe_u32 v22, v2, 1, 3
  v_xor_b32 v22, v22, v21
  v_lshlrev_b32 v21, 7, v20
  v_lshl_add_u32 v21, v22, 4, v21
  v_add_u32 v21, s30, v21
  v_xor_b32 v22, 64, v21
  v_lshlrev_b32 v20, 3, v20
  s_lshl_b32 s30, s17, 10
  s_add_u32 s30, s30, 0x1808000
  s_mov_b32 exec_lo, 0x00f0000f
  s_mov_b32 exec_hi, 0xf0000f00
  v_add_u32 v20, 4, v20
  s_mov_b64 exec, -1
  v_mov_b32 v24, 0x3f803f80
  v_mov_b32 v25, v24
  v_mov_b32 v26, v24
  v_mov_b32 v27, v24
  s_lshl_b32 s31, s31, 1
  s_sub_u32 s31, 31, s31
  v_lshlrev_b32 v52, 3, v2
  v_add_u32 v52, 155648, v52
  v_mov_b32 v54, 1.0
  v_mov_b32 v55, 1.0
  v_mov_b32 v56, 0
  v_mov_b32 v57, 0
  ds_write_b64 v52, v[54:55] offset:6400
  ds_write_b64 v52, v[56:57] offset:6912
  s_mov_b32 s20, s48
  s_mov_b32 s21, s49
  s_mov_b32 s22, 0x800
  s_mov_b32 s23, 0x00020000
  v_lshlrev_b32 v40, 5, v2
  buffer_load_dwordx4 v[44:47], v40, s[20:23], 0 offen
  buffer_load_dwordx4 v[48:51], v40, s[20:23], 0 offen offset:16
  v_mov_b32 v40, 0
  s_waitcnt vmcnt(0)
  v_lshlrev_b32 v41, 16, v44
  v_and_b32 v42, 0xffff0000, v44
  v_add_f32 v40, v40, v41
  v_add_f32 v40, v40, v42
  v_lshlrev_b32 v41, 16, v45
  v_and_b32 v42, 0xffff0000, v45
  v_add_f32 v40, v40, v41
  v_add_f32 v40, v40, v42
  v_lshlrev_b32 v41, 16, v46
  v_and_b32 v42, 0xffff0000, v46
  v_add_f32 v40, v40, v41
  v_add_f32 v40, v40, v42
  v_lshlrev_b32 v41, 16, v47
  v_and_b32 v42, 0xffff0000, v47
  v_add_f32 v40, v40, v41
  v_add_f32 v40, v40, v42
  v_lshlrev_b32 v41, 16, v48
  v_and_b32 v42, 0xffff0000, v48
  v_add_f32 v40, v40, v41
  v_add_f32 v40, v40, v42
  v_lshlrev_b32 v41, 16, v49
  v_and_b32 v42, 0xffff0000, v49
  v_add_f32 v40, v40, v41
  v_add_f32 v40, v40, v42
  v_lshlrev_b32 v41, 16, v50
  v_and_b32 v42, 0xffff0000, v50
  v_add_f32 v40, v40, v41
  v_add_f32 v40, v40, v42
  v_lshlrev_b32 v41, 16, v51
  v_and_b32 v42, 0xffff0000, v51
  v_add_f32 v40, v40, v41
  v_add_f32 v40, v40, v42
  s_nop 1
  v_add_f32 v40, v40, v40 quad_perm:[1,0,3,2] row_mask:0xf bank_mask:0xf
  s_nop 1
  v_add_f32 v40, v40, v40 quad_perm:[2,3,0,1] row_mask:0xf bank_mask:0xf
  s_nop 1
  v_add_f32 v40, v40, v40 row_half_mirror row_mask:0xf bank_mask:0xf
  s_nop 1
  v_add_f32 v40, v40, v40 row_mirror row_mask:0xf bank_mask:0xf
  s_nop 0
  v_readlane_b32 s20, v40, 16
  v_readlane_b32 s21, v40, 32
  v_readlane_b32 s22, v40, 48
  v_add_f32 v40, s20, v40
  v_add_f32 v40, s21, v40
  v_add_f32 v40, s22, v40
  v_mul_f32 v40, 0x3a800000, v40
  s_nop 0
  v_readfirstlane_b32 s76, v40
.fz_kernel_xs5:
  s_barrier
  s_sub_u32 s3, s3, 1
  s_cmp_lg_u32 s3, s31
  s_cbranch_scc1 .fz_kernel_xs5
  ds_read_b128 v[64:67], v21 offset:0
  ds_read_b128 v[72:75], v21 offset:2048
  ds_read_b128 v[80:83], v21 offset:4096
  ds_read_b128 v[88:91], v21 offset:6144
  ds_read_b128 v[96:99], v21 offset:8192
  ds_read_b128 v[104:107], v21 offset:10240
  ds_read_b128 v[112:115], v21 offset:12288
  ds_read_b128 v[120:123], v21 offset:14336
  ds_read_b128 v[68:71], v22 offset:0
  ds_read_b128 v[76:79], v22 offset:2048
  ds_read_b128 v[84:87], v22 offset:4096
  ds_read_b128 v[92:95], v22 offset:6144
  ds_read_b128 v[100:103], v22 offset:8192
  ds_read_b128 v[108:111], v22 offset:10240
  ds_read_b128 v[116:119], v22 offset:12288
  ds_read_b128 v[124:127], v22 offset:14336
  s_waitcnt lgkmcnt(0)
  s_cmp_eq_u32 s3, 0
  s_cbranch_scc1 .fz_kernel_hb6
  s_barrier
  s_sub_u32 s3, s3, 1
.fz_kernel_hb6:
  s_setprio 2
  v_mfma_f32_16x16x32_bf16 v[128:131], v[24:27], v[64:67], 0
  v_mfma_f32_16x16x32_bf16 v[160:163], v[64:67], v[64:67], 0
  v_mfma_f32_16x16x32_bf16 v[132:135], v[24:27], v[72:75], 0
  v_mfma_f32_16x16x32_bf16 v[164:167], v[72:75], v[72:75], 0
  v_mfma_f32_16x16x32_bf16 v[136:139], v[24:27], v[80:83], 0
  v_mfma_f32_16x16x32_bf16 v[168:171], v[80:83], v[80:83], 0
  v_mfma_f32_16x16x32_bf16 v[140:143], v[24:27], v[88:91], 0
  v_mfma_f32_16x16x32_bf16 v[172:175], v[88:91], v[88:91], 0
  v_mfma_f32_16x16x32_bf16 v[144:147], v[24:27], v[96:99], 0
  v_mfma_f32_16x16x32_bf16 v[176:179], v[96:99], v[96:99], 0
  v_mfma_f32_16x16x32_bf16 v[148:151], v[24:27], v[104:107], 0
  v_mfma_f32_16x16x32_bf16 v[180:183], v[104:107], v[104:107], 0
  v_mfma_f32_16x16x32_bf16 v[152:155], v[24:27], v[112:115], 0
  v_mfma_f32_16x16x32_bf16 v[184:187], v[112:115], v[112:115], 0
  v_mfma_f32_16x16x32_bf16 v[156:159], v[24:27], v[120:123], 0
  v_mfma_f32_16x16x32_bf16 v[188:191], v[120:123], v[120:123], 0
  v_mfma_f32_16x16x32_bf16 v[128:131], v[24:27], v[68:71], v[128:131]
  v_mfma_f32_16x16x32_bf16 v[160:163], v[68:71], v[68:71], v[160:163]
  v_mfma_f32_16x16x32_bf16 v[132:135], v[24:27], v[76:79], v[132:135]
  v_mfma_f32_16x16x32_bf16 v[164:167], v[76:79], v[76:79], v[164:167]
  v_mfma_f32_16x16x32_bf16 v[136:139], v[24:27], v[84:87], v[136:139]
  v_mfma_f32_16x16x32_bf16 v[168:171], v[84:87], v[84:87], v[168:171]
  v_mfma_f32_16x16x32_bf16 v[140:143], v[24:27], v[92:95], v[140:143]
  v_mfma_f32_16x16x32_bf16 v[172:175], v[92:95], v[92:95], v[172:175]
  v_mfma_f32_16x16x32_bf16 v[144:147], v[24:27], v[100:103], v[144:147]
  v_mfma_f32_16x16x32_bf16 v[176:179], v[100:103], v[100:103], v[176:179]
  v_mfma_f32_16x16x32_bf16 v[148:151], v[24:27], v[108:111], v[148:151]
  v_mfma_f32_16x16x32_bf16 v[180:183], v[108:111], v[108:111], v[180:183]
  v_mfma_f32_16x16x32_bf16 v[152:155], v[24:27], v[116:119], v[152:155]
  v_mfma_f32_16x16x32_bf16 v[184:187], v[116:119], v[116:119], v[184:187]
  v_mfma_f32_16x16x32_bf16 v[156:159], v[24:27], v[124:127], v[156:159]
  v_mfma_f32_16x16x32_bf16 v[188:191], v[124:127], v[124:127], v[188:191]
  s_setprio 0
  s_cmp_eq_u32 s3, 0
  s_cbranch_scc1 .fz_kernel_hb7
  s_barrier
  s_sub_u32 s3, s3, 1
.fz_kernel_hb7:
  s_mov_b32 exec_lo, 0x100001
  s_mov_b32 exec_hi, 0x10000100
  buffer_load_dword v9, v4, s[12:15], 0 offen sc1
  v_mov_b32 v128, v160
  v_mov_b32 v132, v164
  v_mov_b32 v136, v168
  v_mov_b32 v140, v172
  v_mov_b32 v144, v176
  v_mov_b32 v148, v180
  v_mov_b32 v152, v184
  v_mov_b32 v156, v188
  s_mov_b32 exec_lo, 0x200002
  s_mov_b32 exec_hi, 0x20000200
  v_mov_b32 v128, v161
  v_mov_b32 v132, v165
  v_mov_b32 v136, v169
  v_mov_b32 v140, v173
  v_mov_b32 v144, v177
  v_mov_b32 v148, v181
  v_mov_b32 v152, v185
  v_mov_b32 v156, v189
  s_mov_b32 exec_lo, 0x400004
  s_mov_b32 exec_hi, 0x40000400
  v_mov_b32 v128, v162
  v_mov_b32 v132, v166
  v_mov_b32 v136, v170
  v_mov_b32 v140, v174
  v_mov_b32 v144, v178
  v_mov_b32 v148, v182
  v_mov_b32 v152, v186
  v_mov_b32 v156, v190
  s_cmp_eq_u32 s3, 0
  s_cbranch_scc1 .fz_kernel_hb8
  s_barrier
  s_sub_u32 s3, s3, 1
.fz_kernel_hb8:
  s_mov_b32 exec_lo, 0x800008
  s_mov_b32 exec_hi, 0x80000800
  v_mov_b32 v128, v163
  v_mov_b32 v132, v167
  v_mov_b32 v136, v171
  v_mov_b32 v140, v175
  v_mov_b32 v144, v179
  v_mov_b32 v148, v183
  v_mov_b32 v152, v187
  v_mov_b32 v156, v191
  s_mov_b64 exec, 1
  s_mov_b32 s38, 0
.fz_kernel_pw9:
  s_mov_b32 s46, 0
  s_call_b64 s[0:1], .fz_kernel_hw
  s_waitcnt vmcnt(0)
  v_readfirstlane_b32 s31, v9
  s_cmp_eq_u32 s31, 64
  s_cbranch_scc1 .fz_kernel_pw9d
  s_cmp_eq_u32 s3, 0
  s_cbranch_scc1 .fz_kernel_hb10
  s_barrier
  s_sub_u32 s3, s3, 1
.fz_kernel_hb10:
  s_cmp_eq_u32 s3, 0
  s_cbranch_scc1 .fz_kernel_hb11
  s_barrier
  s_sub_u32 s3, s3, 1
.fz_kernel_hb11:
  buffer_load_dword v9, v4, s[12:15], 0 offen sc1
  s_add_u32 s38, s38, 1
  s_cmp_lt_u32 s38, 131072
  s_cbranch_scc1 .fz_kernel_pw9
  s_waitcnt vmcnt(0)
.fz_kernel_pw9d:
  s_mov_b64 exec, -1
  s_cmp_eq_u32 s3, 0
  s_cbranch_scc1 .fz_kernel_hb12
  s_barrier
  s_sub_u32 s3, s3, 1
.fz_kernel_hb12:
  s_mov_b32 exec_lo, 0x00fff00f
  s_mov_b32 exec_hi, 0xff000ff0
  buffer_atomic_add_f32 v128, v20, s[4:7], s30 offen offset:0 sc1
  buffer_atomic_add_f32 v132, v20, s[4:7], s30 offen offset:128 sc1
  buffer_atomic_add_f32 v136, v20, s[4:7], s30 offen offset:256 sc1
  buffer_atomic_add_f32 v140, v20, s[4:7], s30 offen offset:384 sc1
  buffer_atomic_add_f32 v144, v20, s[4:7], s30 offen offset:512 sc1
  buffer_atomic_add_f32 v148, v20, s[4:7], s30 offen offset:640 sc1
  buffer_atomic_add_f32 v152, v20, s[4:7], s30 offen offset:768 sc1
  buffer_atomic_add_f32 v156, v20, s[4:7], s30 offen offset:896 sc1
  s_mov_b64 exec, -1
  s_mov_b32 s46, 0
  s_call_b64 s[0:1], .fz_kernel_hw
  s_waitcnt vmcnt(0)
  v_lshlrev_b32 v7, 11, v2
  s_lshl_b32 s31, s17, 7
  s_lshl_b32 s33, 1, s18
  s_add_u32 s31, s31, s67
  s_add_u32 s31, s31, 0x1800018
  v_mov_b32 v8, s33
  s_mov_b64 exec, 0xffff
  buffer_atomic_or v8, v7, s[4:7], s31 offen sc1
  s_mov_b64 exec, -1
  s_add_u32 s37, s19, 24
.fz_kernel_f113:
  s_cmp_le_u32 s3, 9
  s_cbranch_scc1 .fz_kernel_f113d
  s_barrier
  s_sub_u32 s3, s3, 1
  s_branch .fz_kernel_f113
.fz_kernel_f113d:
  s_mov_b64 exec, 1
  buffer_load_dword v9, v4, s[4:7], s37 offen sc1
  s_mov_b64 exec, 1
  s_mov_b32 s38, 0
.fz_kernel_pw14:
  s_mov_b32 s46, 0
  s_call_b64 s[0:1], .fz_kernel_hw
  s_waitcnt vmcnt(0)
  v_readfirstlane_b32 s31, v9
  s_cmp_eq_u32 s31, 65535
  s_cbranch_scc1 .fz_kernel_pw14d
  s_cmp_eq_u32 s3, 0
  s_cbranch_scc1 .fz_kernel_hb15
  s_barrier
  s_sub_u32 s3, s3, 1
.fz_kernel_hb15:
  s_cmp_eq_u32 s3, 0
  s_cbranch_scc1 .fz_kernel_hb16
  s_barrier
  s_sub_u32 s3, s3, 1
.fz_kernel_hb16:
  buffer_load_dword v9, v4, s[4:7], s37 offen sc1
  s_add_u32 s38, s38, 1
  s_cmp_lt_u32 s38, 131072
  s_cbranch_scc1 .fz_kernel_pw14
  s_waitcnt vmcnt(0)
.fz_kernel_pw14d:
  s_mov_b64 exec, -1
  buffer_load_dwordx4 v[64:67], v3, s[4:7], s30 offen sc1
  s_mov_b32 s46, 0
  s_call_b64 s[0:1], .fz_kernel_hw
  s_waitcnt vmcnt(0)
  s_cmp_eq_u32 s3, 0
  s_cbranch_scc1 .fz_kernel_hb17
  s_barrier
  s_sub_u32 s3, s3, 1
.fz_kernel_hb17:
  v_mov_b32 v26, 0.0009765625
  v_mul_f32 v20, v26, v64
  v_mul_f32 v27, v20, v20
  v_fma_f32 v22, v65, v26, -v27
  v_max_f32 v22, 0, v22
  v_add_f32 v22, 1e-05, v22
  v_rsq_f32 v22, v22
  s_nop 0
  v_mul_f32 v20, v20, v22
  v_sub_f32 v20, 0, v20
  v_mul_f32 v21, v26, v66
  v_mul_f32 v27, v21, v21
  v_fma_f32 v23, v67, v26, -v27
  v_max_f32 v23, 0, v23
  v_add_f32 v23, 1e-05, v23
  v_rsq_f32 v23, v23
  s_nop 0
  v_mul_f32 v21, v21, v23
  v_sub_f32 v21, 0, v21
  ds_write_b64 v52, v[22:23] offset:4608
  ds_write_b64 v52, v[20:21] offset:5120
  v_mov_b32 v24, 159952
  v_mov_b32 v25, s76
  ds_write_b32 v24, v25 offset:8
  s_waitcnt lgkmcnt(0)
.fz_kernel_q_hw2:
  s_add_u32 s3, s3, 2
.fz_kernel_q_he:
  s_cmp_eq_u32 s3, 0
  s_cbranch_scc1 .fz_kernel_chain
  s_barrier
  s_sub_u32 s3, s3, 1
  s_branch .fz_kernel_q_he
.fz_kernel_q_h7:
  s_mov_b32 s8, s58
  s_mov_b32 s9, s59
  s_mov_b32 s10, 0x100
  s_mov_b32 s11, 0x00020000
  v_mov_b32 v12, 0
  v_mov_b32 v13, 0
  v_mov_b32 v14, 0
  v_mov_b32 v15, 0
  s_cmp_ge_u32 s2, 64
  s_cbranch_scc1 .fz_kernel_q_nzero
  s_lshl_b32 s36, s2, 10
  s_add_u32 s36, s36, 0x1800000
  buffer_store_dwordx4 v[12:15], v3, s[4:7], s36 offen sc1
.fz_kernel_q_nzero:
  v_and_b32 v21, 7, v2
  v_and_b32 v20, 16, v2
  v_lshlrev_b32 v20, 1, v20
  v_xor_b32 v20, v20, v3
  s_bfe_u32 s33, s17, 0x10002
  s_lshl_b32 s33, s33, 1
  s_and_b32 s31, s33, 3
  s_mul_i32 s31, s31, 12288
  s_add_u32 s31, s31, 65536
  v_add_u32 v16, s31, v20
  v_xor_b32 v17, 64, v16
  s_add_u32 s31, s31, 12288
  v_add_u32 v18, s31, v20
  v_xor_b32 v19, 64, v18
  s_sub_u32 s33, 31, s33
  v_lshlrev_b32 v21, 5, v21
  v_and_b32 v22, 24, v2
  v_add_u32 v21, v22, v21
  v_lshrrev_b32 v22, 5, v2
  v_lshl_add_u32 v21, v22, 2, v21
  s_lshl_b32 s30, s18, 10
  s_add_u32 s30, s30, 0x180c000
  v_and_b32 v22, 1, v2
  v_lshlrev_b32 v22, 4, v22
  v_mov_b32 v23, 0x3f80
  v_lshlrev_b32 v22, v22, v23
  v_mov_b32 v24, 0
  v_mov_b32 v25, 0
  v_mov_b32 v26, 0
  v_mov_b32 v27, 0
  s_mov_b32 exec_lo, 0x3030303
  s_mov_b32 exec_hi, 0x3030303
  v_mov_b32 v24, v22
  s_mov_b32 exec_lo, 0xc0c0c0c
  s_mov_b32 exec_hi, 0xc0c0c0c
  v_mov_b32 v25, v22
  s_mov_b32 exec_lo, 0x30303030
  s_mov_b32 exec_hi, 0x30303030
  v_mov_b32 v26, v22
  s_mov_b32 exec_lo, 0xc0c0c0c0
  s_mov_b32 exec_hi, 0xc0c0c0c0
  v_mov_b32 v27, v22
  s_mov_b64 exec, -1
  s_cmp_ge_u32 s2, 64
  s_cbranch_scc1 .fz_kernel_nz2
  s_mov_b64 exec, 1
  s_waitcnt vmcnt(0)
  buffer_atomic_add v5, v4, s[8:11], 0 offen sc1
  s_mov_b64 exec, -1
.fz_kernel_nz2:
  s_barrier
  s_sub_u32 s3, s3, 1
  s_cmp_lg_u32 s3, s33
  s_cbranch_scc1 .fz_kernel_nz2
  ds_read_b128 v[64:67], v16 offset:0
  ds_read_b128 v[68:71], v16 offset:4096
  ds_read_b128 v[72:75], v16 offset:8192
  ds_read_b128 v[76:79], v17 offset:1024
  ds_read_b128 v[80:83], v17 offset:5120
  ds_read_b128 v[84:87], v17 offset:9216
  ds_read_b128 v[88:91], v16 offset:2048
  ds_read_b128 v[92:95], v16 offset:6144
  ds_read_b128 v[96:99], v16 offset:10240
  ds_read_b128 v[100:103], v17 offset:3072
  ds_read_b128 v[104:107], v17 offset:7168
  ds_read_b128 v[108:111], v17 offset:11264
  s_waitcnt lgkmcnt(0)
  s_cmp_eq_u32 s3, 0
  s_cbranch_scc1 .fz_kernel_hb18
  s_barrier
  s_sub_u32 s3, s3, 1
.fz_kernel_hb18:
  ds_read_b128 v[112:115], v18 offset:0
  ds_read_b128 v[116:119], v18 offset:4096
  ds_read_b128 v[120:123], v18 offset:8192
  ds_read_b128 v[124:127], v19 offset:1024
  ds_read_b128 v[128:131], v19 offset:5120
  ds_read_b128 v[132:135], v19 offset:9216
  ds_read_b128 v[136:139], v18 offset:2048
  ds_read_b128 v[140:143], v18 offset:6144
  ds_read_b128 v[144:147], v18 offset:10240
  ds_read_b128 v[148:151], v19 offset:3072
  ds_read_b128 v[152:155], v19 offset:7168
  ds_read_b128 v[156:159], v19 offset:11264
  s_waitcnt lgkmcnt(0)
  s_cmp_eq_u32 s3, 0
  s_cbranch_scc1 .fz_kernel_hb19
  s_barrier
  s_sub_u32 s3, s3, 1
.fz_kernel_hb19:
  s_setprio 2
  v_mfma_f32_16x16x32_bf16 v[160:163], v[24:27], v[64:67], 0
  v_mfma_f32_16x16x32_bf16 v[164:167], v[24:27], v[68:71], 0
  v_mfma_f32_16x16x32_bf16 v[168:171], v[24:27], v[72:75], 0
  v_mfma_f32_16x16x32_bf16 v[160:163], v[24:27], v[76:79], v[160:163]
  v_mfma_f32_16x16x32_bf16 v[164:167], v[24:27], v[80:83], v[164:167]
  v_mfma_f32_16x16x32_bf16 v[168:171], v[24:27], v[84:87], v[168:171]
  v_mfma_f32_16x16x32_bf16 v[160:163], v[24:27], v[88:91], v[160:163]
  v_mfma_f32_16x16x32_bf16 v[164:167], v[24:27], v[92:95], v[164:167]
  v_mfma_f32_16x16x32_bf16 v[168:171], v[24:27], v[96:99], v[168:171]
  v_mfma_f32_16x16x32_bf16 v[160:163], v[24:27], v[100:103], v[160:163]
  v_mfma_f32_16x16x32_bf16 v[164:167], v[24:27], v[104:107], v[164:167]
  v_mfma_f32_16x16x32_bf16 v[168:171], v[24:27], v[108:111], v[168:171]
  v_mfma_f32_16x16x32_bf16 v[160:163], v[24:27], v[112:115], v[160:163]
  v_mfma_f32_16x16x32_bf16 v[164:167], v[24:27], v[116:119], v[164:167]
  v_mfma_f32_16x16x32_bf16 v[168:171], v[24:27], v[120:123], v[168:171]
  v_mfma_f32_16x16x32_bf16 v[160:163], v[24:27], v[124:127], v[160:163]
  v_mfma_f32_16x16x32_bf16 v[164:167], v[24:27], v[128:131], v[164:167]
  v_mfma_f32_16x16x32_bf16 v[168:171], v[24:27], v[132:135], v[168:171]
  v_mfma_f32_16x16x32_bf16 v[160:163], v[24:27], v[136:139], v[160:163]
  v_mfma_f32_16x16x32_bf16 v[164:167], v[24:27], v[140:143], v[164:167]
  v_mfma_f32_16x16x32_bf16 v[168:171], v[24:27], v[144:147], v[168:171]
  v_mfma_f32_16x16x32_bf16 v[160:163], v[24:27], v[148:151], v[160:163]
  v_mfma_f32_16x16x32_bf16 v[164:167], v[24:27], v[152:155], v[164:167]
  v_mfma_f32_16x16x32_bf16 v[168:171], v[24:27], v[156:159], v[168:171]
  s_setprio 0
  s_mov_b64 exec, 1
  buffer_load_dword v9, v4, s[8:11], 0 offen sc1
  s_mov_b64 exec, -1
  s_cmp_eq_u32 s3, 0
  s_cbranch_scc1 .fz_kernel_hb20
  s_barrier
  s_sub_u32 s3, s3, 1
.fz_kernel_hb20:
  v_add_f32 v160, v160, v160 row_ror:8 row_mask:0xf bank_mask:0xf
  v_add_f32 v161, v161, v161 row_ror:8 row_mask:0xf bank_mask:0xf
  v_add_f32 v162, v162, v162 row_ror:8 row_mask:0xf bank_mask:0xf
  v_add_f32 v163, v163, v163 row_ror:8 row_mask:0xf bank_mask:0xf
  v_add_f32 v164, v164, v164 row_ror:8 row_mask:0xf bank_mask:0xf
  v_add_f32 v165, v165, v165 row_ror:8 row_mask:0xf bank_mask:0xf
  v_add_f32 v166, v166, v166 row_ror:8 row_mask:0xf bank_mask:0xf
  v_add_f32 v167, v167, v167 row_ror:8 row_mask:0xf bank_mask:0xf
  v_add_f32 v168, v168, v168 row_ror:8 row_mask:0xf bank_mask:0xf
  v_add_f32 v169, v169, v169 row_ror:8 row_mask:0xf bank_mask:0xf
  v_add_f32 v170, v170, v170 row_ror:8 row_mask:0xf bank_mask:0xf
  v_add_f32 v171, v171, v171 row_ror:8 row_mask:0xf bank_mask:0xf
  s_mov_b32 exec_lo, 0x0
  s_mov_b32 exec_hi, 0xff00ff
  v_mov_b32 v160, v161
  v_mov_b32 v164, v165
  v_mov_b32 v168, v169
  s_mov_b32 exec_lo, 0xff00ff00
  s_mov_b32 exec_hi, 0x0
  v_mov_b32 v160, v162
  v_mov_b32 v164, v166
  v_mov_b32 v168, v170
  s_mov_b32 exec_lo, 0x0
  s_mov_b32 exec_hi, 0xff00ff00
  v_mov_b32 v160, v163
  v_mov_b32 v164, v167
  v_mov_b32 v168, v171
  s_cmp_eq_u32 s3, 0
  s_cbranch_scc1 .fz_kernel_hb21
  s_barrier
  s_sub_u32 s3, s3, 1
.fz_kernel_hb21:
  s_mov_b64 exec, 1
  s_mov_b32 s38, 0
.fz_kernel_pw22:
  s_mov_b32 s46, 0
  s_call_b64 s[0:1], .fz_kernel_hw
  s_waitcnt vmcnt(0)
  v_readfirstlane_b32 s31, v9
  s_cmp_eq_u32 s31, 64
  s_cbranch_scc1 .fz_kernel_pw22d
  s_cmp_eq_u32 s3, 0
  s_cbranch_scc1 .fz_kernel_hb23
  s_barrier
  s_sub_u32 s3, s3, 1
.fz_kernel_hb23:
  s_cmp_eq_u32 s3, 0
  s_cbranch_scc1 .fz_kernel_hb24
  s_barrier
  s_sub_u32 s3, s3, 1
.fz_kernel_hb24:
  buffer_load_dword v9, v4, s[8:11], 0 offen sc1
  s_add_u32 s38, s38, 1
  s_cmp_lt_u32 s38, 131072
  s_cbranch_scc1 .fz_kernel_pw22
  s_waitcnt vmcnt(0)
.fz_kernel_pw22d:
  s_mov_b64 exec, -1
  buffer_atomic_add_f32 v160, v21, s[4:7], s30 offen offset:0 sc1
  buffer_atomic_add_f32 v164, v21, s[4:7], s30 offen offset:256 sc1
  buffer_atomic_add_f32 v168, v21, s[4:7], s30 offen offset:512 sc1
  s_mov_b32 s46, 0
  s_call_b64 s[0:1], .fz_kernel_hw
  s_waitcnt vmcnt(0)
  v_lshlrev_b32 v7, 7, v2
  s_lshl_b32 s31, s18, 11
  s_lshl_b32 s33, 1, s17
  s_add_u32 s31, s31, s67
  s_add_u32 s31, s31, 0x180001c
  v_mov_b32 v8, s33
  s_mov_b64 exec, 0xffff
  buffer_atomic_or v8, v7, s[4:7], s31 offen sc1
  s_mov_b64 exec, -1
  s_cmp_eq_u32 s3, 0
  s_cbranch_scc1 .fz_kernel_hb25
  s_barrier
  s_sub_u32 s3, s3, 1
.fz_kernel_hb25:
  s_cmp_ge_u32 s2, 196
  s_cbranch_scc1 .fz_kernel_lz26
  s_lshl_b32 s36, s2, 12
  s_add_u32 s36, s36, 0x1c00000
  s_sub_u32 s31, s2, 66
  s_min_u32 s31, s31, s2
  s_sub_u32 s31, s31, 4
  s_cmp_lt_u32 s31, 6
  s_cbranch_scc1 .fz_kernel_lz26a
  buffer_store_dwordx4 v[12:15], v3, s[4:7], s36 offen sc1
  buffer_store_dwordx4 v[12:15], v3, s[4:7], s36 offen offset:1024 sc1
  buffer_store_dwordx4 v[12:15], v3, s[4:7], s36 offen offset:2048 sc1
  buffer_store_dwordx4 v[12:15], v3, s[4:7], s36 offen offset:3072 sc1
.fz_kernel_lz26:
  s_add_u32 s37, s19, 28
.fz_kernel_f127:
  s_cmp_le_u32 s3, 9
  s_cbranch_scc1 .fz_kernel_f127d
  s_barrier
  s_sub_u32 s3, s3, 1
  s_branch .fz_kernel_f127
.fz_kernel_f127d:
  s_mov_b64 exec, 1
  buffer_load_dword v9, v4, s[4:7], s37 offen sc1
  s_mov_b64 exec, 1
  s_mov_b32 s38, 0
.fz_kernel_pw28:
  s_mov_b32 s46, 0
  s_call_b64 s[0:1], .fz_kernel_hw
  s_waitcnt vmcnt(0)
  v_readfirstlane_b32 s31, v9
  s_cmp_eq_u32 s31, 65535
  s_cbranch_scc1 .fz_kernel_pw28d
  s_cmp_eq_u32 s3, 0
  s_cbranch_scc1 .fz_kernel_hb29
  s_barrier
  s_sub_u32 s3, s3, 1
.fz_kernel_hb29:
  s_cmp_eq_u32 s3, 0
  s_cbranch_scc1 .fz_kernel_hb30
  s_barrier
  s_sub_u32 s3, s3, 1
.fz_kernel_hb30:
  buffer_load_dword v9, v4, s[4:7], s37 offen sc1
  s_add_u32 s38, s38, 1
  s_cmp_lt_u32 s38, 131072
  s_cbranch_scc1 .fz_kernel_pw28
  s_waitcnt vmcnt(0)
.fz_kernel_pw28d:
  s_mov_b64 exec, -1
  buffer_load_dwordx4 v[64:67], v3, s[4:7], s30 offen sc1
  s_mov_b32 s46, 0
  s_call_b64 s[0:1], .fz_kernel_hw
  s_waitcnt vmcnt(0)
  v_add_u32 v24, 155648, v3
  s_mov_b32 exec_hi, 0xffff
  ds_write_b128 v24, v[64:67] offset:5632
  s_mov_b64 exec, -1
  s_waitcnt lgkmcnt(0)
  s_cmp_eq_u32 s3, 0
  s_cbranch_scc1 .fz_kernel_hb31
  s_barrier
  s_sub_u32 s3, s3, 1
.fz_kernel_hb31:
  s_getpc_b64 s[0:1]
.fz_kernel_ct32:
  s_sub_u32 s0, s0, .fz_kernel_ct32-fz_kernel
  s_subb_u32 s1, s1, 0
  s_lshr_b32 s31, s2, 3
  s_mulk_i32 s31, 0x500
  v_lshl_add_u32 v1, v2, 7, s31
  v_min_u32 v1, .fz_kernel_last-fz_kernel, v1
  s_mov_b64 exec, 0x3ff
  global_load_dword v1, v1, s[0:1]
  s_mov_b64 exec, -1
.fz_kernel_ct32e:
  s_branch .fz_kernel_q_hw2
.fz_kernel_att:
  s_setprio 1
  s_lshl_b32 s34, 1, s17
  s_mov_b32 s36, 0
  v_mfma_f32_32x32x16_bf16 v[48:63], v[80:83], v[16:19], 0
  v_mfma_f32_32x32x16_bf16 v[48:63], v[84:87], v[20:23], v[48:63]
  v_and_b32 v1, 31, v2
  v_lshl_add_u32 v1, v1, 3, s11
  v_mov_b32 v208, 0
  v_mov_b32 v209, 0
  v_mov_b32 v210, 0
  v_mov_b32 v211, 0
  v_mov_b32 v212, 0
  v_mov_b32 v213, 0
  v_mov_b32 v214, 0
  v_mov_b32 v215, 0
  v_mov_b32 v216, 0
  v_mov_b32 v217, 0
  v_mov_b32 v218, 0
  v_mov_b32 v219, 0
  v_mov_b32 v220, 0
  v_mov_b32 v221, 0
  v_mov_b32 v222, 0
  v_mov_b32 v223, 0
  s_waitcnt lgkmcnt(0)
  s_barrier
  ds_read_b128 v[32:35], v9 offset:0
  ds_read_b128 v[36:39], v9 offset:1024
  ds_read_b128 v[40:43], v9 offset:2048
  ds_read_b128 v[44:47], v9 offset:3072
  v_mfma_f32_32x32x16_bf16 v[64:79], v[80:83], v[24:27], 0
  v_exp_f32 v48, v48
  v_exp_f32 v49, v49
  v_exp_f32 v50, v50
  v_exp_f32 v51, v51
  v_exp_f32 v52, v52
  v_exp_f32 v53, v53
  v_exp_f32 v54, v54
  v_exp_f32 v55, v55
  v_mfma_f32_32x32x16_bf16 v[64:79], v[84:87], v[28:31], v[64:79]
  v_cvt_pk_bf16_f32 v224, v48, v49
  v_cvt_pk_bf16_f32 v225, v50, v51
  v_cvt_pk_bf16_f32 v226, v52, v53
  v_cvt_pk_bf16_f32 v227, v54, v55
  v_exp_f32 v56, v56
  v_exp_f32 v57, v57
  v_exp_f32 v58, v58
  v_exp_f32 v59, v59
  v_mfma_f32_32x32x16_bf16 v[144:159], v[88:91], v[224:227], 0
  v_exp_f32 v60, v60
  v_exp_f32 v61, v61
  v_exp_f32 v62, v62
  v_exp_f32 v63, v63
  v_cvt_pk_bf16_f32 v228, v56, v57
  v_cvt_pk_bf16_f32 v229, v58, v59
  v_cvt_pk_bf16_f32 v230, v60, v61
  v_cvt_pk_bf16_f32 v231, v62, v63
  s_waitcnt lgkmcnt(0)
  v_mfma_f32_32x32x16_bf16 v[48:63], v[80:83], v[32:35], 0
  v_exp_f32 v64, v64
  v_exp_f32 v65, v65
  v_exp_f32 v66, v66
  v_exp_f32 v67, v67
  v_mfma_f32_32x32x16_bf16 v[144:159], v[92:95], v[228:231], v[144:159]
  v_exp_f32 v68, v68
  v_exp_f32 v69, v69
  v_exp_f32 v70, v70
  v_smfmac_f32_16x16x64_bf16 v[208:211], v[12:15], v[224:231], v11
  v_exp_f32 v71, v71
  v_mfma_f32_32x32x16_bf16 v[48:63], v[84:87], v[36:39], v[48:63]
  v_cvt_pk_bf16_f32 v224, v64, v65
  v_cvt_pk_bf16_f32 v225, v66, v67
  v_cvt_pk_bf16_f32 v226, v68, v69
  v_cvt_pk_bf16_f32 v227, v70, v71
  v_exp_f32 v72, v72
  v_exp_f32 v73, v73
  v_exp_f32 v74, v74
  v_exp_f32 v75, v75
  v_mfma_f32_32x32x16_bf16 v[160:175], v[88:91], v[224:227], 0
  v_exp_f32 v76, v76
  v_exp_f32 v77, v77
  v_exp_f32 v78, v78
  v_exp_f32 v79, v79
  v_cvt_pk_bf16_f32 v228, v72, v73
  v_cvt_pk_bf16_f32 v229, v74, v75
  v_cvt_pk_bf16_f32 v230, v76, v77
  v_cvt_pk_bf16_f32 v231, v78, v79
  s_mov_b64 exec, 1
  s_waitcnt vmcnt(0)
  ds_add_u32 v6, v5 offset:0x100
  s_mov_b64 exec, -1
  v_mfma_f32_32x32x16_bf16 v[64:79], v[80:83], v[40:43], 0
  v_exp_f32 v48, v48
  v_exp_f32 v49, v49
  v_exp_f32 v50, v50
  v_exp_f32 v51, v51
  v_mfma_f32_32x32x16_bf16 v[160:175], v[92:95], v[228:231], v[160:175]
  v_exp_f32 v52, v52
  v_exp_f32 v53, v53
  v_exp_f32 v54, v54
  v_smfmac_f32_16x16x64_bf16 v[212:215], v[12:15], v[224:231], v11
  v_exp_f32 v55, v55
  v_mfma_f32_32x32x16_bf16 v[64:79], v[84:87], v[44:47], v[64:79]
  v_cvt_pk_bf16_f32 v224, v48, v49
  v_cvt_pk_bf16_f32 v225, v50, v51
  v_cvt_pk_bf16_f32 v226, v52, v53
  v_cvt_pk_bf16_f32 v227, v54, v55
  v_exp_f32 v56, v56
  v_exp_f32 v57, v57
  v_exp_f32 v58, v58
  v_exp_f32 v59, v59
  v_mfma_f32_32x32x16_bf16 v[176:191], v[88:91], v[224:227], 0
  ds_read_b32 v7, v6
  v_exp_f32 v60, v60
  v_exp_f32 v61, v61
  v_exp_f32 v62, v62
  v_exp_f32 v63, v63
  v_cvt_pk_bf16_f32 v228, v56, v57
  v_cvt_pk_bf16_f32 v229, v58, v59
  v_cvt_pk_bf16_f32 v230, v60, v61
  v_cvt_pk_bf16_f32 v231, v62, v63
  s_waitcnt lgkmcnt(0)
  v_readfirstlane_b32 s39, v7
  s_andn2_b32 s33, s39, s34
  s_bcnt1_i32_b32 s31, s33
  s_cmp_ge_u32 s31, 2
  s_cbranch_scc1 .fz_kernel_a_e
  v_mfma_f32_32x32x16_bf16 v[48:63], v[96:99], v[16:19], 0
  v_exp_f32 v64, v64
  v_exp_f32 v65, v65
  v_exp_f32 v66, v66
  v_exp_f32 v67, v67
  v_mfma_f32_32x32x16_bf16 v[176:191], v[92:95], v[228:231], v[176:191]
  v_exp_f32 v68, v68
  v_exp_f32 v69, v69
  v_exp_f32 v70, v70
  v_smfmac_f32_16x16x64_bf16 v[216:219], v[12:15], v[224:231], v11
  v_exp_f32 v71, v71
  v_mfma_f32_32x32x16_bf16 v[48:63], v[100:103], v[20:23], v[48:63]
  v_cvt_pk_bf16_f32 v224, v64, v65
  v_cvt_pk_bf16_f32 v225, v66, v67
  v_cvt_pk_bf16_f32 v226, v68, v69
  v_cvt_pk_bf16_f32 v227, v70, v71
  v_exp_f32 v72, v72
  v_exp_f32 v73, v73
  v_exp_f32 v74, v74
  v_exp_f32 v75, v75
  v_mfma_f32_32x32x16_bf16 v[192:207], v[88:91], v[224:227], 0
  v_exp_f32 v76, v76
  v_exp_f32 v77, v77
  v_exp_f32 v78, v78
  v_exp_f32 v79, v79
  v_cvt_pk_bf16_f32 v228, v72, v73
  v_cvt_pk_bf16_f32 v229, v74, v75
  v_cvt_pk_bf16_f32 v230, v76, v77
  v_cvt_pk_bf16_f32 v231, v78, v79
  v_mfma_f32_32x32x16_bf16 v[64:79], v[96:99], v[24:27], 0
  v_exp_f32 v48, v48
  v_exp_f32 v49, v49
  v_exp_f32 v50, v50
  v_exp_f32 v51, v51
  v_mfma_f32_32x32x16_bf16 v[192:207], v[92:95], v[228:231], v[192:207]
  v_exp_f32 v52, v52
  v_exp_f32 v53, v53
  v_exp_f32 v54, v54
  v_smfmac_f32_16x16x64_bf16 v[220:223], v[12:15], v[224:231], v11
  v_exp_f32 v55, v55
  v_mfma_f32_32x32x16_bf16 v[64:79], v[100:103], v[28:31], v[64:79]
  v_cvt_pk_bf16_f32 v224, v48, v49
  v_cvt_pk_bf16_f32 v225, v50, v51
  v_cvt_pk_bf16_f32 v226, v52, v53
  v_cvt_pk_bf16_f32 v227, v54, v55
  v_exp_f32 v56, v56
  v_exp_f32 v57, v57
  v_exp_f32 v58, v58
  v_exp_f32 v59, v59
  v_mfma_f32_32x32x16_bf16 v[144:159], v[104:107], v[224:227], v[144:159]
  v_exp_f32 v60, v60
  v_exp_f32 v61, v61
  v_exp_f32 v62, v62
  v_exp_f32 v63, v63
  v_cvt_pk_bf16_f32 v228, v56, v57
  v_cvt_pk_bf16_f32 v229, v58, v59
  v_cvt_pk_bf16_f32 v230, v60, v61
  v_cvt_pk_bf16_f32 v231, v62, v63
  v_mfma_f32_32x32x16_bf16 v[48:63], v[96:99], v[32:35], 0
  v_exp_f32 v64, v64
  v_exp_f32 v65, v65
  v_exp_f32 v66, v66
  v_exp_f32 v67, v67
  v_mfma_f32_32x32x16_bf16 v[144:159], v[108:111], v[228:231], v[144:159]
  v_exp_f32 v68, v68
  v_exp_f32 v69, v69
  v_exp_f32 v70, v70
  v_smfmac_f32_16x16x64_bf16 v[208:211], v[12:15], v[224:231], v11
  v_exp_f32 v71, v71
  v_mfma_f32_32x32x16_bf16 v[48:63], v[100:103], v[36:39], v[48:63]
  v_cvt_pk_bf16_f32 v224, v64, v65
  v_cvt_pk_bf16_f32 v225, v66, v67
  v_cvt_pk_bf16_f32 v226, v68, v69
  v_cvt_pk_bf16_f32 v227, v70, v71
  v_exp_f32 v72, v72
  v_exp_f32 v73, v73
  v_exp_f32 v74, v74
  v_exp_f32 v75, v75
  v_mfma_f32_32x32x16_bf16 v[160:175], v[104:107], v[224:227], v[160:175]
  ds_read_b32 v7, v6
  v_exp_f32 v76, v76
  v_exp_f32 v77, v77
  v_exp_f32 v78, v78
  v_exp_f32 v79, v79
  v_cvt_pk_bf16_f32 v228, v72, v73
  v_cvt_pk_bf16_f32 v229, v74, v75
  v_cvt_pk_bf16_f32 v230, v76, v77
  v_cvt_pk_bf16_f32 v231, v78, v79
  s_waitcnt lgkmcnt(0)
  v_readfirstlane_b32 s39, v7
  s_andn2_b32 s39, s39, s34
  s_cbranch_scc0 .fz_kernel_a_p0
  s_ff1_i32_b32 s33, s36
  s_bitset0_b32 s36, s33
  s_lshl_b32 s33, s33, 14
  s_add_u32 s30, s33, s35
  s_cbranch_scc1 .fz_kernel_pk33c
.fz_kernel_pk33:
  buffer_load_dwordx4 v[112:115], v3, s[4:7], s30 offen offset:0
  buffer_load_dwordx4 v[116:119], v3, s[4:7], s30 offen offset:1024
  buffer_load_dwordx4 v[120:123], v3, s[4:7], s30 offen offset:2048
  buffer_load_dwordx4 v[124:127], v3, s[4:7], s30 offen offset:3072
  buffer_load_dwordx4 v[128:131], v10, s[4:7], s30 offen offset:0
  buffer_load_dwordx4 v[132:135], v10, s[4:7], s30 offen offset:1024
  buffer_load_dwordx4 v[136:139], v10, s[4:7], s30 offen offset:2048
  buffer_load_dwordx4 v[140:143], v10, s[4:7], s30 offen offset:3072
.fz_kernel_a_p0:
  v_mfma_f32_32x32x16_bf16 v[64:79], v[96:99], v[40:43], 0
  v_exp_f32 v48, v48
  v_exp_f32 v49, v49
  v_exp_f32 v50, v50
  v_exp_f32 v51, v51
  v_mfma_f32_32x32x16_bf16 v[160:175], v[108:111], v[228:231], v[160:175]
  v_exp_f32 v52, v52
  v_exp_f32 v53, v53
  v_exp_f32 v54, v54
  v_smfmac_f32_16x16x64_bf16 v[212:215], v[12:15], v[224:231], v11
  v_exp_f32 v55, v55
  v_mfma_f32_32x32x16_bf16 v[64:79], v[100:103], v[44:47], v[64:79]
  v_cvt_pk_bf16_f32 v224, v48, v49
  v_cvt_pk_bf16_f32 v225, v50, v51
  v_cvt_pk_bf16_f32 v226, v52, v53
  v_cvt_pk_bf16_f32 v227, v54, v55
  v_exp_f32 v56, v56
  v_exp_f32 v57, v57
  v_exp_f32 v58, v58
  v_exp_f32 v59, v59
  v_mfma_f32_32x32x16_bf16 v[176:191], v[104:107], v[224:227], v[176:191]
  v_exp_f32 v60, v60
  v_exp_f32 v61, v61
  v_exp_f32 v62, v62
  v_exp_f32 v63, v63
  v_cvt_pk_bf16_f32 v228, v56, v57
  v_cvt_pk_bf16_f32 v229, v58, v59
  v_cvt_pk_bf16_f32 v230, v60, v61
  v_cvt_pk_bf16_f32 v231, v62, v63
  v_exp_f32 v64, v64
  v_exp_f32 v65, v65
  v_exp_f32 v66, v66
  v_exp_f32 v67, v67
  v_mfma_f32_32x32x16_bf16 v[176:191], v[108:111], v[228:231], v[176:191]
  v_exp_f32 v68, v68
  v_exp_f32 v69, v69
  v_exp_f32 v70, v70
  v_smfmac_f32_16x16x64_bf16 v[216:219], v[12:15], v[224:231], v11
  v_exp_f32 v71, v71
  v_cvt_pk_bf16_f32 v224, v64, v65
  v_cvt_pk_bf16_f32 v225, v66, v67
  v_cvt_pk_bf16_f32 v226, v68, v69
  v_cvt_pk_bf16_f32 v227, v70, v71
  v_exp_f32 v72, v72
  v_exp_f32 v73, v73
  v_exp_f32 v74, v74
  v_exp_f32 v75, v75
  v_mfma_f32_32x32x16_bf16 v[192:207], v[104:107], v[224:227], v[192:207]
  v_exp_f32 v76, v76
  v_exp_f32 v77, v77
  v_exp_f32 v78, v78
  v_exp_f32 v79, v79
  v_cvt_pk_bf16_f32 v228, v72, v73
  v_cvt_pk_bf16_f32 v229, v74, v75
  v_cvt_pk_bf16_f32 v230, v76, v77
  v_cvt_pk_bf16_f32 v231, v78, v79
  s_cmp_lg_u32 s39, 0
  s_cbranch_scc1 .fz_kernel_a_p1
  s_ff1_i32_b32 s33, s36
  s_bitset0_b32 s36, s33
  s_lshl_b32 s33, s33, 14
  s_add_u32 s30, s33, s35
  s_cbranch_scc1 .fz_kernel_pk34c
.fz_kernel_pk34:
  buffer_load_dwordx4 v[112:115], v3, s[4:7], s30 offen offset:0
  buffer_load_dwordx4 v[116:119], v3, s[4:7], s30 offen offset:1024
  buffer_load_dwordx4 v[120:123], v3, s[4:7], s30 offen offset:2048
  buffer_load_dwordx4 v[124:127], v3, s[4:7], s30 offen offset:3072
  buffer_load_dwordx4 v[128:131], v10, s[4:7], s30 offen offset:0
  buffer_load_dwordx4 v[132:135], v10, s[4:7], s30 offen offset:1024
  buffer_load_dwordx4 v[136:139], v10, s[4:7], s30 offen offset:2048
  buffer_load_dwordx4 v[140:143], v10, s[4:7], s30 offen offset:3072
.fz_kernel_a_p1:
  s_ff1_i32_b32 s33, s36
  s_bitset0_b32 s36, s33
  s_lshl_b32 s33, s33, 14
  s_add_u32 s30, s33, s35
  s_cbranch_scc1 .fz_kernel_pk35c
.fz_kernel_pk35:
  buffer_load_dwordx4 v[80:83], v3, s[4:7], s30 offen offset:0
  buffer_load_dwordx4 v[84:87], v3, s[4:7], s30 offen offset:1024
  buffer_load_dwordx4 v[88:91], v3, s[4:7], s30 offen offset:2048
  buffer_load_dwordx4 v[92:95], v3, s[4:7], s30 offen offset:3072
  buffer_load_dwordx4 v[96:99], v10, s[4:7], s30 offen offset:0
  s_waitcnt vmcnt(11)
  v_mfma_f32_32x32x16_bf16 v[48:63], v[112:115], v[16:19], 0
  v_mfma_f32_32x32x16_bf16 v[48:63], v[116:119], v[20:23], v[48:63]
  s_nop 9
  s_branch .fz_kernel_a_b2
.fz_kernel_a_e:
  s_mov_b32 s36, s33
  s_or_b32 s34, s34, s39
  s_ff1_i32_b32 s33, s36
  s_bitset0_b32 s36, s33
  s_lshl_b32 s33, s33, 14
  s_add_u32 s30, s33, s35
  v_mfma_f32_32x32x16_bf16 v[48:63], v[96:99], v[16:19], 0
  buffer_load_dwordx4 v[112:115], v3, s[4:7], s30 offen offset:0
  v_exp_f32 v64, v64
  v_exp_f32 v65, v65
  v_exp_f32 v66, v66
  v_exp_f32 v67, v67
  v_mfma_f32_32x32x16_bf16 v[176:191], v[92:95], v[228:231], v[176:191]
  buffer_load_dwordx4 v[116:119], v3, s[4:7], s30 offen offset:1024
  v_exp_f32 v68, v68
  v_exp_f32 v69, v69
  v_exp_f32 v70, v70
  v_smfmac_f32_16x16x64_bf16 v[216:219], v[12:15], v[224:231], v11
  buffer_load_dwordx4 v[120:123], v3, s[4:7], s30 offen offset:2048
  v_exp_f32 v71, v71
  v_mfma_f32_32x32x16_bf16 v[48:63], v[100:103], v[20:23], v[48:63]
  buffer_load_dwordx4 v[124:127], v3, s[4:7], s30 offen offset:3072
  v_cvt_pk_bf16_f32 v224, v64, v65
  v_cvt_pk_bf16_f32 v225, v66, v67
  v_cvt_pk_bf16_f32 v226, v68, v69
  v_cvt_pk_bf16_f32 v227, v70, v71
  v_exp_f32 v72, v72
  v_exp_f32 v73, v73
  v_exp_f32 v74, v74
  v_exp_f32 v75, v75
  v_mfma_f32_32x32x16_bf16 v[192:207], v[88:91], v[224:227], 0
  buffer_load_dwordx4 v[128:131], v10, s[4:7], s30 offen offset:0
  v_exp_f32 v76, v76
  v_exp_f32 v77, v77
  v_exp_f32 v78, v78
  v_exp_f32 v79, v79
  v_cvt_pk_bf16_f32 v228, v72, v73
  v_cvt_pk_bf16_f32 v229, v74, v75
  v_cvt_pk_bf16_f32 v230, v76, v77
  v_cvt_pk_bf16_f32 v231, v78, v79
  v_mfma_f32_32x32x16_bf16 v[64:79], v[96:99], v[24:27], 0
  buffer_load_dwordx4 v[132:135], v10, s[4:7], s30 offen offset:1024
  v_exp_f32 v48, v48
  v_exp_f32 v49, v49
  v_exp_f32 v50, v50
  v_exp_f32 v51, v51
  v_mfma_f32_32x32x16_bf16 v[192:207], v[92:95], v[228:231], v[192:207]
  buffer_load_dwordx4 v[136:139], v10, s[4:7], s30 offen offset:2048
  v_exp_f32 v52, v52
  v_exp_f32 v53, v53
  v_exp_f32 v54, v54
  v_smfmac_f32_16x16x64_bf16 v[220:223], v[12:15], v[224:231], v11
  buffer_load_dwordx4 v[140:143], v10, s[4:7], s30 offen offset:3072
  v_exp_f32 v55, v55
  v_mfma_f32_32x32x16_bf16 v[64:79], v[100:103], v[28:31], v[64:79]
  s_ff1_i32_b32 s33, s36
  v_cvt_pk_bf16_f32 v224, v48, v49
  v_cvt_pk_bf16_f32 v225, v50, v51
  v_cvt_pk_bf16_f32 v226, v52, v53
  v_cvt_pk_bf16_f32 v227, v54, v55
  v_exp_f32 v56, v56
  v_exp_f32 v57, v57
  v_exp_f32 v58, v58
  v_exp_f32 v59, v59
  v_mfma_f32_32x32x16_bf16 v[144:159], v[104:107], v[224:227], v[144:159]
  s_bitset0_b32 s36, s33
  v_exp_f32 v60, v60
  v_exp_f32 v61, v61
  v_exp_f32 v62, v62
  v_exp_f32 v63, v63
  v_cvt_pk_bf16_f32 v228, v56, v57
  v_cvt_pk_bf16_f32 v229, v58, v59
  v_cvt_pk_bf16_f32 v230, v60, v61
  v_cvt_pk_bf16_f32 v231, v62, v63
  v_mfma_f32_32x32x16_bf16 v[48:63], v[96:99], v[32:35], 0
  s_lshl_b32 s33, s33, 14
  v_exp_f32 v64, v64
  v_exp_f32 v65, v65
  v_exp_f32 v66, v66
  v_exp_f32 v67, v67
  v_mfma_f32_32x32x16_bf16 v[144:159], v[108:111], v[228:231], v[144:159]
  s_add_u32 s30, s33, s35
  v_exp_f32 v68, v68
  v_exp_f32 v69, v69
  v_exp_f32 v70, v70
  v_smfmac_f32_16x16x64_bf16 v[208:211], v[12:15], v[224:231], v11
  buffer_load_dwordx4 v[80:83], v3, s[4:7], s30 offen offset:0
  v_exp_f32 v71, v71
  v_mfma_f32_32x32x16_bf16 v[48:63], v[100:103], v[36:39], v[48:63]
  buffer_load_dwordx4 v[84:87], v3, s[4:7], s30 offen offset:1024
  v_cvt_pk_bf16_f32 v224, v64, v65
  v_cvt_pk_bf16_f32 v225, v66, v67
  v_cvt_pk_bf16_f32 v226, v68, v69
  v_cvt_pk_bf16_f32 v227, v70, v71
  v_exp_f32 v72, v72
  v_exp_f32 v73, v73
  v_exp_f32 v74, v74
  v_exp_f32 v75, v75
  v_mfma_f32_32x32x16_bf16 v[160:175], v[104:107], v[224:227], v[160:175]
  buffer_load_dwordx4 v[88:91], v3, s[4:7], s30 offen offset:2048
  v_exp_f32 v76, v76
  v_exp_f32 v77, v77
  v_exp_f32 v78, v78
  v_exp_f32 v79, v79
  v_cvt_pk_bf16_f32 v228, v72, v73
  v_cvt_pk_bf16_f32 v229, v74, v75
  v_cvt_pk_bf16_f32 v230, v76, v77
  v_cvt_pk_bf16_f32 v231, v78, v79
  v_mfma_f32_32x32x16_bf16 v[64:79], v[96:99], v[40:43], 0
  buffer_load_dwordx4 v[92:95], v3, s[4:7], s30 offen offset:3072
  v_exp_f32 v48, v48
  v_exp_f32 v49, v49
  v_exp_f32 v50, v50
  v_exp_f32 v51, v51
  v_mfma_f32_32x32x16_bf16 v[160:175], v[108:111], v[228:231], v[160:175]
  v_exp_f32 v52, v52
  v_exp_f32 v53, v53
  v_exp_f32 v54, v54
  v_smfmac_f32_16x16x64_bf16 v[212:215], v[12:15], v[224:231], v11
  v_exp_f32 v55, v55
  v_mfma_f32_32x32x16_bf16 v[64:79], v[100:103], v[44:47], v[64:79]
  v_cvt_pk_bf16_f32 v224, v48, v49
  v_cvt_pk_bf16_f32 v225, v50, v51
  v_cvt_pk_bf16_f32 v226, v52, v53
  v_cvt_pk_bf16_f32 v227, v54, v55
  v_exp_f32 v56, v56
  v_exp_f32 v57, v57
  v_exp_f32 v58, v58
  v_exp_f32 v59, v59
  v_mfma_f32_32x32x16_bf16 v[176:191], v[104:107], v[224:227], v[176:191]
  s_waitcnt vmcnt(10)
  v_exp_f32 v60, v60
  v_exp_f32 v61, v61
  v_exp_f32 v62, v62
  v_exp_f32 v63, v63
  v_cvt_pk_bf16_f32 v228, v56, v57
  v_cvt_pk_bf16_f32 v229, v58, v59
  v_cvt_pk_bf16_f32 v230, v60, v61
  v_cvt_pk_bf16_f32 v231, v62, v63
  v_mfma_f32_32x32x16_bf16 v[48:63], v[112:115], v[16:19], 0
  v_exp_f32 v64, v64
  v_exp_f32 v65, v65
  v_exp_f32 v66, v66
  v_exp_f32 v67, v67
  v_mfma_f32_32x32x16_bf16 v[176:191], v[108:111], v[228:231], v[176:191]
  buffer_load_dwordx4 v[96:99], v10, s[4:7], s30 offen offset:0
  v_exp_f32 v68, v68
  v_exp_f32 v69, v69
  v_exp_f32 v70, v70
  v_smfmac_f32_16x16x64_bf16 v[216:219], v[12:15], v[224:231], v11
  v_exp_f32 v71, v71
  v_mfma_f32_32x32x16_bf16 v[48:63], v[116:119], v[20:23], v[48:63]
  v_cvt_pk_bf16_f32 v224, v64, v65
  v_cvt_pk_bf16_f32 v225, v66, v67
  v_cvt_pk_bf16_f32 v226, v68, v69
  v_cvt_pk_bf16_f32 v227, v70, v71
  v_exp_f32 v72, v72
  v_exp_f32 v73, v73
  v_exp_f32 v74, v74
  v_exp_f32 v75, v75
  v_mfma_f32_32x32x16_bf16 v[192:207], v[104:107], v[224:227], v[192:207]
  v_exp_f32 v76, v76
  v_exp_f32 v77, v77
  v_exp_f32 v78, v78
  v_exp_f32 v79, v79
  v_cvt_pk_bf16_f32 v228, v72, v73
  v_cvt_pk_bf16_f32 v229, v74, v75
  v_cvt_pk_bf16_f32 v230, v76, v77
  v_cvt_pk_bf16_f32 v231, v78, v79
  s_branch .fz_kernel_a_b2
  .p2align 6
.fz_kernel_a_loop:
  v_mfma_f32_32x32x16_bf16 v[64:79], v[80:83], v[24:27], 0
  v_exp_f32 v48, v48
  v_exp_f32 v49, v49
  v_exp_f32 v50, v50
  v_exp_f32 v51, v51
  v_mfma_f32_32x32x16_bf16 v[192:207], v[140:143], v[228:231], v[192:207]
  v_exp_f32 v52, v52
  v_exp_f32 v53, v53
  v_exp_f32 v54, v54
  v_smfmac_f32_16x16x64_bf16 v[220:223], v[12:15], v[224:231], v11
  buffer_load_dwordx4 v[132:135], v10, s[4:7], s30 offen offset:1024
  v_exp_f32 v55, v55
  v_mfma_f32_32x32x16_bf16 v[64:79], v[84:87], v[28:31], v[64:79]
  s_waitcnt vmcnt(10)
  v_cvt_pk_bf16_f32 v224, v48, v49
  v_cvt_pk_bf16_f32 v225, v50, v51
  v_cvt_pk_bf16_f32 v226, v52, v53
  v_cvt_pk_bf16_f32 v227, v54, v55
  v_exp_f32 v56, v56
  v_exp_f32 v57, v57
  v_exp_f32 v58, v58
  v_exp_f32 v59, v59
  v_mfma_f32_32x32x16_bf16 v[144:159], v[88:91], v[224:227], v[144:159]
  v_exp_f32 v60, v60
  v_exp_f32 v61, v61
  v_exp_f32 v62, v62
  v_exp_f32 v63, v63
  v_cvt_pk_bf16_f32 v228, v56, v57
  v_cvt_pk_bf16_f32 v229, v58, v59
  v_cvt_pk_bf16_f32 v230, v60, v61
  v_cvt_pk_bf16_f32 v231, v62, v63
  v_mfma_f32_32x32x16_bf16 v[48:63], v[80:83], v[32:35], 0
  v_exp_f32 v64, v64
  v_exp_f32 v65, v65
  v_exp_f32 v66, v66
  v_exp_f32 v67, v67
  v_mfma_f32_32x32x16_bf16 v[144:159], v[92:95], v[228:231], v[144:159]
  v_exp_f32 v68, v68
  v_exp_f32 v69, v69
  v_exp_f32 v70, v70
  v_smfmac_f32_16x16x64_bf16 v[208:211], v[12:15], v[224:231], v11
  buffer_load_dwordx4 v[136:139], v10, s[4:7], s30 offen offset:2048
  v_exp_f32 v71, v71
  v_mfma_f32_32x32x16_bf16 v[48:63], v[84:87], v[36:39], v[48:63]
  s_ff1_i32_b32 s33, s36
  v_cvt_pk_bf16_f32 v224, v64, v65
  v_cvt_pk_bf16_f32 v225, v66, v67
  v_cvt_pk_bf16_f32 v226, v68, v69
  v_cvt_pk_bf16_f32 v227, v70, v71
  v_exp_f32 v72, v72
  v_exp_f32 v73, v73
  v_exp_f32 v74, v74
  v_exp_f32 v75, v75
  v_mfma_f32_32x32x16_bf16 v[160:175], v[88:91], v[224:227], v[160:175]
  s_bitset0_b32 s36, s33
  v_exp_f32 v76, v76
  v_exp_f32 v77, v77
  v_exp_f32 v78, v78
  v_exp_f32 v79, v79
  v_cvt_pk_bf16_f32 v228, v72, v73
  v_cvt_pk_bf16_f32 v229, v74, v75
  v_cvt_pk_bf16_f32 v230, v76, v77
  v_cvt_pk_bf16_f32 v231, v78, v79
  v_mfma_f32_32x32x16_bf16 v[64:79], v[80:83], v[40:43], 0
  s_lshl_b32 s33, s33, 14
  v_exp_f32 v48, v48
  v_exp_f32 v49, v49
  v_exp_f32 v50, v50
  v_exp_f32 v51, v51
  v_mfma_f32_32x32x16_bf16 v[160:175], v[92:95], v[228:231], v[160:175]
  v_exp_f32 v52, v52
  v_exp_f32 v53, v53
  v_exp_f32 v54, v54
  v_smfmac_f32_16x16x64_bf16 v[212:215], v[12:15], v[224:231], v11
  buffer_load_dwordx4 v[140:143], v10, s[4:7], s30 offen offset:3072
  v_exp_f32 v55, v55
  v_mfma_f32_32x32x16_bf16 v[64:79], v[84:87], v[44:47], v[64:79]
  s_add_u32 s30, s33, s35
  v_cvt_pk_bf16_f32 v224, v48, v49
  v_cvt_pk_bf16_f32 v225, v50, v51
  v_cvt_pk_bf16_f32 v226, v52, v53
  v_cvt_pk_bf16_f32 v227, v54, v55
  v_exp_f32 v56, v56
  v_exp_f32 v57, v57
  v_exp_f32 v58, v58
  v_exp_f32 v59, v59
  v_mfma_f32_32x32x16_bf16 v[176:191], v[88:91], v[224:227], v[176:191]
  s_waitcnt vmcnt(10)
  v_exp_f32 v60, v60
  v_exp_f32 v61, v61
  v_exp_f32 v62, v62
  v_exp_f32 v63, v63
  v_cvt_pk_bf16_f32 v228, v56, v57
  v_cvt_pk_bf16_f32 v229, v58, v59
  v_cvt_pk_bf16_f32 v230, v60, v61
  v_cvt_pk_bf16_f32 v231, v62, v63
  v_mfma_f32_32x32x16_bf16 v[48:63], v[96:99], v[16:19], 0
  s_cbranch_scc1 .fz_kernel_pk38c
.fz_kernel_pk38:
  v_exp_f32 v64, v64
  v_exp_f32 v65, v65
  v_exp_f32 v66, v66
  v_exp_f32 v67, v67
  v_mfma_f32_32x32x16_bf16 v[176:191], v[92:95], v[228:231], v[176:191]
  v_exp_f32 v68, v68
  v_exp_f32 v69, v69
  v_exp_f32 v70, v70
  v_smfmac_f32_16x16x64_bf16 v[216:219], v[12:15], v[224:231], v11
  buffer_load_dwordx4 v[80:83], v3, s[4:7], s30 offen offset:0
  v_exp_f32 v71, v71
  v_mfma_f32_32x32x16_bf16 v[48:63], v[100:103], v[20:23], v[48:63]
  v_cvt_pk_bf16_f32 v224, v64, v65
  v_cvt_pk_bf16_f32 v225, v66, v67
  v_cvt_pk_bf16_f32 v226, v68, v69
  v_cvt_pk_bf16_f32 v227, v70, v71
  v_exp_f32 v72, v72
  v_exp_f32 v73, v73
  v_exp_f32 v74, v74
  v_exp_f32 v75, v75
  v_mfma_f32_32x32x16_bf16 v[192:207], v[88:91], v[224:227], v[192:207]
  v_exp_f32 v76, v76
  v_exp_f32 v77, v77
  v_exp_f32 v78, v78
  v_exp_f32 v79, v79
  v_cvt_pk_bf16_f32 v228, v72, v73
  v_cvt_pk_bf16_f32 v229, v74, v75
  v_cvt_pk_bf16_f32 v230, v76, v77
  v_cvt_pk_bf16_f32 v231, v78, v79
  v_mfma_f32_32x32x16_bf16 v[64:79], v[96:99], v[24:27], 0
  v_exp_f32 v48, v48
  v_exp_f32 v49, v49
  v_exp_f32 v50, v50
  v_exp_f32 v51, v51
  v_mfma_f32_32x32x16_bf16 v[192:207], v[92:95], v[228:231], v[192:207]
  v_exp_f32 v52, v52
  v_exp_f32 v53, v53
  v_exp_f32 v54, v54
  v_smfmac_f32_16x16x64_bf16 v[220:223], v[12:15], v[224:231], v11
  buffer_load_dwordx4 v[84:87], v3, s[4:7], s30 offen offset:1024
  v_exp_f32 v55, v55
  v_mfma_f32_32x32x16_bf16 v[64:79], v[100:103], v[28:31], v[64:79]
  s_waitcnt vmcnt(10)
  v_cvt_pk_bf16_f32 v224, v48, v49
  v_cvt_pk_bf16_f32 v225, v50, v51
  v_cvt_pk_bf16_f32 v226, v52, v53
  v_cvt_pk_bf16_f32 v227, v54, v55
  v_exp_f32 v56, v56
  v_exp_f32 v57, v57
  v_exp_f32 v58, v58
  v_exp_f32 v59, v59
  v_mfma_f32_32x32x16_bf16 v[144:159], v[104:107], v[224:227], v[144:159]
  v_exp_f32 v60, v60
  v_exp_f32 v61, v61
  v_exp_f32 v62, v62
  v_exp_f32 v63, v63
  v_cvt_pk_bf16_f32 v228, v56, v57
  v_cvt_pk_bf16_f32 v229, v58, v59
  v_cvt_pk_bf16_f32 v230, v60, v61
  v_cvt_pk_bf16_f32 v231, v62, v63
  v_mfma_f32_32x32x16_bf16 v[48:63], v[96:99], v[32:35], 0
  v_exp_f32 v64, v64
  v_exp_f32 v65, v65
  v_exp_f32 v66, v66
  v_exp_f32 v67, v67
  v_mfma_f32_32x32x16_bf16 v[144:159], v[108:111], v[228:231], v[144:159]
  v_exp_f32 v68, v68
  v_exp_f32 v69, v69
  v_exp_f32 v70, v70
  v_smfmac_f32_16x16x64_bf16 v[208:211], v[12:15], v[224:231], v11
  buffer_load_dwordx4 v[88:91], v3, s[4:7], s30 offen offset:2048
  v_exp_f32 v71, v71
  v_mfma_f32_32x32x16_bf16 v[48:63], v[100:103], v[36:39], v[48:63]
  v_cvt_pk_bf16_f32 v224, v64, v65
  v_cvt_pk_bf16_f32 v225, v66, v67
  v_cvt_pk_bf16_f32 v226, v68, v69
  v_cvt_pk_bf16_f32 v227, v70, v71
  v_exp_f32 v72, v72
  v_exp_f32 v73, v73
  v_exp_f32 v74, v74
  v_exp_f32 v75, v75
  v_mfma_f32_32x32x16_bf16 v[160:175], v[104:107], v[224:227], v[160:175]
  v_exp_f32 v76, v76
  v_exp_f32 v77, v77
  v_exp_f32 v78, v78
  v_exp_f32 v79, v79
  v_cvt_pk_bf16_f32 v228, v72, v73
  v_cvt_pk_bf16_f32 v229, v74, v75
  v_cvt_pk_bf16_f32 v230, v76, v77
  v_cvt_pk_bf16_f32 v231, v78, v79
  v_mfma_f32_32x32x16_bf16 v[64:79], v[96:99], v[40:43], 0
  v_exp_f32 v48, v48
  v_exp_f32 v49, v49
  v_exp_f32 v50, v50
  v_exp_f32 v51, v51
  v_mfma_f32_32x32x16_bf16 v[160:175], v[108:111], v[228:231], v[160:175]
  v_exp_f32 v52, v52
  v_exp_f32 v53, v53
  v_exp_f32 v54, v54
  v_smfmac_f32_16x16x64_bf16 v[212:215], v[12:15], v[224:231], v11
  buffer_load_dwordx4 v[92:95], v3, s[4:7], s30 offen offset:3072
  v_exp_f32 v55, v55
  v_mfma_f32_32x32x16_bf16 v[64:79], v[100:103], v[44:47], v[64:79]
  v_cvt_pk_bf16_f32 v224, v48, v49
  v_cvt_pk_bf16_f32 v225, v50, v51
  v_cvt_pk_bf16_f32 v226, v52, v53
  v_cvt_pk_bf16_f32 v227, v54, v55
  v_exp_f32 v56, v56
  v_exp_f32 v57, v57
  v_exp_f32 v58, v58
  v_exp_f32 v59, v59
  v_mfma_f32_32x32x16_bf16 v[176:191], v[104:107], v[224:227], v[176:191]
  s_waitcnt vmcnt(10)
  v_exp_f32 v60, v60
  v_exp_f32 v61, v61
  v_exp_f32 v62, v62
  v_exp_f32 v63, v63
  v_cvt_pk_bf16_f32 v228, v56, v57
  v_cvt_pk_bf16_f32 v229, v58, v59
  v_cvt_pk_bf16_f32 v230, v60, v61
  v_cvt_pk_bf16_f32 v231, v62, v63
  v_mfma_f32_32x32x16_bf16 v[48:63], v[112:115], v[16:19], 0
  v_exp_f32 v64, v64
  v_exp_f32 v65, v65
  v_exp_f32 v66, v66
  v_exp_f32 v67, v67
  v_mfma_f32_32x32x16_bf16 v[176:191], v[108:111], v[228:231], v[176:191]
  v_exp_f32 v68, v68
  v_exp_f32 v69, v69
  v_exp_f32 v70, v70
  v_smfmac_f32_16x16x64_bf16 v[216:219], v[12:15], v[224:231], v11
  buffer_load_dwordx4 v[96:99], v10, s[4:7], s30 offen offset:0
  v_exp_f32 v71, v71
  v_mfma_f32_32x32x16_bf16 v[48:63], v[116:119], v[20:23], v[48:63]
  s_sub_u32 s32, s32, 1
  v_cvt_pk_bf16_f32 v224, v64, v65
  v_cvt_pk_bf16_f32 v225, v66, v67
  v_cvt_pk_bf16_f32 v226, v68, v69
  v_cvt_pk_bf16_f32 v227, v70, v71
  v_exp_f32 v72, v72
  v_exp_f32 v73, v73
  v_exp_f32 v74, v74
  v_exp_f32 v75, v75
  v_mfma_f32_32x32x16_bf16 v[192:207], v[104:107], v[224:227], v[192:207]
  s_cmp_eq_u32 s32, 0
  v_exp_f32 v76, v76
  v_exp_f32 v77, v77
  v_exp_f32 v78, v78
  v_exp_f32 v79, v79
  v_cvt_pk_bf16_f32 v228, v72, v73
  v_cvt_pk_bf16_f32 v229, v74, v75
  v_cvt_pk_bf16_f32 v230, v76, v77
  v_cvt_pk_bf16_f32 v231, v78, v79
  s_cbranch_scc1 .fz_kernel_a_x
.fz_kernel_a_b2:
  v_mfma_f32_32x32x16_bf16 v[64:79], v[112:115], v[24:27], 0
  v_exp_f32 v48, v48
  v_exp_f32 v49, v49
  v_exp_f32 v50, v50
  v_exp_f32 v51, v51
  v_mfma_f32_32x32x16_bf16 v[192:207], v[108:111], v[228:231], v[192:207]
  v_exp_f32 v52, v52
  v_exp_f32 v53, v53
  v_exp_f32 v54, v54
  v_smfmac_f32_16x16x64_bf16 v[220:223], v[12:15], v[224:231], v11
  buffer_load_dwordx4 v[100:103], v10, s[4:7], s30 offen offset:1024
  v_exp_f32 v55, v55
  v_mfma_f32_32x32x16_bf16 v[64:79], v[116:119], v[28:31], v[64:79]
  s_waitcnt vmcnt(10)
  v_cvt_pk_bf16_f32 v224, v48, v49
  v_cvt_pk_bf16_f32 v225, v50, v51
  v_cvt_pk_bf16_f32 v226, v52, v53
  v_cvt_pk_bf16_f32 v227, v54, v55
  v_exp_f32 v56, v56
  v_exp_f32 v57, v57
  v_exp_f32 v58, v58
  v_exp_f32 v59, v59
  v_mfma_f32_32x32x16_bf16 v[144:159], v[120:123], v[224:227], v[144:159]
  v_exp_f32 v60, v60
  v_exp_f32 v61, v61
  v_exp_f32 v62, v62
  v_exp_f32 v63, v63
  v_cvt_pk_bf16_f32 v228, v56, v57
  v_cvt_pk_bf16_f32 v229, v58, v59
  v_cvt_pk_bf16_f32 v230, v60, v61
  v_cvt_pk_bf16_f32 v231, v62, v63
  v_mfma_f32_32x32x16_bf16 v[48:63], v[112:115], v[32:35], 0
  v_exp_f32 v64, v64
  v_exp_f32 v65, v65
  v_exp_f32 v66, v66
  v_exp_f32 v67, v67
  v_mfma_f32_32x32x16_bf16 v[144:159], v[124:127], v[228:231], v[144:159]
  v_exp_f32 v68, v68
  v_exp_f32 v69, v69
  v_exp_f32 v70, v70
  v_smfmac_f32_16x16x64_bf16 v[208:211], v[12:15], v[224:231], v11
  buffer_load_dwordx4 v[104:107], v10, s[4:7], s30 offen offset:2048
  v_exp_f32 v71, v71
  v_mfma_f32_32x32x16_bf16 v[48:63], v[116:119], v[36:39], v[48:63]
  s_ff1_i32_b32 s33, s36
  v_cvt_pk_bf16_f32 v224, v64, v65
  v_cvt_pk_bf16_f32 v225, v66, v67
  v_cvt_pk_bf16_f32 v226, v68, v69
  v_cvt_pk_bf16_f32 v227, v70, v71
  v_exp_f32 v72, v72
  v_exp_f32 v73, v73
  v_exp_f32 v74, v74
  v_exp_f32 v75, v75
  v_mfma_f32_32x32x16_bf16 v[160:175], v[120:123], v[224:227], v[160:175]
  s_bitset0_b32 s36, s33
  v_exp_f32 v76, v76
  v_exp_f32 v77, v77
  v_exp_f32 v78, v78
  v_exp_f32 v79, v79
  v_cvt_pk_bf16_f32 v228, v72, v73
  v_cvt_pk_bf16_f32 v229, v74, v75
  v_cvt_pk_bf16_f32 v230, v76, v77
  v_cvt_pk_bf16_f32 v231, v78, v79
  v_mfma_f32_32x32x16_bf16 v[64:79], v[112:115], v[40:43], 0
  s_lshl_b32 s33, s33, 14
  v_exp_f32 v48, v48
  v_exp_f32 v49, v49
  v_exp_f32 v50, v50
  v_exp_f32 v51, v51
  v_mfma_f32_32x32x16_bf16 v[160:175], v[124:127], v[228:231], v[160:175]
  v_exp_f32 v52, v52
  v_exp_f32 v53, v53
  v_exp_f32 v54, v54
  v_smfmac_f32_16x16x64_bf16 v[212:215], v[12:15], v[224:231], v11
  buffer_load_dwordx4 v[108:111], v10, s[4:7], s30 offen offset:3072
  v_exp_f32 v55, v55
  v_mfma_f32_32x32x16_bf16 v[64:79], v[116:119], v[44:47], v[64:79]
  s_add_u32 s30, s33, s35
  v_cvt_pk_bf16_f32 v224, v48, v49
  v_cvt_pk_bf16_f32 v225, v50, v51
  v_cvt_pk_bf16_f32 v226, v52, v53
  v_cvt_pk_bf16_f32 v227, v54, v55
  v_exp_f32 v56, v56
  v_exp_f32 v57, v57
  v_exp_f32 v58, v58
  v_exp_f32 v59, v59
  v_mfma_f32_32x32x16_bf16 v[176:191], v[120:123], v[224:227], v[176:191]
  s_waitcnt vmcnt(10)
  v_exp_f32 v60, v60
  v_exp_f32 v61, v61
  v_exp_f32 v62, v62
  v_exp_f32 v63, v63
  v_cvt_pk_bf16_f32 v228, v56, v57
  v_cvt_pk_bf16_f32 v229, v58, v59
  v_cvt_pk_bf16_f32 v230, v60, v61
  v_cvt_pk_bf16_f32 v231, v62, v63
  v_mfma_f32_32x32x16_bf16 v[48:63], v[128:131], v[16:19], 0
  s_cbranch_scc1 .fz_kernel_pk39c
.fz_kernel_pk39:
  v_exp_f32 v64, v64
  v_exp_f32 v65, v65
  v_exp_f32 v66, v66
  v_exp_f32 v67, v67
  v_mfma_f32_32x32x16_bf16 v[176:191], v[124:127], v[228:231], v[176:191]
  v_exp_f32 v68, v68
  v_exp_f32 v69, v69
  v_exp_f32 v70, v70
  v_smfmac_f32_16x16x64_bf16 v[216:219], v[12:15], v[224:231], v11
  buffer_load_dwordx4 v[112:115], v3, s[4:7], s30 offen offset:0
  v_exp_f32 v71, v71
  v_mfma_f32_32x32x16_bf16 v[48:63], v[132:135], v[20:23], v[48:63]
  v_cvt_pk_bf16_f32 v224, v64, v65
  v_cvt_pk_bf16_f32 v225, v66, v67
  v_cvt_pk_bf16_f32 v226, v68, v69
  v_cvt_pk_bf16_f32 v227, v70, v71
  v_exp_f32 v72, v72
  v_exp_f32 v73, v73
  v_exp_f32 v74, v74
  v_exp_f32 v75, v75
  v_mfma_f32_32x32x16_bf16 v[192:207], v[120:123], v[224:227], v[192:207]
  v_exp_f32 v76, v76
  v_exp_f32 v77, v77
  v_exp_f32 v78, v78
  v_exp_f32 v79, v79
  v_cvt_pk_bf16_f32 v228, v72, v73
  v_cvt_pk_bf16_f32 v229, v74, v75
  v_cvt_pk_bf16_f32 v230, v76, v77
  v_cvt_pk_bf16_f32 v231, v78, v79
  v_mfma_f32_32x32x16_bf16 v[64:79], v[128:131], v[24:27], 0
  v_exp_f32 v48, v48
  v_exp_f32 v49, v49
  v_exp_f32 v50, v50
  v_exp_f32 v51, v51
  v_mfma_f32_32x32x16_bf16 v[192:207], v[124:127], v[228:231], v[192:207]
  v_exp_f32 v52, v52
  v_exp_f32 v53, v53
  v_exp_f32 v54, v54
  v_smfmac_f32_16x16x64_bf16 v[220:223], v[12:15], v[224:231], v11
  buffer_load_dwordx4 v[116:119], v3, s[4:7], s30 offen offset:1024
  v_exp_f32 v55, v55
  v_mfma_f32_32x32x16_bf16 v[64:79], v[132:135], v[28:31], v[64:79]
  s_waitcnt vmcnt(10)
  v_cvt_pk_bf16_f32 v224, v48, v49
  v_cvt_pk_bf16_f32 v225, v50, v51
  v_cvt_pk_bf16_f32 v226, v52, v53
  v_cvt_pk_bf16_f32 v227, v54, v55
  v_exp_f32 v56, v56
  v_exp_f32 v57, v57
  v_exp_f32 v58, v58
  v_exp_f32 v59, v59
  v_mfma_f32_32x32x16_bf16 v[144:159], v[136:139], v[224:227], v[144:159]
  v_exp_f32 v60, v60
  v_exp_f32 v61, v61
  v_exp_f32 v62, v62
  v_exp_f32 v63, v63
  v_cvt_pk_bf16_f32 v228, v56, v57
  v_cvt_pk_bf16_f32 v229, v58, v59
  v_cvt_pk_bf16_f32 v230, v60, v61
  v_cvt_pk_bf16_f32 v231, v62, v63
  v_mfma_f32_32x32x16_bf16 v[48:63], v[128:131], v[32:35], 0
  v_exp_f32 v64, v64
  v_exp_f32 v65, v65
  v_exp_f32 v66, v66
  v_exp_f32 v67, v67
  v_mfma_f32_32x32x16_bf16 v[144:159], v[140:143], v[228:231], v[144:159]
  v_exp_f32 v68, v68
  v_exp_f32 v69, v69
  v_exp_f32 v70, v70
  v_smfmac_f32_16x16x64_bf16 v[208:211], v[12:15], v[224:231], v11
  buffer_load_dwordx4 v[120:123], v3, s[4:7], s30 offen offset:2048
  v_exp_f32 v71, v71
  v_mfma_f32_32x32x16_bf16 v[48:63], v[132:135], v[36:39], v[48:63]
  v_cvt_pk_bf16_f32 v224, v64, v65
  v_cvt_pk_bf16_f32 v225, v66, v67
  v_cvt_pk_bf16_f32 v226, v68, v69
  v_cvt_pk_bf16_f32 v227, v70, v71
  v_exp_f32 v72, v72
  v_exp_f32 v73, v73
  v_exp_f32 v74, v74
  v_exp_f32 v75, v75
  v_mfma_f32_32x32x16_bf16 v[160:175], v[136:139], v[224:227], v[160:175]
  v_exp_f32 v76, v76
  v_exp_f32 v77, v77
  v_exp_f32 v78, v78
  v_exp_f32 v79, v79
  v_cvt_pk_bf16_f32 v228, v72, v73
  v_cvt_pk_bf16_f32 v229, v74, v75
  v_cvt_pk_bf16_f32 v230, v76, v77
  v_cvt_pk_bf16_f32 v231, v78, v79
  v_mfma_f32_32x32x16_bf16 v[64:79], v[128:131], v[40:43], 0
  v_exp_f32 v48, v48
  v_exp_f32 v49, v49
  v_exp_f32 v50, v50
  v_exp_f32 v51, v51
  v_mfma_f32_32x32x16_bf16 v[160:175], v[140:143], v[228:231], v[160:175]
  v_exp_f32 v52, v52
  v_exp_f32 v53, v53
  v_exp_f32 v54, v54
  v_smfmac_f32_16x16x64_bf16 v[212:215], v[12:15], v[224:231], v11
  buffer_load_dwordx4 v[124:127], v3, s[4:7], s30 offen offset:3072
  v_exp_f32 v55, v55
  v_mfma_f32_32x32x16_bf16 v[64:79], v[132:135], v[44:47], v[64:79]
  v_cvt_pk_bf16_f32 v224, v48, v49
  v_cvt_pk_bf16_f32 v225, v50, v51
  v_cvt_pk_bf16_f32 v226, v52, v53
  v_cvt_pk_bf16_f32 v227, v54, v55
  v_exp_f32 v56, v56
  v_exp_f32 v57, v57
  v_exp_f32 v58, v58
  v_exp_f32 v59, v59
  v_mfma_f32_32x32x16_bf16 v[176:191], v[136:139], v[224:227], v[176:191]
  s_waitcnt vmcnt(10)
  v_exp_f32 v60, v60
  v_exp_f32 v61, v61
  v_exp_f32 v62, v62
  v_exp_f32 v63, v63
  v_cvt_pk_bf16_f32 v228, v56, v57
  v_cvt_pk_bf16_f32 v229, v58, v59
  v_cvt_pk_bf16_f32 v230, v60, v61
  v_cvt_pk_bf16_f32 v231, v62, v63
  v_mfma_f32_32x32x16_bf16 v[48:63], v[80:83], v[16:19], 0
  v_exp_f32 v64, v64
  v_exp_f32 v65, v65
  v_exp_f32 v66, v66
  v_exp_f32 v67, v67
  v_mfma_f32_32x32x16_bf16 v[176:191], v[140:143], v[228:231], v[176:191]
  v_exp_f32 v68, v68
  v_exp_f32 v69, v69
  v_exp_f32 v70, v70
  v_smfmac_f32_16x16x64_bf16 v[216:219], v[12:15], v[224:231], v11
  buffer_load_dwordx4 v[128:131], v10, s[4:7], s30 offen offset:0
  v_exp_f32 v71, v71
  v_mfma_f32_32x32x16_bf16 v[48:63], v[84:87], v[20:23], v[48:63]
  v_cvt_pk_bf16_f32 v224, v64, v65
  v_cvt_pk_bf16_f32 v225, v66, v67
  v_cvt_pk_bf16_f32 v226, v68, v69
  v_cvt_pk_bf16_f32 v227, v70, v71
  v_exp_f32 v72, v72
  v_exp_f32 v73, v73
  v_exp_f32 v74, v74
  v_exp_f32 v75, v75
  v_mfma_f32_32x32x16_bf16 v[192:207], v[136:139], v[224:227], v[192:207]
  v_exp_f32 v76, v76
  v_exp_f32 v77, v77
  v_exp_f32 v78, v78
  v_exp_f32 v79, v79
  v_cvt_pk_bf16_f32 v228, v72, v73
  v_cvt_pk_bf16_f32 v229, v74, v75
  v_cvt_pk_bf16_f32 v230, v76, v77
  v_cvt_pk_bf16_f32 v231, v78, v79
  s_branch .fz_kernel_a_loop
.fz_kernel_a_x:
  s_waitcnt vmcnt(7)
  v_mfma_f32_32x32x16_bf16 v[64:79], v[128:131], v[16:19], 0
  v_exp_f32 v48, v48
  v_exp_f32 v49, v49
  v_exp_f32 v50, v50
  v_exp_f32 v51, v51
  v_mfma_f32_32x32x16_bf16 v[192:207], v[108:111], v[228:231], v[192:207]
  v_exp_f32 v52, v52
  v_exp_f32 v53, v53
  v_exp_f32 v54, v54
  v_smfmac_f32_16x16x64_bf16 v[220:223], v[12:15], v[224:231], v11
  v_exp_f32 v55, v55
  v_mfma_f32_32x32x16_bf16 v[64:79], v[132:135], v[20:23], v[64:79]
  s_waitcnt vmcnt(5)
  v_cvt_pk_bf16_f32 v224, v48, v49
  v_cvt_pk_bf16_f32 v225, v50, v51
  v_cvt_pk_bf16_f32 v226, v52, v53
  v_cvt_pk_bf16_f32 v227, v54, v55
  v_exp_f32 v56, v56
  v_exp_f32 v57, v57
  v_exp_f32 v58, v58
  v_exp_f32 v59, v59
  v_mfma_f32_32x32x16_bf16 v[144:159], v[120:123], v[224:227], v[144:159]
  v_exp_f32 v60, v60
  v_exp_f32 v61, v61
  v_exp_f32 v62, v62
  v_exp_f32 v63, v63
  v_cvt_pk_bf16_f32 v228, v56, v57
  v_cvt_pk_bf16_f32 v229, v58, v59
  v_cvt_pk_bf16_f32 v230, v60, v61
  v_cvt_pk_bf16_f32 v231, v62, v63
  v_mfma_f32_32x32x16_bf16 v[48:63], v[112:115], v[24:27], 0
  v_exp_f32 v64, v64
  v_exp_f32 v65, v65
  v_exp_f32 v66, v66
  v_exp_f32 v67, v67
  v_mfma_f32_32x32x16_bf16 v[144:159], v[124:127], v[228:231], v[144:159]
  v_exp_f32 v68, v68
  v_exp_f32 v69, v69
  v_exp_f32 v70, v70
  v_smfmac_f32_16x16x64_bf16 v[208:211], v[12:15], v[224:231], v11
  v_exp_f32 v71, v71
  v_mfma_f32_32x32x16_bf16 v[48:63], v[116:119], v[28:31], v[48:63]
  v_cvt_pk_bf16_f32 v224, v64, v65
  v_cvt_pk_bf16_f32 v225, v66, v67
  v_cvt_pk_bf16_f32 v226, v68, v69
  v_cvt_pk_bf16_f32 v227, v70, v71
  v_exp_f32 v72, v72
  v_exp_f32 v73, v73
  v_exp_f32 v74, v74
  v_exp_f32 v75, v75
  v_mfma_f32_32x32x16_bf16 v[144:159], v[136:139], v[224:227], v[144:159]
  v_exp_f32 v76, v76
  v_exp_f32 v77, v77
  v_exp_f32 v78, v78
  v_exp_f32 v79, v79
  v_cvt_pk_bf16_f32 v228, v72, v73
  v_cvt_pk_bf16_f32 v229, v74, v75
  v_cvt_pk_bf16_f32 v230, v76, v77
  v_cvt_pk_bf16_f32 v231, v78, v79
  v_mfma_f32_32x32x16_bf16 v[64:79], v[128:131], v[24:27], 0
  v_exp_f32 v48, v48
  v_exp_f32 v49, v49
  v_exp_f32 v50, v50
  v_exp_f32 v51, v51
  v_mfma_f32_32x32x16_bf16 v[144:159], v[140:143], v[228:231], v[144:159]
  v_exp_f32 v52, v52
  v_exp_f32 v53, v53
  v_exp_f32 v54, v54
  v_smfmac_f32_16x16x64_bf16 v[208:211], v[12:15], v[224:231], v11
  v_exp_f32 v55, v55
  v_mfma_f32_32x32x16_bf16 v[64:79], v[132:135], v[28:31], v[64:79]
  v_cvt_pk_bf16_f32 v224, v48, v49
  v_cvt_pk_bf16_f32 v225, v50, v51
  v_cvt_pk_bf16_f32 v226, v52, v53
  v_cvt_pk_bf16_f32 v227, v54, v55
  v_exp_f32 v56, v56
  v_exp_f32 v57, v57
  v_exp_f32 v58, v58
  v_exp_f32 v59, v59
  v_mfma_f32_32x32x16_bf16 v[160:175], v[120:123], v[224:227], v[160:175]
  v_exp_f32 v60, v60
  v_exp_f32 v61, v61
  v_exp_f32 v62, v62
  v_exp_f32 v63, v63
  v_cvt_pk_bf16_f32 v228, v56, v57
  v_cvt_pk_bf16_f32 v229, v58, v59
  v_cvt_pk_bf16_f32 v230, v60, v61
  v_cvt_pk_bf16_f32 v231, v62, v63
  v_cvt_pk_bf16_f32 v144, v144, v145
  v_cvt_pk_bf16_f32 v145, v146, v147
  v_cvt_pk_bf16_f32 v146, v148, v149
  v_cvt_pk_bf16_f32 v147, v150, v151
  ds_write_b128 v9, v[144:147] offset:0
  v_cvt_pk_bf16_f32 v148, v152, v153
  v_cvt_pk_bf16_f32 v149, v154, v155
  v_cvt_pk_bf16_f32 v150, v156, v157
  v_cvt_pk_bf16_f32 v151, v158, v159
  ds_write_b128 v9, v[148:151] offset:1024
  v_add_f32 v208, v208, v210
  v_add_f32 v209, v209, v211
  v_cndmask_b32 v30, v208, v209, s[20:21]
  v_mfma_f32_32x32x16_bf16 v[48:63], v[112:115], v[32:35], 0
  v_exp_f32 v64, v64
  v_exp_f32 v65, v65
  v_exp_f32 v66, v66
  v_exp_f32 v67, v67
  v_mfma_f32_32x32x16_bf16 v[160:175], v[124:127], v[228:231], v[160:175]
  v_exp_f32 v68, v68
  v_exp_f32 v69, v69
  v_exp_f32 v70, v70
  v_smfmac_f32_16x16x64_bf16 v[212:215], v[12:15], v[224:231], v11
  v_exp_f32 v71, v71
  v_mfma_f32_32x32x16_bf16 v[48:63], v[116:119], v[36:39], v[48:63]
  v_cvt_pk_bf16_f32 v224, v64, v65
  v_cvt_pk_bf16_f32 v225, v66, v67
  v_cvt_pk_bf16_f32 v226, v68, v69
  v_cvt_pk_bf16_f32 v227, v70, v71
  v_exp_f32 v72, v72
  v_exp_f32 v73, v73
  v_exp_f32 v74, v74
  v_exp_f32 v75, v75
  v_mfma_f32_32x32x16_bf16 v[160:175], v[136:139], v[224:227], v[160:175]
  v_exp_f32 v76, v76
  v_exp_f32 v77, v77
  v_exp_f32 v78, v78
  v_exp_f32 v79, v79
  v_cvt_pk_bf16_f32 v228, v72, v73
  v_cvt_pk_bf16_f32 v229, v74, v75
  v_cvt_pk_bf16_f32 v230, v76, v77
  v_cvt_pk_bf16_f32 v231, v78, v79
  v_mfma_f32_32x32x16_bf16 v[64:79], v[128:131], v[32:35], 0
  v_exp_f32 v48, v48
  v_exp_f32 v49, v49
  v_exp_f32 v50, v50
  v_exp_f32 v51, v51
  v_mfma_f32_32x32x16_bf16 v[160:175], v[140:143], v[228:231], v[160:175]
  v_exp_f32 v52, v52
  v_exp_f32 v53, v53
  v_exp_f32 v54, v54
  v_smfmac_f32_16x16x64_bf16 v[212:215], v[12:15], v[224:231], v11
  v_exp_f32 v55, v55
  v_mfma_f32_32x32x16_bf16 v[64:79], v[132:135], v[36:39], v[64:79]
  v_cvt_pk_bf16_f32 v224, v48, v49
  v_cvt_pk_bf16_f32 v225, v50, v51
  v_cvt_pk_bf16_f32 v226, v52, v53
  v_cvt_pk_bf16_f32 v227, v54, v55
  v_exp_f32 v56, v56
  v_exp_f32 v57, v57
  v_exp_f32 v58, v58
  v_exp_f32 v59, v59
  v_mfma_f32_32x32x16_bf16 v[176:191], v[120:123], v[224:227], v[176:191]
  v_exp_f32 v60, v60
  v_exp_f32 v61, v61
  v_exp_f32 v62, v62
  v_exp_f32 v63, v63
  v_cvt_pk_bf16_f32 v228, v56, v57
  v_cvt_pk_bf16_f32 v229, v58, v59
  v_cvt_pk_bf16_f32 v230, v60, v61
  v_cvt_pk_bf16_f32 v231, v62, v63
  v_cvt_pk_bf16_f32 v160, v160, v161
  v_cvt_pk_bf16_f32 v161, v162, v163
  v_cvt_pk_bf16_f32 v162, v164, v165
  v_cvt_pk_bf16_f32 v163, v166, v167
  ds_write_b128 v9, v[160:163] offset:2048
  v_cvt_pk_bf16_f32 v164, v168, v169
  v_cvt_pk_bf16_f32 v165, v170, v171
  v_cvt_pk_bf16_f32 v166, v172, v173
  v_cvt_pk_bf16_f32 v167, v174, v175
  ds_write_b128 v9, v[164:167] offset:3072
  v_add_f32 v212, v212, v214
  v_add_f32 v213, v213, v215
  v_cndmask_b32 v31, v212, v213, s[20:21]
  ds_write_b64 v1, v[30:31]
  v_xor_b32 v1, 512, v1
  v_mfma_f32_32x32x16_bf16 v[48:63], v[112:115], v[40:43], 0
  v_exp_f32 v64, v64
  v_exp_f32 v65, v65
  v_exp_f32 v66, v66
  v_exp_f32 v67, v67
  v_mfma_f32_32x32x16_bf16 v[176:191], v[124:127], v[228:231], v[176:191]
  v_exp_f32 v68, v68
  v_exp_f32 v69, v69
  v_exp_f32 v70, v70
  v_smfmac_f32_16x16x64_bf16 v[216:219], v[12:15], v[224:231], v11
  s_waitcnt vmcnt(0) lgkmcnt(0)
  s_barrier
  ds_read_b128 v[80:83], v8 offset:0
  ds_read_b128 v[84:87], v8 offset:1024
  ds_read_b128 v[88:91], v8 offset:2048
  ds_read_b128 v[92:95], v8 offset:3072
  ds_read_b64 v[30:31], v1
  v_exp_f32 v71, v71
  v_mfma_f32_32x32x16_bf16 v[48:63], v[116:119], v[44:47], v[48:63]
  v_cvt_pk_bf16_f32 v224, v64, v65
  v_cvt_pk_bf16_f32 v225, v66, v67
  v_cvt_pk_bf16_f32 v226, v68, v69
  v_cvt_pk_bf16_f32 v227, v70, v71
  v_exp_f32 v72, v72
  v_exp_f32 v73, v73
  v_exp_f32 v74, v74
  v_exp_f32 v75, v75
  v_mfma_f32_32x32x16_bf16 v[176:191], v[136:139], v[224:227], v[176:191]
  v_exp_f32 v76, v76
  v_exp_f32 v77, v77
  s_waitcnt lgkmcnt(0)
  v_mfma_f32_32x32x16_bf16 v[176:191], v[248:251], v[80:83], v[176:191]
  v_exp_f32 v78, v78
  v_exp_f32 v79, v79
  v_mfma_f32_32x32x16_bf16 v[176:191], v[252:255], v[84:87], v[176:191]
  v_cvt_pk_bf16_f32 v228, v72, v73
  v_cvt_pk_bf16_f32 v229, v74, v75
  v_cvt_pk_bf16_f32 v230, v76, v77
  v_cvt_pk_bf16_f32 v231, v78, v79
  v_mfma_f32_32x32x16_bf16 v[64:79], v[128:131], v[40:43], 0
  v_exp_f32 v48, v48
  v_exp_f32 v49, v49
  v_exp_f32 v50, v50
  v_exp_f32 v51, v51
  v_mfma_f32_32x32x16_bf16 v[176:191], v[140:143], v[228:231], v[176:191]
  v_exp_f32 v52, v52
  v_exp_f32 v53, v53
  v_exp_f32 v54, v54
  v_smfmac_f32_16x16x64_bf16 v[216:219], v[12:15], v[224:231], v11
  v_exp_f32 v55, v55
  v_mfma_f32_32x32x16_bf16 v[64:79], v[132:135], v[44:47], v[64:79]
  v_cvt_pk_bf16_f32 v224, v48, v49
  v_cvt_pk_bf16_f32 v225, v50, v51
  v_cvt_pk_bf16_f32 v226, v52, v53
  v_cvt_pk_bf16_f32 v227, v54, v55
  v_exp_f32 v56, v56
  v_exp_f32 v57, v57
  v_exp_f32 v58, v58
  v_exp_f32 v59, v59
  s_nop 1
  v_add_f32 v216, v216, v218
  v_add_f32 v217, v217, v219
  v_cndmask_b32 v24, v216, v217, s[20:21]
  v_add_f32 v24, v24, v30
  s_mov_b64 s[36:37], -1
  v_rcp_f32 v26, v24
  v_cmp_le_f32 vcc, s24, v24
  s_and_b64 s[36:37], s[36:37], vcc
  v_cmp_ge_f32 vcc, s25, v24
  s_and_b64 s[36:37], s[36:37], vcc
  v_pk_mul_f32 v[176:177], v[176:177], v[26:27] op_sel_hi:[1,0]
  v_pk_mul_f32 v[178:179], v[178:179], v[26:27] op_sel_hi:[1,0]
  v_pk_mul_f32 v[180:181], v[180:181], v[26:27] op_sel_hi:[1,0]
  v_pk_mul_f32 v[182:183], v[182:183], v[26:27] op_sel_hi:[1,0]
  v_cvt_pk_bf16_f32 v80, v176, v177
  v_cvt_pk_bf16_f32 v81, v178, v179
  v_cvt_pk_bf16_f32 v82, v180, v181
  v_cvt_pk_bf16_f32 v83, v182, v183
  buffer_store_dwordx4 v[80:83], v3, s[4:7], s8 offen offset:0 sc1
  v_pk_mul_f32 v[184:185], v[184:185], v[26:27] op_sel_hi:[1,0]
  v_pk_mul_f32 v[186:187], v[186:187], v[26:27] op_sel_hi:[1,0]
  v_pk_mul_f32 v[188:189], v[188:189], v[26:27] op_sel_hi:[1,0]
  v_pk_mul_f32 v[190:191], v[190:191], v[26:27] op_sel_hi:[1,0]
  v_cvt_pk_bf16_f32 v84, v184, v185
  v_cvt_pk_bf16_f32 v85, v186, v187
  v_cvt_pk_bf16_f32 v86, v188, v189
  v_cvt_pk_bf16_f32 v87, v190, v191
  buffer_store_dwordx4 v[84:87], v3, s[4:7], s8 offen offset:1024 sc1
  v_mfma_f32_32x32x16_bf16 v[192:207], v[120:123], v[224:227], v[192:207]
  v_exp_f32 v60, v60
  v_exp_f32 v61, v61
  v_exp_f32 v62, v62
  v_exp_f32 v63, v63
  v_cvt_pk_bf16_f32 v228, v56, v57
  v_cvt_pk_bf16_f32 v229, v58, v59
  v_cvt_pk_bf16_f32 v230, v60, v61
  v_cvt_pk_bf16_f32 v231, v62, v63
  v_mfma_f32_32x32x16_bf16 v[192:207], v[248:251], v[88:91], v[192:207]
  v_exp_f32 v64, v64
  v_exp_f32 v65, v65
  v_exp_f32 v66, v66
  v_exp_f32 v67, v67
  v_mfma_f32_32x32x16_bf16 v[192:207], v[124:127], v[228:231], v[192:207]
  v_exp_f32 v68, v68
  v_exp_f32 v69, v69
  v_exp_f32 v70, v70
  v_smfmac_f32_16x16x64_bf16 v[220:223], v[12:15], v[224:231], v11
  v_exp_f32 v71, v71
  v_mfma_f32_32x32x16_bf16 v[192:207], v[252:255], v[92:95], v[192:207]
  v_cvt_pk_bf16_f32 v224, v64, v65
  v_cvt_pk_bf16_f32 v225, v66, v67
  v_cvt_pk_bf16_f32 v226, v68, v69
  v_cvt_pk_bf16_f32 v227, v70, v71
  v_exp_f32 v72, v72
  v_exp_f32 v73, v73
  v_exp_f32 v74, v74
  v_exp_f32 v75, v75
  v_mfma_f32_32x32x16_bf16 v[192:207], v[136:139], v[224:227], v[192:207]
  v_exp_f32 v76, v76
  v_exp_f32 v77, v77
  v_exp_f32 v78, v78
  v_exp_f32 v79, v79
  v_cvt_pk_bf16_f32 v228, v72, v73
  v_cvt_pk_bf16_f32 v229, v74, v75
  v_cvt_pk_bf16_f32 v230, v76, v77
  v_cvt_pk_bf16_f32 v231, v78, v79
  s_nop 1
  v_smfmac_f32_16x16x64_bf16 v[220:223], v[12:15], v[224:231], v11
  v_mfma_f32_32x32x16_bf16 v[192:207], v[140:143], v[228:231], v[192:207]
  s_nop 10
  v_add_f32 v220, v220, v222
  v_add_f32 v221, v221, v223
  v_cndmask_b32 v25, v220, v221, s[20:21]
  v_add_f32 v25, v25, v31
.fz_kernel_a_fin:
  v_rcp_f32 v28, v25
  v_cmp_le_f32 vcc, s24, v25
  s_and_b64 s[36:37], s[36:37], vcc
  v_cmp_ge_f32 vcc, s25, v25
  s_and_b64 s[36:37], s[36:37], vcc
  v_pk_mul_f32 v[192:193], v[192:193], v[28:29] op_sel_hi:[1,0]
  v_pk_mul_f32 v[194:195], v[194:195], v[28:29] op_sel_hi:[1,0]
  v_pk_mul_f32 v[196:197], v[196:197], v[28:29] op_sel_hi:[1,0]
  v_pk_mul_f32 v[198:199], v[198:199], v[28:29] op_sel_hi:[1,0]
  v_cvt_pk_bf16_f32 v88, v192, v193
  v_cvt_pk_bf16_f32 v89, v194, v195
  v_cvt_pk_bf16_f32 v90, v196, v197
  v_cvt_pk_bf16_f32 v91, v198, v199
  buffer_store_dwordx4 v[88:91], v3, s[4:7], s9 offen offset:0 sc1
  v_pk_mul_f32 v[200:201], v[200:201], v[28:29] op_sel_hi:[1,0]
  v_pk_mul_f32 v[202:203], v[202:203], v[28:29] op_sel_hi:[1,0]
  v_pk_mul_f32 v[204:205], v[204:205], v[28:29] op_sel_hi:[1,0]
  v_pk_mul_f32 v[206:207], v[206:207], v[28:29] op_sel_hi:[1,0]
  v_cvt_pk_bf16_f32 v92, v200, v201
  v_cvt_pk_bf16_f32 v93, v202, v203
  v_cvt_pk_bf16_f32 v94, v204, v205
  v_cvt_pk_bf16_f32 v95, v206, v207
  buffer_store_dwordx4 v[92:95], v3, s[4:7], s9 offen offset:1024 sc1
  ds_read_b32 v7, v6 offset:8
  v_pk_fma_f32 v[64:65], v[176:177], 0, 0 op_sel_hi:[1,0,0]
  v_pk_fma_f32 v[66:67], v[178:179], 0, 0 op_sel_hi:[1,0,0]
  v_pk_fma_f32 v[64:65], v[180:181], 0, v[64:65] op_sel_hi:[1,0,1]
  v_pk_fma_f32 v[66:67], v[182:183], 0, v[66:67] op_sel_hi:[1,0,1]
  v_pk_fma_f32 v[64:65], v[184:185], 0, v[64:65] op_sel_hi:[1,0,1]
  v_pk_fma_f32 v[66:67], v[186:187], 0, v[66:67] op_sel_hi:[1,0,1]
  v_pk_fma_f32 v[64:65], v[188:189], 0, v[64:65] op_sel_hi:[1,0,1]
  v_pk_fma_f32 v[66:67], v[190:191], 0, v[66:67] op_sel_hi:[1,0,1]
  v_pk_fma_f32 v[64:65], v[192:193], 0, v[64:65] op_sel_hi:[1,0,1]
  v_pk_fma_f32 v[66:67], v[194:195], 0, v[66:67] op_sel_hi:[1,0,1]
  v_pk_fma_f32 v[64:65], v[196:197], 0, v[64:65] op_sel_hi:[1,0,1]
  v_pk_fma_f32 v[66:67], v[198:199], 0, v[66:67] op_sel_hi:[1,0,1]
  v_pk_fma_f32 v[64:65], v[200:201], 0, v[64:65] op_sel_hi:[1,0,1]
  v_pk_fma_f32 v[66:67], v[202:203], 0, v[66:67] op_sel_hi:[1,0,1]
  v_pk_fma_f32 v[64:65], v[204:205], 0, v[64:65] op_sel_hi:[1,0,1]
  v_pk_fma_f32 v[66:67], v[206:207], 0, v[66:67] op_sel_hi:[1,0,1]
  v_pk_add_f32 v[64:65], v[64:65], v[66:67]
  v_cmp_o_f32 vcc, v64, v65
  s_and_b64 s[36:37], s[36:37], vcc
  s_cmp_eq_u64 s[36:37], -1
  s_cbranch_scc0 .fz_kernel_a_slow
.fz_kernel_a_ok:
  s_mov_b32 s8, s48
  s_mov_b32 s9, s49
  s_mov_b32 s10, 0x800
  s_mov_b32 s11, 0x00020000
  v_lshrrev_b32 v17, 5, v2
  v_lshlrev_b32 v19, 4, v17
  s_lshl_b32 s22, s18, 7
  s_lshl2_add_u32 s32, s17, s16
  s_lshl_b32 s35, s32, 16
  s_add_u32 s35, s35, s64
  v_add_u32 v8, s35, v3
  v_add_u32 v6, 8, v6
  buffer_load_dwordx4 v[48:51], v19, s[8:11], s22 offen offset:0
  buffer_load_dwordx4 v[52:55], v19, s[8:11], s22 offen offset:32
  buffer_load_dwordx4 v[56:59], v19, s[8:11], s22 offen offset:64
  buffer_load_dwordx4 v[60:63], v19, s[8:11], s22 offen offset:96
  s_waitcnt lgkmcnt(0)
  v_readfirstlane_b32 s36, v7
  s_mov_b32 s34, s36
  s_bcnt1_i32_b32 s29, s36
  s_cmp_lt_u32 s29, 2
  s_cbranch_scc1 .fz_kernel_w_e0
  s_cmp_eq_u32 s36, 0
  s_cbranch_scc1 .fz_kernel_pk48c
.fz_kernel_pk48:
  s_ff1_i32_b32 s33, s36
  s_bitset0_b32 s36, s33
  s_lshl_b32 s20, s33, 12
  buffer_load_dwordx4 v[96:99], v8, s[4:7], s20 offen offset:0
  buffer_load_dwordx4 v[100:103], v8, s[4:7], s20 offen offset:1024
  buffer_load_dwordx4 v[104:107], v8, s[4:7], s20 offen offset:2048
  buffer_load_dwordx4 v[108:111], v8, s[4:7], s20 offen offset:3072
  s_cmp_eq_u32 s36, 0
  s_cbranch_scc1 .fz_kernel_pk49c
.fz_kernel_pk49:
  s_ff1_i32_b32 s33, s36
  s_bitset0_b32 s36, s33
  s_lshl_b32 s21, s33, 12
  buffer_load_dwordx4 v[112:115], v8, s[4:7], s21 offen offset:0
  buffer_load_dwordx4 v[116:119], v8, s[4:7], s21 offen offset:1024
  buffer_load_dwordx4 v[120:123], v8, s[4:7], s21 offen offset:2048
  buffer_load_dwordx4 v[124:127], v8, s[4:7], s21 offen offset:3072
.fz_kernel_w_e0:
  v_and_b32 v18, 31, v2
  s_lshl_b32 s39, s17, 4
  s_add_u32 s39, s39, s18
  s_lshl_b32 s39, s39, 2
  s_add_u32 s39, s39, s16
  s_lshl_b32 s39, s39, 12
  v_and_b32 v16, 16, v2
  v_lshlrev_b32 v16, 7, v16
  v_lshl_add_u32 v16, v17, 8, v16
  v_and_b32 v1, 0xf0, v3
  v_add_u32 v16, v16, v1
  s_add_u32 s39, s39, s65
  s_lshl_b32 s31, s16, 5
  v_add_u32 v45, s31, v18
  v_lshlrev_b32 v11, 2, v45
  v_add_u32 v11, 155648, v11
  v_mov_b32 v44, 159952
  ds_read_b32 v40, v11 offset:6400
  ds_read_b32 v42, v11 offset:6912
  ds_read_b32 v46, v44 offset:8
  ds_read_b32 v44, v44
  v_mov_b32 v47, 0.32768
  v_add_u32 v45, 1, v45
  v_bfe_u32 v11, v2, 2, 2
  v_lshl_add_u32 v12, v17, 2, v11
  v_lshlrev_b32 v12, 7, v12
  v_lshrrev_b32 v13, 1, v11
  v_lshl_add_u32 v12, v13, 6, v12
  v_bfe_u32 v13, v2, 4, 1
  v_lshl_add_u32 v12, v13, 5, v12
  v_and_b32 v13, 1, v2
  v_lshl_add_u32 v12, v13, 4, v12
  v_bfe_u32 v13, v2, 1, 1
  v_lshl_add_u32 v14, v13, 3, v12
  v_xor_b32 v15, 64, v14
  s_mov_b64 exec, 1
  s_cmp_lt_u32 s29, 2
  s_cbranch_scc1 .fz_kernel_w_e1
  s_waitcnt vmcnt(12)
  s_branch .fz_kernel_w_e3
.fz_kernel_w_e1:
  s_waitcnt vmcnt(4)
.fz_kernel_w_e3:
  ds_add_u32 v6, v5 offset:0x100
  s_mov_b64 exec, -1
  v_lshlrev_b32 v64, 16, v232
  v_and_b32 v65, 0xffff0000, v232
  v_lshlrev_b32 v66, 16, v233
  v_and_b32 v67, 0xffff0000, v233
  v_lshlrev_b32 v68, 16, v234
  v_and_b32 v69, 0xffff0000, v234
  v_lshlrev_b32 v70, 16, v235
  v_and_b32 v71, 0xffff0000, v235
  v_lshlrev_b32 v72, 16, v236
  v_and_b32 v73, 0xffff0000, v236
  v_lshlrev_b32 v74, 16, v237
  v_and_b32 v75, 0xffff0000, v237
  v_lshlrev_b32 v76, 16, v238
  v_and_b32 v77, 0xffff0000, v238
  v_lshlrev_b32 v78, 16, v239
  v_and_b32 v79, 0xffff0000, v239
  v_lshlrev_b32 v80, 16, v240
  v_and_b32 v81, 0xffff0000, v240
  v_lshlrev_b32 v82, 16, v241
  v_and_b32 v83, 0xffff0000, v241
  v_lshlrev_b32 v84, 16, v242
  v_and_b32 v85, 0xffff0000, v242
  v_lshlrev_b32 v86, 16, v243
  v_and_b32 v87, 0xffff0000, v243
  v_lshlrev_b32 v88, 16, v244
  v_and_b32 v89, 0xffff0000, v244
  v_lshlrev_b32 v90, 16, v245
  v_and_b32 v91, 0xffff0000, v245
  v_lshlrev_b32 v92, 16, v246
  v_and_b32 v93, 0xffff0000, v246
  v_lshlrev_b32 v94, 16, v247
  v_and_b32 v95, 0xffff0000, v247
  s_waitcnt lgkmcnt(0)
  v_pk_fma_f32 v[64:65], v[64:65], v[40:41], v[42:43] op_sel_hi:[1,0,0]
  v_pk_fma_f32 v[66:67], v[66:67], v[40:41], v[42:43] op_sel_hi:[1,0,0]
  v_pk_fma_f32 v[68:69], v[68:69], v[40:41], v[42:43] op_sel_hi:[1,0,0]
  v_pk_fma_f32 v[70:71], v[70:71], v[40:41], v[42:43] op_sel_hi:[1,0,0]
  v_pk_fma_f32 v[72:73], v[72:73], v[40:41], v[42:43] op_sel_hi:[1,0,0]
  v_pk_fma_f32 v[74:75], v[74:75], v[40:41], v[42:43] op_sel_hi:[1,0,0]
  v_pk_fma_f32 v[76:77], v[76:77], v[40:41], v[42:43] op_sel_hi:[1,0,0]
  v_pk_fma_f32 v[78:79], v[78:79], v[40:41], v[42:43] op_sel_hi:[1,0,0]
  v_pk_fma_f32 v[80:81], v[80:81], v[40:41], v[42:43] op_sel_hi:[1,0,0]
  v_pk_fma_f32 v[82:83], v[82:83], v[40:41], v[42:43] op_sel_hi:[1,0,0]
  v_pk_fma_f32 v[84:85], v[84:85], v[40:41], v[42:43] op_sel_hi:[1,0,0]
  v_pk_fma_f32 v[86:87], v[86:87], v[40:41], v[42:43] op_sel_hi:[1,0,0]
  v_pk_fma_f32 v[88:89], v[88:89], v[40:41], v[42:43] op_sel_hi:[1,0,0]
  v_pk_fma_f32 v[90:91], v[90:91], v[40:41], v[42:43] op_sel_hi:[1,0,0]
  v_pk_fma_f32 v[92:93], v[92:93], v[40:41], v[42:43] op_sel_hi:[1,0,0]
  v_pk_fma_f32 v[94:95], v[94:95], v[40:41], v[42:43] op_sel_hi:[1,0,0]
  v_cmp_eq_u32 vcc, v44, v45
  s_cbranch_vccnz .fz_kernel_w_pt
.fz_kernel_w_pb:
  s_cmp_ge_u32 s29, 2
  s_cbranch_scc1 .fz_kernel_w_e2
  s_cmp_eq_u32 s36, 0
  s_cbranch_scc1 .fz_kernel_pk50c
.fz_kernel_pk50:
  s_ff1_i32_b32 s33, s36
  s_bitset0_b32 s36, s33
  s_lshl_b32 s20, s33, 12
  buffer_load_dwordx4 v[96:99], v8, s[4:7], s20 offen offset:0
  buffer_load_dwordx4 v[100:103], v8, s[4:7], s20 offen offset:1024
  buffer_load_dwordx4 v[104:107], v8, s[4:7], s20 offen offset:2048
  buffer_load_dwordx4 v[108:111], v8, s[4:7], s20 offen offset:3072
  s_cmp_eq_u32 s36, 0
  s_cbranch_scc1 .fz_kernel_pk51c
.fz_kernel_pk51:
  s_ff1_i32_b32 s33, s36
  s_bitset0_b32 s36, s33
  s_lshl_b32 s21, s33, 12
  buffer_load_dwordx4 v[112:115], v8, s[4:7], s21 offen offset:0
  buffer_load_dwordx4 v[116:119], v8, s[4:7], s21 offen offset:1024
  buffer_load_dwordx4 v[120:123], v8, s[4:7], s21 offen offset:2048
  buffer_load_dwordx4 v[124:127], v8, s[4:7], s21 offen offset:3072
.fz_kernel_w_e2:
  s_cmp_eq_u32 s36, 0
  s_cbranch_scc1 .fz_kernel_pk52c
.fz_kernel_pk52:
  s_ff1_i32_b32 s33, s36
  s_bitset0_b32 s36, s33
  s_lshl_b32 s22, s33, 12
  buffer_load_dwordx4 v[128:131], v8, s[4:7], s22 offen offset:0
  buffer_load_dwordx4 v[132:135], v8, s[4:7], s22 offen offset:1024
  buffer_load_dwordx4 v[136:139], v8, s[4:7], s22 offen offset:2048
  buffer_load_dwordx4 v[140:143], v8, s[4:7], s22 offen offset:3072
  v_lshl_add_u32 v10, s20, 1, v14
  v_lshl_add_u32 v11, s20, 1, v15
  ds_read_b64_tr_b16 v[224:225], v10 offset:0
  ds_read_b64_tr_b16 v[226:227], v10 offset:1024
  ds_read_b64_tr_b16 v[228:229], v11 offset:0
  ds_read_b64_tr_b16 v[230:231], v11 offset:1024
  ds_read_b64_tr_b16 v[232:233], v10 offset:2048
  ds_read_b64_tr_b16 v[234:235], v10 offset:3072
  ds_read_b64_tr_b16 v[236:237], v11 offset:2048
  ds_read_b64_tr_b16 v[238:239], v11 offset:3072
  ds_read_b64_tr_b16 v[240:241], v10 offset:4096
  ds_read_b64_tr_b16 v[242:243], v10 offset:5120
  ds_read_b64_tr_b16 v[244:245], v11 offset:4096
  ds_read_b64_tr_b16 v[246:247], v11 offset:5120
  s_cmp_eq_u32 s36, 0
  s_cbranch_scc1 .fz_kernel_pk53c
.fz_kernel_pk53:
  s_ff1_i32_b32 s33, s36
  s_bitset0_b32 s36, s33
  s_lshl_b32 s23, s33, 12
  s_waitcnt vmcnt(11) lgkmcnt(8)
  v_mfma_f32_32x32x16_bf16 v[64:79], v[224:227], v[96:99], v[64:79]
  buffer_load_dwordx4 v[144:147], v8, s[4:7], s23 offen offset:0
  ds_read_b64_tr_b16 v[248:249], v10 offset:6144
  ds_read_b64_tr_b16 v[250:251], v10 offset:7168
  v_mfma_f32_32x32x16_bf16 v[80:95], v[228:231], v[96:99], v[80:95]
  ds_read_b64_tr_b16 v[252:253], v11 offset:6144
  ds_read_b64_tr_b16 v[254:255], v11 offset:7168
  v_lshl_add_u32 v12, s21, 1, v14
  v_lshl_add_u32 v13, s21, 1, v15
  s_waitcnt vmcnt(11) lgkmcnt(8)
  v_mfma_f32_32x32x16_bf16 v[64:79], v[232:235], v[100:103], v[64:79]
  buffer_load_dwordx4 v[148:151], v8, s[4:7], s23 offen offset:1024
  ds_read_b64_tr_b16 v[224:225], v12 offset:0
  ds_read_b64_tr_b16 v[226:227], v12 offset:1024
  v_mfma_f32_32x32x16_bf16 v[80:95], v[236:239], v[100:103], v[80:95]
  ds_read_b64_tr_b16 v[228:229], v13 offset:0
  ds_read_b64_tr_b16 v[230:231], v13 offset:1024
  s_waitcnt vmcnt(11) lgkmcnt(8)
  v_mfma_f32_32x32x16_bf16 v[64:79], v[240:243], v[104:107], v[64:79]
  buffer_load_dwordx4 v[152:155], v8, s[4:7], s23 offen offset:2048
  ds_read_b64_tr_b16 v[232:233], v12 offset:2048
  ds_read_b64_tr_b16 v[234:235], v12 offset:3072
  v_mfma_f32_32x32x16_bf16 v[80:95], v[244:247], v[104:107], v[80:95]
  ds_read_b64_tr_b16 v[236:237], v13 offset:2048
  ds_read_b64_tr_b16 v[238:239], v13 offset:3072
  s_cmp_eq_u32 s36, 0
  s_cbranch_scc1 .fz_kernel_pk54c
.fz_kernel_pk54:
  s_ff1_i32_b32 s33, s36
  s_waitcnt vmcnt(11) lgkmcnt(8)
  v_mfma_f32_32x32x16_bf16 v[64:79], v[248:251], v[108:111], v[64:79]
  buffer_load_dwordx4 v[156:159], v8, s[4:7], s23 offen offset:3072
  ds_read_b64_tr_b16 v[240:241], v12 offset:4096
  ds_read_b64_tr_b16 v[242:243], v12 offset:5120
  v_mfma_f32_32x32x16_bf16 v[80:95], v[252:255], v[108:111], v[80:95]
  ds_read_b64_tr_b16 v[244:245], v13 offset:4096
  ds_read_b64_tr_b16 v[246:247], v13 offset:5120
  s_bitset0_b32 s36, s33
  s_lshl_b32 s24, s33, 12
  s_waitcnt vmcnt(11) lgkmcnt(8)
  v_mfma_f32_32x32x16_bf16 v[64:79], v[224:227], v[112:115], v[64:79]
  buffer_load_dwordx4 v[160:163], v8, s[4:7], s24 offen offset:0
  ds_read_b64_tr_b16 v[248:249], v12 offset:6144
  ds_read_b64_tr_b16 v[250:251], v12 offset:7168
  v_mfma_f32_32x32x16_bf16 v[80:95], v[228:231], v[112:115], v[80:95]
  ds_read_b64_tr_b16 v[252:253], v13 offset:6144
  ds_read_b64_tr_b16 v[254:255], v13 offset:7168
  v_lshl_add_u32 v10, s22, 1, v14
  v_lshl_add_u32 v11, s22, 1, v15
  s_waitcnt vmcnt(11) lgkmcnt(8)
  v_mfma_f32_32x32x16_bf16 v[64:79], v[232:235], v[116:119], v[64:79]
  buffer_load_dwordx4 v[164:167], v8, s[4:7], s24 offen offset:1024
  ds_read_b64_tr_b16 v[224:225], v10 offset:0
  ds_read_b64_tr_b16 v[226:227], v10 offset:1024
  v_mfma_f32_32x32x16_bf16 v[80:95], v[236:239], v[116:119], v[80:95]
  ds_read_b64_tr_b16 v[228:229], v11 offset:0
  ds_read_b64_tr_b16 v[230:231], v11 offset:1024
  s_waitcnt vmcnt(11) lgkmcnt(8)
  v_mfma_f32_32x32x16_bf16 v[64:79], v[240:243], v[120:123], v[64:79]
  buffer_load_dwordx4 v[168:171], v8, s[4:7], s24 offen offset:2048
  ds_read_b64_tr_b16 v[232:233], v10 offset:2048
  ds_read_b64_tr_b16 v[234:235], v10 offset:3072
  v_mfma_f32_32x32x16_bf16 v[80:95], v[244:247], v[120:123], v[80:95]
  ds_read_b64_tr_b16 v[236:237], v11 offset:2048
  ds_read_b64_tr_b16 v[238:239], v11 offset:3072
  s_cmp_eq_u32 s36, 0
  s_cbranch_scc1 .fz_kernel_pk55c
.fz_kernel_pk55:
  s_ff1_i32_b32 s33, s36
  s_waitcnt vmcnt(11) lgkmcnt(8)
  v_mfma_f32_32x32x16_bf16 v[64:79], v[248:251], v[124:127], v[64:79]
  buffer_load_dwordx4 v[172:175], v8, s[4:7], s24 offen offset:3072
  ds_read_b64_tr_b16 v[240:241], v10 offset:4096
  ds_read_b64_tr_b16 v[242:243], v10 offset:5120
  v_mfma_f32_32x32x16_bf16 v[80:95], v[252:255], v[124:127], v[80:95]
  ds_read_b64_tr_b16 v[244:245], v11 offset:4096
  ds_read_b64_tr_b16 v[246:247], v11 offset:5120
  s_bitset0_b32 s36, s33
  s_lshl_b32 s25, s33, 12
  s_waitcnt vmcnt(11) lgkmcnt(8)
  v_mfma_f32_32x32x16_bf16 v[64:79], v[224:227], v[128:131], v[64:79]
  buffer_load_dwordx4 v[176:179], v8, s[4:7], s25 offen offset:0
  ds_read_b64_tr_b16 v[248:249], v10 offset:6144
  ds_read_b64_tr_b16 v[250:251], v10 offset:7168
  v_mfma_f32_32x32x16_bf16 v[80:95], v[228:231], v[128:131], v[80:95]
  ds_read_b64_tr_b16 v[252:253], v11 offset:6144
  ds_read_b64_tr_b16 v[254:255], v11 offset:7168
  v_lshl_add_u32 v12, s23, 1, v14
  v_lshl_add_u32 v13, s23, 1, v15
  s_waitcnt vmcnt(11) lgkmcnt(8)
  v_mfma_f32_32x32x16_bf16 v[64:79], v[232:235], v[132:135], v[64:79]
  buffer_load_dwordx4 v[180:183], v8, s[4:7], s25 offen offset:1024
  ds_read_b64_tr_b16 v[224:225], v12 offset:0
  ds_read_b64_tr_b16 v[226:227], v12 offset:1024
  v_mfma_f32_32x32x16_bf16 v[80:95], v[236:239], v[132:135], v[80:95]
  ds_read_b64_tr_b16 v[228:229], v13 offset:0
  ds_read_b64_tr_b16 v[230:231], v13 offset:1024
  s_waitcnt vmcnt(11) lgkmcnt(8)
  v_mfma_f32_32x32x16_bf16 v[64:79], v[240:243], v[136:139], v[64:79]
  buffer_load_dwordx4 v[184:187], v8, s[4:7], s25 offen offset:2048
  ds_read_b64_tr_b16 v[232:233], v12 offset:2048
  ds_read_b64_tr_b16 v[234:235], v12 offset:3072
  v_mfma_f32_32x32x16_bf16 v[80:95], v[244:247], v[136:139], v[80:95]
  ds_read_b64_tr_b16 v[236:237], v13 offset:2048
  ds_read_b64_tr_b16 v[238:239], v13 offset:3072
  s_cmp_eq_u32 s36, 0
  s_cbranch_scc1 .fz_kernel_pk56c
.fz_kernel_pk56:
  s_ff1_i32_b32 s33, s36
  s_waitcnt vmcnt(11) lgkmcnt(8)
  v_mfma_f32_32x32x16_bf16 v[64:79], v[248:251], v[140:143], v[64:79]
  buffer_load_dwordx4 v[188:191], v8, s[4:7], s25 offen offset:3072
  ds_read_b64_tr_b16 v[240:241], v12 offset:4096
  ds_read_b64_tr_b16 v[242:243], v12 offset:5120
  v_mfma_f32_32x32x16_bf16 v[80:95], v[252:255], v[140:143], v[80:95]
  ds_read_b64_tr_b16 v[244:245], v13 offset:4096
  ds_read_b64_tr_b16 v[246:247], v13 offset:5120
  s_bitset0_b32 s36, s33
  s_lshl_b32 s26, s33, 12
  s_waitcnt vmcnt(11) lgkmcnt(8)
  v_mfma_f32_32x32x16_bf16 v[64:79], v[224:227], v[144:147], v[64:79]
  buffer_load_dwordx4 v[192:195], v8, s[4:7], s26 offen offset:0
  ds_read_b64_tr_b16 v[248:249], v12 offset:6144
  ds_read_b64_tr_b16 v[250:251], v12 offset:7168
  v_mfma_f32_32x32x16_bf16 v[80:95], v[228:231], v[144:147], v[80:95]
  ds_read_b64_tr_b16 v[252:253], v13 offset:6144
  ds_read_b64_tr_b16 v[254:255], v13 offset:7168
  v_lshl_add_u32 v10, s24, 1, v14
  v_lshl_add_u32 v11, s24, 1, v15
  s_waitcnt vmcnt(11) lgkmcnt(8)
  v_mfma_f32_32x32x16_bf16 v[64:79], v[232:235], v[148:151], v[64:79]
  buffer_load_dwordx4 v[196:199], v8, s[4:7], s26 offen offset:1024
  ds_read_b64_tr_b16 v[224:225], v10 offset:0
  ds_read_b64_tr_b16 v[226:227], v10 offset:1024
  v_mfma_f32_32x32x16_bf16 v[80:95], v[236:239], v[148:151], v[80:95]
  ds_read_b64_tr_b16 v[228:229], v11 offset:0
  ds_read_b64_tr_b16 v[230:231], v11 offset:1024
  s_waitcnt vmcnt(11) lgkmcnt(8)
  v_mfma_f32_32x32x16_bf16 v[64:79], v[240:243], v[152:155], v[64:79]
  buffer_load_dwordx4 v[200:203], v8, s[4:7], s26 offen offset:2048
  ds_read_b64_tr_b16 v[232:233], v10 offset:2048
  ds_read_b64_tr_b16 v[234:235], v10 offset:3072
  v_mfma_f32_32x32x16_bf16 v[80:95], v[244:247], v[152:155], v[80:95]
  ds_read_b64_tr_b16 v[236:237], v11 offset:2048
  ds_read_b64_tr_b16 v[238:239], v11 offset:3072
  s_cmp_eq_u32 s36, 0
  s_cbranch_scc1 .fz_kernel_pk57c
.fz_kernel_pk57:
  s_ff1_i32_b32 s33, s36
  s_waitcnt vmcnt(11) lgkmcnt(8)
  v_mfma_f32_32x32x16_bf16 v[64:79], v[248:251], v[156:159], v[64:79]
  buffer_load_dwordx4 v[204:207], v8, s[4:7], s26 offen offset:3072
  ds_read_b64_tr_b16 v[240:241], v10 offset:4096
  ds_read_b64_tr_b16 v[242:243], v10 offset:5120
  v_mfma_f32_32x32x16_bf16 v[80:95], v[252:255], v[156:159], v[80:95]
  ds_read_b64_tr_b16 v[244:245], v11 offset:4096
  ds_read_b64_tr_b16 v[246:247], v11 offset:5120
  s_bitset0_b32 s36, s33
  s_lshl_b32 s27, s33, 12
  s_waitcnt vmcnt(11) lgkmcnt(8)
  v_mfma_f32_32x32x16_bf16 v[64:79], v[224:227], v[160:163], v[64:79]
  buffer_load_dwordx4 v[208:211], v8, s[4:7], s27 offen offset:0
  ds_read_b64_tr_b16 v[248:249], v10 offset:6144
  ds_read_b64_tr_b16 v[250:251], v10 offset:7168
  v_mfma_f32_32x32x16_bf16 v[80:95], v[228:231], v[160:163], v[80:95]
  ds_read_b64_tr_b16 v[252:253], v11 offset:6144
  ds_read_b64_tr_b16 v[254:255], v11 offset:7168
  v_lshl_add_u32 v12, s25, 1, v14
  v_lshl_add_u32 v13, s25, 1, v15
  s_waitcnt vmcnt(11) lgkmcnt(8)
  v_mfma_f32_32x32x16_bf16 v[64:79], v[232:235], v[164:167], v[64:79]
  buffer_load_dwordx4 v[212:215], v8, s[4:7], s27 offen offset:1024
  ds_read_b64_tr_b16 v[224:225], v12 offset:0
  ds_read_b64_tr_b16 v[226:227], v12 offset:1024
  v_mfma_f32_32x32x16_bf16 v[80:95], v[236:239], v[164:167], v[80:95]
  ds_read_b64_tr_b16 v[228:229], v13 offset:0
  ds_read_b64_tr_b16 v[230:231], v13 offset:1024
  s_waitcnt vmcnt(11) lgkmcnt(8)
  v_mfma_f32_32x32x16_bf16 v[64:79], v[240:243], v[168:171], v[64:79]
  buffer_load_dwordx4 v[216:219], v8, s[4:7], s27 offen offset:2048
  ds_read_b64_tr_b16 v[232:233], v12 offset:2048
  ds_read_b64_tr_b16 v[234:235], v12 offset:3072
  v_mfma_f32_32x32x16_bf16 v[80:95], v[244:247], v[168:171], v[80:95]
  ds_read_b64_tr_b16 v[236:237], v13 offset:2048
  ds_read_b64_tr_b16 v[238:239], v13 offset:3072
  s_cmp_eq_u32 s36, 0
  s_cbranch_scc1 .fz_kernel_pk58c
.fz_kernel_pk58:
  s_ff1_i32_b32 s33, s36
  s_waitcnt vmcnt(11) lgkmcnt(8)
  v_mfma_f32_32x32x16_bf16 v[64:79], v[248:251], v[172:175], v[64:79]
  buffer_load_dwordx4 v[220:223], v8, s[4:7], s27 offen offset:3072
  ds_read_b64_tr_b16 v[240:241], v12 offset:4096
  ds_read_b64_tr_b16 v[242:243], v12 offset:5120
  v_mfma_f32_32x32x16_bf16 v[80:95], v[252:255], v[172:175], v[80:95]
  ds_read_b64_tr_b16 v[244:245], v13 offset:4096
  ds_read_b64_tr_b16 v[246:247], v13 offset:5120
  s_bitset0_b32 s36, s33
  s_lshl_b32 s20, s33, 12
  s_waitcnt vmcnt(11) lgkmcnt(8)
  v_mfma_f32_32x32x16_bf16 v[64:79], v[224:227], v[176:179], v[64:79]
  buffer_load_dwordx4 v[96:99], v8, s[4:7], s20 offen offset:0
  ds_read_b64_tr_b16 v[248:249], v12 offset:6144
  ds_read_b64_tr_b16 v[250:251], v12 offset:7168
  v_mfma_f32_32x32x16_bf16 v[80:95], v[228:231], v[176:179], v[80:95]
  ds_read_b64_tr_b16 v[252:253], v13 offset:6144
  ds_read_b64_tr_b16 v[254:255], v13 offset:7168
  v_lshl_add_u32 v10, s26, 1, v14
  v_lshl_add_u32 v11, s26, 1, v15
  s_waitcnt vmcnt(11) lgkmcnt(8)
  v_mfma_f32_32x32x16_bf16 v[64:79], v[232:235], v[180:183], v[64:79]
  buffer_load_dwordx4 v[100:103], v8, s[4:7], s20 offen offset:1024
  ds_read_b64_tr_b16 v[224:225], v10 offset:0
  ds_read_b64_tr_b16 v[226:227], v10 offset:1024
  v_mfma_f32_32x32x16_bf16 v[80:95], v[236:239], v[180:183], v[80:95]
  ds_read_b64_tr_b16 v[228:229], v11 offset:0
  ds_read_b64_tr_b16 v[230:231], v11 offset:1024
  s_waitcnt vmcnt(11) lgkmcnt(8)
  v_mfma_f32_32x32x16_bf16 v[64:79], v[240:243], v[184:187], v[64:79]
  buffer_load_dwordx4 v[104:107], v8, s[4:7], s20 offen offset:2048
  ds_read_b64_tr_b16 v[232:233], v10 offset:2048
  ds_read_b64_tr_b16 v[234:235], v10 offset:3072
  v_mfma_f32_32x32x16_bf16 v[80:95], v[244:247], v[184:187], v[80:95]
  ds_read_b64_tr_b16 v[236:237], v11 offset:2048
  ds_read_b64_tr_b16 v[238:239], v11 offset:3072
  s_cmp_eq_u32 s36, 0
  s_cbranch_scc1 .fz_kernel_pk59c
.fz_kernel_pk59:
  s_ff1_i32_b32 s33, s36
  s_waitcnt vmcnt(11) lgkmcnt(8)
  v_mfma_f32_32x32x16_bf16 v[64:79], v[248:251], v[188:191], v[64:79]
  buffer_load_dwordx4 v[108:111], v8, s[4:7], s20 offen offset:3072
  ds_read_b64_tr_b16 v[240:241], v10 offset:4096
  ds_read_b64_tr_b16 v[242:243], v10 offset:5120
  v_mfma_f32_32x32x16_bf16 v[80:95], v[252:255], v[188:191], v[80:95]
  ds_read_b64_tr_b16 v[244:245], v11 offset:4096
  ds_read_b64_tr_b16 v[246:247], v11 offset:5120
  s_bitset0_b32 s36, s33
  s_lshl_b32 s21, s33, 12
  s_waitcnt vmcnt(11) lgkmcnt(8)
  v_mfma_f32_32x32x16_bf16 v[64:79], v[224:227], v[192:195], v[64:79]
  buffer_load_dwordx4 v[112:115], v8, s[4:7], s21 offen offset:0
  ds_read_b64_tr_b16 v[248:249], v10 offset:6144
  ds_read_b64_tr_b16 v[250:251], v10 offset:7168
  v_mfma_f32_32x32x16_bf16 v[80:95], v[228:231], v[192:195], v[80:95]
  ds_read_b64_tr_b16 v[252:253], v11 offset:6144
  ds_read_b64_tr_b16 v[254:255], v11 offset:7168
  v_lshl_add_u32 v12, s27, 1, v14
  v_lshl_add_u32 v13, s27, 1, v15
  s_waitcnt vmcnt(11) lgkmcnt(8)
  v_mfma_f32_32x32x16_bf16 v[64:79], v[232:235], v[196:199], v[64:79]
  buffer_load_dwordx4 v[116:119], v8, s[4:7], s21 offen offset:1024
  ds_read_b64_tr_b16 v[224:225], v12 offset:0
  ds_read_b64_tr_b16 v[226:227], v12 offset:1024
  v_mfma_f32_32x32x16_bf16 v[80:95], v[236:239], v[196:199], v[80:95]
  ds_read_b64_tr_b16 v[228:229], v13 offset:0
  ds_read_b64_tr_b16 v[230:231], v13 offset:1024
  s_waitcnt vmcnt(11) lgkmcnt(8)
  v_mfma_f32_32x32x16_bf16 v[64:79], v[240:243], v[200:203], v[64:79]
  buffer_load_dwordx4 v[120:123], v8, s[4:7], s21 offen offset:2048
  ds_read_b64_tr_b16 v[232:233], v12 offset:2048
  ds_read_b64_tr_b16 v[234:235], v12 offset:3072
  v_mfma_f32_32x32x16_bf16 v[80:95], v[244:247], v[200:203], v[80:95]
  ds_read_b64_tr_b16 v[236:237], v13 offset:2048
  ds_read_b64_tr_b16 v[238:239], v13 offset:3072
  s_cmp_eq_u32 s36, 0
  s_cbranch_scc1 .fz_kernel_pk60c
.fz_kernel_pk60:
  s_ff1_i32_b32 s33, s36
  s_waitcnt vmcnt(11) lgkmcnt(8)
  v_mfma_f32_32x32x16_bf16 v[64:79], v[248:251], v[204:207], v[64:79]
  buffer_load_dwordx4 v[124:127], v8, s[4:7], s21 offen offset:3072
  ds_read_b64_tr_b16 v[240:241], v12 offset:4096
  ds_read_b64_tr_b16 v[242:243], v12 offset:5120
  v_mfma_f32_32x32x16_bf16 v[80:95], v[252:255], v[204:207], v[80:95]
  ds_read_b64_tr_b16 v[244:245], v13 offset:4096
  ds_read_b64_tr_b16 v[246:247], v13 offset:5120
  s_bitset0_b32 s36, s33
  s_lshl_b32 s22, s33, 12
  s_waitcnt vmcnt(11) lgkmcnt(8)
  v_mfma_f32_32x32x16_bf16 v[64:79], v[224:227], v[208:211], v[64:79]
  buffer_load_dwordx4 v[128:131], v8, s[4:7], s22 offen offset:0
  ds_read_b64_tr_b16 v[248:249], v12 offset:6144
  ds_read_b64_tr_b16 v[250:251], v12 offset:7168
  v_mfma_f32_32x32x16_bf16 v[80:95], v[228:231], v[208:211], v[80:95]
  ds_read_b64_tr_b16 v[252:253], v13 offset:6144
  ds_read_b64_tr_b16 v[254:255], v13 offset:7168
  v_lshl_add_u32 v10, s20, 1, v14
  v_lshl_add_u32 v11, s20, 1, v15
  s_waitcnt vmcnt(11) lgkmcnt(8)
  v_mfma_f32_32x32x16_bf16 v[64:79], v[232:235], v[212:215], v[64:79]
  buffer_load_dwordx4 v[132:135], v8, s[4:7], s22 offen offset:1024
  ds_read_b64_tr_b16 v[224:225], v10 offset:0
  ds_read_b64_tr_b16 v[226:227], v10 offset:1024
  v_mfma_f32_32x32x16_bf16 v[80:95], v[236:239], v[212:215], v[80:95]
  ds_read_b64_tr_b16 v[228:229], v11 offset:0
  ds_read_b64_tr_b16 v[230:231], v11 offset:1024
  s_waitcnt vmcnt(11) lgkmcnt(8)
  v_mfma_f32_32x32x16_bf16 v[64:79], v[240:243], v[216:219], v[64:79]
  buffer_load_dwordx4 v[136:139], v8, s[4:7], s22 offen offset:2048
  ds_read_b64_tr_b16 v[232:233], v10 offset:2048
  ds_read_b64_tr_b16 v[234:235], v10 offset:3072
  v_mfma_f32_32x32x16_bf16 v[80:95], v[244:247], v[216:219], v[80:95]
  ds_read_b64_tr_b16 v[236:237], v11 offset:2048
  ds_read_b64_tr_b16 v[238:239], v11 offset:3072
  s_cmp_eq_u32 s36, 0
  s_cbranch_scc1 .fz_kernel_pk61c
.fz_kernel_pk61:
  s_ff1_i32_b32 s33, s36
  s_waitcnt vmcnt(11) lgkmcnt(8)
  v_mfma_f32_32x32x16_bf16 v[64:79], v[248:251], v[220:223], v[64:79]
  buffer_load_dwordx4 v[140:143], v8, s[4:7], s22 offen offset:3072
  ds_read_b64_tr_b16 v[240:241], v10 offset:4096
  ds_read_b64_tr_b16 v[242:243], v10 offset:5120
  v_mfma_f32_32x32x16_bf16 v[80:95], v[252:255], v[220:223], v[80:95]
  ds_read_b64_tr_b16 v[244:245], v11 offset:4096
  ds_read_b64_tr_b16 v[246:247], v11 offset:5120
  s_bitset0_b32 s36, s33
  s_lshl_b32 s23, s33, 12
  s_waitcnt vmcnt(11) lgkmcnt(8)
  v_mfma_f32_32x32x16_bf16 v[64:79], v[224:227], v[96:99], v[64:79]
  buffer_load_dwordx4 v[144:147], v8, s[4:7], s23 offen offset:0
  ds_read_b64_tr_b16 v[248:249], v10 offset:6144
  ds_read_b64_tr_b16 v[250:251], v10 offset:7168
  v_mfma_f32_32x32x16_bf16 v[80:95], v[228:231], v[96:99], v[80:95]
  ds_read_b64_tr_b16 v[252:253], v11 offset:6144
  ds_read_b64_tr_b16 v[254:255], v11 offset:7168
  v_lshl_add_u32 v12, s21, 1, v14
  v_lshl_add_u32 v13, s21, 1, v15
  s_waitcnt vmcnt(11) lgkmcnt(8)
  v_mfma_f32_32x32x16_bf16 v[64:79], v[232:235], v[100:103], v[64:79]
  buffer_load_dwordx4 v[148:151], v8, s[4:7], s23 offen offset:1024
  ds_read_b64_tr_b16 v[224:225], v12 offset:0
  ds_read_b64_tr_b16 v[226:227], v12 offset:1024
  v_mfma_f32_32x32x16_bf16 v[80:95], v[236:239], v[100:103], v[80:95]
  ds_read_b64_tr_b16 v[228:229], v13 offset:0
  ds_read_b64_tr_b16 v[230:231], v13 offset:1024
  s_waitcnt vmcnt(11) lgkmcnt(8)
  v_mfma_f32_32x32x16_bf16 v[64:79], v[240:243], v[104:107], v[64:79]
  buffer_load_dwordx4 v[152:155], v8, s[4:7], s23 offen offset:2048
  ds_read_b64_tr_b16 v[232:233], v12 offset:2048
  ds_read_b64_tr_b16 v[234:235], v12 offset:3072
  v_mfma_f32_32x32x16_bf16 v[80:95], v[244:247], v[104:107], v[80:95]
  ds_read_b64_tr_b16 v[236:237], v13 offset:2048
  ds_read_b64_tr_b16 v[238:239], v13 offset:3072
  s_cmp_eq_u32 s36, 0
  s_cbranch_scc1 .fz_kernel_pk62c
.fz_kernel_pk62:
  s_ff1_i32_b32 s33, s36
  s_waitcnt vmcnt(11) lgkmcnt(8)
  v_mfma_f32_32x32x16_bf16 v[64:79], v[248:251], v[108:111], v[64:79]
  buffer_load_dwordx4 v[156:159], v8, s[4:7], s23 offen offset:3072
  ds_read_b64_tr_b16 v[240:241], v12 offset:4096
  ds_read_b64_tr_b16 v[242:243], v12 offset:5120
  v_mfma_f32_32x32x16_bf16 v[80:95], v[252:255], v[108:111], v[80:95]
  ds_read_b64_tr_b16 v[244:245], v13 offset:4096
  ds_read_b64_tr_b16 v[246:247], v13 offset:5120
  s_bitset0_b32 s36, s33
  s_lshl_b32 s24, s33, 12
  s_waitcnt vmcnt(11) lgkmcnt(8)
  v_mfma_f32_32x32x16_bf16 v[64:79], v[224:227], v[112:115], v[64:79]
  buffer_load_dwordx4 v[160:163], v8, s[4:7], s24 offen offset:0
  ds_read_b64_tr_b16 v[248:249], v12 offset:6144
  ds_read_b64_tr_b16 v[250:251], v12 offset:7168
  v_mfma_f32_32x32x16_bf16 v[80:95], v[228:231], v[112:115], v[80:95]
  ds_read_b64_tr_b16 v[252:253], v13 offset:6144
  ds_read_b64_tr_b16 v[254:255], v13 offset:7168
  v_lshl_add_u32 v10, s22, 1, v14
  v_lshl_add_u32 v11, s22, 1, v15
  s_waitcnt vmcnt(11) lgkmcnt(8)
  v_mfma_f32_32x32x16_bf16 v[64:79], v[232:235], v[116:119], v[64:79]
  buffer_load_dwordx4 v[164:167], v8, s[4:7], s24 offen offset:1024
  ds_read_b64_tr_b16 v[224:225], v10 offset:0
  ds_read_b64_tr_b16 v[226:227], v10 offset:1024
  v_mfma_f32_32x32x16_bf16 v[80:95], v[236:239], v[116:119], v[80:95]
  ds_read_b64_tr_b16 v[228:229], v11 offset:0
  ds_read_b64_tr_b16 v[230:231], v11 offset:1024
  s_waitcnt vmcnt(11) lgkmcnt(8)
  v_mfma_f32_32x32x16_bf16 v[64:79], v[240:243], v[120:123], v[64:79]
  buffer_load_dwordx4 v[168:171], v8, s[4:7], s24 offen offset:2048
  ds_read_b64_tr_b16 v[232:233], v10 offset:2048
  ds_read_b64_tr_b16 v[234:235], v10 offset:3072
  v_mfma_f32_32x32x16_bf16 v[80:95], v[244:247], v[120:123], v[80:95]
  ds_read_b64_tr_b16 v[236:237], v11 offset:2048
  ds_read_b64_tr_b16 v[238:239], v11 offset:3072
  s_cmp_eq_u32 s36, 0
  s_cbranch_scc1 .fz_kernel_pk63c
.fz_kernel_pk63:
  s_ff1_i32_b32 s33, s36
  s_waitcnt vmcnt(11) lgkmcnt(8)
  v_mfma_f32_32x32x16_bf16 v[64:79], v[248:251], v[124:127], v[64:79]
  buffer_load_dwordx4 v[172:175], v8, s[4:7], s24 offen offset:3072
  ds_read_b64_tr_b16 v[240:241], v10 offset:4096
  ds_read_b64_tr_b16 v[242:243], v10 offset:5120
  v_mfma_f32_32x32x16_bf16 v[80:95], v[252:255], v[124:127], v[80:95]
  ds_read_b64_tr_b16 v[244:245], v11 offset:4096
  ds_read_b64_tr_b16 v[246:247], v11 offset:5120
  s_bitset0_b32 s36, s33
  s_lshl_b32 s25, s33, 12
  s_waitcnt vmcnt(11) lgkmcnt(8)
  v_mfma_f32_32x32x16_bf16 v[64:79], v[224:227], v[128:131], v[64:79]
  buffer_load_dwordx4 v[176:179], v8, s[4:7], s25 offen offset:0
  ds_read_b64_tr_b16 v[248:249], v10 offset:6144
  ds_read_b64_tr_b16 v[250:251], v10 offset:7168
  v_mfma_f32_32x32x16_bf16 v[80:95], v[228:231], v[128:131], v[80:95]
  ds_read_b64_tr_b16 v[252:253], v11 offset:6144
  ds_read_b64_tr_b16 v[254:255], v11 offset:7168
  v_lshl_add_u32 v12, s23, 1, v14
  v_lshl_add_u32 v13, s23, 1, v15
  s_waitcnt vmcnt(11) lgkmcnt(8)
  v_mfma_f32_32x32x16_bf16 v[64:79], v[232:235], v[132:135], v[64:79]
  buffer_load_dwordx4 v[180:183], v8, s[4:7], s25 offen offset:1024
  ds_read_b64_tr_b16 v[224:225], v12 offset:0
  ds_read_b64_tr_b16 v[226:227], v12 offset:1024
  v_mfma_f32_32x32x16_bf16 v[80:95], v[236:239], v[132:135], v[80:95]
  ds_read_b64_tr_b16 v[228:229], v13 offset:0
  ds_read_b64_tr_b16 v[230:231], v13 offset:1024
  s_waitcnt vmcnt(11) lgkmcnt(8)
  v_mfma_f32_32x32x16_bf16 v[64:79], v[240:243], v[136:139], v[64:79]
  buffer_load_dwordx4 v[184:187], v8, s[4:7], s25 offen offset:2048
  ds_read_b64_tr_b16 v[232:233], v12 offset:2048
  ds_read_b64_tr_b16 v[234:235], v12 offset:3072
  v_mfma_f32_32x32x16_bf16 v[80:95], v[244:247], v[136:139], v[80:95]
  ds_read_b64_tr_b16 v[236:237], v13 offset:2048
  ds_read_b64_tr_b16 v[238:239], v13 offset:3072
  s_cmp_eq_u32 s36, 0
  s_cbranch_scc1 .fz_kernel_pk64c
.fz_kernel_pk64:
  s_ff1_i32_b32 s33, s36
  s_waitcnt vmcnt(11) lgkmcnt(8)
  v_mfma_f32_32x32x16_bf16 v[64:79], v[248:251], v[140:143], v[64:79]
  buffer_load_dwordx4 v[188:191], v8, s[4:7], s25 offen offset:3072
  ds_read_b64_tr_b16 v[240:241], v12 offset:4096
  ds_read_b64_tr_b16 v[242:243], v12 offset:5120
  v_mfma_f32_32x32x16_bf16 v[80:95], v[252:255], v[140:143], v[80:95]
  ds_read_b64_tr_b16 v[244:245], v13 offset:4096
  ds_read_b64_tr_b16 v[246:247], v13 offset:5120
  s_bitset0_b32 s36, s33
  s_lshl_b32 s26, s33, 12
  s_waitcnt vmcnt(11) lgkmcnt(8)
  v_mfma_f32_32x32x16_bf16 v[64:79], v[224:227], v[144:147], v[64:79]
  buffer_load_dwordx4 v[192:195], v8, s[4:7], s26 offen offset:0
  ds_read_b64_tr_b16 v[248:249], v12 offset:6144
  ds_read_b64_tr_b16 v[250:251], v12 offset:7168
  v_mfma_f32_32x32x16_bf16 v[80:95], v[228:231], v[144:147], v[80:95]
  ds_read_b64_tr_b16 v[252:253], v13 offset:6144
  ds_read_b64_tr_b16 v[254:255], v13 offset:7168
  v_lshl_add_u32 v10, s24, 1, v14
  v_lshl_add_u32 v11, s24, 1, v15
  s_waitcnt vmcnt(11) lgkmcnt(8)
  v_mfma_f32_32x32x16_bf16 v[64:79], v[232:235], v[148:151], v[64:79]
  buffer_load_dwordx4 v[196:199], v8, s[4:7], s26 offen offset:1024
  ds_read_b64_tr_b16 v[224:225], v10 offset:0
  ds_read_b64_tr_b16 v[226:227], v10 offset:1024
  v_mfma_f32_32x32x16_bf16 v[80:95], v[236:239], v[148:151], v[80:95]
  ds_read_b64_tr_b16 v[228:229], v11 offset:0
  ds_read_b64_tr_b16 v[230:231], v11 offset:1024
  s_waitcnt vmcnt(11) lgkmcnt(8)
  v_mfma_f32_32x32x16_bf16 v[64:79], v[240:243], v[152:155], v[64:79]
  buffer_load_dwordx4 v[200:203], v8, s[4:7], s26 offen offset:2048
  ds_read_b64_tr_b16 v[232:233], v10 offset:2048
  ds_read_b64_tr_b16 v[234:235], v10 offset:3072
  v_mfma_f32_32x32x16_bf16 v[80:95], v[244:247], v[152:155], v[80:95]
  ds_read_b64_tr_b16 v[236:237], v11 offset:2048
  ds_read_b64_tr_b16 v[238:239], v11 offset:3072
  s_cmp_eq_u32 s36, 0
  s_cbranch_scc1 .fz_kernel_pk65c
.fz_kernel_pk65:
  s_ff1_i32_b32 s33, s36
  s_waitcnt vmcnt(11) lgkmcnt(8)
  v_mfma_f32_32x32x16_bf16 v[64:79], v[248:251], v[156:159], v[64:79]
  buffer_load_dwordx4 v[204:207], v8, s[4:7], s26 offen offset:3072
  ds_read_b64_tr_b16 v[240:241], v10 offset:4096
  ds_read_b64_tr_b16 v[242:243], v10 offset:5120
  v_mfma_f32_32x32x16_bf16 v[80:95], v[252:255], v[156:159], v[80:95]
  ds_read_b64_tr_b16 v[244:245], v11 offset:4096
  ds_read_b64_tr_b16 v[246:247], v11 offset:5120
  s_bitset0_b32 s36, s33
  s_lshl_b32 s27, s33, 12
  s_waitcnt vmcnt(11) lgkmcnt(8)
  v_mfma_f32_32x32x16_bf16 v[64:79], v[224:227], v[160:163], v[64:79]
  buffer_load_dwordx4 v[208:211], v8, s[4:7], s27 offen offset:0
  ds_read_b64_tr_b16 v[248:249], v10 offset:6144
  ds_read_b64_tr_b16 v[250:251], v10 offset:7168
  v_mfma_f32_32x32x16_bf16 v[80:95], v[228:231], v[160:163], v[80:95]
  ds_read_b64_tr_b16 v[252:253], v11 offset:6144
  ds_read_b64_tr_b16 v[254:255], v11 offset:7168
  v_lshl_add_u32 v12, s25, 1, v14
  v_lshl_add_u32 v13, s25, 1, v15
  s_waitcnt vmcnt(11) lgkmcnt(8)
  v_mfma_f32_32x32x16_bf16 v[64:79], v[232:235], v[164:167], v[64:79]
  buffer_load_dwordx4 v[212:215], v8, s[4:7], s27 offen offset:1024
  ds_read_b64_tr_b16 v[224:225], v12 offset:0
  ds_read_b64_tr_b16 v[226:227], v12 offset:1024
  v_mfma_f32_32x32x16_bf16 v[80:95], v[236:239], v[164:167], v[80:95]
  ds_read_b64_tr_b16 v[228:229], v13 offset:0
  ds_read_b64_tr_b16 v[230:231], v13 offset:1024
  s_waitcnt vmcnt(11) lgkmcnt(8)
  v_mfma_f32_32x32x16_bf16 v[64:79], v[240:243], v[168:171], v[64:79]
  buffer_load_dwordx4 v[216:219], v8, s[4:7], s27 offen offset:2048
  ds_read_b64_tr_b16 v[232:233], v12 offset:2048
  ds_read_b64_tr_b16 v[234:235], v12 offset:3072
  v_mfma_f32_32x32x16_bf16 v[80:95], v[244:247], v[168:171], v[80:95]
  ds_read_b64_tr_b16 v[236:237], v13 offset:2048
  ds_read_b64_tr_b16 v[238:239], v13 offset:3072
  s_waitcnt vmcnt(11) lgkmcnt(8)
  v_mfma_f32_32x32x16_bf16 v[64:79], v[248:251], v[172:175], v[64:79]
  buffer_load_dwordx4 v[220:223], v8, s[4:7], s27 offen offset:3072
  ds_read_b64_tr_b16 v[240:241], v12 offset:4096
  ds_read_b64_tr_b16 v[242:243], v12 offset:5120
  v_mfma_f32_32x32x16_bf16 v[80:95], v[252:255], v[172:175], v[80:95]
  ds_read_b64_tr_b16 v[244:245], v13 offset:4096
  ds_read_b64_tr_b16 v[246:247], v13 offset:5120
  s_waitcnt vmcnt(11) lgkmcnt(8)
  v_mfma_f32_32x32x16_bf16 v[64:79], v[224:227], v[176:179], v[64:79]
  ds_read_b64_tr_b16 v[248:249], v12 offset:6144
  ds_read_b64_tr_b16 v[250:251], v12 offset:7168
  v_mfma_f32_32x32x16_bf16 v[80:95], v[228:231], v[176:179], v[80:95]
  ds_read_b64_tr_b16 v[252:253], v13 offset:6144
  ds_read_b64_tr_b16 v[254:255], v13 offset:7168
  v_lshl_add_u32 v10, s26, 1, v14
  v_lshl_add_u32 v11, s26, 1, v15
  s_waitcnt vmcnt(10) lgkmcnt(8)
  v_mfma_f32_32x32x16_bf16 v[64:79], v[232:235], v[180:183], v[64:79]
  ds_read_b64_tr_b16 v[224:225], v10 offset:0
  ds_read_b64_tr_b16 v[226:227], v10 offset:1024
  v_mfma_f32_32x32x16_bf16 v[80:95], v[236:239], v[180:183], v[80:95]
  ds_read_b64_tr_b16 v[228:229], v11 offset:0
  ds_read_b64_tr_b16 v[230:231], v11 offset:1024
  s_waitcnt vmcnt(9) lgkmcnt(8)
  v_mfma_f32_32x32x16_bf16 v[64:79], v[240:243], v[184:187], v[64:79]
  ds_read_b64_tr_b16 v[232:233], v10 offset:2048
  ds_read_b64_tr_b16 v[234:235], v10 offset:3072
  v_mfma_f32_32x32x16_bf16 v[80:95], v[244:247], v[184:187], v[80:95]
  ds_read_b64_tr_b16 v[236:237], v11 offset:2048
  ds_read_b64_tr_b16 v[238:239], v11 offset:3072
  s_waitcnt vmcnt(8) lgkmcnt(8)
  v_mfma_f32_32x32x16_bf16 v[64:79], v[248:251], v[188:191], v[64:79]
  ds_read_b64_tr_b16 v[240:241], v10 offset:4096
  ds_read_b64_tr_b16 v[242:243], v10 offset:5120
  v_mfma_f32_32x32x16_bf16 v[80:95], v[252:255], v[188:191], v[80:95]
  ds_read_b64_tr_b16 v[244:245], v11 offset:4096
  ds_read_b64_tr_b16 v[246:247], v11 offset:5120
  s_waitcnt vmcnt(7) lgkmcnt(8)
  v_mfma_f32_32x32x16_bf16 v[64:79], v[224:227], v[192:195], v[64:79]
  ds_read_b64_tr_b16 v[248:249], v10 offset:6144
  ds_read_b64_tr_b16 v[250:251], v10 offset:7168
  v_mfma_f32_32x32x16_bf16 v[80:95], v[228:231], v[192:195], v[80:95]
  ds_read_b64_tr_b16 v[252:253], v11 offset:6144
  ds_read_b64_tr_b16 v[254:255], v11 offset:7168
  v_lshl_add_u32 v12, s27, 1, v14
  v_lshl_add_u32 v13, s27, 1, v15
  s_waitcnt vmcnt(6) lgkmcnt(8)
  v_mfma_f32_32x32x16_bf16 v[64:79], v[232:235], v[196:199], v[64:79]
  ds_read_b64_tr_b16 v[224:225], v12 offset:0
  ds_read_b64_tr_b16 v[226:227], v12 offset:1024
  v_mfma_f32_32x32x16_bf16 v[80:95], v[236:239], v[196:199], v[80:95]
  ds_read_b64_tr_b16 v[228:229], v13 offset:0
  ds_read_b64_tr_b16 v[230:231], v13 offset:1024
  s_waitcnt vmcnt(5) lgkmcnt(8)
  v_mfma_f32_32x32x16_bf16 v[64:79], v[240:243], v[200:203], v[64:79]
  ds_read_b64_tr_b16 v[232:233], v12 offset:2048
  ds_read_b64_tr_b16 v[234:235], v12 offset:3072
  v_mfma_f32_32x32x16_bf16 v[80:95], v[244:247], v[200:203], v[80:95]
  ds_read_b64_tr_b16 v[236:237], v13 offset:2048
  ds_read_b64_tr_b16 v[238:239], v13 offset:3072
  s_waitcnt vmcnt(4) lgkmcnt(8)
  v_mfma_f32_32x32x16_bf16 v[64:79], v[248:251], v[204:207], v[64:79]
  ds_read_b64_tr_b16 v[240:241], v12 offset:4096
  ds_read_b64_tr_b16 v[242:243], v12 offset:5120
  v_mfma_f32_32x32x16_bf16 v[80:95], v[252:255], v[204:207], v[80:95]
  ds_read_b64_tr_b16 v[244:245], v13 offset:4096
  ds_read_b64_tr_b16 v[246:247], v13 offset:5120
  s_waitcnt vmcnt(3) lgkmcnt(8)
  v_mfma_f32_32x32x16_bf16 v[64:79], v[224:227], v[208:211], v[64:79]
  ds_read_b64_tr_b16 v[248:249], v12 offset:6144
  ds_read_b64_tr_b16 v[250:251], v12 offset:7168
  v_mfma_f32_32x32x16_bf16 v[80:95], v[228:231], v[208:211], v[80:95]
  ds_read_b64_tr_b16 v[252:253], v13 offset:6144
  ds_read_b64_tr_b16 v[254:255], v13 offset:7168
  s_waitcnt vmcnt(2) lgkmcnt(8)
  v_mfma_f32_32x32x16_bf16 v[64:79], v[232:235], v[212:215], v[64:79]
  v_mfma_f32_32x32x16_bf16 v[80:95], v[236:239], v[212:215], v[80:95]
  s_waitcnt vmcnt(1) lgkmcnt(4)
  v_mfma_f32_32x32x16_bf16 v[64:79], v[240:243], v[216:219], v[64:79]
  v_mfma_f32_32x32x16_bf16 v[80:95], v[244:247], v[216:219], v[80:95]
  s_waitcnt vmcnt(0) lgkmcnt(0)
  v_mfma_f32_32x32x16_bf16 v[64:79], v[248:251], v[220:223], v[64:79]
  v_mfma_f32_32x32x16_bf16 v[80:95], v[252:255], v[220:223], v[80:95]
  s_mov_b32 s36, 0x3f803f80
  v_mov_b32 v8, 0
  v_mov_b32 v9, 0
  v_mov_b32 v10, 0
  v_mov_b32 v11, 0
  v_mov_b32 v12, 0
  v_mov_b32 v13, 0
  v_lshlrev_b32 v19, 2, v18
  v_lshl_add_u32 v19, v17, 13, v19
  s_lshl_b32 s34, s32, 7
  s_add_u32 s34, s34, s66
  s_add_u32 s34, s34, 16384
  s_add_u32 s37, s34, 16384
  v_cvt_pk_bf16_f32 v20, v64, v65
  v_cvt_pk_bf16_f32 v21, v66, v67
  v_cvt_pk_bf16_f32 v22, v68, v69
  v_cvt_pk_bf16_f32 v23, v70, v71
  buffer_store_dwordx4 v[20:23], v16, s[4:7], s39 offen offset:0 sc1
  v_cvt_pk_bf16_f32 v24, v72, v73
  v_cvt_pk_bf16_f32 v25, v74, v75
  v_cvt_pk_bf16_f32 v26, v76, v77
  v_cvt_pk_bf16_f32 v27, v78, v79
  buffer_store_dwordx4 v[24:27], v16, s[4:7], s39 offen offset:512 sc1
  v_cvt_pk_bf16_f32 v28, v80, v81
  v_cvt_pk_bf16_f32 v29, v82, v83
  v_cvt_pk_bf16_f32 v30, v84, v85
  v_cvt_pk_bf16_f32 v31, v86, v87
  buffer_store_dwordx4 v[28:31], v16, s[4:7], s39 offen offset:1024 sc1
  v_cvt_pk_bf16_f32 v32, v88, v89
  v_cvt_pk_bf16_f32 v33, v90, v91
  v_cvt_pk_bf16_f32 v34, v92, v93
  v_cvt_pk_bf16_f32 v35, v94, v95
  buffer_store_dwordx4 v[32:35], v16, s[4:7], s39 offen offset:1536 sc1
  v_dot2c_f32_bf16 v8, s36, v20
  v_dot2c_f32_bf16 v9, v20, v20
  v_dot2c_f32_bf16 v10, v20, v48
  v_dot2c_f32_bf16 v11, s36, v21
  v_dot2c_f32_bf16 v12, v21, v21
  v_dot2c_f32_bf16 v13, v21, v49
  v_dot2c_f32_bf16 v8, s36, v22
  v_dot2c_f32_bf16 v9, v22, v22
  v_dot2c_f32_bf16 v10, v22, v50
  v_dot2c_f32_bf16 v11, s36, v23
  v_dot2c_f32_bf16 v12, v23, v23
  v_dot2c_f32_bf16 v13, v23, v51
  v_dot2c_f32_bf16 v8, s36, v24
  v_dot2c_f32_bf16 v9, v24, v24
  v_dot2c_f32_bf16 v10, v24, v52
  v_dot2c_f32_bf16 v11, s36, v25
  v_dot2c_f32_bf16 v12, v25, v25
  v_dot2c_f32_bf16 v13, v25, v53
  v_dot2c_f32_bf16 v8, s36, v26
  v_dot2c_f32_bf16 v9, v26, v26
  v_dot2c_f32_bf16 v10, v26, v54
  v_dot2c_f32_bf16 v11, s36, v27
  v_dot2c_f32_bf16 v12, v27, v27
  v_dot2c_f32_bf16 v13, v27, v55
  v_dot2c_f32_bf16 v8, s36, v28
  v_dot2c_f32_bf16 v9, v28, v28
  v_dot2c_f32_bf16 v10, v28, v56
  v_dot2c_f32_bf16 v11, s36, v29
  v_dot2c_f32_bf16 v12, v29, v29
  v_dot2c_f32_bf16 v13, v29, v57
  v_dot2c_f32_bf16 v8, s36, v30
  v_dot2c_f32_bf16 v9, v30, v30
  v_dot2c_f32_bf16 v10, v30, v58
  v_dot2c_f32_bf16 v11, s36, v31
  v_dot2c_f32_bf16 v12, v31, v31
  v_dot2c_f32_bf16 v13, v31, v59
  v_dot2c_f32_bf16 v8, s36, v32
  v_dot2c_f32_bf16 v9, v32, v32
  v_dot2c_f32_bf16 v10, v32, v60
  v_dot2c_f32_bf16 v11, s36, v33
  v_dot2c_f32_bf16 v12, v33, v33
  v_dot2c_f32_bf16 v13, v33, v61
  v_dot2c_f32_bf16 v8, s36, v34
  v_dot2c_f32_bf16 v9, v34, v34
  v_dot2c_f32_bf16 v10, v34, v62
  v_dot2c_f32_bf16 v11, s36, v35
  v_dot2c_f32_bf16 v12, v35, v35
  v_dot2c_f32_bf16 v13, v35, v63
  s_nop 0
  v_add_f32 v36, v8, v11
  v_add_f32 v37, v9, v12
  v_add_f32 v38, v10, v13
  v_fma_f32 v38, -v36, v46, v38
  v_fmac_f32 v47, 0x44800000, v37
  v_mov_b32 v39, v38
  s_nop 0
  v_permlane32_swap_b32 v36, v47
  v_permlane32_swap_b32 v38, v39
  v_add_f32 v36, v36, v47
  v_add_f32 v38, v38, v39
  buffer_atomic_add_f32 v36, v19, s[4:7], s34 offen sc1
  s_mov_b32 exec_hi, 0
  buffer_atomic_add_f32 v38, v19, s[4:7], s37 offen sc1
  s_mov_b64 exec, -1
  s_barrier
  v_add_u32 v1, 4, v6
  s_mov_b32 s72, s66
  s_mov_b32 s73, s65
  s_mov_b32 s74, s67
  s_mov_b32 s75, s62
  s_cmp_lg_u32 s62, 0
  s_cbranch_scc1 .fz_kernel_tail
  s_mov_b32 s62, 1
  s_mov_b32 s63, 0x2000000
  s_mov_b32 s64, 0x2800000
  s_mov_b32 s65, 0x1400000
  s_mov_b32 s66, 0x1c42000
  s_mov_b32 s67, 12
  s_mov_b32 s71, 159776
  v_mov_b32 v6, 159832
  s_branch .fz_kernel_q_cons2
.fz_kernel_tail:
  s_mov_b32 s28, s56
  s_mov_b32 s29, s57
  s_mov_b32 s30, 0x400000
  s_mov_b32 s31, 0x00020000
  v_lshlrev_b32 v37, 2, v45
  v_add_u32 v37, 155644, v37
  v_mov_b32 v36, 159952
  v_lshlrev_b32 v38, 11, v18
  v_lshl_add_u32 v38, v17, 4, v38
  s_lshl_b32 s32, s32, 16
  s_lshl_b32 s33, s18, 7
  s_add_u32 s32, s32, s33
  v_lshlrev_b32 v64, 16, v20
  v_and_b32 v65, 0xffff0000, v20
  v_lshlrev_b32 v66, 16, v21
  v_and_b32 v67, 0xffff0000, v21
  v_lshlrev_b32 v68, 16, v22
  v_and_b32 v69, 0xffff0000, v22
  v_lshlrev_b32 v70, 16, v23
  v_and_b32 v71, 0xffff0000, v23
  v_lshlrev_b32 v72, 16, v24
  v_and_b32 v73, 0xffff0000, v24
  v_lshlrev_b32 v74, 16, v25
  v_and_b32 v75, 0xffff0000, v25
  v_lshlrev_b32 v76, 16, v26
  v_and_b32 v77, 0xffff0000, v26
  v_lshlrev_b32 v78, 16, v27
  v_and_b32 v79, 0xffff0000, v27
  v_lshlrev_b32 v80, 16, v28
  v_and_b32 v81, 0xffff0000, v28
  v_lshlrev_b32 v82, 16, v29
  v_and_b32 v83, 0xffff0000, v29
  v_lshlrev_b32 v84, 16, v30
  v_and_b32 v85, 0xffff0000, v30
  v_lshlrev_b32 v86, 16, v31
  v_and_b32 v87, 0xffff0000, v31
  v_lshlrev_b32 v88, 16, v32
  v_and_b32 v89, 0xffff0000, v32
  v_lshlrev_b32 v90, 16, v33
  v_and_b32 v91, 0xffff0000, v33
  v_lshlrev_b32 v92, 16, v34
  v_and_b32 v93, 0xffff0000, v34
  v_lshlrev_b32 v94, 16, v35
  v_and_b32 v95, 0xffff0000, v35
  s_mov_b64 exec, 1
  s_waitcnt vmcnt(0)
  ds_add_u32 v1, v5 offset:0x100
  s_mov_b64 exec, -1
  s_barrier
  ds_read_b32 v40, v37 offset:6400
  ds_read_b32 v42, v37 offset:6912
  ds_read_b32 v36, v36
  s_waitcnt lgkmcnt(0)
  v_cmp_ne_u32 vcc, v36, v45
  s_mov_b64 exec, vcc
  v_pk_fma_f32 v[64:65], v[64:65], v[40:41], v[42:43] op_sel_hi:[1,0,0]
  v_pk_fma_f32 v[66:67], v[66:67], v[40:41], v[42:43] op_sel_hi:[1,0,0]
  v_pk_fma_f32 v[68:69], v[68:69], v[40:41], v[42:43] op_sel_hi:[1,0,0]
  v_pk_fma_f32 v[70:71], v[70:71], v[40:41], v[42:43] op_sel_hi:[1,0,0]
  v_cvt_pk_bf16_f32 v20, v64, v65
  v_cvt_pk_bf16_f32 v21, v66, v67
  v_cvt_pk_bf16_f32 v22, v68, v69
  v_cvt_pk_bf16_f32 v23, v70, v71
  buffer_store_dwordx4 v[20:23], v38, s[28:31], s32 offen offset:0
  v_pk_fma_f32 v[72:73], v[72:73], v[40:41], v[42:43] op_sel_hi:[1,0,0]
  v_pk_fma_f32 v[74:75], v[74:75], v[40:41], v[42:43] op_sel_hi:[1,0,0]
  v_pk_fma_f32 v[76:77], v[76:77], v[40:41], v[42:43] op_sel_hi:[1,0,0]
  v_pk_fma_f32 v[78:79], v[78:79], v[40:41], v[42:43] op_sel_hi:[1,0,0]
  v_cvt_pk_bf16_f32 v24, v72, v73
  v_cvt_pk_bf16_f32 v25, v74, v75
  v_cvt_pk_bf16_f32 v26, v76, v77
  v_cvt_pk_bf16_f32 v27, v78, v79
  buffer_store_dwordx4 v[24:27], v38, s[28:31], s32 offen offset:32
  v_pk_fma_f32 v[80:81], v[80:81], v[40:41], v[42:43] op_sel_hi:[1,0,0]
  v_pk_fma_f32 v[82:83], v[82:83], v[40:41], v[42:43] op_sel_hi:[1,0,0]
  v_pk_fma_f32 v[84:85], v[84:85], v[40:41], v[42:43] op_sel_hi:[1,0,0]
  v_pk_fma_f32 v[86:87], v[86:87], v[40:41], v[42:43] op_sel_hi:[1,0,0]
  v_cvt_pk_bf16_f32 v28, v80, v81
  v_cvt_pk_bf16_f32 v29, v82, v83
  v_cvt_pk_bf16_f32 v30, v84, v85
  v_cvt_pk_bf16_f32 v31, v86, v87
  buffer_store_dwordx4 v[28:31], v38, s[28:31], s32 offen offset:64
  v_pk_fma_f32 v[88:89], v[88:89], v[40:41], v[42:43] op_sel_hi:[1,0,0]
  v_pk_fma_f32 v[90:91], v[90:91], v[40:41], v[42:43] op_sel_hi:[1,0,0]
  v_pk_fma_f32 v[92:93], v[92:93], v[40:41], v[42:43] op_sel_hi:[1,0,0]
  v_pk_fma_f32 v[94:95], v[94:95], v[40:41], v[42:43] op_sel_hi:[1,0,0]
  v_cvt_pk_bf16_f32 v32, v88, v89
  v_cvt_pk_bf16_f32 v33, v90, v91
  v_cvt_pk_bf16_f32 v34, v92, v93
  v_cvt_pk_bf16_f32 v35, v94, v95
  buffer_store_dwordx4 v[32:35], v38, s[28:31], s32 offen offset:96
  s_mov_b64 exec, -1
  s_branch .fz_kernel_fin
.fz_kernel_chain:
  s_setprio 0
  s_bitcmp1_b32 s18, 0
  s_cselect_b32 s8, s52, s50
  s_cselect_b32 s9, s53, s51
  s_mov_b32 s10, 0x700000
  s_mov_b32 s11, 0x00020000
  s_lshl_b32 s12, s16, 8
  s_and_b32 s12, s12, 511
  s_and_b32 s31, s18, 2
  s_lshl_b32 s31, s31, 8
  s_add_u32 s12, s12, s31
  s_mul_i32 s12, s12, 7168
  s_lshl_b32 s31, s17, 2
  s_lshr_b32 s33, s18, 2
  s_add_u32 s31, s31, s33
  s_lshl_b32 s31, s31, 7
  s_add_u32 s12, s12, s31
  v_lshrrev_b32 v13, 3, v2
  v_mul_u32_u24 v13, 229376, v13
  v_and_b32 v11, 7, v2
  v_lshl_add_u32 v13, v11, 4, v13
  s_mov_b32 s24, s44
  s_mov_b32 s25, s45
  s_mov_b32 s26, 0x200000
  s_mov_b32 s27, 0x00020000
  v_lshrrev_b32 v8, 3, v2
  v_and_b32 v9, 7, v2
  v_bfe_u32 v10, v2, 4, 1
  v_lshlrev_b32 v10, 2, v10
  v_xor_b32 v9, v9, v10
  v_lshlrev_b32 v9, 4, v9
  v_lshl_add_u32 v10, v8, 11, v9
  s_mov_b32 s24, s54
  s_mov_b32 s25, s55
  s_mov_b32 s26, 0x700000
  s_mov_b32 s27, 0x00020000
  s_mov_b32 s36, 0x05040100
  s_mov_b32 s37, 0x07060302
  s_and_b32 s20, s16, 1
  s_lshl1_add_u32 s13, s17, s20
  s_lshl_b32 s13, s13, 18
  s_lshl_b32 s14, s18, 7
  s_add_u32 s13, s13, s14
  s_cmp_ge_u32 s17, 14
  s_cbranch_scc1 .fz_kernel_c_nl
  s_mov_b32 s38, 0
.fz_kernel_kw66:
  s_sleep 2
  ds_read_b32 v7, v6 offset:0
  s_add_u32 s38, s38, 1
  s_waitcnt lgkmcnt(0)
  v_readfirstlane_b32 s31, v7
  s_bcnt1_i32_b32 s31, s31
  s_cmp_ge_u32 s31, 16
  s_cbranch_scc1 .fz_kernel_kw66d
  s_cmp_lt_u32 s38, 1048576
  s_cbranch_scc1 .fz_kernel_kw66
.fz_kernel_kw66d:
  buffer_load_dwordx4 v[112:115], v13, s[8:11], s12 offen nt
  s_add_u32 s12, s12, 7168
  s_waitcnt vmcnt(2)
  buffer_load_dwordx4 v[116:119], v13, s[8:11], s12 offen nt
  s_add_u32 s12, s12, 7168
  s_waitcnt vmcnt(2)
  buffer_load_dwordx4 v[120:123], v13, s[8:11], s12 offen nt
  s_add_u32 s12, s12, 7168
  s_waitcnt vmcnt(2)
  buffer_load_dwordx4 v[124:127], v13, s[8:11], s12 offen nt
  s_add_u32 s12, s12, 7168
  s_waitcnt vmcnt(2)
  buffer_load_dwordx4 v[128:131], v13, s[8:11], s12 offen nt
  s_add_u32 s12, s12, 7168
  s_waitcnt vmcnt(2)
  buffer_load_dwordx4 v[132:135], v13, s[8:11], s12 offen nt
  s_add_u32 s12, s12, 7168
  s_waitcnt vmcnt(2)
  buffer_load_dwordx4 v[136:139], v13, s[8:11], s12 offen nt
  s_add_u32 s12, s12, 7168
  s_waitcnt vmcnt(2)
  buffer_load_dwordx4 v[140:143], v13, s[8:11], s12 offen nt
  s_add_u32 s12, s12, 7168
  s_waitcnt vmcnt(2)
  buffer_load_dwordx4 v[144:147], v13, s[8:11], s12 offen nt
  s_add_u32 s12, s12, 7168
  s_waitcnt vmcnt(2)
  buffer_load_dwordx4 v[148:151], v13, s[8:11], s12 offen nt
  s_add_u32 s12, s12, 7168
  s_waitcnt vmcnt(2)
  buffer_load_dwordx4 v[152:155], v13, s[8:11], s12 offen nt
  s_add_u32 s12, s12, 7168
  s_waitcnt vmcnt(2)
  buffer_load_dwordx4 v[156:159], v13, s[8:11], s12 offen nt
  s_add_u32 s12, s12, 7168
  s_waitcnt vmcnt(2)
  buffer_load_dwordx4 v[160:163], v13, s[8:11], s12 offen nt
  s_add_u32 s12, s12, 7168
  s_waitcnt vmcnt(2)
  buffer_load_dwordx4 v[164:167], v13, s[8:11], s12 offen nt
  s_add_u32 s12, s12, 7168
  s_waitcnt vmcnt(2)
  buffer_load_dwordx4 v[168:171], v13, s[8:11], s12 offen nt
  s_add_u32 s12, s12, 7168
  s_waitcnt vmcnt(2)
  buffer_load_dwordx4 v[172:175], v13, s[8:11], s12 offen nt
  s_add_u32 s12, s12, 7168
  s_waitcnt vmcnt(2)
  buffer_load_dwordx4 v[176:179], v13, s[8:11], s12 offen nt
  s_add_u32 s12, s12, 7168
  s_waitcnt vmcnt(2)
  buffer_load_dwordx4 v[180:183], v13, s[8:11], s12 offen nt
  s_add_u32 s12, s12, 7168
  s_waitcnt vmcnt(2)
  buffer_load_dwordx4 v[184:187], v13, s[8:11], s12 offen nt
  s_add_u32 s12, s12, 7168
  s_waitcnt vmcnt(2)
  buffer_load_dwordx4 v[188:191], v13, s[8:11], s12 offen nt
  s_add_u32 s12, s12, 7168
  s_waitcnt vmcnt(2)
  buffer_load_dwordx4 v[192:195], v13, s[8:11], s12 offen nt
  s_add_u32 s12, s12, 7168
  s_waitcnt vmcnt(2)
  buffer_load_dwordx4 v[196:199], v13, s[8:11], s12 offen nt
  s_add_u32 s12, s12, 7168
  s_waitcnt vmcnt(2)
  buffer_load_dwordx4 v[200:203], v13, s[8:11], s12 offen nt
  s_add_u32 s12, s12, 7168
  s_waitcnt vmcnt(2)
  buffer_load_dwordx4 v[204:207], v13, s[8:11], s12 offen nt
  s_add_u32 s12, s12, 7168
  s_waitcnt vmcnt(2)
  buffer_load_dwordx4 v[208:211], v13, s[8:11], s12 offen nt
  s_add_u32 s12, s12, 7168
  s_waitcnt vmcnt(2)
  buffer_load_dwordx4 v[212:215], v13, s[8:11], s12 offen nt
  s_add_u32 s12, s12, 7168
  s_waitcnt vmcnt(2)
  buffer_load_dwordx4 v[216:219], v13, s[8:11], s12 offen nt
  s_add_u32 s12, s12, 7168
  s_waitcnt vmcnt(2)
  buffer_load_dwordx4 v[220:223], v13, s[8:11], s12 offen nt
  s_add_u32 s12, s12, 7168
  s_waitcnt vmcnt(2)
  buffer_load_dwordx4 v[224:227], v13, s[8:11], s12 offen nt
  s_add_u32 s12, s12, 7168
  s_waitcnt vmcnt(2)
  buffer_load_dwordx4 v[228:231], v13, s[8:11], s12 offen nt
  s_add_u32 s12, s12, 7168
  s_waitcnt vmcnt(2)
  buffer_load_dwordx4 v[232:235], v13, s[8:11], s12 offen nt
  s_add_u32 s12, s12, 7168
  s_waitcnt vmcnt(2)
  buffer_load_dwordx4 v[236:239], v13, s[8:11], s12 offen nt
  s_add_u32 s12, s12, 7168
  s_waitcnt vmcnt(2)
  buffer_load_dwordx4 v[32:35], v10, s[24:27], s13 offen nt
  s_add_u32 s13, s13, 16384
  s_waitcnt vmcnt(2)
  buffer_load_dwordx4 v[36:39], v10, s[24:27], s13 offen nt
  s_add_u32 s13, s13, 16384
  s_waitcnt vmcnt(2)
  buffer_load_dwordx4 v[40:43], v10, s[24:27], s13 offen nt
  s_add_u32 s13, s13, 16384
  s_waitcnt vmcnt(2)
  buffer_load_dwordx4 v[44:47], v10, s[24:27], s13 offen nt
  s_add_u32 s13, s13, 16384
  s_waitcnt vmcnt(2)
  buffer_load_dwordx4 v[48:51], v10, s[24:27], s13 offen nt
  s_add_u32 s13, s13, 16384
  s_waitcnt vmcnt(2)
  buffer_load_dwordx4 v[52:55], v10, s[24:27], s13 offen nt
  s_add_u32 s13, s13, 16384
  s_waitcnt vmcnt(2)
  buffer_load_dwordx4 v[56:59], v10, s[24:27], s13 offen nt
  s_add_u32 s13, s13, 16384
  s_waitcnt vmcnt(2)
  buffer_load_dwordx4 v[60:63], v10, s[24:27], s13 offen nt
  s_add_u32 s13, s13, 16384
  s_waitcnt vmcnt(2)
  buffer_load_dwordx4 v[64:67], v10, s[24:27], s13 offen nt
  s_add_u32 s13, s13, 16384
  s_waitcnt vmcnt(2)
  buffer_load_dwordx4 v[68:71], v10, s[24:27], s13 offen nt
  s_add_u32 s13, s13, 16384
  s_waitcnt vmcnt(2)
  buffer_load_dwordx4 v[72:75], v10, s[24:27], s13 offen nt
  s_add_u32 s13, s13, 16384
  s_waitcnt vmcnt(2)
  buffer_load_dwordx4 v[76:79], v10, s[24:27], s13 offen nt
  s_add_u32 s13, s13, 16384
  s_waitcnt vmcnt(2)
  buffer_load_dwordx4 v[240:243], v10, s[24:27], s13 offen nt
  s_add_u32 s13, s13, 16384
  s_waitcnt vmcnt(2)
  buffer_load_dwordx4 v[244:247], v10, s[24:27], s13 offen nt
  s_add_u32 s13, s13, 16384
  s_waitcnt vmcnt(2)
  buffer_load_dwordx4 v[248:251], v10, s[24:27], s13 offen nt
  s_add_u32 s13, s13, 16384
  s_waitcnt vmcnt(2)
  buffer_load_dwordx4 v[252:255], v10, s[24:27], s13 offen nt
  s_add_u32 s13, s13, 16384
  s_waitcnt vmcnt(2)
  v_mov_b32 v16, 0x3f803f80
  v_mov_b32 v17, 0x3f803f80
  v_mov_b32 v18, 0x3f803f80
  v_mov_b32 v19, 0x3f803f80
  s_waitcnt vmcnt(0)
  s_barrier
  v_perm_b32 v80, v116, v112, s36
  v_perm_b32 v84, v116, v112, s37
  v_perm_b32 v88, v117, v113, s36
  v_perm_b32 v92, v117, v113, s37
  v_perm_b32 v96, v118, v114, s36
  v_perm_b32 v100, v118, v114, s37
  v_perm_b32 v104, v119, v115, s36
  v_perm_b32 v108, v119, v115, s37
  v_perm_b32 v81, v124, v120, s36
  v_perm_b32 v85, v124, v120, s37
  v_perm_b32 v89, v125, v121, s36
  v_perm_b32 v93, v125, v121, s37
  v_perm_b32 v97, v126, v122, s36
  v_perm_b32 v101, v126, v122, s37
  v_perm_b32 v105, v127, v123, s36
  v_perm_b32 v109, v127, v123, s37
  v_perm_b32 v82, v132, v128, s36
  v_perm_b32 v86, v132, v128, s37
  v_perm_b32 v90, v133, v129, s36
  v_perm_b32 v94, v133, v129, s37
  v_perm_b32 v98, v134, v130, s36
  v_perm_b32 v102, v134, v130, s37
  v_perm_b32 v106, v135, v131, s36
  v_perm_b32 v110, v135, v131, s37
  v_perm_b32 v83, v140, v136, s36
  v_perm_b32 v87, v140, v136, s37
  v_perm_b32 v91, v141, v137, s36
  v_perm_b32 v95, v141, v137, s37
  v_perm_b32 v99, v142, v138, s36
  v_perm_b32 v103, v142, v138, s37
  v_perm_b32 v107, v143, v139, s36
  v_perm_b32 v111, v143, v139, s37
  v_perm_b32 v112, v148, v144, s36
  v_perm_b32 v116, v148, v144, s37
  v_perm_b32 v120, v149, v145, s36
  v_perm_b32 v124, v149, v145, s37
  v_perm_b32 v128, v150, v146, s36
  v_perm_b32 v132, v150, v146, s37
  v_perm_b32 v136, v151, v147, s36
  v_perm_b32 v140, v151, v147, s37
  v_perm_b32 v113, v156, v152, s36
  v_perm_b32 v117, v156, v152, s37
  v_perm_b32 v121, v157, v153, s36
  v_perm_b32 v125, v157, v153, s37
  v_perm_b32 v129, v158, v154, s36
  v_perm_b32 v133, v158, v154, s37
  v_perm_b32 v137, v159, v155, s36
  v_perm_b32 v141, v159, v155, s37
  v_perm_b32 v114, v164, v160, s36
  v_perm_b32 v118, v164, v160, s37
  v_perm_b32 v122, v165, v161, s36
  v_perm_b32 v126, v165, v161, s37
  v_perm_b32 v130, v166, v162, s36
  v_perm_b32 v134, v166, v162, s37
  v_perm_b32 v138, v167, v163, s36
  v_perm_b32 v142, v167, v163, s37
  v_perm_b32 v115, v172, v168, s36
  v_perm_b32 v119, v172, v168, s37
  v_perm_b32 v123, v173, v169, s36
  v_perm_b32 v127, v173, v169, s37
  v_perm_b32 v131, v174, v170, s36
  v_perm_b32 v135, v174, v170, s37
  v_perm_b32 v139, v175, v171, s36
  v_perm_b32 v143, v175, v171, s37
  v_perm_b32 v144, v180, v176, s36
  v_perm_b32 v148, v180, v176, s37
  v_perm_b32 v152, v181, v177, s36
  v_perm_b32 v156, v181, v177, s37
  v_perm_b32 v160, v182, v178, s36
  v_perm_b32 v164, v182, v178, s37
  v_perm_b32 v168, v183, v179, s36
  v_perm_b32 v172, v183, v179, s37
  v_perm_b32 v145, v188, v184, s36
  v_perm_b32 v149, v188, v184, s37
  v_perm_b32 v153, v189, v185, s36
  v_perm_b32 v157, v189, v185, s37
  v_perm_b32 v161, v190, v186, s36
  v_perm_b32 v165, v190, v186, s37
  v_perm_b32 v169, v191, v187, s36
  v_perm_b32 v173, v191, v187, s37
  v_perm_b32 v146, v196, v192, s36
  v_perm_b32 v150, v196, v192, s37
  v_perm_b32 v154, v197, v193, s36
  v_perm_b32 v158, v197, v193, s37
  v_perm_b32 v162, v198, v194, s36
  v_perm_b32 v166, v198, v194, s37
  v_perm_b32 v170, v199, v195, s36
  v_perm_b32 v174, v199, v195, s37
  v_perm_b32 v147, v204, v200, s36
  v_perm_b32 v151, v204, v200, s37
  v_perm_b32 v155, v205, v201, s36
  v_perm_b32 v159, v205, v201, s37
  v_perm_b32 v163, v206, v202, s36
  v_perm_b32 v167, v206, v202, s37
  v_perm_b32 v171, v207, v203, s36
  v_perm_b32 v175, v207, v203, s37
  v_perm_b32 v176, v212, v208, s36
  v_perm_b32 v180, v212, v208, s37
  v_perm_b32 v184, v213, v209, s36
  v_perm_b32 v188, v213, v209, s37
  v_perm_b32 v192, v214, v210, s36
  v_perm_b32 v196, v214, v210, s37
  v_perm_b32 v200, v215, v211, s36
  v_perm_b32 v204, v215, v211, s37
  v_perm_b32 v177, v220, v216, s36
  v_perm_b32 v181, v220, v216, s37
  v_perm_b32 v185, v221, v217, s36
  v_perm_b32 v189, v221, v217, s37
  v_perm_b32 v193, v222, v218, s36
  v_perm_b32 v197, v222, v218, s37
  v_perm_b32 v201, v223, v219, s36
  v_perm_b32 v205, v223, v219, s37
  v_perm_b32 v178, v228, v224, s36
  v_perm_b32 v182, v228, v224, s37
  v_perm_b32 v186, v229, v225, s36
  v_perm_b32 v190, v229, v225, s37
  v_perm_b32 v194, v230, v226, s36
  v_perm_b32 v198, v230, v226, s37
  v_perm_b32 v202, v231, v227, s36
  v_perm_b32 v206, v231, v227, s37
  v_perm_b32 v179, v236, v232, s36
  v_perm_b32 v183, v236, v232, s37
  v_perm_b32 v187, v237, v233, s36
  v_perm_b32 v191, v237, v233, s37
  v_perm_b32 v195, v238, v234, s36
  v_perm_b32 v199, v238, v234, s37
  v_perm_b32 v203, v239, v235, s36
  v_perm_b32 v207, v239, v235, s37
  v_mfma_f32_16x16x32_bf16 v[208:211], v[16:19], v[80:83], 0
  v_mfma_f32_16x16x32_bf16 v[212:215], v[16:19], v[84:87], 0
  v_mfma_f32_16x16x32_bf16 v[216:219], v[16:19], v[88:91], 0
  v_mfma_f32_16x16x32_bf16 v[220:223], v[16:19], v[92:95], 0
  v_mfma_f32_16x16x32_bf16 v[224:227], v[16:19], v[96:99], 0
  v_mfma_f32_16x16x32_bf16 v[228:231], v[16:19], v[100:103], 0
  v_mfma_f32_16x16x32_bf16 v[232:235], v[16:19], v[104:107], 0
  v_mfma_f32_16x16x32_bf16 v[236:239], v[16:19], v[108:111], 0
  v_mfma_f32_16x16x32_bf16 v[208:211], v[16:19], v[112:115], v[208:211]
  v_mfma_f32_16x16x32_bf16 v[212:215], v[16:19], v[116:119], v[212:215]
  v_mfma_f32_16x16x32_bf16 v[216:219], v[16:19], v[120:123], v[216:219]
  v_mfma_f32_16x16x32_bf16 v[220:223], v[16:19], v[124:127], v[220:223]
  v_mfma_f32_16x16x32_bf16 v[224:227], v[16:19], v[128:131], v[224:227]
  v_mfma_f32_16x16x32_bf16 v[228:231], v[16:19], v[132:135], v[228:231]
  v_mfma_f32_16x16x32_bf16 v[232:235], v[16:19], v[136:139], v[232:235]
  v_mfma_f32_16x16x32_bf16 v[236:239], v[16:19], v[140:143], v[236:239]
  v_mfma_f32_16x16x32_bf16 v[208:211], v[16:19], v[144:147], v[208:211]
  v_mfma_f32_16x16x32_bf16 v[212:215], v[16:19], v[148:151], v[212:215]
  v_mfma_f32_16x16x32_bf16 v[216:219], v[16:19], v[152:155], v[216:219]
  v_mfma_f32_16x16x32_bf16 v[220:223], v[16:19], v[156:159], v[220:223]
  v_mfma_f32_16x16x32_bf16 v[224:227], v[16:19], v[160:163], v[224:227]
  v_mfma_f32_16x16x32_bf16 v[228:231], v[16:19], v[164:167], v[228:231]
  v_mfma_f32_16x16x32_bf16 v[232:235], v[16:19], v[168:171], v[232:235]
  v_mfma_f32_16x16x32_bf16 v[236:239], v[16:19], v[172:175], v[236:239]
  v_mfma_f32_16x16x32_bf16 v[208:211], v[16:19], v[176:179], v[208:211]
  v_mfma_f32_16x16x32_bf16 v[212:215], v[16:19], v[180:183], v[212:215]
  v_mfma_f32_16x16x32_bf16 v[216:219], v[16:19], v[184:187], v[216:219]
  v_mfma_f32_16x16x32_bf16 v[220:223], v[16:19], v[188:191], v[220:223]
  v_mfma_f32_16x16x32_bf16 v[224:227], v[16:19], v[192:195], v[224:227]
  v_mfma_f32_16x16x32_bf16 v[228:231], v[16:19], v[196:199], v[228:231]
  v_mfma_f32_16x16x32_bf16 v[232:235], v[16:19], v[200:203], v[232:235]
  v_mfma_f32_16x16x32_bf16 v[236:239], v[16:19], v[204:207], v[236:239]
  s_nop 0
  v_add_f32 v28, v209, v208 row_ror:8 row_mask:0xf bank_mask:0x3
  v_add_f32 v29, v213, v212 row_ror:8 row_mask:0xf bank_mask:0x3
  v_add_f32 v30, v217, v216 row_ror:8 row_mask:0xf bank_mask:0x3
  v_add_f32 v31, v221, v220 row_ror:8 row_mask:0xf bank_mask:0x3
  v_add_f32 v28, v224, v225 row_ror:8 row_mask:0xf bank_mask:0xc
  v_add_f32 v29, v228, v229 row_ror:8 row_mask:0xf bank_mask:0xc
  v_add_f32 v30, v232, v233 row_ror:8 row_mask:0xf bank_mask:0xc
  v_add_f32 v31, v236, v237 row_ror:8 row_mask:0xf bank_mask:0xc
  v_mul_f32 v28, 0.0009765625, v28
  v_mul_f32 v29, 0.0009765625, v29
  v_mul_f32 v30, 0.0009765625, v30
  v_mul_f32 v31, 0.0009765625, v31
.fz_kernel_c_np:
  v_mov_b32 v27, v6
  s_mov_b32 s72, s66
  s_mov_b32 s73, s65
  s_mov_b32 s74, s67
  s_mov_b32 s75, s62
  s_cmp_lg_u32 s62, 0
  s_cbranch_scc1 .fz_kernel_c_n2
  s_mov_b32 s62, 1
  s_mov_b32 s63, 0x2000000
  s_mov_b32 s64, 0x2800000
  s_mov_b32 s65, 0x1400000
  s_mov_b32 s66, 0x1c42000
  s_mov_b32 s67, 12
  s_mov_b32 s71, 159776
  v_mov_b32 v6, 159832
.fz_kernel_c_n2:
  s_lshr_b32 s21, s17, 3
  s_add_u32 s70, s18, s21
  s_lshl1_add_u32 s70, s17, s70
  s_and_b32 s70, s70, 15
  s_cmp_eq_u32 s75, 0
  s_cselect_b32 s3, 32, 0
  s_cselect_b32 s70, s70, s18
  s_and_b32 s20, s16, 1
  s_mov_b32 s34, 0x00030003
  s_mov_b32 s35, 0x00030003
  s_mov_b32 s71, 0
  s_lshl1_add_u32 s26, s17, s20
  v_lshrrev_b32 v8, 4, v2
  v_lshrrev_b32 v12, 5, v2
  v_lshlrev_b32 v12, 10, v12
  v_bfe_u32 v14, v2, 3, 2
  v_lshl_add_u32 v12, v14, 8, v12
  v_and_b32 v14, 7, v2
  v_lshl_add_u32 v12, v14, 1, v12
  v_lshlrev_b32 v10, 7, v2
  v_lshrrev_b32 v14, 1, v8
  v_mul_u32_u24 v7, 12288, v14
  v_and_b32 v14, 1, v8
  v_lshl_add_u32 v7, v14, 11, v7
  v_bfe_u32 v14, v2, 2, 2
  v_lshl_add_u32 v7, v14, 7, v7
  v_lshrrev_b32 v14, 1, v14
  v_lshl_add_u32 v14, s20, 1, v14
  v_lshl_add_u32 v7, v14, 5, v7
  v_and_b32 v14, 3, v2
  v_lshl_add_u32 v7, v14, 3, v7
  v_add_u32 v7, 65536, v7
  v_xor_b32 v9, 32, v7
  s_and_b32 s61, s18, 2
  s_add_u32 s61, s61, s20
  s_and_b32 s32, s18, 1
  s_lshl2_add_u32 s32, s32, s61
  s_lshl_b32 s32, s32, 9
  s_lshl_b32 s22, s17, 13
  s_add_u32 s32, s32, s22
  s_and_b32 s22, s18, 8
  s_lshl_b32 s22, s22, 9
  s_add_u32 s32, s32, s22
  s_and_b32 s22, s18, 4
  s_lshl_b32 s22, s22, 6
  s_add_u32 s32, s32, s22
  s_add_u32 s32, s32, s72
  s_add_u32 s32, s32, 40960
  s_lshl_b32 s61, s61, 16
  s_lshl_b32 s33, s26, 12
  s_add_u32 s33, s33, s72
  s_add_u32 s33, s33, 40960
  s_mul_i32 s39, s18, 28
  s_add_u32 s39, s39, s26
  s_lshl_b32 s39, s39, 8
  s_add_u32 s39, s39, s72
  s_add_u32 s39, s39, 155648
  s_lshl4_add_u32 s60, s18, s17
  s_lshl_b32 s60, s60, 10
  s_add_u32 s60, s60, 0x1c84000
  s_add_u32 s21, s74, 0x1800008
  s_sub_u32 s22, s72, 32768
  v_mov_b32 v14, s21
  v_mov_b32 v15, s22
  v_cmp_gt_u32 vcc, 16, v2
  s_nop 1
  v_cndmask_b32 v14, v15, v14, vcc
  v_lshl_add_u32 v14, v2, 11, v14
  s_lshl_b32 s25, s17, 7
  s_lshl_b32 s22, 1, s18
  v_mov_b32 v15, s22
  v_lshlrev_b32 v16, 3, v2
  s_and_b32 s21, s2, 7
  s_lshl_b32 s21, s21, 11
  s_lshl_b32 s22, s20, 10
  s_add_u32 s21, s21, s22
  s_add_u32 s21, s21, s72
  s_lshl_b32 s22, s20, 12
  s_add_u32 s22, s22, s72
  s_add_u32 s22, s22, 16384
  s_add_u32 s23, s22, 8192
  s_add_u32 s24, s22, 16384
  v_and_b32 v17, 1, v8
  v_lshlrev_b32 v17, 13, v17
  v_lshrrev_b32 v18, 1, v8
  v_mul_u32_u24 v18, 320, v18
  v_add_u32 v17, v17, v18
  v_bfe_u32 v18, v2, 3, 1
  v_lshl_add_u32 v17, v18, 9, v17
  v_bfe_u32 v18, v2, 2, 1
  v_lshl_add_u32 v17, v18, 7, v17
  v_and_b32 v18, 3, v2
  v_lshl_add_u32 v17, v18, 3, v17
  s_lshl_b32 s27, s20, 14
  s_add_u32 s27, s27, 114688
  v_add_u32 v17, s27, v17
  v_xor_b32 v18, 64, v17
  v_and_b32 v20, 7, v2
  v_lshlrev_b32 v20, 5, v20
  v_and_b32 v21, 8, v2
  v_lshl_add_u32 v20, v21, 1, v20
  v_and_b32 v21, 31, v2
  v_lshlrev_b32 v21, 4, v21
  v_lshrrev_b32 v22, 5, v2
  v_lshl_add_u32 v21, v22, 11, v21
  v_mov_b32 v23, 0.0009765625
  v_mov_b32 v24, 9.5367431640625e-07
  v_mov_b32 v25, 1e-05
  v_add_u32 v26, 155648, v16
  s_lshl_b32 s14, s17, 9
  s_add_u32 s14, s14, s72
  s_add_u32 s14, s14, 16384
  s_add_u32 s15, s14, 8192
  v_add_u32 v13, s27, v3
  s_barrier
.fz_kernel_c_n3:
  s_mov_b32 s13, 0xff0000
  s_cmp_eq_u32 s20, 0
  s_cbranch_scc1 .fz_kernel_c_nf
  s_cmp_eq_u32 s75, 0
  s_cselect_b32 exec_lo, 0xffff, s13
  s_mov_b32 exec_hi, 0
  s_mov_b32 s38, 0
.fz_kernel_cw67:
  s_sleep 1
  ds_read_u8 v22, v27 offset:268
  s_add_u32 s38, s38, 1
  s_waitcnt lgkmcnt(0)
  v_cmp_gt_u32 vcc, 4, v22
  s_cbranch_vccz .fz_kernel_cw67d
  s_cmp_lt_u32 s38, 8388608
  s_cbranch_scc1 .fz_kernel_cw67
.fz_kernel_cw67d:
  buffer_atomic_or v15, v14, s[4:7], s25 offen sc1
  s_mov_b64 exec, -1
.fz_kernel_c_nf:
  s_add_u32 s13, s19, s74
  s_mov_b64 exec, 1
  buffer_load_dword v11, v4, s[4:7], s13 offen offset:8 sc1
  s_mov_b64 exec, -1
  ds_write_b128 v13, v[32:35] offset:0
  ds_write_b128 v13, v[36:39] offset:1024
  ds_write_b128 v13, v[40:43] offset:2048
  ds_write_b128 v13, v[44:47] offset:3072
  ds_write_b128 v13, v[48:51] offset:4096
  ds_write_b128 v13, v[52:55] offset:5120
  ds_write_b128 v13, v[56:59] offset:6144
  ds_write_b128 v13, v[60:63] offset:7168
  ds_write_b128 v13, v[64:67] offset:8192
  ds_write_b128 v13, v[68:71] offset:9216
  ds_write_b128 v13, v[72:75] offset:10240
  ds_write_b128 v13, v[76:79] offset:11264
  ds_write_b128 v13, v[240:243] offset:12288
  ds_write_b128 v13, v[244:247] offset:13312
  ds_write_b128 v13, v[248:251] offset:14336
  ds_write_b128 v13, v[252:255] offset:15360
  v_and_b32 v14, 1, v2
  v_lshlrev_b32 v14, 10, v14
  v_lshl_add_u32 v14, v8, 14, v14
  v_add_u32 v14, s61, v14
  s_waitcnt lgkmcnt(0)
  s_cmp_lg_u32 s75, 0
  s_cbranch_scc1 .fz_kernel_c_nw
  v_mov_b32 v13, v9
  s_lshl_b32 s21, s18, 10
  s_add_u32 s21, s21, s72
  s_cmp_lg_u32 s20, 0
  s_cbranch_scc1 .fz_kernel_c_c7
  s_add_u32 s22, s19, s74
  s_add_u32 s23, s14, 16384
  s_mov_b64 exec, 1
  s_mov_b32 s38, 0
  s_branch .fz_kernel_c_c00
.fz_kernel_c_c0:
  s_sleep 6
  buffer_load_dword v11, v4, s[4:7], s22 offen offset:8 sc1
.fz_kernel_c_c00:
  s_add_u32 s38, s38, 1
  s_waitcnt vmcnt(0)
  ds_or_b32 v6, v11 offset:0x114
  v_or_b32 v11, v11, v15
  v_cmp_ne_u32 vcc, 0xffff, v11
  s_cbranch_vccz .fz_kernel_c_c1
  s_cmp_lt_u32 s38, 131072
  s_cbranch_scc1 .fz_kernel_c_c0
.fz_kernel_c_c1:
  s_mov_b32 s38, 0
.fz_kernel_cw68:
  s_sleep 1
  ds_read_u8 v22, v27 offset:268
  s_add_u32 s38, s38, 1
  s_waitcnt lgkmcnt(0)
  v_cmp_gt_u32 vcc, 4, v22
  s_cbranch_vccz .fz_kernel_cw68d
  s_cmp_lt_u32 s38, 8388608
  s_cbranch_scc1 .fz_kernel_cw68
.fz_kernel_cw68d:
  ds_or_b32 v6, v11 offset:0x114
  s_mov_b64 exec, -1
  buffer_load_dwordx2 v[240:241], v16, s[4:7], s14 offen
  buffer_load_dwordx2 v[242:243], v16, s[4:7], s15 offen
  buffer_load_dwordx2 v[244:245], v16, s[4:7], s23 offen
  s_lshl_b32 s23, s17, 6
  s_add_u32 s23, s23, s21
  s_lshl_b32 s24, s17, 18
  s_add_u32 s24, s24, 1
  v_and_b32 v19, 0x38, v2
  v_lshl_add_u32 v19, v19, 8, s24
  v_and_b32 v208, 7, v2
  v_lshl_add_u32 v19, v208, 5, v19
  s_mov_b32 s38, 0
.fz_kernel_cw69:
  s_sleep 1
  ds_read_u8 v22, v6 offset:272
  s_add_u32 s38, s38, 1
  s_waitcnt lgkmcnt(0)
  v_cmp_gt_u32 vcc, 2, v22
  s_cbranch_vccz .fz_kernel_cw69d
  s_cmp_lt_u32 s38, 8388608
  s_cbranch_scc1 .fz_kernel_cw69
.fz_kernel_cw69d:
  ds_read_b64_tr_b16 v[32:33], v7 offset:0
  ds_read_b64_tr_b16 v[34:35], v7 offset:512
  ds_read_b64_tr_b16 v[36:37], v13 offset:0
  ds_read_b64_tr_b16 v[38:39], v13 offset:512
  ds_read_b64_tr_b16 v[40:41], v7 offset:4096
  ds_read_b64_tr_b16 v[42:43], v7 offset:4608
  ds_read_b64_tr_b16 v[44:45], v13 offset:4096
  ds_read_b64_tr_b16 v[46:47], v13 offset:4608
  ds_read_b64_tr_b16 v[48:49], v7 offset:8192
  ds_read_b64_tr_b16 v[50:51], v7 offset:8704
  ds_read_b64_tr_b16 v[52:53], v13 offset:8192
  ds_read_b64_tr_b16 v[54:55], v13 offset:8704
  s_waitcnt lgkmcnt(0)
  v_xor_b32 v7, 64, v7
  v_xor_b32 v13, 64, v13
  ds_read_b64_tr_b16 v[56:57], v7 offset:1024
  ds_read_b64_tr_b16 v[58:59], v7 offset:1536
  ds_read_b64_tr_b16 v[60:61], v13 offset:1024
  ds_read_b64_tr_b16 v[62:63], v13 offset:1536
  ds_read_b64_tr_b16 v[64:65], v7 offset:5120
  ds_read_b64_tr_b16 v[66:67], v7 offset:5632
  ds_read_b64_tr_b16 v[68:69], v13 offset:5120
  ds_read_b64_tr_b16 v[70:71], v13 offset:5632
  ds_read_b64_tr_b16 v[72:73], v7 offset:9216
  ds_read_b64_tr_b16 v[74:75], v7 offset:9728
  ds_read_b64_tr_b16 v[76:77], v13 offset:9216
  ds_read_b64_tr_b16 v[78:79], v13 offset:9728
  s_waitcnt lgkmcnt(0)
  s_waitcnt vmcnt(0)
  v_fma_f32 v208, -v240, v240, v242
  v_fma_f32 v209, -v241, v241, v243
  v_rsq_f32 v208, abs(v208)
  v_rsq_f32 v209, abs(v209)
  v_mul_f32 v208, v208, v244
  v_mul_f32 v209, v209, v245
  v_and_b32 v208, -2, v208
  v_or_b32 v209, 1, v209
  v_cmp_gt_f32 vcc, v209, v208
  v_max_f32 v9, v208, v209
  s_nop 0
  v_cndmask_b32 v210, v240, v241, vcc
  v_max_f32 v7, v9, v9 row_ror:8 row_mask:0xf bank_mask:0xf
  v_cndmask_b32 v211, v242, v243, vcc
  s_nop 0
  v_max_f32 v7, v7, v7 row_ror:4 row_mask:0xf bank_mask:0xf
  s_nop 1
  v_max_f32 v7, v7, v7 row_ror:2 row_mask:0xf bank_mask:0xf
  s_nop 1
  v_max_f32 v7, v7, v7 row_ror:1 row_mask:0xf bank_mask:0xf
  s_nop 1
  v_max_f32 v7, v7, v7 row_bcast:15 row_mask:0xa bank_mask:0xf
  s_nop 1
  v_max_f32 v7, v7, v7 row_bcast:31 row_mask:0xc bank_mask:0xf
  v_and_b32 v209, 1, v9
  v_lshl_add_u32 v209, v209, 4, v19
  v_readlane_b32 s22, v7, 63
  v_mov_b32 v208, v9
  s_nop 0
  v_cmp_eq_u32 vcc, s22, v9
  s_ff1_i32_b64 s22, vcc
  s_lshl_b64 exec, 1, s22
  buffer_store_dwordx4 v[208:211], v4, s[4:7], s23 offen sc1
  s_mov_b64 exec, -1
.fz_kernel_c_c2:
  s_cmp_lg_u32 s20, 0
  s_cbranch_scc1 .fz_kernel_c_c21
  s_call_b64 s[68:69], .fz_kernel_c_coef
  ds_write_b64 v26, v[248:249] offset:4608
  ds_write_b64 v26, v[250:251] offset:5120
  ds_write_b64 v26, v[252:253] offset:6400
  ds_write_b64 v26, v[254:255] offset:6912
.fz_kernel_c_c21:
.fz_kernel_c_c22:
  s_cmp_le_u32 s3, 28
  s_cbranch_scc1 .fz_kernel_c_c3
  s_barrier
  s_sub_u32 s3, s3, 1
  s_branch .fz_kernel_c_c22
.fz_kernel_c_c3:
  v_lshlrev_b32 v22, 6, v2
  s_mov_b64 exec, 0xffff
  s_mov_b32 s38, 0
.fz_kernel_c_c4:
  buffer_load_dwordx4 v[224:227], v22, s[4:7], s21 offen sc1
  s_add_u32 s38, s38, 1
  s_mov_b32 s46, 0
  s_call_b64 s[0:1], .fz_kernel_hw
  s_waitcnt vmcnt(0)
  v_min_u32 v9, v225, v227
  v_max_f32 v7, v224, v224 row_ror:8 row_mask:0xf bank_mask:0xf
  v_cmp_eq_u32 vcc, 0, v9
  s_cbranch_vccz .fz_kernel_c_c5
  s_cmp_lt_u32 s38, 131072
  s_cbranch_scc1 .fz_kernel_c_c4
.fz_kernel_c_c5:
  s_waitcnt lgkmcnt(0)
  v_max_f32 v7, v7, v7 row_ror:4 row_mask:0xf bank_mask:0xf
  s_nop 1
  v_max_f32 v7, v7, v7 row_ror:2 row_mask:0xf bank_mask:0xf
  s_nop 1
  v_max_f32 v7, v7, v7 row_ror:1 row_mask:0xf bank_mask:0xf
  v_cmp_eq_u32 vcc, v7, v224
  s_or_b32 s22, vcc_lo, 0x8000
  s_ff1_i32_b32 s22, s22
  v_readlane_b32 s77, v225, s22
  s_mov_b64 exec, s[34:35]
  s_and_b32 s77, s77, 0x3c38f0
  s_add_u32 s78, s77, s73
  buffer_load_dwordx4 v[208:211], v14, s[4:7], s78 offen offset:0
  buffer_load_dwordx4 v[212:215], v14, s[4:7], s78 offen offset:256
  buffer_load_dwordx4 v[216:219], v14, s[4:7], s78 offen offset:512
  buffer_load_dwordx4 v[220:223], v14, s[4:7], s78 offen offset:768
  s_mov_b64 exec, -1
  s_cmp_eq_u32 s3, 0
  s_cbranch_scc1 .fz_kernel_hb71
  s_barrier
  s_sub_u32 s3, s3, 1
.fz_kernel_hb71:
  v_readlane_b32 s27, v224, s22
  v_readlane_b32 s23, v226, s22
  v_readlane_b32 s24, v227, s22
  s_lshr_b32 s21, s77, 11
  s_and_b32 s22, s21, 7
  s_and_b32 s21, s21, 0x780
  s_lshl4_add_u32 s21, s22, s21
  s_bfe_u32 s77, s77, 0x40004
  s_add_u32 s77, s77, s21
  v_mov_b32 v11, s23
  v_mov_b32 v15, s24
  s_branch .fz_kernel_c_idx
.fz_kernel_c_nw:
  s_mov_b64 exec, 0xff
  s_mov_b32 s38, 0
.fz_kernel_c_gm:
  buffer_load_dword v9, v10, s[4:7], s21 offen sc1
  s_add_u32 s38, s38, 1
  s_waitcnt vmcnt(0)
  v_cmp_ne_u32 vcc, 0xffff, v9
  s_cbranch_vccz .fz_kernel_c_gmd
  s_sleep 10
  s_cmp_lt_u32 s38, 131072
  s_cbranch_scc1 .fz_kernel_c_gm
.fz_kernel_c_gmd:
  s_mov_b64 exec, -1
  buffer_load_dwordx4 v[208:211], v3, s[4:7], s22 offen offset:0
  buffer_load_dwordx4 v[212:215], v3, s[4:7], s23 offen offset:0
  buffer_load_dwordx4 v[216:219], v3, s[4:7], s24 offen offset:0
  buffer_load_dwordx4 v[220:223], v3, s[4:7], s22 offen offset:1024
  buffer_load_dwordx4 v[224:227], v3, s[4:7], s23 offen offset:1024
  buffer_load_dwordx4 v[228:231], v3, s[4:7], s24 offen offset:1024
  buffer_load_dwordx4 v[232:235], v3, s[4:7], s22 offen offset:2048
  buffer_load_dwordx4 v[236:239], v3, s[4:7], s23 offen offset:2048
  buffer_load_dwordx4 v[240:243], v3, s[4:7], s24 offen offset:2048
  buffer_load_dwordx4 v[244:247], v3, s[4:7], s22 offen offset:3072
  buffer_load_dwordx4 v[248:251], v3, s[4:7], s23 offen offset:3072
  buffer_load_dwordx4 v[252:255], v3, s[4:7], s24 offen offset:3072
  s_lshl_b32 s21, s75, 4
  s_add_u32 s21, s21, 159968
  v_mov_b32 v10, s21
  s_lshl_b32 s22, s20, 3
  v_add_u32 v13, s22, v10
  s_waitcnt vmcnt(10)
  v_fma_f32 v212, -v208, v208, v212
  v_fma_f32 v213, -v209, v209, v213
  v_fma_f32 v214, -v210, v210, v214
  v_fma_f32 v215, -v211, v211, v215
  v_rsq_f32 v212, abs(v212)
  v_rsq_f32 v213, abs(v213)
  v_rsq_f32 v214, abs(v214)
  v_rsq_f32 v215, abs(v215)
  s_waitcnt vmcnt(9)
  v_mul_f32 v216, v216, v212
  v_mul_f32 v217, v217, v213
  v_mul_f32 v218, v218, v214
  v_mul_f32 v219, v219, v215
  v_and_or_b32 v216, v216, -16, 0
  v_and_or_b32 v217, v217, -16, 1
  v_and_or_b32 v218, v218, -16, 2
  v_and_or_b32 v219, v219, -16, 3
  v_max3_f32 v9, v216, v217, v218
  v_max_f32 v9, v9, v219
  s_waitcnt vmcnt(7)
  v_fma_f32 v224, -v220, v220, v224
  v_fma_f32 v225, -v221, v221, v225
  v_fma_f32 v226, -v222, v222, v226
  v_fma_f32 v227, -v223, v223, v227
  v_rsq_f32 v224, abs(v224)
  v_rsq_f32 v225, abs(v225)
  v_rsq_f32 v226, abs(v226)
  v_rsq_f32 v227, abs(v227)
  s_waitcnt vmcnt(6)
  v_mul_f32 v228, v228, v224
  v_mul_f32 v229, v229, v225
  v_mul_f32 v230, v230, v226
  v_mul_f32 v231, v231, v227
  v_and_or_b32 v228, v228, -16, 4
  v_and_or_b32 v229, v229, -16, 5
  v_and_or_b32 v230, v230, -16, 6
  v_and_or_b32 v231, v231, -16, 7
  v_max3_f32 v9, v9, v228, v229
  v_max3_f32 v9, v9, v230, v231
  s_waitcnt vmcnt(4)
  v_fma_f32 v236, -v232, v232, v236
  v_fma_f32 v237, -v233, v233, v237
  v_fma_f32 v238, -v234, v234, v238
  v_fma_f32 v239, -v235, v235, v239
  v_rsq_f32 v236, abs(v236)
  v_rsq_f32 v237, abs(v237)
  v_rsq_f32 v238, abs(v238)
  v_rsq_f32 v239, abs(v239)
  s_waitcnt vmcnt(3)
  v_mul_f32 v240, v240, v236
  v_mul_f32 v241, v241, v237
  v_mul_f32 v242, v242, v238
  v_mul_f32 v243, v243, v239
  v_and_or_b32 v240, v240, -16, 8
  v_and_or_b32 v241, v241, -16, 9
  v_and_or_b32 v242, v242, -16, 10
  v_and_or_b32 v243, v243, -16, 11
  v_max3_f32 v9, v9, v240, v241
  v_max3_f32 v9, v9, v242, v243
  s_waitcnt vmcnt(1)
  v_fma_f32 v248, -v244, v244, v248
  v_fma_f32 v249, -v245, v245, v249
  v_fma_f32 v250, -v246, v246, v250
  v_fma_f32 v251, -v247, v247, v251
  v_rsq_f32 v248, abs(v248)
  v_rsq_f32 v249, abs(v249)
  v_rsq_f32 v250, abs(v250)
  v_rsq_f32 v251, abs(v251)
  s_waitcnt vmcnt(0)
  v_mul_f32 v252, v252, v248
  v_mul_f32 v253, v253, v249
  v_mul_f32 v254, v254, v250
  v_mul_f32 v255, v255, v251
  v_and_or_b32 v252, v252, -16, 12
  v_and_or_b32 v253, v253, -16, 13
  v_and_or_b32 v254, v254, -16, 14
  v_and_or_b32 v255, v255, -16, 15
  v_max3_f32 v9, v9, v252, v253
  v_max3_f32 v9, v9, v254, v255
  s_nop 1
  v_max_f32 v7, v9, v9 row_ror:8 row_mask:0xf bank_mask:0xf
  s_nop 1
  v_max_f32 v7, v7, v7 row_ror:4 row_mask:0xf bank_mask:0xf
  s_nop 1
  v_max_f32 v7, v7, v7 row_ror:2 row_mask:0xf bank_mask:0xf
  s_nop 1
  v_max_f32 v7, v7, v7 row_ror:1 row_mask:0xf bank_mask:0xf
  s_nop 1
  v_max_f32 v7, v7, v7 row_bcast:15 row_mask:0xa bank_mask:0xf
  s_nop 1
  v_max_f32 v7, v7, v7 row_bcast:31 row_mask:0xc bank_mask:0xf
  s_nop 0
  v_readlane_b32 s21, v7, 63
  s_nop 1
  v_cmp_eq_u32 vcc, s21, v9
  s_ff1_i32_b64 s22, vcc
  s_lshl_b32 s22, s22, 2
  s_and_b32 s23, s21, 3
  s_add_u32 s22, s22, s23
  s_and_b32 s23, s21, 12
  s_lshl_b32 s23, s23, 6
  s_add_u32 s22, s22, s23
  s_and_b32 s22, s22, 1023
  s_lshl_b32 s23, s20, 10
  s_add_u32 s22, s22, s23
  s_add_u32 s22, s22, 1
  v_mov_b32 v224, s21
  v_mov_b32 v225, s22
  s_mov_b64 exec, 1
  ds_write_b64 v13, v[224:225]
  s_mov_b32 s38, 0
.fz_kernel_c_am:
  ds_read_b128 v[224:227], v10
  s_add_u32 s38, s38, 1
  s_waitcnt lgkmcnt(0)
  v_min_u32 v9, v225, v227
  v_cmp_eq_u32 vcc, 0, v9
  s_cbranch_vccz .fz_kernel_c_amd
  s_cmp_lt_u32 s38, 524288
  s_cbranch_scc1 .fz_kernel_c_am
.fz_kernel_c_amd:
  v_cmp_gt_f32 vcc, v226, v224
  s_nop 1
  v_cndmask_b32 v225, v225, v227, vcc
  v_cndmask_b32 v224, v224, v226, vcc
  v_readfirstlane_b32 s77, v225
  v_readfirstlane_b32 s27, v224
  s_mov_b64 exec, -1
  s_sub_u32 s21, s77, 1
  s_and_b32 s21, s21, 2047
  s_lshl_b32 s21, s21, 2
  s_add_u32 s21, s21, s72
  s_add_u32 s21, s21, 16384
  s_add_u32 s22, s21, 8192
  buffer_load_dword v11, v4, s[4:7], s21 offen
  buffer_load_dword v15, v4, s[4:7], s22 offen
  s_mov_b64 exec, s[34:35]
  s_sub_u32 s77, s77, 1
  s_and_b32 s77, s77, 2047
  s_lshr_b32 s78, s77, 7
  s_lshl_b32 s78, s78, 18
  s_and_b32 s21, s77, 0x70
  s_lshl_b32 s21, s21, 7
  s_add_u32 s78, s78, s21
  s_and_b32 s21, s77, 15
  s_lshl_b32 s21, s21, 4
  s_add_u32 s78, s78, s21
  s_add_u32 s78, s78, s73
  buffer_load_dwordx4 v[208:211], v14, s[4:7], s78 offen offset:0
  buffer_load_dwordx4 v[212:215], v14, s[4:7], s78 offen offset:256
  buffer_load_dwordx4 v[216:219], v14, s[4:7], s78 offen offset:512
  buffer_load_dwordx4 v[220:223], v14, s[4:7], s78 offen offset:768
  s_mov_b64 exec, -1
.fz_kernel_c_idx:
  s_lshr_b32 s21, s77, 7
  s_and_b32 s79, s77, 127
  s_add_u32 s79, s79, 1
  s_cmp_eq_u32 s21, s17
  s_cselect_b32 s79, s79, 0
  v_mov_b32 v1, -1477.3197218702985
  v_mul_f32 v1, s27, v1
  v_exp_f32 v1, v1
  s_nop 0
  v_add_f32 v1, 1.0, v1
  v_rcp_f32 v1, v1
  s_lshl_b32 s23, s70, 14
  s_add_u32 s23, s23, s78
  s_mov_b32 s46, 0
  s_call_b64 s[0:1], .fz_kernel_hw
  s_waitcnt vmcnt(0)
  s_cmp_ge_u32 s17, 14
  s_cbranch_scc1 .fz_kernel_c_ng
  s_setprio 2
  v_mfma_f32_16x16x32_bf16 v[224:227], v[208:211], v[80:83], 0
  v_mfma_f32_16x16x32_bf16 v[228:231], v[208:211], v[84:87], 0
  v_mfma_f32_16x16x32_bf16 v[232:235], v[208:211], v[88:91], 0
  v_mfma_f32_16x16x32_bf16 v[236:239], v[208:211], v[92:95], 0
  v_mfma_f32_16x16x32_bf16 v[240:243], v[208:211], v[96:99], 0
  v_mfma_f32_16x16x32_bf16 v[244:247], v[208:211], v[100:103], 0
  v_mfma_f32_16x16x32_bf16 v[248:251], v[208:211], v[104:107], 0
  v_mfma_f32_16x16x32_bf16 v[252:255], v[208:211], v[108:111], 0
  v_mfma_f32_16x16x32_bf16 v[224:227], v[212:215], v[112:115], v[224:227]
  v_mfma_f32_16x16x32_bf16 v[228:231], v[212:215], v[116:119], v[228:231]
  v_mfma_f32_16x16x32_bf16 v[232:235], v[212:215], v[120:123], v[232:235]
  v_mfma_f32_16x16x32_bf16 v[236:239], v[212:215], v[124:127], v[236:239]
  v_mfma_f32_16x16x32_bf16 v[240:243], v[212:215], v[128:131], v[240:243]
  v_mfma_f32_16x16x32_bf16 v[244:247], v[212:215], v[132:135], v[244:247]
  v_mfma_f32_16x16x32_bf16 v[248:251], v[212:215], v[136:139], v[248:251]
  v_mfma_f32_16x16x32_bf16 v[252:255], v[212:215], v[140:143], v[252:255]
  v_mfma_f32_16x16x32_bf16 v[224:227], v[216:219], v[144:147], v[224:227]
  v_mfma_f32_16x16x32_bf16 v[228:231], v[216:219], v[148:151], v[228:231]
  v_mfma_f32_16x16x32_bf16 v[232:235], v[216:219], v[152:155], v[232:235]
  v_mfma_f32_16x16x32_bf16 v[236:239], v[216:219], v[156:159], v[236:239]
  v_mfma_f32_16x16x32_bf16 v[240:243], v[216:219], v[160:163], v[240:243]
  v_mfma_f32_16x16x32_bf16 v[244:247], v[216:219], v[164:167], v[244:247]
  v_mfma_f32_16x16x32_bf16 v[248:251], v[216:219], v[168:171], v[248:251]
  v_mfma_f32_16x16x32_bf16 v[252:255], v[216:219], v[172:175], v[252:255]
  v_mfma_f32_16x16x32_bf16 v[224:227], v[220:223], v[176:179], v[224:227]
  v_mfma_f32_16x16x32_bf16 v[228:231], v[220:223], v[180:183], v[228:231]
  v_mfma_f32_16x16x32_bf16 v[232:235], v[220:223], v[184:187], v[232:235]
  v_mfma_f32_16x16x32_bf16 v[236:239], v[220:223], v[188:191], v[236:239]
  v_mfma_f32_16x16x32_bf16 v[240:243], v[220:223], v[192:195], v[240:243]
  v_mfma_f32_16x16x32_bf16 v[244:247], v[220:223], v[196:199], v[244:247]
  v_mfma_f32_16x16x32_bf16 v[248:251], v[220:223], v[200:203], v[248:251]
  v_mfma_f32_16x16x32_bf16 v[252:255], v[220:223], v[204:207], v[252:255]
  s_nop 0
  v_add_f32 v208, v225, v224 row_ror:8 row_mask:0xf bank_mask:0x3
  v_add_f32 v209, v229, v228 row_ror:8 row_mask:0xf bank_mask:0x3
  v_add_f32 v210, v233, v232 row_ror:8 row_mask:0xf bank_mask:0x3
  v_add_f32 v211, v237, v236 row_ror:8 row_mask:0xf bank_mask:0x3
  v_add_f32 v208, v240, v241 row_ror:8 row_mask:0xf bank_mask:0xc
  v_add_f32 v209, v244, v245 row_ror:8 row_mask:0xf bank_mask:0xc
  v_add_f32 v210, v248, v249 row_ror:8 row_mask:0xf bank_mask:0xc
  v_add_f32 v211, v252, v253 row_ror:8 row_mask:0xf bank_mask:0xc
  v_fma_f32 v208, -v11, v28, v208
  v_fma_f32 v209, -v11, v29, v209
  v_or_b32 v208, 1, v208
  v_fma_f32 v210, -v11, v30, v210
  v_fma_f32 v211, -v11, v31, v211
  v_or_b32 v210, 1, v210
  s_mov_b64 exec, 0xffff
  buffer_store_dwordx4 v[208:211], v20, s[4:7], s32 offen offset:0 sc1
  s_mov_b64 exec, -1
  s_setprio 0
  s_cmp_eq_u32 s3, 0
  s_cbranch_scc1 .fz_kernel_hb72
  s_barrier
  s_sub_u32 s3, s3, 1
.fz_kernel_hb72:
.fz_kernel_c_ng:
  s_cmp_eq_u32 s20, 0
  s_cbranch_scc1 .fz_kernel_c_ng1
  buffer_load_ushort v184, v12, s[4:7], s23 offen
  s_branch .fz_kernel_c_ng2
.fz_kernel_c_ng1:
  s_cmp_eq_u32 s75, 0
  s_cbranch_scc1 .fz_kernel_c_ng2
  buffer_load_dwordx2 v[240:241], v16, s[4:7], s14 offen
  buffer_load_dwordx2 v[242:243], v16, s[4:7], s15 offen
.fz_kernel_c_ng2:
  s_cmp_ge_u32 s17, 14
  s_cbranch_scc1 .fz_kernel_c_g1
  ds_read_b64_tr_b16 v[80:81], v17 offset:0
  ds_read_b64_tr_b16 v[82:83], v17 offset:1024
  ds_read_b64_tr_b16 v[84:85], v17 offset:32
  ds_read_b64_tr_b16 v[86:87], v17 offset:1056
  ds_read_b64_tr_b16 v[88:89], v18 offset:0
  ds_read_b64_tr_b16 v[90:91], v18 offset:1024
  ds_read_b64_tr_b16 v[92:93], v18 offset:32
  ds_read_b64_tr_b16 v[94:95], v18 offset:1056
  ds_read_b64_tr_b16 v[96:97], v17 offset:2048
  ds_read_b64_tr_b16 v[98:99], v17 offset:3072
  ds_read_b64_tr_b16 v[100:101], v17 offset:2080
  ds_read_b64_tr_b16 v[102:103], v17 offset:3104
  ds_read_b64_tr_b16 v[104:105], v18 offset:2048
  s_cmp_eq_u32 s3, 0
  s_cbranch_scc1 .fz_kernel_hb80
  s_barrier
  s_sub_u32 s3, s3, 1
.fz_kernel_hb80:
  ds_read_b64_tr_b16 v[106:107], v18 offset:3072
  ds_read_b64_tr_b16 v[108:109], v18 offset:2080
  ds_read_b64_tr_b16 v[110:111], v18 offset:3104
  s_waitcnt lgkmcnt(4)
  ds_read_b64_tr_b16 v[112:113], v17 offset:4096
  ds_read_b64_tr_b16 v[114:115], v17 offset:5120
  ds_read_b64_tr_b16 v[116:117], v17 offset:4128
  ds_read_b64_tr_b16 v[118:119], v17 offset:5152
  ds_read_b64_tr_b16 v[120:121], v18 offset:4096
  ds_read_b64_tr_b16 v[122:123], v18 offset:5120
  ds_read_b64_tr_b16 v[124:125], v18 offset:4128
  ds_read_b64_tr_b16 v[126:127], v18 offset:5152
  ds_read_b64_tr_b16 v[128:129], v17 offset:6144
  ds_read_b64_tr_b16 v[130:131], v17 offset:7168
  ds_read_b64_tr_b16 v[132:133], v17 offset:6176
  ds_read_b64_tr_b16 v[134:135], v17 offset:7200
  ds_read_b64_tr_b16 v[136:137], v18 offset:6144
  ds_read_b64_tr_b16 v[138:139], v18 offset:7168
  s_cmp_eq_u32 s3, 0
  s_cbranch_scc1 .fz_kernel_hb81
  s_barrier
  s_sub_u32 s3, s3, 1
.fz_kernel_hb81:
  ds_read_b64_tr_b16 v[140:141], v18 offset:6176
  ds_read_b64_tr_b16 v[142:143], v18 offset:7200
.fz_kernel_c_g1:
  v_fma_f32 v15, -v11, v11, v15
  v_rsq_f32 v15, abs(v15)
  s_nop 0
  v_mul_f32 v179, v11, v15
  v_mul_f32 v15, 0x44800000, v15
  v_sub_f32 v179, 0, v179
  v_add_f32 v178, 1.0, v15
  v_mul_f32 v177, -1.4426950408889634, v15
  v_mul_f32 v15, v15, v15
  v_mul_f32 v1, v1, v15
  s_cmp_eq_u32 s75, 0
  s_cbranch_scc1 .fz_kernel_c_d0
  s_cmp_lg_u32 s20, 0
  s_cbranch_scc1 .fz_kernel_c_t2
  s_waitcnt vmcnt(0)
  s_call_b64 s[68:69], .fz_kernel_c_coef
  v_mov_b32 v9, 159952
  v_mov_b32 v7, s79
  ds_write_b64 v26, v[252:253] offset:6400
  ds_write_b64 v26, v[254:255] offset:6912
  ds_write_b32 v9, v7
  s_waitcnt lgkmcnt(0)
.fz_kernel_c_t2:
  s_barrier
.fz_kernel_c_d0:
  s_cmp_ge_u32 s17, 14
  s_cbranch_scc1 .fz_kernel_c_nd
  s_cmp_eq_u32 s3, 0
  s_cbranch_scc1 .fz_kernel_hb74
  s_barrier
  s_sub_u32 s3, s3, 1
.fz_kernel_hb74:
  buffer_load_dwordx4 v[144:147], v21, s[4:7], s33 offen offset:0 sc1
  buffer_load_dwordx4 v[148:151], v21, s[4:7], s33 offen offset:512 sc1
  buffer_load_dwordx4 v[152:155], v21, s[4:7], s33 offen offset:1024 sc1
  buffer_load_dwordx4 v[156:159], v21, s[4:7], s33 offen offset:1536 sc1
  s_mov_b32 s38, 0
.fz_kernel_c_gu:
  s_mov_b32 s46, 0
  s_call_b64 s[0:1], .fz_kernel_hw
  s_waitcnt vmcnt(0)
  v_min3_u32 v9, v144, v146, v148
  v_min3_u32 v9, v9, v150, v152
  v_min3_u32 v9, v9, v154, v156
  v_min_u32 v9, v9, v158
  v_cmp_eq_u32 vcc, 0, v9
  v_add_f32 v160, v144, v148
  v_add_f32 v161, v145, v149
  v_add_f32 v162, v146, v150
  v_add_f32 v163, v147, v151
  s_cbranch_vccnz .fz_kernel_c_gur
.fz_kernel_c_gud:
  v_add_f32 v152, v152, v156
  v_add_f32 v153, v153, v157
  v_add_f32 v154, v154, v158
  v_add_f32 v155, v155, v159
  v_add_f32 v144, v152, v160
  v_add_f32 v145, v153, v161
  v_add_f32 v146, v154, v162
  v_add_f32 v147, v155, v163
  s_nop 0
  v_permlane32_swap_b32 v144, v146
  v_permlane32_swap_b32 v145, v147
  v_mul_f32 v148, v144, v177
  v_mul_f32 v149, v145, v177
  v_exp_f32 v148, v148
  s_cmp_eq_u32 s3, 0
  s_cbranch_scc1 .fz_kernel_hb82
  s_barrier
  s_sub_u32 s3, s3, 1
.fz_kernel_hb82:
  v_exp_f32 v149, v149
  v_mul_f32 v144, v144, v146
  v_add_f32 v148, 1.0, v148
  v_add_f32 v149, 1.0, v149
  v_rcp_f32 v148, v148
  v_rcp_f32 v149, v149
  v_mul_f32 v145, v145, v147
  v_mul_f32 v144, v144, v148
  v_mul_f32 v145, v145, v149
  v_cvt_pk_bf16_f32 v144, v144, v145
  s_waitcnt lgkmcnt(0)
  s_setprio 2
  v_mov_b32 v160, v144 row_newbcast:0 row_mask:0xf bank_mask:0xf
  v_mov_b32 v161, v144 row_newbcast:1 row_mask:0xf bank_mask:0xf
  v_mov_b32 v162, v144 row_newbcast:2 row_mask:0xf bank_mask:0xf
  v_mov_b32 v163, v144 row_newbcast:3 row_mask:0xf bank_mask:0xf
  v_mov_b32 v164, v144 row_newbcast:4 row_mask:0xf bank_mask:0xf
  v_mov_b32 v165, v144 row_newbcast:5 row_mask:0xf bank_mask:0xf
  v_mov_b32 v166, v144 row_newbcast:6 row_mask:0xf bank_mask:0xf
  v_mov_b32 v167, v144 row_newbcast:7 row_mask:0xf bank_mask:0xf
  v_mfma_f32_16x16x32_bf16 v[208:211], v[160:163], v[80:83], 0
  v_mfma_f32_16x16x32_bf16 v[212:215], v[160:163], v[84:87], 0
  v_mfma_f32_16x16x32_bf16 v[216:219], v[160:163], v[88:91], 0
  v_mfma_f32_16x16x32_bf16 v[220:223], v[160:163], v[92:95], 0
  v_mov_b32 v168, v144 row_newbcast:8 row_mask:0xf bank_mask:0xf
  v_mov_b32 v169, v144 row_newbcast:9 row_mask:0xf bank_mask:0xf
  v_mov_b32 v170, v144 row_newbcast:10 row_mask:0xf bank_mask:0xf
  v_mov_b32 v171, v144 row_newbcast:11 row_mask:0xf bank_mask:0xf
  v_mfma_f32_16x16x32_bf16 v[208:211], v[164:167], v[96:99], v[208:211]
  v_mfma_f32_16x16x32_bf16 v[212:215], v[164:167], v[100:103], v[212:215]
  v_mfma_f32_16x16x32_bf16 v[216:219], v[164:167], v[104:107], v[216:219]
  v_mfma_f32_16x16x32_bf16 v[220:223], v[164:167], v[108:111], v[220:223]
  v_mov_b32 v172, v144 row_newbcast:12 row_mask:0xf bank_mask:0xf
  v_mov_b32 v173, v144 row_newbcast:13 row_mask:0xf bank_mask:0xf
  v_mov_b32 v174, v144 row_newbcast:14 row_mask:0xf bank_mask:0xf
  v_mov_b32 v175, v144 row_newbcast:15 row_mask:0xf bank_mask:0xf
  v_mfma_f32_16x16x32_bf16 v[208:211], v[168:171], v[112:115], v[208:211]
  v_mfma_f32_16x16x32_bf16 v[212:215], v[168:171], v[116:119], v[212:215]
  v_mfma_f32_16x16x32_bf16 v[216:219], v[168:171], v[120:123], v[216:219]
  v_mfma_f32_16x16x32_bf16 v[220:223], v[168:171], v[124:127], v[220:223]
  v_mfma_f32_16x16x32_bf16 v[208:211], v[172:175], v[128:131], v[208:211]
  v_mfma_f32_16x16x32_bf16 v[212:215], v[172:175], v[132:135], v[212:215]
  v_mfma_f32_16x16x32_bf16 v[216:219], v[172:175], v[136:139], v[216:219]
  v_mfma_f32_16x16x32_bf16 v[220:223], v[172:175], v[140:143], v[220:223]
  s_nop 4
  v_or_b32 v208, 1, v208
  v_mov_b32 v209, v212
  v_or_b32 v210, 1, v216
  v_mov_b32 v211, v220
  s_mov_b64 exec, 0xffff
  buffer_store_dwordx4 v[208:211], v3, s[4:7], s39 offen offset:0 sc1
  s_mov_b64 exec, -1
  s_setprio 0
.fz_kernel_c_nd:
  s_cmp_eq_u32 s75, 0
  s_cbranch_scc1 .fz_kernel_c_m0
  s_lshl_b32 s21, s17, 1
  s_add_u32 s21, s21, s20
  s_cmp_lg_u32 s21, 31
  s_cbranch_scc1 .fz_kernel_fin
  s_branch .fz_kernel_c_pp
.fz_kernel_c_m0:
  s_cmp_eq_u32 s79, 0
  s_cselect_b32 s21, 2, 0
  s_add_u32 s3, s3, s21
.fz_kernel_c_pp:
  s_mul_i32 s21, s70, 7168
  s_add_u32 s21, s21, s72
  s_add_u32 s21, s21, 155648
  s_add_u32 s22, s21, 4096
  s_cmp_eq_u32 s3, 0
  s_cbranch_scc1 .fz_kernel_hb75
  s_barrier
  s_sub_u32 s3, s3, 1
.fz_kernel_hb75:
  s_cmp_eq_u32 s3, 0
  s_cbranch_scc1 .fz_kernel_hb76
  s_barrier
  s_sub_u32 s3, s3, 1
.fz_kernel_hb76:
  s_cmp_eq_u32 s3, 0
  s_cbranch_scc1 .fz_kernel_hb77
  s_barrier
  s_sub_u32 s3, s3, 1
.fz_kernel_hb77:
  buffer_load_dwordx4 v[144:147], v3, s[4:7], s21 offen offset:0 sc1
  buffer_load_dwordx4 v[148:151], v3, s[4:7], s21 offen offset:1024 sc1
  buffer_load_dwordx4 v[152:155], v3, s[4:7], s21 offen offset:2048 sc1
  buffer_load_dwordx4 v[156:159], v3, s[4:7], s21 offen offset:3072 sc1
  buffer_load_dwordx4 v[160:163], v3, s[4:7], s22 offen offset:0 sc1
  buffer_load_dwordx4 v[164:167], v3, s[4:7], s22 offen offset:1024 sc1
  buffer_load_dwordx4 v[168:171], v3, s[4:7], s22 offen offset:2048 sc1
  s_mov_b32 s38, 0
.fz_kernel_c_pu:
  s_mov_b32 s46, 0
  s_call_b64 s[0:1], .fz_kernel_hw
  s_waitcnt vmcnt(0)
  v_min3_u32 v9, v144, v146, v148
  v_min3_u32 v9, v9, v150, v152
  v_min3_u32 v9, v9, v154, v156
  v_min3_u32 v9, v9, v158, v160
  v_min3_u32 v9, v9, v162, v164
  v_min3_u32 v9, v9, v166, v168
  v_min_u32 v9, v9, v170
  v_cmp_eq_u32 vcc, 0, v9
  v_add_f32 v236, v144, v148
  v_add_f32 v237, v145, v149
  v_add_f32 v238, v146, v150
  v_add_f32 v239, v147, v151
  s_cbranch_vccnz .fz_kernel_c_pur
.fz_kernel_c_pud:
  v_add_f32 v152, v152, v156
  v_add_f32 v153, v153, v157
  v_add_f32 v154, v154, v158
  v_add_f32 v155, v155, v159
  v_add_f32 v160, v160, v164
  v_add_f32 v161, v161, v165
  v_add_f32 v162, v162, v166
  s_cmp_eq_u32 s3, 0
  s_cbranch_scc1 .fz_kernel_hb83
  s_barrier
  s_sub_u32 s3, s3, 1
.fz_kernel_hb83:
  v_add_f32 v163, v163, v167
  v_add_f32 v236, v236, v168
  v_add_f32 v237, v237, v169
  v_add_f32 v238, v238, v170
  v_add_f32 v239, v239, v171
  v_add_f32 v152, v152, v160
  v_add_f32 v153, v153, v161
  v_add_f32 v154, v154, v162
  v_add_f32 v155, v155, v163
  v_add_f32 v144, v236, v152
  v_add_f32 v146, v238, v154
  v_add_f32 v145, v237, v153
  v_add_f32 v147, v239, v155
  v_permlane32_swap_b32 v144, v146
  s_nop 0
  v_permlane32_swap_b32 v145, v147
  v_add_f32 v144, v144, v146
  v_add_f32 v145, v145, v147
  v_lshlrev_b32 v184, 16, v184
  s_nop 0
  v_permlane16_swap_b32 v144, v145
  v_add_f32 v144, v144, v145
  v_mul_f32 v144, v144, v1
  v_fma_f32 v184, v184, v178, v179
  s_nop 0
  v_mov_b32 v145, v144 quad_perm:[1,0,3,2] row_mask:0xf bank_mask:0xf
  v_cvt_pk_bf16_f32 v144, v144, v145
  s_or_b32 s21, s75, s71
  s_cbranch_scc1 .fz_kernel_c_w7
  s_mul_i32 s21, s20, 384
  s_add_u32 s21, s21, s60
  v_mov_b32 v180, v144 row_newbcast:0 row_mask:0xf bank_mask:0xf
  v_mov_b32 v181, v144 row_newbcast:2 row_mask:0xf bank_mask:0xf
  v_mov_b32 v182, v144 row_newbcast:4 row_mask:0xf bank_mask:0xf
  v_mov_b32 v183, v144 row_newbcast:6 row_mask:0xf bank_mask:0xf
  s_cmp_eq_u32 s3, 0
  s_cbranch_scc1 .fz_kernel_hb79
  s_barrier
  s_sub_u32 s3, s3, 1
.fz_kernel_hb79:
  s_setprio 2
  v_mfma_f32_16x16x32_bf16 v[208:211], v[180:183], v[32:35], 0
  v_mov_b32 v232, v144 row_newbcast:8 row_mask:0xf bank_mask:0xf
  v_mfma_f32_16x16x32_bf16 v[212:215], v[180:183], v[36:39], 0
  v_mov_b32 v233, v144 row_newbcast:10 row_mask:0xf bank_mask:0xf
  v_mfma_f32_16x16x32_bf16 v[216:219], v[180:183], v[40:43], 0
  v_mov_b32 v234, v144 row_newbcast:12 row_mask:0xf bank_mask:0xf
  v_mfma_f32_16x16x32_bf16 v[220:223], v[180:183], v[44:47], 0
  v_mov_b32 v235, v144 row_newbcast:14 row_mask:0xf bank_mask:0xf
  v_mfma_f32_16x16x32_bf16 v[224:227], v[180:183], v[48:51], 0
  v_mfma_f32_16x16x32_bf16 v[228:231], v[180:183], v[52:55], 0
  v_mfma_f32_16x16x32_bf16 v[208:211], v[232:235], v[56:59], v[208:211]
  v_mfma_f32_16x16x32_bf16 v[212:215], v[232:235], v[60:63], v[212:215]
  v_mfma_f32_16x16x32_bf16 v[216:219], v[232:235], v[64:67], v[216:219]
  v_mfma_f32_16x16x32_bf16 v[220:223], v[232:235], v[68:71], v[220:223]
  v_mfma_f32_16x16x32_bf16 v[224:227], v[232:235], v[72:75], v[224:227]
  v_mfma_f32_16x16x32_bf16 v[228:231], v[232:235], v[76:79], v[228:231]
  s_nop 2
  v_or_b32 v208, 1, v208
  v_mov_b32 v209, v212
  v_or_b32 v210, 1, v216
  v_mov_b32 v211, v220
  s_mov_b64 exec, 0xffff
  buffer_store_dwordx4 v[208:211], v3, s[4:7], s21 offen offset:0 sc1
  v_or_b32 v224, 1, v224
  v_mov_b32 v225, v228
  buffer_store_dwordx2 v[224:225], v16, s[4:7], s21 offen offset:256 sc1
  s_mov_b64 exec, -1
  s_setprio 0
  s_cmp_lg_u32 s20, 0
  s_cbranch_scc1 .fz_kernel_c_w7
  s_cmp_eq_u32 s79, 0
  s_cbranch_scc1 .fz_kernel_c_no2
  v_add_u32 v13, 155648, v3
  s_lshl_b32 s21, s18, 14
  s_add_u32 s21, s21, 0x1c84000
  s_add_u32 s22, s21, 4096
  s_add_u32 s23, s21, 8192
  s_add_u32 s24, s21, 12288
  v_rcp_f32 v144, v178
  v_lshlrev_b32 v146, 1, v2
  v_sub_u32 v146, s79, v146
  v_cmp_eq_u32 s[28:29], 1, v146
  v_cmp_eq_u32 s[30:31], 2, v146
  s_nop 0
  v_cndmask_b32 v148, 0, v144, s[28:29]
  v_cndmask_b32 v149, 0, v144, s[30:31]
  v_mov_b32 v9, 159952
  v_mov_b32 v7, s79
  ds_write_b32 v9, v7
  ds_write_b64 v26, v[148:149] offset:512
  s_lshl_b32 s25, s79, 2
  s_add_u32 s25, s25, 155644
  s_cmp_eq_u32 s3, 0
  s_cbranch_scc1 .fz_kernel_hb84
  s_barrier
  s_sub_u32 s3, s3, 1
.fz_kernel_hb84:
  v_mov_b32 v7, s25
  v_mov_b32 v152, 0
  v_mov_b32 v153, 0
  v_mov_b32 v154, 0
  v_mov_b32 v155, 0
  s_bfm_b64 exec, 49, 0
  s_mov_b32 s38, 0
  s_mov_b32 s25, 15
.fz_kernel_c_pw:
  s_cmp_le_u32 s3, 3
  s_cbranch_scc1 .fz_kernel_c_pw1
  s_barrier
  s_sub_u32 s3, s3, 1
  s_branch .fz_kernel_c_pw
.fz_kernel_c_pw1:
  s_setprio 2
.fz_kernel_c_pd:
  s_bitcmp1_b32 s25, 0
  s_cbranch_scc0 .fz_kernel_c_pl0
  buffer_load_dwordx4 v[80:83], v3, s[4:7], s21 offen offset:0 sc1
  buffer_load_dwordx4 v[84:87], v3, s[4:7], s21 offen offset:1024 sc1
  buffer_load_dwordx4 v[88:91], v3, s[4:7], s21 offen offset:2048 sc1
  buffer_load_dwordx4 v[92:95], v3, s[4:7], s21 offen offset:3072 sc1
.fz_kernel_c_pl0:
  s_bitcmp1_b32 s25, 1
  s_cbranch_scc0 .fz_kernel_c_pl1
  buffer_load_dwordx4 v[96:99], v3, s[4:7], s22 offen offset:0 sc1
  buffer_load_dwordx4 v[100:103], v3, s[4:7], s22 offen offset:1024 sc1
  buffer_load_dwordx4 v[104:107], v3, s[4:7], s22 offen offset:2048 sc1
  buffer_load_dwordx4 v[108:111], v3, s[4:7], s22 offen offset:3072 sc1
.fz_kernel_c_pl1:
  s_bitcmp1_b32 s25, 2
  s_cbranch_scc0 .fz_kernel_c_pl2
  buffer_load_dwordx4 v[112:115], v3, s[4:7], s23 offen offset:0 sc1
  buffer_load_dwordx4 v[116:119], v3, s[4:7], s23 offen offset:1024 sc1
  buffer_load_dwordx4 v[120:123], v3, s[4:7], s23 offen offset:2048 sc1
  buffer_load_dwordx4 v[124:127], v3, s[4:7], s23 offen offset:3072 sc1
.fz_kernel_c_pl2:
  s_bitcmp1_b32 s25, 3
  s_cbranch_scc0 .fz_kernel_c_pl3
  buffer_load_dwordx4 v[128:131], v3, s[4:7], s24 offen offset:0 sc1
  buffer_load_dwordx4 v[132:135], v3, s[4:7], s24 offen offset:1024 sc1
  buffer_load_dwordx4 v[136:139], v3, s[4:7], s24 offen offset:2048 sc1
  buffer_load_dwordx4 v[140:143], v3, s[4:7], s24 offen offset:3072 sc1
.fz_kernel_c_pl3:
  s_add_u32 s38, s38, 1
  s_mov_b32 s46, 0
  s_call_b64 s[0:1], .fz_kernel_hw
  s_waitcnt vmcnt(0)
  s_bitcmp1_b32 s25, 0
  s_cbranch_scc0 .fz_kernel_c_pa0
  v_min3_u32 v9, v80, v82, v84
  v_min3_u32 v9, v9, v86, v88
  v_min3_u32 v9, v9, v90, v92
  v_min_u32 v9, v9, v94
  v_cmp_eq_u32 vcc, 0, v9
  v_add_f32 v80, v80, v84
  v_add_f32 v81, v81, v85
  v_add_f32 v82, v82, v86
  v_add_f32 v83, v83, v87
  s_cbranch_vccnz .fz_kernel_c_pa0
  v_add_f32 v88, v88, v92
  v_add_f32 v89, v89, v93
  v_add_f32 v90, v90, v94
  v_add_f32 v91, v91, v95
  v_add_f32 v152, v152, v80
  v_add_f32 v153, v153, v81
  v_add_f32 v154, v154, v82
  v_add_f32 v155, v155, v83
  v_add_f32 v152, v152, v88
  v_add_f32 v153, v153, v89
  v_add_f32 v154, v154, v90
  v_add_f32 v155, v155, v91
  s_bitset0_b32 s25, 0
.fz_kernel_c_pa0:
  s_bitcmp1_b32 s25, 1
  s_cbranch_scc0 .fz_kernel_c_pa1
  v_min3_u32 v9, v96, v98, v100
  v_min3_u32 v9, v9, v102, v104
  v_min3_u32 v9, v9, v106, v108
  v_min_u32 v9, v9, v110
  v_cmp_eq_u32 vcc, 0, v9
  v_add_f32 v96, v96, v100
  v_add_f32 v97, v97, v101
  v_add_f32 v98, v98, v102
  v_add_f32 v99, v99, v103
  s_cbranch_vccnz .fz_kernel_c_pa1
  v_add_f32 v104, v104, v108
  v_add_f32 v105, v105, v109
  v_add_f32 v106, v106, v110
  v_add_f32 v107, v107, v111
  v_add_f32 v152, v152, v96
  v_add_f32 v153, v153, v97
  v_add_f32 v154, v154, v98
  v_add_f32 v155, v155, v99
  v_add_f32 v152, v152, v104
  v_add_f32 v153, v153, v105
  v_add_f32 v154, v154, v106
  v_add_f32 v155, v155, v107
  s_bitset0_b32 s25, 1
.fz_kernel_c_pa1:
  s_bitcmp1_b32 s25, 2
  s_cbranch_scc0 .fz_kernel_c_pa2
  v_min3_u32 v9, v112, v114, v116
  v_min3_u32 v9, v9, v118, v120
  v_min3_u32 v9, v9, v122, v124
  v_min_u32 v9, v9, v126
  v_cmp_eq_u32 vcc, 0, v9
  v_add_f32 v112, v112, v116
  v_add_f32 v113, v113, v117
  v_add_f32 v114, v114, v118
  v_add_f32 v115, v115, v119
  s_cbranch_vccnz .fz_kernel_c_pa2
  v_add_f32 v120, v120, v124
  v_add_f32 v121, v121, v125
  v_add_f32 v122, v122, v126
  v_add_f32 v123, v123, v127
  v_add_f32 v152, v152, v112
  v_add_f32 v153, v153, v113
  v_add_f32 v154, v154, v114
  v_add_f32 v155, v155, v115
  v_add_f32 v152, v152, v120
  v_add_f32 v153, v153, v121
  v_add_f32 v154, v154, v122
  v_add_f32 v155, v155, v123
  s_bitset0_b32 s25, 2
.fz_kernel_c_pa2:
  s_bitcmp1_b32 s25, 3
  s_cbranch_scc0 .fz_kernel_c_pa3
  v_min3_u32 v9, v128, v130, v132
  v_min3_u32 v9, v9, v134, v136
  v_min3_u32 v9, v9, v138, v140
  v_min_u32 v9, v9, v142
  v_cmp_eq_u32 vcc, 0, v9
  v_add_f32 v128, v128, v132
  v_add_f32 v129, v129, v133
  v_add_f32 v130, v130, v134
  v_add_f32 v131, v131, v135
  s_cbranch_vccnz .fz_kernel_c_pa3
  v_add_f32 v136, v136, v140
  v_add_f32 v137, v137, v141
  v_add_f32 v138, v138, v142
  v_add_f32 v139, v139, v143
  v_add_f32 v152, v152, v128
  v_add_f32 v153, v153, v129
  v_add_f32 v154, v154, v130
  v_add_f32 v155, v155, v131
  v_add_f32 v152, v152, v136
  v_add_f32 v153, v153, v137
  v_add_f32 v154, v154, v138
  v_add_f32 v155, v155, v139
  s_bitset0_b32 s25, 3
.fz_kernel_c_pa3:
  s_cmp_eq_u32 s25, 0
  s_cbranch_scc1 .fz_kernel_c_pdd
  s_cmp_lt_u32 s38, 131072
  s_cbranch_scc1 .fz_kernel_c_pd
.fz_kernel_c_pdd:
  s_mov_b32 exec_hi, 0xffff
  ds_write_b128 v13, v[152:155] offset:1536
  s_mov_b64 exec, -1
  v_readlane_b32 s21, v152, 48
  v_readlane_b32 s22, v154, 48
  s_nop 0
  v_mul_f32 v144, s21, v23
  v_fma_f32 v145, s22, v23, v25
  v_fma_f32 v145, -v144, v144, v145
  v_rsq_f32 v145, abs(v145)
  v_sub_f32 v144, v179, v144
  v_mul_f32 v146, v145, v178
  v_mul_f32 v147, v145, v144
  ds_write_b32 v7, v146 offset:4608
  ds_write_b32 v7, v147 offset:5120
  s_waitcnt lgkmcnt(0)
  s_add_u32 s3, s3, 2
  s_setprio 0
.fz_kernel_c_no2:
  s_branch .fz_kernel_q_he
.fz_kernel_c_w7:
  s_setprio 2
  v_lshlrev_b32 v144, 16, v144
  s_cmp_lg_u32 s71, 0
  s_cbranch_scc1 .fz_kernel_c_eu
  v_add_f32 v184, v184, v144
  s_cmp_lg_u32 s75, 0
  s_cbranch_scc1 .fz_kernel_c_t3
  v_mul_f32 v146, v184, v184
  v_lshrrev_b32 v9, 5, v2
  v_lshlrev_b32 v9, 3, v9
  v_permlane32_swap_b32 v184, v146
  v_add_f32 v184, v184, v146
  s_nop 1
  v_add_f32 v184, v184, v184 row_ror:8 row_mask:0xf bank_mask:0xf
  s_nop 1
  v_add_f32 v184, v184, v184 row_ror:4 row_mask:0xf bank_mask:0xf
  s_nop 1
  v_add_f32 v184, v184, v184 row_ror:2 row_mask:0xf bank_mask:0xf
  s_nop 1
  v_add_f32 v184, v184, v184 row_ror:1 row_mask:0xf bank_mask:0xf
  s_nop 1
  v_add_f32 v184, v184, v184 row_bcast:15 row_mask:0xa bank_mask:0xf
  v_or_b32 v184, 1, v184
  s_mov_b32 exec_lo, 0x10000
  s_mov_b32 exec_hi, 0x10000
  buffer_store_dword v184, v9, s[4:7], s60 offen offset:768 sc1
  s_mov_b64 exec, -1
  s_setprio 0
  s_cmp_eq_u32 s79, 0
  s_cbranch_scc1 .fz_kernel_q_he
  s_add_u32 s3, s3, 2
  s_mov_b32 s71, 1
  s_mov_b32 s70, s18
.fz_kernel_c_e0:
  s_cmp_eq_u32 s3, 0
  s_cbranch_scc1 .fz_kernel_c_pp
  s_barrier
  s_sub_u32 s3, s3, 1
  s_branch .fz_kernel_c_e0
.fz_kernel_c_eu:
  v_lshlrev_b32 v9, 2, v2
  v_add_u32 v9, 155648, v9
  ds_write_b32 v9, v144 offset:7424
  s_waitcnt lgkmcnt(0)
  s_branch .fz_kernel_q_he
.fz_kernel_c_t3:
  s_mov_b32 s28, s56
  s_mov_b32 s29, s57
  s_mov_b32 s30, 0x400000
  s_mov_b32 s31, 0x00020000
  v_cvt_pk_bf16_f32 v144, v184, v184
  v_lshlrev_b32 v9, 1, v2
  s_lshl_b32 s21, s77, 11
  s_lshl_b32 s22, s18, 7
  s_add_u32 s21, s21, s22
  buffer_store_short v144, v9, s[28:31], s21 offen
.fz_kernel_fin:
.fz_kernel_end:
  s_endpgm
.fz_kernel_pick:
  s_mov_b32 s38, 0
.fz_kernel_pick_l:
  ds_read_b32 v7, v6
  s_add_u32 s38, s38, 1
  s_waitcnt lgkmcnt(0)
  v_readfirstlane_b32 s33, v7
  s_cmp_lt_u32 s38, 1048576
  s_cselect_b32 s33, s33, 0xffff
  s_andn2_b32 s36, s33, s34
  s_cbranch_scc0 .fz_kernel_pick_l
  s_or_b32 s34, s34, s33
  s_setpc_b64 s[68:69]
.fz_kernel_hw:
  s_mov_b32 s47, 0
.fz_kernel_hwl:
  s_getreg_b32 s100, hwreg(HW_REG_IB_STS)
  s_bfe_u32 s101, s100, 0x20016
  s_and_b32 s100, s100, 15
  s_lshl4_add_u32 s100, s101, s100
  s_cmp_le_u32 s100, s46
  s_cbranch_scc1 .fz_kernel_hwr
  s_sub_u32 s47, s47, 1
  s_cbranch_scc0 .fz_kernel_hwl
  s_cmp_eq_u32 s3, 0
  s_cbranch_scc1 .fz_kernel_hwr
  s_cmp_eq_u32 s3, 32
  s_cbranch_scc1 .fz_kernel_hwp
.fz_kernel_hwb:
  s_barrier
  s_sub_u32 s3, s3, 1
  s_mov_b32 s47, 2
  s_branch .fz_kernel_hwl
.fz_kernel_hwr:
  s_setpc_b64 s[0:1]
  .fz_kernel_hwp:
  ds_read_b32 v27, v6 offset:0x110
  s_mov_b32 s47, 0
  s_waitcnt lgkmcnt(0)
  v_readfirstlane_b32 s100, v27
  s_cmp_ge_u32 s100, 0x200
  s_cbranch_scc1 .fz_kernel_hwb
  s_branch .fz_kernel_hwl
.fz_kernel_q_cons2:
  s_setprio 0
  s_lshr_b32 s26, s16, 1
  s_lshl_b32 s28, s26, 13
  v_add_u32 v8, s28, v3
  v_add_u32 v9, 1024, v8
  v_mov_b32 v232, v20
  v_mov_b32 v233, v21
  v_mov_b32 v234, v22
  v_mov_b32 v235, v23
  v_mov_b32 v236, v24
  v_mov_b32 v237, v25
  v_mov_b32 v238, v26
  v_mov_b32 v239, v27
  v_mov_b32 v240, v28
  v_mov_b32 v241, v29
  v_mov_b32 v242, v30
  v_mov_b32 v243, v31
  v_mov_b32 v244, v32
  v_mov_b32 v245, v33
  v_mov_b32 v246, v34
  v_mov_b32 v247, v35
  s_branch .fz_kernel_q_cs
.fz_kernel_q_patch:
  s_mul_i32 s31, s27, 384
  s_add_u32 s31, s31, 155648
  v_and_b32 v73, 48, v2
  v_lshlrev_b32 v73, 2, v73
  v_add_u32 v73, s31, v73
  v_and_b32 v75, 15, v2
  v_lshlrev_b32 v75, 3, v75
  v_add_u32 v75, s31, v75
  ds_read_b32 v72, v22 offset:512
  ds_read_b32 v74, v22 offset:576
  ds_read_b32 v76, v22 offset:640
  ds_read_b32 v78, v22 offset:704
  ds_read_b128 v[80:83], v73 offset:1536
  ds_read_b128 v[84:87], v73 offset:1552
  ds_read_b128 v[88:91], v73 offset:1568
  ds_read_b128 v[92:95], v73 offset:1584
  s_waitcnt lgkmcnt(0)
  v_fmac_f32 v160, v82, v72
  v_fmac_f32 v161, v86, v72
  v_fmac_f32 v162, v90, v72
  v_fmac_f32 v163, v94, v72
  v_fmac_f32 v164, v82, v74
  v_fmac_f32 v165, v86, v74
  v_fmac_f32 v166, v90, v74
  v_fmac_f32 v167, v94, v74
  v_fmac_f32 v168, v82, v76
  v_fmac_f32 v169, v86, v76
  v_fmac_f32 v170, v90, v76
  v_fmac_f32 v171, v94, v76
  v_fmac_f32 v172, v82, v78
  v_fmac_f32 v173, v86, v78
  v_fmac_f32 v174, v90, v78
  v_fmac_f32 v175, v94, v78
  v_fmac_f32 v176, v83, v72
  v_fmac_f32 v177, v87, v72
  v_fmac_f32 v178, v91, v72
  v_fmac_f32 v179, v95, v72
  v_fmac_f32 v180, v83, v74
  v_fmac_f32 v181, v87, v74
  v_fmac_f32 v182, v91, v74
  v_fmac_f32 v183, v95, v74
  v_fmac_f32 v184, v83, v76
  v_fmac_f32 v185, v87, v76
  v_fmac_f32 v186, v91, v76
  v_fmac_f32 v187, v95, v76
  v_fmac_f32 v188, v83, v78
  v_fmac_f32 v189, v87, v78
  v_fmac_f32 v190, v91, v78
  v_fmac_f32 v191, v95, v78
  v_fmac_f32 v128, v80, v72
  v_fmac_f32 v129, v84, v72
  v_fmac_f32 v130, v88, v72
  v_fmac_f32 v131, v92, v72
  v_fmac_f32 v132, v80, v74
  v_fmac_f32 v133, v84, v74
  v_fmac_f32 v134, v88, v74
  v_fmac_f32 v135, v92, v74
  v_fmac_f32 v136, v80, v76
  v_fmac_f32 v137, v84, v76
  v_fmac_f32 v138, v88, v76
  v_fmac_f32 v139, v92, v76
  v_fmac_f32 v140, v80, v78
  v_fmac_f32 v141, v84, v78
  v_fmac_f32 v142, v88, v78
  v_fmac_f32 v143, v92, v78
  v_fmac_f32 v144, v81, v72
  v_fmac_f32 v145, v85, v72
  v_fmac_f32 v146, v89, v72
  v_fmac_f32 v147, v93, v72
  v_fmac_f32 v148, v81, v74
  v_fmac_f32 v149, v85, v74
  v_fmac_f32 v150, v89, v74
  v_fmac_f32 v151, v93, v74
  v_fmac_f32 v152, v81, v76
  v_fmac_f32 v153, v85, v76
  v_fmac_f32 v154, v89, v76
  v_fmac_f32 v155, v93, v76
  v_fmac_f32 v156, v81, v78
  v_fmac_f32 v157, v85, v78
  v_fmac_f32 v158, v89, v78
  v_fmac_f32 v159, v93, v78
  ds_read_b128 v[80:83], v23 offset:512
  ds_read_b128 v[84:87], v23 offset:576
  ds_read_b128 v[88:91], v23 offset:640
  ds_read_b128 v[92:95], v23 offset:704
  ds_read_b64 v[72:73], v75 offset:1792
  s_waitcnt lgkmcnt(0)
  v_fmac_f32 v192, v80, v72
  v_fmac_f32 v193, v81, v72
  v_fmac_f32 v194, v82, v72
  v_fmac_f32 v195, v83, v72
  v_fmac_f32 v196, v84, v72
  v_fmac_f32 v197, v85, v72
  v_fmac_f32 v198, v86, v72
  v_fmac_f32 v199, v87, v72
  v_fmac_f32 v200, v88, v72
  v_fmac_f32 v201, v89, v72
  v_fmac_f32 v202, v90, v72
  v_fmac_f32 v203, v91, v72
  v_fmac_f32 v204, v92, v72
  v_fmac_f32 v205, v93, v72
  v_fmac_f32 v206, v94, v72
  v_fmac_f32 v207, v95, v72
  v_fmac_f32 v208, v80, v73
  v_fmac_f32 v209, v81, v73
  v_fmac_f32 v210, v82, v73
  v_fmac_f32 v211, v83, v73
  v_fmac_f32 v212, v84, v73
  v_fmac_f32 v213, v85, v73
  v_fmac_f32 v214, v86, v73
  v_fmac_f32 v215, v87, v73
  v_fmac_f32 v216, v88, v73
  v_fmac_f32 v217, v89, v73
  v_fmac_f32 v218, v90, v73
  v_fmac_f32 v219, v91, v73
  v_fmac_f32 v220, v92, v73
  v_fmac_f32 v221, v93, v73
  v_fmac_f32 v222, v94, v73
  v_fmac_f32 v223, v95, v73
  s_branch .fz_kernel_q_pback
.fz_kernel_q_prod2:
  s_setprio 0
  s_mov_b64 s[8:9], s[4:5]
  s_mov_b64 s[10:11], s[6:7]
  s_mov_b64 s[12:13], s[42:43]
  s_lshl_b32 s35, s17, 6
  s_and_b32 s31, s16, 1
  s_add_u32 s35, s35, s31
  s_lshl_b32 s35, s35, 12
  s_add_u32 s35, s35, s73
  s_lshr_b32 s33, s17, 3
  s_add_u32 s29, s18, s33
  s_lshl1_add_u32 s29, s17, s29
  s_and_b32 s29, s29, 15
  s_mov_b32 s22, 16384
  s_mov_b32 s23, 8192
  s_mov_b32 s36, 0
  s_add_u32 s37, s19, s74
  s_add_u32 s37, s37, 8
  v_mov_b32 v40, v3
  v_mov_b32 v41, v3
  v_mov_b32 v42, v3
  v_mov_b32 v43, v3
  s_branch .fz_kernel_q_pc
.fz_kernel_xok1w:
  s_call_b64 s[68:69], .fz_kernel_q_xw
  s_branch .fz_kernel_xok1
.fz_kernel_xok2w:
  s_call_b64 s[68:69], .fz_kernel_q_xw
  s_branch .fz_kernel_xok2
.fz_kernel_q_xw:
  s_mov_b64 exec, 1
  s_mov_b32 s38, 0
.fz_kernel_q_xwl:
  ds_read_b32 v11, v6 offset:0x114
  s_add_u32 s38, s38, 1
  s_waitcnt lgkmcnt(0)
  v_readfirstlane_b32 s36, v11
  s_bitcmp1_b32 s36, s24
  s_cbranch_scc1 .fz_kernel_q_xwd
  s_cmp_lt_u32 s38, 1048576
  s_cbranch_scc1 .fz_kernel_q_xwl
  s_mov_b32 s36, -1
.fz_kernel_q_xwd:
  s_mov_b64 exec, -1
  s_nop 4
  s_setpc_b64 s[68:69]
.fz_kernel_xok3w:
  s_call_b64 s[68:69], .fz_kernel_q_xw
  s_branch .fz_kernel_xok3
.fz_kernel_lz26a:
  v_lshlrev_b32 v16, 3, v2
  buffer_atomic_and_x2 v[12:13], v16, s[4:7], s36 offen offset:0 sc1
  buffer_atomic_and_x2 v[12:13], v16, s[4:7], s36 offen offset:512 sc1
  buffer_atomic_and_x2 v[12:13], v16, s[4:7], s36 offen offset:1024 sc1
  buffer_atomic_and_x2 v[12:13], v16, s[4:7], s36 offen offset:1536 sc1
  buffer_atomic_and_x2 v[12:13], v16, s[4:7], s36 offen offset:2048 sc1
  buffer_atomic_and_x2 v[12:13], v16, s[4:7], s36 offen offset:2560 sc1
  buffer_atomic_and_x2 v[12:13], v16, s[4:7], s36 offen offset:3072 sc1
  buffer_atomic_and_x2 v[12:13], v16, s[4:7], s36 offen offset:3584 sc1
  s_branch .fz_kernel_lz26
.fz_kernel_a_pick:
  s_cmp_eq_u32 s34, 0xffff
  s_cbranch_scc1 .fz_kernel_a_picke
  s_mov_b32 s38, 0
.fz_kernel_a_pickl:
  ds_read_b32 v7, v6
  s_add_u32 s38, s38, 1
  s_waitcnt lgkmcnt(0)
  v_readfirstlane_b32 s33, v7
  s_cmp_lt_u32 s38, 1048576
  s_cselect_b32 s33, s33, 0xffff
  s_andn2_b32 s36, s33, s34
  s_cbranch_scc0 .fz_kernel_a_pickl
  s_or_b32 s34, s34, s33
  s_ff1_i32_b32 s33, s36
  s_bitset0_b32 s36, s33
  s_lshl_b32 s33, s33, 14
  s_add_u32 s30, s33, s35
  s_setpc_b64 s[68:69]
.fz_kernel_a_picke:
  s_mov_b32 s30, 0x40000000
  ds_write_b32 v6, v5 offset:0x104
  s_setpc_b64 s[68:69]
.fz_kernel_pk33c:
  s_call_b64 s[68:69], .fz_kernel_a_pick
  s_branch .fz_kernel_pk33
.fz_kernel_pk34c:
  s_call_b64 s[68:69], .fz_kernel_a_pick
  s_branch .fz_kernel_pk34
.fz_kernel_pk35c:
  s_call_b64 s[68:69], .fz_kernel_a_pick
  s_branch .fz_kernel_pk35
.fz_kernel_pk38c:
  s_call_b64 s[68:69], .fz_kernel_a_pick
  s_branch .fz_kernel_pk38
.fz_kernel_pk39c:
  s_call_b64 s[68:69], .fz_kernel_a_pick
  s_branch .fz_kernel_pk39
.fz_kernel_a_slow:
  s_cmp_lg_u32 s73, 0
  s_cbranch_scc1 .fz_kernel_a_ok
  s_mov_b32 s73, 1
  s_and_b32 s39, s16, 1
  v_mov_b32 v16, v32
  v_mov_b32 v17, v33
  v_mov_b32 v18, v34
  v_mov_b32 v19, v35
  v_mov_b32 v20, v36
  v_mov_b32 v21, v37
  v_mov_b32 v22, v38
  v_mov_b32 v23, v39
  s_call_b64 s[68:69], .fz_kernel_a_sl
  v_mov_b32 v176, v144
  v_mov_b32 v177, v145
  v_mov_b32 v178, v146
  v_mov_b32 v179, v147
  v_mov_b32 v180, v148
  v_mov_b32 v181, v149
  v_mov_b32 v182, v150
  v_mov_b32 v183, v151
  v_mov_b32 v184, v152
  v_mov_b32 v185, v153
  v_mov_b32 v186, v154
  v_mov_b32 v187, v155
  v_mov_b32 v188, v156
  v_mov_b32 v189, v157
  v_mov_b32 v190, v158
  v_mov_b32 v191, v159
  v_mov_b32 v24, v25
  v_mov_b32 v16, v40
  v_mov_b32 v17, v41
  v_mov_b32 v18, v42
  v_mov_b32 v19, v43
  v_mov_b32 v20, v44
  v_mov_b32 v21, v45
  v_mov_b32 v22, v46
  v_mov_b32 v23, v47
  s_call_b64 s[68:69], .fz_kernel_a_sl
  v_mov_b32 v192, v144
  v_mov_b32 v193, v145
  v_mov_b32 v194, v146
  v_mov_b32 v195, v147
  v_mov_b32 v196, v148
  v_mov_b32 v197, v149
  v_mov_b32 v198, v150
  v_mov_b32 v199, v151
  v_mov_b32 v200, v152
  v_mov_b32 v201, v153
  v_mov_b32 v202, v154
  v_mov_b32 v203, v155
  v_mov_b32 v204, v156
  v_mov_b32 v205, v157
  v_mov_b32 v206, v158
  v_mov_b32 v207, v159
  v_rcp_f32 v26, v24
  v_cmp_le_f32 vcc, s24, v24
  s_and_b64 s[36:37], s[36:37], vcc
  v_cmp_ge_f32 vcc, s25, v24
  s_and_b64 s[36:37], s[36:37], vcc
  v_pk_mul_f32 v[176:177], v[176:177], v[26:27] op_sel_hi:[1,0]
  v_pk_mul_f32 v[178:179], v[178:179], v[26:27] op_sel_hi:[1,0]
  v_pk_mul_f32 v[180:181], v[180:181], v[26:27] op_sel_hi:[1,0]
  v_pk_mul_f32 v[182:183], v[182:183], v[26:27] op_sel_hi:[1,0]
  v_cvt_pk_bf16_f32 v80, v176, v177
  v_cvt_pk_bf16_f32 v81, v178, v179
  v_cvt_pk_bf16_f32 v82, v180, v181
  v_cvt_pk_bf16_f32 v83, v182, v183
  buffer_store_dwordx4 v[80:83], v3, s[4:7], s8 offen offset:0 sc1
  v_pk_mul_f32 v[184:185], v[184:185], v[26:27] op_sel_hi:[1,0]
  v_pk_mul_f32 v[186:187], v[186:187], v[26:27] op_sel_hi:[1,0]
  v_pk_mul_f32 v[188:189], v[188:189], v[26:27] op_sel_hi:[1,0]
  v_pk_mul_f32 v[190:191], v[190:191], v[26:27] op_sel_hi:[1,0]
  v_cvt_pk_bf16_f32 v84, v184, v185
  v_cvt_pk_bf16_f32 v85, v186, v187
  v_cvt_pk_bf16_f32 v86, v188, v189
  v_cvt_pk_bf16_f32 v87, v190, v191
  buffer_store_dwordx4 v[84:87], v3, s[4:7], s8 offen offset:1024 sc1
  s_branch .fz_kernel_a_fin
.fz_kernel_a_sl:
  s_waitcnt vmcnt(0)
  s_lshl_b32 s23, s18, 1
  s_add_u32 s23, s23, s39
  s_lshl_b32 s23, s23, 18
  s_add_u32 s23, s23, s63
  s_mov_b32 s30, s23
  s_mov_b32 s33, 64
  v_mov_b32 v27, 0xff800000
.fz_kernel_a_s1:
  buffer_load_dwordx4 v[80:83], v3, s[4:7], s30 offen offset:0
  buffer_load_dwordx4 v[84:87], v3, s[4:7], s30 offen offset:1024
  s_waitcnt vmcnt(0)
  v_mfma_f32_32x32x16_bf16 v[48:63], v[80:83], v[16:19], 0
  v_mfma_f32_32x32x16_bf16 v[48:63], v[84:87], v[20:23], v[48:63]
  s_nop 11
  v_max3_f32 v27, v27, v48, v49
  v_max3_f32 v27, v27, v50, v51
  v_max3_f32 v27, v27, v52, v53
  v_max3_f32 v27, v27, v54, v55
  v_max3_f32 v27, v27, v56, v57
  v_max3_f32 v27, v27, v58, v59
  v_max3_f32 v27, v27, v60, v61
  v_max3_f32 v27, v27, v62, v63
  s_add_u32 s30, s30, 4096
  s_sub_u32 s33, s33, 1
  s_cmp_lg_u32 s33, 0
  s_cbranch_scc1 .fz_kernel_a_s1
  v_mov_b32 v29, v27
  s_nop 1
  v_permlane32_swap_b32 v29, v27
  v_max_f32 v27, v27, v29
  v_sub_f32 v27, 0, v27
  v_mov_b32 v64, v27
  v_mov_b32 v144, 0
  v_mov_b32 v65, v27
  v_mov_b32 v145, 0
  v_mov_b32 v66, v27
  v_mov_b32 v146, 0
  v_mov_b32 v67, v27
  v_mov_b32 v147, 0
  v_mov_b32 v68, v27
  v_mov_b32 v148, 0
  v_mov_b32 v69, v27
  v_mov_b32 v149, 0
  v_mov_b32 v70, v27
  v_mov_b32 v150, 0
  v_mov_b32 v71, v27
  v_mov_b32 v151, 0
  v_mov_b32 v72, v27
  v_mov_b32 v152, 0
  v_mov_b32 v73, v27
  v_mov_b32 v153, 0
  v_mov_b32 v74, v27
  v_mov_b32 v154, 0
  v_mov_b32 v75, v27
  v_mov_b32 v155, 0
  v_mov_b32 v76, v27
  v_mov_b32 v156, 0
  v_mov_b32 v77, v27
  v_mov_b32 v157, 0
  v_mov_b32 v78, v27
  v_mov_b32 v158, 0
  v_mov_b32 v79, v27
  v_mov_b32 v159, 0
  v_mov_b32 v208, 0
  v_mov_b32 v209, 0
  v_mov_b32 v210, 0
  v_mov_b32 v211, 0
  s_mov_b32 s30, s23
  s_mov_b32 s33, 64
.fz_kernel_a_s2:
  buffer_load_dwordx4 v[80:83], v3, s[4:7], s30 offen offset:0
  buffer_load_dwordx4 v[84:87], v3, s[4:7], s30 offen offset:1024
  buffer_load_dwordx4 v[88:91], v3, s[4:7], s30 offen offset:2048
  buffer_load_dwordx4 v[92:95], v3, s[4:7], s30 offen offset:3072
  s_waitcnt vmcnt(0)
  v_mfma_f32_32x32x16_bf16 v[48:63], v[80:83], v[16:19], v[64:79]
  v_mfma_f32_32x32x16_bf16 v[48:63], v[84:87], v[20:23], v[48:63]
  s_nop 11
  v_exp_f32 v48, v48
  v_exp_f32 v49, v49
  v_exp_f32 v50, v50
  v_exp_f32 v51, v51
  v_exp_f32 v52, v52
  v_exp_f32 v53, v53
  v_exp_f32 v54, v54
  v_exp_f32 v55, v55
  v_exp_f32 v56, v56
  v_exp_f32 v57, v57
  v_exp_f32 v58, v58
  v_exp_f32 v59, v59
  v_exp_f32 v60, v60
  v_exp_f32 v61, v61
  v_exp_f32 v62, v62
  v_exp_f32 v63, v63
  v_cvt_pk_bf16_f32 v224, v48, v49
  v_cvt_pk_bf16_f32 v225, v50, v51
  v_cvt_pk_bf16_f32 v226, v52, v53
  v_cvt_pk_bf16_f32 v227, v54, v55
  v_cvt_pk_bf16_f32 v228, v56, v57
  v_cvt_pk_bf16_f32 v229, v58, v59
  v_cvt_pk_bf16_f32 v230, v60, v61
  v_cvt_pk_bf16_f32 v231, v62, v63
  v_mfma_f32_32x32x16_bf16 v[144:159], v[88:91], v[224:227], v[144:159]
  s_nop 0
  v_mfma_f32_32x32x16_bf16 v[144:159], v[92:95], v[228:231], v[144:159]
  v_smfmac_f32_16x16x64_bf16 v[208:211], v[12:15], v[224:231], v11
  s_add_u32 s30, s30, 4096
  s_sub_u32 s33, s33, 1
  s_cmp_lg_u32 s33, 0
  s_cbranch_scc1 .fz_kernel_a_s2
  s_nop 7
  v_add_f32 v208, v208, v210
  v_add_f32 v209, v209, v211
  v_cndmask_b32 v25, v208, v209, s[20:21]
  s_nop 7
  s_setpc_b64 s[68:69]
.fz_kernel_serv:
  s_setprio 3
  s_mov_b32 s24, s44
  s_mov_b32 s25, s45
  s_mov_b32 s26, 0x200000
  s_mov_b32 s27, 0x00020000
  v_lshrrev_b32 v8, 3, v2
  v_and_b32 v9, 7, v2
  v_bfe_u32 v10, v2, 4, 1
  v_lshlrev_b32 v10, 2, v10
  v_xor_b32 v9, v9, v10
  v_lshlrev_b32 v9, 4, v9
  v_lshl_add_u32 v10, v8, 11, v9
  s_cmp_eq_u32 s16, 5
  s_cbranch_scc1 .fz_kernel_sv1
  s_barrier
  v_lshlrev_b32 v7, 7, v2
  s_lshl_b32 s31, s18, 11
  s_lshl_b32 s33, 1, s17
  s_add_u32 s31, s31, s67
  s_add_u32 s31, s31, 0x1800000
  v_mov_b32 v8, s33
  s_mov_b64 exec, 0xffff
  s_mov_b32 s38, 0
.fz_kernel_cw40:
  s_sleep 1
  ds_read_u8 v9, v6 offset:256
  s_add_u32 s38, s38, 1
  s_waitcnt lgkmcnt(0)
  v_cmp_gt_u32 vcc, 4, v9
  s_cbranch_vccz .fz_kernel_cw40d
  s_cmp_lt_u32 s38, 8388608
  s_cbranch_scc1 .fz_kernel_cw40
.fz_kernel_cw40d:
  buffer_atomic_or v8, v7, s[4:7], s31 offen sc1
  s_mov_b64 exec, -1
  s_setprio 0
  s_mov_b32 s38, 0
.fz_kernel_kw41:
  s_sleep 2
  ds_read_b32 v7, v6 offset:0
  s_add_u32 s38, s38, 1
  s_waitcnt lgkmcnt(0)
  v_readfirstlane_b32 s31, v7
  s_bcnt1_i32_b32 s31, s31
  s_cmp_ge_u32 s31, 16
  s_cbranch_scc1 .fz_kernel_kw41d
  s_cmp_lt_u32 s38, 1048576
  s_cbranch_scc1 .fz_kernel_kw41
.fz_kernel_kw41d:
  s_branch .fz_kernel_sv2
.fz_kernel_sv1:
  s_add_u32 s37, s19, s67
  s_mov_b64 exec, 1
  buffer_load_dword v7, v4, s[4:7], s37 offen sc1
  s_waitcnt vmcnt(0)
  ds_or_b32 v6, v7
  buffer_load_dword v9, v4, s[4:7], s37 offen sc1
  s_barrier
  s_waitcnt vmcnt(0)
  ds_or_b32 v6, v9
  s_add_u32 s37, s19, s67
  s_mov_b64 exec, 1
  s_mov_b32 s38, 0
.fz_kernel_po42:
  buffer_load_dword v7, v4, s[4:7], s37 offen offset:0 sc1
  s_add_u32 s38, s38, 1
  s_waitcnt vmcnt(0)
  ds_or_b32 v6, v7 offset:0
  v_cmp_ne_u32 vcc, 0xffff, v7
  s_cbranch_vccz .fz_kernel_po42d
  s_sleep 12
  s_cmp_lt_u32 s38, 131072
  s_cbranch_scc1 .fz_kernel_po42
.fz_kernel_po42d:
  s_mov_b64 exec, -1
  s_setprio 0
  s_mov_b32 s38, 0
.fz_kernel_kw43:
  s_sleep 2
  ds_read_b32 v7, v6 offset:0
  s_add_u32 s38, s38, 1
  s_waitcnt lgkmcnt(0)
  v_readfirstlane_b32 s31, v7
  s_bcnt1_i32_b32 s31, s31
  s_cmp_ge_u32 s31, 16
  s_cbranch_scc1 .fz_kernel_kw43d
  s_cmp_lt_u32 s38, 1048576
  s_cbranch_scc1 .fz_kernel_kw43
.fz_kernel_kw43d:
.fz_kernel_sv2:
  s_and_b32 s30, s16, 1
  s_lshl_b32 s30, s30, 16
  s_add_u32 s32, s30, 65536
  s_lshl_b32 s31, s18, 7
  v_add_u32 v10, s31, v10
.fz_kernel_sv3:
  s_mov_b32 m0, s30
  s_lshl_b32 s31, s30, 4
  s_add_u32 s30, s30, 1024
  buffer_load_dwordx4 v10, s[24:27], s31 offen  lds
  s_cmp_lg_u32 s30, s32
  s_waitcnt vmcnt(3)
  s_cbranch_scc1 .fz_kernel_sv3
  s_cmp_lg_u32 s62, 0
  s_cbranch_scc1 .fz_kernel_wt44
  s_mov_b32 s12, s42
  s_mov_b32 s13, s43
  s_mov_b32 s14, 0x600000
  s_mov_b32 s15, 0x00020000
  s_and_b32 s30, s16, 1
  s_lshl1_add_u32 s30, s17, s30
  s_and_b32 s30, s30, 15
  s_mul_i32 s30, s30, 393216
  s_lshl_b32 s31, s18, 7
  s_add_u32 s30, s30, s31
  v_mul_u32_u24 v11, 6144, v2
  buffer_load_dword v1, v11, s[12:15], s30 offen
  s_add_u32 s30, s30, 2048
  s_waitcnt vmcnt(0)
  buffer_load_dword v1, v11, s[12:15], s30 offen
  s_add_u32 s30, s30, 2048
  s_waitcnt vmcnt(0)
  buffer_load_dword v1, v11, s[12:15], s30 offen
  s_add_u32 s30, s30, 2048
  s_waitcnt vmcnt(0)
.fz_kernel_wt44:
  s_cmp_lg_u32 s16, 4
  s_cbranch_scc1 .fz_kernel_ct45e
  s_getpc_b64 s[0:1]
.fz_kernel_ct45:
  s_sub_u32 s0, s0, .fz_kernel_ct45-fz_kernel
  s_subb_u32 s1, s1, 0
  s_lshr_b32 s31, s2, 3
  s_mulk_i32 s31, 0x500
  v_lshl_add_u32 v1, v2, 7, s31
  v_min_u32 v1, .fz_kernel_last-fz_kernel, v1
  s_mov_b64 exec, 0x3ff
  global_load_dword v1, v1, s[0:1]
  s_mov_b64 exec, -1
.fz_kernel_ct45e:
  s_waitcnt vmcnt(0)
  s_cmp_lg_u32 s16, 5
  s_cbranch_scc1 .fz_kernel_sv35
  s_mov_b64 exec, 1
  s_mov_b32 s38, 0
.fz_kernel_sv34:
  s_sleep 4
  buffer_load_dword v7, v4, s[4:7], s37 offen offset:4 sc1
  ds_read_b32 v8, v6 offset:0x104
  s_add_u32 s38, s38, 1
  s_waitcnt vmcnt(0) lgkmcnt(0)
  ds_or_b32 v6, v7 offset:8
  v_cmp_ne_u32 vcc, 0, v8
  s_cbranch_vccnz .fz_kernel_sv35
  s_cmp_lt_u32 s38, 131072
  s_cbranch_scc1 .fz_kernel_sv34
.fz_kernel_sv35:
  s_mov_b64 exec, -1
  s_setprio 3
  s_barrier
  s_cmp_eq_u32 s16, 5
  s_cbranch_scc1 .fz_kernel_sv4
  v_lshlrev_b32 v7, 11, v2
  s_lshl_b32 s31, s17, 7
  s_lshl_b32 s33, 1, s18
  s_add_u32 s31, s31, s67
  s_add_u32 s31, s31, 0x1800004
  v_mov_b32 v8, s33
  s_mov_b64 exec, 0xffff
  s_mov_b32 s38, 0
.fz_kernel_cw46:
  s_sleep 1
  ds_read_u8 v9, v6 offset:264
  s_add_u32 s38, s38, 1
  s_waitcnt lgkmcnt(0)
  v_cmp_gt_u32 vcc, 4, v9
  s_cbranch_vccz .fz_kernel_cw46d
  s_cmp_lt_u32 s38, 8388608
  s_cbranch_scc1 .fz_kernel_cw46
.fz_kernel_cw46d:
  buffer_atomic_or v8, v7, s[4:7], s31 offen sc1
  s_mov_b64 exec, -1
  s_mov_b64 exec, 1
  ds_or_b32 v6, v8 offset:8
  s_mov_b64 exec, -1
  s_branch .fz_kernel_sv5
.fz_kernel_sv4:
  s_add_u32 s37, s19, s67
  s_mov_b64 exec, 1
  s_mov_b32 s38, 0
.fz_kernel_po47:
  buffer_load_dword v7, v4, s[4:7], s37 offen offset:4 sc1
  s_add_u32 s38, s38, 1
  s_waitcnt vmcnt(0)
  ds_or_b32 v6, v7 offset:8
  v_cmp_ne_u32 vcc, 0xffff, v7
  s_cbranch_vccz .fz_kernel_po47d
  s_sleep 12
  s_cmp_lt_u32 s38, 131072
  s_cbranch_scc1 .fz_kernel_po47
.fz_kernel_po47d:
  s_mov_b64 exec, -1
.fz_kernel_sv5:
  s_mov_b32 s72, s66
  s_mov_b32 s73, s65
  s_mov_b32 s74, s67
  s_mov_b32 s75, s62
  s_cmp_lg_u32 s62, 0
  s_cbranch_scc1 .fz_kernel_w_lt
  s_mov_b32 s62, 1
  s_mov_b32 s63, 0x2000000
  s_mov_b32 s64, 0x2800000
  s_mov_b32 s65, 0x1400000
  s_mov_b32 s66, 0x1c42000
  s_mov_b32 s67, 12
  s_mov_b32 s71, 159776
  v_mov_b32 v6, 159832
  s_branch .fz_kernel_q_prod2
.fz_kernel_w_lt:
  s_barrier
  s_barrier
  s_branch .fz_kernel_fin
.fz_kernel_pk48c:
  s_call_b64 s[68:69], .fz_kernel_pick
  s_branch .fz_kernel_pk48
.fz_kernel_pk49c:
  s_call_b64 s[68:69], .fz_kernel_pick
  s_branch .fz_kernel_pk49
.fz_kernel_w_pt:
  v_lshlrev_b32 v44, 5, v17
  v_add_u32 v44, 155648, v44
  s_mov_b64 exec, vcc
  ds_read_b128 v[232:235], v44 offset:7424
  ds_read_b128 v[236:239], v44 offset:7440
  ds_read_b128 v[240:243], v44 offset:7488
  ds_read_b128 v[244:247], v44 offset:7504
  s_waitcnt lgkmcnt(0)
  v_pk_add_f32 v[64:65], v[64:65], v[232:233]
  v_pk_add_f32 v[66:67], v[66:67], v[234:235]
  v_pk_add_f32 v[68:69], v[68:69], v[236:237]
  v_pk_add_f32 v[70:71], v[70:71], v[238:239]
  v_pk_add_f32 v[72:73], v[72:73], v[240:241]
  v_pk_add_f32 v[74:75], v[74:75], v[242:243]
  v_pk_add_f32 v[76:77], v[76:77], v[244:245]
  v_pk_add_f32 v[78:79], v[78:79], v[246:247]
  ds_read_b128 v[232:235], v44 offset:7552
  ds_read_b128 v[236:239], v44 offset:7568
  ds_read_b128 v[240:243], v44 offset:7616
  ds_read_b128 v[244:247], v44 offset:7632
  s_waitcnt lgkmcnt(0)
  v_pk_add_f32 v[80:81], v[80:81], v[232:233]
  v_pk_add_f32 v[82:83], v[82:83], v[234:235]
  v_pk_add_f32 v[84:85], v[84:85], v[236:237]
  v_pk_add_f32 v[86:87], v[86:87], v[238:239]
  v_pk_add_f32 v[88:89], v[88:89], v[240:241]
  v_pk_add_f32 v[90:91], v[90:91], v[242:243]
  v_pk_add_f32 v[92:93], v[92:93], v[244:245]
  v_pk_add_f32 v[94:95], v[94:95], v[246:247]
  s_mov_b64 exec, -1
  s_branch .fz_kernel_w_pb
.fz_kernel_pk50c:
  s_call_b64 s[68:69], .fz_kernel_pick
  s_branch .fz_kernel_pk50
.fz_kernel_pk51c:
  s_call_b64 s[68:69], .fz_kernel_pick
  s_branch .fz_kernel_pk51
.fz_kernel_pk52c:
  s_call_b64 s[68:69], .fz_kernel_pick
  s_branch .fz_kernel_pk52
.fz_kernel_pk53c:
  s_call_b64 s[68:69], .fz_kernel_pick
  s_branch .fz_kernel_pk53
.fz_kernel_pk54c:
  s_call_b64 s[68:69], .fz_kernel_pick
  s_branch .fz_kernel_pk54
.fz_kernel_pk55c:
  s_call_b64 s[68:69], .fz_kernel_pick
  s_branch .fz_kernel_pk55
.fz_kernel_pk56c:
  s_call_b64 s[68:69], .fz_kernel_pick
  s_branch .fz_kernel_pk56
.fz_kernel_pk57c:
  s_call_b64 s[68:69], .fz_kernel_pick
  s_branch .fz_kernel_pk57
.fz_kernel_pk58c:
  s_call_b64 s[68:69], .fz_kernel_pick
  s_branch .fz_kernel_pk58
.fz_kernel_pk59c:
  s_call_b64 s[68:69], .fz_kernel_pick
  s_branch .fz_kernel_pk59
.fz_kernel_pk60c:
  s_call_b64 s[68:69], .fz_kernel_pick
  s_branch .fz_kernel_pk60
.fz_kernel_pk61c:
  s_call_b64 s[68:69], .fz_kernel_pick
  s_branch .fz_kernel_pk61
.fz_kernel_pk62c:
  s_call_b64 s[68:69], .fz_kernel_pick
  s_branch .fz_kernel_pk62
.fz_kernel_pk63c:
  s_call_b64 s[68:69], .fz_kernel_pick
  s_branch .fz_kernel_pk63
.fz_kernel_pk64c:
  s_call_b64 s[68:69], .fz_kernel_pick
  s_branch .fz_kernel_pk64
.fz_kernel_pk65c:
  s_call_b64 s[68:69], .fz_kernel_pick
  s_branch .fz_kernel_pk65
.fz_kernel_c_nl:
  s_barrier
  s_branch .fz_kernel_c_np
.fz_kernel_c_c7:
  s_mov_b32 s38, 0
.fz_kernel_cw70:
  s_sleep 1
  ds_read_u8 v22, v6 offset:272
  s_add_u32 s38, s38, 1
  s_waitcnt lgkmcnt(0)
  v_cmp_gt_u32 vcc, 2, v22
  s_cbranch_vccz .fz_kernel_cw70d
  s_cmp_lt_u32 s38, 8388608
  s_cbranch_scc1 .fz_kernel_cw70
.fz_kernel_cw70d:
  ds_read_b64_tr_b16 v[32:33], v7 offset:0
  ds_read_b64_tr_b16 v[34:35], v7 offset:512
  ds_read_b64_tr_b16 v[36:37], v13 offset:0
  ds_read_b64_tr_b16 v[38:39], v13 offset:512
  ds_read_b64_tr_b16 v[40:41], v7 offset:4096
  ds_read_b64_tr_b16 v[42:43], v7 offset:4608
  ds_read_b64_tr_b16 v[44:45], v13 offset:4096
  ds_read_b64_tr_b16 v[46:47], v13 offset:4608
  ds_read_b64_tr_b16 v[48:49], v7 offset:8192
  ds_read_b64_tr_b16 v[50:51], v7 offset:8704
  ds_read_b64_tr_b16 v[52:53], v13 offset:8192
  ds_read_b64_tr_b16 v[54:55], v13 offset:8704
  s_waitcnt lgkmcnt(0)
  v_xor_b32 v7, 64, v7
  v_xor_b32 v13, 64, v13
  ds_read_b64_tr_b16 v[56:57], v7 offset:1024
  ds_read_b64_tr_b16 v[58:59], v7 offset:1536
  ds_read_b64_tr_b16 v[60:61], v13 offset:1024
  ds_read_b64_tr_b16 v[62:63], v13 offset:1536
  ds_read_b64_tr_b16 v[64:65], v7 offset:5120
  ds_read_b64_tr_b16 v[66:67], v7 offset:5632
  ds_read_b64_tr_b16 v[68:69], v13 offset:5120
  ds_read_b64_tr_b16 v[70:71], v13 offset:5632
  ds_read_b64_tr_b16 v[72:73], v7 offset:9216
  ds_read_b64_tr_b16 v[74:75], v7 offset:9728
  ds_read_b64_tr_b16 v[76:77], v13 offset:9216
  ds_read_b64_tr_b16 v[78:79], v13 offset:9728
  s_waitcnt lgkmcnt(0)
  s_branch .fz_kernel_c_c2
.fz_kernel_c_coef:
  v_fma_f32 v242, -v240, v240, v242
  v_fma_f32 v243, -v241, v241, v243
  v_rsq_f32 v248, abs(v242)
  v_rsq_f32 v249, abs(v243)
  v_mul_f32 v254, v240, v248
  v_sub_f32 v254, 0, v254
  v_mov_b32 v252, 1.0
  v_fmac_f32 v252, 0x44800000, v248
  v_fma_f32 v242, v242, v24, -v25
  v_max_f32 v242, 0, v242
  v_mul_f32 v248, v252, v252
  v_fma_f32 v248, v248, v242, v25
  v_rsq_f32 v248, v248
  v_mul_f32 v240, v23, v240
  v_mul_f32 v248, v248, v252
  v_mul_f32 v250, v248, v240
  v_sub_f32 v250, 0, v250
  v_mul_f32 v255, v241, v249
  v_sub_f32 v255, 0, v255
  v_mov_b32 v253, 1.0
  v_fmac_f32 v253, 0x44800000, v249
  s_cmp_eq_u32 s3, 0
  s_cbranch_scc1 .fz_kernel_hb73
  s_barrier
  s_sub_u32 s3, s3, 1
.fz_kernel_hb73:
  v_fma_f32 v243, v243, v24, -v25
  v_max_f32 v243, 0, v243
  v_mul_f32 v249, v253, v253
  v_fma_f32 v249, v249, v243, v25
  v_rsq_f32 v249, v249
  v_mul_f32 v241, v23, v241
  v_mul_f32 v249, v249, v253
  v_mul_f32 v251, v249, v241
  v_sub_f32 v251, 0, v251
  s_setpc_b64 s[68:69]
.fz_kernel_c_gur:
  v_min_u32 v9, v144, v146
  v_cmp_eq_u32 s[8:9], 0, v9
  v_min_u32 v9, v148, v150
  v_cmp_eq_u32 s[10:11], 0, v9
  v_min_u32 v9, v152, v154
  v_cmp_eq_u32 s[12:13], 0, v9
  v_min_u32 v9, v156, v158
  v_cmp_eq_u32 s[14:15], 0, v9
  s_add_u32 s38, s38, 1
  s_cmp_ge_u32 s38, 131072
  s_cbranch_scc1 .fz_kernel_c_gud
  s_or_b64 exec, s[8:9], 1
  buffer_load_dwordx4 v[144:147], v21, s[4:7], s33 offen offset:0 sc1
  s_or_b64 exec, s[10:11], 1
  buffer_load_dwordx4 v[148:151], v21, s[4:7], s33 offen offset:512 sc1
  s_or_b64 exec, s[12:13], 1
  buffer_load_dwordx4 v[152:155], v21, s[4:7], s33 offen offset:1024 sc1
  s_or_b64 exec, s[14:15], 1
  buffer_load_dwordx4 v[156:159], v21, s[4:7], s33 offen offset:1536 sc1
  s_mov_b64 exec, -1
  s_branch .fz_kernel_c_gu
.fz_kernel_c_pur:
  s_cmp_eq_u32 s3, 0
  s_cbranch_scc1 .fz_kernel_hb78
  s_barrier
  s_sub_u32 s3, s3, 1
.fz_kernel_hb78:
  s_add_u32 s38, s38, 1
  s_cmp_ge_u32 s38, 131072
  s_cbranch_scc1 .fz_kernel_c_pud
  v_min_u32 v9, v144, v146
  v_cmp_eq_u32 vcc, 0, v9
  s_cbranch_vccz .fz_kernel_c_ps0
  buffer_load_dwordx4 v[144:147], v3, s[4:7], s21 offen offset:0 sc1
.fz_kernel_c_ps0:
  v_min_u32 v9, v148, v150
  v_cmp_eq_u32 vcc, 0, v9
  s_cbranch_vccz .fz_kernel_c_ps1
  buffer_load_dwordx4 v[148:151], v3, s[4:7], s21 offen offset:1024 sc1
.fz_kernel_c_ps1:
  v_min_u32 v9, v152, v154
  v_cmp_eq_u32 vcc, 0, v9
  s_cbranch_vccz .fz_kernel_c_ps2
  buffer_load_dwordx4 v[152:155], v3, s[4:7], s21 offen offset:2048 sc1
.fz_kernel_c_ps2:
  v_min_u32 v9, v156, v158
  v_cmp_eq_u32 vcc, 0, v9
  s_cbranch_vccz .fz_kernel_c_ps3
  buffer_load_dwordx4 v[156:159], v3, s[4:7], s21 offen offset:3072 sc1
.fz_kernel_c_ps3:
  v_min_u32 v9, v160, v162
  v_cmp_eq_u32 vcc, 0, v9
  s_cbranch_vccz .fz_kernel_c_ps4
  buffer_load_dwordx4 v[160:163], v3, s[4:7], s22 offen offset:0 sc1
.fz_kernel_c_ps4:
  v_min_u32 v9, v164, v166
  v_cmp_eq_u32 vcc, 0, v9
  s_cbranch_vccz .fz_kernel_c_ps5
  buffer_load_dwordx4 v[164:167], v3, s[4:7], s22 offen offset:1024 sc1
.fz_kernel_c_ps5:
  v_min_u32 v9, v168, v170
  v_cmp_eq_u32 vcc, 0, v9
  s_cbranch_vccz .fz_kernel_c_ps6
  buffer_load_dwordx4 v[168:171], v3, s[4:7], s22 offen offset:2048 sc1
.fz_kernel_c_ps6:
  s_branch .fz_kernel_c_pu
.fz_kernel_last:
  s_endpgm

.section .rodata,"a"
.p2align 6
.amdhsa_kernel fz_kernel
  .amdhsa_next_free_vgpr 256
  .amdhsa_next_free_sgpr 102
  .amdhsa_accum_offset 256
  .amdhsa_group_segment_fixed_size 0
  .amdhsa_kernarg_size 88
  .amdhsa_user_sgpr_count 2
  .amdhsa_user_sgpr_kernarg_segment_ptr 1
  .amdhsa_system_sgpr_workgroup_id_x 1
.end_amdhsa_kernel
```

```asm
; @launch kernel=fz_kernel grid=(256,1,1) block=(512,1,1) lds=163840
.amdgcn_target "amdgcn-amd-amdhsa--gfx950"
.text
.globl fz_kernel
.p2align 8
.type fz_kernel,@function
fz_kernel:
  s_cmp_ge_u32 s2, 256
  s_cbranch_scc1 .fz_kernel_end
  s_load_dwordx2 s[8:9], s[0:1], 0
  s_load_dwordx2 s[12:13], s[0:1], 8
  s_load_dwordx2 s[4:5], s[0:1], 80
  s_load_dwordx16 s[40:55], s[0:1], 0
  s_load_dwordx4 s[56:59], s[0:1], 64
  v_lshrrev_b32 v1, 6, v0
  v_and_b32 v2, 63, v0
  v_readfirstlane_b32 s16, v1
  s_and_b32 s21, s2, 7
  s_lshr_b32 s22, s2, 3
  s_and_b32 s23, s21, 3
  s_lshl_b32 s23, s23, 2
  s_and_b32 s24, s22, 3
  s_add_u32 s18, s23, s24
  s_lshr_b32 s24, s21, 2
  s_lshl_b32 s24, s24, 3
  s_lshr_b32 s25, s22, 2
  s_add_u32 s17, s24, s25
  s_lshl_b32 s19, s18, 4
  s_add_u32 s19, s19, s17
  s_lshl_b32 s19, s19, 7
  s_add_u32 s19, s19, 0x1800000
  v_lshlrev_b32 v3, 4, v2
  v_mov_b32 v4, 0
  v_mov_b32 v5, 1
  s_mov_b32 s6, 0x2c00000
  s_mov_b32 s7, 0x00020000
  s_mov_b32 s62, 0
  s_mov_b32 s63, 0x400000
  s_mov_b32 s64, 0xc00000
  s_mov_b32 s65, 0x1000000
  s_mov_b32 s66, 0x1c00000
  s_mov_b32 s67, 0
  s_mov_b32 s71, 159744
  v_mov_b32 v6, 159808
  s_cmp_lt_u32 s16, 4
  s_cbranch_scc1 .fz_kernel_q_cons1
  s_cmp_ge_u32 s16, 6
  s_cbranch_scc1 .fz_kernel_q_help1
  s_mov_b32 s10, 0x400000
  s_mov_b32 s11, 0x00020000
  v_lshrrev_b32 v20, 3, v2
  v_and_b32 v21, 7, v2
  v_lshrrev_b32 v22, 4, v2
  v_xor_b32 v23, v21, v22
  v_lshlrev_b32 v23, 4, v23
  v_lshl_add_u32 v24, v20, 11, v23
  v_xor_b32 v25, 64, v24
  s_lshl_b32 s35, s17, 2
  s_and_b32 s31, s16, 1
  s_add_u32 s35, s35, s31
  s_lshl_b32 s35, s35, 16
  s_and_b32 s29, s18, 12
  s_lshr_b32 s33, s17, 3
  s_lshl1_add_u32 s29, s33, s29
  s_lshl2_add_u32 s29, s17, s29
  s_and_b32 s29, s29, 15
  s_mov_b32 s22, 128
  s_mov_b32 s23, 131072
  s_mov_b32 s36, -1
  v_add_u32 v40, 0, v24
  v_add_u32 v41, 15360, v25
  v_add_u32 v42, 30720, v24
  v_add_u32 v43, 46080, v25
.fz_kernel_q_pc:
  s_mov_b32 s14, 0x600000
  s_mov_b32 s15, 0x00020000
  v_lshrrev_b32 v28, 3, v2
  v_and_b32 v29, 7, v2
  v_bfe_u32 v30, v2, 4, 1
  v_lshlrev_b32 v30, 1, v30
  v_xor_b32 v31, v29, v30
  v_lshlrev_b32 v31, 4, v31
  v_mul_u32_u24 v28, 6144, v28
  v_add_u32 v28, v28, v31
  v_xor_b32 v29, 64, v28
  s_lshl_b32 s32, s18, 7
  s_add_u32 s39, s32, 6291456
  s_mul_i32 s33, s29, 393216
  s_add_u32 s33, s33, s32
  s_lshl_b32 s29, s29, 1
  s_mul_i32 s25, s31, 6144
  s_add_u32 s25, s25, 65536
  s_mov_b32 s30, s25
  s_add_u32 s26, s25, 49152
  s_lshl_b32 s21, s31, 12
  s_cmp_eq_u32 s31, 0
  s_mov_b32 s24, 100352
  s_cselect_b32 s24, 0, s24
  v_add_u32 v32, s24, v28
  s_mov_b32 s24, 148480
  s_cselect_b32 s24, 48128, s24
  v_add_u32 v33, s24, v29
  s_mov_b32 s24, 2048
  s_cselect_b32 s24, 96256, s24
  v_add_u32 v34, s24, v28
  s_mov_b32 s24, 50176
  s_cselect_b32 s24, 144384, s24
  v_add_u32 v35, s24, v29
  s_mov_b32 s24, 102400
  s_cselect_b32 s24, 2048, s24
  v_add_u32 v36, s24, v28
  s_mov_b32 s24, 150528
  s_cselect_b32 s24, 50176, s24
  v_add_u32 v37, s24, v29
  s_cmp_lg_u32 s62, 0
  s_cbranch_scc1 .fz_kernel_q_st2
  s_waitcnt lgkmcnt(0)
  s_mov_b32 s34, 32
  s_call_b64 s[0:1], .fz_kernel_q_ix
  s_call_b64 s[0:1], .fz_kernel_q_iu
  s_call_b64 s[0:1], .fz_kernel_q_iu
  s_call_b64 s[0:1], .fz_kernel_q_iu
  s_waitcnt vmcnt(20)
  s_barrier
  s_call_b64 s[0:1], .fz_kernel_q_iu
  s_waitcnt vmcnt(24)
  s_barrier
  s_call_b64 s[0:1], .fz_kernel_q_iu
  s_branch .fz_kernel_q_pl
.fz_kernel_q_ix:
  s_bfe_u32 s24, s29, 0x40001
  s_mul_i32 s20, s24, s22
  s_bitcmp1_b32 s29, 0
  s_cselect_b32 s31, s23, 0
  s_add_u32 s20, s20, s35
  s_add_u32 s20, s20, s31
  s_bitcmp1_b32 s36, s24
  s_cbranch_scc0 .fz_kernel_xok1w
.fz_kernel_xok1:
  s_mov_b32 m0, s21
  s_add_u32 s21, s21, 8192
  s_and_b32 s21, s21, 0xffff
  s_add_u32 s29, s29, 1
  buffer_load_dwordx4 v40, s[8:11], s20 offen offset:0 lds
  buffer_load_dwordx4 v41, s[8:11], s20 offen offset:1024 lds
  buffer_load_dwordx4 v42, s[8:11], s20 offen offset:2048 lds
  buffer_load_dwordx4 v43, s[8:11], s20 offen offset:3072 lds
  s_setpc_b64 s[0:1]
.fz_kernel_q_iu:
  s_mov_b32 m0, s30
  s_add_u32 s30, s30, 12288
  buffer_load_dwordx4 v32, s[12:15], s33 offen offset:0 lds
  s_bfe_u32 s24, s29, 0x40001
  buffer_load_dwordx4 v33, s[12:15], s33 offen offset:1024 lds
  s_mul_i32 s20, s24, s22
  buffer_load_dwordx4 v34, s[12:15], s33 offen offset:2048 lds
  s_bitcmp1_b32 s29, 0
  s_cselect_b32 s31, s23, 0
  buffer_load_dwordx4 v35, s[12:15], s33 offen offset:3072 lds
  s_add_u32 m0, m0, 4096
  s_add_u32 s20, s20, s35
  buffer_load_dwordx4 v36, s[12:15], s33 offen offset:0 lds
  s_add_u32 s20, s20, s31
  buffer_load_dwordx4 v37, s[12:15], s33 offen offset:1024 lds
  s_bitcmp1_b32 s36, s24
  s_cbranch_scc0 .fz_kernel_xok2w
.fz_kernel_xok2:
  s_mov_b32 m0, s21
  s_add_u32 s21, s21, 8192
  s_and_b32 s21, s21, 0xffff
  s_add_u32 s29, s29, 1
  buffer_load_dwordx4 v40, s[8:11], s20 offen offset:0 lds
  s_add_u32 s33, s33, 196608
  s_cmp_eq_u32 s33, s39
  s_cselect_b32 s33, s32, s33
  buffer_load_dwordx4 v41, s[8:11], s20 offen offset:1024 lds
  s_cmp_eq_u32 s30, s26
  s_cselect_b32 s30, s25, s30
  buffer_load_dwordx4 v42, s[8:11], s20 offen offset:2048 lds
  s_sub_u32 s34, s34, 1
  s_cmp_lg_u32 s34, 0
  buffer_load_dwordx4 v43, s[8:11], s20 offen offset:3072 lds
  s_setpc_b64 s[0:1]
.fz_kernel_q_iw:
  s_mov_b32 m0, s30
  s_add_u32 s30, s30, 12288
  buffer_load_dwordx4 v32, s[12:15], s33 offen offset:0 lds
  s_nop 0
  buffer_load_dwordx4 v33, s[12:15], s33 offen offset:1024 lds
  s_nop 0
  buffer_load_dwordx4 v34, s[12:15], s33 offen offset:2048 lds
  s_nop 0
  buffer_load_dwordx4 v35, s[12:15], s33 offen offset:3072 lds
  s_add_u32 m0, m0, 4096
  s_nop 0
  buffer_load_dwordx4 v36, s[12:15], s33 offen offset:0 lds
  buffer_load_dwordx4 v37, s[12:15], s33 offen offset:1024 lds
  s_add_u32 s33, s33, 196608
  s_cmp_eq_u32 s33, s39
  s_cselect_b32 s33, s32, s33
  s_cmp_eq_u32 s30, s26
  s_cselect_b32 s30, s25, s30
  s_sub_u32 s34, s34, 1
  s_cmp_lg_u32 s34, 0
  s_setpc_b64 s[0:1]
.fz_kernel_q_st2:
  s_mov_b32 s34, 32
  s_waitcnt vmcnt(0)
  s_barrier
  s_call_b64 s[0:1], .fz_kernel_q_iw
  s_call_b64 s[0:1], .fz_kernel_q_iw
  s_call_b64 s[0:1], .fz_kernel_q_iw
  s_call_b64 s[0:1], .fz_kernel_q_iw
  s_call_b64 s[0:1], .fz_kernel_q_ix
  s_call_b64 s[0:1], .fz_kernel_q_ix
  s_mov_b64 exec, 1
  s_waitcnt vmcnt(20)
  ds_add_u32 v6, v5 offset:0x110
  s_mov_b64 exec, -1
  v_mov_b32 v12, 0x100
  s_call_b64 s[0:1], .fz_kernel_q_ix
  s_call_b64 s[0:1], .fz_kernel_q_ix
  s_waitcnt vmcnt(8)
  s_mov_b64 exec, 1
  ds_add_u32 v6, v12 offset:0x110
  s_mov_b64 exec, -1
  s_barrier
  s_waitcnt vmcnt(8)
  s_barrier
  s_call_b64 s[0:1], .fz_kernel_q_ix
  s_call_b64 s[0:1], .fz_kernel_q_iu
  s_waitcnt vmcnt(14)
  s_barrier
  s_call_b64 s[0:1], .fz_kernel_q_iu
  s_waitcnt vmcnt(20)
  s_barrier
  s_call_b64 s[0:1], .fz_kernel_q_iu
.fz_kernel_q_pl:
  s_waitcnt vmcnt(20)
  s_barrier
  s_mov_b32 m0, s30
  s_add_u32 s30, s30, 12288
  buffer_load_dwordx4 v32, s[12:15], s33 offen offset:0 lds
  s_bfe_u32 s24, s29, 0x40001
  buffer_load_dwordx4 v33, s[12:15], s33 offen offset:1024 lds
  s_mul_i32 s20, s24, s22
  buffer_load_dwordx4 v34, s[12:15], s33 offen offset:2048 lds
  s_bitcmp1_b32 s29, 0
  s_cselect_b32 s31, s23, 0
  buffer_load_dwordx4 v35, s[12:15], s33 offen offset:3072 lds
  s_add_u32 m0, m0, 4096
  s_add_u32 s20, s20, s35
  buffer_load_dwordx4 v36, s[12:15], s33 offen offset:0 lds
  s_add_u32 s20, s20, s31
  buffer_load_dwordx4 v37, s[12:15], s33 offen offset:1024 lds
  s_bitcmp1_b32 s36, s24
  s_cbranch_scc0 .fz_kernel_xok3w
.fz_kernel_xok3:
  s_mov_b32 m0, s21
  s_add_u32 s21, s21, 8192
  s_and_b32 s21, s21, 0xffff
  s_add_u32 s29, s29, 1
  buffer_load_dwordx4 v40, s[8:11], s20 offen offset:0 lds
  s_add_u32 s33, s33, 196608
  s_cmp_eq_u32 s33, s39
  s_cselect_b32 s33, s32, s33
  buffer_load_dwordx4 v41, s[8:11], s20 offen offset:1024 lds
  s_cmp_eq_u32 s30, s26
  s_cselect_b32 s30, s25, s30
  buffer_load_dwordx4 v42, s[8:11], s20 offen offset:2048 lds
  s_sub_u32 s34, s34, 1
  s_cmp_lg_u32 s34, 0
  buffer_load_dwordx4 v43, s[8:11], s20 offen offset:3072 lds
  s_cbranch_scc1 .fz_kernel_q_pl
  s_waitcnt vmcnt(20)
  s_barrier
  s_waitcnt vmcnt(10)
  s_barrier
  s_waitcnt vmcnt(0)
  s_barrier
  s_barrier
  s_branch .fz_kernel_serv
.fz_kernel_q_cons1:
  s_waitcnt lgkmcnt(0)
  s_mov_b32 s12, s42
  s_mov_b32 s13, s43
  s_mov_b32 s14, 0x600000
  s_mov_b32 s15, 0x00020000
  s_and_b32 s20, s18, 4
  s_add_u32 s20, s20, s16
  s_cmp_ge_u32 s20, 3
  s_cbranch_scc1 .fz_kernel_q_nsp
  s_and_b32 s20, s17, 7
  s_and_b32 s21, s18, 3
  s_lshl2_add_u32 s20, s20, s21
  s_mul_i32 s20, s20, 196608
  s_or_b32 s21, s18, 3
  s_lshl4_add_u32 s21, s16, s21
  s_lshl_b32 s21, s21, 7
  s_add_u32 s20, s20, s21
  v_mul_u32_u24 v20, 6144, v2
  s_mov_b32 exec_hi, 0
  buffer_load_dword v231, v20, s[12:15], s20 offen
  s_mov_b32 exec_hi, -1
.fz_kernel_q_nsp:
  v_lshlrev_b32 v20, 2, v0
  v_add_u32 v20, 159744, v20
  s_cmp_ge_u32 s16, 2
  s_cbranch_scc1 .fz_kernel_q_nz
  ds_write_b32 v20, v4
.fz_kernel_q_nz:
  s_lshr_b32 s26, s16, 1
  s_lshl_b32 s28, s26, 13
  v_and_b32 v20, 15, v2
  v_lshrrev_b32 v21, 4, v2
  v_bfe_u32 v22, v2, 1, 3
  v_xor_b32 v22, v22, v21
  v_lshlrev_b32 v20, 7, v20
  v_lshl_add_u32 v20, v22, 4, v20
  v_add_u32 v8, s28, v20
  v_xor_b32 v9, 64, v8
.fz_kernel_q_cs:
  s_and_b32 s27, s16, 1
  s_lshl_b32 s28, s27, 1
  v_lshrrev_b32 v14, 4, v2
  v_bfe_u32 v15, v2, 2, 2
  v_lshl_add_u32 v16, v14, 3, v15
  v_lshlrev_b32 v16, 7, v16
  v_and_b32 v14, 1, v14
  v_lshrrev_b32 v15, 1, v15
  v_lshl_add_u32 v14, v14, 1, v15
  v_xor_b32 v14, s28, v14
  v_lshl_add_u32 v16, v14, 5, v16
  v_and_b32 v14, 3, v2
  v_lshl_add_u32 v16, v14, 3, v16
  v_add_u32 v12, 65536, v16
  v_xor_b32 v13, 32, v12
  v_mov_b32 v10, v12
  v_mov_b32 v11, v13
  s_mov_b32 s29, 16
  s_mov_b32 s30, 0
  v_mov_b32 v128, 0
  v_mov_b32 v129, 0
  v_mov_b32 v130, 0
  v_mov_b32 v131, 0
  v_mov_b32 v132, 0
  v_mov_b32 v133, 0
  v_mov_b32 v134, 0
  v_mov_b32 v135, 0
  v_mov_b32 v136, 0
  v_mov_b32 v137, 0
  v_mov_b32 v138, 0
  v_mov_b32 v139, 0
  v_mov_b32 v140, 0
  v_mov_b32 v141, 0
  v_mov_b32 v142, 0
  v_mov_b32 v143, 0
  v_mov_b32 v144, 0
  v_mov_b32 v145, 0
  v_mov_b32 v146, 0
  v_mov_b32 v147, 0
  v_mov_b32 v148, 0
  v_mov_b32 v149, 0
  v_mov_b32 v150, 0
  v_mov_b32 v151, 0
  v_mov_b32 v152, 0
  v_mov_b32 v153, 0
  v_mov_b32 v154, 0
  v_mov_b32 v155, 0
  v_mov_b32 v156, 0
  v_mov_b32 v157, 0
  v_mov_b32 v158, 0
  v_mov_b32 v159, 0
  v_mov_b32 v160, 0
  v_mov_b32 v161, 0
  v_mov_b32 v162, 0
  v_mov_b32 v163, 0
  v_mov_b32 v164, 0
  v_mov_b32 v165, 0
  v_mov_b32 v166, 0
  v_mov_b32 v167, 0
  v_mov_b32 v168, 0
  v_mov_b32 v169, 0
  v_mov_b32 v170, 0
  v_mov_b32 v171, 0
  v_mov_b32 v172, 0
  v_mov_b32 v173, 0
  v_mov_b32 v174, 0
  v_mov_b32 v175, 0
  s_cmp_eq_u32 s62, 0
  s_cbranch_scc1 .fz_kernel_q_i1
  s_mov_b64 exec, 1
  s_waitcnt vmcnt(0)
  ds_add_u32 v1, v5 offset:0x100
  s_mov_b64 exec, -1
.fz_kernel_q_i1:
  v_mov_b32 v176, 0
  v_mov_b32 v177, 0
  v_mov_b32 v178, 0
  v_mov_b32 v179, 0
  v_mov_b32 v180, 0
  v_mov_b32 v181, 0
  v_mov_b32 v182, 0
  v_mov_b32 v183, 0
  v_mov_b32 v184, 0
  v_mov_b32 v185, 0
  v_mov_b32 v186, 0
  v_mov_b32 v187, 0
  v_mov_b32 v188, 0
  v_mov_b32 v189, 0
  v_mov_b32 v190, 0
  v_mov_b32 v191, 0
  v_mov_b32 v192, 0
  v_mov_b32 v193, 0
  v_mov_b32 v194, 0
  v_mov_b32 v195, 0
  v_mov_b32 v196, 0
  v_mov_b32 v197, 0
  v_mov_b32 v198, 0
  v_mov_b32 v199, 0
  v_mov_b32 v200, 0
  v_mov_b32 v201, 0
  v_mov_b32 v202, 0
  v_mov_b32 v203, 0
  v_mov_b32 v204, 0
  v_mov_b32 v205, 0
  v_mov_b32 v206, 0
  v_mov_b32 v207, 0
  v_mov_b32 v208, 0
  v_mov_b32 v209, 0
  v_mov_b32 v210, 0
  v_mov_b32 v211, 0
  v_mov_b32 v212, 0
  v_mov_b32 v213, 0
  v_mov_b32 v214, 0
  v_mov_b32 v215, 0
  v_mov_b32 v216, 0
  v_mov_b32 v217, 0
  v_mov_b32 v218, 0
  v_mov_b32 v219, 0
  v_mov_b32 v220, 0
  v_mov_b32 v221, 0
  v_mov_b32 v222, 0
  v_mov_b32 v223, 0
  v_and_b32 v14, 1, v2
  v_lshlrev_b32 v14, 4, v14
  v_mov_b32 v15, 0x3f80
  v_lshlrev_b32 v14, v14, v15
  v_mov_b32 v248, 0
  v_mov_b32 v249, 0
  v_mov_b32 v250, 0
  v_mov_b32 v251, 0
  v_mov_b32 v252, 0
  v_mov_b32 v253, 0
  v_mov_b32 v254, 0
  v_mov_b32 v255, 0
  s_mov_b32 exec_lo, 0x3
  s_mov_b32 exec_hi, 0x30
  v_mov_b32 v248, v14
  s_mov_b32 exec_lo, 0xc
  s_mov_b32 exec_hi, 0xc0
  v_mov_b32 v249, v14
  s_mov_b32 exec_lo, 0x300
  s_mov_b32 exec_hi, 0x3000
  v_mov_b32 v250, v14
  s_mov_b32 exec_lo, 0xc00
  s_mov_b32 exec_hi, 0xc000
  v_mov_b32 v251, v14
  s_mov_b32 exec_lo, 0x30000
  s_mov_b32 exec_hi, 0x300000
  v_mov_b32 v252, v14
  s_mov_b32 exec_lo, 0xc0000
  s_mov_b32 exec_hi, 0xc00000
  v_mov_b32 v253, v14
  s_mov_b32 exec_lo, 0x3000000
  s_mov_b32 exec_hi, 0x30000000
  v_mov_b32 v254, v14
  s_mov_b32 exec_lo, 0xc000000
  s_mov_b32 exec_hi, 0xc0000000
  v_mov_b32 v255, v14
  s_mov_b64 exec, -1
  s_lshl1_add_u32 s35, s18, s27
  s_lshl_b32 s35, s35, 5
  s_add_u32 s35, s35, s26
  s_lshl_b32 s35, s35, 13
  s_add_u32 s35, s35, s63
  s_lshl_b32 s11, s16, 8
  s_add_u32 s11, s11, 147456
  s_mov_b32 s20, 0xffff0000
  s_mov_b32 s21, 0xffff0000
  s_mov_b32 s24, 0x21800000
  s_mov_b32 s25, 0x5d800000
  s_andn2_b32 s8, 2, s16
  s_lshl2_add_u32 s8, s17, s8
  s_lshl4_add_u32 s8, s8, s18
  s_lshl1_add_u32 s8, s8, s27
  s_lshl_b32 s8, s8, 11
  s_add_u32 s8, s8, s64
  s_add_u32 s9, s8, 65536
  s_mov_b32 s73, 0
  s_mov_b32 s32, 7
  s_mov_b32 s12, s40
  s_mov_b32 s13, s41
  s_mov_b32 s14, 0x400000
  s_mov_b32 s15, 0x00020000
  v_lshrrev_b32 v14, 5, v2
  v_and_b32 v15, 31, v2
  v_lshlrev_b32 v14, 4, v14
  v_lshl_add_u32 v15, v15, 11, v14
  s_lshl2_add_u32 s23, s17, s16
  s_lshl_b32 s23, s23, 16
  s_lshl_b32 s22, s18, 7
  s_add_u32 s23, s22, s23
  s_waitcnt lgkmcnt(0)
  s_barrier
  ds_read_b64_tr_b16 v[56:57], v10 offset:4096
  ds_read_b64_tr_b16 v[58:59], v10 offset:4608
  ds_read_b128 v[32:35], v8 offset:0
  ds_read_b128 v[36:39], v8 offset:2048
  ds_read_b128 v[40:43], v8 offset:4096
  ds_read_b128 v[44:47], v8 offset:6144
  ds_read_b64_tr_b16 v[60:61], v11 offset:4096
  ds_read_b64_tr_b16 v[62:63], v11 offset:4608
  ds_read_b64_tr_b16 v[64:65], v10 offset:8192
  ds_read_b64_tr_b16 v[66:67], v10 offset:8704
  ds_read_b64_tr_b16 v[68:69], v11 offset:8192
  ds_read_b64_tr_b16 v[70:71], v11 offset:8704
  ds_read_b64_tr_b16 v[48:49], v10 offset:0
  ds_read_b64_tr_b16 v[50:51], v10 offset:512
  ds_read_b64_tr_b16 v[52:53], v11 offset:0
  ds_read_b64_tr_b16 v[54:55], v11 offset:512
  s_add_u32 s30, s30, 12288
  s_cmp_eq_u32 s30, 49152
  s_cselect_b32 s30, 0, s30
  v_add_u32 v8, 0x4000, v8
  v_add_u32 v10, s30, v12
  v_add_u32 v11, s30, v13
  v_and_b32 v8, 0xffff, v8
  s_waitcnt lgkmcnt(0)
  s_branch .fz_kernel_q_l0
  .p2align 6
.fz_kernel_q_loop:
  v_mfma_f32_16x16x32_bf16 v[148:151], v[52:55], v[36:39], v[148:151]
  v_mfma_f32_16x16x32_bf16 v[152:155], v[52:55], v[40:43], v[152:155]
  s_waitcnt lgkmcnt(0)
  v_mfma_f32_16x16x32_bf16 v[156:159], v[52:55], v[44:47], v[156:159]
  s_barrier
  v_mfma_f32_16x16x32_bf16 v[160:163], v[96:99], v[72:75], v[160:163]
  ds_read_b64_tr_b16 v[56:57], v10 offset:4096
  v_mfma_f32_16x16x32_bf16 v[164:167], v[96:99], v[76:79], v[164:167]
  ds_read_b64_tr_b16 v[58:59], v10 offset:4608
  v_mfma_f32_16x16x32_bf16 v[168:171], v[96:99], v[80:83], v[168:171]
  ds_read_b128 v[32:35], v8 offset:0
  v_mfma_f32_16x16x32_bf16 v[172:175], v[96:99], v[84:87], v[172:175]
  ds_read_b128 v[36:39], v8 offset:2048
  v_mfma_f32_16x16x32_bf16 v[176:179], v[100:103], v[72:75], v[176:179]
  ds_read_b128 v[40:43], v8 offset:4096
  v_mfma_f32_16x16x32_bf16 v[180:183], v[100:103], v[76:79], v[180:183]
  ds_read_b128 v[44:47], v8 offset:6144
  v_mfma_f32_16x16x32_bf16 v[184:187], v[100:103], v[80:83], v[184:187]
  ds_read_b64_tr_b16 v[60:61], v11 offset:4096
  v_mfma_f32_16x16x32_bf16 v[188:191], v[100:103], v[84:87], v[188:191]
  ds_read_b64_tr_b16 v[62:63], v11 offset:4608
  v_mfma_f32_16x16x32_bf16 v[192:195], v[72:75], v[104:107], v[192:195]
  ds_read_b64_tr_b16 v[64:65], v10 offset:8192
  s_add_u32 s30, s30, 12288
  v_mfma_f32_16x16x32_bf16 v[196:199], v[76:79], v[104:107], v[196:199]
  ds_read_b64_tr_b16 v[66:67], v10 offset:8704
  s_cmp_eq_u32 s30, 49152
  v_mfma_f32_16x16x32_bf16 v[200:203], v[80:83], v[104:107], v[200:203]
  ds_read_b64_tr_b16 v[68:69], v11 offset:8192
  s_cselect_b32 s30, 0, s30
  v_mfma_f32_16x16x32_bf16 v[204:207], v[84:87], v[104:107], v[204:207]
  ds_read_b64_tr_b16 v[70:71], v11 offset:8704
  v_mfma_f32_16x16x32_bf16 v[208:211], v[72:75], v[108:111], v[208:211]
  ds_read_b64_tr_b16 v[48:49], v10 offset:0
  v_mfma_f32_16x16x32_bf16 v[212:215], v[76:79], v[108:111], v[212:215]
  ds_read_b64_tr_b16 v[50:51], v10 offset:512
  v_mfma_f32_16x16x32_bf16 v[216:219], v[80:83], v[108:111], v[216:219]
  ds_read_b64_tr_b16 v[52:53], v11 offset:0
  v_mfma_f32_16x16x32_bf16 v[220:223], v[84:87], v[108:111], v[220:223]
  ds_read_b64_tr_b16 v[54:55], v11 offset:512
  v_mfma_f32_16x16x32_bf16 v[128:131], v[88:91], v[72:75], v[128:131]
  v_add_u32 v8, 0x4000, v8
  v_mfma_f32_16x16x32_bf16 v[132:135], v[88:91], v[76:79], v[132:135]
  v_add_u32 v10, s30, v12
  v_mfma_f32_16x16x32_bf16 v[136:139], v[88:91], v[80:83], v[136:139]
  v_add_u32 v11, s30, v13
  v_mfma_f32_16x16x32_bf16 v[140:143], v[88:91], v[84:87], v[140:143]
  v_and_b32 v8, 0xffff, v8
  v_mfma_f32_16x16x32_bf16 v[144:147], v[92:95], v[72:75], v[144:147]
  v_mfma_f32_16x16x32_bf16 v[148:151], v[92:95], v[76:79], v[148:151]
  v_mfma_f32_16x16x32_bf16 v[152:155], v[92:95], v[80:83], v[152:155]
  s_waitcnt lgkmcnt(0)
  v_mfma_f32_16x16x32_bf16 v[156:159], v[92:95], v[84:87], v[156:159]
.fz_kernel_q_l0:
  s_barrier
  v_mfma_f32_16x16x32_bf16 v[160:163], v[56:59], v[32:35], v[160:163]
  ds_read_b64_tr_b16 v[96:97], v10 offset:4096
  v_mfma_f32_16x16x32_bf16 v[164:167], v[56:59], v[36:39], v[164:167]
  ds_read_b64_tr_b16 v[98:99], v10 offset:4608
  v_mfma_f32_16x16x32_bf16 v[168:171], v[56:59], v[40:43], v[168:171]
  ds_read_b128 v[72:75], v9 offset:0
  v_mfma_f32_16x16x32_bf16 v[172:175], v[56:59], v[44:47], v[172:175]
  ds_read_b128 v[76:79], v9 offset:2048
  v_mfma_f32_16x16x32_bf16 v[176:179], v[60:63], v[32:35], v[176:179]
  ds_read_b128 v[80:83], v9 offset:4096
  v_mfma_f32_16x16x32_bf16 v[180:183], v[60:63], v[36:39], v[180:183]
  ds_read_b128 v[84:87], v9 offset:6144
  v_mfma_f32_16x16x32_bf16 v[184:187], v[60:63], v[40:43], v[184:187]
  ds_read_b64_tr_b16 v[100:101], v11 offset:4096
  v_mfma_f32_16x16x32_bf16 v[188:191], v[60:63], v[44:47], v[188:191]
  ds_read_b64_tr_b16 v[102:103], v11 offset:4608
  v_mfma_f32_16x16x32_bf16 v[192:195], v[32:35], v[64:67], v[192:195]
  ds_read_b64_tr_b16 v[104:105], v10 offset:8192
  s_add_u32 s30, s30, 12288
  v_mfma_f32_16x16x32_bf16 v[196:199], v[36:39], v[64:67], v[196:199]
  ds_read_b64_tr_b16 v[106:107], v10 offset:8704
  s_cmp_eq_u32 s30, 49152
  v_mfma_f32_16x16x32_bf16 v[200:203], v[40:43], v[64:67], v[200:203]
  ds_read_b64_tr_b16 v[108:109], v11 offset:8192
  s_cselect_b32 s30, 0, s30
  v_mfma_f32_16x16x32_bf16 v[204:207], v[44:47], v[64:67], v[204:207]
  ds_read_b64_tr_b16 v[110:111], v11 offset:8704
  s_sub_u32 s29, s29, 1
  v_mfma_f32_16x16x32_bf16 v[208:211], v[32:35], v[68:71], v[208:211]
  ds_read_b64_tr_b16 v[88:89], v10 offset:0
  s_cmp_lg_u32 s29, 0
  v_mfma_f32_16x16x32_bf16 v[212:215], v[36:39], v[68:71], v[212:215]
  ds_read_b64_tr_b16 v[90:91], v10 offset:512
  v_mfma_f32_16x16x32_bf16 v[216:219], v[40:43], v[68:71], v[216:219]
  ds_read_b64_tr_b16 v[92:93], v11 offset:0
  v_mfma_f32_16x16x32_bf16 v[220:223], v[44:47], v[68:71], v[220:223]
  ds_read_b64_tr_b16 v[94:95], v11 offset:512
  v_mfma_f32_16x16x32_bf16 v[128:131], v[48:51], v[32:35], v[128:131]
  v_add_u32 v9, 0x4000, v9
  v_mfma_f32_16x16x32_bf16 v[132:135], v[48:51], v[36:39], v[132:135]
  v_add_u32 v10, s30, v12
  v_mfma_f32_16x16x32_bf16 v[136:139], v[48:51], v[40:43], v[136:139]
  v_add_u32 v11, s30, v13
  v_mfma_f32_16x16x32_bf16 v[140:143], v[48:51], v[44:47], v[140:143]
  v_and_b32 v9, 0xffff, v9
  v_mfma_f32_16x16x32_bf16 v[144:147], v[52:55], v[32:35], v[144:147]
  s_cbranch_scc1 .fz_kernel_q_loop
  v_mfma_f32_16x16x32_bf16 v[148:151], v[52:55], v[36:39], v[148:151]
  v_mfma_f32_16x16x32_bf16 v[152:155], v[52:55], v[40:43], v[152:155]
  s_waitcnt lgkmcnt(0)
  v_mfma_f32_16x16x32_bf16 v[156:159], v[52:55], v[44:47], v[156:159]
  s_cmp_lg_u32 s62, 0
  s_cbranch_scc1 .fz_kernel_q_nr
  buffer_load_dwordx4 v[232:235], v15, s[12:15], s23 offen offset:0
  buffer_load_dwordx4 v[236:239], v15, s[12:15], s23 offen offset:32
  buffer_load_dwordx4 v[240:243], v15, s[12:15], s23 offen offset:64
  buffer_load_dwordx4 v[244:247], v15, s[12:15], s23 offen offset:96
.fz_kernel_q_nr:
  s_barrier
  v_mfma_f32_16x16x32_bf16 v[160:163], v[96:99], v[72:75], v[160:163]
  s_lshl_b32 s31, s26, 8
  s_add_u32 s31, s31, 155648
  v_and_b32 v22, 15, v2
  v_and_b32 v23, 48, v2
  v_mfma_f32_16x16x32_bf16 v[164:167], v[96:99], v[76:79], v[164:167]
  s_lshl_b32 s33, s27, 7
  s_add_u32 s33, s33, 155648
  v_lshlrev_b32 v22, 2, v22
  v_mov_b32 v1, 159952
  v_mfma_f32_16x16x32_bf16 v[168:171], v[96:99], v[80:83], v[168:171]
  v_add_u32 v29, s33, v22
  v_add_u32 v22, s31, v22
  v_mfma_f32_16x16x32_bf16 v[172:175], v[96:99], v[84:87], v[172:175]
  v_add_u32 v28, s33, v23
  v_add_u32 v23, s31, v23
  v_mfma_f32_16x16x32_bf16 v[176:179], v[100:103], v[72:75], v[176:179]
  ds_read_b32 v1, v1
  v_add_u32 v64, 4608, v22
  v_mfma_f32_16x16x32_bf16 v[180:183], v[100:103], v[76:79], v[180:183]
  ds_read_b128 v[120:123], v28 offset:5888
  v_and_b32 v12, 1, v2
  v_mfma_f32_16x16x32_bf16 v[184:187], v[100:103], v[80:83], v[184:187]
  ds_read_b128 v[124:127], v28 offset:5952
  v_add_u32 v12, -1, v12
  v_mfma_f32_16x16x32_bf16 v[188:191], v[100:103], v[84:87], v[188:191]
  ds_read2_b32 v[224:225], v64 offset0:0 offset1:128
  v_and_b32 v12, 0x3f803f80, v12
  v_mfma_f32_16x16x32_bf16 v[192:195], v[72:75], v[104:107], v[192:195]
  ds_read2_b32 v[226:227], v64 offset0:16 offset1:144
  v_and_b32 v11, 2, v2
  v_mfma_f32_16x16x32_bf16 v[196:199], v[76:79], v[104:107], v[196:199]
  ds_read2_b32 v[228:229], v64 offset0:32 offset1:160
  v_xor_b32 v14, 0x3f803f80, v12
  v_mfma_f32_16x16x32_bf16 v[200:203], v[80:83], v[104:107], v[200:203]
  ds_read2_b32 v[230:231], v64 offset0:48 offset1:176
  v_mul_u32_u24 v11, 0x5555, v11
  v_mfma_f32_16x16x32_bf16 v[204:207], v[84:87], v[104:107], v[204:207]
  ds_read_b32 v24, v29 offset:6144
  v_mov_b32 v13, v12
  v_mfma_f32_16x16x32_bf16 v[208:211], v[72:75], v[108:111], v[208:211]
  ds_read_b32 v26, v29 offset:6208
  v_mov_b32 v15, v14
  v_mfma_f32_16x16x32_bf16 v[212:215], v[76:79], v[108:111], v[212:215]
  ds_read_b128 v[32:35], v23 offset:4608
  ds_read_b128 v[48:51], v23 offset:5120
  v_mfma_f32_16x16x32_bf16 v[216:219], v[80:83], v[108:111], v[216:219]
  ds_read_b128 v[36:39], v23 offset:4672
  ds_read_b128 v[52:55], v23 offset:5184
  v_mfma_f32_16x16x32_bf16 v[220:223], v[84:87], v[108:111], v[220:223]
  ds_read_b128 v[40:43], v23 offset:4736
  ds_read_b128 v[56:59], v23 offset:5248
  v_mfma_f32_16x16x32_bf16 v[128:131], v[88:91], v[72:75], v[128:131]
  ds_read_b128 v[44:47], v23 offset:4800
  ds_read_b128 v[60:63], v23 offset:5312
  v_mfma_f32_16x16x32_bf16 v[132:135], v[88:91], v[76:79], v[132:135]
  ds_read_b128 v[112:115], v28 offset:5632
  ds_read_b128 v[116:119], v28 offset:5696
  v_mfma_f32_16x16x32_bf16 v[136:139], v[88:91], v[80:83], v[136:139]
  s_lshl1_add_u32 s34, s18, s27
  s_lshl4_add_u32 s34, s34, s17
  s_lshl1_add_u32 s34, s34, s26
  v_mfma_f32_16x16x32_bf16 v[140:143], v[88:91], v[84:87], v[140:143]
  s_lshl_b32 s36, s34, 13
  s_add_u32 s36, s36, s63
  s_add_u32 s37, s36, 4096
  v_mfma_f32_16x16x32_bf16 v[144:147], v[92:95], v[72:75], v[144:147]
  s_lshl_b32 s34, s16, 12
  s_add_u32 s34, s34, 131072
  v_add_u32 v9, s34, v3
  v_mfma_f32_16x16x32_bf16 v[148:151], v[92:95], v[76:79], v[148:151]
  v_xor_b32 v8, 8192, v9
  v_mfma_f32_16x16x32_bf16 v[152:155], v[92:95], v[80:83], v[152:155]
  v_add_u32 v11, 0x4444, v11
  v_mfma_f32_16x16x32_bf16 v[156:159], v[92:95], v[84:87], v[156:159]
  v_add_u32 v10, 4096, v3
  s_waitcnt lgkmcnt(12)
  v_add_u32 v1, -1, v1
  v_lshrrev_b32 v1, 6, v1
  v_cmp_eq_u32 vcc, s26, v1
  s_cbranch_vccnz .fz_kernel_q_patch
.fz_kernel_q_pback:
  v_pk_mul_f32 v[64:65], v[120:121], v[224:225] op_sel:[0,1] op_sel_hi:[1,1]
  v_pk_fma_f32 v[160:161], v[160:161], v[224:225], v[64:65] op_sel_hi:[1,0,1]
  v_pk_mul_f32 v[66:67], v[122:123], v[224:225] op_sel:[0,1] op_sel_hi:[1,1]
  v_pk_fma_f32 v[162:163], v[162:163], v[224:225], v[66:67] op_sel_hi:[1,0,1]
  v_pk_mul_f32 v[68:69], v[124:125], v[224:225] op_sel:[0,1] op_sel_hi:[1,1]
  v_pk_fma_f32 v[176:177], v[176:177], v[224:225], v[68:69] op_sel_hi:[1,0,1]
  v_pk_mul_f32 v[70:71], v[126:127], v[224:225] op_sel:[0,1] op_sel_hi:[1,1]
  v_pk_fma_f32 v[178:179], v[178:179], v[224:225], v[70:71] op_sel_hi:[1,0,1]
  v_cvt_pk_bf16_f32 v80, v160, v161
  v_cvt_pk_bf16_f32 v81, v162, v163
  v_cvt_pk_bf16_f32 v82, v176, v177
  v_cvt_pk_bf16_f32 v83, v178, v179
  v_pk_mul_f32 v[64:65], v[120:121], v[226:227] op_sel:[0,1] op_sel_hi:[1,1]
  v_pk_fma_f32 v[164:165], v[164:165], v[226:227], v[64:65] op_sel_hi:[1,0,1]
  v_pk_mul_f32 v[66:67], v[122:123], v[226:227] op_sel:[0,1] op_sel_hi:[1,1]
  v_pk_fma_f32 v[166:167], v[166:167], v[226:227], v[66:67] op_sel_hi:[1,0,1]
  v_pk_mul_f32 v[68:69], v[124:125], v[226:227] op_sel:[0,1] op_sel_hi:[1,1]
  v_pk_fma_f32 v[180:181], v[180:181], v[226:227], v[68:69] op_sel_hi:[1,0,1]
  v_pk_mul_f32 v[70:71], v[126:127], v[226:227] op_sel:[0,1] op_sel_hi:[1,1]
  v_pk_fma_f32 v[182:183], v[182:183], v[226:227], v[70:71] op_sel_hi:[1,0,1]
  v_cvt_pk_bf16_f32 v84, v164, v165
  v_cvt_pk_bf16_f32 v85, v166, v167
  v_cvt_pk_bf16_f32 v86, v180, v181
  v_cvt_pk_bf16_f32 v87, v182, v183
  v_permlane16_swap_b32 v80, v84
  v_permlane16_swap_b32 v81, v85
  v_permlane16_swap_b32 v82, v86
  v_permlane16_swap_b32 v83, v87
  buffer_store_dwordx4 v[80:83], v3, s[4:7], s36 offen offset:0 sc1
  buffer_store_dwordx4 v[84:87], v3, s[4:7], s36 offen offset:1024 sc1
  v_pk_mul_f32 v[64:65], v[120:121], v[228:229] op_sel:[0,1] op_sel_hi:[1,1]
  v_pk_fma_f32 v[168:169], v[168:169], v[228:229], v[64:65] op_sel_hi:[1,0,1]
  v_pk_mul_f32 v[66:67], v[122:123], v[228:229] op_sel:[0,1] op_sel_hi:[1,1]
  v_pk_fma_f32 v[170:171], v[170:171], v[228:229], v[66:67] op_sel_hi:[1,0,1]
  v_pk_mul_f32 v[68:69], v[124:125], v[228:229] op_sel:[0,1] op_sel_hi:[1,1]
  v_pk_fma_f32 v[184:185], v[184:185], v[228:229], v[68:69] op_sel_hi:[1,0,1]
  v_pk_mul_f32 v[70:71], v[126:127], v[228:229] op_sel:[0,1] op_sel_hi:[1,1]
  v_pk_fma_f32 v[186:187], v[186:187], v[228:229], v[70:71] op_sel_hi:[1,0,1]
  v_cvt_pk_bf16_f32 v96, v168, v169
  v_cvt_pk_bf16_f32 v97, v170, v171
  v_cvt_pk_bf16_f32 v98, v184, v185
  v_cvt_pk_bf16_f32 v99, v186, v187
  v_pk_mul_f32 v[64:65], v[120:121], v[230:231] op_sel:[0,1] op_sel_hi:[1,1]
  v_pk_fma_f32 v[172:173], v[172:173], v[230:231], v[64:65] op_sel_hi:[1,0,1]
  v_pk_mul_f32 v[66:67], v[122:123], v[230:231] op_sel:[0,1] op_sel_hi:[1,1]
  v_pk_fma_f32 v[174:175], v[174:175], v[230:231], v[66:67] op_sel_hi:[1,0,1]
  v_pk_mul_f32 v[68:69], v[124:125], v[230:231] op_sel:[0,1] op_sel_hi:[1,1]
  v_pk_fma_f32 v[188:189], v[188:189], v[230:231], v[68:69] op_sel_hi:[1,0,1]
  v_pk_mul_f32 v[70:71], v[126:127], v[230:231] op_sel:[0,1] op_sel_hi:[1,1]
  v_pk_fma_f32 v[190:191], v[190:191], v[230:231], v[70:71] op_sel_hi:[1,0,1]
  v_cvt_pk_bf16_f32 v100, v172, v173
  v_cvt_pk_bf16_f32 v101, v174, v175
  v_cvt_pk_bf16_f32 v102, v188, v189
  v_cvt_pk_bf16_f32 v103, v190, v191
  v_permlane16_swap_b32 v96, v100
  v_permlane16_swap_b32 v97, v101
  v_permlane16_swap_b32 v98, v102
  v_permlane16_swap_b32 v99, v103
  buffer_store_dwordx4 v[96:99], v3, s[4:7], s37 offen offset:0 sc1
  buffer_store_dwordx4 v[100:103], v3, s[4:7], s37 offen offset:1024 sc1
  s_waitcnt lgkmcnt(0)
  v_pk_mul_f32 v[64:65], v[48:49], v[24:25] op_sel_hi:[1,0]
  v_pk_fma_f32 v[192:193], v[192:193], v[32:33], v[64:65]
  v_pk_mul_f32 v[66:67], v[50:51], v[24:25] op_sel_hi:[1,0]
  v_pk_fma_f32 v[194:195], v[194:195], v[34:35], v[66:67]
  v_pk_mul_f32 v[68:69], v[48:49], v[26:27] op_sel_hi:[1,0]
  v_pk_fma_f32 v[208:209], v[208:209], v[32:33], v[68:69]
  v_pk_mul_f32 v[70:71], v[50:51], v[26:27] op_sel_hi:[1,0]
  v_pk_fma_f32 v[210:211], v[210:211], v[34:35], v[70:71]
  v_cvt_pk_bf16_f32 v88, v192, v193
  v_cvt_pk_bf16_f32 v90, v208, v209
  v_cvt_pk_bf16_f32 v89, v194, v195
  v_cvt_pk_bf16_f32 v91, v210, v211
  v_pk_mul_f32 v[64:65], v[52:53], v[24:25] op_sel_hi:[1,0]
  v_pk_fma_f32 v[196:197], v[196:197], v[36:37], v[64:65]
  v_pk_mul_f32 v[66:67], v[54:55], v[24:25] op_sel_hi:[1,0]
  v_pk_fma_f32 v[198:199], v[198:199], v[38:39], v[66:67]
  v_pk_mul_f32 v[68:69], v[52:53], v[26:27] op_sel_hi:[1,0]
  v_pk_fma_f32 v[212:213], v[212:213], v[36:37], v[68:69]
  v_pk_mul_f32 v[70:71], v[54:55], v[26:27] op_sel_hi:[1,0]
  v_pk_fma_f32 v[214:215], v[214:215], v[38:39], v[70:71]
  v_cvt_pk_bf16_f32 v92, v196, v197
  v_cvt_pk_bf16_f32 v94, v212, v213
  v_cvt_pk_bf16_f32 v93, v198, v199
  v_cvt_pk_bf16_f32 v95, v214, v215
  v_permlane16_swap_b32 v88, v90
  v_permlane16_swap_b32 v89, v91
  v_permlane16_swap_b32 v92, v94
  v_permlane16_swap_b32 v93, v95
  v_permlane32_swap_b32 v88, v90
  v_permlane32_swap_b32 v89, v91
  v_permlane32_swap_b32 v92, v94
  v_permlane32_swap_b32 v93, v95
  buffer_store_dwordx4 v[88:91], v3, s[4:7], s36 offen offset:2048 sc1
  buffer_store_dwordx4 v[92:95], v3, s[4:7], s36 offen offset:3072 sc1
  v_pk_mul_f32 v[64:65], v[56:57], v[24:25] op_sel_hi:[1,0]
  v_pk_fma_f32 v[200:201], v[200:201], v[40:41], v[64:65]
  v_pk_mul_f32 v[66:67], v[58:59], v[24:25] op_sel_hi:[1,0]
  v_pk_fma_f32 v[202:203], v[202:203], v[42:43], v[66:67]
  v_pk_mul_f32 v[68:69], v[56:57], v[26:27] op_sel_hi:[1,0]
  v_pk_fma_f32 v[216:217], v[216:217], v[40:41], v[68:69]
  v_pk_mul_f32 v[70:71], v[58:59], v[26:27] op_sel_hi:[1,0]
  v_pk_fma_f32 v[218:219], v[218:219], v[42:43], v[70:71]
  v_cvt_pk_bf16_f32 v104, v200, v201
  v_cvt_pk_bf16_f32 v106, v216, v217
  v_cvt_pk_bf16_f32 v105, v202, v203
  v_cvt_pk_bf16_f32 v107, v218, v219
  v_pk_mul_f32 v[64:65], v[60:61], v[24:25] op_sel_hi:[1,0]
  v_pk_fma_f32 v[204:205], v[204:205], v[44:45], v[64:65]
  v_pk_mul_f32 v[66:67], v[62:63], v[24:25] op_sel_hi:[1,0]
  v_pk_fma_f32 v[206:207], v[206:207], v[46:47], v[66:67]
  v_pk_mul_f32 v[68:69], v[60:61], v[26:27] op_sel_hi:[1,0]
  v_pk_fma_f32 v[220:221], v[220:221], v[44:45], v[68:69]
  v_pk_mul_f32 v[70:71], v[62:63], v[26:27] op_sel_hi:[1,0]
  v_pk_fma_f32 v[222:223], v[222:223], v[46:47], v[70:71]
  v_cvt_pk_bf16_f32 v108, v204, v205
  v_cvt_pk_bf16_f32 v110, v220, v221
  v_cvt_pk_bf16_f32 v109, v206, v207
  v_cvt_pk_bf16_f32 v111, v222, v223
  v_permlane16_swap_b32 v104, v106
  v_permlane16_swap_b32 v105, v107
  v_permlane16_swap_b32 v108, v110
  v_permlane16_swap_b32 v109, v111
  v_permlane32_swap_b32 v104, v106
  v_permlane32_swap_b32 v105, v107
  v_permlane32_swap_b32 v108, v110
  v_permlane32_swap_b32 v109, v111
  buffer_store_dwordx4 v[104:107], v3, s[4:7], s37 offen offset:2048 sc1
  buffer_store_dwordx4 v[108:111], v3, s[4:7], s37 offen offset:3072 sc1
  v_mul_f32 v224, 0.25503486164919736, v224
  v_mul_f32 v225, 0.25503486164919736, v225
  v_mul_f32 v226, 0.25503486164919736, v226
  v_mul_f32 v227, 0.25503486164919736, v227
  v_mul_f32 v228, 0.25503486164919736, v228
  v_mul_f32 v229, 0.25503486164919736, v229
  v_mul_f32 v230, 0.25503486164919736, v230
  v_mul_f32 v231, 0.25503486164919736, v231
  v_pk_mul_f32 v[64:65], v[112:113], v[224:225] op_sel:[0,1] op_sel_hi:[1,1]
  v_pk_fma_f32 v[128:129], v[128:129], v[224:225], v[64:65] op_sel_hi:[1,0,1]
  v_pk_mul_f32 v[66:67], v[114:115], v[224:225] op_sel:[0,1] op_sel_hi:[1,1]
  v_pk_fma_f32 v[130:131], v[130:131], v[224:225], v[66:67] op_sel_hi:[1,0,1]
  v_pk_mul_f32 v[68:69], v[116:117], v[224:225] op_sel:[0,1] op_sel_hi:[1,1]
  v_pk_fma_f32 v[144:145], v[144:145], v[224:225], v[68:69] op_sel_hi:[1,0,1]
  v_pk_mul_f32 v[70:71], v[118:119], v[224:225] op_sel:[0,1] op_sel_hi:[1,1]
  v_pk_fma_f32 v[146:147], v[146:147], v[224:225], v[70:71] op_sel_hi:[1,0,1]
  v_cvt_pk_bf16_f32 v16, v128, v129
  v_cvt_pk_bf16_f32 v17, v130, v131
  v_cvt_pk_bf16_f32 v18, v144, v145
  v_cvt_pk_bf16_f32 v19, v146, v147
  v_pk_mul_f32 v[64:65], v[112:113], v[226:227] op_sel:[0,1] op_sel_hi:[1,1]
  v_pk_fma_f32 v[132:133], v[132:133], v[226:227], v[64:65] op_sel_hi:[1,0,1]
  v_pk_mul_f32 v[66:67], v[114:115], v[226:227] op_sel:[0,1] op_sel_hi:[1,1]
  v_pk_fma_f32 v[134:135], v[134:135], v[226:227], v[66:67] op_sel_hi:[1,0,1]
  v_pk_mul_f32 v[68:69], v[116:117], v[226:227] op_sel:[0,1] op_sel_hi:[1,1]
  v_pk_fma_f32 v[148:149], v[148:149], v[226:227], v[68:69] op_sel_hi:[1,0,1]
  v_pk_mul_f32 v[70:71], v[118:119], v[226:227] op_sel:[0,1] op_sel_hi:[1,1]
  v_pk_fma_f32 v[150:151], v[150:151], v[226:227], v[70:71] op_sel_hi:[1,0,1]
  v_cvt_pk_bf16_f32 v20, v132, v133
  v_cvt_pk_bf16_f32 v21, v134, v135
  v_cvt_pk_bf16_f32 v22, v148, v149
  v_cvt_pk_bf16_f32 v23, v150, v151
  v_permlane16_swap_b32 v16, v20
  v_permlane16_swap_b32 v17, v21
  v_permlane16_swap_b32 v18, v22
  v_permlane16_swap_b32 v19, v23
  ds_write_b128 v8, v[16:19] offset:0
  ds_write_b128 v8, v[20:23] offset:1024
  v_pk_mul_f32 v[64:65], v[112:113], v[228:229] op_sel:[0,1] op_sel_hi:[1,1]
  v_pk_fma_f32 v[136:137], v[136:137], v[228:229], v[64:65] op_sel_hi:[1,0,1]
  v_pk_mul_f32 v[66:67], v[114:115], v[228:229] op_sel:[0,1] op_sel_hi:[1,1]
  v_pk_fma_f32 v[138:139], v[138:139], v[228:229], v[66:67] op_sel_hi:[1,0,1]
  v_pk_mul_f32 v[68:69], v[116:117], v[228:229] op_sel:[0,1] op_sel_hi:[1,1]
  v_pk_fma_f32 v[152:153], v[152:153], v[228:229], v[68:69] op_sel_hi:[1,0,1]
  v_pk_mul_f32 v[70:71], v[118:119], v[228:229] op_sel:[0,1] op_sel_hi:[1,1]
  v_pk_fma_f32 v[154:155], v[154:155], v[228:229], v[70:71] op_sel_hi:[1,0,1]
  v_cvt_pk_bf16_f32 v24, v136, v137
  v_cvt_pk_bf16_f32 v25, v138, v139
  v_cvt_pk_bf16_f32 v26, v152, v153
  v_cvt_pk_bf16_f32 v27, v154, v155
  v_pk_mul_f32 v[64:65], v[112:113], v[230:231] op_sel:[0,1] op_sel_hi:[1,1]
  v_pk_fma_f32 v[140:141], v[140:141], v[230:231], v[64:65] op_sel_hi:[1,0,1]
  v_pk_mul_f32 v[66:67], v[114:115], v[230:231] op_sel:[0,1] op_sel_hi:[1,1]
  v_pk_fma_f32 v[142:143], v[142:143], v[230:231], v[66:67] op_sel_hi:[1,0,1]
  v_pk_mul_f32 v[68:69], v[116:117], v[230:231] op_sel:[0,1] op_sel_hi:[1,1]
  v_pk_fma_f32 v[156:157], v[156:157], v[230:231], v[68:69] op_sel_hi:[1,0,1]
  v_pk_mul_f32 v[70:71], v[118:119], v[230:231] op_sel:[0,1] op_sel_hi:[1,1]
  v_pk_fma_f32 v[158:159], v[158:159], v[230:231], v[70:71] op_sel_hi:[1,0,1]
  v_cvt_pk_bf16_f32 v28, v140, v141
  v_cvt_pk_bf16_f32 v29, v142, v143
  v_cvt_pk_bf16_f32 v30, v156, v157
  v_cvt_pk_bf16_f32 v31, v158, v159
  v_permlane16_swap_b32 v24, v28
  v_permlane16_swap_b32 v25, v29
  v_permlane16_swap_b32 v26, v30
  v_permlane16_swap_b32 v27, v31
  ds_write_b128 v8, v[24:27] offset:2048
  ds_write_b128 v8, v[28:31] offset:3072
  s_branch .fz_kernel_att
.fz_kernel_q_help1:
  s_waitcnt lgkmcnt(0)
  s_mov_b32 s3, 32
  s_cmp_eq_u32 s16, 7
  s_cbranch_scc1 .fz_kernel_q_h7
  s_getpc_b64 s[0:1]
.fz_kernel_ct4:
  s_sub_u32 s0, s0, .fz_kernel_ct4-fz_kernel
  s_subb_u32 s1, s1, 0
  s_lshr_b32 s31, s2, 3
  s_mulk_i32 s31, 0x500
  v_lshl_add_u32 v1, v2, 7, s31
  v_min_u32 v1, .fz_kernel_last-fz_kernel, v1
  s_mov_b64 exec, 0x3ff
  global_load_dword v1, v1, s[0:1]
  s_mov_b64 exec, -1
.fz_kernel_ct4e:
  s_mov_b32 s12, s58
  s_mov_b32 s13, s59
  s_mov_b32 s14, 0x100
  s_mov_b32 s15, 0x00020000
  s_mov_b32 s30, 0
  s_and_b32 s31, s18, 3
  s_sub_u32 s31, s31, s30
  s_and_b32 s30, s31, 3
  s_lshl_b32 s30, s30, 14
  v_and_b32 v20, 15, v2
  v_lshrrev_b32 v21, 4, v2
  v_bfe_u32 v22, v2, 1, 3
  v_xor_b32 v22, v22, v21
  v_lshlrev_b32 v21, 7, v20
  v_lshl_add_u32 v21, v22, 4, v21
  v_add_u32 v21, s30, v21
  v_xor_b32 v22, 64, v21
  v_lshlrev_b32 v20, 3, v20
  s_lshl_b32 s30, s17, 10
  s_add_u32 s30, s30, 0x1808000
  s_mov_b32 exec_lo, 0x00f0000f
  s_mov_b32 exec_hi, 0xf0000f00
  v_add_u32 v20, 4, v20
  s_mov_b64 exec, -1
  v_mov_b32 v24, 0x3f803f80
  v_mov_b32 v25, v24
  v_mov_b32 v26, v24
  v_mov_b32 v27, v24
  s_lshl_b32 s31, s31, 1
  s_sub_u32 s31, 31, s31
  v_lshlrev_b32 v52, 3, v2
  v_add_u32 v52, 155648, v52
  v_mov_b32 v54, 1.0
  v_mov_b32 v55, 1.0
  v_mov_b32 v56, 0
  v_mov_b32 v57, 0
  ds_write_b64 v52, v[54:55] offset:6400
  ds_write_b64 v52, v[56:57] offset:6912
  s_mov_b32 s20, s48
  s_mov_b32 s21, s49
  s_mov_b32 s22, 0x800
  s_mov_b32 s23, 0x00020000
  v_lshlrev_b32 v40, 5, v2
  buffer_load_dwordx4 v[44:47], v40, s[20:23], 0 offen
  buffer_load_dwordx4 v[48:51], v40, s[20:23], 0 offen offset:16
  v_mov_b32 v40, 0
  s_waitcnt vmcnt(0)
  v_lshlrev_b32 v41, 16, v44
  v_and_b32 v42, 0xffff0000, v44
  v_add_f32 v40, v40, v41
  v_add_f32 v40, v40, v42
  v_lshlrev_b32 v41, 16, v45
  v_and_b32 v42, 0xffff0000, v45
  v_add_f32 v40, v40, v41
  v_add_f32 v40, v40, v42
  v_lshlrev_b32 v41, 16, v46
  v_and_b32 v42, 0xffff0000, v46
  v_add_f32 v40, v40, v41
  v_add_f32 v40, v40, v42
  v_lshlrev_b32 v41, 16, v47
  v_and_b32 v42, 0xffff0000, v47
  v_add_f32 v40, v40, v41
  v_add_f32 v40, v40, v42
  v_lshlrev_b32 v41, 16, v48
  v_and_b32 v42, 0xffff0000, v48
  v_add_f32 v40, v40, v41
  v_add_f32 v40, v40, v42
  v_lshlrev_b32 v41, 16, v49
  v_and_b32 v42, 0xffff0000, v49
  v_add_f32 v40, v40, v41
  v_add_f32 v40, v40, v42
  v_lshlrev_b32 v41, 16, v50
  v_and_b32 v42, 0xffff0000, v50
  v_add_f32 v40, v40, v41
  v_add_f32 v40, v40, v42
  v_lshlrev_b32 v41, 16, v51
  v_and_b32 v42, 0xffff0000, v51
  v_add_f32 v40, v40, v41
  v_add_f32 v40, v40, v42
  s_nop 1
  v_add_f32 v40, v40, v40 quad_perm:[1,0,3,2] row_mask:0xf bank_mask:0xf
  s_nop 1
  v_add_f32 v40, v40, v40 quad_perm:[2,3,0,1] row_mask:0xf bank_mask:0xf
  s_nop 1
  v_add_f32 v40, v40, v40 row_half_mirror row_mask:0xf bank_mask:0xf
  s_nop 1
  v_add_f32 v40, v40, v40 row_mirror row_mask:0xf bank_mask:0xf
  s_nop 0
  v_readlane_b32 s20, v40, 16
  v_readlane_b32 s21, v40, 32
  v_readlane_b32 s22, v40, 48
  v_add_f32 v40, s20, v40
  v_add_f32 v40, s21, v40
  v_add_f32 v40, s22, v40
  v_mul_f32 v40, 0x3a800000, v40
  s_nop 0
  v_readfirstlane_b32 s76, v40
.fz_kernel_xs5:
  s_barrier
  s_sub_u32 s3, s3, 1
  s_cmp_lg_u32 s3, s31
  s_cbranch_scc1 .fz_kernel_xs5
  ds_read_b128 v[64:67], v21 offset:0
  ds_read_b128 v[72:75], v21 offset:2048
  ds_read_b128 v[80:83], v21 offset:4096
  ds_read_b128 v[88:91], v21 offset:6144
  ds_read_b128 v[96:99], v21 offset:8192
  ds_read_b128 v[104:107], v21 offset:10240
  ds_read_b128 v[112:115], v21 offset:12288
  ds_read_b128 v[120:123], v21 offset:14336
  ds_read_b128 v[68:71], v22 offset:0
  ds_read_b128 v[76:79], v22 offset:2048
  ds_read_b128 v[84:87], v22 offset:4096
  ds_read_b128 v[92:95], v22 offset:6144
  ds_read_b128 v[100:103], v22 offset:8192
  ds_read_b128 v[108:111], v22 offset:10240
  ds_read_b128 v[116:119], v22 offset:12288
  ds_read_b128 v[124:127], v22 offset:14336
  s_waitcnt lgkmcnt(0)
  s_cmp_eq_u32 s3, 0
  s_cbranch_scc1 .fz_kernel_hb6
  s_barrier
  s_sub_u32 s3, s3, 1
.fz_kernel_hb6:
  s_setprio 2
  v_mfma_f32_16x16x32_bf16 v[128:131], v[24:27], v[64:67], 0
  v_mfma_f32_16x16x32_bf16 v[160:163], v[64:67], v[64:67], 0
  v_mfma_f32_16x16x32_bf16 v[132:135], v[24:27], v[72:75], 0
  v_mfma_f32_16x16x32_bf16 v[164:167], v[72:75], v[72:75], 0
  v_mfma_f32_16x16x32_bf16 v[136:139], v[24:27], v[80:83], 0
  v_mfma_f32_16x16x32_bf16 v[168:171], v[80:83], v[80:83], 0
  v_mfma_f32_16x16x32_bf16 v[140:143], v[24:27], v[88:91], 0
  v_mfma_f32_16x16x32_bf16 v[172:175], v[88:91], v[88:91], 0
  v_mfma_f32_16x16x32_bf16 v[144:147], v[24:27], v[96:99], 0
  v_mfma_f32_16x16x32_bf16 v[176:179], v[96:99], v[96:99], 0
  v_mfma_f32_16x16x32_bf16 v[148:151], v[24:27], v[104:107], 0
  v_mfma_f32_16x16x32_bf16 v[180:183], v[104:107], v[104:107], 0
  v_mfma_f32_16x16x32_bf16 v[152:155], v[24:27], v[112:115], 0
  v_mfma_f32_16x16x32_bf16 v[184:187], v[112:115], v[112:115], 0
  v_mfma_f32_16x16x32_bf16 v[156:159], v[24:27], v[120:123], 0
  v_mfma_f32_16x16x32_bf16 v[188:191], v[120:123], v[120:123], 0
  v_mfma_f32_16x16x32_bf16 v[128:131], v[24:27], v[68:71], v[128:131]
  v_mfma_f32_16x16x32_bf16 v[160:163], v[68:71], v[68:71], v[160:163]
  v_mfma_f32_16x16x32_bf16 v[132:135], v[24:27], v[76:79], v[132:135]
  v_mfma_f32_16x16x32_bf16 v[164:167], v[76:79], v[76:79], v[164:167]
  v_mfma_f32_16x16x32_bf16 v[136:139], v[24:27], v[84:87], v[136:139]
  v_mfma_f32_16x16x32_bf16 v[168:171], v[84:87], v[84:87], v[168:171]
  v_mfma_f32_16x16x32_bf16 v[140:143], v[24:27], v[92:95], v[140:143]
  v_mfma_f32_16x16x32_bf16 v[172:175], v[92:95], v[92:95], v[172:175]
  v_mfma_f32_16x16x32_bf16 v[144:147], v[24:27], v[100:103], v[144:147]
  v_mfma_f32_16x16x32_bf16 v[176:179], v[100:103], v[100:103], v[176:179]
  v_mfma_f32_16x16x32_bf16 v[148:151], v[24:27], v[108:111], v[148:151]
  v_mfma_f32_16x16x32_bf16 v[180:183], v[108:111], v[108:111], v[180:183]
  v_mfma_f32_16x16x32_bf16 v[152:155], v[24:27], v[116:119], v[152:155]
  v_mfma_f32_16x16x32_bf16 v[184:187], v[116:119], v[116:119], v[184:187]
  v_mfma_f32_16x16x32_bf16 v[156:159], v[24:27], v[124:127], v[156:159]
  v_mfma_f32_16x16x32_bf16 v[188:191], v[124:127], v[124:127], v[188:191]
  s_setprio 0
  s_cmp_eq_u32 s3, 0
  s_cbranch_scc1 .fz_kernel_hb7
  s_barrier
  s_sub_u32 s3, s3, 1
.fz_kernel_hb7:
  s_mov_b32 exec_lo, 0x100001
  s_mov_b32 exec_hi, 0x10000100
  buffer_load_dword v9, v4, s[12:15], 0 offen sc1
  v_mov_b32 v128, v160
  v_mov_b32 v132, v164
  v_mov_b32 v136, v168
  v_mov_b32 v140, v172
  v_mov_b32 v144, v176
  v_mov_b32 v148, v180
  v_mov_b32 v152, v184
  v_mov_b32 v156, v188
  s_mov_b32 exec_lo, 0x200002
  s_mov_b32 exec_hi, 0x20000200
  v_mov_b32 v128, v161
  v_mov_b32 v132, v165
  v_mov_b32 v136, v169
  v_mov_b32 v140, v173
  v_mov_b32 v144, v177
  v_mov_b32 v148, v181
  v_mov_b32 v152, v185
  v_mov_b32 v156, v189
  s_mov_b32 exec_lo, 0x400004
  s_mov_b32 exec_hi, 0x40000400
  v_mov_b32 v128, v162
  v_mov_b32 v132, v166
  v_mov_b32 v136, v170
  v_mov_b32 v140, v174
  v_mov_b32 v144, v178
  v_mov_b32 v148, v182
  v_mov_b32 v152, v186
  v_mov_b32 v156, v190
  s_cmp_eq_u32 s3, 0
  s_cbranch_scc1 .fz_kernel_hb8
  s_barrier
  s_sub_u32 s3, s3, 1
.fz_kernel_hb8:
  s_mov_b32 exec_lo, 0x800008
  s_mov_b32 exec_hi, 0x80000800
  v_mov_b32 v128, v163
  v_mov_b32 v132, v167
  v_mov_b32 v136, v171
  v_mov_b32 v140, v175
  v_mov_b32 v144, v179
  v_mov_b32 v148, v183
  v_mov_b32 v152, v187
  v_mov_b32 v156, v191
  s_mov_b64 exec, 1
  s_mov_b32 s38, 0
.fz_kernel_pw9:
  s_mov_b32 s46, 0
  s_call_b64 s[0:1], .fz_kernel_hw
  s_waitcnt vmcnt(0)
  v_readfirstlane_b32 s31, v9
  s_cmp_eq_u32 s31, 64
  s_cbranch_scc1 .fz_kernel_pw9d
  s_cmp_eq_u32 s3, 0
  s_cbranch_scc1 .fz_kernel_hb10
  s_barrier
  s_sub_u32 s3, s3, 1
.fz_kernel_hb10:
  s_cmp_eq_u32 s3, 0
  s_cbranch_scc1 .fz_kernel_hb11
  s_barrier
  s_sub_u32 s3, s3, 1
.fz_kernel_hb11:
  buffer_load_dword v9, v4, s[12:15], 0 offen sc1
  s_add_u32 s38, s38, 1
  s_cmp_lt_u32 s38, 131072
  s_cbranch_scc1 .fz_kernel_pw9
  s_waitcnt vmcnt(0)
.fz_kernel_pw9d:
  s_mov_b64 exec, -1
  s_cmp_eq_u32 s3, 0
  s_cbranch_scc1 .fz_kernel_hb12
  s_barrier
  s_sub_u32 s3, s3, 1
.fz_kernel_hb12:
  s_mov_b32 exec_lo, 0x00fff00f
  s_mov_b32 exec_hi, 0xff000ff0
  buffer_atomic_add_f32 v128, v20, s[4:7], s30 offen offset:0 sc1
  buffer_atomic_add_f32 v132, v20, s[4:7], s30 offen offset:128 sc1
  buffer_atomic_add_f32 v136, v20, s[4:7], s30 offen offset:256 sc1
  buffer_atomic_add_f32 v140, v20, s[4:7], s30 offen offset:384 sc1
  buffer_atomic_add_f32 v144, v20, s[4:7], s30 offen offset:512 sc1
  buffer_atomic_add_f32 v148, v20, s[4:7], s30 offen offset:640 sc1
  buffer_atomic_add_f32 v152, v20, s[4:7], s30 offen offset:768 sc1
  buffer_atomic_add_f32 v156, v20, s[4:7], s30 offen offset:896 sc1
  s_mov_b64 exec, -1
  s_mov_b32 s46, 0
  s_call_b64 s[0:1], .fz_kernel_hw
  s_waitcnt vmcnt(0)
  v_lshlrev_b32 v7, 11, v2
  s_lshl_b32 s31, s17, 7
  s_lshl_b32 s33, 1, s18
  s_add_u32 s31, s31, s67
  s_add_u32 s31, s31, 0x1800018
  v_mov_b32 v8, s33
  s_mov_b64 exec, 0xffff
  buffer_atomic_or v8, v7, s[4:7], s31 offen sc1
  s_mov_b64 exec, -1
  s_add_u32 s37, s19, 24
.fz_kernel_f113:
  s_cmp_le_u32 s3, 9
  s_cbranch_scc1 .fz_kernel_f113d
  s_barrier
  s_sub_u32 s3, s3, 1
  s_branch .fz_kernel_f113
.fz_kernel_f113d:
  s_mov_b64 exec, 1
  buffer_load_dword v9, v4, s[4:7], s37 offen sc1
  s_mov_b64 exec, 1
  s_mov_b32 s38, 0
.fz_kernel_pw14:
  s_mov_b32 s46, 0
  s_call_b64 s[0:1], .fz_kernel_hw
  s_waitcnt vmcnt(0)
  v_readfirstlane_b32 s31, v9
  s_cmp_eq_u32 s31, 65535
  s_cbranch_scc1 .fz_kernel_pw14d
  s_cmp_eq_u32 s3, 0
  s_cbranch_scc1 .fz_kernel_hb15
  s_barrier
  s_sub_u32 s3, s3, 1
.fz_kernel_hb15:
  s_cmp_eq_u32 s3, 0
  s_cbranch_scc1 .fz_kernel_hb16
  s_barrier
  s_sub_u32 s3, s3, 1
.fz_kernel_hb16:
  buffer_load_dword v9, v4, s[4:7], s37 offen sc1
  s_add_u32 s38, s38, 1
  s_cmp_lt_u32 s38, 131072
  s_cbranch_scc1 .fz_kernel_pw14
  s_waitcnt vmcnt(0)
.fz_kernel_pw14d:
  s_mov_b64 exec, -1
  buffer_load_dwordx4 v[64:67], v3, s[4:7], s30 offen sc1
  s_mov_b32 s46, 0
  s_call_b64 s[0:1], .fz_kernel_hw
  s_waitcnt vmcnt(0)
  s_cmp_eq_u32 s3, 0
  s_cbranch_scc1 .fz_kernel_hb17
  s_barrier
  s_sub_u32 s3, s3, 1
.fz_kernel_hb17:
  v_mov_b32 v26, 0.0009765625
  v_mul_f32 v20, v26, v64
  v_mul_f32 v27, v20, v20
  v_fma_f32 v22, v65, v26, -v27
  v_max_f32 v22, 0, v22
  v_add_f32 v22, 1e-05, v22
  v_rsq_f32 v22, v22
  s_nop 0
  v_mul_f32 v20, v20, v22
  v_sub_f32 v20, 0, v20
  v_mul_f32 v21, v26, v66
  v_mul_f32 v27, v21, v21
  v_fma_f32 v23, v67, v26, -v27
  v_max_f32 v23, 0, v23
  v_add_f32 v23, 1e-05, v23
  v_rsq_f32 v23, v23
  s_nop 0
  v_mul_f32 v21, v21, v23
  v_sub_f32 v21, 0, v21
  ds_write_b64 v52, v[22:23] offset:4608
  ds_write_b64 v52, v[20:21] offset:5120
  v_mov_b32 v24, 159952
  v_mov_b32 v25, s76
  ds_write_b32 v24, v25 offset:8
  s_waitcnt lgkmcnt(0)
.fz_kernel_q_hw2:
  s_add_u32 s3, s3, 2
.fz_kernel_q_he:
  s_cmp_eq_u32 s3, 0
  s_cbranch_scc1 .fz_kernel_chain
  s_barrier
  s_sub_u32 s3, s3, 1
  s_branch .fz_kernel_q_he
.fz_kernel_q_h7:
  s_mov_b32 s8, s58
  s_mov_b32 s9, s59
  s_mov_b32 s10, 0x100
  s_mov_b32 s11, 0x00020000
  v_mov_b32 v12, 0
  v_mov_b32 v13, 0
  v_mov_b32 v14, 0
  v_mov_b32 v15, 0
  s_cmp_ge_u32 s2, 64
  s_cbranch_scc1 .fz_kernel_q_nzero
  s_lshl_b32 s36, s2, 10
  s_add_u32 s36, s36, 0x1800000
  buffer_store_dwordx4 v[12:15], v3, s[4:7], s36 offen sc1
.fz_kernel_q_nzero:
  v_and_b32 v21, 7, v2
  v_and_b32 v20, 16, v2
  v_lshlrev_b32 v20, 1, v20
  v_xor_b32 v20, v20, v3
  s_bfe_u32 s33, s17, 0x10002
  s_lshl_b32 s33, s33, 1
  s_and_b32 s31, s33, 3
  s_mul_i32 s31, s31, 12288
  s_add_u32 s31, s31, 65536
  v_add_u32 v16, s31, v20
  v_xor_b32 v17, 64, v16
  s_add_u32 s31, s31, 12288
  v_add_u32 v18, s31, v20
  v_xor_b32 v19, 64, v18
  s_sub_u32 s33, 31, s33
  v_lshlrev_b32 v21, 5, v21
  v_and_b32 v22, 24, v2
  v_add_u32 v21, v22, v21
  v_lshrrev_b32 v22, 5, v2
  v_lshl_add_u32 v21, v22, 2, v21
  s_lshl_b32 s30, s18, 10
  s_add_u32 s30, s30, 0x180c000
  v_and_b32 v22, 1, v2
  v_lshlrev_b32 v22, 4, v22
  v_mov_b32 v23, 0x3f80
  v_lshlrev_b32 v22, v22, v23
  v_mov_b32 v24, 0
  v_mov_b32 v25, 0
  v_mov_b32 v26, 0
  v_mov_b32 v27, 0
  s_mov_b32 exec_lo, 0x3030303
  s_mov_b32 exec_hi, 0x3030303
  v_mov_b32 v24, v22
  s_mov_b32 exec_lo, 0xc0c0c0c
  s_mov_b32 exec_hi, 0xc0c0c0c
  v_mov_b32 v25, v22
  s_mov_b32 exec_lo, 0x30303030
  s_mov_b32 exec_hi, 0x30303030
  v_mov_b32 v26, v22
  s_mov_b32 exec_lo, 0xc0c0c0c0
  s_mov_b32 exec_hi, 0xc0c0c0c0
  v_mov_b32 v27, v22
  s_mov_b64 exec, -1
  s_cmp_ge_u32 s2, 64
  s_cbranch_scc1 .fz_kernel_nz2
  s_mov_b64 exec, 1
  s_waitcnt vmcnt(0)
  buffer_atomic_add v5, v4, s[8:11], 0 offen sc1
  s_mov_b64 exec, -1
.fz_kernel_nz2:
  s_barrier
  s_sub_u32 s3, s3, 1
  s_cmp_lg_u32 s3, s33
  s_cbranch_scc1 .fz_kernel_nz2
  ds_read_b128 v[64:67], v16 offset:0
  ds_read_b128 v[68:71], v16 offset:4096
  ds_read_b128 v[72:75], v16 offset:8192
  ds_read_b128 v[76:79], v17 offset:1024
  ds_read_b128 v[80:83], v17 offset:5120
  ds_read_b128 v[84:87], v17 offset:9216
  ds_read_b128 v[88:91], v16 offset:2048
  ds_read_b128 v[92:95], v16 offset:6144
  ds_read_b128 v[96:99], v16 offset:10240
  ds_read_b128 v[100:103], v17 offset:3072
  ds_read_b128 v[104:107], v17 offset:7168
  ds_read_b128 v[108:111], v17 offset:11264
  s_waitcnt lgkmcnt(0)
  s_cmp_eq_u32 s3, 0
  s_cbranch_scc1 .fz_kernel_hb18
  s_barrier
  s_sub_u32 s3, s3, 1
.fz_kernel_hb18:
  ds_read_b128 v[112:115], v18 offset:0
  ds_read_b128 v[116:119], v18 offset:4096
  ds_read_b128 v[120:123], v18 offset:8192
  ds_read_b128 v[124:127], v19 offset:1024
  ds_read_b128 v[128:131], v19 offset:5120
  ds_read_b128 v[132:135], v19 offset:9216
  ds_read_b128 v[136:139], v18 offset:2048
  ds_read_b128 v[140:143], v18 offset:6144
  ds_read_b128 v[144:147], v18 offset:10240
  ds_read_b128 v[148:151], v19 offset:3072
  ds_read_b128 v[152:155], v19 offset:7168
  ds_read_b128 v[156:159], v19 offset:11264
  s_waitcnt lgkmcnt(0)
  s_cmp_eq_u32 s3, 0
  s_cbranch_scc1 .fz_kernel_hb19
  s_barrier
  s_sub_u32 s3, s3, 1
.fz_kernel_hb19:
  s_setprio 2
  v_mfma_f32_16x16x32_bf16 v[160:163], v[24:27], v[64:67], 0
  v_mfma_f32_16x16x32_bf16 v[164:167], v[24:27], v[68:71], 0
  v_mfma_f32_16x16x32_bf16 v[168:171], v[24:27], v[72:75], 0
  v_mfma_f32_16x16x32_bf16 v[160:163], v[24:27], v[76:79], v[160:163]
  v_mfma_f32_16x16x32_bf16 v[164:167], v[24:27], v[80:83], v[164:167]
  v_mfma_f32_16x16x32_bf16 v[168:171], v[24:27], v[84:87], v[168:171]
  v_mfma_f32_16x16x32_bf16 v[160:163], v[24:27], v[88:91], v[160:163]
  v_mfma_f32_16x16x32_bf16 v[164:167], v[24:27], v[92:95], v[164:167]
  v_mfma_f32_16x16x32_bf16 v[168:171], v[24:27], v[96:99], v[168:171]
  v_mfma_f32_16x16x32_bf16 v[160:163], v[24:27], v[100:103], v[160:163]
  v_mfma_f32_16x16x32_bf16 v[164:167], v[24:27], v[104:107], v[164:167]
  v_mfma_f32_16x16x32_bf16 v[168:171], v[24:27], v[108:111], v[168:171]
  v_mfma_f32_16x16x32_bf16 v[160:163], v[24:27], v[112:115], v[160:163]
  v_mfma_f32_16x16x32_bf16 v[164:167], v[24:27], v[116:119], v[164:167]
  v_mfma_f32_16x16x32_bf16 v[168:171], v[24:27], v[120:123], v[168:171]
  v_mfma_f32_16x16x32_bf16 v[160:163], v[24:27], v[124:127], v[160:163]
  v_mfma_f32_16x16x32_bf16 v[164:167], v[24:27], v[128:131], v[164:167]
  v_mfma_f32_16x16x32_bf16 v[168:171], v[24:27], v[132:135], v[168:171]
  v_mfma_f32_16x16x32_bf16 v[160:163], v[24:27], v[136:139], v[160:163]
  v_mfma_f32_16x16x32_bf16 v[164:167], v[24:27], v[140:143], v[164:167]
  v_mfma_f32_16x16x32_bf16 v[168:171], v[24:27], v[144:147], v[168:171]
  v_mfma_f32_16x16x32_bf16 v[160:163], v[24:27], v[148:151], v[160:163]
  v_mfma_f32_16x16x32_bf16 v[164:167], v[24:27], v[152:155], v[164:167]
  v_mfma_f32_16x16x32_bf16 v[168:171], v[24:27], v[156:159], v[168:171]
  s_setprio 0
  s_mov_b64 exec, 1
  buffer_load_dword v9, v4, s[8:11], 0 offen sc1
  s_mov_b64 exec, -1
  s_cmp_eq_u32 s3, 0
  s_cbranch_scc1 .fz_kernel_hb20
  s_barrier
  s_sub_u32 s3, s3, 1
.fz_kernel_hb20:
  v_add_f32 v160, v160, v160 row_ror:8 row_mask:0xf bank_mask:0xf
  v_add_f32 v161, v161, v161 row_ror:8 row_mask:0xf bank_mask:0xf
  v_add_f32 v162, v162, v162 row_ror:8 row_mask:0xf bank_mask:0xf
  v_add_f32 v163, v163, v163 row_ror:8 row_mask:0xf bank_mask:0xf
  v_add_f32 v164, v164, v164 row_ror:8 row_mask:0xf bank_mask:0xf
  v_add_f32 v165, v165, v165 row_ror:8 row_mask:0xf bank_mask:0xf
  v_add_f32 v166, v166, v166 row_ror:8 row_mask:0xf bank_mask:0xf
  v_add_f32 v167, v167, v167 row_ror:8 row_mask:0xf bank_mask:0xf
  v_add_f32 v168, v168, v168 row_ror:8 row_mask:0xf bank_mask:0xf
  v_add_f32 v169, v169, v169 row_ror:8 row_mask:0xf bank_mask:0xf
  v_add_f32 v170, v170, v170 row_ror:8 row_mask:0xf bank_mask:0xf
  v_add_f32 v171, v171, v171 row_ror:8 row_mask:0xf bank_mask:0xf
  s_mov_b32 exec_lo, 0x0
  s_mov_b32 exec_hi, 0xff00ff
  v_mov_b32 v160, v161
  v_mov_b32 v164, v165
  v_mov_b32 v168, v169
  s_mov_b32 exec_lo, 0xff00ff00
  s_mov_b32 exec_hi, 0x0
  v_mov_b32 v160, v162
  v_mov_b32 v164, v166
  v_mov_b32 v168, v170
  s_mov_b32 exec_lo, 0x0
  s_mov_b32 exec_hi, 0xff00ff00
  v_mov_b32 v160, v163
  v_mov_b32 v164, v167
  v_mov_b32 v168, v171
  s_cmp_eq_u32 s3, 0
  s_cbranch_scc1 .fz_kernel_hb21
  s_barrier
  s_sub_u32 s3, s3, 1
.fz_kernel_hb21:
  s_mov_b64 exec, 1
  s_mov_b32 s38, 0
.fz_kernel_pw22:
  s_mov_b32 s46, 0
  s_call_b64 s[0:1], .fz_kernel_hw
  s_waitcnt vmcnt(0)
  v_readfirstlane_b32 s31, v9
  s_cmp_eq_u32 s31, 64
  s_cbranch_scc1 .fz_kernel_pw22d
  s_cmp_eq_u32 s3, 0
  s_cbranch_scc1 .fz_kernel_hb23
  s_barrier
  s_sub_u32 s3, s3, 1
.fz_kernel_hb23:
  s_cmp_eq_u32 s3, 0
  s_cbranch_scc1 .fz_kernel_hb24
  s_barrier
  s_sub_u32 s3, s3, 1
.fz_kernel_hb24:
  buffer_load_dword v9, v4, s[8:11], 0 offen sc1
  s_add_u32 s38, s38, 1
  s_cmp_lt_u32 s38, 131072
  s_cbranch_scc1 .fz_kernel_pw22
  s_waitcnt vmcnt(0)
.fz_kernel_pw22d:
  s_mov_b64 exec, -1
  buffer_atomic_add_f32 v160, v21, s[4:7], s30 offen offset:0 sc1
  buffer_atomic_add_f32 v164, v21, s[4:7], s30 offen offset:256 sc1
  buffer_atomic_add_f32 v168, v21, s[4:7], s30 offen offset:512 sc1
  s_mov_b32 s46, 0
  s_call_b64 s[0:1], .fz_kernel_hw
  s_waitcnt vmcnt(0)
  v_lshlrev_b32 v7, 7, v2
  s_lshl_b32 s31, s18, 11
  s_lshl_b32 s33, 1, s17
  s_add_u32 s31, s31, s67
  s_add_u32 s31, s31, 0x180001c
  v_mov_b32 v8, s33
  s_mov_b64 exec, 0xffff
  buffer_atomic_or v8, v7, s[4:7], s31 offen sc1
  s_mov_b64 exec, -1
  s_cmp_eq_u32 s3, 0
  s_cbranch_scc1 .fz_kernel_hb25
  s_barrier
  s_sub_u32 s3, s3, 1
.fz_kernel_hb25:
  s_cmp_ge_u32 s2, 196
  s_cbranch_scc1 .fz_kernel_lz26
  s_lshl_b32 s36, s2, 12
  s_add_u32 s36, s36, 0x1c00000
  s_sub_u32 s31, s2, 66
  s_min_u32 s31, s31, s2
  s_sub_u32 s31, s31, 4
  s_cmp_lt_u32 s31, 6
  s_cbranch_scc1 .fz_kernel_lz26a
  buffer_store_dwordx4 v[12:15], v3, s[4:7], s36 offen sc1
  buffer_store_dwordx4 v[12:15], v3, s[4:7], s36 offen offset:1024 sc1
  buffer_store_dwordx4 v[12:15], v3, s[4:7], s36 offen offset:2048 sc1
  buffer_store_dwordx4 v[12:15], v3, s[4:7], s36 offen offset:3072 sc1
.fz_kernel_lz26:
  s_add_u32 s37, s19, 28
.fz_kernel_f127:
  s_cmp_le_u32 s3, 9
  s_cbranch_scc1 .fz_kernel_f127d
  s_barrier
  s_sub_u32 s3, s3, 1
  s_branch .fz_kernel_f127
.fz_kernel_f127d:
  s_mov_b64 exec, 1
  buffer_load_dword v9, v4, s[4:7], s37 offen sc1
  s_mov_b64 exec, 1
  s_mov_b32 s38, 0
.fz_kernel_pw28:
  s_mov_b32 s46, 0
  s_call_b64 s[0:1], .fz_kernel_hw
  s_waitcnt vmcnt(0)
  v_readfirstlane_b32 s31, v9
  s_cmp_eq_u32 s31, 65535
  s_cbranch_scc1 .fz_kernel_pw28d
  s_cmp_eq_u32 s3, 0
  s_cbranch_scc1 .fz_kernel_hb29
  s_barrier
  s_sub_u32 s3, s3, 1
.fz_kernel_hb29:
  s_cmp_eq_u32 s3, 0
  s_cbranch_scc1 .fz_kernel_hb30
  s_barrier
  s_sub_u32 s3, s3, 1
.fz_kernel_hb30:
  buffer_load_dword v9, v4, s[4:7], s37 offen sc1
  s_add_u32 s38, s38, 1
  s_cmp_lt_u32 s38, 131072
  s_cbranch_scc1 .fz_kernel_pw28
  s_waitcnt vmcnt(0)
.fz_kernel_pw28d:
  s_mov_b64 exec, -1
  buffer_load_dwordx4 v[64:67], v3, s[4:7], s30 offen sc1
  s_mov_b32 s46, 0
  s_call_b64 s[0:1], .fz_kernel_hw
  s_waitcnt vmcnt(0)
  v_add_u32 v24, 155648, v3
  s_mov_b32 exec_hi, 0xffff
  ds_write_b128 v24, v[64:67] offset:5632
  s_mov_b64 exec, -1
  s_waitcnt lgkmcnt(0)
  s_cmp_eq_u32 s3, 0
  s_cbranch_scc1 .fz_kernel_hb31
  s_barrier
  s_sub_u32 s3, s3, 1
.fz_kernel_hb31:
  s_getpc_b64 s[0:1]
.fz_kernel_ct32:
  s_sub_u32 s0, s0, .fz_kernel_ct32-fz_kernel
  s_subb_u32 s1, s1, 0
  s_lshr_b32 s31, s2, 3
  s_mulk_i32 s31, 0x500
  v_lshl_add_u32 v1, v2, 7, s31
  v_min_u32 v1, .fz_kernel_last-fz_kernel, v1
  s_mov_b64 exec, 0x3ff
  global_load_dword v1, v1, s[0:1]
  s_mov_b64 exec, -1
.fz_kernel_ct32e:
  s_branch .fz_kernel_q_hw2
.fz_kernel_att:
  s_setprio 1
  s_lshl_b32 s34, 1, s17
  s_mov_b32 s36, 0
  v_mfma_f32_32x32x16_bf16 v[48:63], v[80:83], v[16:19], 0
  v_mfma_f32_32x32x16_bf16 v[48:63], v[84:87], v[20:23], v[48:63]
  v_and_b32 v1, 31, v2
  v_lshl_add_u32 v1, v1, 3, s11
  v_mov_b32 v208, 0
  v_mov_b32 v209, 0
  v_mov_b32 v210, 0
  v_mov_b32 v211, 0
  v_mov_b32 v212, 0
  v_mov_b32 v213, 0
  v_mov_b32 v214, 0
  v_mov_b32 v215, 0
  v_mov_b32 v216, 0
  v_mov_b32 v217, 0
  v_mov_b32 v218, 0
  v_mov_b32 v219, 0
  v_mov_b32 v220, 0
  v_mov_b32 v221, 0
  v_mov_b32 v222, 0
  v_mov_b32 v223, 0
  s_waitcnt lgkmcnt(0)
  s_barrier
  ds_read_b128 v[32:35], v9 offset:0
  ds_read_b128 v[36:39], v9 offset:1024
  ds_read_b128 v[40:43], v9 offset:2048
  ds_read_b128 v[44:47], v9 offset:3072
  v_mfma_f32_32x32x16_bf16 v[64:79], v[80:83], v[24:27], 0
  v_exp_f32 v48, v48
  v_exp_f32 v49, v49
  v_exp_f32 v50, v50
  v_exp_f32 v51, v51
  v_exp_f32 v52, v52
  v_exp_f32 v53, v53
  v_exp_f32 v54, v54
  v_exp_f32 v55, v55
  v_mfma_f32_32x32x16_bf16 v[64:79], v[84:87], v[28:31], v[64:79]
  v_cvt_pk_bf16_f32 v224, v48, v49
  v_cvt_pk_bf16_f32 v225, v50, v51
  v_cvt_pk_bf16_f32 v226, v52, v53
  v_cvt_pk_bf16_f32 v227, v54, v55
  v_exp_f32 v56, v56
  v_exp_f32 v57, v57
  v_exp_f32 v58, v58
  v_exp_f32 v59, v59
  v_mfma_f32_32x32x16_bf16 v[144:159], v[88:91], v[224:227], 0
  v_exp_f32 v60, v60
  v_exp_f32 v61, v61
  v_exp_f32 v62, v62
  v_exp_f32 v63, v63
  v_cvt_pk_bf16_f32 v228, v56, v57
  v_cvt_pk_bf16_f32 v229, v58, v59
  v_cvt_pk_bf16_f32 v230, v60, v61
  v_cvt_pk_bf16_f32 v231, v62, v63
  s_waitcnt lgkmcnt(0)
  v_mfma_f32_32x32x16_bf16 v[48:63], v[80:83], v[32:35], 0
  v_exp_f32 v64, v64
  v_exp_f32 v65, v65
  v_exp_f32 v66, v66
  v_exp_f32 v67, v67
  v_mfma_f32_32x32x16_bf16 v[144:159], v[92:95], v[228:231], v[144:159]
  v_exp_f32 v68, v68
  v_exp_f32 v69, v69
  v_exp_f32 v70, v70
  v_smfmac_f32_16x16x64_bf16 v[208:211], v[12:15], v[224:231], v11
  v_exp_f32 v71, v71
  v_mfma_f32_32x32x16_bf16 v[48:63], v[84:87], v[36:39], v[48:63]
  v_cvt_pk_bf16_f32 v224, v64, v65
  v_cvt_pk_bf16_f32 v225, v66, v67
  v_cvt_pk_bf16_f32 v226, v68, v69
  v_cvt_pk_bf16_f32 v227, v70, v71
  v_exp_f32 v72, v72
  v_exp_f32 v73, v73
  v_exp_f32 v74, v74
  v_exp_f32 v75, v75
  v_mfma_f32_32x32x16_bf16 v[160:175], v[88:91], v[224:227], 0
  v_exp_f32 v76, v76
  v_exp_f32 v77, v77
  v_exp_f32 v78, v78
  v_exp_f32 v79, v79
  v_cvt_pk_bf16_f32 v228, v72, v73
  v_cvt_pk_bf16_f32 v229, v74, v75
  v_cvt_pk_bf16_f32 v230, v76, v77
  v_cvt_pk_bf16_f32 v231, v78, v79
  s_mov_b64 exec, 1
  s_waitcnt vmcnt(0)
  ds_add_u32 v6, v5 offset:0x100
  s_mov_b64 exec, -1
  v_mfma_f32_32x32x16_bf16 v[64:79], v[80:83], v[40:43], 0
  v_exp_f32 v48, v48
  v_exp_f32 v49, v49
  v_exp_f32 v50, v50
  v_exp_f32 v51, v51
  v_mfma_f32_32x32x16_bf16 v[160:175], v[92:95], v[228:231], v[160:175]
  v_exp_f32 v52, v52
  v_exp_f32 v53, v53
  v_exp_f32 v54, v54
  v_smfmac_f32_16x16x64_bf16 v[212:215], v[12:15], v[224:231], v11
  v_exp_f32 v55, v55
  v_mfma_f32_32x32x16_bf16 v[64:79], v[84:87], v[44:47], v[64:79]
  v_cvt_pk_bf16_f32 v224, v48, v49
  v_cvt_pk_bf16_f32 v225, v50, v51
  v_cvt_pk_bf16_f32 v226, v52, v53
  v_cvt_pk_bf16_f32 v227, v54, v55
  v_exp_f32 v56, v56
  v_exp_f32 v57, v57
  v_exp_f32 v58, v58
  v_exp_f32 v59, v59
  v_mfma_f32_32x32x16_bf16 v[176:191], v[88:91], v[224:227], 0
  ds_read_b32 v7, v6
  v_exp_f32 v60, v60
  v_exp_f32 v61, v61
  v_exp_f32 v62, v62
  v_exp_f32 v63, v63
  v_cvt_pk_bf16_f32 v228, v56, v57
  v_cvt_pk_bf16_f32 v229, v58, v59
  v_cvt_pk_bf16_f32 v230, v60, v61
  v_cvt_pk_bf16_f32 v231, v62, v63
  s_waitcnt lgkmcnt(0)
  v_readfirstlane_b32 s39, v7
  s_andn2_b32 s33, s39, s34
  s_bcnt1_i32_b32 s31, s33
  s_cmp_ge_u32 s31, 2
  s_cbranch_scc1 .fz_kernel_a_e
  v_mfma_f32_32x32x16_bf16 v[48:63], v[96:99], v[16:19], 0
  v_exp_f32 v64, v64
  v_exp_f32 v65, v65
  v_exp_f32 v66, v66
  v_exp_f32 v67, v67
  v_mfma_f32_32x32x16_bf16 v[176:191], v[92:95], v[228:231], v[176:191]
  v_exp_f32 v68, v68
  v_exp_f32 v69, v69
  v_exp_f32 v70, v70
  v_smfmac_f32_16x16x64_bf16 v[216:219], v[12:15], v[224:231], v11
  v_exp_f32 v71, v71
  v_mfma_f32_32x32x16_bf16 v[48:63], v[100:103], v[20:23], v[48:63]
  v_cvt_pk_bf16_f32 v224, v64, v65
  v_cvt_pk_bf16_f32 v225, v66, v67
  v_cvt_pk_bf16_f32 v226, v68, v69
  v_cvt_pk_bf16_f32 v227, v70, v71
  v_exp_f32 v72, v72
  v_exp_f32 v73, v73
  v_exp_f32 v74, v74
  v_exp_f32 v75, v75
  v_mfma_f32_32x32x16_bf16 v[192:207], v[88:91], v[224:227], 0
  v_exp_f32 v76, v76
  v_exp_f32 v77, v77
  v_exp_f32 v78, v78
  v_exp_f32 v79, v79
  v_cvt_pk_bf16_f32 v228, v72, v73
  v_cvt_pk_bf16_f32 v229, v74, v75
  v_cvt_pk_bf16_f32 v230, v76, v77
  v_cvt_pk_bf16_f32 v231, v78, v79
  v_mfma_f32_32x32x16_bf16 v[64:79], v[96:99], v[24:27], 0
  v_exp_f32 v48, v48
  v_exp_f32 v49, v49
  v_exp_f32 v50, v50
  v_exp_f32 v51, v51
  v_mfma_f32_32x32x16_bf16 v[192:207], v[92:95], v[228:231], v[192:207]
  v_exp_f32 v52, v52
  v_exp_f32 v53, v53
  v_exp_f32 v54, v54
  v_smfmac_f32_16x16x64_bf16 v[220:223], v[12:15], v[224:231], v11
  v_exp_f32 v55, v55
  v_mfma_f32_32x32x16_bf16 v[64:79], v[100:103], v[28:31], v[64:79]
  v_cvt_pk_bf16_f32 v224, v48, v49
  v_cvt_pk_bf16_f32 v225, v50, v51
  v_cvt_pk_bf16_f32 v226, v52, v53
  v_cvt_pk_bf16_f32 v227, v54, v55
  v_exp_f32 v56, v56
  v_exp_f32 v57, v57
  v_exp_f32 v58, v58
  v_exp_f32 v59, v59
  v_mfma_f32_32x32x16_bf16 v[144:159], v[104:107], v[224:227], v[144:159]
  v_exp_f32 v60, v60
  v_exp_f32 v61, v61
  v_exp_f32 v62, v62
  v_exp_f32 v63, v63
  v_cvt_pk_bf16_f32 v228, v56, v57
  v_cvt_pk_bf16_f32 v229, v58, v59
  v_cvt_pk_bf16_f32 v230, v60, v61
  v_cvt_pk_bf16_f32 v231, v62, v63
  v_mfma_f32_32x32x16_bf16 v[48:63], v[96:99], v[32:35], 0
  v_exp_f32 v64, v64
  v_exp_f32 v65, v65
  v_exp_f32 v66, v66
  v_exp_f32 v67, v67
  v_mfma_f32_32x32x16_bf16 v[144:159], v[108:111], v[228:231], v[144:159]
  v_exp_f32 v68, v68
  v_exp_f32 v69, v69
  v_exp_f32 v70, v70
  v_smfmac_f32_16x16x64_bf16 v[208:211], v[12:15], v[224:231], v11
  v_exp_f32 v71, v71
  v_mfma_f32_32x32x16_bf16 v[48:63], v[100:103], v[36:39], v[48:63]
  v_cvt_pk_bf16_f32 v224, v64, v65
  v_cvt_pk_bf16_f32 v225, v66, v67
  v_cvt_pk_bf16_f32 v226, v68, v69
  v_cvt_pk_bf16_f32 v227, v70, v71
  v_exp_f32 v72, v72
  v_exp_f32 v73, v73
  v_exp_f32 v74, v74
  v_exp_f32 v75, v75
  v_mfma_f32_32x32x16_bf16 v[160:175], v[104:107], v[224:227], v[160:175]
  ds_read_b32 v7, v6
  v_exp_f32 v76, v76
  v_exp_f32 v77, v77
  v_exp_f32 v78, v78
  v_exp_f32 v79, v79
  v_cvt_pk_bf16_f32 v228, v72, v73
  v_cvt_pk_bf16_f32 v229, v74, v75
  v_cvt_pk_bf16_f32 v230, v76, v77
  v_cvt_pk_bf16_f32 v231, v78, v79
  s_waitcnt lgkmcnt(0)
  v_readfirstlane_b32 s39, v7
  s_andn2_b32 s39, s39, s34
  s_cbranch_scc0 .fz_kernel_a_p0
  s_ff1_i32_b32 s33, s36
  s_bitset0_b32 s36, s33
  s_lshl_b32 s33, s33, 14
  s_add_u32 s30, s33, s35
  s_cbranch_scc1 .fz_kernel_pk33c
.fz_kernel_pk33:
  buffer_load_dwordx4 v[112:115], v3, s[4:7], s30 offen offset:0
  buffer_load_dwordx4 v[116:119], v3, s[4:7], s30 offen offset:1024
  buffer_load_dwordx4 v[120:123], v3, s[4:7], s30 offen offset:2048
  buffer_load_dwordx4 v[124:127], v3, s[4:7], s30 offen offset:3072
  buffer_load_dwordx4 v[128:131], v10, s[4:7], s30 offen offset:0
  buffer_load_dwordx4 v[132:135], v10, s[4:7], s30 offen offset:1024
  buffer_load_dwordx4 v[136:139], v10, s[4:7], s30 offen offset:2048
  buffer_load_dwordx4 v[140:143], v10, s[4:7], s30 offen offset:3072
.fz_kernel_a_p0:
  v_mfma_f32_32x32x16_bf16 v[64:79], v[96:99], v[40:43], 0
  v_exp_f32 v48, v48
  v_exp_f32 v49, v49
  v_exp_f32 v50, v50
  v_exp_f32 v51, v51
  v_mfma_f32_32x32x16_bf16 v[160:175], v[108:111], v[228:231], v[160:175]
  v_exp_f32 v52, v52
  v_exp_f32 v53, v53
  v_exp_f32 v54, v54
  v_smfmac_f32_16x16x64_bf16 v[212:215], v[12:15], v[224:231], v11
  v_exp_f32 v55, v55
  v_mfma_f32_32x32x16_bf16 v[64:79], v[100:103], v[44:47], v[64:79]
  v_cvt_pk_bf16_f32 v224, v48, v49
  v_cvt_pk_bf16_f32 v225, v50, v51
  v_cvt_pk_bf16_f32 v226, v52, v53
  v_cvt_pk_bf16_f32 v227, v54, v55
  v_exp_f32 v56, v56
  v_exp_f32 v57, v57
  v_exp_f32 v58, v58
  v_exp_f32 v59, v59
  v_mfma_f32_32x32x16_bf16 v[176:191], v[104:107], v[224:227], v[176:191]
  v_exp_f32 v60, v60
  v_exp_f32 v61, v61
  v_exp_f32 v62, v62
  v_exp_f32 v63, v63
  v_cvt_pk_bf16_f32 v228, v56, v57
  v_cvt_pk_bf16_f32 v229, v58, v59
  v_cvt_pk_bf16_f32 v230, v60, v61
  v_cvt_pk_bf16_f32 v231, v62, v63
  v_exp_f32 v64, v64
  v_exp_f32 v65, v65
  v_exp_f32 v66, v66
  v_exp_f32 v67, v67
  v_mfma_f32_32x32x16_bf16 v[176:191], v[108:111], v[228:231], v[176:191]
  v_exp_f32 v68, v68
  v_exp_f32 v69, v69
  v_exp_f32 v70, v70
  v_smfmac_f32_16x16x64_bf16 v[216:219], v[12:15], v[224:231], v11
  v_exp_f32 v71, v71
  v_cvt_pk_bf16_f32 v224, v64, v65
  v_cvt_pk_bf16_f32 v225, v66, v67
  v_cvt_pk_bf16_f32 v226, v68, v69
  v_cvt_pk_bf16_f32 v227, v70, v71
  v_exp_f32 v72, v72
  v_exp_f32 v73, v73
  v_exp_f32 v74, v74
  v_exp_f32 v75, v75
  v_mfma_f32_32x32x16_bf16 v[192:207], v[104:107], v[224:227], v[192:207]
  v_exp_f32 v76, v76
  v_exp_f32 v77, v77
  v_exp_f32 v78, v78
  v_exp_f32 v79, v79
  v_cvt_pk_bf16_f32 v228, v72, v73
  v_cvt_pk_bf16_f32 v229, v74, v75
  v_cvt_pk_bf16_f32 v230, v76, v77
  v_cvt_pk_bf16_f32 v231, v78, v79
  s_cmp_lg_u32 s39, 0
  s_cbranch_scc1 .fz_kernel_a_p1
  s_ff1_i32_b32 s33, s36
  s_bitset0_b32 s36, s33
  s_lshl_b32 s33, s33, 14
  s_add_u32 s30, s33, s35
  s_cbranch_scc1 .fz_kernel_pk34c
.fz_kernel_pk34:
  buffer_load_dwordx4 v[112:115], v3, s[4:7], s30 offen offset:0
  buffer_load_dwordx4 v[116:119], v3, s[4:7], s30 offen offset:1024
  buffer_load_dwordx4 v[120:123], v3, s[4:7], s30 offen offset:2048
  buffer_load_dwordx4 v[124:127], v3, s[4:7], s30 offen offset:3072
  buffer_load_dwordx4 v[128:131], v10, s[4:7], s30 offen offset:0
  buffer_load_dwordx4 v[132:135], v10, s[4:7], s30 offen offset:1024
  buffer_load_dwordx4 v[136:139], v10, s[4:7], s30 offen offset:2048
  buffer_load_dwordx4 v[140:143], v10, s[4:7], s30 offen offset:3072
.fz_kernel_a_p1:
  s_ff1_i32_b32 s33, s36
  s_bitset0_b32 s36, s33
  s_lshl_b32 s33, s33, 14
  s_add_u32 s30, s33, s35
  s_cbranch_scc1 .fz_kernel_pk35c
.fz_kernel_pk35:
  buffer_load_dwordx4 v[80:83], v3, s[4:7], s30 offen offset:0
  buffer_load_dwordx4 v[84:87], v3, s[4:7], s30 offen offset:1024
  buffer_load_dwordx4 v[88:91], v3, s[4:7], s30 offen offset:2048
  buffer_load_dwordx4 v[92:95], v3, s[4:7], s30 offen offset:3072
  buffer_load_dwordx4 v[96:99], v10, s[4:7], s30 offen offset:0
  s_waitcnt vmcnt(11)
  v_mfma_f32_32x32x16_bf16 v[48:63], v[112:115], v[16:19], 0
  v_mfma_f32_32x32x16_bf16 v[48:63], v[116:119], v[20:23], v[48:63]
  s_nop 9
  s_branch .fz_kernel_a_b2
.fz_kernel_a_e:
  s_mov_b32 s36, s33
  s_or_b32 s34, s34, s39
  s_ff1_i32_b32 s33, s36
  s_bitset0_b32 s36, s33
  s_lshl_b32 s33, s33, 14
  s_add_u32 s30, s33, s35
  v_mfma_f32_32x32x16_bf16 v[48:63], v[96:99], v[16:19], 0
  buffer_load_dwordx4 v[112:115], v3, s[4:7], s30 offen offset:0
  v_exp_f32 v64, v64
  v_exp_f32 v65, v65
  v_exp_f32 v66, v66
  v_exp_f32 v67, v67
  v_mfma_f32_32x32x16_bf16 v[176:191], v[92:95], v[228:231], v[176:191]
  buffer_load_dwordx4 v[116:119], v3, s[4:7], s30 offen offset:1024
  v_exp_f32 v68, v68
  v_exp_f32 v69, v69
  v_exp_f32 v70, v70
  v_smfmac_f32_16x16x64_bf16 v[216:219], v[12:15], v[224:231], v11
  buffer_load_dwordx4 v[120:123], v3, s[4:7], s30 offen offset:2048
  v_exp_f32 v71, v71
  v_mfma_f32_32x32x16_bf16 v[48:63], v[100:103], v[20:23], v[48:63]
  buffer_load_dwordx4 v[124:127], v3, s[4:7], s30 offen offset:3072
  v_cvt_pk_bf16_f32 v224, v64, v65
  v_cvt_pk_bf16_f32 v225, v66, v67
  v_cvt_pk_bf16_f32 v226, v68, v69
  v_cvt_pk_bf16_f32 v227, v70, v71
  v_exp_f32 v72, v72
  v_exp_f32 v73, v73
  v_exp_f32 v74, v74
  v_exp_f32 v75, v75
  v_mfma_f32_32x32x16_bf16 v[192:207], v[88:91], v[224:227], 0
  buffer_load_dwordx4 v[128:131], v10, s[4:7], s30 offen offset:0
  v_exp_f32 v76, v76
  v_exp_f32 v77, v77
  v_exp_f32 v78, v78
  v_exp_f32 v79, v79
  v_cvt_pk_bf16_f32 v228, v72, v73
  v_cvt_pk_bf16_f32 v229, v74, v75
  v_cvt_pk_bf16_f32 v230, v76, v77
  v_cvt_pk_bf16_f32 v231, v78, v79
  v_mfma_f32_32x32x16_bf16 v[64:79], v[96:99], v[24:27], 0
  buffer_load_dwordx4 v[132:135], v10, s[4:7], s30 offen offset:1024
  v_exp_f32 v48, v48
  v_exp_f32 v49, v49
  v_exp_f32 v50, v50
  v_exp_f32 v51, v51
  v_mfma_f32_32x32x16_bf16 v[192:207], v[92:95], v[228:231], v[192:207]
  buffer_load_dwordx4 v[136:139], v10, s[4:7], s30 offen offset:2048
  v_exp_f32 v52, v52
  v_exp_f32 v53, v53
  v_exp_f32 v54, v54
  v_smfmac_f32_16x16x64_bf16 v[220:223], v[12:15], v[224:231], v11
  buffer_load_dwordx4 v[140:143], v10, s[4:7], s30 offen offset:3072
  v_exp_f32 v55, v55
  v_mfma_f32_32x32x16_bf16 v[64:79], v[100:103], v[28:31], v[64:79]
  s_ff1_i32_b32 s33, s36
  v_cvt_pk_bf16_f32 v224, v48, v49
  v_cvt_pk_bf16_f32 v225, v50, v51
  v_cvt_pk_bf16_f32 v226, v52, v53
  v_cvt_pk_bf16_f32 v227, v54, v55
  v_exp_f32 v56, v56
  v_exp_f32 v57, v57
  v_exp_f32 v58, v58
  v_exp_f32 v59, v59
  v_mfma_f32_32x32x16_bf16 v[144:159], v[104:107], v[224:227], v[144:159]
  s_bitset0_b32 s36, s33
  v_exp_f32 v60, v60
  v_exp_f32 v61, v61
  v_exp_f32 v62, v62
  v_exp_f32 v63, v63
  v_cvt_pk_bf16_f32 v228, v56, v57
  v_cvt_pk_bf16_f32 v229, v58, v59
  v_cvt_pk_bf16_f32 v230, v60, v61
  v_cvt_pk_bf16_f32 v231, v62, v63
  v_mfma_f32_32x32x16_bf16 v[48:63], v[96:99], v[32:35], 0
  s_lshl_b32 s33, s33, 14
  v_exp_f32 v64, v64
  v_exp_f32 v65, v65
  v_exp_f32 v66, v66
  v_exp_f32 v67, v67
  v_mfma_f32_32x32x16_bf16 v[144:159], v[108:111], v[228:231], v[144:159]
  s_add_u32 s30, s33, s35
  v_exp_f32 v68, v68
  v_exp_f32 v69, v69
  v_exp_f32 v70, v70
  v_smfmac_f32_16x16x64_bf16 v[208:211], v[12:15], v[224:231], v11
  buffer_load_dwordx4 v[80:83], v3, s[4:7], s30 offen offset:0
  v_exp_f32 v71, v71
  v_mfma_f32_32x32x16_bf16 v[48:63], v[100:103], v[36:39], v[48:63]
  buffer_load_dwordx4 v[84:87], v3, s[4:7], s30 offen offset:1024
  v_cvt_pk_bf16_f32 v224, v64, v65
  v_cvt_pk_bf16_f32 v225, v66, v67
  v_cvt_pk_bf16_f32 v226, v68, v69
  v_cvt_pk_bf16_f32 v227, v70, v71
  v_exp_f32 v72, v72
  v_exp_f32 v73, v73
  v_exp_f32 v74, v74
  v_exp_f32 v75, v75
  v_mfma_f32_32x32x16_bf16 v[160:175], v[104:107], v[224:227], v[160:175]
  buffer_load_dwordx4 v[88:91], v3, s[4:7], s30 offen offset:2048
  v_exp_f32 v76, v76
  v_exp_f32 v77, v77
  v_exp_f32 v78, v78
  v_exp_f32 v79, v79
  v_cvt_pk_bf16_f32 v228, v72, v73
  v_cvt_pk_bf16_f32 v229, v74, v75
  v_cvt_pk_bf16_f32 v230, v76, v77
  v_cvt_pk_bf16_f32 v231, v78, v79
  v_mfma_f32_32x32x16_bf16 v[64:79], v[96:99], v[40:43], 0
  buffer_load_dwordx4 v[92:95], v3, s[4:7], s30 offen offset:3072
  v_exp_f32 v48, v48
  v_exp_f32 v49, v49
  v_exp_f32 v50, v50
  v_exp_f32 v51, v51
  v_mfma_f32_32x32x16_bf16 v[160:175], v[108:111], v[228:231], v[160:175]
  v_exp_f32 v52, v52
  v_exp_f32 v53, v53
  v_exp_f32 v54, v54
  v_smfmac_f32_16x16x64_bf16 v[212:215], v[12:15], v[224:231], v11
  v_exp_f32 v55, v55
  v_mfma_f32_32x32x16_bf16 v[64:79], v[100:103], v[44:47], v[64:79]
  v_cvt_pk_bf16_f32 v224, v48, v49
  v_cvt_pk_bf16_f32 v225, v50, v51
  v_cvt_pk_bf16_f32 v226, v52, v53
  v_cvt_pk_bf16_f32 v227, v54, v55
  v_exp_f32 v56, v56
  v_exp_f32 v57, v57
  v_exp_f32 v58, v58
  v_exp_f32 v59, v59
  v_mfma_f32_32x32x16_bf16 v[176:191], v[104:107], v[224:227], v[176:191]
  s_waitcnt vmcnt(10)
  v_exp_f32 v60, v60
  v_exp_f32 v61, v61
  v_exp_f32 v62, v62
  v_exp_f32 v63, v63
  v_cvt_pk_bf16_f32 v228, v56, v57
  v_cvt_pk_bf16_f32 v229, v58, v59
  v_cvt_pk_bf16_f32 v230, v60, v61
  v_cvt_pk_bf16_f32 v231, v62, v63
  v_mfma_f32_32x32x16_bf16 v[48:63], v[112:115], v[16:19], 0
  v_exp_f32 v64, v64
  v_exp_f32 v65, v65
  v_exp_f32 v66, v66
  v_exp_f32 v67, v67
  v_mfma_f32_32x32x16_bf16 v[176:191], v[108:111], v[228:231], v[176:191]
  buffer_load_dwordx4 v[96:99], v10, s[4:7], s30 offen offset:0
  v_exp_f32 v68, v68
  v_exp_f32 v69, v69
  v_exp_f32 v70, v70
  v_smfmac_f32_16x16x64_bf16 v[216:219], v[12:15], v[224:231], v11
  v_exp_f32 v71, v71
  v_mfma_f32_32x32x16_bf16 v[48:63], v[116:119], v[20:23], v[48:63]
  v_cvt_pk_bf16_f32 v224, v64, v65
  v_cvt_pk_bf16_f32 v225, v66, v67
  v_cvt_pk_bf16_f32 v226, v68, v69
  v_cvt_pk_bf16_f32 v227, v70, v71
  v_exp_f32 v72, v72
  v_exp_f32 v73, v73
  v_exp_f32 v74, v74
  v_exp_f32 v75, v75
  v_mfma_f32_32x32x16_bf16 v[192:207], v[104:107], v[224:227], v[192:207]
  v_exp_f32 v76, v76
  v_exp_f32 v77, v77
  v_exp_f32 v78, v78
  v_exp_f32 v79, v79
  v_cvt_pk_bf16_f32 v228, v72, v73
  v_cvt_pk_bf16_f32 v229, v74, v75
  v_cvt_pk_bf16_f32 v230, v76, v77
  v_cvt_pk_bf16_f32 v231, v78, v79
  s_branch .fz_kernel_a_b2
  .p2align 6
.fz_kernel_a_loop:
  v_mfma_f32_32x32x16_bf16 v[64:79], v[80:83], v[24:27], 0
  v_exp_f32 v48, v48
  v_exp_f32 v49, v49
  v_exp_f32 v50, v50
  v_exp_f32 v51, v51
  v_mfma_f32_32x32x16_bf16 v[192:207], v[140:143], v[228:231], v[192:207]
  v_exp_f32 v52, v52
  v_exp_f32 v53, v53
  v_exp_f32 v54, v54
  v_smfmac_f32_16x16x64_bf16 v[220:223], v[12:15], v[224:231], v11
  buffer_load_dwordx4 v[132:135], v10, s[4:7], s30 offen offset:1024
  v_exp_f32 v55, v55
  v_mfma_f32_32x32x16_bf16 v[64:79], v[84:87], v[28:31], v[64:79]
  s_waitcnt vmcnt(10)
  v_cvt_pk_bf16_f32 v224, v48, v49
  v_cvt_pk_bf16_f32 v225, v50, v51
  v_cvt_pk_bf16_f32 v226, v52, v53
  v_cvt_pk_bf16_f32 v227, v54, v55
  v_exp_f32 v56, v56
  v_exp_f32 v57, v57
  v_exp_f32 v58, v58
  v_exp_f32 v59, v59
  v_mfma_f32_32x32x16_bf16 v[144:159], v[88:91], v[224:227], v[144:159]
  v_exp_f32 v60, v60
  v_exp_f32 v61, v61
  v_exp_f32 v62, v62
  v_exp_f32 v63, v63
  v_cvt_pk_bf16_f32 v228, v56, v57
  v_cvt_pk_bf16_f32 v229, v58, v59
  v_cvt_pk_bf16_f32 v230, v60, v61
  v_cvt_pk_bf16_f32 v231, v62, v63
  v_mfma_f32_32x32x16_bf16 v[48:63], v[80:83], v[32:35], 0
  v_exp_f32 v64, v64
  v_exp_f32 v65, v65
  v_exp_f32 v66, v66
  v_exp_f32 v67, v67
  v_mfma_f32_32x32x16_bf16 v[144:159], v[92:95], v[228:231], v[144:159]
  v_exp_f32 v68, v68
  v_exp_f32 v69, v69
  v_exp_f32 v70, v70
  v_smfmac_f32_16x16x64_bf16 v[208:211], v[12:15], v[224:231], v11
  buffer_load_dwordx4 v[136:139], v10, s[4:7], s30 offen offset:2048
  v_exp_f32 v71, v71
  v_mfma_f32_32x32x16_bf16 v[48:63], v[84:87], v[36:39], v[48:63]
  s_ff1_i32_b32 s33, s36
  v_cvt_pk_bf16_f32 v224, v64, v65
  v_cvt_pk_bf16_f32 v225, v66, v67
  v_cvt_pk_bf16_f32 v226, v68, v69
  v_cvt_pk_bf16_f32 v227, v70, v71
  v_exp_f32 v72, v72
  v_exp_f32 v73, v73
  v_exp_f32 v74, v74
  v_exp_f32 v75, v75
  v_mfma_f32_32x32x16_bf16 v[160:175], v[88:91], v[224:227], v[160:175]
  s_bitset0_b32 s36, s33
  v_exp_f32 v76, v76
  v_exp_f32 v77, v77
  v_exp_f32 v78, v78
  v_exp_f32 v79, v79
  v_cvt_pk_bf16_f32 v228, v72, v73
  v_cvt_pk_bf16_f32 v229, v74, v75
  v_cvt_pk_bf16_f32 v230, v76, v77
  v_cvt_pk_bf16_f32 v231, v78, v79
  v_mfma_f32_32x32x16_bf16 v[64:79], v[80:83], v[40:43], 0
  s_lshl_b32 s33, s33, 14
  v_exp_f32 v48, v48
  v_exp_f32 v49, v49
  v_exp_f32 v50, v50
  v_exp_f32 v51, v51
  v_mfma_f32_32x32x16_bf16 v[160:175], v[92:95], v[228:231], v[160:175]
  v_exp_f32 v52, v52
  v_exp_f32 v53, v53
  v_exp_f32 v54, v54
  v_smfmac_f32_16x16x64_bf16 v[212:215], v[12:15], v[224:231], v11
  buffer_load_dwordx4 v[140:143], v10, s[4:7], s30 offen offset:3072
  v_exp_f32 v55, v55
  v_mfma_f32_32x32x16_bf16 v[64:79], v[84:87], v[44:47], v[64:79]
  s_add_u32 s30, s33, s35
  v_cvt_pk_bf16_f32 v224, v48, v49
  v_cvt_pk_bf16_f32 v225, v50, v51
  v_cvt_pk_bf16_f32 v226, v52, v53
  v_cvt_pk_bf16_f32 v227, v54, v55
  v_exp_f32 v56, v56
  v_exp_f32 v57, v57
  v_exp_f32 v58, v58
  v_exp_f32 v59, v59
  v_mfma_f32_32x32x16_bf16 v[176:191], v[88:91], v[224:227], v[176:191]
  s_waitcnt vmcnt(10)
  v_exp_f32 v60, v60
  v_exp_f32 v61, v61
  v_exp_f32 v62, v62
  v_exp_f32 v63, v63
  v_cvt_pk_bf16_f32 v228, v56, v57
  v_cvt_pk_bf16_f32 v229, v58, v59
  v_cvt_pk_bf16_f32 v230, v60, v61
  v_cvt_pk_bf16_f32 v231, v62, v63
  v_mfma_f32_32x32x16_bf16 v[48:63], v[96:99], v[16:19], 0
  s_cbranch_scc1 .fz_kernel_pk38c
.fz_kernel_pk38:
  v_exp_f32 v64, v64
  v_exp_f32 v65, v65
  v_exp_f32 v66, v66
  v_exp_f32 v67, v67
  v_mfma_f32_32x32x16_bf16 v[176:191], v[92:95], v[228:231], v[176:191]
  v_exp_f32 v68, v68
  v_exp_f32 v69, v69
  v_exp_f32 v70, v70
  v_smfmac_f32_16x16x64_bf16 v[216:219], v[12:15], v[224:231], v11
  buffer_load_dwordx4 v[80:83], v3, s[4:7], s30 offen offset:0
  v_exp_f32 v71, v71
  v_mfma_f32_32x32x16_bf16 v[48:63], v[100:103], v[20:23], v[48:63]
  v_cvt_pk_bf16_f32 v224, v64, v65
  v_cvt_pk_bf16_f32 v225, v66, v67
  v_cvt_pk_bf16_f32 v226, v68, v69
  v_cvt_pk_bf16_f32 v227, v70, v71
  v_exp_f32 v72, v72
  v_exp_f32 v73, v73
  v_exp_f32 v74, v74
  v_exp_f32 v75, v75
  v_mfma_f32_32x32x16_bf16 v[192:207], v[88:91], v[224:227], v[192:207]
  v_exp_f32 v76, v76
  v_exp_f32 v77, v77
  v_exp_f32 v78, v78
  v_exp_f32 v79, v79
  v_cvt_pk_bf16_f32 v228, v72, v73
  v_cvt_pk_bf16_f32 v229, v74, v75
  v_cvt_pk_bf16_f32 v230, v76, v77
  v_cvt_pk_bf16_f32 v231, v78, v79
  v_mfma_f32_32x32x16_bf16 v[64:79], v[96:99], v[24:27], 0
  v_exp_f32 v48, v48
  v_exp_f32 v49, v49
  v_exp_f32 v50, v50
  v_exp_f32 v51, v51
  v_mfma_f32_32x32x16_bf16 v[192:207], v[92:95], v[228:231], v[192:207]
  v_exp_f32 v52, v52
  v_exp_f32 v53, v53
  v_exp_f32 v54, v54
  v_smfmac_f32_16x16x64_bf16 v[220:223], v[12:15], v[224:231], v11
  buffer_load_dwordx4 v[84:87], v3, s[4:7], s30 offen offset:1024
  v_exp_f32 v55, v55
  v_mfma_f32_32x32x16_bf16 v[64:79], v[100:103], v[28:31], v[64:79]
  s_waitcnt vmcnt(10)
  v_cvt_pk_bf16_f32 v224, v48, v49
  v_cvt_pk_bf16_f32 v225, v50, v51
  v_cvt_pk_bf16_f32 v226, v52, v53
  v_cvt_pk_bf16_f32 v227, v54, v55
  v_exp_f32 v56, v56
  v_exp_f32 v57, v57
  v_exp_f32 v58, v58
  v_exp_f32 v59, v59
  v_mfma_f32_32x32x16_bf16 v[144:159], v[104:107], v[224:227], v[144:159]
  v_exp_f32 v60, v60
  v_exp_f32 v61, v61
  v_exp_f32 v62, v62
  v_exp_f32 v63, v63
  v_cvt_pk_bf16_f32 v228, v56, v57
  v_cvt_pk_bf16_f32 v229, v58, v59
  v_cvt_pk_bf16_f32 v230, v60, v61
  v_cvt_pk_bf16_f32 v231, v62, v63
  v_mfma_f32_32x32x16_bf16 v[48:63], v[96:99], v[32:35], 0
  v_exp_f32 v64, v64
  v_exp_f32 v65, v65
  v_exp_f32 v66, v66
  v_exp_f32 v67, v67
  v_mfma_f32_32x32x16_bf16 v[144:159], v[108:111], v[228:231], v[144:159]
  v_exp_f32 v68, v68
  v_exp_f32 v69, v69
  v_exp_f32 v70, v70
  v_smfmac_f32_16x16x64_bf16 v[208:211], v[12:15], v[224:231], v11
  buffer_load_dwordx4 v[88:91], v3, s[4:7], s30 offen offset:2048
  v_exp_f32 v71, v71
  v_mfma_f32_32x32x16_bf16 v[48:63], v[100:103], v[36:39], v[48:63]
  v_cvt_pk_bf16_f32 v224, v64, v65
  v_cvt_pk_bf16_f32 v225, v66, v67
  v_cvt_pk_bf16_f32 v226, v68, v69
  v_cvt_pk_bf16_f32 v227, v70, v71
  v_exp_f32 v72, v72
  v_exp_f32 v73, v73
  v_exp_f32 v74, v74
  v_exp_f32 v75, v75
  v_mfma_f32_32x32x16_bf16 v[160:175], v[104:107], v[224:227], v[160:175]
  v_exp_f32 v76, v76
  v_exp_f32 v77, v77
  v_exp_f32 v78, v78
  v_exp_f32 v79, v79
  v_cvt_pk_bf16_f32 v228, v72, v73
  v_cvt_pk_bf16_f32 v229, v74, v75
  v_cvt_pk_bf16_f32 v230, v76, v77
  v_cvt_pk_bf16_f32 v231, v78, v79
  v_mfma_f32_32x32x16_bf16 v[64:79], v[96:99], v[40:43], 0
  v_exp_f32 v48, v48
  v_exp_f32 v49, v49
  v_exp_f32 v50, v50
  v_exp_f32 v51, v51
  v_mfma_f32_32x32x16_bf16 v[160:175], v[108:111], v[228:231], v[160:175]
  v_exp_f32 v52, v52
  v_exp_f32 v53, v53
  v_exp_f32 v54, v54
  v_smfmac_f32_16x16x64_bf16 v[212:215], v[12:15], v[224:231], v11
  buffer_load_dwordx4 v[92:95], v3, s[4:7], s30 offen offset:3072
  v_exp_f32 v55, v55
  v_mfma_f32_32x32x16_bf16 v[64:79], v[100:103], v[44:47], v[64:79]
  v_cvt_pk_bf16_f32 v224, v48, v49
  v_cvt_pk_bf16_f32 v225, v50, v51
  v_cvt_pk_bf16_f32 v226, v52, v53
  v_cvt_pk_bf16_f32 v227, v54, v55
  v_exp_f32 v56, v56
  v_exp_f32 v57, v57
  v_exp_f32 v58, v58
  v_exp_f32 v59, v59
  v_mfma_f32_32x32x16_bf16 v[176:191], v[104:107], v[224:227], v[176:191]
  s_waitcnt vmcnt(10)
  v_exp_f32 v60, v60
  v_exp_f32 v61, v61
  v_exp_f32 v62, v62
  v_exp_f32 v63, v63
  v_cvt_pk_bf16_f32 v228, v56, v57
  v_cvt_pk_bf16_f32 v229, v58, v59
  v_cvt_pk_bf16_f32 v230, v60, v61
  v_cvt_pk_bf16_f32 v231, v62, v63
  v_mfma_f32_32x32x16_bf16 v[48:63], v[112:115], v[16:19], 0
  v_exp_f32 v64, v64
  v_exp_f32 v65, v65
  v_exp_f32 v66, v66
  v_exp_f32 v67, v67
  v_mfma_f32_32x32x16_bf16 v[176:191], v[108:111], v[228:231], v[176:191]
  v_exp_f32 v68, v68
  v_exp_f32 v69, v69
  v_exp_f32 v70, v70
  v_smfmac_f32_16x16x64_bf16 v[216:219], v[12:15], v[224:231], v11
  buffer_load_dwordx4 v[96:99], v10, s[4:7], s30 offen offset:0
  v_exp_f32 v71, v71
  v_mfma_f32_32x32x16_bf16 v[48:63], v[116:119], v[20:23], v[48:63]
  s_sub_u32 s32, s32, 1
  v_cvt_pk_bf16_f32 v224, v64, v65
  v_cvt_pk_bf16_f32 v225, v66, v67
  v_cvt_pk_bf16_f32 v226, v68, v69
  v_cvt_pk_bf16_f32 v227, v70, v71
  v_exp_f32 v72, v72
  v_exp_f32 v73, v73
  v_exp_f32 v74, v74
  v_exp_f32 v75, v75
  v_mfma_f32_32x32x16_bf16 v[192:207], v[104:107], v[224:227], v[192:207]
  s_cmp_eq_u32 s32, 0
  v_exp_f32 v76, v76
  v_exp_f32 v77, v77
  v_exp_f32 v78, v78
  v_exp_f32 v79, v79
  v_cvt_pk_bf16_f32 v228, v72, v73
  v_cvt_pk_bf16_f32 v229, v74, v75
  v_cvt_pk_bf16_f32 v230, v76, v77
  v_cvt_pk_bf16_f32 v231, v78, v79
  s_cbranch_scc1 .fz_kernel_a_x
.fz_kernel_a_b2:
  v_mfma_f32_32x32x16_bf16 v[64:79], v[112:115], v[24:27], 0
  v_exp_f32 v48, v48
  v_exp_f32 v49, v49
  v_exp_f32 v50, v50
  v_exp_f32 v51, v51
  v_mfma_f32_32x32x16_bf16 v[192:207], v[108:111], v[228:231], v[192:207]
  v_exp_f32 v52, v52
  v_exp_f32 v53, v53
  v_exp_f32 v54, v54
  v_smfmac_f32_16x16x64_bf16 v[220:223], v[12:15], v[224:231], v11
  buffer_load_dwordx4 v[100:103], v10, s[4:7], s30 offen offset:1024
  v_exp_f32 v55, v55
  v_mfma_f32_32x32x16_bf16 v[64:79], v[116:119], v[28:31], v[64:79]
  s_waitcnt vmcnt(10)
  v_cvt_pk_bf16_f32 v224, v48, v49
  v_cvt_pk_bf16_f32 v225, v50, v51
  v_cvt_pk_bf16_f32 v226, v52, v53
  v_cvt_pk_bf16_f32 v227, v54, v55
  v_exp_f32 v56, v56
  v_exp_f32 v57, v57
  v_exp_f32 v58, v58
  v_exp_f32 v59, v59
  v_mfma_f32_32x32x16_bf16 v[144:159], v[120:123], v[224:227], v[144:159]
  v_exp_f32 v60, v60
  v_exp_f32 v61, v61
  v_exp_f32 v62, v62
  v_exp_f32 v63, v63
  v_cvt_pk_bf16_f32 v228, v56, v57
  v_cvt_pk_bf16_f32 v229, v58, v59
  v_cvt_pk_bf16_f32 v230, v60, v61
  v_cvt_pk_bf16_f32 v231, v62, v63
  v_mfma_f32_32x32x16_bf16 v[48:63], v[112:115], v[32:35], 0
  v_exp_f32 v64, v64
  v_exp_f32 v65, v65
  v_exp_f32 v66, v66
  v_exp_f32 v67, v67
  v_mfma_f32_32x32x16_bf16 v[144:159], v[124:127], v[228:231], v[144:159]
  v_exp_f32 v68, v68
  v_exp_f32 v69, v69
  v_exp_f32 v70, v70
  v_smfmac_f32_16x16x64_bf16 v[208:211], v[12:15], v[224:231], v11
  buffer_load_dwordx4 v[104:107], v10, s[4:7], s30 offen offset:2048
  v_exp_f32 v71, v71
  v_mfma_f32_32x32x16_bf16 v[48:63], v[116:119], v[36:39], v[48:63]
  s_ff1_i32_b32 s33, s36
  v_cvt_pk_bf16_f32 v224, v64, v65
  v_cvt_pk_bf16_f32 v225, v66, v67
  v_cvt_pk_bf16_f32 v226, v68, v69
  v_cvt_pk_bf16_f32 v227, v70, v71
  v_exp_f32 v72, v72
  v_exp_f32 v73, v73
  v_exp_f32 v74, v74
  v_exp_f32 v75, v75
  v_mfma_f32_32x32x16_bf16 v[160:175], v[120:123], v[224:227], v[160:175]
  s_bitset0_b32 s36, s33
  v_exp_f32 v76, v76
  v_exp_f32 v77, v77
  v_exp_f32 v78, v78
  v_exp_f32 v79, v79
  v_cvt_pk_bf16_f32 v228, v72, v73
  v_cvt_pk_bf16_f32 v229, v74, v75
  v_cvt_pk_bf16_f32 v230, v76, v77
  v_cvt_pk_bf16_f32 v231, v78, v79
  v_mfma_f32_32x32x16_bf16 v[64:79], v[112:115], v[40:43], 0
  s_lshl_b32 s33, s33, 14
  v_exp_f32 v48, v48
  v_exp_f32 v49, v49
  v_exp_f32 v50, v50
  v_exp_f32 v51, v51
  v_mfma_f32_32x32x16_bf16 v[160:175], v[124:127], v[228:231], v[160:175]
  v_exp_f32 v52, v52
  v_exp_f32 v53, v53
  v_exp_f32 v54, v54
  v_smfmac_f32_16x16x64_bf16 v[212:215], v[12:15], v[224:231], v11
  buffer_load_dwordx4 v[108:111], v10, s[4:7], s30 offen offset:3072
  v_exp_f32 v55, v55
  v_mfma_f32_32x32x16_bf16 v[64:79], v[116:119], v[44:47], v[64:79]
  s_add_u32 s30, s33, s35
  v_cvt_pk_bf16_f32 v224, v48, v49
  v_cvt_pk_bf16_f32 v225, v50, v51
  v_cvt_pk_bf16_f32 v226, v52, v53
  v_cvt_pk_bf16_f32 v227, v54, v55
  v_exp_f32 v56, v56
  v_exp_f32 v57, v57
  v_exp_f32 v58, v58
  v_exp_f32 v59, v59
  v_mfma_f32_32x32x16_bf16 v[176:191], v[120:123], v[224:227], v[176:191]
  s_waitcnt vmcnt(10)
  v_exp_f32 v60, v60
  v_exp_f32 v61, v61
  v_exp_f32 v62, v62
  v_exp_f32 v63, v63
  v_cvt_pk_bf16_f32 v228, v56, v57
  v_cvt_pk_bf16_f32 v229, v58, v59
  v_cvt_pk_bf16_f32 v230, v60, v61
  v_cvt_pk_bf16_f32 v231, v62, v63
  v_mfma_f32_32x32x16_bf16 v[48:63], v[128:131], v[16:19], 0
  s_cbranch_scc1 .fz_kernel_pk39c
.fz_kernel_pk39:
  v_exp_f32 v64, v64
  v_exp_f32 v65, v65
  v_exp_f32 v66, v66
  v_exp_f32 v67, v67
  v_mfma_f32_32x32x16_bf16 v[176:191], v[124:127], v[228:231], v[176:191]
  v_exp_f32 v68, v68
  v_exp_f32 v69, v69
  v_exp_f32 v70, v70
  v_smfmac_f32_16x16x64_bf16 v[216:219], v[12:15], v[224:231], v11
  buffer_load_dwordx4 v[112:115], v3, s[4:7], s30 offen offset:0
  v_exp_f32 v71, v71
  v_mfma_f32_32x32x16_bf16 v[48:63], v[132:135], v[20:23], v[48:63]
  v_cvt_pk_bf16_f32 v224, v64, v65
  v_cvt_pk_bf16_f32 v225, v66, v67
  v_cvt_pk_bf16_f32 v226, v68, v69
  v_cvt_pk_bf16_f32 v227, v70, v71
  v_exp_f32 v72, v72
  v_exp_f32 v73, v73
  v_exp_f32 v74, v74
  v_exp_f32 v75, v75
  v_mfma_f32_32x32x16_bf16 v[192:207], v[120:123], v[224:227], v[192:207]
  v_exp_f32 v76, v76
  v_exp_f32 v77, v77
  v_exp_f32 v78, v78
  v_exp_f32 v79, v79
  v_cvt_pk_bf16_f32 v228, v72, v73
  v_cvt_pk_bf16_f32 v229, v74, v75
  v_cvt_pk_bf16_f32 v230, v76, v77
  v_cvt_pk_bf16_f32 v231, v78, v79
  v_mfma_f32_32x32x16_bf16 v[64:79], v[128:131], v[24:27], 0
  v_exp_f32 v48, v48
  v_exp_f32 v49, v49
  v_exp_f32 v50, v50
  v_exp_f32 v51, v51
  v_mfma_f32_32x32x16_bf16 v[192:207], v[124:127], v[228:231], v[192:207]
  v_exp_f32 v52, v52
  v_exp_f32 v53, v53
  v_exp_f32 v54, v54
  v_smfmac_f32_16x16x64_bf16 v[220:223], v[12:15], v[224:231], v11
  buffer_load_dwordx4 v[116:119], v3, s[4:7], s30 offen offset:1024
  v_exp_f32 v55, v55
  v_mfma_f32_32x32x16_bf16 v[64:79], v[132:135], v[28:31], v[64:79]
  s_waitcnt vmcnt(10)
  v_cvt_pk_bf16_f32 v224, v48, v49
  v_cvt_pk_bf16_f32 v225, v50, v51
  v_cvt_pk_bf16_f32 v226, v52, v53
  v_cvt_pk_bf16_f32 v227, v54, v55
  v_exp_f32 v56, v56
  v_exp_f32 v57, v57
  v_exp_f32 v58, v58
  v_exp_f32 v59, v59
  v_mfma_f32_32x32x16_bf16 v[144:159], v[136:139], v[224:227], v[144:159]
  v_exp_f32 v60, v60
  v_exp_f32 v61, v61
  v_exp_f32 v62, v62
  v_exp_f32 v63, v63
  v_cvt_pk_bf16_f32 v228, v56, v57
  v_cvt_pk_bf16_f32 v229, v58, v59
  v_cvt_pk_bf16_f32 v230, v60, v61
  v_cvt_pk_bf16_f32 v231, v62, v63
  v_mfma_f32_32x32x16_bf16 v[48:63], v[128:131], v[32:35], 0
  v_exp_f32 v64, v64
  v_exp_f32 v65, v65
  v_exp_f32 v66, v66
  v_exp_f32 v67, v67
  v_mfma_f32_32x32x16_bf16 v[144:159], v[140:143], v[228:231], v[144:159]
  v_exp_f32 v68, v68
  v_exp_f32 v69, v69
  v_exp_f32 v70, v70
  v_smfmac_f32_16x16x64_bf16 v[208:211], v[12:15], v[224:231], v11
  buffer_load_dwordx4 v[120:123], v3, s[4:7], s30 offen offset:2048
  v_exp_f32 v71, v71
  v_mfma_f32_32x32x16_bf16 v[48:63], v[132:135], v[36:39], v[48:63]
  v_cvt_pk_bf16_f32 v224, v64, v65
  v_cvt_pk_bf16_f32 v225, v66, v67
  v_cvt_pk_bf16_f32 v226, v68, v69
  v_cvt_pk_bf16_f32 v227, v70, v71
  v_exp_f32 v72, v72
  v_exp_f32 v73, v73
  v_exp_f32 v74, v74
  v_exp_f32 v75, v75
  v_mfma_f32_32x32x16_bf16 v[160:175], v[136:139], v[224:227], v[160:175]
  v_exp_f32 v76, v76
  v_exp_f32 v77, v77
  v_exp_f32 v78, v78
  v_exp_f32 v79, v79
  v_cvt_pk_bf16_f32 v228, v72, v73
  v_cvt_pk_bf16_f32 v229, v74, v75
  v_cvt_pk_bf16_f32 v230, v76, v77
  v_cvt_pk_bf16_f32 v231, v78, v79
  v_mfma_f32_32x32x16_bf16 v[64:79], v[128:131], v[40:43], 0
  v_exp_f32 v48, v48
  v_exp_f32 v49, v49
  v_exp_f32 v50, v50
  v_exp_f32 v51, v51
  v_mfma_f32_32x32x16_bf16 v[160:175], v[140:143], v[228:231], v[160:175]
  v_exp_f32 v52, v52
  v_exp_f32 v53, v53
  v_exp_f32 v54, v54
  v_smfmac_f32_16x16x64_bf16 v[212:215], v[12:15], v[224:231], v11
  buffer_load_dwordx4 v[124:127], v3, s[4:7], s30 offen offset:3072
  v_exp_f32 v55, v55
  v_mfma_f32_32x32x16_bf16 v[64:79], v[132:135], v[44:47], v[64:79]
  v_cvt_pk_bf16_f32 v224, v48, v49
  v_cvt_pk_bf16_f32 v225, v50, v51
  v_cvt_pk_bf16_f32 v226, v52, v53
  v_cvt_pk_bf16_f32 v227, v54, v55
  v_exp_f32 v56, v56
  v_exp_f32 v57, v57
  v_exp_f32 v58, v58
  v_exp_f32 v59, v59
  v_mfma_f32_32x32x16_bf16 v[176:191], v[136:139], v[224:227], v[176:191]
  s_waitcnt vmcnt(10)
  v_exp_f32 v60, v60
  v_exp_f32 v61, v61
  v_exp_f32 v62, v62
  v_exp_f32 v63, v63
  v_cvt_pk_bf16_f32 v228, v56, v57
  v_cvt_pk_bf16_f32 v229, v58, v59
  v_cvt_pk_bf16_f32 v230, v60, v61
  v_cvt_pk_bf16_f32 v231, v62, v63
  v_mfma_f32_32x32x16_bf16 v[48:63], v[80:83], v[16:19], 0
  v_exp_f32 v64, v64
  v_exp_f32 v65, v65
  v_exp_f32 v66, v66
  v_exp_f32 v67, v67
  v_mfma_f32_32x32x16_bf16 v[176:191], v[140:143], v[228:231], v[176:191]
  v_exp_f32 v68, v68
  v_exp_f32 v69, v69
  v_exp_f32 v70, v70
  v_smfmac_f32_16x16x64_bf16 v[216:219], v[12:15], v[224:231], v11
  buffer_load_dwordx4 v[128:131], v10, s[4:7], s30 offen offset:0
  v_exp_f32 v71, v71
  v_mfma_f32_32x32x16_bf16 v[48:63], v[84:87], v[20:23], v[48:63]
  v_cvt_pk_bf16_f32 v224, v64, v65
  v_cvt_pk_bf16_f32 v225, v66, v67
  v_cvt_pk_bf16_f32 v226, v68, v69
  v_cvt_pk_bf16_f32 v227, v70, v71
  v_exp_f32 v72, v72
  v_exp_f32 v73, v73
  v_exp_f32 v74, v74
  v_exp_f32 v75, v75
  v_mfma_f32_32x32x16_bf16 v[192:207], v[136:139], v[224:227], v[192:207]
  v_exp_f32 v76, v76
  v_exp_f32 v77, v77
  v_exp_f32 v78, v78
  v_exp_f32 v79, v79
  v_cvt_pk_bf16_f32 v228, v72, v73
  v_cvt_pk_bf16_f32 v229, v74, v75
  v_cvt_pk_bf16_f32 v230, v76, v77
  v_cvt_pk_bf16_f32 v231, v78, v79
  s_branch .fz_kernel_a_loop
.fz_kernel_a_x:
  s_waitcnt vmcnt(7)
  v_mfma_f32_32x32x16_bf16 v[64:79], v[128:131], v[16:19], 0
  v_exp_f32 v48, v48
  v_exp_f32 v49, v49
  v_exp_f32 v50, v50
  v_exp_f32 v51, v51
  v_mfma_f32_32x32x16_bf16 v[192:207], v[108:111], v[228:231], v[192:207]
  v_exp_f32 v52, v52
  v_exp_f32 v53, v53
  v_exp_f32 v54, v54
  v_smfmac_f32_16x16x64_bf16 v[220:223], v[12:15], v[224:231], v11
  v_exp_f32 v55, v55
  v_mfma_f32_32x32x16_bf16 v[64:79], v[132:135], v[20:23], v[64:79]
  s_waitcnt vmcnt(5)
  v_cvt_pk_bf16_f32 v224, v48, v49
  v_cvt_pk_bf16_f32 v225, v50, v51
  v_cvt_pk_bf16_f32 v226, v52, v53
  v_cvt_pk_bf16_f32 v227, v54, v55
  v_exp_f32 v56, v56
  v_exp_f32 v57, v57
  v_exp_f32 v58, v58
  v_exp_f32 v59, v59
  v_mfma_f32_32x32x16_bf16 v[144:159], v[120:123], v[224:227], v[144:159]
  v_exp_f32 v60, v60
  v_exp_f32 v61, v61
  v_exp_f32 v62, v62
  v_exp_f32 v63, v63
  v_cvt_pk_bf16_f32 v228, v56, v57
  v_cvt_pk_bf16_f32 v229, v58, v59
  v_cvt_pk_bf16_f32 v230, v60, v61
  v_cvt_pk_bf16_f32 v231, v62, v63
  v_mfma_f32_32x32x16_bf16 v[48:63], v[112:115], v[24:27], 0
  v_exp_f32 v64, v64
  v_exp_f32 v65, v65
  v_exp_f32 v66, v66
  v_exp_f32 v67, v67
  v_mfma_f32_32x32x16_bf16 v[144:159], v[124:127], v[228:231], v[144:159]
  v_exp_f32 v68, v68
  v_exp_f32 v69, v69
  v_exp_f32 v70, v70
  v_smfmac_f32_16x16x64_bf16 v[208:211], v[12:15], v[224:231], v11
  v_exp_f32 v71, v71
  v_mfma_f32_32x32x16_bf16 v[48:63], v[116:119], v[28:31], v[48:63]
  v_cvt_pk_bf16_f32 v224, v64, v65
  v_cvt_pk_bf16_f32 v225, v66, v67
  v_cvt_pk_bf16_f32 v226, v68, v69
  v_cvt_pk_bf16_f32 v227, v70, v71
  v_exp_f32 v72, v72
  v_exp_f32 v73, v73
  v_exp_f32 v74, v74
  v_exp_f32 v75, v75
  v_mfma_f32_32x32x16_bf16 v[144:159], v[136:139], v[224:227], v[144:159]
  v_exp_f32 v76, v76
  v_exp_f32 v77, v77
  v_exp_f32 v78, v78
  v_exp_f32 v79, v79
  v_cvt_pk_bf16_f32 v228, v72, v73
  v_cvt_pk_bf16_f32 v229, v74, v75
  v_cvt_pk_bf16_f32 v230, v76, v77
  v_cvt_pk_bf16_f32 v231, v78, v79
  v_mfma_f32_32x32x16_bf16 v[64:79], v[128:131], v[24:27], 0
  v_exp_f32 v48, v48
  v_exp_f32 v49, v49
  v_exp_f32 v50, v50
  v_exp_f32 v51, v51
  v_mfma_f32_32x32x16_bf16 v[144:159], v[140:143], v[228:231], v[144:159]
  v_exp_f32 v52, v52
  v_exp_f32 v53, v53
  v_exp_f32 v54, v54
  v_smfmac_f32_16x16x64_bf16 v[208:211], v[12:15], v[224:231], v11
  v_exp_f32 v55, v55
  v_mfma_f32_32x32x16_bf16 v[64:79], v[132:135], v[28:31], v[64:79]
  v_cvt_pk_bf16_f32 v224, v48, v49
  v_cvt_pk_bf16_f32 v225, v50, v51
  v_cvt_pk_bf16_f32 v226, v52, v53
  v_cvt_pk_bf16_f32 v227, v54, v55
  v_exp_f32 v56, v56
  v_exp_f32 v57, v57
  v_exp_f32 v58, v58
  v_exp_f32 v59, v59
  v_mfma_f32_32x32x16_bf16 v[160:175], v[120:123], v[224:227], v[160:175]
  v_exp_f32 v60, v60
  v_exp_f32 v61, v61
  v_exp_f32 v62, v62
  v_exp_f32 v63, v63
  v_cvt_pk_bf16_f32 v228, v56, v57
  v_cvt_pk_bf16_f32 v229, v58, v59
  v_cvt_pk_bf16_f32 v230, v60, v61
  v_cvt_pk_bf16_f32 v231, v62, v63
  v_cvt_pk_bf16_f32 v144, v144, v145
  v_cvt_pk_bf16_f32 v145, v146, v147
  v_cvt_pk_bf16_f32 v146, v148, v149
  v_cvt_pk_bf16_f32 v147, v150, v151
  ds_write_b128 v9, v[144:147] offset:0
  v_cvt_pk_bf16_f32 v148, v152, v153
  v_cvt_pk_bf16_f32 v149, v154, v155
  v_cvt_pk_bf16_f32 v150, v156, v157
  v_cvt_pk_bf16_f32 v151, v158, v159
  ds_write_b128 v9, v[148:151] offset:1024
  v_add_f32 v208, v208, v210
  v_add_f32 v209, v209, v211
  v_cndmask_b32 v30, v208, v209, s[20:21]
  v_mfma_f32_32x32x16_bf16 v[48:63], v[112:115], v[32:35], 0
  v_exp_f32 v64, v64
  v_exp_f32 v65, v65
  v_exp_f32 v66, v66
  v_exp_f32 v67, v67
  v_mfma_f32_32x32x16_bf16 v[160:175], v[124:127], v[228:231], v[160:175]
  v_exp_f32 v68, v68
  v_exp_f32 v69, v69
  v_exp_f32 v70, v70
  v_smfmac_f32_16x16x64_bf16 v[212:215], v[12:15], v[224:231], v11
  v_exp_f32 v71, v71
  v_mfma_f32_32x32x16_bf16 v[48:63], v[116:119], v[36:39], v[48:63]
  v_cvt_pk_bf16_f32 v224, v64, v65
  v_cvt_pk_bf16_f32 v225, v66, v67
  v_cvt_pk_bf16_f32 v226, v68, v69
  v_cvt_pk_bf16_f32 v227, v70, v71
  v_exp_f32 v72, v72
  v_exp_f32 v73, v73
  v_exp_f32 v74, v74
  v_exp_f32 v75, v75
  v_mfma_f32_32x32x16_bf16 v[160:175], v[136:139], v[224:227], v[160:175]
  v_exp_f32 v76, v76
  v_exp_f32 v77, v77
  v_exp_f32 v78, v78
  v_exp_f32 v79, v79
  v_cvt_pk_bf16_f32 v228, v72, v73
  v_cvt_pk_bf16_f32 v229, v74, v75
  v_cvt_pk_bf16_f32 v230, v76, v77
  v_cvt_pk_bf16_f32 v231, v78, v79
  v_mfma_f32_32x32x16_bf16 v[64:79], v[128:131], v[32:35], 0
  v_exp_f32 v48, v48
  v_exp_f32 v49, v49
  v_exp_f32 v50, v50
  v_exp_f32 v51, v51
  v_mfma_f32_32x32x16_bf16 v[160:175], v[140:143], v[228:231], v[160:175]
  v_exp_f32 v52, v52
  v_exp_f32 v53, v53
  v_exp_f32 v54, v54
  v_smfmac_f32_16x16x64_bf16 v[212:215], v[12:15], v[224:231], v11
  v_exp_f32 v55, v55
  v_mfma_f32_32x32x16_bf16 v[64:79], v[132:135], v[36:39], v[64:79]
  v_cvt_pk_bf16_f32 v224, v48, v49
  v_cvt_pk_bf16_f32 v225, v50, v51
  v_cvt_pk_bf16_f32 v226, v52, v53
  v_cvt_pk_bf16_f32 v227, v54, v55
  v_exp_f32 v56, v56
  v_exp_f32 v57, v57
  v_exp_f32 v58, v58
  v_exp_f32 v59, v59
  v_mfma_f32_32x32x16_bf16 v[176:191], v[120:123], v[224:227], v[176:191]
  v_exp_f32 v60, v60
  v_exp_f32 v61, v61
  v_exp_f32 v62, v62
  v_exp_f32 v63, v63
  v_cvt_pk_bf16_f32 v228, v56, v57
  v_cvt_pk_bf16_f32 v229, v58, v59
  v_cvt_pk_bf16_f32 v230, v60, v61
  v_cvt_pk_bf16_f32 v231, v62, v63
  v_cvt_pk_bf16_f32 v160, v160, v161
  v_cvt_pk_bf16_f32 v161, v162, v163
  v_cvt_pk_bf16_f32 v162, v164, v165
  v_cvt_pk_bf16_f32 v163, v166, v167
  ds_write_b128 v9, v[160:163] offset:2048
  v_cvt_pk_bf16_f32 v164, v168, v169
  v_cvt_pk_bf16_f32 v165, v170, v171
  v_cvt_pk_bf16_f32 v166, v172, v173
  v_cvt_pk_bf16_f32 v167, v174, v175
  ds_write_b128 v9, v[164:167] offset:3072
  v_add_f32 v212, v212, v214
  v_add_f32 v213, v213, v215
  v_cndmask_b32 v31, v212, v213, s[20:21]
  ds_write_b64 v1, v[30:31]
  v_xor_b32 v1, 512, v1
  v_mfma_f32_32x32x16_bf16 v[48:63], v[112:115], v[40:43], 0
  v_exp_f32 v64, v64
  v_exp_f32 v65, v65
  v_exp_f32 v66, v66
  v_exp_f32 v67, v67
  v_mfma_f32_32x32x16_bf16 v[176:191], v[124:127], v[228:231], v[176:191]
  v_exp_f32 v68, v68
  v_exp_f32 v69, v69
  v_exp_f32 v70, v70
  v_smfmac_f32_16x16x64_bf16 v[216:219], v[12:15], v[224:231], v11
  s_waitcnt vmcnt(0) lgkmcnt(0)
  s_barrier
  ds_read_b128 v[80:83], v8 offset:0
  ds_read_b128 v[84:87], v8 offset:1024
  ds_read_b128 v[88:91], v8 offset:2048
  ds_read_b128 v[92:95], v8 offset:3072
  ds_read_b64 v[30:31], v1
  v_exp_f32 v71, v71
  v_mfma_f32_32x32x16_bf16 v[48:63], v[116:119], v[44:47], v[48:63]
  v_cvt_pk_bf16_f32 v224, v64, v65
  v_cvt_pk_bf16_f32 v225, v66, v67
  v_cvt_pk_bf16_f32 v226, v68, v69
  v_cvt_pk_bf16_f32 v227, v70, v71
  v_exp_f32 v72, v72
  v_exp_f32 v73, v73
  v_exp_f32 v74, v74
  v_exp_f32 v75, v75
  v_mfma_f32_32x32x16_bf16 v[176:191], v[136:139], v[224:227], v[176:191]
  v_exp_f32 v76, v76
  v_exp_f32 v77, v77
  s_waitcnt lgkmcnt(0)
  v_mfma_f32_32x32x16_bf16 v[176:191], v[248:251], v[80:83], v[176:191]
  v_exp_f32 v78, v78
  v_exp_f32 v79, v79
  v_mfma_f32_32x32x16_bf16 v[176:191], v[252:255], v[84:87], v[176:191]
  v_cvt_pk_bf16_f32 v228, v72, v73
  v_cvt_pk_bf16_f32 v229, v74, v75
  v_cvt_pk_bf16_f32 v230, v76, v77
  v_cvt_pk_bf16_f32 v231, v78, v79
  v_mfma_f32_32x32x16_bf16 v[64:79], v[128:131], v[40:43], 0
  v_exp_f32 v48, v48
  v_exp_f32 v49, v49
  v_exp_f32 v50, v50
  v_exp_f32 v51, v51
  v_mfma_f32_32x32x16_bf16 v[176:191], v[140:143], v[228:231], v[176:191]
  v_exp_f32 v52, v52
  v_exp_f32 v53, v53
  v_exp_f32 v54, v54
  v_smfmac_f32_16x16x64_bf16 v[216:219], v[12:15], v[224:231], v11
  v_exp_f32 v55, v55
  v_mfma_f32_32x32x16_bf16 v[64:79], v[132:135], v[44:47], v[64:79]
  v_cvt_pk_bf16_f32 v224, v48, v49
  v_cvt_pk_bf16_f32 v225, v50, v51
  v_cvt_pk_bf16_f32 v226, v52, v53
  v_cvt_pk_bf16_f32 v227, v54, v55
  v_exp_f32 v56, v56
  v_exp_f32 v57, v57
  v_exp_f32 v58, v58
  v_exp_f32 v59, v59
  s_nop 1
  v_add_f32 v216, v216, v218
  v_add_f32 v217, v217, v219
  v_cndmask_b32 v24, v216, v217, s[20:21]
  v_add_f32 v24, v24, v30
  s_mov_b64 s[36:37], -1
  v_rcp_f32 v26, v24
  v_cmp_le_f32 vcc, s24, v24
  s_and_b64 s[36:37], s[36:37], vcc
  v_cmp_ge_f32 vcc, s25, v24
  s_and_b64 s[36:37], s[36:37], vcc
  v_pk_mul_f32 v[176:177], v[176:177], v[26:27] op_sel_hi:[1,0]
  v_pk_mul_f32 v[178:179], v[178:179], v[26:27] op_sel_hi:[1,0]
  v_pk_mul_f32 v[180:181], v[180:181], v[26:27] op_sel_hi:[1,0]
  v_pk_mul_f32 v[182:183], v[182:183], v[26:27] op_sel_hi:[1,0]
  v_cvt_pk_bf16_f32 v80, v176, v177
  v_cvt_pk_bf16_f32 v81, v178, v179
  v_cvt_pk_bf16_f32 v82, v180, v181
  v_cvt_pk_bf16_f32 v83, v182, v183
  buffer_store_dwordx4 v[80:83], v3, s[4:7], s8 offen offset:0 sc1
  v_pk_mul_f32 v[184:185], v[184:185], v[26:27] op_sel_hi:[1,0]
  v_pk_mul_f32 v[186:187], v[186:187], v[26:27] op_sel_hi:[1,0]
  v_pk_mul_f32 v[188:189], v[188:189], v[26:27] op_sel_hi:[1,0]
  v_pk_mul_f32 v[190:191], v[190:191], v[26:27] op_sel_hi:[1,0]
  v_cvt_pk_bf16_f32 v84, v184, v185
  v_cvt_pk_bf16_f32 v85, v186, v187
  v_cvt_pk_bf16_f32 v86, v188, v189
  v_cvt_pk_bf16_f32 v87, v190, v191
  buffer_store_dwordx4 v[84:87], v3, s[4:7], s8 offen offset:1024 sc1
  v_mfma_f32_32x32x16_bf16 v[192:207], v[120:123], v[224:227], v[192:207]
  v_exp_f32 v60, v60
  v_exp_f32 v61, v61
  v_exp_f32 v62, v62
  v_exp_f32 v63, v63
  v_cvt_pk_bf16_f32 v228, v56, v57
  v_cvt_pk_bf16_f32 v229, v58, v59
  v_cvt_pk_bf16_f32 v230, v60, v61
  v_cvt_pk_bf16_f32 v231, v62, v63
  v_mfma_f32_32x32x16_bf16 v[192:207], v[248:251], v[88:91], v[192:207]
  v_exp_f32 v64, v64
  v_exp_f32 v65, v65
  v_exp_f32 v66, v66
  v_exp_f32 v67, v67
  v_mfma_f32_32x32x16_bf16 v[192:207], v[124:127], v[228:231], v[192:207]
  v_exp_f32 v68, v68
  v_exp_f32 v69, v69
  v_exp_f32 v70, v70
  v_smfmac_f32_16x16x64_bf16 v[220:223], v[12:15], v[224:231], v11
  v_exp_f32 v71, v71
  v_mfma_f32_32x32x16_bf16 v[192:207], v[252:255], v[92:95], v[192:207]
  v_cvt_pk_bf16_f32 v224, v64, v65
  v_cvt_pk_bf16_f32 v225, v66, v67
  v_cvt_pk_bf16_f32 v226, v68, v69
  v_cvt_pk_bf16_f32 v227, v70, v71
  v_exp_f32 v72, v72
  v_exp_f32 v73, v73
  v_exp_f32 v74, v74
  v_exp_f32 v75, v75
  v_mfma_f32_32x32x16_bf16 v[192:207], v[136:139], v[224:227], v[192:207]
  v_exp_f32 v76, v76
  v_exp_f32 v77, v77
  v_exp_f32 v78, v78
  v_exp_f32 v79, v79
  v_cvt_pk_bf16_f32 v228, v72, v73
  v_cvt_pk_bf16_f32 v229, v74, v75
  v_cvt_pk_bf16_f32 v230, v76, v77
  v_cvt_pk_bf16_f32 v231, v78, v79
  s_nop 1
  v_smfmac_f32_16x16x64_bf16 v[220:223], v[12:15], v[224:231], v11
  v_mfma_f32_32x32x16_bf16 v[192:207], v[140:143], v[228:231], v[192:207]
  s_nop 10
  v_add_f32 v220, v220, v222
  v_add_f32 v221, v221, v223
  v_cndmask_b32 v25, v220, v221, s[20:21]
  v_add_f32 v25, v25, v31
.fz_kernel_a_fin:
  v_rcp_f32 v28, v25
  v_cmp_le_f32 vcc, s24, v25
  s_and_b64 s[36:37], s[36:37], vcc
  v_cmp_ge_f32 vcc, s25, v25
  s_and_b64 s[36:37], s[36:37], vcc
  v_pk_mul_f32 v[192:193], v[192:193], v[28:29] op_sel_hi:[1,0]
  v_pk_mul_f32 v[194:195], v[194:195], v[28:29] op_sel_hi:[1,0]
  v_pk_mul_f32 v[196:197], v[196:197], v[28:29] op_sel_hi:[1,0]
  v_pk_mul_f32 v[198:199], v[198:199], v[28:29] op_sel_hi:[1,0]
  v_cvt_pk_bf16_f32 v88, v192, v193
  v_cvt_pk_bf16_f32 v89, v194, v195
  v_cvt_pk_bf16_f32 v90, v196, v197
  v_cvt_pk_bf16_f32 v91, v198, v199
  buffer_store_dwordx4 v[88:91], v3, s[4:7], s9 offen offset:0 sc1
  v_pk_mul_f32 v[200:201], v[200:201], v[28:29] op_sel_hi:[1,0]
  v_pk_mul_f32 v[202:203], v[202:203], v[28:29] op_sel_hi:[1,0]
  v_pk_mul_f32 v[204:205], v[204:205], v[28:29] op_sel_hi:[1,0]
  v_pk_mul_f32 v[206:207], v[206:207], v[28:29] op_sel_hi:[1,0]
  v_cvt_pk_bf16_f32 v92, v200, v201
  v_cvt_pk_bf16_f32 v93, v202, v203
  v_cvt_pk_bf16_f32 v94, v204, v205
  v_cvt_pk_bf16_f32 v95, v206, v207
  buffer_store_dwordx4 v[92:95], v3, s[4:7], s9 offen offset:1024 sc1
  ds_read_b32 v7, v6 offset:8
  v_pk_fma_f32 v[64:65], v[176:177], 0, 0 op_sel_hi:[1,0,0]
  v_pk_fma_f32 v[66:67], v[178:179], 0, 0 op_sel_hi:[1,0,0]
  v_pk_fma_f32 v[64:65], v[180:181], 0, v[64:65] op_sel_hi:[1,0,1]
  v_pk_fma_f32 v[66:67], v[182:183], 0, v[66:67] op_sel_hi:[1,0,1]
  v_pk_fma_f32 v[64:65], v[184:185], 0, v[64:65] op_sel_hi:[1,0,1]
  v_pk_fma_f32 v[66:67], v[186:187], 0, v[66:67] op_sel_hi:[1,0,1]
  v_pk_fma_f32 v[64:65], v[188:189], 0, v[64:65] op_sel_hi:[1,0,1]
  v_pk_fma_f32 v[66:67], v[190:191], 0, v[66:67] op_sel_hi:[1,0,1]
  v_pk_fma_f32 v[64:65], v[192:193], 0, v[64:65] op_sel_hi:[1,0,1]
  v_pk_fma_f32 v[66:67], v[194:195], 0, v[66:67] op_sel_hi:[1,0,1]
  v_pk_fma_f32 v[64:65], v[196:197], 0, v[64:65] op_sel_hi:[1,0,1]
  v_pk_fma_f32 v[66:67], v[198:199], 0, v[66:67] op_sel_hi:[1,0,1]
  v_pk_fma_f32 v[64:65], v[200:201], 0, v[64:65] op_sel_hi:[1,0,1]
  v_pk_fma_f32 v[66:67], v[202:203], 0, v[66:67] op_sel_hi:[1,0,1]
  v_pk_fma_f32 v[64:65], v[204:205], 0, v[64:65] op_sel_hi:[1,0,1]
  v_pk_fma_f32 v[66:67], v[206:207], 0, v[66:67] op_sel_hi:[1,0,1]
  v_pk_add_f32 v[64:65], v[64:65], v[66:67]
  v_cmp_o_f32 vcc, v64, v65
  s_and_b64 s[36:37], s[36:37], vcc
  s_cmp_eq_u64 s[36:37], -1
  s_cbranch_scc0 .fz_kernel_a_slow
.fz_kernel_a_ok:
  s_mov_b32 s8, s48
  s_mov_b32 s9, s49
  s_mov_b32 s10, 0x800
  s_mov_b32 s11, 0x00020000
  v_lshrrev_b32 v17, 5, v2
  v_lshlrev_b32 v19, 4, v17
  s_lshl_b32 s22, s18, 7
  s_lshl2_add_u32 s32, s17, s16
  s_lshl_b32 s35, s32, 16
  s_add_u32 s35, s35, s64
  v_add_u32 v8, s35, v3
  v_add_u32 v6, 8, v6
  buffer_load_dwordx4 v[48:51], v19, s[8:11], s22 offen offset:0
  buffer_load_dwordx4 v[52:55], v19, s[8:11], s22 offen offset:32
  buffer_load_dwordx4 v[56:59], v19, s[8:11], s22 offen offset:64
  buffer_load_dwordx4 v[60:63], v19, s[8:11], s22 offen offset:96
  s_waitcnt lgkmcnt(0)
  v_readfirstlane_b32 s36, v7
  s_mov_b32 s34, s36
  s_bcnt1_i32_b32 s29, s36
  s_cmp_lt_u32 s29, 2
  s_cbranch_scc1 .fz_kernel_w_e0
  s_cmp_eq_u32 s36, 0
  s_cbranch_scc1 .fz_kernel_pk48c
.fz_kernel_pk48:
  s_ff1_i32_b32 s33, s36
  s_bitset0_b32 s36, s33
  s_lshl_b32 s20, s33, 12
  buffer_load_dwordx4 v[96:99], v8, s[4:7], s20 offen offset:0
  buffer_load_dwordx4 v[100:103], v8, s[4:7], s20 offen offset:1024
  buffer_load_dwordx4 v[104:107], v8, s[4:7], s20 offen offset:2048
  buffer_load_dwordx4 v[108:111], v8, s[4:7], s20 offen offset:3072
  s_cmp_eq_u32 s36, 0
  s_cbranch_scc1 .fz_kernel_pk49c
.fz_kernel_pk49:
  s_ff1_i32_b32 s33, s36
  s_bitset0_b32 s36, s33
  s_lshl_b32 s21, s33, 12
  buffer_load_dwordx4 v[112:115], v8, s[4:7], s21 offen offset:0
  buffer_load_dwordx4 v[116:119], v8, s[4:7], s21 offen offset:1024
  buffer_load_dwordx4 v[120:123], v8, s[4:7], s21 offen offset:2048
  buffer_load_dwordx4 v[124:127], v8, s[4:7], s21 offen offset:3072
.fz_kernel_w_e0:
  v_and_b32 v18, 31, v2
  s_lshl_b32 s39, s17, 4
  s_add_u32 s39, s39, s18
  s_lshl_b32 s39, s39, 2
  s_add_u32 s39, s39, s16
  s_lshl_b32 s39, s39, 12
  v_and_b32 v16, 16, v2
  v_lshlrev_b32 v16, 7, v16
  v_lshl_add_u32 v16, v17, 8, v16
  v_and_b32 v1, 0xf0, v3
  v_add_u32 v16, v16, v1
  s_add_u32 s39, s39, s65
  s_lshl_b32 s31, s16, 5
  v_add_u32 v45, s31, v18
  v_lshlrev_b32 v11, 2, v45
  v_add_u32 v11, 155648, v11
  v_mov_b32 v44, 159952
  ds_read_b32 v40, v11 offset:6400
  ds_read_b32 v42, v11 offset:6912
  ds_read_b32 v46, v44 offset:8
  ds_read_b32 v44, v44
  v_mov_b32 v47, 0.32768
  v_add_u32 v45, 1, v45
  v_bfe_u32 v11, v2, 2, 2
  v_lshl_add_u32 v12, v17, 2, v11
  v_lshlrev_b32 v12, 7, v12
  v_lshrrev_b32 v13, 1, v11
  v_lshl_add_u32 v12, v13, 6, v12
  v_bfe_u32 v13, v2, 4, 1
  v_lshl_add_u32 v12, v13, 5, v12
  v_and_b32 v13, 1, v2
  v_lshl_add_u32 v12, v13, 4, v12
  v_bfe_u32 v13, v2, 1, 1
  v_lshl_add_u32 v14, v13, 3, v12
  v_xor_b32 v15, 64, v14
  s_mov_b64 exec, 1
  s_cmp_lt_u32 s29, 2
  s_cbranch_scc1 .fz_kernel_w_e1
  s_waitcnt vmcnt(12)
  s_branch .fz_kernel_w_e3
.fz_kernel_w_e1:
  s_waitcnt vmcnt(4)
.fz_kernel_w_e3:
  ds_add_u32 v6, v5 offset:0x100
  s_mov_b64 exec, -1
  v_lshlrev_b32 v64, 16, v232
  v_and_b32 v65, 0xffff0000, v232
  v_lshlrev_b32 v66, 16, v233
  v_and_b32 v67, 0xffff0000, v233
  v_lshlrev_b32 v68, 16, v234
  v_and_b32 v69, 0xffff0000, v234
  v_lshlrev_b32 v70, 16, v235
  v_and_b32 v71, 0xffff0000, v235
  v_lshlrev_b32 v72, 16, v236
  v_and_b32 v73, 0xffff0000, v236
  v_lshlrev_b32 v74, 16, v237
  v_and_b32 v75, 0xffff0000, v237
  v_lshlrev_b32 v76, 16, v238
  v_and_b32 v77, 0xffff0000, v238
  v_lshlrev_b32 v78, 16, v239
  v_and_b32 v79, 0xffff0000, v239
  v_lshlrev_b32 v80, 16, v240
  v_and_b32 v81, 0xffff0000, v240
  v_lshlrev_b32 v82, 16, v241
  v_and_b32 v83, 0xffff0000, v241
  v_lshlrev_b32 v84, 16, v242
  v_and_b32 v85, 0xffff0000, v242
  v_lshlrev_b32 v86, 16, v243
  v_and_b32 v87, 0xffff0000, v243
  v_lshlrev_b32 v88, 16, v244
  v_and_b32 v89, 0xffff0000, v244
  v_lshlrev_b32 v90, 16, v245
  v_and_b32 v91, 0xffff0000, v245
  v_lshlrev_b32 v92, 16, v246
  v_and_b32 v93, 0xffff0000, v246
  v_lshlrev_b32 v94, 16, v247
  v_and_b32 v95, 0xffff0000, v247
  s_waitcnt lgkmcnt(0)
  v_pk_fma_f32 v[64:65], v[64:65], v[40:41], v[42:43] op_sel_hi:[1,0,0]
  v_pk_fma_f32 v[66:67], v[66:67], v[40:41], v[42:43] op_sel_hi:[1,0,0]
  v_pk_fma_f32 v[68:69], v[68:69], v[40:41], v[42:43] op_sel_hi:[1,0,0]
  v_pk_fma_f32 v[70:71], v[70:71], v[40:41], v[42:43] op_sel_hi:[1,0,0]
  v_pk_fma_f32 v[72:73], v[72:73], v[40:41], v[42:43] op_sel_hi:[1,0,0]
  v_pk_fma_f32 v[74:75], v[74:75], v[40:41], v[42:43] op_sel_hi:[1,0,0]
  v_pk_fma_f32 v[76:77], v[76:77], v[40:41], v[42:43] op_sel_hi:[1,0,0]
  v_pk_fma_f32 v[78:79], v[78:79], v[40:41], v[42:43] op_sel_hi:[1,0,0]
  v_pk_fma_f32 v[80:81], v[80:81], v[40:41], v[42:43] op_sel_hi:[1,0,0]
  v_pk_fma_f32 v[82:83], v[82:83], v[40:41], v[42:43] op_sel_hi:[1,0,0]
  v_pk_fma_f32 v[84:85], v[84:85], v[40:41], v[42:43] op_sel_hi:[1,0,0]
  v_pk_fma_f32 v[86:87], v[86:87], v[40:41], v[42:43] op_sel_hi:[1,0,0]
  v_pk_fma_f32 v[88:89], v[88:89], v[40:41], v[42:43] op_sel_hi:[1,0,0]
  v_pk_fma_f32 v[90:91], v[90:91], v[40:41], v[42:43] op_sel_hi:[1,0,0]
  v_pk_fma_f32 v[92:93], v[92:93], v[40:41], v[42:43] op_sel_hi:[1,0,0]
  v_pk_fma_f32 v[94:95], v[94:95], v[40:41], v[42:43] op_sel_hi:[1,0,0]
  v_cmp_eq_u32 vcc, v44, v45
  s_cbranch_vccnz .fz_kernel_w_pt
.fz_kernel_w_pb:
  s_cmp_ge_u32 s29, 2
  s_cbranch_scc1 .fz_kernel_w_e2
  s_cmp_eq_u32 s36, 0
  s_cbranch_scc1 .fz_kernel_pk50c
.fz_kernel_pk50:
  s_ff1_i32_b32 s33, s36
  s_bitset0_b32 s36, s33
  s_lshl_b32 s20, s33, 12
  buffer_load_dwordx4 v[96:99], v8, s[4:7], s20 offen offset:0
  buffer_load_dwordx4 v[100:103], v8, s[4:7], s20 offen offset:1024
  buffer_load_dwordx4 v[104:107], v8, s[4:7], s20 offen offset:2048
  buffer_load_dwordx4 v[108:111], v8, s[4:7], s20 offen offset:3072
  s_cmp_eq_u32 s36, 0
  s_cbranch_scc1 .fz_kernel_pk51c
.fz_kernel_pk51:
  s_ff1_i32_b32 s33, s36
  s_bitset0_b32 s36, s33
  s_lshl_b32 s21, s33, 12
  buffer_load_dwordx4 v[112:115], v8, s[4:7], s21 offen offset:0
  buffer_load_dwordx4 v[116:119], v8, s[4:7], s21 offen offset:1024
  buffer_load_dwordx4 v[120:123], v8, s[4:7], s21 offen offset:2048
  buffer_load_dwordx4 v[124:127], v8, s[4:7], s21 offen offset:3072
.fz_kernel_w_e2:
  s_cmp_eq_u32 s36, 0
  s_cbranch_scc1 .fz_kernel_pk52c
.fz_kernel_pk52:
  s_ff1_i32_b32 s33, s36
  s_bitset0_b32 s36, s33
  s_lshl_b32 s22, s33, 12
  buffer_load_dwordx4 v[128:131], v8, s[4:7], s22 offen offset:0
  buffer_load_dwordx4 v[132:135], v8, s[4:7], s22 offen offset:1024
  buffer_load_dwordx4 v[136:139], v8, s[4:7], s22 offen offset:2048
  buffer_load_dwordx4 v[140:143], v8, s[4:7], s22 offen offset:3072
  v_lshl_add_u32 v10, s20, 1, v14
  v_lshl_add_u32 v11, s20, 1, v15
  ds_read_b64_tr_b16 v[224:225], v10 offset:0
  ds_read_b64_tr_b16 v[226:227], v10 offset:1024
  ds_read_b64_tr_b16 v[228:229], v11 offset:0
  ds_read_b64_tr_b16 v[230:231], v11 offset:1024
  ds_read_b64_tr_b16 v[232:233], v10 offset:2048
  ds_read_b64_tr_b16 v[234:235], v10 offset:3072
  ds_read_b64_tr_b16 v[236:237], v11 offset:2048
  ds_read_b64_tr_b16 v[238:239], v11 offset:3072
  ds_read_b64_tr_b16 v[240:241], v10 offset:4096
  ds_read_b64_tr_b16 v[242:243], v10 offset:5120
  ds_read_b64_tr_b16 v[244:245], v11 offset:4096
  ds_read_b64_tr_b16 v[246:247], v11 offset:5120
  s_cmp_eq_u32 s36, 0
  s_cbranch_scc1 .fz_kernel_pk53c
.fz_kernel_pk53:
  s_ff1_i32_b32 s33, s36
  s_bitset0_b32 s36, s33
  s_lshl_b32 s23, s33, 12
  s_waitcnt vmcnt(11) lgkmcnt(8)
  v_mfma_f32_32x32x16_bf16 v[64:79], v[224:227], v[96:99], v[64:79]
  buffer_load_dwordx4 v[144:147], v8, s[4:7], s23 offen offset:0
  ds_read_b64_tr_b16 v[248:249], v10 offset:6144
  ds_read_b64_tr_b16 v[250:251], v10 offset:7168
  v_mfma_f32_32x32x16_bf16 v[80:95], v[228:231], v[96:99], v[80:95]
  ds_read_b64_tr_b16 v[252:253], v11 offset:6144
  ds_read_b64_tr_b16 v[254:255], v11 offset:7168
  v_lshl_add_u32 v12, s21, 1, v14
  v_lshl_add_u32 v13, s21, 1, v15
  s_waitcnt vmcnt(11) lgkmcnt(8)
  v_mfma_f32_32x32x16_bf16 v[64:79], v[232:235], v[100:103], v[64:79]
  buffer_load_dwordx4 v[148:151], v8, s[4:7], s23 offen offset:1024
  ds_read_b64_tr_b16 v[224:225], v12 offset:0
  ds_read_b64_tr_b16 v[226:227], v12 offset:1024
  v_mfma_f32_32x32x16_bf16 v[80:95], v[236:239], v[100:103], v[80:95]
  ds_read_b64_tr_b16 v[228:229], v13 offset:0
  ds_read_b64_tr_b16 v[230:231], v13 offset:1024
  s_waitcnt vmcnt(11) lgkmcnt(8)
  v_mfma_f32_32x32x16_bf16 v[64:79], v[240:243], v[104:107], v[64:79]
  buffer_load_dwordx4 v[152:155], v8, s[4:7], s23 offen offset:2048
  ds_read_b64_tr_b16 v[232:233], v12 offset:2048
  ds_read_b64_tr_b16 v[234:235], v12 offset:3072
  v_mfma_f32_32x32x16_bf16 v[80:95], v[244:247], v[104:107], v[80:95]
  ds_read_b64_tr_b16 v[236:237], v13 offset:2048
  ds_read_b64_tr_b16 v[238:239], v13 offset:3072
  s_cmp_eq_u32 s36, 0
  s_cbranch_scc1 .fz_kernel_pk54c
.fz_kernel_pk54:
  s_ff1_i32_b32 s33, s36
  s_waitcnt vmcnt(11) lgkmcnt(8)
  v_mfma_f32_32x32x16_bf16 v[64:79], v[248:251], v[108:111], v[64:79]
  buffer_load_dwordx4 v[156:159], v8, s[4:7], s23 offen offset:3072
  ds_read_b64_tr_b16 v[240:241], v12 offset:4096
  ds_read_b64_tr_b16 v[242:243], v12 offset:5120
  v_mfma_f32_32x32x16_bf16 v[80:95], v[252:255], v[108:111], v[80:95]
  ds_read_b64_tr_b16 v[244:245], v13 offset:4096
  ds_read_b64_tr_b16 v[246:247], v13 offset:5120
  s_bitset0_b32 s36, s33
  s_lshl_b32 s24, s33, 12
  s_waitcnt vmcnt(11) lgkmcnt(8)
  v_mfma_f32_32x32x16_bf16 v[64:79], v[224:227], v[112:115], v[64:79]
  buffer_load_dwordx4 v[160:163], v8, s[4:7], s24 offen offset:0
  ds_read_b64_tr_b16 v[248:249], v12 offset:6144
  ds_read_b64_tr_b16 v[250:251], v12 offset:7168
  v_mfma_f32_32x32x16_bf16 v[80:95], v[228:231], v[112:115], v[80:95]
  ds_read_b64_tr_b16 v[252:253], v13 offset:6144
  ds_read_b64_tr_b16 v[254:255], v13 offset:7168
  v_lshl_add_u32 v10, s22, 1, v14
  v_lshl_add_u32 v11, s22, 1, v15
  s_waitcnt vmcnt(11) lgkmcnt(8)
  v_mfma_f32_32x32x16_bf16 v[64:79], v[232:235], v[116:119], v[64:79]
  buffer_load_dwordx4 v[164:167], v8, s[4:7], s24 offen offset:1024
  ds_read_b64_tr_b16 v[224:225], v10 offset:0
  ds_read_b64_tr_b16 v[226:227], v10 offset:1024
  v_mfma_f32_32x32x16_bf16 v[80:95], v[236:239], v[116:119], v[80:95]
  ds_read_b64_tr_b16 v[228:229], v11 offset:0
  ds_read_b64_tr_b16 v[230:231], v11 offset:1024
  s_waitcnt vmcnt(11) lgkmcnt(8)
  v_mfma_f32_32x32x16_bf16 v[64:79], v[240:243], v[120:123], v[64:79]
  buffer_load_dwordx4 v[168:171], v8, s[4:7], s24 offen offset:2048
  ds_read_b64_tr_b16 v[232:233], v10 offset:2048
  ds_read_b64_tr_b16 v[234:235], v10 offset:3072
  v_mfma_f32_32x32x16_bf16 v[80:95], v[244:247], v[120:123], v[80:95]
  ds_read_b64_tr_b16 v[236:237], v11 offset:2048
  ds_read_b64_tr_b16 v[238:239], v11 offset:3072
  s_cmp_eq_u32 s36, 0
  s_cbranch_scc1 .fz_kernel_pk55c
.fz_kernel_pk55:
  s_ff1_i32_b32 s33, s36
  s_waitcnt vmcnt(11) lgkmcnt(8)
  v_mfma_f32_32x32x16_bf16 v[64:79], v[248:251], v[124:127], v[64:79]
  buffer_load_dwordx4 v[172:175], v8, s[4:7], s24 offen offset:3072
  ds_read_b64_tr_b16 v[240:241], v10 offset:4096
  ds_read_b64_tr_b16 v[242:243], v10 offset:5120
  v_mfma_f32_32x32x16_bf16 v[80:95], v[252:255], v[124:127], v[80:95]
  ds_read_b64_tr_b16 v[244:245], v11 offset:4096
  ds_read_b64_tr_b16 v[246:247], v11 offset:5120
  s_bitset0_b32 s36, s33
  s_lshl_b32 s25, s33, 12
  s_waitcnt vmcnt(11) lgkmcnt(8)
  v_mfma_f32_32x32x16_bf16 v[64:79], v[224:227], v[128:131], v[64:79]
  buffer_load_dwordx4 v[176:179], v8, s[4:7], s25 offen offset:0
  ds_read_b64_tr_b16 v[248:249], v10 offset:6144
  ds_read_b64_tr_b16 v[250:251], v10 offset:7168
  v_mfma_f32_32x32x16_bf16 v[80:95], v[228:231], v[128:131], v[80:95]
  ds_read_b64_tr_b16 v[252:253], v11 offset:6144
  ds_read_b64_tr_b16 v[254:255], v11 offset:7168
  v_lshl_add_u32 v12, s23, 1, v14
  v_lshl_add_u32 v13, s23, 1, v15
  s_waitcnt vmcnt(11) lgkmcnt(8)
  v_mfma_f32_32x32x16_bf16 v[64:79], v[232:235], v[132:135], v[64:79]
  buffer_load_dwordx4 v[180:183], v8, s[4:7], s25 offen offset:1024
  ds_read_b64_tr_b16 v[224:225], v12 offset:0
  ds_read_b64_tr_b16 v[226:227], v12 offset:1024
  v_mfma_f32_32x32x16_bf16 v[80:95], v[236:239], v[132:135], v[80:95]
  ds_read_b64_tr_b16 v[228:229], v13 offset:0
  ds_read_b64_tr_b16 v[230:231], v13 offset:1024
  s_waitcnt vmcnt(11) lgkmcnt(8)
  v_mfma_f32_32x32x16_bf16 v[64:79], v[240:243], v[136:139], v[64:79]
  buffer_load_dwordx4 v[184:187], v8, s[4:7], s25 offen offset:2048
  ds_read_b64_tr_b16 v[232:233], v12 offset:2048
  ds_read_b64_tr_b16 v[234:235], v12 offset:3072
  v_mfma_f32_32x32x16_bf16 v[80:95], v[244:247], v[136:139], v[80:95]
  ds_read_b64_tr_b16 v[236:237], v13 offset:2048
  ds_read_b64_tr_b16 v[238:239], v13 offset:3072
  s_cmp_eq_u32 s36, 0
  s_cbranch_scc1 .fz_kernel_pk56c
.fz_kernel_pk56:
  s_ff1_i32_b32 s33, s36
  s_waitcnt vmcnt(11) lgkmcnt(8)
  v_mfma_f32_32x32x16_bf16 v[64:79], v[248:251], v[140:143], v[64:79]
  buffer_load_dwordx4 v[188:191], v8, s[4:7], s25 offen offset:3072
  ds_read_b64_tr_b16 v[240:241], v12 offset:4096
  ds_read_b64_tr_b16 v[242:243], v12 offset:5120
  v_mfma_f32_32x32x16_bf16 v[80:95], v[252:255], v[140:143], v[80:95]
  ds_read_b64_tr_b16 v[244:245], v13 offset:4096
  ds_read_b64_tr_b16 v[246:247], v13 offset:5120
  s_bitset0_b32 s36, s33
  s_lshl_b32 s26, s33, 12
  s_waitcnt vmcnt(11) lgkmcnt(8)
  v_mfma_f32_32x32x16_bf16 v[64:79], v[224:227], v[144:147], v[64:79]
  buffer_load_dwordx4 v[192:195], v8, s[4:7], s26 offen offset:0
  ds_read_b64_tr_b16 v[248:249], v12 offset:6144
  ds_read_b64_tr_b16 v[250:251], v12 offset:7168
  v_mfma_f32_32x32x16_bf16 v[80:95], v[228:231], v[144:147], v[80:95]
  ds_read_b64_tr_b16 v[252:253], v13 offset:6144
  ds_read_b64_tr_b16 v[254:255], v13 offset:7168
  v_lshl_add_u32 v10, s24, 1, v14
  v_lshl_add_u32 v11, s24, 1, v15
  s_waitcnt vmcnt(11) lgkmcnt(8)
  v_mfma_f32_32x32x16_bf16 v[64:79], v[232:235], v[148:151], v[64:79]
  buffer_load_dwordx4 v[196:199], v8, s[4:7], s26 offen offset:1024
  ds_read_b64_tr_b16 v[224:225], v10 offset:0
  ds_read_b64_tr_b16 v[226:227], v10 offset:1024
  v_mfma_f32_32x32x16_bf16 v[80:95], v[236:239], v[148:151], v[80:95]
  ds_read_b64_tr_b16 v[228:229], v11 offset:0
  ds_read_b64_tr_b16 v[230:231], v11 offset:1024
  s_waitcnt vmcnt(11) lgkmcnt(8)
  v_mfma_f32_32x32x16_bf16 v[64:79], v[240:243], v[152:155], v[64:79]
  buffer_load_dwordx4 v[200:203], v8, s[4:7], s26 offen offset:2048
  ds_read_b64_tr_b16 v[232:233], v10 offset:2048
  ds_read_b64_tr_b16 v[234:235], v10 offset:3072
  v_mfma_f32_32x32x16_bf16 v[80:95], v[244:247], v[152:155], v[80:95]
  ds_read_b64_tr_b16 v[236:237], v11 offset:2048
  ds_read_b64_tr_b16 v[238:239], v11 offset:3072
  s_cmp_eq_u32 s36, 0
  s_cbranch_scc1 .fz_kernel_pk57c
.fz_kernel_pk57:
  s_ff1_i32_b32 s33, s36
  s_waitcnt vmcnt(11) lgkmcnt(8)
  v_mfma_f32_32x32x16_bf16 v[64:79], v[248:251], v[156:159], v[64:79]
  buffer_load_dwordx4 v[204:207], v8, s[4:7], s26 offen offset:3072
  ds_read_b64_tr_b16 v[240:241], v10 offset:4096
  ds_read_b64_tr_b16 v[242:243], v10 offset:5120
  v_mfma_f32_32x32x16_bf16 v[80:95], v[252:255], v[156:159], v[80:95]
  ds_read_b64_tr_b16 v[244:245], v11 offset:4096
  ds_read_b64_tr_b16 v[246:247], v11 offset:5120
  s_bitset0_b32 s36, s33
  s_lshl_b32 s27, s33, 12
  s_waitcnt vmcnt(11) lgkmcnt(8)
  v_mfma_f32_32x32x16_bf16 v[64:79], v[224:227], v[160:163], v[64:79]
  buffer_load_dwordx4 v[208:211], v8, s[4:7], s27 offen offset:0
  ds_read_b64_tr_b16 v[248:249], v10 offset:6144
  ds_read_b64_tr_b16 v[250:251], v10 offset:7168
  v_mfma_f32_32x32x16_bf16 v[80:95], v[228:231], v[160:163], v[80:95]
  ds_read_b64_tr_b16 v[252:253], v11 offset:6144
  ds_read_b64_tr_b16 v[254:255], v11 offset:7168
  v_lshl_add_u32 v12, s25, 1, v14
  v_lshl_add_u32 v13, s25, 1, v15
  s_waitcnt vmcnt(11) lgkmcnt(8)
  v_mfma_f32_32x32x16_bf16 v[64:79], v[232:235], v[164:167], v[64:79]
  buffer_load_dwordx4 v[212:215], v8, s[4:7], s27 offen offset:1024
  ds_read_b64_tr_b16 v[224:225], v12 offset:0
  ds_read_b64_tr_b16 v[226:227], v12 offset:1024
  v_mfma_f32_32x32x16_bf16 v[80:95], v[236:239], v[164:167], v[80:95]
  ds_read_b64_tr_b16 v[228:229], v13 offset:0
  ds_read_b64_tr_b16 v[230:231], v13 offset:1024
  s_waitcnt vmcnt(11) lgkmcnt(8)
  v_mfma_f32_32x32x16_bf16 v[64:79], v[240:243], v[168:171], v[64:79]
  buffer_load_dwordx4 v[216:219], v8, s[4:7], s27 offen offset:2048
  ds_read_b64_tr_b16 v[232:233], v12 offset:2048
  ds_read_b64_tr_b16 v[234:235], v12 offset:3072
  v_mfma_f32_32x32x16_bf16 v[80:95], v[244:247], v[168:171], v[80:95]
  ds_read_b64_tr_b16 v[236:237], v13 offset:2048
  ds_read_b64_tr_b16 v[238:239], v13 offset:3072
  s_cmp_eq_u32 s36, 0
  s_cbranch_scc1 .fz_kernel_pk58c
.fz_kernel_pk58:
  s_ff1_i32_b32 s33, s36
  s_waitcnt vmcnt(11) lgkmcnt(8)
  v_mfma_f32_32x32x16_bf16 v[64:79], v[248:251], v[172:175], v[64:79]
  buffer_load_dwordx4 v[220:223], v8, s[4:7], s27 offen offset:3072
  ds_read_b64_tr_b16 v[240:241], v12 offset:4096
  ds_read_b64_tr_b16 v[242:243], v12 offset:5120
  v_mfma_f32_32x32x16_bf16 v[80:95], v[252:255], v[172:175], v[80:95]
  ds_read_b64_tr_b16 v[244:245], v13 offset:4096
  ds_read_b64_tr_b16 v[246:247], v13 offset:5120
  s_bitset0_b32 s36, s33
  s_lshl_b32 s20, s33, 12
  s_waitcnt vmcnt(11) lgkmcnt(8)
  v_mfma_f32_32x32x16_bf16 v[64:79], v[224:227], v[176:179], v[64:79]
  buffer_load_dwordx4 v[96:99], v8, s[4:7], s20 offen offset:0
  ds_read_b64_tr_b16 v[248:249], v12 offset:6144
  ds_read_b64_tr_b16 v[250:251], v12 offset:7168
  v_mfma_f32_32x32x16_bf16 v[80:95], v[228:231], v[176:179], v[80:95]
  ds_read_b64_tr_b16 v[252:253], v13 offset:6144
  ds_read_b64_tr_b16 v[254:255], v13 offset:7168
  v_lshl_add_u32 v10, s26, 1, v14
  v_lshl_add_u32 v11, s26, 1, v15
  s_waitcnt vmcnt(11) lgkmcnt(8)
  v_mfma_f32_32x32x16_bf16 v[64:79], v[232:235], v[180:183], v[64:79]
  buffer_load_dwordx4 v[100:103], v8, s[4:7], s20 offen offset:1024
  ds_read_b64_tr_b16 v[224:225], v10 offset:0
  ds_read_b64_tr_b16 v[226:227], v10 offset:1024
  v_mfma_f32_32x32x16_bf16 v[80:95], v[236:239], v[180:183], v[80:95]
  ds_read_b64_tr_b16 v[228:229], v11 offset:0
  ds_read_b64_tr_b16 v[230:231], v11 offset:1024
  s_waitcnt vmcnt(11) lgkmcnt(8)
  v_mfma_f32_32x32x16_bf16 v[64:79], v[240:243], v[184:187], v[64:79]
  buffer_load_dwordx4 v[104:107], v8, s[4:7], s20 offen offset:2048
  ds_read_b64_tr_b16 v[232:233], v10 offset:2048
  ds_read_b64_tr_b16 v[234:235], v10 offset:3072
  v_mfma_f32_32x32x16_bf16 v[80:95], v[244:247], v[184:187], v[80:95]
  ds_read_b64_tr_b16 v[236:237], v11 offset:2048
  ds_read_b64_tr_b16 v[238:239], v11 offset:3072
  s_cmp_eq_u32 s36, 0
  s_cbranch_scc1 .fz_kernel_pk59c
.fz_kernel_pk59:
  s_ff1_i32_b32 s33, s36
  s_waitcnt vmcnt(11) lgkmcnt(8)
  v_mfma_f32_32x32x16_bf16 v[64:79], v[248:251], v[188:191], v[64:79]
  buffer_load_dwordx4 v[108:111], v8, s[4:7], s20 offen offset:3072
  ds_read_b64_tr_b16 v[240:241], v10 offset:4096
  ds_read_b64_tr_b16 v[242:243], v10 offset:5120
  v_mfma_f32_32x32x16_bf16 v[80:95], v[252:255], v[188:191], v[80:95]
  ds_read_b64_tr_b16 v[244:245], v11 offset:4096
  ds_read_b64_tr_b16 v[246:247], v11 offset:5120
  s_bitset0_b32 s36, s33
  s_lshl_b32 s21, s33, 12
  s_waitcnt vmcnt(11) lgkmcnt(8)
  v_mfma_f32_32x32x16_bf16 v[64:79], v[224:227], v[192:195], v[64:79]
  buffer_load_dwordx4 v[112:115], v8, s[4:7], s21 offen offset:0
  ds_read_b64_tr_b16 v[248:249], v10 offset:6144
  ds_read_b64_tr_b16 v[250:251], v10 offset:7168
  v_mfma_f32_32x32x16_bf16 v[80:95], v[228:231], v[192:195], v[80:95]
  ds_read_b64_tr_b16 v[252:253], v11 offset:6144
  ds_read_b64_tr_b16 v[254:255], v11 offset:7168
  v_lshl_add_u32 v12, s27, 1, v14
  v_lshl_add_u32 v13, s27, 1, v15
  s_waitcnt vmcnt(11) lgkmcnt(8)
  v_mfma_f32_32x32x16_bf16 v[64:79], v[232:235], v[196:199], v[64:79]
  buffer_load_dwordx4 v[116:119], v8, s[4:7], s21 offen offset:1024
  ds_read_b64_tr_b16 v[224:225], v12 offset:0
  ds_read_b64_tr_b16 v[226:227], v12 offset:1024
  v_mfma_f32_32x32x16_bf16 v[80:95], v[236:239], v[196:199], v[80:95]
  ds_read_b64_tr_b16 v[228:229], v13 offset:0
  ds_read_b64_tr_b16 v[230:231], v13 offset:1024
  s_waitcnt vmcnt(11) lgkmcnt(8)
  v_mfma_f32_32x32x16_bf16 v[64:79], v[240:243], v[200:203], v[64:79]
  buffer_load_dwordx4 v[120:123], v8, s[4:7], s21 offen offset:2048
  ds_read_b64_tr_b16 v[232:233], v12 offset:2048
  ds_read_b64_tr_b16 v[234:235], v12 offset:3072
  v_mfma_f32_32x32x16_bf16 v[80:95], v[244:247], v[200:203], v[80:95]
  ds_read_b64_tr_b16 v[236:237], v13 offset:2048
  ds_read_b64_tr_b16 v[238:239], v13 offset:3072
  s_cmp_eq_u32 s36, 0
  s_cbranch_scc1 .fz_kernel_pk60c
.fz_kernel_pk60:
  s_ff1_i32_b32 s33, s36
  s_waitcnt vmcnt(11) lgkmcnt(8)
  v_mfma_f32_32x32x16_bf16 v[64:79], v[248:251], v[204:207], v[64:79]
  buffer_load_dwordx4 v[124:127], v8, s[4:7], s21 offen offset:3072
  ds_read_b64_tr_b16 v[240:241], v12 offset:4096
  ds_read_b64_tr_b16 v[242:243], v12 offset:5120
  v_mfma_f32_32x32x16_bf16 v[80:95], v[252:255], v[204:207], v[80:95]
  ds_read_b64_tr_b16 v[244:245], v13 offset:4096
  ds_read_b64_tr_b16 v[246:247], v13 offset:5120
  s_bitset0_b32 s36, s33
  s_lshl_b32 s22, s33, 12
  s_waitcnt vmcnt(11) lgkmcnt(8)
  v_mfma_f32_32x32x16_bf16 v[64:79], v[224:227], v[208:211], v[64:79]
  buffer_load_dwordx4 v[128:131], v8, s[4:7], s22 offen offset:0
  ds_read_b64_tr_b16 v[248:249], v12 offset:6144
  ds_read_b64_tr_b16 v[250:251], v12 offset:7168
  v_mfma_f32_32x32x16_bf16 v[80:95], v[228:231], v[208:211], v[80:95]
  ds_read_b64_tr_b16 v[252:253], v13 offset:6144
  ds_read_b64_tr_b16 v[254:255], v13 offset:7168
  v_lshl_add_u32 v10, s20, 1, v14
  v_lshl_add_u32 v11, s20, 1, v15
  s_waitcnt vmcnt(11) lgkmcnt(8)
  v_mfma_f32_32x32x16_bf16 v[64:79], v[232:235], v[212:215], v[64:79]
  buffer_load_dwordx4 v[132:135], v8, s[4:7], s22 offen offset:1024
  ds_read_b64_tr_b16 v[224:225], v10 offset:0
  ds_read_b64_tr_b16 v[226:227], v10 offset:1024
  v_mfma_f32_32x32x16_bf16 v[80:95], v[236:239], v[212:215], v[80:95]
  ds_read_b64_tr_b16 v[228:229], v11 offset:0
  ds_read_b64_tr_b16 v[230:231], v11 offset:1024
  s_waitcnt vmcnt(11) lgkmcnt(8)
  v_mfma_f32_32x32x16_bf16 v[64:79], v[240:243], v[216:219], v[64:79]
  buffer_load_dwordx4 v[136:139], v8, s[4:7], s22 offen offset:2048
  ds_read_b64_tr_b16 v[232:233], v10 offset:2048
  ds_read_b64_tr_b16 v[234:235], v10 offset:3072
  v_mfma_f32_32x32x16_bf16 v[80:95], v[244:247], v[216:219], v[80:95]
  ds_read_b64_tr_b16 v[236:237], v11 offset:2048
  ds_read_b64_tr_b16 v[238:239], v11 offset:3072
  s_cmp_eq_u32 s36, 0
  s_cbranch_scc1 .fz_kernel_pk61c
.fz_kernel_pk61:
  s_ff1_i32_b32 s33, s36
  s_waitcnt vmcnt(11) lgkmcnt(8)
  v_mfma_f32_32x32x16_bf16 v[64:79], v[248:251], v[220:223], v[64:79]
  buffer_load_dwordx4 v[140:143], v8, s[4:7], s22 offen offset:3072
  ds_read_b64_tr_b16 v[240:241], v10 offset:4096
  ds_read_b64_tr_b16 v[242:243], v10 offset:5120
  v_mfma_f32_32x32x16_bf16 v[80:95], v[252:255], v[220:223], v[80:95]
  ds_read_b64_tr_b16 v[244:245], v11 offset:4096
  ds_read_b64_tr_b16 v[246:247], v11 offset:5120
  s_bitset0_b32 s36, s33
  s_lshl_b32 s23, s33, 12
  s_waitcnt vmcnt(11) lgkmcnt(8)
  v_mfma_f32_32x32x16_bf16 v[64:79], v[224:227], v[96:99], v[64:79]
  buffer_load_dwordx4 v[144:147], v8, s[4:7], s23 offen offset:0
  ds_read_b64_tr_b16 v[248:249], v10 offset:6144
  ds_read_b64_tr_b16 v[250:251], v10 offset:7168
  v_mfma_f32_32x32x16_bf16 v[80:95], v[228:231], v[96:99], v[80:95]
  ds_read_b64_tr_b16 v[252:253], v11 offset:6144
  ds_read_b64_tr_b16 v[254:255], v11 offset:7168
  v_lshl_add_u32 v12, s21, 1, v14
  v_lshl_add_u32 v13, s21, 1, v15
  s_waitcnt vmcnt(11) lgkmcnt(8)
  v_mfma_f32_32x32x16_bf16 v[64:79], v[232:235], v[100:103], v[64:79]
  buffer_load_dwordx4 v[148:151], v8, s[4:7], s23 offen offset:1024
  ds_read_b64_tr_b16 v[224:225], v12 offset:0
  ds_read_b64_tr_b16 v[226:227], v12 offset:1024
  v_mfma_f32_32x32x16_bf16 v[80:95], v[236:239], v[100:103], v[80:95]
  ds_read_b64_tr_b16 v[228:229], v13 offset:0
  ds_read_b64_tr_b16 v[230:231], v13 offset:1024
  s_waitcnt vmcnt(11) lgkmcnt(8)
  v_mfma_f32_32x32x16_bf16 v[64:79], v[240:243], v[104:107], v[64:79]
  buffer_load_dwordx4 v[152:155], v8, s[4:7], s23 offen offset:2048
  ds_read_b64_tr_b16 v[232:233], v12 offset:2048
  ds_read_b64_tr_b16 v[234:235], v12 offset:3072
  v_mfma_f32_32x32x16_bf16 v[80:95], v[244:247], v[104:107], v[80:95]
  ds_read_b64_tr_b16 v[236:237], v13 offset:2048
  ds_read_b64_tr_b16 v[238:239], v13 offset:3072
  s_cmp_eq_u32 s36, 0
  s_cbranch_scc1 .fz_kernel_pk62c
.fz_kernel_pk62:
  s_ff1_i32_b32 s33, s36
  s_waitcnt vmcnt(11) lgkmcnt(8)
  v_mfma_f32_32x32x16_bf16 v[64:79], v[248:251], v[108:111], v[64:79]
  buffer_load_dwordx4 v[156:159], v8, s[4:7], s23 offen offset:3072
  ds_read_b64_tr_b16 v[240:241], v12 offset:4096
  ds_read_b64_tr_b16 v[242:243], v12 offset:5120
  v_mfma_f32_32x32x16_bf16 v[80:95], v[252:255], v[108:111], v[80:95]
  ds_read_b64_tr_b16 v[244:245], v13 offset:4096
  ds_read_b64_tr_b16 v[246:247], v13 offset:5120
  s_bitset0_b32 s36, s33
  s_lshl_b32 s24, s33, 12
  s_waitcnt vmcnt(11) lgkmcnt(8)
  v_mfma_f32_32x32x16_bf16 v[64:79], v[224:227], v[112:115], v[64:79]
  buffer_load_dwordx4 v[160:163], v8, s[4:7], s24 offen offset:0
  ds_read_b64_tr_b16 v[248:249], v12 offset:6144
  ds_read_b64_tr_b16 v[250:251], v12 offset:7168
  v_mfma_f32_32x32x16_bf16 v[80:95], v[228:231], v[112:115], v[80:95]
  ds_read_b64_tr_b16 v[252:253], v13 offset:6144
  ds_read_b64_tr_b16 v[254:255], v13 offset:7168
  v_lshl_add_u32 v10, s22, 1, v14
  v_lshl_add_u32 v11, s22, 1, v15
  s_waitcnt vmcnt(11) lgkmcnt(8)
  v_mfma_f32_32x32x16_bf16 v[64:79], v[232:235], v[116:119], v[64:79]
  buffer_load_dwordx4 v[164:167], v8, s[4:7], s24 offen offset:1024
  ds_read_b64_tr_b16 v[224:225], v10 offset:0
  ds_read_b64_tr_b16 v[226:227], v10 offset:1024
  v_mfma_f32_32x32x16_bf16 v[80:95], v[236:239], v[116:119], v[80:95]
  ds_read_b64_tr_b16 v[228:229], v11 offset:0
  ds_read_b64_tr_b16 v[230:231], v11 offset:1024
  s_waitcnt vmcnt(11) lgkmcnt(8)
  v_mfma_f32_32x32x16_bf16 v[64:79], v[240:243], v[120:123], v[64:79]
  buffer_load_dwordx4 v[168:171], v8, s[4:7], s24 offen offset:2048
  ds_read_b64_tr_b16 v[232:233], v10 offset:2048
  ds_read_b64_tr_b16 v[234:235], v10 offset:3072
  v_mfma_f32_32x32x16_bf16 v[80:95], v[244:247], v[120:123], v[80:95]
  ds_read_b64_tr_b16 v[236:237], v11 offset:2048
  ds_read_b64_tr_b16 v[238:239], v11 offset:3072
  s_cmp_eq_u32 s36, 0
  s_cbranch_scc1 .fz_kernel_pk63c
.fz_kernel_pk63:
  s_ff1_i32_b32 s33, s36
  s_waitcnt vmcnt(11) lgkmcnt(8)
  v_mfma_f32_32x32x16_bf16 v[64:79], v[248:251], v[124:127], v[64:79]
  buffer_load_dwordx4 v[172:175], v8, s[4:7], s24 offen offset:3072
  ds_read_b64_tr_b16 v[240:241], v10 offset:4096
  ds_read_b64_tr_b16 v[242:243], v10 offset:5120
  v_mfma_f32_32x32x16_bf16 v[80:95], v[252:255], v[124:127], v[80:95]
  ds_read_b64_tr_b16 v[244:245], v11 offset:4096
  ds_read_b64_tr_b16 v[246:247], v11 offset:5120
  s_bitset0_b32 s36, s33
  s_lshl_b32 s25, s33, 12
  s_waitcnt vmcnt(11) lgkmcnt(8)
  v_mfma_f32_32x32x16_bf16 v[64:79], v[224:227], v[128:131], v[64:79]
  buffer_load_dwordx4 v[176:179], v8, s[4:7], s25 offen offset:0
  ds_read_b64_tr_b16 v[248:249], v10 offset:6144
  ds_read_b64_tr_b16 v[250:251], v10 offset:7168
  v_mfma_f32_32x32x16_bf16 v[80:95], v[228:231], v[128:131], v[80:95]
  ds_read_b64_tr_b16 v[252:253], v11 offset:6144
  ds_read_b64_tr_b16 v[254:255], v11 offset:7168
  v_lshl_add_u32 v12, s23, 1, v14
  v_lshl_add_u32 v13, s23, 1, v15
  s_waitcnt vmcnt(11) lgkmcnt(8)
  v_mfma_f32_32x32x16_bf16 v[64:79], v[232:235], v[132:135], v[64:79]
  buffer_load_dwordx4 v[180:183], v8, s[4:7], s25 offen offset:1024
  ds_read_b64_tr_b16 v[224:225], v12 offset:0
  ds_read_b64_tr_b16 v[226:227], v12 offset:1024
  v_mfma_f32_32x32x16_bf16 v[80:95], v[236:239], v[132:135], v[80:95]
  ds_read_b64_tr_b16 v[228:229], v13 offset:0
  ds_read_b64_tr_b16 v[230:231], v13 offset:1024
  s_waitcnt vmcnt(11) lgkmcnt(8)
  v_mfma_f32_32x32x16_bf16 v[64:79], v[240:243], v[136:139], v[64:79]
  buffer_load_dwordx4 v[184:187], v8, s[4:7], s25 offen offset:2048
  ds_read_b64_tr_b16 v[232:233], v12 offset:2048
  ds_read_b64_tr_b16 v[234:235], v12 offset:3072
  v_mfma_f32_32x32x16_bf16 v[80:95], v[244:247], v[136:139], v[80:95]
  ds_read_b64_tr_b16 v[236:237], v13 offset:2048
  ds_read_b64_tr_b16 v[238:239], v13 offset:3072
  s_cmp_eq_u32 s36, 0
  s_cbranch_scc1 .fz_kernel_pk64c
.fz_kernel_pk64:
  s_ff1_i32_b32 s33, s36
  s_waitcnt vmcnt(11) lgkmcnt(8)
  v_mfma_f32_32x32x16_bf16 v[64:79], v[248:251], v[140:143], v[64:79]
  buffer_load_dwordx4 v[188:191], v8, s[4:7], s25 offen offset:3072
  ds_read_b64_tr_b16 v[240:241], v12 offset:4096
  ds_read_b64_tr_b16 v[242:243], v12 offset:5120
  v_mfma_f32_32x32x16_bf16 v[80:95], v[252:255], v[140:143], v[80:95]
  ds_read_b64_tr_b16 v[244:245], v13 offset:4096
  ds_read_b64_tr_b16 v[246:247], v13 offset:5120
  s_bitset0_b32 s36, s33
  s_lshl_b32 s26, s33, 12
  s_waitcnt vmcnt(11) lgkmcnt(8)
  v_mfma_f32_32x32x16_bf16 v[64:79], v[224:227], v[144:147], v[64:79]
  buffer_load_dwordx4 v[192:195], v8, s[4:7], s26 offen offset:0
  ds_read_b64_tr_b16 v[248:249], v12 offset:6144
  ds_read_b64_tr_b16 v[250:251], v12 offset:7168
  v_mfma_f32_32x32x16_bf16 v[80:95], v[228:231], v[144:147], v[80:95]
  ds_read_b64_tr_b16 v[252:253], v13 offset:6144
  ds_read_b64_tr_b16 v[254:255], v13 offset:7168
  v_lshl_add_u32 v10, s24, 1, v14
  v_lshl_add_u32 v11, s24, 1, v15
  s_waitcnt vmcnt(11) lgkmcnt(8)
  v_mfma_f32_32x32x16_bf16 v[64:79], v[232:235], v[148:151], v[64:79]
  buffer_load_dwordx4 v[196:199], v8, s[4:7], s26 offen offset:1024
  ds_read_b64_tr_b16 v[224:225], v10 offset:0
  ds_read_b64_tr_b16 v[226:227], v10 offset:1024
  v_mfma_f32_32x32x16_bf16 v[80:95], v[236:239], v[148:151], v[80:95]
  ds_read_b64_tr_b16 v[228:229], v11 offset:0
  ds_read_b64_tr_b16 v[230:231], v11 offset:1024
  s_waitcnt vmcnt(11) lgkmcnt(8)
  v_mfma_f32_32x32x16_bf16 v[64:79], v[240:243], v[152:155], v[64:79]
  buffer_load_dwordx4 v[200:203], v8, s[4:7], s26 offen offset:2048
  ds_read_b64_tr_b16 v[232:233], v10 offset:2048
  ds_read_b64_tr_b16 v[234:235], v10 offset:3072
  v_mfma_f32_32x32x16_bf16 v[80:95], v[244:247], v[152:155], v[80:95]
  ds_read_b64_tr_b16 v[236:237], v11 offset:2048
  ds_read_b64_tr_b16 v[238:239], v11 offset:3072
  s_cmp_eq_u32 s36, 0
  s_cbranch_scc1 .fz_kernel_pk65c
.fz_kernel_pk65:
  s_ff1_i32_b32 s33, s36
  s_waitcnt vmcnt(11) lgkmcnt(8)
  v_mfma_f32_32x32x16_bf16 v[64:79], v[248:251], v[156:159], v[64:79]
  buffer_load_dwordx4 v[204:207], v8, s[4:7], s26 offen offset:3072
  ds_read_b64_tr_b16 v[240:241], v10 offset:4096
  ds_read_b64_tr_b16 v[242:243], v10 offset:5120
  v_mfma_f32_32x32x16_bf16 v[80:95], v[252:255], v[156:159], v[80:95]
  ds_read_b64_tr_b16 v[244:245], v11 offset:4096
  ds_read_b64_tr_b16 v[246:247], v11 offset:5120
  s_bitset0_b32 s36, s33
  s_lshl_b32 s27, s33, 12
  s_waitcnt vmcnt(11) lgkmcnt(8)
  v_mfma_f32_32x32x16_bf16 v[64:79], v[224:227], v[160:163], v[64:79]
  buffer_load_dwordx4 v[208:211], v8, s[4:7], s27 offen offset:0
  ds_read_b64_tr_b16 v[248:249], v10 offset:6144
  ds_read_b64_tr_b16 v[250:251], v10 offset:7168
  v_mfma_f32_32x32x16_bf16 v[80:95], v[228:231], v[160:163], v[80:95]
  ds_read_b64_tr_b16 v[252:253], v11 offset:6144
  ds_read_b64_tr_b16 v[254:255], v11 offset:7168
  v_lshl_add_u32 v12, s25, 1, v14
  v_lshl_add_u32 v13, s25, 1, v15
  s_waitcnt vmcnt(11) lgkmcnt(8)
  v_mfma_f32_32x32x16_bf16 v[64:79], v[232:235], v[164:167], v[64:79]
  buffer_load_dwordx4 v[212:215], v8, s[4:7], s27 offen offset:1024
  ds_read_b64_tr_b16 v[224:225], v12 offset:0
  ds_read_b64_tr_b16 v[226:227], v12 offset:1024
  v_mfma_f32_32x32x16_bf16 v[80:95], v[236:239], v[164:167], v[80:95]
  ds_read_b64_tr_b16 v[228:229], v13 offset:0
  ds_read_b64_tr_b16 v[230:231], v13 offset:1024
  s_waitcnt vmcnt(11) lgkmcnt(8)
  v_mfma_f32_32x32x16_bf16 v[64:79], v[240:243], v[168:171], v[64:79]
  buffer_load_dwordx4 v[216:219], v8, s[4:7], s27 offen offset:2048
  ds_read_b64_tr_b16 v[232:233], v12 offset:2048
  ds_read_b64_tr_b16 v[234:235], v12 offset:3072
  v_mfma_f32_32x32x16_bf16 v[80:95], v[244:247], v[168:171], v[80:95]
  ds_read_b64_tr_b16 v[236:237], v13 offset:2048
  ds_read_b64_tr_b16 v[238:239], v13 offset:3072
  s_waitcnt vmcnt(11) lgkmcnt(8)
  v_mfma_f32_32x32x16_bf16 v[64:79], v[248:251], v[172:175], v[64:79]
  buffer_load_dwordx4 v[220:223], v8, s[4:7], s27 offen offset:3072
  ds_read_b64_tr_b16 v[240:241], v12 offset:4096
  ds_read_b64_tr_b16 v[242:243], v12 offset:5120
  v_mfma_f32_32x32x16_bf16 v[80:95], v[252:255], v[172:175], v[80:95]
  ds_read_b64_tr_b16 v[244:245], v13 offset:4096
  ds_read_b64_tr_b16 v[246:247], v13 offset:5120
  s_waitcnt vmcnt(11) lgkmcnt(8)
  v_mfma_f32_32x32x16_bf16 v[64:79], v[224:227], v[176:179], v[64:79]
  ds_read_b64_tr_b16 v[248:249], v12 offset:6144
  ds_read_b64_tr_b16 v[250:251], v12 offset:7168
  s_mov_b32 s36, 0x3f803f80
  v_mov_b32 v36, 0
  v_mov_b32 v37, 0
  v_mfma_f32_32x32x16_bf16 v[80:95], v[228:231], v[176:179], v[80:95]
  ds_read_b64_tr_b16 v[252:253], v13 offset:6144
  ds_read_b64_tr_b16 v[254:255], v13 offset:7168
  v_lshl_add_u32 v10, s26, 1, v14
  v_lshl_add_u32 v11, s26, 1, v15
  v_mov_b32 v38, 0
  v_mov_b32 v39, 0
  v_mov_b32 v41, 0
  s_waitcnt vmcnt(10) lgkmcnt(8)
  v_mfma_f32_32x32x16_bf16 v[64:79], v[232:235], v[180:183], v[64:79]
  ds_read_b64_tr_b16 v[224:225], v10 offset:0
  ds_read_b64_tr_b16 v[226:227], v10 offset:1024
  v_mov_b32 v43, 0
  v_lshlrev_b32 v19, 2, v18
  v_mfma_f32_32x32x16_bf16 v[80:95], v[236:239], v[180:183], v[80:95]
  ds_read_b64_tr_b16 v[228:229], v11 offset:0
  ds_read_b64_tr_b16 v[230:231], v11 offset:1024
  v_lshl_add_u32 v19, v17, 13, v19
  s_lshl_b32 s34, s32, 7
  s_add_u32 s34, s34, s66
  s_waitcnt vmcnt(9) lgkmcnt(8)
  v_mfma_f32_32x32x16_bf16 v[64:79], v[240:243], v[184:187], v[64:79]
  ds_read_b64_tr_b16 v[232:233], v10 offset:2048
  ds_read_b64_tr_b16 v[234:235], v10 offset:3072
  s_add_u32 s34, s34, 16384
  s_add_u32 s37, s34, 16384
  v_mfma_f32_32x32x16_bf16 v[80:95], v[244:247], v[184:187], v[80:95]
  ds_read_b64_tr_b16 v[236:237], v11 offset:2048
  ds_read_b64_tr_b16 v[238:239], v11 offset:3072
  s_waitcnt vmcnt(8) lgkmcnt(8)
  v_mfma_f32_32x32x16_bf16 v[64:79], v[248:251], v[188:191], v[64:79]
  ds_read_b64_tr_b16 v[240:241], v10 offset:4096
  ds_read_b64_tr_b16 v[242:243], v10 offset:5120
  v_mfma_f32_32x32x16_bf16 v[80:95], v[252:255], v[188:191], v[80:95]
  ds_read_b64_tr_b16 v[244:245], v11 offset:4096
  ds_read_b64_tr_b16 v[246:247], v11 offset:5120
  s_waitcnt vmcnt(7) lgkmcnt(8)
  v_mfma_f32_32x32x16_bf16 v[64:79], v[224:227], v[192:195], v[64:79]
  ds_read_b64_tr_b16 v[248:249], v10 offset:6144
  ds_read_b64_tr_b16 v[250:251], v10 offset:7168
  v_mfma_f32_32x32x16_bf16 v[80:95], v[228:231], v[192:195], v[80:95]
  ds_read_b64_tr_b16 v[252:253], v11 offset:6144
  ds_read_b64_tr_b16 v[254:255], v11 offset:7168
  v_lshl_add_u32 v12, s27, 1, v14
  v_lshl_add_u32 v13, s27, 1, v15
  s_waitcnt vmcnt(6) lgkmcnt(8)
  v_mfma_f32_32x32x16_bf16 v[64:79], v[232:235], v[196:199], v[64:79]
  ds_read_b64_tr_b16 v[224:225], v12 offset:0
  ds_read_b64_tr_b16 v[226:227], v12 offset:1024
  v_mfma_f32_32x32x16_bf16 v[80:95], v[236:239], v[196:199], v[80:95]
  ds_read_b64_tr_b16 v[228:229], v13 offset:0
  ds_read_b64_tr_b16 v[230:231], v13 offset:1024
  s_waitcnt vmcnt(5) lgkmcnt(8)
  v_mfma_f32_32x32x16_bf16 v[64:79], v[240:243], v[200:203], v[64:79]
  ds_read_b64_tr_b16 v[232:233], v12 offset:2048
  ds_read_b64_tr_b16 v[234:235], v12 offset:3072
  v_mfma_f32_32x32x16_bf16 v[80:95], v[244:247], v[200:203], v[80:95]
  ds_read_b64_tr_b16 v[236:237], v13 offset:2048
  ds_read_b64_tr_b16 v[238:239], v13 offset:3072
  s_waitcnt vmcnt(4) lgkmcnt(8)
  v_mfma_f32_32x32x16_bf16 v[64:79], v[248:251], v[204:207], v[64:79]
  ds_read_b64_tr_b16 v[240:241], v12 offset:4096
  ds_read_b64_tr_b16 v[242:243], v12 offset:5120
  v_mfma_f32_32x32x16_bf16 v[80:95], v[252:255], v[204:207], v[80:95]
  ds_read_b64_tr_b16 v[244:245], v13 offset:4096
  ds_read_b64_tr_b16 v[246:247], v13 offset:5120
  s_waitcnt vmcnt(3) lgkmcnt(8)
  v_mfma_f32_32x32x16_bf16 v[64:79], v[224:227], v[208:211], v[64:79]
  ds_read_b64_tr_b16 v[248:249], v12 offset:6144
  ds_read_b64_tr_b16 v[250:251], v12 offset:7168
  v_mfma_f32_32x32x16_bf16 v[80:95], v[228:231], v[208:211], v[80:95]
  ds_read_b64_tr_b16 v[252:253], v13 offset:6144
  ds_read_b64_tr_b16 v[254:255], v13 offset:7168
  s_waitcnt vmcnt(2) lgkmcnt(8)
  v_mfma_f32_32x32x16_bf16 v[64:79], v[232:235], v[212:215], v[64:79]
  v_mfma_f32_32x32x16_bf16 v[80:95], v[236:239], v[212:215], v[80:95]
  s_waitcnt vmcnt(1) lgkmcnt(4)
  v_mfma_f32_32x32x16_bf16 v[64:79], v[240:243], v[216:219], v[64:79]
  v_mfma_f32_32x32x16_bf16 v[80:95], v[244:247], v[216:219], v[80:95]
  s_waitcnt vmcnt(0) lgkmcnt(0)
  v_mfma_f32_32x32x16_bf16 v[64:79], v[248:251], v[220:223], v[64:79]
  v_mfma_f32_32x32x16_bf16 v[80:95], v[252:255], v[220:223], v[80:95]
  s_nop 10
  v_cvt_pk_bf16_f32 v20, v64, v65
  v_cvt_pk_bf16_f32 v21, v66, v67
  v_cvt_pk_bf16_f32 v22, v68, v69
  v_cvt_pk_bf16_f32 v23, v70, v71
  buffer_store_dwordx4 v[20:23], v16, s[4:7], s39 offen offset:0 sc1
  v_cvt_pk_bf16_f32 v24, v72, v73
  v_cvt_pk_bf16_f32 v25, v74, v75
  v_cvt_pk_bf16_f32 v26, v76, v77
  v_cvt_pk_bf16_f32 v27, v78, v79
  buffer_store_dwordx4 v[24:27], v16, s[4:7], s39 offen offset:512 sc1
  v_cvt_pk_bf16_f32 v28, v80, v81
  v_cvt_pk_bf16_f32 v29, v82, v83
  v_cvt_pk_bf16_f32 v30, v84, v85
  v_cvt_pk_bf16_f32 v31, v86, v87
  buffer_store_dwordx4 v[28:31], v16, s[4:7], s39 offen offset:1024 sc1
  v_cvt_pk_bf16_f32 v32, v88, v89
  v_cvt_pk_bf16_f32 v33, v90, v91
  v_cvt_pk_bf16_f32 v34, v92, v93
  v_cvt_pk_bf16_f32 v35, v94, v95
  buffer_store_dwordx4 v[32:35], v16, s[4:7], s39 offen offset:1536 sc1
  v_dot2c_f32_bf16 v36, s36, v20
  v_dot2c_f32_bf16 v37, v20, v20
  v_dot2c_f32_bf16 v38, v20, v48
  v_dot2c_f32_bf16 v39, s36, v21
  v_dot2c_f32_bf16 v41, v21, v21
  v_dot2c_f32_bf16 v43, v21, v49
  v_dot2c_f32_bf16 v36, s36, v22
  v_dot2c_f32_bf16 v37, v22, v22
  v_dot2c_f32_bf16 v38, v22, v50
  v_dot2c_f32_bf16 v39, s36, v23
  v_dot2c_f32_bf16 v41, v23, v23
  v_dot2c_f32_bf16 v43, v23, v51
  v_dot2c_f32_bf16 v36, s36, v24
  v_dot2c_f32_bf16 v37, v24, v24
  v_dot2c_f32_bf16 v38, v24, v52
  v_dot2c_f32_bf16 v39, s36, v25
  v_dot2c_f32_bf16 v41, v25, v25
  v_dot2c_f32_bf16 v43, v25, v53
  v_dot2c_f32_bf16 v36, s36, v26
  v_dot2c_f32_bf16 v37, v26, v26
  v_dot2c_f32_bf16 v38, v26, v54
  v_dot2c_f32_bf16 v39, s36, v27
  v_dot2c_f32_bf16 v41, v27, v27
  v_dot2c_f32_bf16 v43, v27, v55
  v_dot2c_f32_bf16 v36, s36, v28
  v_dot2c_f32_bf16 v37, v28, v28
  v_dot2c_f32_bf16 v38, v28, v56
  v_dot2c_f32_bf16 v39, s36, v29
  v_dot2c_f32_bf16 v41, v29, v29
  v_dot2c_f32_bf16 v43, v29, v57
  v_dot2c_f32_bf16 v36, s36, v30
  v_dot2c_f32_bf16 v37, v30, v30
  v_dot2c_f32_bf16 v38, v30, v58
  v_dot2c_f32_bf16 v39, s36, v31
  v_dot2c_f32_bf16 v41, v31, v31
  v_dot2c_f32_bf16 v43, v31, v59
  v_dot2c_f32_bf16 v36, s36, v32
  v_dot2c_f32_bf16 v37, v32, v32
  v_dot2c_f32_bf16 v38, v32, v60
  v_dot2c_f32_bf16 v39, s36, v33
  v_dot2c_f32_bf16 v41, v33, v33
  v_dot2c_f32_bf16 v43, v33, v61
  v_dot2c_f32_bf16 v36, s36, v34
  v_dot2c_f32_bf16 v37, v34, v34
  v_dot2c_f32_bf16 v38, v34, v62
  v_dot2c_f32_bf16 v39, s36, v35
  v_dot2c_f32_bf16 v41, v35, v35
  v_dot2c_f32_bf16 v43, v35, v63
  s_nop 0
  v_add_f32 v36, v36, v39
  v_add_f32 v37, v37, v41
  v_add_f32 v38, v38, v43
  v_fma_f32 v38, -v36, v46, v38
  v_fmac_f32 v47, 0x44800000, v37
  v_mov_b32 v39, v38
  s_nop 0
  v_permlane32_swap_b32 v36, v47
  v_permlane32_swap_b32 v38, v39
  v_add_f32 v36, v36, v47
  v_add_f32 v38, v38, v39
  buffer_atomic_add_f32 v36, v19, s[4:7], s34 offen sc1
  s_mov_b32 exec_hi, 0
  buffer_atomic_add_f32 v38, v19, s[4:7], s37 offen sc1
  s_mov_b64 exec, -1
  s_barrier
  v_add_u32 v1, 4, v6
  s_mov_b32 s72, s66
  s_mov_b32 s73, s65
  s_mov_b32 s74, s67
  s_mov_b32 s75, s62
  s_cmp_lg_u32 s62, 0
  s_cbranch_scc1 .fz_kernel_tail
  s_mov_b32 s62, 1
  s_mov_b32 s63, 0x2000000
  s_mov_b32 s64, 0x2800000
  s_mov_b32 s65, 0x1400000
  s_mov_b32 s66, 0x1c42000
  s_mov_b32 s67, 12
  s_mov_b32 s71, 159776
  v_mov_b32 v6, 159832
  s_branch .fz_kernel_q_cons2
.fz_kernel_tail:
  s_mov_b32 s28, s56
  s_mov_b32 s29, s57
  s_mov_b32 s30, 0x400000
  s_mov_b32 s31, 0x00020000
  v_lshlrev_b32 v37, 2, v45
  v_add_u32 v37, 155644, v37
  v_mov_b32 v36, 159952
  v_lshlrev_b32 v38, 11, v18
  v_lshl_add_u32 v38, v17, 4, v38
  s_lshl_b32 s32, s32, 16
  s_lshl_b32 s33, s18, 7
  s_add_u32 s32, s32, s33
  v_lshlrev_b32 v64, 16, v20
  v_and_b32 v65, 0xffff0000, v20
  v_lshlrev_b32 v66, 16, v21
  v_and_b32 v67, 0xffff0000, v21
  v_lshlrev_b32 v68, 16, v22
  v_and_b32 v69, 0xffff0000, v22
  v_lshlrev_b32 v70, 16, v23
  v_and_b32 v71, 0xffff0000, v23
  v_lshlrev_b32 v72, 16, v24
  v_and_b32 v73, 0xffff0000, v24
  v_lshlrev_b32 v74, 16, v25
  v_and_b32 v75, 0xffff0000, v25
  v_lshlrev_b32 v76, 16, v26
  v_and_b32 v77, 0xffff0000, v26
  v_lshlrev_b32 v78, 16, v27
  v_and_b32 v79, 0xffff0000, v27
  v_lshlrev_b32 v80, 16, v28
  v_and_b32 v81, 0xffff0000, v28
  v_lshlrev_b32 v82, 16, v29
  v_and_b32 v83, 0xffff0000, v29
  v_lshlrev_b32 v84, 16, v30
  v_and_b32 v85, 0xffff0000, v30
  v_lshlrev_b32 v86, 16, v31
  v_and_b32 v87, 0xffff0000, v31
  v_lshlrev_b32 v88, 16, v32
  v_and_b32 v89, 0xffff0000, v32
  v_lshlrev_b32 v90, 16, v33
  v_and_b32 v91, 0xffff0000, v33
  v_lshlrev_b32 v92, 16, v34
  v_and_b32 v93, 0xffff0000, v34
  v_lshlrev_b32 v94, 16, v35
  v_and_b32 v95, 0xffff0000, v35
  s_mov_b64 exec, 1
  s_waitcnt vmcnt(0)
  ds_add_u32 v1, v5 offset:0x100
  s_mov_b64 exec, -1
  s_barrier
  ds_read_b32 v40, v37 offset:6400
  ds_read_b32 v42, v37 offset:6912
  ds_read_b32 v36, v36
  s_waitcnt lgkmcnt(0)
  v_cmp_ne_u32 vcc, v36, v45
  s_mov_b64 exec, vcc
  v_pk_fma_f32 v[64:65], v[64:65], v[40:41], v[42:43] op_sel_hi:[1,0,0]
  v_pk_fma_f32 v[66:67], v[66:67], v[40:41], v[42:43] op_sel_hi:[1,0,0]
  v_pk_fma_f32 v[68:69], v[68:69], v[40:41], v[42:43] op_sel_hi:[1,0,0]
  v_pk_fma_f32 v[70:71], v[70:71], v[40:41], v[42:43] op_sel_hi:[1,0,0]
  v_cvt_pk_bf16_f32 v20, v64, v65
  v_cvt_pk_bf16_f32 v21, v66, v67
  v_cvt_pk_bf16_f32 v22, v68, v69
  v_cvt_pk_bf16_f32 v23, v70, v71
  buffer_store_dwordx4 v[20:23], v38, s[28:31], s32 offen offset:0
  v_pk_fma_f32 v[72:73], v[72:73], v[40:41], v[42:43] op_sel_hi:[1,0,0]
  v_pk_fma_f32 v[74:75], v[74:75], v[40:41], v[42:43] op_sel_hi:[1,0,0]
  v_pk_fma_f32 v[76:77], v[76:77], v[40:41], v[42:43] op_sel_hi:[1,0,0]
  v_pk_fma_f32 v[78:79], v[78:79], v[40:41], v[42:43] op_sel_hi:[1,0,0]
  v_cvt_pk_bf16_f32 v24, v72, v73
  v_cvt_pk_bf16_f32 v25, v74, v75
  v_cvt_pk_bf16_f32 v26, v76, v77
  v_cvt_pk_bf16_f32 v27, v78, v79
  buffer_store_dwordx4 v[24:27], v38, s[28:31], s32 offen offset:32
  v_pk_fma_f32 v[80:81], v[80:81], v[40:41], v[42:43] op_sel_hi:[1,0,0]
  v_pk_fma_f32 v[82:83], v[82:83], v[40:41], v[42:43] op_sel_hi:[1,0,0]
  v_pk_fma_f32 v[84:85], v[84:85], v[40:41], v[42:43] op_sel_hi:[1,0,0]
  v_pk_fma_f32 v[86:87], v[86:87], v[40:41], v[42:43] op_sel_hi:[1,0,0]
  v_cvt_pk_bf16_f32 v28, v80, v81
  v_cvt_pk_bf16_f32 v29, v82, v83
  v_cvt_pk_bf16_f32 v30, v84, v85
  v_cvt_pk_bf16_f32 v31, v86, v87
  buffer_store_dwordx4 v[28:31], v38, s[28:31], s32 offen offset:64
  v_pk_fma_f32 v[88:89], v[88:89], v[40:41], v[42:43] op_sel_hi:[1,0,0]
  v_pk_fma_f32 v[90:91], v[90:91], v[40:41], v[42:43] op_sel_hi:[1,0,0]
  v_pk_fma_f32 v[92:93], v[92:93], v[40:41], v[42:43] op_sel_hi:[1,0,0]
  v_pk_fma_f32 v[94:95], v[94:95], v[40:41], v[42:43] op_sel_hi:[1,0,0]
  v_cvt_pk_bf16_f32 v32, v88, v89
  v_cvt_pk_bf16_f32 v33, v90, v91
  v_cvt_pk_bf16_f32 v34, v92, v93
  v_cvt_pk_bf16_f32 v35, v94, v95
  buffer_store_dwordx4 v[32:35], v38, s[28:31], s32 offen offset:96
  s_mov_b64 exec, -1
  s_branch .fz_kernel_fin
.fz_kernel_chain:
  s_setprio 0
  s_bitcmp1_b32 s18, 0
  s_cselect_b32 s8, s52, s50
  s_cselect_b32 s9, s53, s51
  s_mov_b32 s10, 0x700000
  s_mov_b32 s11, 0x00020000
  s_lshl_b32 s12, s16, 8
  s_and_b32 s12, s12, 511
  s_and_b32 s31, s18, 2
  s_lshl_b32 s31, s31, 8
  s_add_u32 s12, s12, s31
  s_mul_i32 s12, s12, 7168
  s_lshl_b32 s31, s17, 2
  s_lshr_b32 s33, s18, 2
  s_add_u32 s31, s31, s33
  s_lshl_b32 s31, s31, 7
  s_add_u32 s12, s12, s31
  v_lshrrev_b32 v13, 3, v2
  v_mul_u32_u24 v13, 229376, v13
  v_and_b32 v11, 7, v2
  v_lshl_add_u32 v13, v11, 4, v13
  s_mov_b32 s24, s44
  s_mov_b32 s25, s45
  s_mov_b32 s26, 0x200000
  s_mov_b32 s27, 0x00020000
  v_lshrrev_b32 v8, 3, v2
  v_and_b32 v9, 7, v2
  v_bfe_u32 v10, v2, 4, 1
  v_lshlrev_b32 v10, 2, v10
  v_xor_b32 v9, v9, v10
  v_lshlrev_b32 v9, 4, v9
  v_lshl_add_u32 v10, v8, 11, v9
  s_mov_b32 s24, s54
  s_mov_b32 s25, s55
  s_mov_b32 s26, 0x700000
  s_mov_b32 s27, 0x00020000
  s_mov_b32 s36, 0x05040100
  s_mov_b32 s37, 0x07060302
  s_and_b32 s20, s16, 1
  s_lshl1_add_u32 s13, s17, s20
  s_lshl_b32 s13, s13, 18
  s_lshl_b32 s14, s18, 7
  s_add_u32 s13, s13, s14
  s_cmp_ge_u32 s17, 14
  s_cbranch_scc1 .fz_kernel_c_nl
  s_mov_b32 s38, 0
.fz_kernel_kw66:
  s_sleep 2
  ds_read_b32 v7, v6 offset:0
  s_add_u32 s38, s38, 1
  s_waitcnt lgkmcnt(0)
  v_readfirstlane_b32 s31, v7
  s_bcnt1_i32_b32 s31, s31
  s_cmp_ge_u32 s31, 16
  s_cbranch_scc1 .fz_kernel_kw66d
  s_cmp_lt_u32 s38, 1048576
  s_cbranch_scc1 .fz_kernel_kw66
.fz_kernel_kw66d:
  buffer_load_dwordx4 v[112:115], v13, s[8:11], s12 offen nt
  s_add_u32 s12, s12, 7168
  s_waitcnt vmcnt(2)
  buffer_load_dwordx4 v[116:119], v13, s[8:11], s12 offen nt
  s_add_u32 s12, s12, 7168
  s_waitcnt vmcnt(2)
  buffer_load_dwordx4 v[120:123], v13, s[8:11], s12 offen nt
  s_add_u32 s12, s12, 7168
  s_waitcnt vmcnt(2)
  buffer_load_dwordx4 v[124:127], v13, s[8:11], s12 offen nt
  s_add_u32 s12, s12, 7168
  s_waitcnt vmcnt(2)
  buffer_load_dwordx4 v[128:131], v13, s[8:11], s12 offen nt
  s_add_u32 s12, s12, 7168
  s_waitcnt vmcnt(2)
  buffer_load_dwordx4 v[132:135], v13, s[8:11], s12 offen nt
  s_add_u32 s12, s12, 7168
  s_waitcnt vmcnt(2)
  buffer_load_dwordx4 v[136:139], v13, s[8:11], s12 offen nt
  s_add_u32 s12, s12, 7168
  s_waitcnt vmcnt(2)
  buffer_load_dwordx4 v[140:143], v13, s[8:11], s12 offen nt
  s_add_u32 s12, s12, 7168
  s_waitcnt vmcnt(2)
  buffer_load_dwordx4 v[144:147], v13, s[8:11], s12 offen nt
  s_add_u32 s12, s12, 7168
  s_waitcnt vmcnt(2)
  buffer_load_dwordx4 v[148:151], v13, s[8:11], s12 offen nt
  s_add_u32 s12, s12, 7168
  s_waitcnt vmcnt(2)
  buffer_load_dwordx4 v[152:155], v13, s[8:11], s12 offen nt
  s_add_u32 s12, s12, 7168
  s_waitcnt vmcnt(2)
  buffer_load_dwordx4 v[156:159], v13, s[8:11], s12 offen nt
  s_add_u32 s12, s12, 7168
  s_waitcnt vmcnt(2)
  buffer_load_dwordx4 v[160:163], v13, s[8:11], s12 offen nt
  s_add_u32 s12, s12, 7168
  s_waitcnt vmcnt(2)
  buffer_load_dwordx4 v[164:167], v13, s[8:11], s12 offen nt
  s_add_u32 s12, s12, 7168
  s_waitcnt vmcnt(2)
  buffer_load_dwordx4 v[168:171], v13, s[8:11], s12 offen nt
  s_add_u32 s12, s12, 7168
  s_waitcnt vmcnt(2)
  buffer_load_dwordx4 v[172:175], v13, s[8:11], s12 offen nt
  s_add_u32 s12, s12, 7168
  s_waitcnt vmcnt(2)
  buffer_load_dwordx4 v[176:179], v13, s[8:11], s12 offen nt
  s_add_u32 s12, s12, 7168
  s_waitcnt vmcnt(2)
  buffer_load_dwordx4 v[180:183], v13, s[8:11], s12 offen nt
  s_add_u32 s12, s12, 7168
  s_waitcnt vmcnt(2)
  buffer_load_dwordx4 v[184:187], v13, s[8:11], s12 offen nt
  s_add_u32 s12, s12, 7168
  s_waitcnt vmcnt(2)
  buffer_load_dwordx4 v[188:191], v13, s[8:11], s12 offen nt
  s_add_u32 s12, s12, 7168
  s_waitcnt vmcnt(2)
  buffer_load_dwordx4 v[192:195], v13, s[8:11], s12 offen nt
  s_add_u32 s12, s12, 7168
  s_waitcnt vmcnt(2)
  buffer_load_dwordx4 v[196:199], v13, s[8:11], s12 offen nt
  s_add_u32 s12, s12, 7168
  s_waitcnt vmcnt(2)
  buffer_load_dwordx4 v[200:203], v13, s[8:11], s12 offen nt
  s_add_u32 s12, s12, 7168
  s_waitcnt vmcnt(2)
  buffer_load_dwordx4 v[204:207], v13, s[8:11], s12 offen nt
  s_add_u32 s12, s12, 7168
  s_waitcnt vmcnt(2)
  buffer_load_dwordx4 v[208:211], v13, s[8:11], s12 offen nt
  s_add_u32 s12, s12, 7168
  s_waitcnt vmcnt(2)
  buffer_load_dwordx4 v[212:215], v13, s[8:11], s12 offen nt
  s_add_u32 s12, s12, 7168
  s_waitcnt vmcnt(2)
  buffer_load_dwordx4 v[216:219], v13, s[8:11], s12 offen nt
  s_add_u32 s12, s12, 7168
  s_waitcnt vmcnt(2)
  buffer_load_dwordx4 v[220:223], v13, s[8:11], s12 offen nt
  s_add_u32 s12, s12, 7168
  s_waitcnt vmcnt(2)
  buffer_load_dwordx4 v[224:227], v13, s[8:11], s12 offen nt
  s_add_u32 s12, s12, 7168
  s_waitcnt vmcnt(2)
  buffer_load_dwordx4 v[228:231], v13, s[8:11], s12 offen nt
  s_add_u32 s12, s12, 7168
  s_waitcnt vmcnt(2)
  buffer_load_dwordx4 v[232:235], v13, s[8:11], s12 offen nt
  s_add_u32 s12, s12, 7168
  s_waitcnt vmcnt(2)
  buffer_load_dwordx4 v[236:239], v13, s[8:11], s12 offen nt
  s_add_u32 s12, s12, 7168
  s_waitcnt vmcnt(2)
  buffer_load_dwordx4 v[32:35], v10, s[24:27], s13 offen nt
  s_add_u32 s13, s13, 16384
  s_waitcnt vmcnt(2)
  buffer_load_dwordx4 v[36:39], v10, s[24:27], s13 offen nt
  s_add_u32 s13, s13, 16384
  s_waitcnt vmcnt(2)
  buffer_load_dwordx4 v[40:43], v10, s[24:27], s13 offen nt
  s_add_u32 s13, s13, 16384
  s_waitcnt vmcnt(2)
  buffer_load_dwordx4 v[44:47], v10, s[24:27], s13 offen nt
  s_add_u32 s13, s13, 16384
  s_waitcnt vmcnt(2)
  buffer_load_dwordx4 v[48:51], v10, s[24:27], s13 offen nt
  s_add_u32 s13, s13, 16384
  s_waitcnt vmcnt(2)
  buffer_load_dwordx4 v[52:55], v10, s[24:27], s13 offen nt
  s_add_u32 s13, s13, 16384
  s_waitcnt vmcnt(2)
  buffer_load_dwordx4 v[56:59], v10, s[24:27], s13 offen nt
  s_add_u32 s13, s13, 16384
  s_waitcnt vmcnt(2)
  buffer_load_dwordx4 v[60:63], v10, s[24:27], s13 offen nt
  s_add_u32 s13, s13, 16384
  s_waitcnt vmcnt(2)
  buffer_load_dwordx4 v[64:67], v10, s[24:27], s13 offen nt
  s_add_u32 s13, s13, 16384
  s_waitcnt vmcnt(2)
  buffer_load_dwordx4 v[68:71], v10, s[24:27], s13 offen nt
  s_add_u32 s13, s13, 16384
  s_waitcnt vmcnt(2)
  buffer_load_dwordx4 v[72:75], v10, s[24:27], s13 offen nt
  s_add_u32 s13, s13, 16384
  s_waitcnt vmcnt(2)
  buffer_load_dwordx4 v[76:79], v10, s[24:27], s13 offen nt
  s_add_u32 s13, s13, 16384
  s_waitcnt vmcnt(2)
  buffer_load_dwordx4 v[240:243], v10, s[24:27], s13 offen nt
  s_add_u32 s13, s13, 16384
  s_waitcnt vmcnt(2)
  buffer_load_dwordx4 v[244:247], v10, s[24:27], s13 offen nt
  s_add_u32 s13, s13, 16384
  s_waitcnt vmcnt(2)
  buffer_load_dwordx4 v[248:251], v10, s[24:27], s13 offen nt
  s_add_u32 s13, s13, 16384
  s_waitcnt vmcnt(2)
  buffer_load_dwordx4 v[252:255], v10, s[24:27], s13 offen nt
  s_add_u32 s13, s13, 16384
  s_waitcnt vmcnt(2)
  v_mov_b32 v16, 0x3f803f80
  v_mov_b32 v17, 0x3f803f80
  v_mov_b32 v18, 0x3f803f80
  v_mov_b32 v19, 0x3f803f80
  s_waitcnt vmcnt(0)
  s_barrier
  v_perm_b32 v80, v116, v112, s36
  v_perm_b32 v84, v116, v112, s37
  v_perm_b32 v88, v117, v113, s36
  v_perm_b32 v92, v117, v113, s37
  v_perm_b32 v96, v118, v114, s36
  v_perm_b32 v100, v118, v114, s37
  v_perm_b32 v104, v119, v115, s36
  v_perm_b32 v108, v119, v115, s37
  v_perm_b32 v81, v124, v120, s36
  v_perm_b32 v85, v124, v120, s37
  v_perm_b32 v89, v125, v121, s36
  v_perm_b32 v93, v125, v121, s37
  v_perm_b32 v97, v126, v122, s36
  v_perm_b32 v101, v126, v122, s37
  v_perm_b32 v105, v127, v123, s36
  v_perm_b32 v109, v127, v123, s37
  v_perm_b32 v82, v132, v128, s36
  v_perm_b32 v86, v132, v128, s37
  v_perm_b32 v90, v133, v129, s36
  v_perm_b32 v94, v133, v129, s37
  v_perm_b32 v98, v134, v130, s36
  v_perm_b32 v102, v134, v130, s37
  v_perm_b32 v106, v135, v131, s36
  v_perm_b32 v110, v135, v131, s37
  v_perm_b32 v83, v140, v136, s36
  v_perm_b32 v87, v140, v136, s37
  v_perm_b32 v91, v141, v137, s36
  v_perm_b32 v95, v141, v137, s37
  v_perm_b32 v99, v142, v138, s36
  v_perm_b32 v103, v142, v138, s37
  v_perm_b32 v107, v143, v139, s36
  v_perm_b32 v111, v143, v139, s37
  v_perm_b32 v112, v148, v144, s36
  v_perm_b32 v116, v148, v144, s37
  v_perm_b32 v120, v149, v145, s36
  v_perm_b32 v124, v149, v145, s37
  v_perm_b32 v128, v150, v146, s36
  v_perm_b32 v132, v150, v146, s37
  v_perm_b32 v136, v151, v147, s36
  v_perm_b32 v140, v151, v147, s37
  v_perm_b32 v113, v156, v152, s36
  v_perm_b32 v117, v156, v152, s37
  v_perm_b32 v121, v157, v153, s36
  v_perm_b32 v125, v157, v153, s37
  v_perm_b32 v129, v158, v154, s36
  v_perm_b32 v133, v158, v154, s37
  v_perm_b32 v137, v159, v155, s36
  v_perm_b32 v141, v159, v155, s37
  v_perm_b32 v114, v164, v160, s36
  v_perm_b32 v118, v164, v160, s37
  v_perm_b32 v122, v165, v161, s36
  v_perm_b32 v126, v165, v161, s37
  v_perm_b32 v130, v166, v162, s36
  v_perm_b32 v134, v166, v162, s37
  v_perm_b32 v138, v167, v163, s36
  v_perm_b32 v142, v167, v163, s37
  v_perm_b32 v115, v172, v168, s36
  v_perm_b32 v119, v172, v168, s37
  v_perm_b32 v123, v173, v169, s36
  v_perm_b32 v127, v173, v169, s37
  v_perm_b32 v131, v174, v170, s36
  v_perm_b32 v135, v174, v170, s37
  v_perm_b32 v139, v175, v171, s36
  v_perm_b32 v143, v175, v171, s37
  v_perm_b32 v144, v180, v176, s36
  v_perm_b32 v148, v180, v176, s37
  v_perm_b32 v152, v181, v177, s36
  v_perm_b32 v156, v181, v177, s37
  v_perm_b32 v160, v182, v178, s36
  v_perm_b32 v164, v182, v178, s37
  v_perm_b32 v168, v183, v179, s36
  v_perm_b32 v172, v183, v179, s37
  v_perm_b32 v145, v188, v184, s36
  v_perm_b32 v149, v188, v184, s37
  v_perm_b32 v153, v189, v185, s36
  v_perm_b32 v157, v189, v185, s37
  v_perm_b32 v161, v190, v186, s36
  v_perm_b32 v165, v190, v186, s37
  v_perm_b32 v169, v191, v187, s36
  v_perm_b32 v173, v191, v187, s37
  v_perm_b32 v146, v196, v192, s36
  v_perm_b32 v150, v196, v192, s37
  v_perm_b32 v154, v197, v193, s36
  v_perm_b32 v158, v197, v193, s37
  v_perm_b32 v162, v198, v194, s36
  v_perm_b32 v166, v198, v194, s37
  v_perm_b32 v170, v199, v195, s36
  v_perm_b32 v174, v199, v195, s37
  v_perm_b32 v147, v204, v200, s36
  v_perm_b32 v151, v204, v200, s37
  v_perm_b32 v155, v205, v201, s36
  v_perm_b32 v159, v205, v201, s37
  v_perm_b32 v163, v206, v202, s36
  v_perm_b32 v167, v206, v202, s37
  v_perm_b32 v171, v207, v203, s36
  v_perm_b32 v175, v207, v203, s37
  v_perm_b32 v176, v212, v208, s36
  v_perm_b32 v180, v212, v208, s37
  v_perm_b32 v184, v213, v209, s36
  v_perm_b32 v188, v213, v209, s37
  v_perm_b32 v192, v214, v210, s36
  v_perm_b32 v196, v214, v210, s37
  v_perm_b32 v200, v215, v211, s36
  v_perm_b32 v204, v215, v211, s37
  v_perm_b32 v177, v220, v216, s36
  v_perm_b32 v181, v220, v216, s37
  v_perm_b32 v185, v221, v217, s36
  v_perm_b32 v189, v221, v217, s37
  v_perm_b32 v193, v222, v218, s36
  v_perm_b32 v197, v222, v218, s37
  v_perm_b32 v201, v223, v219, s36
  v_perm_b32 v205, v223, v219, s37
  v_perm_b32 v178, v228, v224, s36
  v_perm_b32 v182, v228, v224, s37
  v_perm_b32 v186, v229, v225, s36
  v_perm_b32 v190, v229, v225, s37
  v_perm_b32 v194, v230, v226, s36
  v_perm_b32 v198, v230, v226, s37
  v_perm_b32 v202, v231, v227, s36
  v_perm_b32 v206, v231, v227, s37
  v_perm_b32 v179, v236, v232, s36
  v_perm_b32 v183, v236, v232, s37
  v_perm_b32 v187, v237, v233, s36
  v_perm_b32 v191, v237, v233, s37
  v_perm_b32 v195, v238, v234, s36
  v_perm_b32 v199, v238, v234, s37
  v_perm_b32 v203, v239, v235, s36
  v_perm_b32 v207, v239, v235, s37
  v_mfma_f32_16x16x32_bf16 v[208:211], v[16:19], v[80:83], 0
  v_mfma_f32_16x16x32_bf16 v[212:215], v[16:19], v[84:87], 0
  v_mfma_f32_16x16x32_bf16 v[216:219], v[16:19], v[88:91], 0
  v_mfma_f32_16x16x32_bf16 v[220:223], v[16:19], v[92:95], 0
  v_mfma_f32_16x16x32_bf16 v[224:227], v[16:19], v[96:99], 0
  v_mfma_f32_16x16x32_bf16 v[228:231], v[16:19], v[100:103], 0
  v_mfma_f32_16x16x32_bf16 v[232:235], v[16:19], v[104:107], 0
  v_mfma_f32_16x16x32_bf16 v[236:239], v[16:19], v[108:111], 0
  v_mfma_f32_16x16x32_bf16 v[208:211], v[16:19], v[112:115], v[208:211]
  v_mfma_f32_16x16x32_bf16 v[212:215], v[16:19], v[116:119], v[212:215]
  v_mfma_f32_16x16x32_bf16 v[216:219], v[16:19], v[120:123], v[216:219]
  v_mfma_f32_16x16x32_bf16 v[220:223], v[16:19], v[124:127], v[220:223]
  v_mfma_f32_16x16x32_bf16 v[224:227], v[16:19], v[128:131], v[224:227]
  v_mfma_f32_16x16x32_bf16 v[228:231], v[16:19], v[132:135], v[228:231]
  v_mfma_f32_16x16x32_bf16 v[232:235], v[16:19], v[136:139], v[232:235]
  v_mfma_f32_16x16x32_bf16 v[236:239], v[16:19], v[140:143], v[236:239]
  v_mfma_f32_16x16x32_bf16 v[208:211], v[16:19], v[144:147], v[208:211]
  v_mfma_f32_16x16x32_bf16 v[212:215], v[16:19], v[148:151], v[212:215]
  v_mfma_f32_16x16x32_bf16 v[216:219], v[16:19], v[152:155], v[216:219]
  v_mfma_f32_16x16x32_bf16 v[220:223], v[16:19], v[156:159], v[220:223]
  v_mfma_f32_16x16x32_bf16 v[224:227], v[16:19], v[160:163], v[224:227]
  v_mfma_f32_16x16x32_bf16 v[228:231], v[16:19], v[164:167], v[228:231]
  v_mfma_f32_16x16x32_bf16 v[232:235], v[16:19], v[168:171], v[232:235]
  v_mfma_f32_16x16x32_bf16 v[236:239], v[16:19], v[172:175], v[236:239]
  v_mfma_f32_16x16x32_bf16 v[208:211], v[16:19], v[176:179], v[208:211]
  v_mfma_f32_16x16x32_bf16 v[212:215], v[16:19], v[180:183], v[212:215]
  v_mfma_f32_16x16x32_bf16 v[216:219], v[16:19], v[184:187], v[216:219]
  v_mfma_f32_16x16x32_bf16 v[220:223], v[16:19], v[188:191], v[220:223]
  v_mfma_f32_16x16x32_bf16 v[224:227], v[16:19], v[192:195], v[224:227]
  v_mfma_f32_16x16x32_bf16 v[228:231], v[16:19], v[196:199], v[228:231]
  v_mfma_f32_16x16x32_bf16 v[232:235], v[16:19], v[200:203], v[232:235]
  v_mfma_f32_16x16x32_bf16 v[236:239], v[16:19], v[204:207], v[236:239]
  s_nop 0
  v_add_f32 v28, v209, v208 row_ror:8 row_mask:0xf bank_mask:0x3
  v_add_f32 v29, v213, v212 row_ror:8 row_mask:0xf bank_mask:0x3
  v_add_f32 v30, v217, v216 row_ror:8 row_mask:0xf bank_mask:0x3
  v_add_f32 v31, v221, v220 row_ror:8 row_mask:0xf bank_mask:0x3
  v_add_f32 v28, v224, v225 row_ror:8 row_mask:0xf bank_mask:0xc
  v_add_f32 v29, v228, v229 row_ror:8 row_mask:0xf bank_mask:0xc
  v_add_f32 v30, v232, v233 row_ror:8 row_mask:0xf bank_mask:0xc
  v_add_f32 v31, v236, v237 row_ror:8 row_mask:0xf bank_mask:0xc
  v_mul_f32 v28, 0.0009765625, v28
  v_mul_f32 v29, 0.0009765625, v29
  v_mul_f32 v30, 0.0009765625, v30
  v_mul_f32 v31, 0.0009765625, v31
.fz_kernel_c_np:
  v_mov_b32 v27, v6
  s_mov_b32 s72, s66
  s_mov_b32 s73, s65
  s_mov_b32 s74, s67
  s_mov_b32 s75, s62
  s_cmp_lg_u32 s62, 0
  s_cbranch_scc1 .fz_kernel_c_n2
  s_mov_b32 s62, 1
  s_mov_b32 s63, 0x2000000
  s_mov_b32 s64, 0x2800000
  s_mov_b32 s65, 0x1400000
  s_mov_b32 s66, 0x1c42000
  s_mov_b32 s67, 12
  s_mov_b32 s71, 159776
  v_mov_b32 v6, 159832
.fz_kernel_c_n2:
  s_lshr_b32 s21, s17, 3
  s_add_u32 s70, s18, s21
  s_lshl1_add_u32 s70, s17, s70
  s_and_b32 s70, s70, 15
  s_cmp_eq_u32 s75, 0
  s_cselect_b32 s3, 32, 0
  s_cselect_b32 s70, s70, s18
  s_and_b32 s20, s16, 1
  s_mov_b32 s34, 0x00030003
  s_mov_b32 s35, 0x00030003
  s_mov_b32 s71, 0
  s_lshl1_add_u32 s26, s17, s20
  v_lshrrev_b32 v8, 4, v2
  v_lshrrev_b32 v12, 5, v2
  v_lshlrev_b32 v12, 10, v12
  v_bfe_u32 v14, v2, 3, 2
  v_lshl_add_u32 v12, v14, 8, v12
  v_and_b32 v14, 7, v2
  v_lshl_add_u32 v12, v14, 1, v12
  v_lshlrev_b32 v10, 7, v2
  v_lshrrev_b32 v14, 1, v8
  v_mul_u32_u24 v7, 12288, v14
  v_and_b32 v14, 1, v8
  v_lshl_add_u32 v7, v14, 11, v7
  v_bfe_u32 v14, v2, 2, 2
  v_lshl_add_u32 v7, v14, 7, v7
  v_lshrrev_b32 v14, 1, v14
  v_lshl_add_u32 v14, s20, 1, v14
  v_lshl_add_u32 v7, v14, 5, v7
  v_and_b32 v14, 3, v2
  v_lshl_add_u32 v7, v14, 3, v7
  v_add_u32 v7, 65536, v7
  v_xor_b32 v9, 32, v7
  s_and_b32 s61, s18, 2
  s_add_u32 s61, s61, s20
  s_and_b32 s32, s18, 1
  s_lshl2_add_u32 s32, s32, s61
  s_lshl_b32 s32, s32, 9
  s_lshl_b32 s22, s17, 13
  s_add_u32 s32, s32, s22
  s_and_b32 s22, s18, 8
  s_lshl_b32 s22, s22, 9
  s_add_u32 s32, s32, s22
  s_and_b32 s22, s18, 4
  s_lshl_b32 s22, s22, 6
  s_add_u32 s32, s32, s22
  s_add_u32 s32, s32, s72
  s_add_u32 s32, s32, 40960
  s_lshl_b32 s61, s61, 16
  s_lshl_b32 s33, s26, 12
  s_add_u32 s33, s33, s72
  s_add_u32 s33, s33, 40960
  s_mul_i32 s39, s18, 28
  s_add_u32 s39, s39, s26
  s_lshl_b32 s39, s39, 8
  s_add_u32 s39, s39, s72
  s_add_u32 s39, s39, 155648
  s_lshl4_add_u32 s60, s18, s17
  s_lshl_b32 s60, s60, 10
  s_add_u32 s60, s60, 0x1c84000
  s_add_u32 s21, s74, 0x1800008
  s_sub_u32 s22, s72, 32768
  v_mov_b32 v14, s21
  v_mov_b32 v15, s22
  v_cmp_gt_u32 vcc, 16, v2
  s_nop 1
  v_cndmask_b32 v14, v15, v14, vcc
  v_lshl_add_u32 v14, v2, 11, v14
  s_lshl_b32 s25, s17, 7
  s_lshl_b32 s22, 1, s18
  v_mov_b32 v15, s22
  v_lshlrev_b32 v16, 3, v2
  s_and_b32 s21, s2, 7
  s_lshl_b32 s21, s21, 11
  s_lshl_b32 s22, s20, 10
  s_add_u32 s21, s21, s22
  s_add_u32 s21, s21, s72
  s_lshl_b32 s22, s20, 12
  s_add_u32 s22, s22, s72
  s_add_u32 s22, s22, 16384
  s_add_u32 s23, s22, 8192
  s_add_u32 s24, s22, 16384
  v_and_b32 v17, 1, v8
  v_lshlrev_b32 v17, 13, v17
  v_lshrrev_b32 v18, 1, v8
  v_mul_u32_u24 v18, 320, v18
  v_add_u32 v17, v17, v18
  v_bfe_u32 v18, v2, 3, 1
  v_lshl_add_u32 v17, v18, 9, v17
  v_bfe_u32 v18, v2, 2, 1
  v_lshl_add_u32 v17, v18, 7, v17
  v_and_b32 v18, 3, v2
  v_lshl_add_u32 v17, v18, 3, v17
  s_lshl_b32 s27, s20, 14
  s_add_u32 s27, s27, 114688
  v_add_u32 v17, s27, v17
  v_xor_b32 v18, 64, v17
  v_and_b32 v20, 7, v2
  v_lshlrev_b32 v20, 5, v20
  v_and_b32 v21, 8, v2
  v_lshl_add_u32 v20, v21, 1, v20
  v_and_b32 v21, 31, v2
  v_lshlrev_b32 v21, 4, v21
  v_lshrrev_b32 v22, 5, v2
  v_lshl_add_u32 v21, v22, 11, v21
  v_mov_b32 v23, 0.0009765625
  v_mov_b32 v24, 9.5367431640625e-07
  v_mov_b32 v25, 1e-05
  v_add_u32 v26, 155648, v16
  s_lshl_b32 s14, s17, 9
  s_add_u32 s14, s14, s72
  s_add_u32 s14, s14, 16384
  s_add_u32 s15, s14, 8192
  v_add_u32 v13, s27, v3
  s_barrier
.fz_kernel_c_n3:
  s_mov_b32 s13, 0xff0000
  s_cmp_eq_u32 s20, 0
  s_cbranch_scc1 .fz_kernel_c_nf
  s_cmp_eq_u32 s75, 0
  s_cselect_b32 exec_lo, 0xffff, s13
  s_mov_b32 exec_hi, 0
  s_mov_b32 s38, 0
.fz_kernel_cw67:
  s_sleep 1
  ds_read_u8 v22, v27 offset:268
  s_add_u32 s38, s38, 1
  s_waitcnt lgkmcnt(0)
  v_cmp_gt_u32 vcc, 4, v22
  s_cbranch_vccz .fz_kernel_cw67d
  s_cmp_lt_u32 s38, 8388608
  s_cbranch_scc1 .fz_kernel_cw67
.fz_kernel_cw67d:
  buffer_atomic_or v15, v14, s[4:7], s25 offen sc1
  s_mov_b64 exec, -1
.fz_kernel_c_nf:
  s_add_u32 s13, s19, s74
  s_mov_b64 exec, 1
  buffer_load_dword v11, v4, s[4:7], s13 offen offset:8 sc1
  s_mov_b64 exec, -1
  ds_write_b128 v13, v[32:35] offset:0
  ds_write_b128 v13, v[36:39] offset:1024
  ds_write_b128 v13, v[40:43] offset:2048
  ds_write_b128 v13, v[44:47] offset:3072
  ds_write_b128 v13, v[48:51] offset:4096
  ds_write_b128 v13, v[52:55] offset:5120
  ds_write_b128 v13, v[56:59] offset:6144
  ds_write_b128 v13, v[60:63] offset:7168
  ds_write_b128 v13, v[64:67] offset:8192
  ds_write_b128 v13, v[68:71] offset:9216
  ds_write_b128 v13, v[72:75] offset:10240
  ds_write_b128 v13, v[76:79] offset:11264
  ds_write_b128 v13, v[240:243] offset:12288
  ds_write_b128 v13, v[244:247] offset:13312
  ds_write_b128 v13, v[248:251] offset:14336
  ds_write_b128 v13, v[252:255] offset:15360
  v_and_b32 v14, 1, v2
  v_lshlrev_b32 v14, 10, v14
  v_lshl_add_u32 v14, v8, 14, v14
  v_add_u32 v14, s61, v14
  s_waitcnt lgkmcnt(0)
  s_cmp_lg_u32 s75, 0
  s_cbranch_scc1 .fz_kernel_c_nw
  v_mov_b32 v13, v9
  s_lshl_b32 s21, s18, 10
  s_add_u32 s21, s21, s72
  s_cmp_lg_u32 s20, 0
  s_cbranch_scc1 .fz_kernel_c_c7
  s_add_u32 s22, s19, s74
  s_add_u32 s23, s14, 16384
  s_mov_b64 exec, 1
  s_mov_b32 s38, 0
  s_branch .fz_kernel_c_c00
.fz_kernel_c_c0:
  s_sleep 6
  buffer_load_dword v11, v4, s[4:7], s22 offen offset:8 sc1
.fz_kernel_c_c00:
  s_add_u32 s38, s38, 1
  s_waitcnt vmcnt(0)
  ds_or_b32 v6, v11 offset:0x114
  v_or_b32 v11, v11, v15
  v_cmp_ne_u32 vcc, 0xffff, v11
  s_cbranch_vccz .fz_kernel_c_c1
  s_cmp_lt_u32 s38, 131072
  s_cbranch_scc1 .fz_kernel_c_c0
.fz_kernel_c_c1:
  s_mov_b32 s38, 0
.fz_kernel_cw68:
  s_sleep 1
  ds_read_u8 v22, v27 offset:268
  s_add_u32 s38, s38, 1
  s_waitcnt lgkmcnt(0)
  v_cmp_gt_u32 vcc, 4, v22
  s_cbranch_vccz .fz_kernel_cw68d
  s_cmp_lt_u32 s38, 8388608
  s_cbranch_scc1 .fz_kernel_cw68
.fz_kernel_cw68d:
  ds_or_b32 v6, v11 offset:0x114
  s_mov_b64 exec, -1
  buffer_load_dwordx2 v[240:241], v16, s[4:7], s14 offen
  buffer_load_dwordx2 v[242:243], v16, s[4:7], s15 offen
  buffer_load_dwordx2 v[244:245], v16, s[4:7], s23 offen
  s_lshl_b32 s23, s17, 6
  s_add_u32 s23, s23, s21
  s_lshl_b32 s24, s17, 18
  s_add_u32 s24, s24, 1
  v_and_b32 v19, 0x38, v2
  v_lshl_add_u32 v19, v19, 8, s24
  v_and_b32 v208, 7, v2
  v_lshl_add_u32 v19, v208, 5, v19
  s_mov_b32 s38, 0
.fz_kernel_cw69:
  s_sleep 1
  ds_read_u8 v22, v6 offset:272
  s_add_u32 s38, s38, 1
  s_waitcnt lgkmcnt(0)
  v_cmp_gt_u32 vcc, 2, v22
  s_cbranch_vccz .fz_kernel_cw69d
  s_cmp_lt_u32 s38, 8388608
  s_cbranch_scc1 .fz_kernel_cw69
.fz_kernel_cw69d:
  ds_read_b64_tr_b16 v[32:33], v7 offset:0
  ds_read_b64_tr_b16 v[34:35], v7 offset:512
  ds_read_b64_tr_b16 v[36:37], v13 offset:0
  ds_read_b64_tr_b16 v[38:39], v13 offset:512
  ds_read_b64_tr_b16 v[40:41], v7 offset:4096
  ds_read_b64_tr_b16 v[42:43], v7 offset:4608
  ds_read_b64_tr_b16 v[44:45], v13 offset:4096
  ds_read_b64_tr_b16 v[46:47], v13 offset:4608
  ds_read_b64_tr_b16 v[48:49], v7 offset:8192
  ds_read_b64_tr_b16 v[50:51], v7 offset:8704
  ds_read_b64_tr_b16 v[52:53], v13 offset:8192
  ds_read_b64_tr_b16 v[54:55], v13 offset:8704
  s_waitcnt lgkmcnt(0)
  v_xor_b32 v7, 64, v7
  v_xor_b32 v13, 64, v13
  ds_read_b64_tr_b16 v[56:57], v7 offset:1024
  ds_read_b64_tr_b16 v[58:59], v7 offset:1536
  ds_read_b64_tr_b16 v[60:61], v13 offset:1024
  ds_read_b64_tr_b16 v[62:63], v13 offset:1536
  ds_read_b64_tr_b16 v[64:65], v7 offset:5120
  ds_read_b64_tr_b16 v[66:67], v7 offset:5632
  ds_read_b64_tr_b16 v[68:69], v13 offset:5120
  ds_read_b64_tr_b16 v[70:71], v13 offset:5632
  ds_read_b64_tr_b16 v[72:73], v7 offset:9216
  ds_read_b64_tr_b16 v[74:75], v7 offset:9728
  ds_read_b64_tr_b16 v[76:77], v13 offset:9216
  ds_read_b64_tr_b16 v[78:79], v13 offset:9728
  s_waitcnt lgkmcnt(0)
  s_waitcnt vmcnt(0)
  v_fma_f32 v208, -v240, v240, v242
  v_fma_f32 v209, -v241, v241, v243
  v_rsq_f32 v208, abs(v208)
  v_rsq_f32 v209, abs(v209)
  v_mul_f32 v208, v208, v244
  v_mul_f32 v209, v209, v245
  v_and_b32 v208, -2, v208
  v_or_b32 v209, 1, v209
  v_cmp_gt_f32 vcc, v209, v208
  v_max_f32 v9, v208, v209
  s_nop 0
  v_cndmask_b32 v210, v240, v241, vcc
  v_max_f32 v7, v9, v9 row_ror:8 row_mask:0xf bank_mask:0xf
  v_cndmask_b32 v211, v242, v243, vcc
  s_nop 0
  v_max_f32 v7, v7, v7 row_ror:4 row_mask:0xf bank_mask:0xf
  s_nop 1
  v_max_f32 v7, v7, v7 row_ror:2 row_mask:0xf bank_mask:0xf
  s_nop 1
  v_max_f32 v7, v7, v7 row_ror:1 row_mask:0xf bank_mask:0xf
  s_nop 1
  v_max_f32 v7, v7, v7 row_bcast:15 row_mask:0xa bank_mask:0xf
  s_nop 1
  v_max_f32 v7, v7, v7 row_bcast:31 row_mask:0xc bank_mask:0xf
  v_and_b32 v209, 1, v9
  v_lshl_add_u32 v209, v209, 4, v19
  v_readlane_b32 s22, v7, 63
  v_mov_b32 v208, v9
  s_nop 0
  v_cmp_eq_u32 vcc, s22, v9
  s_ff1_i32_b64 s22, vcc
  s_lshl_b64 exec, 1, s22
  buffer_store_dwordx4 v[208:211], v4, s[4:7], s23 offen sc1
  s_mov_b64 exec, -1
.fz_kernel_c_c2:
  s_cmp_lg_u32 s20, 0
  s_cbranch_scc1 .fz_kernel_c_c21
  s_call_b64 s[68:69], .fz_kernel_c_coef
  ds_write_b64 v26, v[248:249] offset:4608
  ds_write_b64 v26, v[250:251] offset:5120
  ds_write_b64 v26, v[252:253] offset:6400
  ds_write_b64 v26, v[254:255] offset:6912
.fz_kernel_c_c21:
.fz_kernel_c_c22:
  s_cmp_le_u32 s3, 28
  s_cbranch_scc1 .fz_kernel_c_c3
  s_barrier
  s_sub_u32 s3, s3, 1
  s_branch .fz_kernel_c_c22
.fz_kernel_c_c3:
  v_lshlrev_b32 v22, 6, v2
  s_mov_b64 exec, 0xffff
  s_mov_b32 s38, 0
.fz_kernel_c_c4:
  buffer_load_dwordx4 v[224:227], v22, s[4:7], s21 offen sc1
  s_add_u32 s38, s38, 1
  s_mov_b32 s46, 0
  s_call_b64 s[0:1], .fz_kernel_hw
  s_waitcnt vmcnt(0)
  v_min_u32 v9, v225, v227
  v_max_f32 v7, v224, v224 row_ror:8 row_mask:0xf bank_mask:0xf
  v_cmp_eq_u32 vcc, 0, v9
  s_cbranch_vccz .fz_kernel_c_c5
  s_cmp_lt_u32 s38, 131072
  s_cbranch_scc1 .fz_kernel_c_c4
.fz_kernel_c_c5:
  s_waitcnt lgkmcnt(0)
  v_max_f32 v7, v7, v7 row_ror:4 row_mask:0xf bank_mask:0xf
  s_nop 1
  v_max_f32 v7, v7, v7 row_ror:2 row_mask:0xf bank_mask:0xf
  s_nop 1
  v_max_f32 v7, v7, v7 row_ror:1 row_mask:0xf bank_mask:0xf
  v_cmp_eq_u32 vcc, v7, v224
  s_or_b32 s22, vcc_lo, 0x8000
  s_ff1_i32_b32 s22, s22
  v_readlane_b32 s77, v225, s22
  s_mov_b64 exec, s[34:35]
  s_and_b32 s77, s77, 0x3c38f0
  s_add_u32 s78, s77, s73
  buffer_load_dwordx4 v[208:211], v14, s[4:7], s78 offen offset:0
  buffer_load_dwordx4 v[212:215], v14, s[4:7], s78 offen offset:256
  buffer_load_dwordx4 v[216:219], v14, s[4:7], s78 offen offset:512
  buffer_load_dwordx4 v[220:223], v14, s[4:7], s78 offen offset:768
  s_mov_b64 exec, -1
  s_cmp_eq_u32 s3, 0
  s_cbranch_scc1 .fz_kernel_hb71
  s_barrier
  s_sub_u32 s3, s3, 1
.fz_kernel_hb71:
  v_readlane_b32 s27, v224, s22
  v_readlane_b32 s23, v226, s22
  v_readlane_b32 s24, v227, s22
  s_lshr_b32 s21, s77, 11
  s_and_b32 s22, s21, 7
  s_and_b32 s21, s21, 0x780
  s_lshl4_add_u32 s21, s22, s21
  s_bfe_u32 s77, s77, 0x40004
  s_add_u32 s77, s77, s21
  v_mov_b32 v11, s23
  v_mov_b32 v15, s24
  s_branch .fz_kernel_c_idx
.fz_kernel_c_nw:
  s_mov_b64 exec, 0xff
  s_mov_b32 s38, 0
.fz_kernel_c_gm:
  buffer_load_dword v9, v10, s[4:7], s21 offen sc1
  s_add_u32 s38, s38, 1
  s_waitcnt vmcnt(0)
  v_cmp_ne_u32 vcc, 0xffff, v9
  s_cbranch_vccz .fz_kernel_c_gmd
  s_sleep 10
  s_cmp_lt_u32 s38, 131072
  s_cbranch_scc1 .fz_kernel_c_gm
.fz_kernel_c_gmd:
  s_mov_b64 exec, -1
  buffer_load_dwordx4 v[208:211], v3, s[4:7], s22 offen offset:0
  buffer_load_dwordx4 v[212:215], v3, s[4:7], s23 offen offset:0
  buffer_load_dwordx4 v[216:219], v3, s[4:7], s24 offen offset:0
  buffer_load_dwordx4 v[220:223], v3, s[4:7], s22 offen offset:1024
  buffer_load_dwordx4 v[224:227], v3, s[4:7], s23 offen offset:1024
  buffer_load_dwordx4 v[228:231], v3, s[4:7], s24 offen offset:1024
  buffer_load_dwordx4 v[232:235], v3, s[4:7], s22 offen offset:2048
  buffer_load_dwordx4 v[236:239], v3, s[4:7], s23 offen offset:2048
  buffer_load_dwordx4 v[240:243], v3, s[4:7], s24 offen offset:2048
  buffer_load_dwordx4 v[244:247], v3, s[4:7], s22 offen offset:3072
  buffer_load_dwordx4 v[248:251], v3, s[4:7], s23 offen offset:3072
  buffer_load_dwordx4 v[252:255], v3, s[4:7], s24 offen offset:3072
  s_lshl_b32 s21, s75, 4
  s_add_u32 s21, s21, 159968
  v_mov_b32 v10, s21
  s_lshl_b32 s22, s20, 3
  v_add_u32 v13, s22, v10
  s_waitcnt vmcnt(10)
  v_fma_f32 v212, -v208, v208, v212
  v_fma_f32 v213, -v209, v209, v213
  v_fma_f32 v214, -v210, v210, v214
  v_fma_f32 v215, -v211, v211, v215
  v_rsq_f32 v212, abs(v212)
  v_rsq_f32 v213, abs(v213)
  v_rsq_f32 v214, abs(v214)
  v_rsq_f32 v215, abs(v215)
  s_waitcnt vmcnt(9)
  v_mul_f32 v216, v216, v212
  v_mul_f32 v217, v217, v213
  v_mul_f32 v218, v218, v214
  v_mul_f32 v219, v219, v215
  v_and_or_b32 v216, v216, -16, 0
  v_and_or_b32 v217, v217, -16, 1
  v_and_or_b32 v218, v218, -16, 2
  v_and_or_b32 v219, v219, -16, 3
  v_max3_f32 v9, v216, v217, v218
  v_max_f32 v9, v9, v219
  s_waitcnt vmcnt(7)
  v_fma_f32 v224, -v220, v220, v224
  v_fma_f32 v225, -v221, v221, v225
  v_fma_f32 v226, -v222, v222, v226
  v_fma_f32 v227, -v223, v223, v227
  v_rsq_f32 v224, abs(v224)
  v_rsq_f32 v225, abs(v225)
  v_rsq_f32 v226, abs(v226)
  v_rsq_f32 v227, abs(v227)
  s_waitcnt vmcnt(6)
  v_mul_f32 v228, v228, v224
  v_mul_f32 v229, v229, v225
  v_mul_f32 v230, v230, v226
  v_mul_f32 v231, v231, v227
  v_and_or_b32 v228, v228, -16, 4
  v_and_or_b32 v229, v229, -16, 5
  v_and_or_b32 v230, v230, -16, 6
  v_and_or_b32 v231, v231, -16, 7
  v_max3_f32 v9, v9, v228, v229
  v_max3_f32 v9, v9, v230, v231
  s_waitcnt vmcnt(4)
  v_fma_f32 v236, -v232, v232, v236
  v_fma_f32 v237, -v233, v233, v237
  v_fma_f32 v238, -v234, v234, v238
  v_fma_f32 v239, -v235, v235, v239
  v_rsq_f32 v236, abs(v236)
  v_rsq_f32 v237, abs(v237)
  v_rsq_f32 v238, abs(v238)
  v_rsq_f32 v239, abs(v239)
  s_waitcnt vmcnt(3)
  v_mul_f32 v240, v240, v236
  v_mul_f32 v241, v241, v237
  v_mul_f32 v242, v242, v238
  v_mul_f32 v243, v243, v239
  v_and_or_b32 v240, v240, -16, 8
  v_and_or_b32 v241, v241, -16, 9
  v_and_or_b32 v242, v242, -16, 10
  v_and_or_b32 v243, v243, -16, 11
  v_max3_f32 v9, v9, v240, v241
  v_max3_f32 v9, v9, v242, v243
  s_waitcnt vmcnt(1)
  v_fma_f32 v248, -v244, v244, v248
  v_fma_f32 v249, -v245, v245, v249
  v_fma_f32 v250, -v246, v246, v250
  v_fma_f32 v251, -v247, v247, v251
  v_rsq_f32 v248, abs(v248)
  v_rsq_f32 v249, abs(v249)
  v_rsq_f32 v250, abs(v250)
  v_rsq_f32 v251, abs(v251)
  s_waitcnt vmcnt(0)
  v_mul_f32 v252, v252, v248
  v_mul_f32 v253, v253, v249
  v_mul_f32 v254, v254, v250
  v_mul_f32 v255, v255, v251
  v_and_or_b32 v252, v252, -16, 12
  v_and_or_b32 v253, v253, -16, 13
  v_and_or_b32 v254, v254, -16, 14
  v_and_or_b32 v255, v255, -16, 15
  v_max3_f32 v9, v9, v252, v253
  v_max3_f32 v9, v9, v254, v255
  s_nop 1
  v_max_f32 v7, v9, v9 row_ror:8 row_mask:0xf bank_mask:0xf
  s_nop 1
  v_max_f32 v7, v7, v7 row_ror:4 row_mask:0xf bank_mask:0xf
  s_nop 1
  v_max_f32 v7, v7, v7 row_ror:2 row_mask:0xf bank_mask:0xf
  s_nop 1
  v_max_f32 v7, v7, v7 row_ror:1 row_mask:0xf bank_mask:0xf
  s_nop 1
  v_max_f32 v7, v7, v7 row_bcast:15 row_mask:0xa bank_mask:0xf
  s_nop 1
  v_max_f32 v7, v7, v7 row_bcast:31 row_mask:0xc bank_mask:0xf
  s_nop 0
  v_readlane_b32 s21, v7, 63
  s_nop 1
  v_cmp_eq_u32 vcc, s21, v9
  s_ff1_i32_b64 s22, vcc
  s_lshl_b32 s22, s22, 2
  s_and_b32 s23, s21, 3
  s_add_u32 s22, s22, s23
  s_and_b32 s23, s21, 12
  s_lshl_b32 s23, s23, 6
  s_add_u32 s22, s22, s23
  s_and_b32 s22, s22, 1023
  s_lshl_b32 s23, s20, 10
  s_add_u32 s22, s22, s23
  s_add_u32 s22, s22, 1
  v_mov_b32 v224, s21
  v_mov_b32 v225, s22
  s_mov_b64 exec, 1
  ds_write_b64 v13, v[224:225]
  s_mov_b32 s38, 0
.fz_kernel_c_am:
  ds_read_b128 v[224:227], v10
  s_add_u32 s38, s38, 1
  s_waitcnt lgkmcnt(0)
  v_min_u32 v9, v225, v227
  v_cmp_eq_u32 vcc, 0, v9
  s_cbranch_vccz .fz_kernel_c_amd
  s_cmp_lt_u32 s38, 524288
  s_cbranch_scc1 .fz_kernel_c_am
.fz_kernel_c_amd:
  v_cmp_gt_f32 vcc, v226, v224
  s_nop 1
  v_cndmask_b32 v225, v225, v227, vcc
  v_cndmask_b32 v224, v224, v226, vcc
  v_readfirstlane_b32 s77, v225
  v_readfirstlane_b32 s27, v224
  s_mov_b64 exec, -1
  s_sub_u32 s21, s77, 1
  s_and_b32 s21, s21, 2047
  s_lshl_b32 s21, s21, 2
  s_add_u32 s21, s21, s72
  s_add_u32 s21, s21, 16384
  s_add_u32 s22, s21, 8192
  buffer_load_dword v11, v4, s[4:7], s21 offen
  buffer_load_dword v15, v4, s[4:7], s22 offen
  s_mov_b64 exec, s[34:35]
  s_sub_u32 s77, s77, 1
  s_and_b32 s77, s77, 2047
  s_lshr_b32 s78, s77, 7
  s_lshl_b32 s78, s78, 18
  s_and_b32 s21, s77, 0x70
  s_lshl_b32 s21, s21, 7
  s_add_u32 s78, s78, s21
  s_and_b32 s21, s77, 15
  s_lshl_b32 s21, s21, 4
  s_add_u32 s78, s78, s21
  s_add_u32 s78, s78, s73
  buffer_load_dwordx4 v[208:211], v14, s[4:7], s78 offen offset:0
  buffer_load_dwordx4 v[212:215], v14, s[4:7], s78 offen offset:256
  buffer_load_dwordx4 v[216:219], v14, s[4:7], s78 offen offset:512
  buffer_load_dwordx4 v[220:223], v14, s[4:7], s78 offen offset:768
  s_mov_b64 exec, -1
.fz_kernel_c_idx:
  s_lshr_b32 s21, s77, 7
  s_and_b32 s79, s77, 127
  s_add_u32 s79, s79, 1
  s_cmp_eq_u32 s21, s17
  s_cselect_b32 s79, s79, 0
  v_mov_b32 v1, -1477.3197218702985
  v_mul_f32 v1, s27, v1
  v_exp_f32 v1, v1
  s_nop 0
  v_add_f32 v1, 1.0, v1
  v_rcp_f32 v1, v1
  s_lshl_b32 s23, s70, 14
  s_add_u32 s23, s23, s78
  s_mov_b32 s46, 0
  s_call_b64 s[0:1], .fz_kernel_hw
  s_waitcnt vmcnt(0)
  s_cmp_ge_u32 s17, 14
  s_cbranch_scc1 .fz_kernel_c_ng
  s_setprio 2
  v_mfma_f32_16x16x32_bf16 v[224:227], v[208:211], v[80:83], 0
  v_mfma_f32_16x16x32_bf16 v[228:231], v[208:211], v[84:87], 0
  v_mfma_f32_16x16x32_bf16 v[232:235], v[208:211], v[88:91], 0
  v_mfma_f32_16x16x32_bf16 v[236:239], v[208:211], v[92:95], 0
  v_mfma_f32_16x16x32_bf16 v[240:243], v[208:211], v[96:99], 0
  v_mfma_f32_16x16x32_bf16 v[244:247], v[208:211], v[100:103], 0
  v_mfma_f32_16x16x32_bf16 v[248:251], v[208:211], v[104:107], 0
  v_mfma_f32_16x16x32_bf16 v[252:255], v[208:211], v[108:111], 0
  v_mfma_f32_16x16x32_bf16 v[224:227], v[212:215], v[112:115], v[224:227]
  v_mfma_f32_16x16x32_bf16 v[228:231], v[212:215], v[116:119], v[228:231]
  v_mfma_f32_16x16x32_bf16 v[232:235], v[212:215], v[120:123], v[232:235]
  v_mfma_f32_16x16x32_bf16 v[236:239], v[212:215], v[124:127], v[236:239]
  v_mfma_f32_16x16x32_bf16 v[240:243], v[212:215], v[128:131], v[240:243]
  v_mfma_f32_16x16x32_bf16 v[244:247], v[212:215], v[132:135], v[244:247]
  v_mfma_f32_16x16x32_bf16 v[248:251], v[212:215], v[136:139], v[248:251]
  v_mfma_f32_16x16x32_bf16 v[252:255], v[212:215], v[140:143], v[252:255]
  v_mfma_f32_16x16x32_bf16 v[224:227], v[216:219], v[144:147], v[224:227]
  v_mfma_f32_16x16x32_bf16 v[228:231], v[216:219], v[148:151], v[228:231]
  v_mfma_f32_16x16x32_bf16 v[232:235], v[216:219], v[152:155], v[232:235]
  v_mfma_f32_16x16x32_bf16 v[236:239], v[216:219], v[156:159], v[236:239]
  v_mfma_f32_16x16x32_bf16 v[240:243], v[216:219], v[160:163], v[240:243]
  v_mfma_f32_16x16x32_bf16 v[244:247], v[216:219], v[164:167], v[244:247]
  v_mfma_f32_16x16x32_bf16 v[248:251], v[216:219], v[168:171], v[248:251]
  v_mfma_f32_16x16x32_bf16 v[252:255], v[216:219], v[172:175], v[252:255]
  v_mfma_f32_16x16x32_bf16 v[224:227], v[220:223], v[176:179], v[224:227]
  v_mfma_f32_16x16x32_bf16 v[228:231], v[220:223], v[180:183], v[228:231]
  v_mfma_f32_16x16x32_bf16 v[232:235], v[220:223], v[184:187], v[232:235]
  v_mfma_f32_16x16x32_bf16 v[236:239], v[220:223], v[188:191], v[236:239]
  v_mfma_f32_16x16x32_bf16 v[240:243], v[220:223], v[192:195], v[240:243]
  v_mfma_f32_16x16x32_bf16 v[244:247], v[220:223], v[196:199], v[244:247]
  v_mfma_f32_16x16x32_bf16 v[248:251], v[220:223], v[200:203], v[248:251]
  v_mfma_f32_16x16x32_bf16 v[252:255], v[220:223], v[204:207], v[252:255]
  s_nop 0
  v_add_f32 v208, v225, v224 row_ror:8 row_mask:0xf bank_mask:0x3
  v_add_f32 v209, v229, v228 row_ror:8 row_mask:0xf bank_mask:0x3
  v_add_f32 v210, v233, v232 row_ror:8 row_mask:0xf bank_mask:0x3
  v_add_f32 v211, v237, v236 row_ror:8 row_mask:0xf bank_mask:0x3
  v_add_f32 v208, v240, v241 row_ror:8 row_mask:0xf bank_mask:0xc
  v_add_f32 v209, v244, v245 row_ror:8 row_mask:0xf bank_mask:0xc
  v_add_f32 v210, v248, v249 row_ror:8 row_mask:0xf bank_mask:0xc
  v_add_f32 v211, v252, v253 row_ror:8 row_mask:0xf bank_mask:0xc
  v_fma_f32 v208, -v11, v28, v208
  v_fma_f32 v209, -v11, v29, v209
  v_or_b32 v208, 1, v208
  v_fma_f32 v210, -v11, v30, v210
  v_fma_f32 v211, -v11, v31, v211
  v_or_b32 v210, 1, v210
  s_mov_b64 exec, 0xffff
  buffer_store_dwordx4 v[208:211], v20, s[4:7], s32 offen offset:0 sc1
  s_mov_b64 exec, -1
  s_setprio 0
  s_cmp_eq_u32 s3, 0
  s_cbranch_scc1 .fz_kernel_hb72
  s_barrier
  s_sub_u32 s3, s3, 1
.fz_kernel_hb72:
.fz_kernel_c_ng:
  s_cmp_eq_u32 s20, 0
  s_cbranch_scc1 .fz_kernel_c_ng1
  buffer_load_ushort v184, v12, s[4:7], s23 offen
  s_branch .fz_kernel_c_ng2
.fz_kernel_c_ng1:
  s_cmp_eq_u32 s75, 0
  s_cbranch_scc1 .fz_kernel_c_ng2
  buffer_load_dwordx2 v[240:241], v16, s[4:7], s14 offen
  buffer_load_dwordx2 v[242:243], v16, s[4:7], s15 offen
.fz_kernel_c_ng2:
  s_cmp_ge_u32 s17, 14
  s_cbranch_scc1 .fz_kernel_c_g1
  ds_read_b64_tr_b16 v[80:81], v17 offset:0
  ds_read_b64_tr_b16 v[82:83], v17 offset:1024
  ds_read_b64_tr_b16 v[84:85], v17 offset:32
  ds_read_b64_tr_b16 v[86:87], v17 offset:1056
  ds_read_b64_tr_b16 v[88:89], v18 offset:0
  ds_read_b64_tr_b16 v[90:91], v18 offset:1024
  ds_read_b64_tr_b16 v[92:93], v18 offset:32
  ds_read_b64_tr_b16 v[94:95], v18 offset:1056
  ds_read_b64_tr_b16 v[96:97], v17 offset:2048
  ds_read_b64_tr_b16 v[98:99], v17 offset:3072
  ds_read_b64_tr_b16 v[100:101], v17 offset:2080
  ds_read_b64_tr_b16 v[102:103], v17 offset:3104
  ds_read_b64_tr_b16 v[104:105], v18 offset:2048
  s_cmp_eq_u32 s3, 0
  s_cbranch_scc1 .fz_kernel_hb80
  s_barrier
  s_sub_u32 s3, s3, 1
.fz_kernel_hb80:
  ds_read_b64_tr_b16 v[106:107], v18 offset:3072
  ds_read_b64_tr_b16 v[108:109], v18 offset:2080
  ds_read_b64_tr_b16 v[110:111], v18 offset:3104
  s_waitcnt lgkmcnt(4)
  ds_read_b64_tr_b16 v[112:113], v17 offset:4096
  ds_read_b64_tr_b16 v[114:115], v17 offset:5120
  ds_read_b64_tr_b16 v[116:117], v17 offset:4128
  ds_read_b64_tr_b16 v[118:119], v17 offset:5152
  ds_read_b64_tr_b16 v[120:121], v18 offset:4096
  ds_read_b64_tr_b16 v[122:123], v18 offset:5120
  ds_read_b64_tr_b16 v[124:125], v18 offset:4128
  ds_read_b64_tr_b16 v[126:127], v18 offset:5152
  ds_read_b64_tr_b16 v[128:129], v17 offset:6144
  ds_read_b64_tr_b16 v[130:131], v17 offset:7168
  ds_read_b64_tr_b16 v[132:133], v17 offset:6176
  ds_read_b64_tr_b16 v[134:135], v17 offset:7200
  ds_read_b64_tr_b16 v[136:137], v18 offset:6144
  ds_read_b64_tr_b16 v[138:139], v18 offset:7168
  s_cmp_eq_u32 s3, 0
  s_cbranch_scc1 .fz_kernel_hb81
  s_barrier
  s_sub_u32 s3, s3, 1
.fz_kernel_hb81:
  ds_read_b64_tr_b16 v[140:141], v18 offset:6176
  ds_read_b64_tr_b16 v[142:143], v18 offset:7200
.fz_kernel_c_g1:
  v_fma_f32 v15, -v11, v11, v15
  v_rsq_f32 v15, abs(v15)
  s_nop 0
  v_mul_f32 v179, v11, v15
  v_mul_f32 v15, 0x44800000, v15
  v_sub_f32 v179, 0, v179
  v_add_f32 v178, 1.0, v15
  v_mul_f32 v177, -1.4426950408889634, v15
  v_mul_f32 v15, v15, v15
  v_mul_f32 v1, v1, v15
  s_cmp_eq_u32 s75, 0
  s_cbranch_scc1 .fz_kernel_c_d0
  s_cmp_lg_u32 s20, 0
  s_cbranch_scc1 .fz_kernel_c_t2
  s_waitcnt vmcnt(0)
  s_call_b64 s[68:69], .fz_kernel_c_coef
  v_mov_b32 v9, 159952
  v_mov_b32 v7, s79
  ds_write_b64 v26, v[252:253] offset:6400
  ds_write_b64 v26, v[254:255] offset:6912
  ds_write_b32 v9, v7
  s_waitcnt lgkmcnt(0)
.fz_kernel_c_t2:
  s_barrier
.fz_kernel_c_d0:
  s_cmp_ge_u32 s17, 14
  s_cbranch_scc1 .fz_kernel_c_nd
  s_cmp_eq_u32 s3, 0
  s_cbranch_scc1 .fz_kernel_hb74
  s_barrier
  s_sub_u32 s3, s3, 1
.fz_kernel_hb74:
  buffer_load_dwordx4 v[144:147], v21, s[4:7], s33 offen offset:0 sc1
  buffer_load_dwordx4 v[148:151], v21, s[4:7], s33 offen offset:512 sc1
  buffer_load_dwordx4 v[152:155], v21, s[4:7], s33 offen offset:1024 sc1
  buffer_load_dwordx4 v[156:159], v21, s[4:7], s33 offen offset:1536 sc1
  s_mov_b32 s38, 0
.fz_kernel_c_gu:
  s_mov_b32 s46, 0
  s_call_b64 s[0:1], .fz_kernel_hw
  s_waitcnt vmcnt(0)
  v_min3_u32 v9, v144, v146, v148
  v_min3_u32 v9, v9, v150, v152
  v_min3_u32 v9, v9, v154, v156
  v_min_u32 v9, v9, v158
  v_cmp_eq_u32 vcc, 0, v9
  v_add_f32 v160, v144, v148
  v_add_f32 v161, v145, v149
  v_add_f32 v162, v146, v150
  v_add_f32 v163, v147, v151
  s_cbranch_vccnz .fz_kernel_c_gur
.fz_kernel_c_gud:
  v_add_f32 v152, v152, v156
  v_add_f32 v153, v153, v157
  v_add_f32 v154, v154, v158
  v_add_f32 v155, v155, v159
  v_add_f32 v144, v152, v160
  v_add_f32 v145, v153, v161
  v_add_f32 v146, v154, v162
  v_add_f32 v147, v155, v163
  s_nop 0
  v_permlane32_swap_b32 v144, v146
  v_permlane32_swap_b32 v145, v147
  v_mul_f32 v148, v144, v177
  v_mul_f32 v149, v145, v177
  v_exp_f32 v148, v148
  s_cmp_eq_u32 s3, 0
  s_cbranch_scc1 .fz_kernel_hb82
  s_barrier
  s_sub_u32 s3, s3, 1
.fz_kernel_hb82:
  v_exp_f32 v149, v149
  v_mul_f32 v144, v144, v146
  v_add_f32 v148, 1.0, v148
  v_add_f32 v149, 1.0, v149
  v_rcp_f32 v148, v148
  v_rcp_f32 v149, v149
  v_mul_f32 v145, v145, v147
  v_mul_f32 v144, v144, v148
  v_mul_f32 v145, v145, v149
  v_cvt_pk_bf16_f32 v144, v144, v145
  s_waitcnt lgkmcnt(0)
  s_setprio 2
  v_mov_b32 v160, v144 row_newbcast:0 row_mask:0xf bank_mask:0xf
  v_mov_b32 v161, v144 row_newbcast:1 row_mask:0xf bank_mask:0xf
  v_mov_b32 v162, v144 row_newbcast:2 row_mask:0xf bank_mask:0xf
  v_mov_b32 v163, v144 row_newbcast:3 row_mask:0xf bank_mask:0xf
  v_mov_b32 v164, v144 row_newbcast:4 row_mask:0xf bank_mask:0xf
  v_mov_b32 v165, v144 row_newbcast:5 row_mask:0xf bank_mask:0xf
  v_mov_b32 v166, v144 row_newbcast:6 row_mask:0xf bank_mask:0xf
  v_mov_b32 v167, v144 row_newbcast:7 row_mask:0xf bank_mask:0xf
  v_mfma_f32_16x16x32_bf16 v[208:211], v[160:163], v[80:83], 0
  v_mfma_f32_16x16x32_bf16 v[212:215], v[160:163], v[84:87], 0
  v_mfma_f32_16x16x32_bf16 v[216:219], v[160:163], v[88:91], 0
  v_mfma_f32_16x16x32_bf16 v[220:223], v[160:163], v[92:95], 0
  v_mov_b32 v168, v144 row_newbcast:8 row_mask:0xf bank_mask:0xf
  v_mov_b32 v169, v144 row_newbcast:9 row_mask:0xf bank_mask:0xf
  v_mov_b32 v170, v144 row_newbcast:10 row_mask:0xf bank_mask:0xf
  v_mov_b32 v171, v144 row_newbcast:11 row_mask:0xf bank_mask:0xf
  v_mfma_f32_16x16x32_bf16 v[208:211], v[164:167], v[96:99], v[208:211]
  v_mfma_f32_16x16x32_bf16 v[212:215], v[164:167], v[100:103], v[212:215]
  v_mfma_f32_16x16x32_bf16 v[216:219], v[164:167], v[104:107], v[216:219]
  v_mfma_f32_16x16x32_bf16 v[220:223], v[164:167], v[108:111], v[220:223]
  v_mov_b32 v172, v144 row_newbcast:12 row_mask:0xf bank_mask:0xf
  v_mov_b32 v173, v144 row_newbcast:13 row_mask:0xf bank_mask:0xf
  v_mov_b32 v174, v144 row_newbcast:14 row_mask:0xf bank_mask:0xf
  v_mov_b32 v175, v144 row_newbcast:15 row_mask:0xf bank_mask:0xf
  v_mfma_f32_16x16x32_bf16 v[208:211], v[168:171], v[112:115], v[208:211]
  v_mfma_f32_16x16x32_bf16 v[212:215], v[168:171], v[116:119], v[212:215]
  v_mfma_f32_16x16x32_bf16 v[216:219], v[168:171], v[120:123], v[216:219]
  v_mfma_f32_16x16x32_bf16 v[220:223], v[168:171], v[124:127], v[220:223]
  v_mfma_f32_16x16x32_bf16 v[208:211], v[172:175], v[128:131], v[208:211]
  v_mfma_f32_16x16x32_bf16 v[212:215], v[172:175], v[132:135], v[212:215]
  v_mfma_f32_16x16x32_bf16 v[216:219], v[172:175], v[136:139], v[216:219]
  v_mfma_f32_16x16x32_bf16 v[220:223], v[172:175], v[140:143], v[220:223]
  s_nop 4
  v_or_b32 v208, 1, v208
  v_mov_b32 v209, v212
  v_or_b32 v210, 1, v216
  v_mov_b32 v211, v220
  s_mov_b64 exec, 0xffff
  buffer_store_dwordx4 v[208:211], v3, s[4:7], s39 offen offset:0 sc1
  s_mov_b64 exec, -1
  s_setprio 0
.fz_kernel_c_nd:
  s_cmp_eq_u32 s75, 0
  s_cbranch_scc1 .fz_kernel_c_m0
  s_lshl_b32 s21, s17, 1
  s_add_u32 s21, s21, s20
  s_cmp_lg_u32 s21, 31
  s_cbranch_scc1 .fz_kernel_fin
  s_branch .fz_kernel_c_pp
.fz_kernel_c_m0:
  s_cmp_eq_u32 s79, 0
  s_cselect_b32 s21, 2, 0
  s_add_u32 s3, s3, s21
.fz_kernel_c_pp:
  s_mul_i32 s21, s70, 7168
  s_add_u32 s21, s21, s72
  s_add_u32 s21, s21, 155648
  s_add_u32 s22, s21, 4096
  s_cmp_eq_u32 s3, 0
  s_cbranch_scc1 .fz_kernel_hb75
  s_barrier
  s_sub_u32 s3, s3, 1
.fz_kernel_hb75:
  s_cmp_eq_u32 s3, 0
  s_cbranch_scc1 .fz_kernel_hb76
  s_barrier
  s_sub_u32 s3, s3, 1
.fz_kernel_hb76:
  s_cmp_eq_u32 s3, 0
  s_cbranch_scc1 .fz_kernel_hb77
  s_barrier
  s_sub_u32 s3, s3, 1
.fz_kernel_hb77:
  buffer_load_dwordx4 v[144:147], v3, s[4:7], s21 offen offset:0 sc1
  buffer_load_dwordx4 v[148:151], v3, s[4:7], s21 offen offset:1024 sc1
  buffer_load_dwordx4 v[152:155], v3, s[4:7], s21 offen offset:2048 sc1
  buffer_load_dwordx4 v[156:159], v3, s[4:7], s21 offen offset:3072 sc1
  buffer_load_dwordx4 v[160:163], v3, s[4:7], s22 offen offset:0 sc1
  buffer_load_dwordx4 v[164:167], v3, s[4:7], s22 offen offset:1024 sc1
  buffer_load_dwordx4 v[168:171], v3, s[4:7], s22 offen offset:2048 sc1
  s_mov_b32 s38, 0
.fz_kernel_c_pu:
  s_mov_b32 s46, 0
  s_call_b64 s[0:1], .fz_kernel_hw
  s_waitcnt vmcnt(0)
  v_min3_u32 v9, v144, v146, v148
  v_min3_u32 v9, v9, v150, v152
  v_min3_u32 v9, v9, v154, v156
  v_min3_u32 v9, v9, v158, v160
  v_min3_u32 v9, v9, v162, v164
  v_min3_u32 v9, v9, v166, v168
  v_min_u32 v9, v9, v170
  v_cmp_eq_u32 vcc, 0, v9
  v_add_f32 v236, v144, v148
  v_add_f32 v237, v145, v149
  v_add_f32 v238, v146, v150
  v_add_f32 v239, v147, v151
  s_cbranch_vccnz .fz_kernel_c_pur
.fz_kernel_c_pud:
  v_add_f32 v152, v152, v156
  v_add_f32 v153, v153, v157
  v_add_f32 v154, v154, v158
  v_add_f32 v155, v155, v159
  v_add_f32 v160, v160, v164
  v_add_f32 v161, v161, v165
  v_add_f32 v162, v162, v166
  s_cmp_eq_u32 s3, 0
  s_cbranch_scc1 .fz_kernel_hb83
  s_barrier
  s_sub_u32 s3, s3, 1
.fz_kernel_hb83:
  v_add_f32 v163, v163, v167
  v_add_f32 v236, v236, v168
  v_add_f32 v237, v237, v169
  v_add_f32 v238, v238, v170
  v_add_f32 v239, v239, v171
  v_add_f32 v152, v152, v160
  v_add_f32 v153, v153, v161
  v_add_f32 v154, v154, v162
  v_add_f32 v155, v155, v163
  v_add_f32 v144, v236, v152
  v_add_f32 v146, v238, v154
  v_add_f32 v145, v237, v153
  v_add_f32 v147, v239, v155
  v_permlane32_swap_b32 v144, v146
  s_nop 0
  v_permlane32_swap_b32 v145, v147
  v_add_f32 v144, v144, v146
  v_add_f32 v145, v145, v147
  v_lshlrev_b32 v184, 16, v184
  s_nop 0
  v_permlane16_swap_b32 v144, v145
  v_add_f32 v144, v144, v145
  v_mul_f32 v144, v144, v1
  v_fma_f32 v184, v184, v178, v179
  s_nop 0
  v_mov_b32 v145, v144 quad_perm:[1,0,3,2] row_mask:0xf bank_mask:0xf
  v_cvt_pk_bf16_f32 v144, v144, v145
  s_or_b32 s21, s75, s71
  s_cbranch_scc1 .fz_kernel_c_w7
  s_mul_i32 s21, s20, 384
  s_add_u32 s21, s21, s60
  v_mov_b32 v180, v144 row_newbcast:0 row_mask:0xf bank_mask:0xf
  v_mov_b32 v181, v144 row_newbcast:2 row_mask:0xf bank_mask:0xf
  v_mov_b32 v182, v144 row_newbcast:4 row_mask:0xf bank_mask:0xf
  v_mov_b32 v183, v144 row_newbcast:6 row_mask:0xf bank_mask:0xf
  s_cmp_eq_u32 s3, 0
  s_cbranch_scc1 .fz_kernel_hb79
  s_barrier
  s_sub_u32 s3, s3, 1
.fz_kernel_hb79:
  s_setprio 2
  v_mfma_f32_16x16x32_bf16 v[208:211], v[180:183], v[32:35], 0
  v_mov_b32 v232, v144 row_newbcast:8 row_mask:0xf bank_mask:0xf
  v_mfma_f32_16x16x32_bf16 v[212:215], v[180:183], v[36:39], 0
  v_mov_b32 v233, v144 row_newbcast:10 row_mask:0xf bank_mask:0xf
  v_mfma_f32_16x16x32_bf16 v[216:219], v[180:183], v[40:43], 0
  v_mov_b32 v234, v144 row_newbcast:12 row_mask:0xf bank_mask:0xf
  v_mfma_f32_16x16x32_bf16 v[220:223], v[180:183], v[44:47], 0
  v_mov_b32 v235, v144 row_newbcast:14 row_mask:0xf bank_mask:0xf
  v_mfma_f32_16x16x32_bf16 v[224:227], v[180:183], v[48:51], 0
  v_mfma_f32_16x16x32_bf16 v[228:231], v[180:183], v[52:55], 0
  v_mfma_f32_16x16x32_bf16 v[208:211], v[232:235], v[56:59], v[208:211]
  v_mfma_f32_16x16x32_bf16 v[212:215], v[232:235], v[60:63], v[212:215]
  v_mfma_f32_16x16x32_bf16 v[216:219], v[232:235], v[64:67], v[216:219]
  v_mfma_f32_16x16x32_bf16 v[220:223], v[232:235], v[68:71], v[220:223]
  v_mfma_f32_16x16x32_bf16 v[224:227], v[232:235], v[72:75], v[224:227]
  v_mfma_f32_16x16x32_bf16 v[228:231], v[232:235], v[76:79], v[228:231]
  s_nop 2
  v_or_b32 v208, 1, v208
  v_mov_b32 v209, v212
  v_or_b32 v210, 1, v216
  v_mov_b32 v211, v220
  s_mov_b64 exec, 0xffff
  buffer_store_dwordx4 v[208:211], v3, s[4:7], s21 offen offset:0 sc1
  v_or_b32 v224, 1, v224
  v_mov_b32 v225, v228
  buffer_store_dwordx2 v[224:225], v16, s[4:7], s21 offen offset:256 sc1
  s_mov_b64 exec, -1
  s_setprio 0
  s_cmp_lg_u32 s20, 0
  s_cbranch_scc1 .fz_kernel_c_w7
  s_cmp_eq_u32 s79, 0
  s_cbranch_scc1 .fz_kernel_c_no2
  v_add_u32 v13, 155648, v3
  s_lshl_b32 s21, s18, 14
  s_add_u32 s21, s21, 0x1c84000
  s_add_u32 s22, s21, 4096
  s_add_u32 s23, s21, 8192
  s_add_u32 s24, s21, 12288
  v_rcp_f32 v144, v178
  v_lshlrev_b32 v146, 1, v2
  v_sub_u32 v146, s79, v146
  v_cmp_eq_u32 s[28:29], 1, v146
  v_cmp_eq_u32 s[30:31], 2, v146
  s_nop 0
  v_cndmask_b32 v148, 0, v144, s[28:29]
  v_cndmask_b32 v149, 0, v144, s[30:31]
  v_mov_b32 v9, 159952
  v_mov_b32 v7, s79
  ds_write_b32 v9, v7
  ds_write_b64 v26, v[148:149] offset:512
  s_lshl_b32 s25, s79, 2
  s_add_u32 s25, s25, 155644
  s_cmp_eq_u32 s3, 0
  s_cbranch_scc1 .fz_kernel_hb84
  s_barrier
  s_sub_u32 s3, s3, 1
.fz_kernel_hb84:
  v_mov_b32 v7, s25
  v_mov_b32 v152, 0
  v_mov_b32 v153, 0
  v_mov_b32 v154, 0
  v_mov_b32 v155, 0
  s_bfm_b64 exec, 49, 0
  s_mov_b32 s38, 0
  s_mov_b32 s25, 15
.fz_kernel_c_pw:
  s_cmp_le_u32 s3, 3
  s_cbranch_scc1 .fz_kernel_c_pw1
  s_barrier
  s_sub_u32 s3, s3, 1
  s_branch .fz_kernel_c_pw
.fz_kernel_c_pw1:
  s_setprio 2
.fz_kernel_c_pd:
  s_bitcmp1_b32 s25, 0
  s_cbranch_scc0 .fz_kernel_c_pl0
  buffer_load_dwordx4 v[80:83], v3, s[4:7], s21 offen offset:0 sc1
  buffer_load_dwordx4 v[84:87], v3, s[4:7], s21 offen offset:1024 sc1
  buffer_load_dwordx4 v[88:91], v3, s[4:7], s21 offen offset:2048 sc1
  buffer_load_dwordx4 v[92:95], v3, s[4:7], s21 offen offset:3072 sc1
.fz_kernel_c_pl0:
  s_bitcmp1_b32 s25, 1
  s_cbranch_scc0 .fz_kernel_c_pl1
  buffer_load_dwordx4 v[96:99], v3, s[4:7], s22 offen offset:0 sc1
  buffer_load_dwordx4 v[100:103], v3, s[4:7], s22 offen offset:1024 sc1
  buffer_load_dwordx4 v[104:107], v3, s[4:7], s22 offen offset:2048 sc1
  buffer_load_dwordx4 v[108:111], v3, s[4:7], s22 offen offset:3072 sc1
.fz_kernel_c_pl1:
  s_bitcmp1_b32 s25, 2
  s_cbranch_scc0 .fz_kernel_c_pl2
  buffer_load_dwordx4 v[112:115], v3, s[4:7], s23 offen offset:0 sc1
  buffer_load_dwordx4 v[116:119], v3, s[4:7], s23 offen offset:1024 sc1
  buffer_load_dwordx4 v[120:123], v3, s[4:7], s23 offen offset:2048 sc1
  buffer_load_dwordx4 v[124:127], v3, s[4:7], s23 offen offset:3072 sc1
.fz_kernel_c_pl2:
  s_bitcmp1_b32 s25, 3
  s_cbranch_scc0 .fz_kernel_c_pl3
  buffer_load_dwordx4 v[128:131], v3, s[4:7], s24 offen offset:0 sc1
  buffer_load_dwordx4 v[132:135], v3, s[4:7], s24 offen offset:1024 sc1
  buffer_load_dwordx4 v[136:139], v3, s[4:7], s24 offen offset:2048 sc1
  buffer_load_dwordx4 v[140:143], v3, s[4:7], s24 offen offset:3072 sc1
.fz_kernel_c_pl3:
  s_add_u32 s38, s38, 1
  s_mov_b32 s46, 0
  s_call_b64 s[0:1], .fz_kernel_hw
  s_waitcnt vmcnt(0)
  s_bitcmp1_b32 s25, 0
  s_cbranch_scc0 .fz_kernel_c_pa0
  v_min3_u32 v9, v80, v82, v84
  v_min3_u32 v9, v9, v86, v88
  v_min3_u32 v9, v9, v90, v92
  v_min_u32 v9, v9, v94
  v_cmp_eq_u32 vcc, 0, v9
  v_add_f32 v80, v80, v84
  v_add_f32 v81, v81, v85
  v_add_f32 v82, v82, v86
  v_add_f32 v83, v83, v87
  s_cbranch_vccnz .fz_kernel_c_pa0
  v_add_f32 v88, v88, v92
  v_add_f32 v89, v89, v93
  v_add_f32 v90, v90, v94
  v_add_f32 v91, v91, v95
  v_add_f32 v152, v152, v80
  v_add_f32 v153, v153, v81
  v_add_f32 v154, v154, v82
  v_add_f32 v155, v155, v83
  v_add_f32 v152, v152, v88
  v_add_f32 v153, v153, v89
  v_add_f32 v154, v154, v90
  v_add_f32 v155, v155, v91
  s_bitset0_b32 s25, 0
.fz_kernel_c_pa0:
  s_bitcmp1_b32 s25, 1
  s_cbranch_scc0 .fz_kernel_c_pa1
  v_min3_u32 v9, v96, v98, v100
  v_min3_u32 v9, v9, v102, v104
  v_min3_u32 v9, v9, v106, v108
  v_min_u32 v9, v9, v110
  v_cmp_eq_u32 vcc, 0, v9
  v_add_f32 v96, v96, v100
  v_add_f32 v97, v97, v101
  v_add_f32 v98, v98, v102
  v_add_f32 v99, v99, v103
  s_cbranch_vccnz .fz_kernel_c_pa1
  v_add_f32 v104, v104, v108
  v_add_f32 v105, v105, v109
  v_add_f32 v106, v106, v110
  v_add_f32 v107, v107, v111
  v_add_f32 v152, v152, v96
  v_add_f32 v153, v153, v97
  v_add_f32 v154, v154, v98
  v_add_f32 v155, v155, v99
  v_add_f32 v152, v152, v104
  v_add_f32 v153, v153, v105
  v_add_f32 v154, v154, v106
  v_add_f32 v155, v155, v107
  s_bitset0_b32 s25, 1
.fz_kernel_c_pa1:
  s_bitcmp1_b32 s25, 2
  s_cbranch_scc0 .fz_kernel_c_pa2
  v_min3_u32 v9, v112, v114, v116
  v_min3_u32 v9, v9, v118, v120
  v_min3_u32 v9, v9, v122, v124
  v_min_u32 v9, v9, v126
  v_cmp_eq_u32 vcc, 0, v9
  v_add_f32 v112, v112, v116
  v_add_f32 v113, v113, v117
  v_add_f32 v114, v114, v118
  v_add_f32 v115, v115, v119
  s_cbranch_vccnz .fz_kernel_c_pa2
  v_add_f32 v120, v120, v124
  v_add_f32 v121, v121, v125
  v_add_f32 v122, v122, v126
  v_add_f32 v123, v123, v127
  v_add_f32 v152, v152, v112
  v_add_f32 v153, v153, v113
  v_add_f32 v154, v154, v114
  v_add_f32 v155, v155, v115
  v_add_f32 v152, v152, v120
  v_add_f32 v153, v153, v121
  v_add_f32 v154, v154, v122
  v_add_f32 v155, v155, v123
  s_bitset0_b32 s25, 2
.fz_kernel_c_pa2:
  s_bitcmp1_b32 s25, 3
  s_cbranch_scc0 .fz_kernel_c_pa3
  v_min3_u32 v9, v128, v130, v132
  v_min3_u32 v9, v9, v134, v136
  v_min3_u32 v9, v9, v138, v140
  v_min_u32 v9, v9, v142
  v_cmp_eq_u32 vcc, 0, v9
  v_add_f32 v128, v128, v132
  v_add_f32 v129, v129, v133
  v_add_f32 v130, v130, v134
  v_add_f32 v131, v131, v135
  s_cbranch_vccnz .fz_kernel_c_pa3
  v_add_f32 v136, v136, v140
  v_add_f32 v137, v137, v141
  v_add_f32 v138, v138, v142
  v_add_f32 v139, v139, v143
  v_add_f32 v152, v152, v128
  v_add_f32 v153, v153, v129
  v_add_f32 v154, v154, v130
  v_add_f32 v155, v155, v131
  v_add_f32 v152, v152, v136
  v_add_f32 v153, v153, v137
  v_add_f32 v154, v154, v138
  v_add_f32 v155, v155, v139
  s_bitset0_b32 s25, 3
.fz_kernel_c_pa3:
  s_cmp_eq_u32 s25, 0
  s_cbranch_scc1 .fz_kernel_c_pdd
  s_cmp_lt_u32 s38, 131072
  s_cbranch_scc1 .fz_kernel_c_pd
.fz_kernel_c_pdd:
  s_mov_b32 exec_hi, 0xffff
  ds_write_b128 v13, v[152:155] offset:1536
  s_mov_b64 exec, -1
  v_readlane_b32 s21, v152, 48
  v_readlane_b32 s22, v154, 48
  s_nop 0
  v_mul_f32 v144, s21, v23
  v_fma_f32 v145, s22, v23, v25
  v_fma_f32 v145, -v144, v144, v145
  v_rsq_f32 v145, abs(v145)
  v_sub_f32 v144, v179, v144
  v_mul_f32 v146, v145, v178
  v_mul_f32 v147, v145, v144
  ds_write_b32 v7, v146 offset:4608
  ds_write_b32 v7, v147 offset:5120
  s_waitcnt lgkmcnt(0)
  s_add_u32 s3, s3, 2
  s_setprio 0
.fz_kernel_c_no2:
  s_branch .fz_kernel_q_he
.fz_kernel_c_w7:
  s_setprio 2
  v_lshlrev_b32 v144, 16, v144
  s_cmp_lg_u32 s71, 0
  s_cbranch_scc1 .fz_kernel_c_eu
  v_add_f32 v184, v184, v144
  s_cmp_lg_u32 s75, 0
  s_cbranch_scc1 .fz_kernel_c_t3
  v_mul_f32 v146, v184, v184
  v_lshrrev_b32 v9, 5, v2
  v_lshlrev_b32 v9, 3, v9
  v_permlane32_swap_b32 v184, v146
  v_add_f32 v184, v184, v146
  s_nop 1
  v_add_f32 v184, v184, v184 row_ror:8 row_mask:0xf bank_mask:0xf
  s_nop 1
  v_add_f32 v184, v184, v184 row_ror:4 row_mask:0xf bank_mask:0xf
  s_nop 1
  v_add_f32 v184, v184, v184 row_ror:2 row_mask:0xf bank_mask:0xf
  s_nop 1
  v_add_f32 v184, v184, v184 row_ror:1 row_mask:0xf bank_mask:0xf
  s_nop 1
  v_add_f32 v184, v184, v184 row_bcast:15 row_mask:0xa bank_mask:0xf
  v_or_b32 v184, 1, v184
  s_mov_b32 exec_lo, 0x10000
  s_mov_b32 exec_hi, 0x10000
  buffer_store_dword v184, v9, s[4:7], s60 offen offset:768 sc1
  s_mov_b64 exec, -1
  s_setprio 0
  s_cmp_eq_u32 s79, 0
  s_cbranch_scc1 .fz_kernel_q_he
  s_add_u32 s3, s3, 2
  s_mov_b32 s71, 1
  s_mov_b32 s70, s18
.fz_kernel_c_e0:
  s_cmp_eq_u32 s3, 0
  s_cbranch_scc1 .fz_kernel_c_pp
  s_barrier
  s_sub_u32 s3, s3, 1
  s_branch .fz_kernel_c_e0
.fz_kernel_c_eu:
  v_lshlrev_b32 v9, 2, v2
  v_add_u32 v9, 155648, v9
  ds_write_b32 v9, v144 offset:7424
  s_waitcnt lgkmcnt(0)
  s_branch .fz_kernel_q_he
.fz_kernel_c_t3:
  s_mov_b32 s28, s56
  s_mov_b32 s29, s57
  s_mov_b32 s30, 0x400000
  s_mov_b32 s31, 0x00020000
  v_cvt_pk_bf16_f32 v144, v184, v184
  v_lshlrev_b32 v9, 1, v2
  s_lshl_b32 s21, s77, 11
  s_lshl_b32 s22, s18, 7
  s_add_u32 s21, s21, s22
  buffer_store_short v144, v9, s[28:31], s21 offen
.fz_kernel_fin:
.fz_kernel_end:
  s_endpgm
.fz_kernel_pick:
  s_mov_b32 s38, 0
.fz_kernel_pick_l:
  ds_read_b32 v7, v6
  s_add_u32 s38, s38, 1
  s_waitcnt lgkmcnt(0)
  v_readfirstlane_b32 s33, v7
  s_cmp_lt_u32 s38, 1048576
  s_cselect_b32 s33, s33, 0xffff
  s_andn2_b32 s36, s33, s34
  s_cbranch_scc0 .fz_kernel_pick_l
  s_or_b32 s34, s34, s33
  s_setpc_b64 s[68:69]
.fz_kernel_hw:
  s_mov_b32 s47, 0
.fz_kernel_hwl:
  s_getreg_b32 s100, hwreg(HW_REG_IB_STS)
  s_bfe_u32 s101, s100, 0x20016
  s_and_b32 s100, s100, 15
  s_lshl4_add_u32 s100, s101, s100
  s_cmp_le_u32 s100, s46
  s_cbranch_scc1 .fz_kernel_hwr
  s_sub_u32 s47, s47, 1
  s_cbranch_scc0 .fz_kernel_hwl
  s_cmp_eq_u32 s3, 0
  s_cbranch_scc1 .fz_kernel_hwr
  s_cmp_eq_u32 s3, 32
  s_cbranch_scc1 .fz_kernel_hwp
.fz_kernel_hwb:
  s_barrier
  s_sub_u32 s3, s3, 1
  s_mov_b32 s47, 2
  s_branch .fz_kernel_hwl
.fz_kernel_hwr:
  s_setpc_b64 s[0:1]
  .fz_kernel_hwp:
  ds_read_b32 v27, v6 offset:0x110
  s_mov_b32 s47, 0
  s_waitcnt lgkmcnt(0)
  v_readfirstlane_b32 s100, v27
  s_cmp_ge_u32 s100, 0x200
  s_cbranch_scc1 .fz_kernel_hwb
  s_branch .fz_kernel_hwl
.fz_kernel_q_cons2:
  s_setprio 0
  s_lshr_b32 s26, s16, 1
  s_lshl_b32 s28, s26, 13
  v_add_u32 v8, s28, v3
  v_add_u32 v9, 1024, v8
  v_mov_b32 v232, v20
  v_mov_b32 v233, v21
  v_mov_b32 v234, v22
  v_mov_b32 v235, v23
  v_mov_b32 v236, v24
  v_mov_b32 v237, v25
  v_mov_b32 v238, v26
  v_mov_b32 v239, v27
  v_mov_b32 v240, v28
  v_mov_b32 v241, v29
  v_mov_b32 v242, v30
  v_mov_b32 v243, v31
  v_mov_b32 v244, v32
  v_mov_b32 v245, v33
  v_mov_b32 v246, v34
  v_mov_b32 v247, v35
  s_branch .fz_kernel_q_cs
.fz_kernel_q_patch:
  s_mul_i32 s31, s27, 384
  s_add_u32 s31, s31, 155648
  v_and_b32 v73, 48, v2
  v_lshlrev_b32 v73, 2, v73
  v_add_u32 v73, s31, v73
  v_and_b32 v75, 15, v2
  v_lshlrev_b32 v75, 3, v75
  v_add_u32 v75, s31, v75
  ds_read_b32 v72, v22 offset:512
  ds_read_b32 v74, v22 offset:576
  ds_read_b32 v76, v22 offset:640
  ds_read_b32 v78, v22 offset:704
  ds_read_b128 v[80:83], v73 offset:1536
  ds_read_b128 v[84:87], v73 offset:1552
  ds_read_b128 v[88:91], v73 offset:1568
  ds_read_b128 v[92:95], v73 offset:1584
  s_waitcnt lgkmcnt(0)
  v_fmac_f32 v160, v82, v72
  v_fmac_f32 v161, v86, v72
  v_fmac_f32 v162, v90, v72
  v_fmac_f32 v163, v94, v72
  v_fmac_f32 v164, v82, v74
  v_fmac_f32 v165, v86, v74
  v_fmac_f32 v166, v90, v74
  v_fmac_f32 v167, v94, v74
  v_fmac_f32 v168, v82, v76
  v_fmac_f32 v169, v86, v76
  v_fmac_f32 v170, v90, v76
  v_fmac_f32 v171, v94, v76
  v_fmac_f32 v172, v82, v78
  v_fmac_f32 v173, v86, v78
  v_fmac_f32 v174, v90, v78
  v_fmac_f32 v175, v94, v78
  v_fmac_f32 v176, v83, v72
  v_fmac_f32 v177, v87, v72
  v_fmac_f32 v178, v91, v72
  v_fmac_f32 v179, v95, v72
  v_fmac_f32 v180, v83, v74
  v_fmac_f32 v181, v87, v74
  v_fmac_f32 v182, v91, v74
  v_fmac_f32 v183, v95, v74
  v_fmac_f32 v184, v83, v76
  v_fmac_f32 v185, v87, v76
  v_fmac_f32 v186, v91, v76
  v_fmac_f32 v187, v95, v76
  v_fmac_f32 v188, v83, v78
  v_fmac_f32 v189, v87, v78
  v_fmac_f32 v190, v91, v78
  v_fmac_f32 v191, v95, v78
  v_fmac_f32 v128, v80, v72
  v_fmac_f32 v129, v84, v72
  v_fmac_f32 v130, v88, v72
  v_fmac_f32 v131, v92, v72
  v_fmac_f32 v132, v80, v74
  v_fmac_f32 v133, v84, v74
  v_fmac_f32 v134, v88, v74
  v_fmac_f32 v135, v92, v74
  v_fmac_f32 v136, v80, v76
  v_fmac_f32 v137, v84, v76
  v_fmac_f32 v138, v88, v76
  v_fmac_f32 v139, v92, v76
  v_fmac_f32 v140, v80, v78
  v_fmac_f32 v141, v84, v78
  v_fmac_f32 v142, v88, v78
  v_fmac_f32 v143, v92, v78
  v_fmac_f32 v144, v81, v72
  v_fmac_f32 v145, v85, v72
  v_fmac_f32 v146, v89, v72
  v_fmac_f32 v147, v93, v72
  v_fmac_f32 v148, v81, v74
  v_fmac_f32 v149, v85, v74
  v_fmac_f32 v150, v89, v74
  v_fmac_f32 v151, v93, v74
  v_fmac_f32 v152, v81, v76
  v_fmac_f32 v153, v85, v76
  v_fmac_f32 v154, v89, v76
  v_fmac_f32 v155, v93, v76
  v_fmac_f32 v156, v81, v78
  v_fmac_f32 v157, v85, v78
  v_fmac_f32 v158, v89, v78
  v_fmac_f32 v159, v93, v78
  ds_read_b128 v[80:83], v23 offset:512
  ds_read_b128 v[84:87], v23 offset:576
  ds_read_b128 v[88:91], v23 offset:640
  ds_read_b128 v[92:95], v23 offset:704
  ds_read_b64 v[72:73], v75 offset:1792
  s_waitcnt lgkmcnt(0)
  v_fmac_f32 v192, v80, v72
  v_fmac_f32 v193, v81, v72
  v_fmac_f32 v194, v82, v72
  v_fmac_f32 v195, v83, v72
  v_fmac_f32 v196, v84, v72
  v_fmac_f32 v197, v85, v72
  v_fmac_f32 v198, v86, v72
  v_fmac_f32 v199, v87, v72
  v_fmac_f32 v200, v88, v72
  v_fmac_f32 v201, v89, v72
  v_fmac_f32 v202, v90, v72
  v_fmac_f32 v203, v91, v72
  v_fmac_f32 v204, v92, v72
  v_fmac_f32 v205, v93, v72
  v_fmac_f32 v206, v94, v72
  v_fmac_f32 v207, v95, v72
  v_fmac_f32 v208, v80, v73
  v_fmac_f32 v209, v81, v73
  v_fmac_f32 v210, v82, v73
  v_fmac_f32 v211, v83, v73
  v_fmac_f32 v212, v84, v73
  v_fmac_f32 v213, v85, v73
  v_fmac_f32 v214, v86, v73
  v_fmac_f32 v215, v87, v73
  v_fmac_f32 v216, v88, v73
  v_fmac_f32 v217, v89, v73
  v_fmac_f32 v218, v90, v73
  v_fmac_f32 v219, v91, v73
  v_fmac_f32 v220, v92, v73
  v_fmac_f32 v221, v93, v73
  v_fmac_f32 v222, v94, v73
  v_fmac_f32 v223, v95, v73
  s_branch .fz_kernel_q_pback
.fz_kernel_q_prod2:
  s_setprio 0
  s_mov_b64 s[8:9], s[4:5]
  s_mov_b64 s[10:11], s[6:7]
  s_mov_b64 s[12:13], s[42:43]
  s_lshl_b32 s35, s17, 6
  s_and_b32 s31, s16, 1
  s_add_u32 s35, s35, s31
  s_lshl_b32 s35, s35, 12
  s_add_u32 s35, s35, s73
  s_lshr_b32 s33, s17, 3
  s_add_u32 s29, s18, s33
  s_lshl1_add_u32 s29, s17, s29
  s_and_b32 s29, s29, 15
  s_mov_b32 s22, 16384
  s_mov_b32 s23, 8192
  s_mov_b32 s36, 0
  s_add_u32 s37, s19, s74
  s_add_u32 s37, s37, 8
  v_mov_b32 v40, v3
  v_mov_b32 v41, v3
  v_mov_b32 v42, v3
  v_mov_b32 v43, v3
  s_branch .fz_kernel_q_pc
.fz_kernel_xok1w:
  s_call_b64 s[68:69], .fz_kernel_q_xw
  s_branch .fz_kernel_xok1
.fz_kernel_xok2w:
  s_call_b64 s[68:69], .fz_kernel_q_xw
  s_branch .fz_kernel_xok2
.fz_kernel_q_xw:
  s_mov_b64 exec, 1
  s_mov_b32 s38, 0
.fz_kernel_q_xwl:
  ds_read_b32 v11, v6 offset:0x114
  s_add_u32 s38, s38, 1
  s_waitcnt lgkmcnt(0)
  v_readfirstlane_b32 s36, v11
  s_bitcmp1_b32 s36, s24
  s_cbranch_scc1 .fz_kernel_q_xwd
  s_cmp_lt_u32 s38, 1048576
  s_cbranch_scc1 .fz_kernel_q_xwl
  s_mov_b32 s36, -1
.fz_kernel_q_xwd:
  s_mov_b64 exec, -1
  s_nop 4
  s_setpc_b64 s[68:69]
.fz_kernel_xok3w:
  s_call_b64 s[68:69], .fz_kernel_q_xw
  s_branch .fz_kernel_xok3
.fz_kernel_lz26a:
  v_lshlrev_b32 v16, 3, v2
  buffer_atomic_and_x2 v[12:13], v16, s[4:7], s36 offen offset:0 sc1
  buffer_atomic_and_x2 v[12:13], v16, s[4:7], s36 offen offset:512 sc1
  buffer_atomic_and_x2 v[12:13], v16, s[4:7], s36 offen offset:1024 sc1
  buffer_atomic_and_x2 v[12:13], v16, s[4:7], s36 offen offset:1536 sc1
  buffer_atomic_and_x2 v[12:13], v16, s[4:7], s36 offen offset:2048 sc1
  buffer_atomic_and_x2 v[12:13], v16, s[4:7], s36 offen offset:2560 sc1
  buffer_atomic_and_x2 v[12:13], v16, s[4:7], s36 offen offset:3072 sc1
  buffer_atomic_and_x2 v[12:13], v16, s[4:7], s36 offen offset:3584 sc1
  s_branch .fz_kernel_lz26
.fz_kernel_a_pick:
  s_mov_b32 s38, 0
.fz_kernel_a_pickl:
  ds_read_b32 v7, v6
  s_add_u32 s38, s38, 1
  s_waitcnt lgkmcnt(0)
  v_readfirstlane_b32 s33, v7
  s_cmp_lt_u32 s38, 1048576
  s_cselect_b32 s33, s33, 0xffff
  s_andn2_b32 s36, s33, s34
  s_cbranch_scc0 .fz_kernel_a_pickl
  s_or_b32 s34, s34, s33
  s_ff1_i32_b32 s33, s36
  s_bitset0_b32 s36, s33
  s_lshl_b32 s33, s33, 14
  s_add_u32 s30, s33, s35
  s_setpc_b64 s[68:69]
.fz_kernel_pk33c:
  v_mov_b32 v7, s34
  s_brev_b32 s30, 2
  s_cmp_eq_u32 s34, 0xffff
  ds_write_b32 v6, v7 offset:0x104
  s_cbranch_scc1 .fz_kernel_pk33
  s_call_b64 s[68:69], .fz_kernel_a_pick
  s_branch .fz_kernel_pk33
.fz_kernel_pk34c:
  v_mov_b32 v7, s34
  s_brev_b32 s30, 2
  s_cmp_eq_u32 s34, 0xffff
  ds_write_b32 v6, v7 offset:0x104
  s_cbranch_scc1 .fz_kernel_pk34
  s_call_b64 s[68:69], .fz_kernel_a_pick
  s_branch .fz_kernel_pk34
.fz_kernel_pk35c:
  v_mov_b32 v7, s34
  s_brev_b32 s30, 2
  s_cmp_eq_u32 s34, 0xffff
  ds_write_b32 v6, v7 offset:0x104
  s_cbranch_scc1 .fz_kernel_pk35
  s_call_b64 s[68:69], .fz_kernel_a_pick
  s_branch .fz_kernel_pk35
.fz_kernel_pk38c:
  v_mov_b32 v7, s34
  s_brev_b32 s30, 2
  s_cmp_eq_u32 s34, 0xffff
  ds_write_b32 v6, v7 offset:0x104
  s_cbranch_scc1 .fz_kernel_pk38
  s_call_b64 s[68:69], .fz_kernel_a_pick
  s_branch .fz_kernel_pk38
.fz_kernel_pk39c:
  v_mov_b32 v7, s34
  s_brev_b32 s30, 2
  s_cmp_eq_u32 s34, 0xffff
  ds_write_b32 v6, v7 offset:0x104
  s_cbranch_scc1 .fz_kernel_pk39
  s_call_b64 s[68:69], .fz_kernel_a_pick
  s_branch .fz_kernel_pk39
.fz_kernel_a_slow:
  s_cmp_lg_u32 s73, 0
  s_cbranch_scc1 .fz_kernel_a_ok
  s_mov_b32 s73, 1
  s_and_b32 s39, s16, 1
  v_mov_b32 v16, v32
  v_mov_b32 v17, v33
  v_mov_b32 v18, v34
  v_mov_b32 v19, v35
  v_mov_b32 v20, v36
  v_mov_b32 v21, v37
  v_mov_b32 v22, v38
  v_mov_b32 v23, v39
  s_call_b64 s[68:69], .fz_kernel_a_sl
  v_mov_b32 v176, v144
  v_mov_b32 v177, v145
  v_mov_b32 v178, v146
  v_mov_b32 v179, v147
  v_mov_b32 v180, v148
  v_mov_b32 v181, v149
  v_mov_b32 v182, v150
  v_mov_b32 v183, v151
  v_mov_b32 v184, v152
  v_mov_b32 v185, v153
  v_mov_b32 v186, v154
  v_mov_b32 v187, v155
  v_mov_b32 v188, v156
  v_mov_b32 v189, v157
  v_mov_b32 v190, v158
  v_mov_b32 v191, v159
  v_mov_b32 v24, v25
  v_mov_b32 v16, v40
  v_mov_b32 v17, v41
  v_mov_b32 v18, v42
  v_mov_b32 v19, v43
  v_mov_b32 v20, v44
  v_mov_b32 v21, v45
  v_mov_b32 v22, v46
  v_mov_b32 v23, v47
  s_call_b64 s[68:69], .fz_kernel_a_sl
  v_mov_b32 v192, v144
  v_mov_b32 v193, v145
  v_mov_b32 v194, v146
  v_mov_b32 v195, v147
  v_mov_b32 v196, v148
  v_mov_b32 v197, v149
  v_mov_b32 v198, v150
  v_mov_b32 v199, v151
  v_mov_b32 v200, v152
  v_mov_b32 v201, v153
  v_mov_b32 v202, v154
  v_mov_b32 v203, v155
  v_mov_b32 v204, v156
  v_mov_b32 v205, v157
  v_mov_b32 v206, v158
  v_mov_b32 v207, v159
  v_rcp_f32 v26, v24
  v_cmp_le_f32 vcc, s24, v24
  s_and_b64 s[36:37], s[36:37], vcc
  v_cmp_ge_f32 vcc, s25, v24
  s_and_b64 s[36:37], s[36:37], vcc
  v_pk_mul_f32 v[176:177], v[176:177], v[26:27] op_sel_hi:[1,0]
  v_pk_mul_f32 v[178:179], v[178:179], v[26:27] op_sel_hi:[1,0]
  v_pk_mul_f32 v[180:181], v[180:181], v[26:27] op_sel_hi:[1,0]
  v_pk_mul_f32 v[182:183], v[182:183], v[26:27] op_sel_hi:[1,0]
  v_cvt_pk_bf16_f32 v80, v176, v177
  v_cvt_pk_bf16_f32 v81, v178, v179
  v_cvt_pk_bf16_f32 v82, v180, v181
  v_cvt_pk_bf16_f32 v83, v182, v183
  buffer_store_dwordx4 v[80:83], v3, s[4:7], s8 offen offset:0 sc1
  v_pk_mul_f32 v[184:185], v[184:185], v[26:27] op_sel_hi:[1,0]
  v_pk_mul_f32 v[186:187], v[186:187], v[26:27] op_sel_hi:[1,0]
  v_pk_mul_f32 v[188:189], v[188:189], v[26:27] op_sel_hi:[1,0]
  v_pk_mul_f32 v[190:191], v[190:191], v[26:27] op_sel_hi:[1,0]
  v_cvt_pk_bf16_f32 v84, v184, v185
  v_cvt_pk_bf16_f32 v85, v186, v187
  v_cvt_pk_bf16_f32 v86, v188, v189
  v_cvt_pk_bf16_f32 v87, v190, v191
  buffer_store_dwordx4 v[84:87], v3, s[4:7], s8 offen offset:1024 sc1
  s_branch .fz_kernel_a_fin
.fz_kernel_a_sl:
  s_waitcnt vmcnt(0)
  s_lshl_b32 s23, s18, 1
  s_add_u32 s23, s23, s39
  s_lshl_b32 s23, s23, 18
  s_add_u32 s23, s23, s63
  s_mov_b32 s30, s23
  s_mov_b32 s33, 64
  v_mov_b32 v27, 0xff800000
.fz_kernel_a_s1:
  buffer_load_dwordx4 v[80:83], v3, s[4:7], s30 offen offset:0
  buffer_load_dwordx4 v[84:87], v3, s[4:7], s30 offen offset:1024
  s_waitcnt vmcnt(0)
  v_mfma_f32_32x32x16_bf16 v[48:63], v[80:83], v[16:19], 0
  v_mfma_f32_32x32x16_bf16 v[48:63], v[84:87], v[20:23], v[48:63]
  s_nop 11
  v_max3_f32 v27, v27, v48, v49
  v_max3_f32 v27, v27, v50, v51
  v_max3_f32 v27, v27, v52, v53
  v_max3_f32 v27, v27, v54, v55
  v_max3_f32 v27, v27, v56, v57
  v_max3_f32 v27, v27, v58, v59
  v_max3_f32 v27, v27, v60, v61
  v_max3_f32 v27, v27, v62, v63
  s_add_u32 s30, s30, 4096
  s_sub_u32 s33, s33, 1
  s_cmp_lg_u32 s33, 0
  s_cbranch_scc1 .fz_kernel_a_s1
  v_mov_b32 v29, v27
  s_nop 1
  v_permlane32_swap_b32 v29, v27
  v_max_f32 v27, v27, v29
  v_sub_f32 v27, 0, v27
  v_mov_b32 v64, v27
  v_mov_b32 v144, 0
  v_mov_b32 v65, v27
  v_mov_b32 v145, 0
  v_mov_b32 v66, v27
  v_mov_b32 v146, 0
  v_mov_b32 v67, v27
  v_mov_b32 v147, 0
  v_mov_b32 v68, v27
  v_mov_b32 v148, 0
  v_mov_b32 v69, v27
  v_mov_b32 v149, 0
  v_mov_b32 v70, v27
  v_mov_b32 v150, 0
  v_mov_b32 v71, v27
  v_mov_b32 v151, 0
  v_mov_b32 v72, v27
  v_mov_b32 v152, 0
  v_mov_b32 v73, v27
  v_mov_b32 v153, 0
  v_mov_b32 v74, v27
  v_mov_b32 v154, 0
  v_mov_b32 v75, v27
  v_mov_b32 v155, 0
  v_mov_b32 v76, v27
  v_mov_b32 v156, 0
  v_mov_b32 v77, v27
  v_mov_b32 v157, 0
  v_mov_b32 v78, v27
  v_mov_b32 v158, 0
  v_mov_b32 v79, v27
  v_mov_b32 v159, 0
  v_mov_b32 v208, 0
  v_mov_b32 v209, 0
  v_mov_b32 v210, 0
  v_mov_b32 v211, 0
  s_mov_b32 s30, s23
  s_mov_b32 s33, 64
.fz_kernel_a_s2:
  buffer_load_dwordx4 v[80:83], v3, s[4:7], s30 offen offset:0
  buffer_load_dwordx4 v[84:87], v3, s[4:7], s30 offen offset:1024
  buffer_load_dwordx4 v[88:91], v3, s[4:7], s30 offen offset:2048
  buffer_load_dwordx4 v[92:95], v3, s[4:7], s30 offen offset:3072
  s_waitcnt vmcnt(0)
  v_mfma_f32_32x32x16_bf16 v[48:63], v[80:83], v[16:19], v[64:79]
  v_mfma_f32_32x32x16_bf16 v[48:63], v[84:87], v[20:23], v[48:63]
  s_nop 11
  v_exp_f32 v48, v48
  v_exp_f32 v49, v49
  v_exp_f32 v50, v50
  v_exp_f32 v51, v51
  v_exp_f32 v52, v52
  v_exp_f32 v53, v53
  v_exp_f32 v54, v54
  v_exp_f32 v55, v55
  v_exp_f32 v56, v56
  v_exp_f32 v57, v57
  v_exp_f32 v58, v58
  v_exp_f32 v59, v59
  v_exp_f32 v60, v60
  v_exp_f32 v61, v61
  v_exp_f32 v62, v62
  v_exp_f32 v63, v63
  v_cvt_pk_bf16_f32 v224, v48, v49
  v_cvt_pk_bf16_f32 v225, v50, v51
  v_cvt_pk_bf16_f32 v226, v52, v53
  v_cvt_pk_bf16_f32 v227, v54, v55
  v_cvt_pk_bf16_f32 v228, v56, v57
  v_cvt_pk_bf16_f32 v229, v58, v59
  v_cvt_pk_bf16_f32 v230, v60, v61
  v_cvt_pk_bf16_f32 v231, v62, v63
  v_mfma_f32_32x32x16_bf16 v[144:159], v[88:91], v[224:227], v[144:159]
  s_nop 0
  v_mfma_f32_32x32x16_bf16 v[144:159], v[92:95], v[228:231], v[144:159]
  v_smfmac_f32_16x16x64_bf16 v[208:211], v[12:15], v[224:231], v11
  s_add_u32 s30, s30, 4096
  s_sub_u32 s33, s33, 1
  s_cmp_lg_u32 s33, 0
  s_cbranch_scc1 .fz_kernel_a_s2
  s_nop 7
  v_add_f32 v208, v208, v210
  v_add_f32 v209, v209, v211
  v_cndmask_b32 v25, v208, v209, s[20:21]
  s_nop 7
  s_setpc_b64 s[68:69]
.fz_kernel_serv:
  s_setprio 3
  s_mov_b32 s24, s44
  s_mov_b32 s25, s45
  s_mov_b32 s26, 0x200000
  s_mov_b32 s27, 0x00020000
  v_lshrrev_b32 v8, 3, v2
  v_and_b32 v9, 7, v2
  v_bfe_u32 v10, v2, 4, 1
  v_lshlrev_b32 v10, 2, v10
  v_xor_b32 v9, v9, v10
  v_lshlrev_b32 v9, 4, v9
  v_lshl_add_u32 v10, v8, 11, v9
  s_cmp_eq_u32 s16, 5
  s_cbranch_scc1 .fz_kernel_sv1
  s_barrier
  v_lshlrev_b32 v7, 7, v2
  s_lshl_b32 s31, s18, 11
  s_lshl_b32 s33, 1, s17
  s_add_u32 s31, s31, s67
  s_add_u32 s31, s31, 0x1800000
  v_mov_b32 v8, s33
  s_mov_b64 exec, 0xffff
  s_mov_b32 s38, 0
.fz_kernel_cw40:
  s_sleep 1
  ds_read_u8 v9, v6 offset:256
  s_add_u32 s38, s38, 1
  s_waitcnt lgkmcnt(0)
  v_cmp_gt_u32 vcc, 4, v9
  s_cbranch_vccz .fz_kernel_cw40d
  s_cmp_lt_u32 s38, 8388608
  s_cbranch_scc1 .fz_kernel_cw40
.fz_kernel_cw40d:
  buffer_atomic_or v8, v7, s[4:7], s31 offen sc1
  s_mov_b64 exec, -1
  s_setprio 0
  s_mov_b32 s38, 0
.fz_kernel_kw41:
  s_sleep 2
  ds_read_b32 v7, v6 offset:0
  s_add_u32 s38, s38, 1
  s_waitcnt lgkmcnt(0)
  v_readfirstlane_b32 s31, v7
  s_bcnt1_i32_b32 s31, s31
  s_cmp_ge_u32 s31, 16
  s_cbranch_scc1 .fz_kernel_kw41d
  s_cmp_lt_u32 s38, 1048576
  s_cbranch_scc1 .fz_kernel_kw41
.fz_kernel_kw41d:
  s_branch .fz_kernel_sv2
.fz_kernel_sv1:
  s_add_u32 s37, s19, s67
  s_mov_b64 exec, 1
  buffer_load_dword v7, v4, s[4:7], s37 offen sc1
  s_waitcnt vmcnt(0)
  ds_or_b32 v6, v7
  buffer_load_dword v9, v4, s[4:7], s37 offen sc1
  s_barrier
  s_waitcnt vmcnt(0)
  ds_or_b32 v6, v9
  s_add_u32 s37, s19, s67
  s_mov_b64 exec, 1
  s_mov_b32 s38, 0
.fz_kernel_po42:
  buffer_load_dword v7, v4, s[4:7], s37 offen offset:0 sc1
  s_add_u32 s38, s38, 1
  s_waitcnt vmcnt(0)
  ds_or_b32 v6, v7 offset:0
  v_cmp_ne_u32 vcc, 0xffff, v7
  s_cbranch_vccz .fz_kernel_po42d
  s_sleep 12
  s_cmp_lt_u32 s38, 131072
  s_cbranch_scc1 .fz_kernel_po42
.fz_kernel_po42d:
  s_mov_b64 exec, -1
  s_setprio 0
  s_mov_b32 s38, 0
.fz_kernel_kw43:
  s_sleep 2
  ds_read_b32 v7, v6 offset:0
  s_add_u32 s38, s38, 1
  s_waitcnt lgkmcnt(0)
  v_readfirstlane_b32 s31, v7
  s_bcnt1_i32_b32 s31, s31
  s_cmp_ge_u32 s31, 16
  s_cbranch_scc1 .fz_kernel_kw43d
  s_cmp_lt_u32 s38, 1048576
  s_cbranch_scc1 .fz_kernel_kw43
.fz_kernel_kw43d:
.fz_kernel_sv2:
  s_and_b32 s30, s16, 1
  s_lshl_b32 s30, s30, 16
  s_add_u32 s32, s30, 65536
  s_lshl_b32 s31, s18, 7
  v_add_u32 v10, s31, v10
.fz_kernel_sv3:
  s_mov_b32 m0, s30
  s_lshl_b32 s31, s30, 4
  s_add_u32 s30, s30, 1024
  buffer_load_dwordx4 v10, s[24:27], s31 offen  lds
  s_cmp_lg_u32 s30, s32
  s_waitcnt vmcnt(3)
  s_cbranch_scc1 .fz_kernel_sv3
  s_cmp_lg_u32 s62, 0
  s_cbranch_scc1 .fz_kernel_wt44
  s_mov_b32 s12, s42
  s_mov_b32 s13, s43
  s_mov_b32 s14, 0x600000
  s_mov_b32 s15, 0x00020000
  s_and_b32 s30, s16, 1
  s_lshl1_add_u32 s30, s17, s30
  s_and_b32 s30, s30, 15
  s_mul_i32 s30, s30, 393216
  s_lshl_b32 s31, s18, 7
  s_add_u32 s30, s30, s31
  v_mul_u32_u24 v11, 6144, v2
  buffer_load_dword v1, v11, s[12:15], s30 offen
  s_add_u32 s30, s30, 2048
  s_waitcnt vmcnt(0)
  buffer_load_dword v1, v11, s[12:15], s30 offen
  s_add_u32 s30, s30, 2048
  s_waitcnt vmcnt(0)
  buffer_load_dword v1, v11, s[12:15], s30 offen
  s_add_u32 s30, s30, 2048
  s_waitcnt vmcnt(0)
.fz_kernel_wt44:
  s_cmp_lg_u32 s16, 4
  s_cbranch_scc1 .fz_kernel_ct45e
  s_getpc_b64 s[0:1]
.fz_kernel_ct45:
  s_sub_u32 s0, s0, .fz_kernel_ct45-fz_kernel
  s_subb_u32 s1, s1, 0
  s_lshr_b32 s31, s2, 3
  s_mulk_i32 s31, 0x500
  v_lshl_add_u32 v1, v2, 7, s31
  v_min_u32 v1, .fz_kernel_last-fz_kernel, v1
  s_mov_b64 exec, 0x3ff
  global_load_dword v1, v1, s[0:1]
  s_mov_b64 exec, -1
.fz_kernel_ct45e:
  s_waitcnt vmcnt(0)
  s_cmp_lg_u32 s16, 5
  s_cbranch_scc1 .fz_kernel_sv35
  s_mov_b64 exec, 1
  s_mov_b32 s38, 0
.fz_kernel_sv34:
  s_sleep 4
  buffer_load_dword v7, v4, s[4:7], s37 offen offset:4 sc1
  ds_read_b32 v8, v6 offset:0x104
  s_add_u32 s38, s38, 1
  s_waitcnt vmcnt(0) lgkmcnt(0)
  ds_or_b32 v6, v7 offset:8
  v_cmp_eq_u32 vcc, 0xffff, v8
  s_cbranch_vccnz .fz_kernel_sv35
  s_cmp_lt_u32 s38, 131072
  s_cbranch_scc1 .fz_kernel_sv34
.fz_kernel_sv35:
  s_mov_b64 exec, -1
  s_setprio 3
  s_barrier
  s_cmp_eq_u32 s16, 5
  s_cbranch_scc1 .fz_kernel_sv4
  v_lshlrev_b32 v7, 11, v2
  s_lshl_b32 s31, s17, 7
  s_lshl_b32 s33, 1, s18
  s_add_u32 s31, s31, s67
  s_add_u32 s31, s31, 0x1800004
  v_mov_b32 v8, s33
  s_mov_b64 exec, 0xffff
  s_mov_b32 s38, 0
.fz_kernel_cw46:
  s_sleep 1
  ds_read_u8 v9, v6 offset:264
  s_add_u32 s38, s38, 1
  s_waitcnt lgkmcnt(0)
  v_cmp_gt_u32 vcc, 4, v9
  s_cbranch_vccz .fz_kernel_cw46d
  s_cmp_lt_u32 s38, 8388608
  s_cbranch_scc1 .fz_kernel_cw46
.fz_kernel_cw46d:
  buffer_atomic_or v8, v7, s[4:7], s31 offen sc1
  s_mov_b64 exec, -1
  s_mov_b64 exec, 1
  ds_or_b32 v6, v8 offset:8
  s_mov_b64 exec, -1
  s_branch .fz_kernel_sv5
.fz_kernel_sv4:
  s_add_u32 s37, s19, s67
  s_mov_b64 exec, 1
  s_mov_b32 s38, 0
.fz_kernel_po47:
  buffer_load_dword v7, v4, s[4:7], s37 offen offset:4 sc1
  s_add_u32 s38, s38, 1
  s_waitcnt vmcnt(0)
  ds_or_b32 v6, v7 offset:8
  v_cmp_ne_u32 vcc, 0xffff, v7
  s_cbranch_vccz .fz_kernel_po47d
  s_sleep 12
  s_cmp_lt_u32 s38, 131072
  s_cbranch_scc1 .fz_kernel_po47
.fz_kernel_po47d:
  s_mov_b64 exec, -1
.fz_kernel_sv5:
  s_mov_b32 s72, s66
  s_mov_b32 s73, s65
  s_mov_b32 s74, s67
  s_mov_b32 s75, s62
  s_cmp_lg_u32 s62, 0
  s_cbranch_scc1 .fz_kernel_w_lt
  s_mov_b32 s62, 1
  s_mov_b32 s63, 0x2000000
  s_mov_b32 s64, 0x2800000
  s_mov_b32 s65, 0x1400000
  s_mov_b32 s66, 0x1c42000
  s_mov_b32 s67, 12
  s_mov_b32 s71, 159776
  v_mov_b32 v6, 159832
  s_branch .fz_kernel_q_prod2
.fz_kernel_w_lt:
  s_barrier
  s_barrier
  s_branch .fz_kernel_fin
.fz_kernel_pk48c:
  s_call_b64 s[68:69], .fz_kernel_pick
  s_branch .fz_kernel_pk48
.fz_kernel_pk49c:
  s_call_b64 s[68:69], .fz_kernel_pick
  s_branch .fz_kernel_pk49
.fz_kernel_w_pt:
  v_lshlrev_b32 v44, 5, v17
  v_add_u32 v44, 155648, v44
  s_mov_b64 exec, vcc
  ds_read_b128 v[232:235], v44 offset:7424
  ds_read_b128 v[236:239], v44 offset:7440
  ds_read_b128 v[240:243], v44 offset:7488
  ds_read_b128 v[244:247], v44 offset:7504
  s_waitcnt lgkmcnt(0)
  v_pk_add_f32 v[64:65], v[64:65], v[232:233]
  v_pk_add_f32 v[66:67], v[66:67], v[234:235]
  v_pk_add_f32 v[68:69], v[68:69], v[236:237]
  v_pk_add_f32 v[70:71], v[70:71], v[238:239]
  v_pk_add_f32 v[72:73], v[72:73], v[240:241]
  v_pk_add_f32 v[74:75], v[74:75], v[242:243]
  v_pk_add_f32 v[76:77], v[76:77], v[244:245]
  v_pk_add_f32 v[78:79], v[78:79], v[246:247]
  ds_read_b128 v[232:235], v44 offset:7552
  ds_read_b128 v[236:239], v44 offset:7568
  ds_read_b128 v[240:243], v44 offset:7616
  ds_read_b128 v[244:247], v44 offset:7632
  s_waitcnt lgkmcnt(0)
  v_pk_add_f32 v[80:81], v[80:81], v[232:233]
  v_pk_add_f32 v[82:83], v[82:83], v[234:235]
  v_pk_add_f32 v[84:85], v[84:85], v[236:237]
  v_pk_add_f32 v[86:87], v[86:87], v[238:239]
  v_pk_add_f32 v[88:89], v[88:89], v[240:241]
  v_pk_add_f32 v[90:91], v[90:91], v[242:243]
  v_pk_add_f32 v[92:93], v[92:93], v[244:245]
  v_pk_add_f32 v[94:95], v[94:95], v[246:247]
  s_mov_b64 exec, -1
  s_branch .fz_kernel_w_pb
.fz_kernel_pk50c:
  s_call_b64 s[68:69], .fz_kernel_pick
  s_branch .fz_kernel_pk50
.fz_kernel_pk51c:
  s_call_b64 s[68:69], .fz_kernel_pick
  s_branch .fz_kernel_pk51
.fz_kernel_pk52c:
  s_call_b64 s[68:69], .fz_kernel_pick
  s_branch .fz_kernel_pk52
.fz_kernel_pk53c:
  s_call_b64 s[68:69], .fz_kernel_pick
  s_branch .fz_kernel_pk53
.fz_kernel_pk54c:
  s_call_b64 s[68:69], .fz_kernel_pick
  s_branch .fz_kernel_pk54
.fz_kernel_pk55c:
  s_call_b64 s[68:69], .fz_kernel_pick
  s_branch .fz_kernel_pk55
.fz_kernel_pk56c:
  s_call_b64 s[68:69], .fz_kernel_pick
  s_branch .fz_kernel_pk56
.fz_kernel_pk57c:
  s_call_b64 s[68:69], .fz_kernel_pick
  s_branch .fz_kernel_pk57
.fz_kernel_pk58c:
  s_call_b64 s[68:69], .fz_kernel_pick
  s_branch .fz_kernel_pk58
.fz_kernel_pk59c:
  s_call_b64 s[68:69], .fz_kernel_pick
  s_branch .fz_kernel_pk59
.fz_kernel_pk60c:
  s_call_b64 s[68:69], .fz_kernel_pick
  s_branch .fz_kernel_pk60
.fz_kernel_pk61c:
  s_call_b64 s[68:69], .fz_kernel_pick
  s_branch .fz_kernel_pk61
.fz_kernel_pk62c:
  s_call_b64 s[68:69], .fz_kernel_pick
  s_branch .fz_kernel_pk62
.fz_kernel_pk63c:
  s_call_b64 s[68:69], .fz_kernel_pick
  s_branch .fz_kernel_pk63
.fz_kernel_pk64c:
  s_call_b64 s[68:69], .fz_kernel_pick
  s_branch .fz_kernel_pk64
.fz_kernel_pk65c:
  s_call_b64 s[68:69], .fz_kernel_pick
  s_branch .fz_kernel_pk65
.fz_kernel_c_nl:
  s_barrier
  s_branch .fz_kernel_c_np
.fz_kernel_c_c7:
  s_mov_b32 s38, 0
.fz_kernel_cw70:
  s_sleep 1
  ds_read_u8 v22, v6 offset:272
  s_add_u32 s38, s38, 1
  s_waitcnt lgkmcnt(0)
  v_cmp_gt_u32 vcc, 2, v22
  s_cbranch_vccz .fz_kernel_cw70d
  s_cmp_lt_u32 s38, 8388608
  s_cbranch_scc1 .fz_kernel_cw70
.fz_kernel_cw70d:
  ds_read_b64_tr_b16 v[32:33], v7 offset:0
  ds_read_b64_tr_b16 v[34:35], v7 offset:512
  ds_read_b64_tr_b16 v[36:37], v13 offset:0
  ds_read_b64_tr_b16 v[38:39], v13 offset:512
  ds_read_b64_tr_b16 v[40:41], v7 offset:4096
  ds_read_b64_tr_b16 v[42:43], v7 offset:4608
  ds_read_b64_tr_b16 v[44:45], v13 offset:4096
  ds_read_b64_tr_b16 v[46:47], v13 offset:4608
  ds_read_b64_tr_b16 v[48:49], v7 offset:8192
  ds_read_b64_tr_b16 v[50:51], v7 offset:8704
  ds_read_b64_tr_b16 v[52:53], v13 offset:8192
  ds_read_b64_tr_b16 v[54:55], v13 offset:8704
  s_waitcnt lgkmcnt(0)
  v_xor_b32 v7, 64, v7
  v_xor_b32 v13, 64, v13
  ds_read_b64_tr_b16 v[56:57], v7 offset:1024
  ds_read_b64_tr_b16 v[58:59], v7 offset:1536
  ds_read_b64_tr_b16 v[60:61], v13 offset:1024
  ds_read_b64_tr_b16 v[62:63], v13 offset:1536
  ds_read_b64_tr_b16 v[64:65], v7 offset:5120
  ds_read_b64_tr_b16 v[66:67], v7 offset:5632
  ds_read_b64_tr_b16 v[68:69], v13 offset:5120
  ds_read_b64_tr_b16 v[70:71], v13 offset:5632
  ds_read_b64_tr_b16 v[72:73], v7 offset:9216
  ds_read_b64_tr_b16 v[74:75], v7 offset:9728
  ds_read_b64_tr_b16 v[76:77], v13 offset:9216
  ds_read_b64_tr_b16 v[78:79], v13 offset:9728
  s_waitcnt lgkmcnt(0)
  s_branch .fz_kernel_c_c2
.fz_kernel_c_coef:
  v_fma_f32 v242, -v240, v240, v242
  v_fma_f32 v243, -v241, v241, v243
  v_rsq_f32 v248, abs(v242)
  v_rsq_f32 v249, abs(v243)
  v_mul_f32 v254, v240, v248
  v_sub_f32 v254, 0, v254
  v_mov_b32 v252, 1.0
  v_fmac_f32 v252, 0x44800000, v248
  v_fma_f32 v242, v242, v24, -v25
  v_max_f32 v242, 0, v242
  v_mul_f32 v248, v252, v252
  v_fma_f32 v248, v248, v242, v25
  v_rsq_f32 v248, v248
  v_mul_f32 v240, v23, v240
  v_mul_f32 v248, v248, v252
  v_mul_f32 v250, v248, v240
  v_sub_f32 v250, 0, v250
  v_mul_f32 v255, v241, v249
  v_sub_f32 v255, 0, v255
  v_mov_b32 v253, 1.0
  v_fmac_f32 v253, 0x44800000, v249
  s_cmp_eq_u32 s3, 0
  s_cbranch_scc1 .fz_kernel_hb73
  s_barrier
  s_sub_u32 s3, s3, 1
.fz_kernel_hb73:
  v_fma_f32 v243, v243, v24, -v25
  v_max_f32 v243, 0, v243
  v_mul_f32 v249, v253, v253
  v_fma_f32 v249, v249, v243, v25
  v_rsq_f32 v249, v249
  v_mul_f32 v241, v23, v241
  v_mul_f32 v249, v249, v253
  v_mul_f32 v251, v249, v241
  v_sub_f32 v251, 0, v251
  s_setpc_b64 s[68:69]
.fz_kernel_c_gur:
  v_min_u32 v9, v144, v146
  v_cmp_eq_u32 s[8:9], 0, v9
  v_min_u32 v9, v148, v150
  v_cmp_eq_u32 s[10:11], 0, v9
  v_min_u32 v9, v152, v154
  v_cmp_eq_u32 s[12:13], 0, v9
  v_min_u32 v9, v156, v158
  v_cmp_eq_u32 s[14:15], 0, v9
  s_add_u32 s38, s38, 1
  s_cmp_ge_u32 s38, 131072
  s_cbranch_scc1 .fz_kernel_c_gud
  s_or_b64 exec, s[8:9], 1
  buffer_load_dwordx4 v[144:147], v21, s[4:7], s33 offen offset:0 sc1
  s_or_b64 exec, s[10:11], 1
  buffer_load_dwordx4 v[148:151], v21, s[4:7], s33 offen offset:512 sc1
  s_or_b64 exec, s[12:13], 1
  buffer_load_dwordx4 v[152:155], v21, s[4:7], s33 offen offset:1024 sc1
  s_or_b64 exec, s[14:15], 1
  buffer_load_dwordx4 v[156:159], v21, s[4:7], s33 offen offset:1536 sc1
  s_mov_b64 exec, -1
  s_branch .fz_kernel_c_gu
.fz_kernel_c_pur:
  s_cmp_eq_u32 s3, 0
  s_cbranch_scc1 .fz_kernel_hb78
  s_barrier
  s_sub_u32 s3, s3, 1
.fz_kernel_hb78:
  s_add_u32 s38, s38, 1
  s_cmp_ge_u32 s38, 131072
  s_cbranch_scc1 .fz_kernel_c_pud
  v_min_u32 v9, v144, v146
  v_cmp_eq_u32 vcc, 0, v9
  s_cbranch_vccz .fz_kernel_c_ps0
  buffer_load_dwordx4 v[144:147], v3, s[4:7], s21 offen offset:0 sc1
.fz_kernel_c_ps0:
  v_min_u32 v9, v148, v150
  v_cmp_eq_u32 vcc, 0, v9
  s_cbranch_vccz .fz_kernel_c_ps1
  buffer_load_dwordx4 v[148:151], v3, s[4:7], s21 offen offset:1024 sc1
.fz_kernel_c_ps1:
  v_min_u32 v9, v152, v154
  v_cmp_eq_u32 vcc, 0, v9
  s_cbranch_vccz .fz_kernel_c_ps2
  buffer_load_dwordx4 v[152:155], v3, s[4:7], s21 offen offset:2048 sc1
.fz_kernel_c_ps2:
  v_min_u32 v9, v156, v158
  v_cmp_eq_u32 vcc, 0, v9
  s_cbranch_vccz .fz_kernel_c_ps3
  buffer_load_dwordx4 v[156:159], v3, s[4:7], s21 offen offset:3072 sc1
.fz_kernel_c_ps3:
  v_min_u32 v9, v160, v162
  v_cmp_eq_u32 vcc, 0, v9
  s_cbranch_vccz .fz_kernel_c_ps4
  buffer_load_dwordx4 v[160:163], v3, s[4:7], s22 offen offset:0 sc1
.fz_kernel_c_ps4:
  v_min_u32 v9, v164, v166
  v_cmp_eq_u32 vcc, 0, v9
  s_cbranch_vccz .fz_kernel_c_ps5
  buffer_load_dwordx4 v[164:167], v3, s[4:7], s22 offen offset:1024 sc1
.fz_kernel_c_ps5:
  v_min_u32 v9, v168, v170
  v_cmp_eq_u32 vcc, 0, v9
  s_cbranch_vccz .fz_kernel_c_ps6
  buffer_load_dwordx4 v[168:171], v3, s[4:7], s22 offen offset:2048 sc1
.fz_kernel_c_ps6:
  s_branch .fz_kernel_c_pu
.fz_kernel_last:
  s_endpgm

.section .rodata,"a"
.p2align 6
.amdhsa_kernel fz_kernel
  .amdhsa_next_free_vgpr 256
  .amdhsa_next_free_sgpr 102
  .amdhsa_accum_offset 256
  .amdhsa_group_segment_fixed_size 0
  .amdhsa_kernarg_size 88
  .amdhsa_user_sgpr_count 2
  .amdhsa_user_sgpr_kernarg_segment_ptr 1
  .amdhsa_system_sgpr_workgroup_id_x 1
.end_amdhsa_kernel
```

```asm
; @launch kernel=fz_kernel grid=(256,1,1) block=(512,1,1) lds=163840
.amdgcn_target "amdgcn-amd-amdhsa--gfx950"
.text
.globl fz_kernel
.p2align 8
.type fz_kernel,@function
fz_kernel:
  s_cmp_ge_u32 s2, 256
  s_cbranch_scc1 .fz_kernel_end
  s_load_dwordx2 s[8:9], s[0:1], 0
  s_load_dwordx2 s[12:13], s[0:1], 8
  s_load_dwordx2 s[4:5], s[0:1], 80
  s_load_dwordx16 s[40:55], s[0:1], 0
  s_load_dwordx4 s[56:59], s[0:1], 64
  v_lshrrev_b32 v1, 6, v0
  v_and_b32 v2, 63, v0
  v_readfirstlane_b32 s16, v1
  s_and_b32 s21, s2, 7
  s_lshr_b32 s22, s2, 3
  s_and_b32 s23, s21, 3
  s_lshl_b32 s23, s23, 2
  s_and_b32 s24, s22, 3
  s_add_u32 s18, s23, s24
  s_lshr_b32 s24, s21, 2
  s_lshl_b32 s24, s24, 3
  s_lshr_b32 s25, s22, 2
  s_add_u32 s17, s24, s25
  s_lshl_b32 s19, s18, 4
  s_add_u32 s19, s19, s17
  s_lshl_b32 s19, s19, 7
  s_add_u32 s19, s19, 0x1800000
  v_lshlrev_b32 v3, 4, v2
  v_mov_b32 v4, 0
  v_mov_b32 v5, 1
  s_mov_b32 s6, 0x2c00000
  s_mov_b32 s7, 0x00020000
  s_mov_b32 s62, 0
  s_mov_b32 s63, 0x400000
  s_mov_b32 s64, 0xc00000
  s_mov_b32 s65, 0x1000000
  s_mov_b32 s66, 0x1c00000
  s_mov_b32 s67, 0
  s_mov_b32 s71, 159744
  v_mov_b32 v6, 159808
  s_cmp_lt_u32 s16, 4
  s_cbranch_scc1 .fz_kernel_q_cons1
  s_cmp_ge_u32 s16, 6
  s_cbranch_scc1 .fz_kernel_q_help1
  s_mov_b32 s10, 0x400000
  s_mov_b32 s11, 0x00020000
  v_lshrrev_b32 v20, 3, v2
  v_and_b32 v21, 7, v2
  v_lshrrev_b32 v22, 4, v2
  v_xor_b32 v23, v21, v22
  v_lshlrev_b32 v23, 4, v23
  v_lshl_add_u32 v24, v20, 11, v23
  v_xor_b32 v25, 64, v24
  s_lshl_b32 s35, s17, 2
  s_and_b32 s31, s16, 1
  s_add_u32 s35, s35, s31
  s_lshl_b32 s35, s35, 16
  s_and_b32 s29, s18, 12
  s_lshr_b32 s33, s17, 3
  s_lshl1_add_u32 s29, s33, s29
  s_lshl2_add_u32 s29, s17, s29
  s_and_b32 s29, s29, 15
  s_mov_b32 s22, 128
  s_mov_b32 s23, 131072
  s_mov_b32 s36, -1
  v_add_u32 v40, 0, v24
  v_add_u32 v41, 15360, v25
  v_add_u32 v42, 30720, v24
  v_add_u32 v43, 46080, v25
.fz_kernel_q_pc:
  s_mov_b32 s14, 0x600000
  s_mov_b32 s15, 0x00020000
  v_lshrrev_b32 v28, 3, v2
  v_and_b32 v29, 7, v2
  v_bfe_u32 v30, v2, 4, 1
  v_lshlrev_b32 v30, 1, v30
  v_xor_b32 v31, v29, v30
  v_lshlrev_b32 v31, 4, v31
  v_mul_u32_u24 v28, 6144, v28
  v_add_u32 v28, v28, v31
  v_xor_b32 v29, 64, v28
  s_lshl_b32 s32, s18, 7
  s_add_u32 s39, s32, 6291456
  s_mul_i32 s33, s29, 393216
  s_add_u32 s33, s33, s32
  s_lshl_b32 s29, s29, 1
  s_mul_i32 s25, s31, 6144
  s_add_u32 s25, s25, 65536
  s_mov_b32 s30, s25
  s_add_u32 s26, s25, 49152
  s_lshl_b32 s21, s31, 12
  s_cmp_eq_u32 s31, 0
  s_mov_b32 s24, 100352
  s_cselect_b32 s24, 0, s24
  v_add_u32 v32, s24, v28
  s_mov_b32 s24, 148480
  s_cselect_b32 s24, 48128, s24
  v_add_u32 v33, s24, v29
  s_mov_b32 s24, 2048
  s_cselect_b32 s24, 96256, s24
  v_add_u32 v34, s24, v28
  s_mov_b32 s24, 50176
  s_cselect_b32 s24, 144384, s24
  v_add_u32 v35, s24, v29
  s_mov_b32 s24, 102400
  s_cselect_b32 s24, 2048, s24
  v_add_u32 v36, s24, v28
  s_mov_b32 s24, 150528
  s_cselect_b32 s24, 50176, s24
  v_add_u32 v37, s24, v29
  s_cmp_lg_u32 s62, 0
  s_cbranch_scc1 .fz_kernel_q_st2
  s_waitcnt lgkmcnt(0)
  s_mov_b32 s34, 32
  s_call_b64 s[0:1], .fz_kernel_q_ix
  s_call_b64 s[0:1], .fz_kernel_q_iu
  s_call_b64 s[0:1], .fz_kernel_q_iu
  s_call_b64 s[0:1], .fz_kernel_q_iu
  s_waitcnt vmcnt(20)
  s_barrier
  s_call_b64 s[0:1], .fz_kernel_q_iu
  s_waitcnt vmcnt(24)
  s_barrier
  s_call_b64 s[0:1], .fz_kernel_q_iu
  s_branch .fz_kernel_q_pl
.fz_kernel_q_ix:
  s_bfe_u32 s24, s29, 0x40001
  s_mul_i32 s20, s24, s22
  s_bitcmp1_b32 s29, 0
  s_cselect_b32 s31, s23, 0
  s_add_u32 s20, s20, s35
  s_add_u32 s20, s20, s31
  s_bitcmp1_b32 s36, s24
  s_cbranch_scc0 .fz_kernel_xok1w
.fz_kernel_xok1:
  s_mov_b32 m0, s21
  s_add_u32 s21, s21, 8192
  s_and_b32 s21, s21, 0xffff
  s_add_u32 s29, s29, 1
  buffer_load_dwordx4 v40, s[8:11], s20 offen offset:0 lds
  buffer_load_dwordx4 v41, s[8:11], s20 offen offset:1024 lds
  buffer_load_dwordx4 v42, s[8:11], s20 offen offset:2048 lds
  buffer_load_dwordx4 v43, s[8:11], s20 offen offset:3072 lds
  s_setpc_b64 s[0:1]
.fz_kernel_q_iu:
  s_mov_b32 m0, s30
  s_add_u32 s30, s30, 12288
  buffer_load_dwordx4 v32, s[12:15], s33 offen offset:0 lds
  s_bfe_u32 s24, s29, 0x40001
  buffer_load_dwordx4 v33, s[12:15], s33 offen offset:1024 lds
  s_mul_i32 s20, s24, s22
  buffer_load_dwordx4 v34, s[12:15], s33 offen offset:2048 lds
  s_bitcmp1_b32 s29, 0
  s_cselect_b32 s31, s23, 0
  buffer_load_dwordx4 v35, s[12:15], s33 offen offset:3072 lds
  s_add_u32 m0, m0, 4096
  s_add_u32 s20, s20, s35
  buffer_load_dwordx4 v36, s[12:15], s33 offen offset:0 lds
  s_add_u32 s20, s20, s31
  buffer_load_dwordx4 v37, s[12:15], s33 offen offset:1024 lds
  s_bitcmp1_b32 s36, s24
  s_cbranch_scc0 .fz_kernel_xok2w
.fz_kernel_xok2:
  s_mov_b32 m0, s21
  s_add_u32 s21, s21, 8192
  s_and_b32 s21, s21, 0xffff
  s_add_u32 s29, s29, 1
  buffer_load_dwordx4 v40, s[8:11], s20 offen offset:0 lds
  s_add_u32 s33, s33, 196608
  s_cmp_eq_u32 s33, s39
  s_cselect_b32 s33, s32, s33
  buffer_load_dwordx4 v41, s[8:11], s20 offen offset:1024 lds
  s_cmp_eq_u32 s30, s26
  s_cselect_b32 s30, s25, s30
  buffer_load_dwordx4 v42, s[8:11], s20 offen offset:2048 lds
  s_sub_u32 s34, s34, 1
  s_cmp_lg_u32 s34, 0
  buffer_load_dwordx4 v43, s[8:11], s20 offen offset:3072 lds
  s_setpc_b64 s[0:1]
.fz_kernel_q_iw:
  s_mov_b32 m0, s30
  s_add_u32 s30, s30, 12288
  buffer_load_dwordx4 v32, s[12:15], s33 offen offset:0 lds
  s_nop 0
  buffer_load_dwordx4 v33, s[12:15], s33 offen offset:1024 lds
  s_nop 0
  buffer_load_dwordx4 v34, s[12:15], s33 offen offset:2048 lds
  s_nop 0
  buffer_load_dwordx4 v35, s[12:15], s33 offen offset:3072 lds
  s_add_u32 m0, m0, 4096
  s_nop 0
  buffer_load_dwordx4 v36, s[12:15], s33 offen offset:0 lds
  buffer_load_dwordx4 v37, s[12:15], s33 offen offset:1024 lds
  s_add_u32 s33, s33, 196608
  s_cmp_eq_u32 s33, s39
  s_cselect_b32 s33, s32, s33
  s_cmp_eq_u32 s30, s26
  s_cselect_b32 s30, s25, s30
  s_sub_u32 s34, s34, 1
  s_cmp_lg_u32 s34, 0
  s_setpc_b64 s[0:1]
.fz_kernel_q_st2:
  s_mov_b32 s34, 32
  s_waitcnt vmcnt(0)
  s_barrier
  ds_write_b128 v44, v[64:67] offset:0
  ds_write_b128 v44, v[68:71] offset:1024
  ds_write_b128 v44, v[72:75] offset:2048
  ds_write_b128 v44, v[76:79] offset:3072
  ds_write_b128 v44, v[80:83] offset:4096
  ds_write_b128 v44, v[84:87] offset:5120
  ds_write_b128 v44, v[88:91] offset:6144
  ds_write_b128 v44, v[92:95] offset:7168
  ds_write_b128 v44, v[96:99] offset:8192
  ds_write_b128 v44, v[100:103] offset:9216
  ds_write_b128 v44, v[104:107] offset:10240
  ds_write_b128 v44, v[108:111] offset:11264
  ds_write_b128 v44, v[112:115] offset:12288
  ds_write_b128 v44, v[116:119] offset:13312
  ds_write_b128 v44, v[120:123] offset:14336
  ds_write_b128 v44, v[124:127] offset:15360
  s_waitcnt lgkmcnt(0)
  s_call_b64 s[0:1], .fz_kernel_q_iw
  s_call_b64 s[0:1], .fz_kernel_q_iw
  s_call_b64 s[0:1], .fz_kernel_q_iw
  s_call_b64 s[0:1], .fz_kernel_q_iw
  s_call_b64 s[0:1], .fz_kernel_q_ix
  s_call_b64 s[0:1], .fz_kernel_q_ix
  s_mov_b64 exec, 1
  s_waitcnt vmcnt(20)
  ds_add_u32 v6, v5 offset:0x110
  s_mov_b64 exec, -1
  v_mov_b32 v12, 0x100
  s_call_b64 s[0:1], .fz_kernel_q_ix
  s_call_b64 s[0:1], .fz_kernel_q_ix
  s_waitcnt vmcnt(8)
  s_mov_b64 exec, 1
  ds_add_u32 v6, v12 offset:0x110
  s_mov_b64 exec, -1
  s_barrier
  s_waitcnt vmcnt(8)
  s_barrier
  s_call_b64 s[0:1], .fz_kernel_q_ix
  s_call_b64 s[0:1], .fz_kernel_q_iu
  s_waitcnt vmcnt(14)
  s_barrier
  s_call_b64 s[0:1], .fz_kernel_q_iu
  s_waitcnt vmcnt(20)
  s_barrier
  s_call_b64 s[0:1], .fz_kernel_q_iu
.fz_kernel_q_pl:
  s_waitcnt vmcnt(20)
  s_barrier
  s_mov_b32 m0, s30
  s_add_u32 s30, s30, 12288
  buffer_load_dwordx4 v32, s[12:15], s33 offen offset:0 lds
  s_bfe_u32 s24, s29, 0x40001
  buffer_load_dwordx4 v33, s[12:15], s33 offen offset:1024 lds
  s_mul_i32 s20, s24, s22
  buffer_load_dwordx4 v34, s[12:15], s33 offen offset:2048 lds
  s_bitcmp1_b32 s29, 0
  s_cselect_b32 s31, s23, 0
  buffer_load_dwordx4 v35, s[12:15], s33 offen offset:3072 lds
  s_add_u32 m0, m0, 4096
  s_add_u32 s20, s20, s35
  buffer_load_dwordx4 v36, s[12:15], s33 offen offset:0 lds
  s_add_u32 s20, s20, s31
  buffer_load_dwordx4 v37, s[12:15], s33 offen offset:1024 lds
  s_bitcmp1_b32 s36, s24
  s_cbranch_scc0 .fz_kernel_xok3w
.fz_kernel_xok3:
  s_mov_b32 m0, s21
  s_add_u32 s21, s21, 8192
  s_and_b32 s21, s21, 0xffff
  s_add_u32 s29, s29, 1
  buffer_load_dwordx4 v40, s[8:11], s20 offen offset:0 lds
  s_add_u32 s33, s33, 196608
  s_cmp_eq_u32 s33, s39
  s_cselect_b32 s33, s32, s33
  buffer_load_dwordx4 v41, s[8:11], s20 offen offset:1024 lds
  s_cmp_eq_u32 s30, s26
  s_cselect_b32 s30, s25, s30
  buffer_load_dwordx4 v42, s[8:11], s20 offen offset:2048 lds
  s_sub_u32 s34, s34, 1
  s_cmp_lg_u32 s34, 0
  buffer_load_dwordx4 v43, s[8:11], s20 offen offset:3072 lds
  s_cbranch_scc1 .fz_kernel_q_pl
  s_waitcnt vmcnt(20)
  s_barrier
  s_waitcnt vmcnt(10)
  s_barrier
  s_waitcnt vmcnt(0)
  s_barrier
  s_barrier
  s_branch .fz_kernel_serv
.fz_kernel_q_cons1:
  s_waitcnt lgkmcnt(0)
  s_mov_b32 s12, s42
  s_mov_b32 s13, s43
  s_mov_b32 s14, 0x600000
  s_mov_b32 s15, 0x00020000
  s_and_b32 s20, s18, 4
  s_add_u32 s20, s20, s16
  s_cmp_ge_u32 s20, 3
  s_cbranch_scc1 .fz_kernel_q_nsp
  s_and_b32 s20, s17, 7
  s_and_b32 s21, s18, 3
  s_lshl2_add_u32 s20, s20, s21
  s_mul_i32 s20, s20, 196608
  s_or_b32 s21, s18, 3
  s_lshl4_add_u32 s21, s16, s21
  s_lshl_b32 s21, s21, 7
  s_add_u32 s20, s20, s21
  v_mul_u32_u24 v20, 6144, v2
  s_mov_b32 exec_hi, 0
  buffer_load_dword v231, v20, s[12:15], s20 offen
  s_mov_b32 exec_hi, -1
.fz_kernel_q_nsp:
  v_lshlrev_b32 v20, 2, v0
  v_add_u32 v20, 159744, v20
  s_cmp_ge_u32 s16, 2
  s_cbranch_scc1 .fz_kernel_q_nz
  ds_write_b32 v20, v4
.fz_kernel_q_nz:
  s_lshr_b32 s26, s16, 1
  s_lshl_b32 s28, s26, 13
  v_and_b32 v20, 15, v2
  v_lshrrev_b32 v21, 4, v2
  v_bfe_u32 v22, v2, 1, 3
  v_xor_b32 v22, v22, v21
  v_lshlrev_b32 v20, 7, v20
  v_lshl_add_u32 v20, v22, 4, v20
  v_add_u32 v8, s28, v20
  v_xor_b32 v9, 64, v8
.fz_kernel_q_cs:
  s_and_b32 s27, s16, 1
  s_lshl_b32 s28, s27, 1
  v_lshrrev_b32 v14, 4, v2
  v_bfe_u32 v15, v2, 2, 2
  v_lshl_add_u32 v16, v14, 3, v15
  v_lshlrev_b32 v16, 7, v16
  v_and_b32 v14, 1, v14
  v_lshrrev_b32 v15, 1, v15
  v_lshl_add_u32 v14, v14, 1, v15
  v_xor_b32 v14, s28, v14
  v_lshl_add_u32 v16, v14, 5, v16
  v_and_b32 v14, 3, v2
  v_lshl_add_u32 v16, v14, 3, v16
  v_add_u32 v12, 65536, v16
  v_xor_b32 v13, 32, v12
  v_mov_b32 v10, v12
  v_mov_b32 v11, v13
  s_mov_b32 s29, 16
  s_mov_b32 s30, 0
  v_mov_b32 v128, 0
  v_mov_b32 v129, 0
  v_mov_b32 v130, 0
  v_mov_b32 v131, 0
  v_mov_b32 v132, 0
  v_mov_b32 v133, 0
  v_mov_b32 v134, 0
  v_mov_b32 v135, 0
  v_mov_b32 v136, 0
  v_mov_b32 v137, 0
  v_mov_b32 v138, 0
  v_mov_b32 v139, 0
  v_mov_b32 v140, 0
  v_mov_b32 v141, 0
  v_mov_b32 v142, 0
  v_mov_b32 v143, 0
  v_mov_b32 v144, 0
  v_mov_b32 v145, 0
  v_mov_b32 v146, 0
  v_mov_b32 v147, 0
  v_mov_b32 v148, 0
  v_mov_b32 v149, 0
  v_mov_b32 v150, 0
  v_mov_b32 v151, 0
  v_mov_b32 v152, 0
  v_mov_b32 v153, 0
  v_mov_b32 v154, 0
  v_mov_b32 v155, 0
  v_mov_b32 v156, 0
  v_mov_b32 v157, 0
  v_mov_b32 v158, 0
  v_mov_b32 v159, 0
  v_mov_b32 v160, 0
  v_mov_b32 v161, 0
  v_mov_b32 v162, 0
  v_mov_b32 v163, 0
  v_mov_b32 v164, 0
  v_mov_b32 v165, 0
  v_mov_b32 v166, 0
  v_mov_b32 v167, 0
  v_mov_b32 v168, 0
  v_mov_b32 v169, 0
  v_mov_b32 v170, 0
  v_mov_b32 v171, 0
  v_mov_b32 v172, 0
  v_mov_b32 v173, 0
  v_mov_b32 v174, 0
  v_mov_b32 v175, 0
  s_cmp_eq_u32 s62, 0
  s_cbranch_scc1 .fz_kernel_q_i1
  s_mov_b64 exec, 1
  s_waitcnt vmcnt(0)
  ds_add_u32 v1, v5 offset:0x100
  s_mov_b64 exec, -1
.fz_kernel_q_i1:
  v_mov_b32 v176, 0
  v_mov_b32 v177, 0
  v_mov_b32 v178, 0
  v_mov_b32 v179, 0
  v_mov_b32 v180, 0
  v_mov_b32 v181, 0
  v_mov_b32 v182, 0
  v_mov_b32 v183, 0
  v_mov_b32 v184, 0
  v_mov_b32 v185, 0
  v_mov_b32 v186, 0
  v_mov_b32 v187, 0
  v_mov_b32 v188, 0
  v_mov_b32 v189, 0
  v_mov_b32 v190, 0
  v_mov_b32 v191, 0
  v_mov_b32 v192, 0
  v_mov_b32 v193, 0
  v_mov_b32 v194, 0
  v_mov_b32 v195, 0
  v_mov_b32 v196, 0
  v_mov_b32 v197, 0
  v_mov_b32 v198, 0
  v_mov_b32 v199, 0
  v_mov_b32 v200, 0
  v_mov_b32 v201, 0
  v_mov_b32 v202, 0
  v_mov_b32 v203, 0
  v_mov_b32 v204, 0
  v_mov_b32 v205, 0
  v_mov_b32 v206, 0
  v_mov_b32 v207, 0
  v_mov_b32 v208, 0
  v_mov_b32 v209, 0
  v_mov_b32 v210, 0
  v_mov_b32 v211, 0
  v_mov_b32 v212, 0
  v_mov_b32 v213, 0
  v_mov_b32 v214, 0
  v_mov_b32 v215, 0
  v_mov_b32 v216, 0
  v_mov_b32 v217, 0
  v_mov_b32 v218, 0
  v_mov_b32 v219, 0
  v_mov_b32 v220, 0
  v_mov_b32 v221, 0
  v_mov_b32 v222, 0
  v_mov_b32 v223, 0
  v_and_b32 v14, 1, v2
  v_lshlrev_b32 v14, 4, v14
  v_mov_b32 v15, 0x3f80
  v_lshlrev_b32 v14, v14, v15
  v_mov_b32 v248, 0
  v_mov_b32 v249, 0
  v_mov_b32 v250, 0
  v_mov_b32 v251, 0
  v_mov_b32 v252, 0
  v_mov_b32 v253, 0
  v_mov_b32 v254, 0
  v_mov_b32 v255, 0
  s_mov_b32 exec_lo, 0x3
  s_mov_b32 exec_hi, 0x30
  v_mov_b32 v248, v14
  s_mov_b32 exec_lo, 0xc
  s_mov_b32 exec_hi, 0xc0
  v_mov_b32 v249, v14
  s_mov_b32 exec_lo, 0x300
  s_mov_b32 exec_hi, 0x3000
  v_mov_b32 v250, v14
  s_mov_b32 exec_lo, 0xc00
  s_mov_b32 exec_hi, 0xc000
  v_mov_b32 v251, v14
  s_mov_b32 exec_lo, 0x30000
  s_mov_b32 exec_hi, 0x300000
  v_mov_b32 v252, v14
  s_mov_b32 exec_lo, 0xc0000
  s_mov_b32 exec_hi, 0xc00000
  v_mov_b32 v253, v14
  s_mov_b32 exec_lo, 0x3000000
  s_mov_b32 exec_hi, 0x30000000
  v_mov_b32 v254, v14
  s_mov_b32 exec_lo, 0xc000000
  s_mov_b32 exec_hi, 0xc0000000
  v_mov_b32 v255, v14
  s_mov_b64 exec, -1
  s_lshl1_add_u32 s35, s18, s27
  s_lshl_b32 s35, s35, 5
  s_add_u32 s35, s35, s26
  s_lshl_b32 s35, s35, 13
  s_add_u32 s35, s35, s63
  s_lshl_b32 s11, s16, 8
  s_add_u32 s11, s11, 147456
  s_mov_b32 s20, 0xffff0000
  s_mov_b32 s21, 0xffff0000
  s_mov_b32 s24, 0x21800000
  s_mov_b32 s25, 0x5d800000
  s_andn2_b32 s8, 2, s16
  s_lshl2_add_u32 s8, s17, s8
  s_lshl4_add_u32 s8, s8, s18
  s_lshl1_add_u32 s8, s8, s27
  s_lshl_b32 s8, s8, 11
  s_add_u32 s8, s8, s64
  s_add_u32 s9, s8, 65536
  s_mov_b32 s73, 0
  s_mov_b32 s32, 7
  s_mov_b32 s12, s40
  s_mov_b32 s13, s41
  s_mov_b32 s14, 0x400000
  s_mov_b32 s15, 0x00020000
  v_lshrrev_b32 v14, 5, v2
  v_and_b32 v15, 31, v2
  v_lshlrev_b32 v14, 4, v14
  v_lshl_add_u32 v15, v15, 11, v14
  s_lshl2_add_u32 s23, s17, s16
  s_lshl_b32 s23, s23, 16
  s_lshl_b32 s22, s18, 7
  s_add_u32 s23, s22, s23
  s_waitcnt lgkmcnt(0)
  s_barrier
  ds_read_b64_tr_b16 v[56:57], v10 offset:4096
  ds_read_b64_tr_b16 v[58:59], v10 offset:4608
  ds_read_b128 v[32:35], v8 offset:0
  ds_read_b128 v[36:39], v8 offset:2048
  ds_read_b128 v[40:43], v8 offset:4096
  ds_read_b128 v[44:47], v8 offset:6144
  ds_read_b64_tr_b16 v[60:61], v11 offset:4096
  ds_read_b64_tr_b16 v[62:63], v11 offset:4608
  ds_read_b64_tr_b16 v[64:65], v10 offset:8192
  ds_read_b64_tr_b16 v[66:67], v10 offset:8704
  ds_read_b64_tr_b16 v[68:69], v11 offset:8192
  ds_read_b64_tr_b16 v[70:71], v11 offset:8704
  ds_read_b64_tr_b16 v[48:49], v10 offset:0
  ds_read_b64_tr_b16 v[50:51], v10 offset:512
  ds_read_b64_tr_b16 v[52:53], v11 offset:0
  ds_read_b64_tr_b16 v[54:55], v11 offset:512
  s_add_u32 s30, s30, 12288
  s_cmp_eq_u32 s30, 49152
  s_cselect_b32 s30, 0, s30
  v_add_u32 v8, 0x4000, v8
  v_add_u32 v10, s30, v12
  v_add_u32 v11, s30, v13
  v_and_b32 v8, 0xffff, v8
  s_waitcnt lgkmcnt(0)
  s_branch .fz_kernel_q_l0
  .p2align 6
.fz_kernel_q_loop:
  v_mfma_f32_16x16x32_bf16 v[148:151], v[52:55], v[36:39], v[148:151]
  v_mfma_f32_16x16x32_bf16 v[152:155], v[52:55], v[40:43], v[152:155]
  s_waitcnt lgkmcnt(0)
  v_mfma_f32_16x16x32_bf16 v[156:159], v[52:55], v[44:47], v[156:159]
  s_barrier
  v_mfma_f32_16x16x32_bf16 v[160:163], v[96:99], v[72:75], v[160:163]
  ds_read_b64_tr_b16 v[56:57], v10 offset:4096
  v_mfma_f32_16x16x32_bf16 v[164:167], v[96:99], v[76:79], v[164:167]
  ds_read_b64_tr_b16 v[58:59], v10 offset:4608
  v_mfma_f32_16x16x32_bf16 v[168:171], v[96:99], v[80:83], v[168:171]
  ds_read_b128 v[32:35], v8 offset:0
  v_mfma_f32_16x16x32_bf16 v[172:175], v[96:99], v[84:87], v[172:175]
  ds_read_b128 v[36:39], v8 offset:2048
  v_mfma_f32_16x16x32_bf16 v[176:179], v[100:103], v[72:75], v[176:179]
  ds_read_b128 v[40:43], v8 offset:4096
  v_mfma_f32_16x16x32_bf16 v[180:183], v[100:103], v[76:79], v[180:183]
  ds_read_b128 v[44:47], v8 offset:6144
  v_mfma_f32_16x16x32_bf16 v[184:187], v[100:103], v[80:83], v[184:187]
  ds_read_b64_tr_b16 v[60:61], v11 offset:4096
  v_mfma_f32_16x16x32_bf16 v[188:191], v[100:103], v[84:87], v[188:191]
  ds_read_b64_tr_b16 v[62:63], v11 offset:4608
  v_mfma_f32_16x16x32_bf16 v[192:195], v[72:75], v[104:107], v[192:195]
  ds_read_b64_tr_b16 v[64:65], v10 offset:8192
  s_add_u32 s30, s30, 12288
  v_mfma_f32_16x16x32_bf16 v[196:199], v[76:79], v[104:107], v[196:199]
  ds_read_b64_tr_b16 v[66:67], v10 offset:8704
  s_cmp_eq_u32 s30, 49152
  v_mfma_f32_16x16x32_bf16 v[200:203], v[80:83], v[104:107], v[200:203]
  ds_read_b64_tr_b16 v[68:69], v11 offset:8192
  s_cselect_b32 s30, 0, s30
  v_mfma_f32_16x16x32_bf16 v[204:207], v[84:87], v[104:107], v[204:207]
  ds_read_b64_tr_b16 v[70:71], v11 offset:8704
  v_mfma_f32_16x16x32_bf16 v[208:211], v[72:75], v[108:111], v[208:211]
  ds_read_b64_tr_b16 v[48:49], v10 offset:0
  v_mfma_f32_16x16x32_bf16 v[212:215], v[76:79], v[108:111], v[212:215]
  ds_read_b64_tr_b16 v[50:51], v10 offset:512
  v_mfma_f32_16x16x32_bf16 v[216:219], v[80:83], v[108:111], v[216:219]
  ds_read_b64_tr_b16 v[52:53], v11 offset:0
  v_mfma_f32_16x16x32_bf16 v[220:223], v[84:87], v[108:111], v[220:223]
  ds_read_b64_tr_b16 v[54:55], v11 offset:512
  v_mfma_f32_16x16x32_bf16 v[128:131], v[88:91], v[72:75], v[128:131]
  v_add_u32 v8, 0x4000, v8
  v_mfma_f32_16x16x32_bf16 v[132:135], v[88:91], v[76:79], v[132:135]
  v_add_u32 v10, s30, v12
  v_mfma_f32_16x16x32_bf16 v[136:139], v[88:91], v[80:83], v[136:139]
  v_add_u32 v11, s30, v13
  v_mfma_f32_16x16x32_bf16 v[140:143], v[88:91], v[84:87], v[140:143]
  v_and_b32 v8, 0xffff, v8
  v_mfma_f32_16x16x32_bf16 v[144:147], v[92:95], v[72:75], v[144:147]
  v_mfma_f32_16x16x32_bf16 v[148:151], v[92:95], v[76:79], v[148:151]
  v_mfma_f32_16x16x32_bf16 v[152:155], v[92:95], v[80:83], v[152:155]
  s_waitcnt lgkmcnt(0)
  v_mfma_f32_16x16x32_bf16 v[156:159], v[92:95], v[84:87], v[156:159]
.fz_kernel_q_l0:
  s_barrier
  v_mfma_f32_16x16x32_bf16 v[160:163], v[56:59], v[32:35], v[160:163]
  ds_read_b64_tr_b16 v[96:97], v10 offset:4096
  v_mfma_f32_16x16x32_bf16 v[164:167], v[56:59], v[36:39], v[164:167]
  ds_read_b64_tr_b16 v[98:99], v10 offset:4608
  v_mfma_f32_16x16x32_bf16 v[168:171], v[56:59], v[40:43], v[168:171]
  ds_read_b128 v[72:75], v9 offset:0
  v_mfma_f32_16x16x32_bf16 v[172:175], v[56:59], v[44:47], v[172:175]
  ds_read_b128 v[76:79], v9 offset:2048
  v_mfma_f32_16x16x32_bf16 v[176:179], v[60:63], v[32:35], v[176:179]
  ds_read_b128 v[80:83], v9 offset:4096
  v_mfma_f32_16x16x32_bf16 v[180:183], v[60:63], v[36:39], v[180:183]
  ds_read_b128 v[84:87], v9 offset:6144
  v_mfma_f32_16x16x32_bf16 v[184:187], v[60:63], v[40:43], v[184:187]
  ds_read_b64_tr_b16 v[100:101], v11 offset:4096
  v_mfma_f32_16x16x32_bf16 v[188:191], v[60:63], v[44:47], v[188:191]
  ds_read_b64_tr_b16 v[102:103], v11 offset:4608
  v_mfma_f32_16x16x32_bf16 v[192:195], v[32:35], v[64:67], v[192:195]
  ds_read_b64_tr_b16 v[104:105], v10 offset:8192
  s_add_u32 s30, s30, 12288
  v_mfma_f32_16x16x32_bf16 v[196:199], v[36:39], v[64:67], v[196:199]
  ds_read_b64_tr_b16 v[106:107], v10 offset:8704
  s_cmp_eq_u32 s30, 49152
  v_mfma_f32_16x16x32_bf16 v[200:203], v[40:43], v[64:67], v[200:203]
  ds_read_b64_tr_b16 v[108:109], v11 offset:8192
  s_cselect_b32 s30, 0, s30
  v_mfma_f32_16x16x32_bf16 v[204:207], v[44:47], v[64:67], v[204:207]
  ds_read_b64_tr_b16 v[110:111], v11 offset:8704
  s_sub_u32 s29, s29, 1
  v_mfma_f32_16x16x32_bf16 v[208:211], v[32:35], v[68:71], v[208:211]
  ds_read_b64_tr_b16 v[88:89], v10 offset:0
  s_cmp_lg_u32 s29, 0
  v_mfma_f32_16x16x32_bf16 v[212:215], v[36:39], v[68:71], v[212:215]
  ds_read_b64_tr_b16 v[90:91], v10 offset:512
  v_mfma_f32_16x16x32_bf16 v[216:219], v[40:43], v[68:71], v[216:219]
  ds_read_b64_tr_b16 v[92:93], v11 offset:0
  v_mfma_f32_16x16x32_bf16 v[220:223], v[44:47], v[68:71], v[220:223]
  ds_read_b64_tr_b16 v[94:95], v11 offset:512
  v_mfma_f32_16x16x32_bf16 v[128:131], v[48:51], v[32:35], v[128:131]
  v_add_u32 v9, 0x4000, v9
  v_mfma_f32_16x16x32_bf16 v[132:135], v[48:51], v[36:39], v[132:135]
  v_add_u32 v10, s30, v12
  v_mfma_f32_16x16x32_bf16 v[136:139], v[48:51], v[40:43], v[136:139]
  v_add_u32 v11, s30, v13
  v_mfma_f32_16x16x32_bf16 v[140:143], v[48:51], v[44:47], v[140:143]
  v_and_b32 v9, 0xffff, v9
  v_mfma_f32_16x16x32_bf16 v[144:147], v[52:55], v[32:35], v[144:147]
  s_cbranch_scc1 .fz_kernel_q_loop
  v_mfma_f32_16x16x32_bf16 v[148:151], v[52:55], v[36:39], v[148:151]
  v_mfma_f32_16x16x32_bf16 v[152:155], v[52:55], v[40:43], v[152:155]
  s_waitcnt lgkmcnt(0)
  v_mfma_f32_16x16x32_bf16 v[156:159], v[52:55], v[44:47], v[156:159]
  s_cmp_lg_u32 s62, 0
  s_cbranch_scc1 .fz_kernel_q_nr
  buffer_load_dwordx4 v[232:235], v15, s[12:15], s23 offen offset:0
  buffer_load_dwordx4 v[236:239], v15, s[12:15], s23 offen offset:32
  buffer_load_dwordx4 v[240:243], v15, s[12:15], s23 offen offset:64
  buffer_load_dwordx4 v[244:247], v15, s[12:15], s23 offen offset:96
.fz_kernel_q_nr:
  s_barrier
  v_mfma_f32_16x16x32_bf16 v[160:163], v[96:99], v[72:75], v[160:163]
  s_lshl_b32 s31, s26, 8
  s_add_u32 s31, s31, 155648
  v_and_b32 v22, 15, v2
  v_and_b32 v23, 48, v2
  v_mfma_f32_16x16x32_bf16 v[164:167], v[96:99], v[76:79], v[164:167]
  s_lshl_b32 s33, s27, 7
  s_add_u32 s33, s33, 155648
  v_lshlrev_b32 v22, 2, v22
  v_mov_b32 v1, 159952
  v_mfma_f32_16x16x32_bf16 v[168:171], v[96:99], v[80:83], v[168:171]
  v_add_u32 v29, s33, v22
  v_add_u32 v22, s31, v22
  v_mfma_f32_16x16x32_bf16 v[172:175], v[96:99], v[84:87], v[172:175]
  v_add_u32 v28, s33, v23
  v_add_u32 v23, s31, v23
  v_mfma_f32_16x16x32_bf16 v[176:179], v[100:103], v[72:75], v[176:179]
  ds_read_b32 v1, v1
  v_add_u32 v64, 4608, v22
  v_mfma_f32_16x16x32_bf16 v[180:183], v[100:103], v[76:79], v[180:183]
  ds_read_b128 v[120:123], v28 offset:5888
  v_and_b32 v12, 1, v2
  v_mfma_f32_16x16x32_bf16 v[184:187], v[100:103], v[80:83], v[184:187]
  ds_read_b128 v[124:127], v28 offset:5952
  v_add_u32 v12, -1, v12
  v_mfma_f32_16x16x32_bf16 v[188:191], v[100:103], v[84:87], v[188:191]
  ds_read2_b32 v[224:225], v64 offset0:0 offset1:128
  v_and_b32 v12, 0x3f803f80, v12
  v_mfma_f32_16x16x32_bf16 v[192:195], v[72:75], v[104:107], v[192:195]
  ds_read2_b32 v[226:227], v64 offset0:16 offset1:144
  v_and_b32 v11, 2, v2
  v_mfma_f32_16x16x32_bf16 v[196:199], v[76:79], v[104:107], v[196:199]
  ds_read2_b32 v[228:229], v64 offset0:32 offset1:160
  v_xor_b32 v14, 0x3f803f80, v12
  v_mfma_f32_16x16x32_bf16 v[200:203], v[80:83], v[104:107], v[200:203]
  ds_read2_b32 v[230:231], v64 offset0:48 offset1:176
  v_mul_u32_u24 v11, 0x5555, v11
  v_mfma_f32_16x16x32_bf16 v[204:207], v[84:87], v[104:107], v[204:207]
  ds_read_b32 v24, v29 offset:6144
  v_mov_b32 v13, v12
  v_mfma_f32_16x16x32_bf16 v[208:211], v[72:75], v[108:111], v[208:211]
  ds_read_b32 v26, v29 offset:6208
  v_mov_b32 v15, v14
  v_mfma_f32_16x16x32_bf16 v[212:215], v[76:79], v[108:111], v[212:215]
  ds_read_b128 v[32:35], v23 offset:4608
  ds_read_b128 v[48:51], v23 offset:5120
  v_mfma_f32_16x16x32_bf16 v[216:219], v[80:83], v[108:111], v[216:219]
  ds_read_b128 v[36:39], v23 offset:4672
  ds_read_b128 v[52:55], v23 offset:5184
  v_mfma_f32_16x16x32_bf16 v[220:223], v[84:87], v[108:111], v[220:223]
  ds_read_b128 v[40:43], v23 offset:4736
  ds_read_b128 v[56:59], v23 offset:5248
  v_mfma_f32_16x16x32_bf16 v[128:131], v[88:91], v[72:75], v[128:131]
  ds_read_b128 v[44:47], v23 offset:4800
  ds_read_b128 v[60:63], v23 offset:5312
  v_mfma_f32_16x16x32_bf16 v[132:135], v[88:91], v[76:79], v[132:135]
  ds_read_b128 v[112:115], v28 offset:5632
  ds_read_b128 v[116:119], v28 offset:5696
  v_mfma_f32_16x16x32_bf16 v[136:139], v[88:91], v[80:83], v[136:139]
  s_lshl1_add_u32 s34, s18, s27
  s_lshl4_add_u32 s34, s34, s17
  s_lshl1_add_u32 s34, s34, s26
  v_mfma_f32_16x16x32_bf16 v[140:143], v[88:91], v[84:87], v[140:143]
  s_lshl_b32 s36, s34, 13
  s_add_u32 s36, s36, s63
  s_add_u32 s37, s36, 4096
  v_mfma_f32_16x16x32_bf16 v[144:147], v[92:95], v[72:75], v[144:147]
  s_lshl_b32 s34, s16, 12
  s_add_u32 s34, s34, 131072
  v_add_u32 v9, s34, v3
  v_mfma_f32_16x16x32_bf16 v[148:151], v[92:95], v[76:79], v[148:151]
  v_xor_b32 v8, 8192, v9
  v_mfma_f32_16x16x32_bf16 v[152:155], v[92:95], v[80:83], v[152:155]
  v_add_u32 v11, 0x4444, v11
  v_mfma_f32_16x16x32_bf16 v[156:159], v[92:95], v[84:87], v[156:159]
  v_add_u32 v10, 4096, v3
  s_waitcnt lgkmcnt(12)
  v_add_u32 v1, -1, v1
  v_lshrrev_b32 v1, 6, v1
  v_cmp_eq_u32 vcc, s26, v1
  s_cbranch_vccnz .fz_kernel_q_patch
.fz_kernel_q_pback:
  v_pk_mul_f32 v[64:65], v[120:121], v[224:225] op_sel:[0,1] op_sel_hi:[1,1]
  v_pk_fma_f32 v[160:161], v[160:161], v[224:225], v[64:65] op_sel_hi:[1,0,1]
  v_pk_mul_f32 v[66:67], v[122:123], v[224:225] op_sel:[0,1] op_sel_hi:[1,1]
  v_pk_fma_f32 v[162:163], v[162:163], v[224:225], v[66:67] op_sel_hi:[1,0,1]
  v_pk_mul_f32 v[68:69], v[124:125], v[224:225] op_sel:[0,1] op_sel_hi:[1,1]
  v_pk_fma_f32 v[176:177], v[176:177], v[224:225], v[68:69] op_sel_hi:[1,0,1]
  v_pk_mul_f32 v[70:71], v[126:127], v[224:225] op_sel:[0,1] op_sel_hi:[1,1]
  v_pk_fma_f32 v[178:179], v[178:179], v[224:225], v[70:71] op_sel_hi:[1,0,1]
  v_cvt_pk_bf16_f32 v80, v160, v161
  v_cvt_pk_bf16_f32 v81, v162, v163
  v_cvt_pk_bf16_f32 v82, v176, v177
  v_cvt_pk_bf16_f32 v83, v178, v179
  v_pk_mul_f32 v[64:65], v[120:121], v[226:227] op_sel:[0,1] op_sel_hi:[1,1]
  v_pk_fma_f32 v[164:165], v[164:165], v[226:227], v[64:65] op_sel_hi:[1,0,1]
  v_pk_mul_f32 v[66:67], v[122:123], v[226:227] op_sel:[0,1] op_sel_hi:[1,1]
  v_pk_fma_f32 v[166:167], v[166:167], v[226:227], v[66:67] op_sel_hi:[1,0,1]
  v_pk_mul_f32 v[68:69], v[124:125], v[226:227] op_sel:[0,1] op_sel_hi:[1,1]
  v_pk_fma_f32 v[180:181], v[180:181], v[226:227], v[68:69] op_sel_hi:[1,0,1]
  v_pk_mul_f32 v[70:71], v[126:127], v[226:227] op_sel:[0,1] op_sel_hi:[1,1]
  v_pk_fma_f32 v[182:183], v[182:183], v[226:227], v[70:71] op_sel_hi:[1,0,1]
  v_cvt_pk_bf16_f32 v84, v164, v165
  v_cvt_pk_bf16_f32 v85, v166, v167
  v_cvt_pk_bf16_f32 v86, v180, v181
  v_cvt_pk_bf16_f32 v87, v182, v183
  v_permlane16_swap_b32 v80, v84
  v_permlane16_swap_b32 v81, v85
  v_permlane16_swap_b32 v82, v86
  v_permlane16_swap_b32 v83, v87
  buffer_store_dwordx4 v[80:83], v3, s[4:7], s36 offen offset:0 sc1
  buffer_store_dwordx4 v[84:87], v3, s[4:7], s36 offen offset:1024 sc1
  v_pk_mul_f32 v[64:65], v[120:121], v[228:229] op_sel:[0,1] op_sel_hi:[1,1]
  v_pk_fma_f32 v[168:169], v[168:169], v[228:229], v[64:65] op_sel_hi:[1,0,1]
  v_pk_mul_f32 v[66:67], v[122:123], v[228:229] op_sel:[0,1] op_sel_hi:[1,1]
  v_pk_fma_f32 v[170:171], v[170:171], v[228:229], v[66:67] op_sel_hi:[1,0,1]
  v_pk_mul_f32 v[68:69], v[124:125], v[228:229] op_sel:[0,1] op_sel_hi:[1,1]
  v_pk_fma_f32 v[184:185], v[184:185], v[228:229], v[68:69] op_sel_hi:[1,0,1]
  v_pk_mul_f32 v[70:71], v[126:127], v[228:229] op_sel:[0,1] op_sel_hi:[1,1]
  v_pk_fma_f32 v[186:187], v[186:187], v[228:229], v[70:71] op_sel_hi:[1,0,1]
  v_cvt_pk_bf16_f32 v96, v168, v169
  v_cvt_pk_bf16_f32 v97, v170, v171
  v_cvt_pk_bf16_f32 v98, v184, v185
  v_cvt_pk_bf16_f32 v99, v186, v187
  v_pk_mul_f32 v[64:65], v[120:121], v[230:231] op_sel:[0,1] op_sel_hi:[1,1]
  v_pk_fma_f32 v[172:173], v[172:173], v[230:231], v[64:65] op_sel_hi:[1,0,1]
  v_pk_mul_f32 v[66:67], v[122:123], v[230:231] op_sel:[0,1] op_sel_hi:[1,1]
  v_pk_fma_f32 v[174:175], v[174:175], v[230:231], v[66:67] op_sel_hi:[1,0,1]
  v_pk_mul_f32 v[68:69], v[124:125], v[230:231] op_sel:[0,1] op_sel_hi:[1,1]
  v_pk_fma_f32 v[188:189], v[188:189], v[230:231], v[68:69] op_sel_hi:[1,0,1]
  v_pk_mul_f32 v[70:71], v[126:127], v[230:231] op_sel:[0,1] op_sel_hi:[1,1]
  v_pk_fma_f32 v[190:191], v[190:191], v[230:231], v[70:71] op_sel_hi:[1,0,1]
  v_cvt_pk_bf16_f32 v100, v172, v173
  v_cvt_pk_bf16_f32 v101, v174, v175
  v_cvt_pk_bf16_f32 v102, v188, v189
  v_cvt_pk_bf16_f32 v103, v190, v191
  v_permlane16_swap_b32 v96, v100
  v_permlane16_swap_b32 v97, v101
  v_permlane16_swap_b32 v98, v102
  v_permlane16_swap_b32 v99, v103
  buffer_store_dwordx4 v[96:99], v3, s[4:7], s37 offen offset:0 sc1
  buffer_store_dwordx4 v[100:103], v3, s[4:7], s37 offen offset:1024 sc1
  s_waitcnt lgkmcnt(0)
  v_pk_mul_f32 v[64:65], v[48:49], v[24:25] op_sel_hi:[1,0]
  v_pk_fma_f32 v[192:193], v[192:193], v[32:33], v[64:65]
  v_pk_mul_f32 v[66:67], v[50:51], v[24:25] op_sel_hi:[1,0]
  v_pk_fma_f32 v[194:195], v[194:195], v[34:35], v[66:67]
  v_pk_mul_f32 v[68:69], v[48:49], v[26:27] op_sel_hi:[1,0]
  v_pk_fma_f32 v[208:209], v[208:209], v[32:33], v[68:69]
  v_pk_mul_f32 v[70:71], v[50:51], v[26:27] op_sel_hi:[1,0]
  v_pk_fma_f32 v[210:211], v[210:211], v[34:35], v[70:71]
  v_cvt_pk_bf16_f32 v88, v192, v193
  v_cvt_pk_bf16_f32 v90, v208, v209
  v_cvt_pk_bf16_f32 v89, v194, v195
  v_cvt_pk_bf16_f32 v91, v210, v211
  v_pk_mul_f32 v[64:65], v[52:53], v[24:25] op_sel_hi:[1,0]
  v_pk_fma_f32 v[196:197], v[196:197], v[36:37], v[64:65]
  v_pk_mul_f32 v[66:67], v[54:55], v[24:25] op_sel_hi:[1,0]
  v_pk_fma_f32 v[198:199], v[198:199], v[38:39], v[66:67]
  v_pk_mul_f32 v[68:69], v[52:53], v[26:27] op_sel_hi:[1,0]
  v_pk_fma_f32 v[212:213], v[212:213], v[36:37], v[68:69]
  v_pk_mul_f32 v[70:71], v[54:55], v[26:27] op_sel_hi:[1,0]
  v_pk_fma_f32 v[214:215], v[214:215], v[38:39], v[70:71]
  v_cvt_pk_bf16_f32 v92, v196, v197
  v_cvt_pk_bf16_f32 v94, v212, v213
  v_cvt_pk_bf16_f32 v93, v198, v199
  v_cvt_pk_bf16_f32 v95, v214, v215
  v_permlane16_swap_b32 v88, v90
  v_permlane16_swap_b32 v89, v91
  v_permlane16_swap_b32 v92, v94
  v_permlane16_swap_b32 v93, v95
  v_permlane32_swap_b32 v88, v90
  v_permlane32_swap_b32 v89, v91
  v_permlane32_swap_b32 v92, v94
  v_permlane32_swap_b32 v93, v95
  buffer_store_dwordx4 v[88:91], v3, s[4:7], s36 offen offset:2048 sc1
  buffer_store_dwordx4 v[92:95], v3, s[4:7], s36 offen offset:3072 sc1
  v_pk_mul_f32 v[64:65], v[56:57], v[24:25] op_sel_hi:[1,0]
  v_pk_fma_f32 v[200:201], v[200:201], v[40:41], v[64:65]
  v_pk_mul_f32 v[66:67], v[58:59], v[24:25] op_sel_hi:[1,0]
  v_pk_fma_f32 v[202:203], v[202:203], v[42:43], v[66:67]
  v_pk_mul_f32 v[68:69], v[56:57], v[26:27] op_sel_hi:[1,0]
  v_pk_fma_f32 v[216:217], v[216:217], v[40:41], v[68:69]
  v_pk_mul_f32 v[70:71], v[58:59], v[26:27] op_sel_hi:[1,0]
  v_pk_fma_f32 v[218:219], v[218:219], v[42:43], v[70:71]
  v_cvt_pk_bf16_f32 v104, v200, v201
  v_cvt_pk_bf16_f32 v106, v216, v217
  v_cvt_pk_bf16_f32 v105, v202, v203
  v_cvt_pk_bf16_f32 v107, v218, v219
  v_pk_mul_f32 v[64:65], v[60:61], v[24:25] op_sel_hi:[1,0]
  v_pk_fma_f32 v[204:205], v[204:205], v[44:45], v[64:65]
  v_pk_mul_f32 v[66:67], v[62:63], v[24:25] op_sel_hi:[1,0]
  v_pk_fma_f32 v[206:207], v[206:207], v[46:47], v[66:67]
  v_pk_mul_f32 v[68:69], v[60:61], v[26:27] op_sel_hi:[1,0]
  v_pk_fma_f32 v[220:221], v[220:221], v[44:45], v[68:69]
  v_pk_mul_f32 v[70:71], v[62:63], v[26:27] op_sel_hi:[1,0]
  v_pk_fma_f32 v[222:223], v[222:223], v[46:47], v[70:71]
  v_cvt_pk_bf16_f32 v108, v204, v205
  v_cvt_pk_bf16_f32 v110, v220, v221
  v_cvt_pk_bf16_f32 v109, v206, v207
  v_cvt_pk_bf16_f32 v111, v222, v223
  v_permlane16_swap_b32 v104, v106
  v_permlane16_swap_b32 v105, v107
  v_permlane16_swap_b32 v108, v110
  v_permlane16_swap_b32 v109, v111
  v_permlane32_swap_b32 v104, v106
  v_permlane32_swap_b32 v105, v107
  v_permlane32_swap_b32 v108, v110
  v_permlane32_swap_b32 v109, v111
  buffer_store_dwordx4 v[104:107], v3, s[4:7], s37 offen offset:2048 sc1
  buffer_store_dwordx4 v[108:111], v3, s[4:7], s37 offen offset:3072 sc1
  v_mul_f32 v224, 0.25503486164919736, v224
  v_mul_f32 v225, 0.25503486164919736, v225
  v_mul_f32 v226, 0.25503486164919736, v226
  v_mul_f32 v227, 0.25503486164919736, v227
  v_mul_f32 v228, 0.25503486164919736, v228
  v_mul_f32 v229, 0.25503486164919736, v229
  v_mul_f32 v230, 0.25503486164919736, v230
  v_mul_f32 v231, 0.25503486164919736, v231
  v_pk_mul_f32 v[64:65], v[112:113], v[224:225] op_sel:[0,1] op_sel_hi:[1,1]
  v_pk_fma_f32 v[128:129], v[128:129], v[224:225], v[64:65] op_sel_hi:[1,0,1]
  v_pk_mul_f32 v[66:67], v[114:115], v[224:225] op_sel:[0,1] op_sel_hi:[1,1]
  v_pk_fma_f32 v[130:131], v[130:131], v[224:225], v[66:67] op_sel_hi:[1,0,1]
  v_pk_mul_f32 v[68:69], v[116:117], v[224:225] op_sel:[0,1] op_sel_hi:[1,1]
  v_pk_fma_f32 v[144:145], v[144:145], v[224:225], v[68:69] op_sel_hi:[1,0,1]
  v_pk_mul_f32 v[70:71], v[118:119], v[224:225] op_sel:[0,1] op_sel_hi:[1,1]
  v_pk_fma_f32 v[146:147], v[146:147], v[224:225], v[70:71] op_sel_hi:[1,0,1]
  v_cvt_pk_bf16_f32 v16, v128, v129
  v_cvt_pk_bf16_f32 v17, v130, v131
  v_cvt_pk_bf16_f32 v18, v144, v145
  v_cvt_pk_bf16_f32 v19, v146, v147
  v_pk_mul_f32 v[64:65], v[112:113], v[226:227] op_sel:[0,1] op_sel_hi:[1,1]
  v_pk_fma_f32 v[132:133], v[132:133], v[226:227], v[64:65] op_sel_hi:[1,0,1]
  v_pk_mul_f32 v[66:67], v[114:115], v[226:227] op_sel:[0,1] op_sel_hi:[1,1]
  v_pk_fma_f32 v[134:135], v[134:135], v[226:227], v[66:67] op_sel_hi:[1,0,1]
  v_pk_mul_f32 v[68:69], v[116:117], v[226:227] op_sel:[0,1] op_sel_hi:[1,1]
  v_pk_fma_f32 v[148:149], v[148:149], v[226:227], v[68:69] op_sel_hi:[1,0,1]
  v_pk_mul_f32 v[70:71], v[118:119], v[226:227] op_sel:[0,1] op_sel_hi:[1,1]
  v_pk_fma_f32 v[150:151], v[150:151], v[226:227], v[70:71] op_sel_hi:[1,0,1]
  v_cvt_pk_bf16_f32 v20, v132, v133
  v_cvt_pk_bf16_f32 v21, v134, v135
  v_cvt_pk_bf16_f32 v22, v148, v149
  v_cvt_pk_bf16_f32 v23, v150, v151
  v_permlane16_swap_b32 v16, v20
  v_permlane16_swap_b32 v17, v21
  v_permlane16_swap_b32 v18, v22
  v_permlane16_swap_b32 v19, v23
  ds_write_b128 v8, v[16:19] offset:0
  ds_write_b128 v8, v[20:23] offset:1024
  v_pk_mul_f32 v[64:65], v[112:113], v[228:229] op_sel:[0,1] op_sel_hi:[1,1]
  v_pk_fma_f32 v[136:137], v[136:137], v[228:229], v[64:65] op_sel_hi:[1,0,1]
  v_pk_mul_f32 v[66:67], v[114:115], v[228:229] op_sel:[0,1] op_sel_hi:[1,1]
  v_pk_fma_f32 v[138:139], v[138:139], v[228:229], v[66:67] op_sel_hi:[1,0,1]
  v_pk_mul_f32 v[68:69], v[116:117], v[228:229] op_sel:[0,1] op_sel_hi:[1,1]
  v_pk_fma_f32 v[152:153], v[152:153], v[228:229], v[68:69] op_sel_hi:[1,0,1]
  v_pk_mul_f32 v[70:71], v[118:119], v[228:229] op_sel:[0,1] op_sel_hi:[1,1]
  v_pk_fma_f32 v[154:155], v[154:155], v[228:229], v[70:71] op_sel_hi:[1,0,1]
  v_cvt_pk_bf16_f32 v24, v136, v137
  v_cvt_pk_bf16_f32 v25, v138, v139
  v_cvt_pk_bf16_f32 v26, v152, v153
  v_cvt_pk_bf16_f32 v27, v154, v155
  v_pk_mul_f32 v[64:65], v[112:113], v[230:231] op_sel:[0,1] op_sel_hi:[1,1]
  v_pk_fma_f32 v[140:141], v[140:141], v[230:231], v[64:65] op_sel_hi:[1,0,1]
  v_pk_mul_f32 v[66:67], v[114:115], v[230:231] op_sel:[0,1] op_sel_hi:[1,1]
  v_pk_fma_f32 v[142:143], v[142:143], v[230:231], v[66:67] op_sel_hi:[1,0,1]
  v_pk_mul_f32 v[68:69], v[116:117], v[230:231] op_sel:[0,1] op_sel_hi:[1,1]
  v_pk_fma_f32 v[156:157], v[156:157], v[230:231], v[68:69] op_sel_hi:[1,0,1]
  v_pk_mul_f32 v[70:71], v[118:119], v[230:231] op_sel:[0,1] op_sel_hi:[1,1]
  v_pk_fma_f32 v[158:159], v[158:159], v[230:231], v[70:71] op_sel_hi:[1,0,1]
  v_cvt_pk_bf16_f32 v28, v140, v141
  v_cvt_pk_bf16_f32 v29, v142, v143
  v_cvt_pk_bf16_f32 v30, v156, v157
  v_cvt_pk_bf16_f32 v31, v158, v159
  v_permlane16_swap_b32 v24, v28
  v_permlane16_swap_b32 v25, v29
  v_permlane16_swap_b32 v26, v30
  v_permlane16_swap_b32 v27, v31
  ds_write_b128 v8, v[24:27] offset:2048
  ds_write_b128 v8, v[28:31] offset:3072
  s_branch .fz_kernel_att
.fz_kernel_q_help1:
  s_waitcnt lgkmcnt(0)
  s_mov_b32 s3, 32
  s_cmp_eq_u32 s16, 7
  s_cbranch_scc1 .fz_kernel_q_h7
  s_getpc_b64 s[0:1]
.fz_kernel_ct4:
  s_sub_u32 s0, s0, .fz_kernel_ct4-fz_kernel
  s_subb_u32 s1, s1, 0
  s_lshr_b32 s31, s2, 3
  s_mulk_i32 s31, 0x500
  v_lshl_add_u32 v1, v2, 7, s31
  v_min_u32 v1, .fz_kernel_last-fz_kernel, v1
  s_mov_b64 exec, 0x3ff
  global_load_dword v1, v1, s[0:1]
  s_mov_b64 exec, -1
.fz_kernel_ct4e:
  s_mov_b32 s12, s58
  s_mov_b32 s13, s59
  s_mov_b32 s14, 0x100
  s_mov_b32 s15, 0x00020000
  s_mov_b32 s30, 0
  s_and_b32 s31, s18, 3
  s_sub_u32 s31, s31, s30
  s_and_b32 s30, s31, 3
  s_lshl_b32 s30, s30, 14
  v_and_b32 v20, 15, v2
  v_lshrrev_b32 v21, 4, v2
  v_bfe_u32 v22, v2, 1, 3
  v_xor_b32 v22, v22, v21
  v_lshlrev_b32 v21, 7, v20
  v_lshl_add_u32 v21, v22, 4, v21
  v_add_u32 v21, s30, v21
  v_xor_b32 v22, 64, v21
  v_lshlrev_b32 v20, 3, v20
  s_lshl_b32 s30, s17, 10
  s_add_u32 s30, s30, 0x1808000
  s_mov_b32 exec_lo, 0x00f0000f
  s_mov_b32 exec_hi, 0xf0000f00
  v_add_u32 v20, 4, v20
  s_mov_b64 exec, -1
  v_mov_b32 v24, 0x3f803f80
  v_mov_b32 v25, v24
  v_mov_b32 v26, v24
  v_mov_b32 v27, v24
  s_lshl_b32 s31, s31, 1
  s_sub_u32 s31, 31, s31
  v_lshlrev_b32 v52, 3, v2
  v_add_u32 v52, 155648, v52
  v_mov_b32 v54, 1.0
  v_mov_b32 v55, 1.0
  v_mov_b32 v56, 0
  v_mov_b32 v57, 0
  ds_write_b64 v52, v[54:55] offset:6400
  ds_write_b64 v52, v[56:57] offset:6912
  s_mov_b32 s20, s48
  s_mov_b32 s21, s49
  s_mov_b32 s22, 0x800
  s_mov_b32 s23, 0x00020000
  v_lshlrev_b32 v40, 5, v2
  buffer_load_dwordx4 v[44:47], v40, s[20:23], 0 offen
  buffer_load_dwordx4 v[48:51], v40, s[20:23], 0 offen offset:16
  v_mov_b32 v40, 0
  s_waitcnt vmcnt(0)
  v_lshlrev_b32 v41, 16, v44
  v_and_b32 v42, 0xffff0000, v44
  v_add_f32 v40, v40, v41
  v_add_f32 v40, v40, v42
  v_lshlrev_b32 v41, 16, v45
  v_and_b32 v42, 0xffff0000, v45
  v_add_f32 v40, v40, v41
  v_add_f32 v40, v40, v42
  v_lshlrev_b32 v41, 16, v46
  v_and_b32 v42, 0xffff0000, v46
  v_add_f32 v40, v40, v41
  v_add_f32 v40, v40, v42
  v_lshlrev_b32 v41, 16, v47
  v_and_b32 v42, 0xffff0000, v47
  v_add_f32 v40, v40, v41
  v_add_f32 v40, v40, v42
  v_lshlrev_b32 v41, 16, v48
  v_and_b32 v42, 0xffff0000, v48
  v_add_f32 v40, v40, v41
  v_add_f32 v40, v40, v42
  v_lshlrev_b32 v41, 16, v49
  v_and_b32 v42, 0xffff0000, v49
  v_add_f32 v40, v40, v41
  v_add_f32 v40, v40, v42
  v_lshlrev_b32 v41, 16, v50
  v_and_b32 v42, 0xffff0000, v50
  v_add_f32 v40, v40, v41
  v_add_f32 v40, v40, v42
  v_lshlrev_b32 v41, 16, v51
  v_and_b32 v42, 0xffff0000, v51
  v_add_f32 v40, v40, v41
  v_add_f32 v40, v40, v42
  s_nop 1
  v_add_f32 v40, v40, v40 quad_perm:[1,0,3,2] row_mask:0xf bank_mask:0xf
  s_nop 1
  v_add_f32 v40, v40, v40 quad_perm:[2,3,0,1] row_mask:0xf bank_mask:0xf
  s_nop 1
  v_add_f32 v40, v40, v40 row_half_mirror row_mask:0xf bank_mask:0xf
  s_nop 1
  v_add_f32 v40, v40, v40 row_mirror row_mask:0xf bank_mask:0xf
  s_nop 0
  v_readlane_b32 s20, v40, 16
  v_readlane_b32 s21, v40, 32
  v_readlane_b32 s22, v40, 48
  v_add_f32 v40, s20, v40
  v_add_f32 v40, s21, v40
  v_add_f32 v40, s22, v40
  v_mul_f32 v40, 0x3a800000, v40
  s_nop 0
  v_readfirstlane_b32 s76, v40
.fz_kernel_xs5:
  s_barrier
  s_sub_u32 s3, s3, 1
  s_cmp_lg_u32 s3, s31
  s_cbranch_scc1 .fz_kernel_xs5
  ds_read_b128 v[64:67], v21 offset:0
  ds_read_b128 v[72:75], v21 offset:2048
  ds_read_b128 v[80:83], v21 offset:4096
  ds_read_b128 v[88:91], v21 offset:6144
  ds_read_b128 v[96:99], v21 offset:8192
  ds_read_b128 v[104:107], v21 offset:10240
  ds_read_b128 v[112:115], v21 offset:12288
  ds_read_b128 v[120:123], v21 offset:14336
  ds_read_b128 v[68:71], v22 offset:0
  ds_read_b128 v[76:79], v22 offset:2048
  ds_read_b128 v[84:87], v22 offset:4096
  ds_read_b128 v[92:95], v22 offset:6144
  ds_read_b128 v[100:103], v22 offset:8192
  ds_read_b128 v[108:111], v22 offset:10240
  ds_read_b128 v[116:119], v22 offset:12288
  ds_read_b128 v[124:127], v22 offset:14336
  s_waitcnt lgkmcnt(0)
  s_cmp_eq_u32 s3, 0
  s_cbranch_scc1 .fz_kernel_hb6
  s_barrier
  s_sub_u32 s3, s3, 1
.fz_kernel_hb6:
  s_setprio 2
  v_mfma_f32_16x16x32_bf16 v[128:131], v[24:27], v[64:67], 0
  v_mfma_f32_16x16x32_bf16 v[160:163], v[64:67], v[64:67], 0
  v_mfma_f32_16x16x32_bf16 v[132:135], v[24:27], v[72:75], 0
  v_mfma_f32_16x16x32_bf16 v[164:167], v[72:75], v[72:75], 0
  v_mfma_f32_16x16x32_bf16 v[136:139], v[24:27], v[80:83], 0
  v_mfma_f32_16x16x32_bf16 v[168:171], v[80:83], v[80:83], 0
  v_mfma_f32_16x16x32_bf16 v[140:143], v[24:27], v[88:91], 0
  v_mfma_f32_16x16x32_bf16 v[172:175], v[88:91], v[88:91], 0
  v_mfma_f32_16x16x32_bf16 v[144:147], v[24:27], v[96:99], 0
  v_mfma_f32_16x16x32_bf16 v[176:179], v[96:99], v[96:99], 0
  v_mfma_f32_16x16x32_bf16 v[148:151], v[24:27], v[104:107], 0
  v_mfma_f32_16x16x32_bf16 v[180:183], v[104:107], v[104:107], 0
  v_mfma_f32_16x16x32_bf16 v[152:155], v[24:27], v[112:115], 0
  v_mfma_f32_16x16x32_bf16 v[184:187], v[112:115], v[112:115], 0
  v_mfma_f32_16x16x32_bf16 v[156:159], v[24:27], v[120:123], 0
  v_mfma_f32_16x16x32_bf16 v[188:191], v[120:123], v[120:123], 0
  v_mfma_f32_16x16x32_bf16 v[128:131], v[24:27], v[68:71], v[128:131]
  v_mfma_f32_16x16x32_bf16 v[160:163], v[68:71], v[68:71], v[160:163]
  v_mfma_f32_16x16x32_bf16 v[132:135], v[24:27], v[76:79], v[132:135]
  v_mfma_f32_16x16x32_bf16 v[164:167], v[76:79], v[76:79], v[164:167]
  v_mfma_f32_16x16x32_bf16 v[136:139], v[24:27], v[84:87], v[136:139]
  v_mfma_f32_16x16x32_bf16 v[168:171], v[84:87], v[84:87], v[168:171]
  v_mfma_f32_16x16x32_bf16 v[140:143], v[24:27], v[92:95], v[140:143]
  v_mfma_f32_16x16x32_bf16 v[172:175], v[92:95], v[92:95], v[172:175]
  v_mfma_f32_16x16x32_bf16 v[144:147], v[24:27], v[100:103], v[144:147]
  v_mfma_f32_16x16x32_bf16 v[176:179], v[100:103], v[100:103], v[176:179]
  v_mfma_f32_16x16x32_bf16 v[148:151], v[24:27], v[108:111], v[148:151]
  v_mfma_f32_16x16x32_bf16 v[180:183], v[108:111], v[108:111], v[180:183]
  v_mfma_f32_16x16x32_bf16 v[152:155], v[24:27], v[116:119], v[152:155]
  v_mfma_f32_16x16x32_bf16 v[184:187], v[116:119], v[116:119], v[184:187]
  v_mfma_f32_16x16x32_bf16 v[156:159], v[24:27], v[124:127], v[156:159]
  v_mfma_f32_16x16x32_bf16 v[188:191], v[124:127], v[124:127], v[188:191]
  s_setprio 0
  s_cmp_eq_u32 s3, 0
  s_cbranch_scc1 .fz_kernel_hb7
  s_barrier
  s_sub_u32 s3, s3, 1
.fz_kernel_hb7:
  s_mov_b32 exec_lo, 0x100001
  s_mov_b32 exec_hi, 0x10000100
  buffer_load_dword v9, v4, s[12:15], 0 offen sc1
  v_mov_b32 v128, v160
  v_mov_b32 v132, v164
  v_mov_b32 v136, v168
  v_mov_b32 v140, v172
  v_mov_b32 v144, v176
  v_mov_b32 v148, v180
  v_mov_b32 v152, v184
  v_mov_b32 v156, v188
  s_mov_b32 exec_lo, 0x200002
  s_mov_b32 exec_hi, 0x20000200
  v_mov_b32 v128, v161
  v_mov_b32 v132, v165
  v_mov_b32 v136, v169
  v_mov_b32 v140, v173
  v_mov_b32 v144, v177
  v_mov_b32 v148, v181
  v_mov_b32 v152, v185
  v_mov_b32 v156, v189
  s_mov_b32 exec_lo, 0x400004
  s_mov_b32 exec_hi, 0x40000400
  v_mov_b32 v128, v162
  v_mov_b32 v132, v166
  v_mov_b32 v136, v170
  v_mov_b32 v140, v174
  v_mov_b32 v144, v178
  v_mov_b32 v148, v182
  v_mov_b32 v152, v186
  v_mov_b32 v156, v190
  s_cmp_eq_u32 s3, 0
  s_cbranch_scc1 .fz_kernel_hb8
  s_barrier
  s_sub_u32 s3, s3, 1
.fz_kernel_hb8:
  s_mov_b32 exec_lo, 0x800008
  s_mov_b32 exec_hi, 0x80000800
  v_mov_b32 v128, v163
  v_mov_b32 v132, v167
  v_mov_b32 v136, v171
  v_mov_b32 v140, v175
  v_mov_b32 v144, v179
  v_mov_b32 v148, v183
  v_mov_b32 v152, v187
  v_mov_b32 v156, v191
  s_mov_b64 exec, 1
  s_mov_b32 s38, 0
.fz_kernel_pw9:
  s_mov_b32 s46, 0
  s_call_b64 s[0:1], .fz_kernel_hw
  s_waitcnt vmcnt(0)
  v_readfirstlane_b32 s31, v9
  s_cmp_eq_u32 s31, 64
  s_cbranch_scc1 .fz_kernel_pw9d
  s_cmp_eq_u32 s3, 0
  s_cbranch_scc1 .fz_kernel_hb10
  s_barrier
  s_sub_u32 s3, s3, 1
.fz_kernel_hb10:
  s_cmp_eq_u32 s3, 0
  s_cbranch_scc1 .fz_kernel_hb11
  s_barrier
  s_sub_u32 s3, s3, 1
.fz_kernel_hb11:
  buffer_load_dword v9, v4, s[12:15], 0 offen sc1
  s_add_u32 s38, s38, 1
  s_cmp_lt_u32 s38, 131072
  s_cbranch_scc1 .fz_kernel_pw9
  s_waitcnt vmcnt(0)
.fz_kernel_pw9d:
  s_mov_b64 exec, -1
  s_cmp_eq_u32 s3, 0
  s_cbranch_scc1 .fz_kernel_hb12
  s_barrier
  s_sub_u32 s3, s3, 1
.fz_kernel_hb12:
  s_mov_b32 exec_lo, 0x00fff00f
  s_mov_b32 exec_hi, 0xff000ff0
  buffer_atomic_add_f32 v128, v20, s[4:7], s30 offen offset:0 sc1
  buffer_atomic_add_f32 v132, v20, s[4:7], s30 offen offset:128 sc1
  buffer_atomic_add_f32 v136, v20, s[4:7], s30 offen offset:256 sc1
  buffer_atomic_add_f32 v140, v20, s[4:7], s30 offen offset:384 sc1
  buffer_atomic_add_f32 v144, v20, s[4:7], s30 offen offset:512 sc1
  buffer_atomic_add_f32 v148, v20, s[4:7], s30 offen offset:640 sc1
  buffer_atomic_add_f32 v152, v20, s[4:7], s30 offen offset:768 sc1
  buffer_atomic_add_f32 v156, v20, s[4:7], s30 offen offset:896 sc1
  s_mov_b64 exec, -1
  s_mov_b32 s46, 0
  s_call_b64 s[0:1], .fz_kernel_hw
  s_waitcnt vmcnt(0)
  v_lshlrev_b32 v7, 11, v2
  s_lshl_b32 s31, s17, 7
  s_lshl_b32 s33, 1, s18
  s_add_u32 s31, s31, s67
  s_add_u32 s31, s31, 0x1800018
  v_mov_b32 v8, s33
  s_mov_b64 exec, 0xffff
  buffer_atomic_or v8, v7, s[4:7], s31 offen sc1
  s_mov_b64 exec, -1
  s_add_u32 s37, s19, 24
.fz_kernel_f113:
  s_cmp_le_u32 s3, 9
  s_cbranch_scc1 .fz_kernel_f113d
  s_barrier
  s_sub_u32 s3, s3, 1
  s_branch .fz_kernel_f113
.fz_kernel_f113d:
  s_mov_b64 exec, 1
  buffer_load_dword v9, v4, s[4:7], s37 offen sc1
  s_mov_b64 exec, 1
  s_mov_b32 s38, 0
.fz_kernel_pw14:
  s_mov_b32 s46, 0
  s_call_b64 s[0:1], .fz_kernel_hw
  s_waitcnt vmcnt(0)
  v_readfirstlane_b32 s31, v9
  s_cmp_eq_u32 s31, 65535
  s_cbranch_scc1 .fz_kernel_pw14d
  s_cmp_eq_u32 s3, 0
  s_cbranch_scc1 .fz_kernel_hb15
  s_barrier
  s_sub_u32 s3, s3, 1
.fz_kernel_hb15:
  s_cmp_eq_u32 s3, 0
  s_cbranch_scc1 .fz_kernel_hb16
  s_barrier
  s_sub_u32 s3, s3, 1
.fz_kernel_hb16:
  buffer_load_dword v9, v4, s[4:7], s37 offen sc1
  s_add_u32 s38, s38, 1
  s_cmp_lt_u32 s38, 131072
  s_cbranch_scc1 .fz_kernel_pw14
  s_waitcnt vmcnt(0)
.fz_kernel_pw14d:
  s_mov_b64 exec, -1
  buffer_load_dwordx4 v[64:67], v3, s[4:7], s30 offen sc1
  s_mov_b32 s46, 0
  s_call_b64 s[0:1], .fz_kernel_hw
  s_waitcnt vmcnt(0)
  s_cmp_eq_u32 s3, 0
  s_cbranch_scc1 .fz_kernel_hb17
  s_barrier
  s_sub_u32 s3, s3, 1
.fz_kernel_hb17:
  v_mov_b32 v26, 0.0009765625
  v_mul_f32 v20, v26, v64
  v_mul_f32 v27, v20, v20
  v_fma_f32 v22, v65, v26, -v27
  v_max_f32 v22, 0, v22
  v_add_f32 v22, 1e-05, v22
  v_rsq_f32 v22, v22
  s_nop 0
  v_mul_f32 v20, v20, v22
  v_sub_f32 v20, 0, v20
  v_mul_f32 v21, v26, v66
  v_mul_f32 v27, v21, v21
  v_fma_f32 v23, v67, v26, -v27
  v_max_f32 v23, 0, v23
  v_add_f32 v23, 1e-05, v23
  v_rsq_f32 v23, v23
  s_nop 0
  v_mul_f32 v21, v21, v23
  v_sub_f32 v21, 0, v21
  ds_write_b64 v52, v[22:23] offset:4608
  ds_write_b64 v52, v[20:21] offset:5120
  v_mov_b32 v24, 159952
  v_mov_b32 v25, s76
  ds_write_b32 v24, v25 offset:8
  s_waitcnt lgkmcnt(0)
.fz_kernel_q_hw2:
  s_add_u32 s3, s3, 2
.fz_kernel_q_he:
  s_cmp_eq_u32 s3, 0
  s_cbranch_scc1 .fz_kernel_chain
  s_barrier
  s_sub_u32 s3, s3, 1
  s_branch .fz_kernel_q_he
.fz_kernel_q_h7:
  s_mov_b32 s8, s58
  s_mov_b32 s9, s59
  s_mov_b32 s10, 0x100
  s_mov_b32 s11, 0x00020000
  v_mov_b32 v12, 0
  v_mov_b32 v13, 0
  v_mov_b32 v14, 0
  v_mov_b32 v15, 0
  s_cmp_ge_u32 s2, 64
  s_cbranch_scc1 .fz_kernel_q_nzero
  s_lshl_b32 s36, s2, 10
  s_add_u32 s36, s36, 0x1800000
  buffer_store_dwordx4 v[12:15], v3, s[4:7], s36 offen sc1
.fz_kernel_q_nzero:
  v_and_b32 v21, 7, v2
  v_and_b32 v20, 16, v2
  v_lshlrev_b32 v20, 1, v20
  v_xor_b32 v20, v20, v3
  s_bfe_u32 s33, s17, 0x10002
  s_lshl_b32 s33, s33, 1
  s_and_b32 s31, s33, 3
  s_mul_i32 s31, s31, 12288
  s_add_u32 s31, s31, 65536
  v_add_u32 v16, s31, v20
  v_xor_b32 v17, 64, v16
  s_add_u32 s31, s31, 12288
  v_add_u32 v18, s31, v20
  v_xor_b32 v19, 64, v18
  s_sub_u32 s33, 31, s33
  v_lshlrev_b32 v21, 5, v21
  v_and_b32 v22, 24, v2
  v_add_u32 v21, v22, v21
  v_lshrrev_b32 v22, 5, v2
  v_lshl_add_u32 v21, v22, 2, v21
  s_lshl_b32 s30, s18, 10
  s_add_u32 s30, s30, 0x180c000
  v_and_b32 v22, 1, v2
  v_lshlrev_b32 v22, 4, v22
  v_mov_b32 v23, 0x3f80
  v_lshlrev_b32 v22, v22, v23
  v_mov_b32 v24, 0
  v_mov_b32 v25, 0
  v_mov_b32 v26, 0
  v_mov_b32 v27, 0
  s_mov_b32 exec_lo, 0x3030303
  s_mov_b32 exec_hi, 0x3030303
  v_mov_b32 v24, v22
  s_mov_b32 exec_lo, 0xc0c0c0c
  s_mov_b32 exec_hi, 0xc0c0c0c
  v_mov_b32 v25, v22
  s_mov_b32 exec_lo, 0x30303030
  s_mov_b32 exec_hi, 0x30303030
  v_mov_b32 v26, v22
  s_mov_b32 exec_lo, 0xc0c0c0c0
  s_mov_b32 exec_hi, 0xc0c0c0c0
  v_mov_b32 v27, v22
  s_mov_b64 exec, -1
  s_cmp_ge_u32 s2, 64
  s_cbranch_scc1 .fz_kernel_nz2
  s_mov_b64 exec, 1
  s_waitcnt vmcnt(0)
  buffer_atomic_add v5, v4, s[8:11], 0 offen sc1
  s_mov_b64 exec, -1
.fz_kernel_nz2:
  s_barrier
  s_sub_u32 s3, s3, 1
  s_cmp_lg_u32 s3, s33
  s_cbranch_scc1 .fz_kernel_nz2
  ds_read_b128 v[64:67], v16 offset:0
  ds_read_b128 v[68:71], v16 offset:4096
  ds_read_b128 v[72:75], v16 offset:8192
  ds_read_b128 v[76:79], v17 offset:1024
  ds_read_b128 v[80:83], v17 offset:5120
  ds_read_b128 v[84:87], v17 offset:9216
  ds_read_b128 v[88:91], v16 offset:2048
  ds_read_b128 v[92:95], v16 offset:6144
  ds_read_b128 v[96:99], v16 offset:10240
  ds_read_b128 v[100:103], v17 offset:3072
  ds_read_b128 v[104:107], v17 offset:7168
  ds_read_b128 v[108:111], v17 offset:11264
  s_waitcnt lgkmcnt(0)
  s_cmp_eq_u32 s3, 0
  s_cbranch_scc1 .fz_kernel_hb18
  s_barrier
  s_sub_u32 s3, s3, 1
.fz_kernel_hb18:
  ds_read_b128 v[112:115], v18 offset:0
  ds_read_b128 v[116:119], v18 offset:4096
  ds_read_b128 v[120:123], v18 offset:8192
  ds_read_b128 v[124:127], v19 offset:1024
  ds_read_b128 v[128:131], v19 offset:5120
  ds_read_b128 v[132:135], v19 offset:9216
  ds_read_b128 v[136:139], v18 offset:2048
  ds_read_b128 v[140:143], v18 offset:6144
  ds_read_b128 v[144:147], v18 offset:10240
  ds_read_b128 v[148:151], v19 offset:3072
  ds_read_b128 v[152:155], v19 offset:7168
  ds_read_b128 v[156:159], v19 offset:11264
  s_waitcnt lgkmcnt(0)
  s_cmp_eq_u32 s3, 0
  s_cbranch_scc1 .fz_kernel_hb19
  s_barrier
  s_sub_u32 s3, s3, 1
.fz_kernel_hb19:
  s_setprio 2
  v_mfma_f32_16x16x32_bf16 v[160:163], v[24:27], v[64:67], 0
  v_mfma_f32_16x16x32_bf16 v[164:167], v[24:27], v[68:71], 0
  v_mfma_f32_16x16x32_bf16 v[168:171], v[24:27], v[72:75], 0
  v_mfma_f32_16x16x32_bf16 v[160:163], v[24:27], v[76:79], v[160:163]
  v_mfma_f32_16x16x32_bf16 v[164:167], v[24:27], v[80:83], v[164:167]
  v_mfma_f32_16x16x32_bf16 v[168:171], v[24:27], v[84:87], v[168:171]
  v_mfma_f32_16x16x32_bf16 v[160:163], v[24:27], v[88:91], v[160:163]
  v_mfma_f32_16x16x32_bf16 v[164:167], v[24:27], v[92:95], v[164:167]
  v_mfma_f32_16x16x32_bf16 v[168:171], v[24:27], v[96:99], v[168:171]
  v_mfma_f32_16x16x32_bf16 v[160:163], v[24:27], v[100:103], v[160:163]
  v_mfma_f32_16x16x32_bf16 v[164:167], v[24:27], v[104:107], v[164:167]
  v_mfma_f32_16x16x32_bf16 v[168:171], v[24:27], v[108:111], v[168:171]
  v_mfma_f32_16x16x32_bf16 v[160:163], v[24:27], v[112:115], v[160:163]
  v_mfma_f32_16x16x32_bf16 v[164:167], v[24:27], v[116:119], v[164:167]
  v_mfma_f32_16x16x32_bf16 v[168:171], v[24:27], v[120:123], v[168:171]
  v_mfma_f32_16x16x32_bf16 v[160:163], v[24:27], v[124:127], v[160:163]
  v_mfma_f32_16x16x32_bf16 v[164:167], v[24:27], v[128:131], v[164:167]
  v_mfma_f32_16x16x32_bf16 v[168:171], v[24:27], v[132:135], v[168:171]
  v_mfma_f32_16x16x32_bf16 v[160:163], v[24:27], v[136:139], v[160:163]
  v_mfma_f32_16x16x32_bf16 v[164:167], v[24:27], v[140:143], v[164:167]
  v_mfma_f32_16x16x32_bf16 v[168:171], v[24:27], v[144:147], v[168:171]
  v_mfma_f32_16x16x32_bf16 v[160:163], v[24:27], v[148:151], v[160:163]
  v_mfma_f32_16x16x32_bf16 v[164:167], v[24:27], v[152:155], v[164:167]
  v_mfma_f32_16x16x32_bf16 v[168:171], v[24:27], v[156:159], v[168:171]
  s_setprio 0
  s_mov_b64 exec, 1
  buffer_load_dword v9, v4, s[8:11], 0 offen sc1
  s_mov_b64 exec, -1
  s_cmp_eq_u32 s3, 0
  s_cbranch_scc1 .fz_kernel_hb20
  s_barrier
  s_sub_u32 s3, s3, 1
.fz_kernel_hb20:
  v_add_f32 v160, v160, v160 row_ror:8 row_mask:0xf bank_mask:0xf
  v_add_f32 v161, v161, v161 row_ror:8 row_mask:0xf bank_mask:0xf
  v_add_f32 v162, v162, v162 row_ror:8 row_mask:0xf bank_mask:0xf
  v_add_f32 v163, v163, v163 row_ror:8 row_mask:0xf bank_mask:0xf
  v_add_f32 v164, v164, v164 row_ror:8 row_mask:0xf bank_mask:0xf
  v_add_f32 v165, v165, v165 row_ror:8 row_mask:0xf bank_mask:0xf
  v_add_f32 v166, v166, v166 row_ror:8 row_mask:0xf bank_mask:0xf
  v_add_f32 v167, v167, v167 row_ror:8 row_mask:0xf bank_mask:0xf
  v_add_f32 v168, v168, v168 row_ror:8 row_mask:0xf bank_mask:0xf
  v_add_f32 v169, v169, v169 row_ror:8 row_mask:0xf bank_mask:0xf
  v_add_f32 v170, v170, v170 row_ror:8 row_mask:0xf bank_mask:0xf
  v_add_f32 v171, v171, v171 row_ror:8 row_mask:0xf bank_mask:0xf
  s_mov_b32 exec_lo, 0x0
  s_mov_b32 exec_hi, 0xff00ff
  v_mov_b32 v160, v161
  v_mov_b32 v164, v165
  v_mov_b32 v168, v169
  s_mov_b32 exec_lo, 0xff00ff00
  s_mov_b32 exec_hi, 0x0
  v_mov_b32 v160, v162
  v_mov_b32 v164, v166
  v_mov_b32 v168, v170
  s_mov_b32 exec_lo, 0x0
  s_mov_b32 exec_hi, 0xff00ff00
  v_mov_b32 v160, v163
  v_mov_b32 v164, v167
  v_mov_b32 v168, v171
  s_cmp_eq_u32 s3, 0
  s_cbranch_scc1 .fz_kernel_hb21
  s_barrier
  s_sub_u32 s3, s3, 1
.fz_kernel_hb21:
  s_mov_b64 exec, 1
  s_mov_b32 s38, 0
.fz_kernel_pw22:
  s_mov_b32 s46, 0
  s_call_b64 s[0:1], .fz_kernel_hw
  s_waitcnt vmcnt(0)
  v_readfirstlane_b32 s31, v9
  s_cmp_eq_u32 s31, 64
  s_cbranch_scc1 .fz_kernel_pw22d
  s_cmp_eq_u32 s3, 0
  s_cbranch_scc1 .fz_kernel_hb23
  s_barrier
  s_sub_u32 s3, s3, 1
.fz_kernel_hb23:
  s_cmp_eq_u32 s3, 0
  s_cbranch_scc1 .fz_kernel_hb24
  s_barrier
  s_sub_u32 s3, s3, 1
.fz_kernel_hb24:
  buffer_load_dword v9, v4, s[8:11], 0 offen sc1
  s_add_u32 s38, s38, 1
  s_cmp_lt_u32 s38, 131072
  s_cbranch_scc1 .fz_kernel_pw22
  s_waitcnt vmcnt(0)
.fz_kernel_pw22d:
  s_mov_b64 exec, -1
  buffer_atomic_add_f32 v160, v21, s[4:7], s30 offen offset:0 sc1
  buffer_atomic_add_f32 v164, v21, s[4:7], s30 offen offset:256 sc1
  buffer_atomic_add_f32 v168, v21, s[4:7], s30 offen offset:512 sc1
  s_mov_b32 s46, 0
  s_call_b64 s[0:1], .fz_kernel_hw
  s_waitcnt vmcnt(0)
  v_lshlrev_b32 v7, 7, v2
  s_lshl_b32 s31, s18, 11
  s_lshl_b32 s33, 1, s17
  s_add_u32 s31, s31, s67
  s_add_u32 s31, s31, 0x180001c
  v_mov_b32 v8, s33
  s_mov_b64 exec, 0xffff
  buffer_atomic_or v8, v7, s[4:7], s31 offen sc1
  s_mov_b64 exec, -1
  s_cmp_eq_u32 s3, 0
  s_cbranch_scc1 .fz_kernel_hb25
  s_barrier
  s_sub_u32 s3, s3, 1
.fz_kernel_hb25:
  s_cmp_ge_u32 s2, 196
  s_cbranch_scc1 .fz_kernel_lz26
  s_lshl_b32 s36, s2, 12
  s_add_u32 s36, s36, 0x1c00000
  s_sub_u32 s31, s2, 66
  s_min_u32 s31, s31, s2
  s_sub_u32 s31, s31, 4
  s_cmp_lt_u32 s31, 6
  s_cbranch_scc1 .fz_kernel_lz26a
  buffer_store_dwordx4 v[12:15], v3, s[4:7], s36 offen sc1
  buffer_store_dwordx4 v[12:15], v3, s[4:7], s36 offen offset:1024 sc1
  buffer_store_dwordx4 v[12:15], v3, s[4:7], s36 offen offset:2048 sc1
  buffer_store_dwordx4 v[12:15], v3, s[4:7], s36 offen offset:3072 sc1
.fz_kernel_lz26:
  s_add_u32 s37, s19, 28
.fz_kernel_f127:
  s_cmp_le_u32 s3, 9
  s_cbranch_scc1 .fz_kernel_f127d
  s_barrier
  s_sub_u32 s3, s3, 1
  s_branch .fz_kernel_f127
.fz_kernel_f127d:
  s_mov_b64 exec, 1
  buffer_load_dword v9, v4, s[4:7], s37 offen sc1
  s_mov_b64 exec, 1
  s_mov_b32 s38, 0
.fz_kernel_pw28:
  s_mov_b32 s46, 0
  s_call_b64 s[0:1], .fz_kernel_hw
  s_waitcnt vmcnt(0)
  v_readfirstlane_b32 s31, v9
  s_cmp_eq_u32 s31, 65535
  s_cbranch_scc1 .fz_kernel_pw28d
  s_cmp_eq_u32 s3, 0
  s_cbranch_scc1 .fz_kernel_hb29
  s_barrier
  s_sub_u32 s3, s3, 1
.fz_kernel_hb29:
  s_cmp_eq_u32 s3, 0
  s_cbranch_scc1 .fz_kernel_hb30
  s_barrier
  s_sub_u32 s3, s3, 1
.fz_kernel_hb30:
  buffer_load_dword v9, v4, s[4:7], s37 offen sc1
  s_add_u32 s38, s38, 1
  s_cmp_lt_u32 s38, 131072
  s_cbranch_scc1 .fz_kernel_pw28
  s_waitcnt vmcnt(0)
.fz_kernel_pw28d:
  s_mov_b64 exec, -1
  buffer_load_dwordx4 v[64:67], v3, s[4:7], s30 offen sc1
  s_mov_b32 s46, 0
  s_call_b64 s[0:1], .fz_kernel_hw
  s_waitcnt vmcnt(0)
  v_add_u32 v24, 155648, v3
  s_mov_b32 exec_hi, 0xffff
  ds_write_b128 v24, v[64:67] offset:5632
  s_mov_b64 exec, -1
  s_waitcnt lgkmcnt(0)
  s_cmp_eq_u32 s3, 0
  s_cbranch_scc1 .fz_kernel_hb31
  s_barrier
  s_sub_u32 s3, s3, 1
.fz_kernel_hb31:
  s_getpc_b64 s[0:1]
.fz_kernel_ct32:
  s_sub_u32 s0, s0, .fz_kernel_ct32-fz_kernel
  s_subb_u32 s1, s1, 0
  s_lshr_b32 s31, s2, 3
  s_mulk_i32 s31, 0x500
  v_lshl_add_u32 v1, v2, 7, s31
  v_min_u32 v1, .fz_kernel_last-fz_kernel, v1
  s_mov_b64 exec, 0x3ff
  global_load_dword v1, v1, s[0:1]
  s_mov_b64 exec, -1
.fz_kernel_ct32e:
  s_branch .fz_kernel_q_hw2
.fz_kernel_att:
  s_setprio 1
  s_lshl_b32 s34, 1, s17
  s_mov_b32 s36, 0
  v_mfma_f32_32x32x16_bf16 v[48:63], v[80:83], v[16:19], 0
  v_mfma_f32_32x32x16_bf16 v[48:63], v[84:87], v[20:23], v[48:63]
  v_and_b32 v1, 31, v2
  v_lshl_add_u32 v1, v1, 3, s11
  v_mov_b32 v208, 0
  v_mov_b32 v209, 0
  v_mov_b32 v210, 0
  v_mov_b32 v211, 0
  v_mov_b32 v212, 0
  v_mov_b32 v213, 0
  v_mov_b32 v214, 0
  v_mov_b32 v215, 0
  v_mov_b32 v216, 0
  v_mov_b32 v217, 0
  v_mov_b32 v218, 0
  v_mov_b32 v219, 0
  v_mov_b32 v220, 0
  v_mov_b32 v221, 0
  v_mov_b32 v222, 0
  v_mov_b32 v223, 0
  s_waitcnt lgkmcnt(0)
  s_barrier
  ds_read_b128 v[32:35], v9 offset:0
  ds_read_b128 v[36:39], v9 offset:1024
  ds_read_b128 v[40:43], v9 offset:2048
  ds_read_b128 v[44:47], v9 offset:3072
  v_mfma_f32_32x32x16_bf16 v[64:79], v[80:83], v[24:27], 0
  v_exp_f32 v48, v48
  v_exp_f32 v49, v49
  v_exp_f32 v50, v50
  v_exp_f32 v51, v51
  v_exp_f32 v52, v52
  v_exp_f32 v53, v53
  v_exp_f32 v54, v54
  v_exp_f32 v55, v55
  v_mfma_f32_32x32x16_bf16 v[64:79], v[84:87], v[28:31], v[64:79]
  v_cvt_pk_bf16_f32 v224, v48, v49
  v_cvt_pk_bf16_f32 v225, v50, v51
  v_cvt_pk_bf16_f32 v226, v52, v53
  v_cvt_pk_bf16_f32 v227, v54, v55
  v_exp_f32 v56, v56
  v_exp_f32 v57, v57
  v_exp_f32 v58, v58
  v_exp_f32 v59, v59
  v_mfma_f32_32x32x16_bf16 v[144:159], v[88:91], v[224:227], 0
  v_exp_f32 v60, v60
  v_exp_f32 v61, v61
  v_exp_f32 v62, v62
  v_exp_f32 v63, v63
  v_cvt_pk_bf16_f32 v228, v56, v57
  v_cvt_pk_bf16_f32 v229, v58, v59
  v_cvt_pk_bf16_f32 v230, v60, v61
  v_cvt_pk_bf16_f32 v231, v62, v63
  s_waitcnt lgkmcnt(0)
  v_mfma_f32_32x32x16_bf16 v[48:63], v[80:83], v[32:35], 0
  v_exp_f32 v64, v64
  v_exp_f32 v65, v65
  v_exp_f32 v66, v66
  v_exp_f32 v67, v67
  v_mfma_f32_32x32x16_bf16 v[144:159], v[92:95], v[228:231], v[144:159]
  v_exp_f32 v68, v68
  v_exp_f32 v69, v69
  v_exp_f32 v70, v70
  v_smfmac_f32_16x16x64_bf16 v[208:211], v[12:15], v[224:231], v11
  v_exp_f32 v71, v71
  v_mfma_f32_32x32x16_bf16 v[48:63], v[84:87], v[36:39], v[48:63]
  v_cvt_pk_bf16_f32 v224, v64, v65
  v_cvt_pk_bf16_f32 v225, v66, v67
  v_cvt_pk_bf16_f32 v226, v68, v69
  v_cvt_pk_bf16_f32 v227, v70, v71
  v_exp_f32 v72, v72
  v_exp_f32 v73, v73
  v_exp_f32 v74, v74
  v_exp_f32 v75, v75
  v_mfma_f32_32x32x16_bf16 v[160:175], v[88:91], v[224:227], 0
  v_exp_f32 v76, v76
  v_exp_f32 v77, v77
  v_exp_f32 v78, v78
  v_exp_f32 v79, v79
  v_cvt_pk_bf16_f32 v228, v72, v73
  v_cvt_pk_bf16_f32 v229, v74, v75
  v_cvt_pk_bf16_f32 v230, v76, v77
  v_cvt_pk_bf16_f32 v231, v78, v79
  s_mov_b64 exec, 1
  s_waitcnt vmcnt(0)
  ds_add_u32 v6, v5 offset:0x100
  s_mov_b64 exec, -1
  v_mfma_f32_32x32x16_bf16 v[64:79], v[80:83], v[40:43], 0
  v_exp_f32 v48, v48
  v_exp_f32 v49, v49
  v_exp_f32 v50, v50
  v_exp_f32 v51, v51
  v_mfma_f32_32x32x16_bf16 v[160:175], v[92:95], v[228:231], v[160:175]
  v_exp_f32 v52, v52
  v_exp_f32 v53, v53
  v_exp_f32 v54, v54
  v_smfmac_f32_16x16x64_bf16 v[212:215], v[12:15], v[224:231], v11
  v_exp_f32 v55, v55
  v_mfma_f32_32x32x16_bf16 v[64:79], v[84:87], v[44:47], v[64:79]
  v_cvt_pk_bf16_f32 v224, v48, v49
  v_cvt_pk_bf16_f32 v225, v50, v51
  v_cvt_pk_bf16_f32 v226, v52, v53
  v_cvt_pk_bf16_f32 v227, v54, v55
  v_exp_f32 v56, v56
  v_exp_f32 v57, v57
  v_exp_f32 v58, v58
  v_exp_f32 v59, v59
  v_mfma_f32_32x32x16_bf16 v[176:191], v[88:91], v[224:227], 0
  ds_read_b32 v7, v6
  v_exp_f32 v60, v60
  v_exp_f32 v61, v61
  v_exp_f32 v62, v62
  v_exp_f32 v63, v63
  v_cvt_pk_bf16_f32 v228, v56, v57
  v_cvt_pk_bf16_f32 v229, v58, v59
  v_cvt_pk_bf16_f32 v230, v60, v61
  v_cvt_pk_bf16_f32 v231, v62, v63
  s_waitcnt lgkmcnt(0)
  v_readfirstlane_b32 s39, v7
  s_andn2_b32 s33, s39, s34
  s_bcnt1_i32_b32 s31, s33
  s_cmp_ge_u32 s31, 2
  s_cbranch_scc1 .fz_kernel_a_e
  v_mfma_f32_32x32x16_bf16 v[48:63], v[96:99], v[16:19], 0
  v_exp_f32 v64, v64
  v_exp_f32 v65, v65
  v_exp_f32 v66, v66
  v_exp_f32 v67, v67
  v_mfma_f32_32x32x16_bf16 v[176:191], v[92:95], v[228:231], v[176:191]
  v_exp_f32 v68, v68
  v_exp_f32 v69, v69
  v_exp_f32 v70, v70
  v_smfmac_f32_16x16x64_bf16 v[216:219], v[12:15], v[224:231], v11
  v_exp_f32 v71, v71
  v_mfma_f32_32x32x16_bf16 v[48:63], v[100:103], v[20:23], v[48:63]
  v_cvt_pk_bf16_f32 v224, v64, v65
  v_cvt_pk_bf16_f32 v225, v66, v67
  v_cvt_pk_bf16_f32 v226, v68, v69
  v_cvt_pk_bf16_f32 v227, v70, v71
  v_exp_f32 v72, v72
  v_exp_f32 v73, v73
  v_exp_f32 v74, v74
  v_exp_f32 v75, v75
  v_mfma_f32_32x32x16_bf16 v[192:207], v[88:91], v[224:227], 0
  v_exp_f32 v76, v76
  v_exp_f32 v77, v77
  v_exp_f32 v78, v78
  v_exp_f32 v79, v79
  v_cvt_pk_bf16_f32 v228, v72, v73
  v_cvt_pk_bf16_f32 v229, v74, v75
  v_cvt_pk_bf16_f32 v230, v76, v77
  v_cvt_pk_bf16_f32 v231, v78, v79
  v_mfma_f32_32x32x16_bf16 v[64:79], v[96:99], v[24:27], 0
  v_exp_f32 v48, v48
  v_exp_f32 v49, v49
  v_exp_f32 v50, v50
  v_exp_f32 v51, v51
  v_mfma_f32_32x32x16_bf16 v[192:207], v[92:95], v[228:231], v[192:207]
  v_exp_f32 v52, v52
  v_exp_f32 v53, v53
  v_exp_f32 v54, v54
  v_smfmac_f32_16x16x64_bf16 v[220:223], v[12:15], v[224:231], v11
  v_exp_f32 v55, v55
  v_mfma_f32_32x32x16_bf16 v[64:79], v[100:103], v[28:31], v[64:79]
  v_cvt_pk_bf16_f32 v224, v48, v49
  v_cvt_pk_bf16_f32 v225, v50, v51
  v_cvt_pk_bf16_f32 v226, v52, v53
  v_cvt_pk_bf16_f32 v227, v54, v55
  v_exp_f32 v56, v56
  v_exp_f32 v57, v57
  v_exp_f32 v58, v58
  v_exp_f32 v59, v59
  v_mfma_f32_32x32x16_bf16 v[144:159], v[104:107], v[224:227], v[144:159]
  v_exp_f32 v60, v60
  v_exp_f32 v61, v61
  v_exp_f32 v62, v62
  v_exp_f32 v63, v63
  v_cvt_pk_bf16_f32 v228, v56, v57
  v_cvt_pk_bf16_f32 v229, v58, v59
  v_cvt_pk_bf16_f32 v230, v60, v61
  v_cvt_pk_bf16_f32 v231, v62, v63
  v_mfma_f32_32x32x16_bf16 v[48:63], v[96:99], v[32:35], 0
  v_exp_f32 v64, v64
  v_exp_f32 v65, v65
  v_exp_f32 v66, v66
  v_exp_f32 v67, v67
  v_mfma_f32_32x32x16_bf16 v[144:159], v[108:111], v[228:231], v[144:159]
  v_exp_f32 v68, v68
  v_exp_f32 v69, v69
  v_exp_f32 v70, v70
  v_smfmac_f32_16x16x64_bf16 v[208:211], v[12:15], v[224:231], v11
  v_exp_f32 v71, v71
  v_mfma_f32_32x32x16_bf16 v[48:63], v[100:103], v[36:39], v[48:63]
  v_cvt_pk_bf16_f32 v224, v64, v65
  v_cvt_pk_bf16_f32 v225, v66, v67
  v_cvt_pk_bf16_f32 v226, v68, v69
  v_cvt_pk_bf16_f32 v227, v70, v71
  v_exp_f32 v72, v72
  v_exp_f32 v73, v73
  v_exp_f32 v74, v74
  v_exp_f32 v75, v75
  v_mfma_f32_32x32x16_bf16 v[160:175], v[104:107], v[224:227], v[160:175]
  ds_read_b32 v7, v6
  v_exp_f32 v76, v76
  v_exp_f32 v77, v77
  v_exp_f32 v78, v78
  v_exp_f32 v79, v79
  v_cvt_pk_bf16_f32 v228, v72, v73
  v_cvt_pk_bf16_f32 v229, v74, v75
  v_cvt_pk_bf16_f32 v230, v76, v77
  v_cvt_pk_bf16_f32 v231, v78, v79
  s_waitcnt lgkmcnt(0)
  v_readfirstlane_b32 s39, v7
  s_andn2_b32 s39, s39, s34
  s_cbranch_scc0 .fz_kernel_a_p0
  s_ff1_i32_b32 s33, s36
  s_bitset0_b32 s36, s33
  s_lshl_b32 s33, s33, 14
  s_add_u32 s30, s33, s35
  s_cbranch_scc1 .fz_kernel_pk33c
.fz_kernel_pk33:
  buffer_load_dwordx4 v[112:115], v3, s[4:7], s30 offen offset:0
  buffer_load_dwordx4 v[116:119], v3, s[4:7], s30 offen offset:1024
  buffer_load_dwordx4 v[120:123], v3, s[4:7], s30 offen offset:2048
  buffer_load_dwordx4 v[124:127], v3, s[4:7], s30 offen offset:3072
  buffer_load_dwordx4 v[128:131], v10, s[4:7], s30 offen offset:0
  buffer_load_dwordx4 v[132:135], v10, s[4:7], s30 offen offset:1024
  buffer_load_dwordx4 v[136:139], v10, s[4:7], s30 offen offset:2048
  buffer_load_dwordx4 v[140:143], v10, s[4:7], s30 offen offset:3072
.fz_kernel_a_p0:
  v_mfma_f32_32x32x16_bf16 v[64:79], v[96:99], v[40:43], 0
  v_exp_f32 v48, v48
  v_exp_f32 v49, v49
  v_exp_f32 v50, v50
  v_exp_f32 v51, v51
  v_mfma_f32_32x32x16_bf16 v[160:175], v[108:111], v[228:231], v[160:175]
  v_exp_f32 v52, v52
  v_exp_f32 v53, v53
  v_exp_f32 v54, v54
  v_smfmac_f32_16x16x64_bf16 v[212:215], v[12:15], v[224:231], v11
  v_exp_f32 v55, v55
  v_mfma_f32_32x32x16_bf16 v[64:79], v[100:103], v[44:47], v[64:79]
  v_cvt_pk_bf16_f32 v224, v48, v49
  v_cvt_pk_bf16_f32 v225, v50, v51
  v_cvt_pk_bf16_f32 v226, v52, v53
  v_cvt_pk_bf16_f32 v227, v54, v55
  v_exp_f32 v56, v56
  v_exp_f32 v57, v57
  v_exp_f32 v58, v58
  v_exp_f32 v59, v59
  v_mfma_f32_32x32x16_bf16 v[176:191], v[104:107], v[224:227], v[176:191]
  v_exp_f32 v60, v60
  v_exp_f32 v61, v61
  v_exp_f32 v62, v62
  v_exp_f32 v63, v63
  v_cvt_pk_bf16_f32 v228, v56, v57
  v_cvt_pk_bf16_f32 v229, v58, v59
  v_cvt_pk_bf16_f32 v230, v60, v61
  v_cvt_pk_bf16_f32 v231, v62, v63
  v_exp_f32 v64, v64
  v_exp_f32 v65, v65
  v_exp_f32 v66, v66
  v_exp_f32 v67, v67
  v_mfma_f32_32x32x16_bf16 v[176:191], v[108:111], v[228:231], v[176:191]
  v_exp_f32 v68, v68
  v_exp_f32 v69, v69
  v_exp_f32 v70, v70
  v_smfmac_f32_16x16x64_bf16 v[216:219], v[12:15], v[224:231], v11
  v_exp_f32 v71, v71
  v_cvt_pk_bf16_f32 v224, v64, v65
  v_cvt_pk_bf16_f32 v225, v66, v67
  v_cvt_pk_bf16_f32 v226, v68, v69
  v_cvt_pk_bf16_f32 v227, v70, v71
  v_exp_f32 v72, v72
  v_exp_f32 v73, v73
  v_exp_f32 v74, v74
  v_exp_f32 v75, v75
  v_mfma_f32_32x32x16_bf16 v[192:207], v[104:107], v[224:227], v[192:207]
  v_exp_f32 v76, v76
  v_exp_f32 v77, v77
  v_exp_f32 v78, v78
  v_exp_f32 v79, v79
  v_cvt_pk_bf16_f32 v228, v72, v73
  v_cvt_pk_bf16_f32 v229, v74, v75
  v_cvt_pk_bf16_f32 v230, v76, v77
  v_cvt_pk_bf16_f32 v231, v78, v79
  s_cmp_lg_u32 s39, 0
  s_cbranch_scc1 .fz_kernel_a_p1
  s_ff1_i32_b32 s33, s36
  s_bitset0_b32 s36, s33
  s_lshl_b32 s33, s33, 14
  s_add_u32 s30, s33, s35
  s_cbranch_scc1 .fz_kernel_pk34c
.fz_kernel_pk34:
  buffer_load_dwordx4 v[112:115], v3, s[4:7], s30 offen offset:0
  buffer_load_dwordx4 v[116:119], v3, s[4:7], s30 offen offset:1024
  buffer_load_dwordx4 v[120:123], v3, s[4:7], s30 offen offset:2048
  buffer_load_dwordx4 v[124:127], v3, s[4:7], s30 offen offset:3072
  buffer_load_dwordx4 v[128:131], v10, s[4:7], s30 offen offset:0
  buffer_load_dwordx4 v[132:135], v10, s[4:7], s30 offen offset:1024
  buffer_load_dwordx4 v[136:139], v10, s[4:7], s30 offen offset:2048
  buffer_load_dwordx4 v[140:143], v10, s[4:7], s30 offen offset:3072
.fz_kernel_a_p1:
  s_ff1_i32_b32 s33, s36
  s_bitset0_b32 s36, s33
  s_lshl_b32 s33, s33, 14
  s_add_u32 s30, s33, s35
  s_cbranch_scc1 .fz_kernel_pk35c
.fz_kernel_pk35:
  buffer_load_dwordx4 v[80:83], v3, s[4:7], s30 offen offset:0
  buffer_load_dwordx4 v[84:87], v3, s[4:7], s30 offen offset:1024
  buffer_load_dwordx4 v[88:91], v3, s[4:7], s30 offen offset:2048
  buffer_load_dwordx4 v[92:95], v3, s[4:7], s30 offen offset:3072
  buffer_load_dwordx4 v[96:99], v10, s[4:7], s30 offen offset:0
  s_waitcnt vmcnt(11)
  v_mfma_f32_32x32x16_bf16 v[48:63], v[112:115], v[16:19], 0
  v_mfma_f32_32x32x16_bf16 v[48:63], v[116:119], v[20:23], v[48:63]
  s_nop 9
  s_branch .fz_kernel_a_b2
.fz_kernel_a_e:
  s_mov_b32 s36, s33
  s_or_b32 s34, s34, s39
  s_ff1_i32_b32 s33, s36
  s_bitset0_b32 s36, s33
  s_lshl_b32 s33, s33, 14
  s_add_u32 s30, s33, s35
  v_mfma_f32_32x32x16_bf16 v[48:63], v[96:99], v[16:19], 0
  buffer_load_dwordx4 v[112:115], v3, s[4:7], s30 offen offset:0
  v_exp_f32 v64, v64
  v_exp_f32 v65, v65
  v_exp_f32 v66, v66
  v_exp_f32 v67, v67
  v_mfma_f32_32x32x16_bf16 v[176:191], v[92:95], v[228:231], v[176:191]
  buffer_load_dwordx4 v[116:119], v3, s[4:7], s30 offen offset:1024
  v_exp_f32 v68, v68
  v_exp_f32 v69, v69
  v_exp_f32 v70, v70
  v_smfmac_f32_16x16x64_bf16 v[216:219], v[12:15], v[224:231], v11
  buffer_load_dwordx4 v[120:123], v3, s[4:7], s30 offen offset:2048
  v_exp_f32 v71, v71
  v_mfma_f32_32x32x16_bf16 v[48:63], v[100:103], v[20:23], v[48:63]
  buffer_load_dwordx4 v[124:127], v3, s[4:7], s30 offen offset:3072
  v_cvt_pk_bf16_f32 v224, v64, v65
  v_cvt_pk_bf16_f32 v225, v66, v67
  v_cvt_pk_bf16_f32 v226, v68, v69
  v_cvt_pk_bf16_f32 v227, v70, v71
  v_exp_f32 v72, v72
  v_exp_f32 v73, v73
  v_exp_f32 v74, v74
  v_exp_f32 v75, v75
  v_mfma_f32_32x32x16_bf16 v[192:207], v[88:91], v[224:227], 0
  buffer_load_dwordx4 v[128:131], v10, s[4:7], s30 offen offset:0
  v_exp_f32 v76, v76
  v_exp_f32 v77, v77
  v_exp_f32 v78, v78
  v_exp_f32 v79, v79
  v_cvt_pk_bf16_f32 v228, v72, v73
  v_cvt_pk_bf16_f32 v229, v74, v75
  v_cvt_pk_bf16_f32 v230, v76, v77
  v_cvt_pk_bf16_f32 v231, v78, v79
  v_mfma_f32_32x32x16_bf16 v[64:79], v[96:99], v[24:27], 0
  buffer_load_dwordx4 v[132:135], v10, s[4:7], s30 offen offset:1024
  v_exp_f32 v48, v48
  v_exp_f32 v49, v49
  v_exp_f32 v50, v50
  v_exp_f32 v51, v51
  v_mfma_f32_32x32x16_bf16 v[192:207], v[92:95], v[228:231], v[192:207]
  buffer_load_dwordx4 v[136:139], v10, s[4:7], s30 offen offset:2048
  v_exp_f32 v52, v52
  v_exp_f32 v53, v53
  v_exp_f32 v54, v54
  v_smfmac_f32_16x16x64_bf16 v[220:223], v[12:15], v[224:231], v11
  buffer_load_dwordx4 v[140:143], v10, s[4:7], s30 offen offset:3072
  v_exp_f32 v55, v55
  v_mfma_f32_32x32x16_bf16 v[64:79], v[100:103], v[28:31], v[64:79]
  s_ff1_i32_b32 s33, s36
  v_cvt_pk_bf16_f32 v224, v48, v49
  v_cvt_pk_bf16_f32 v225, v50, v51
  v_cvt_pk_bf16_f32 v226, v52, v53
  v_cvt_pk_bf16_f32 v227, v54, v55
  v_exp_f32 v56, v56
  v_exp_f32 v57, v57
  v_exp_f32 v58, v58
  v_exp_f32 v59, v59
  v_mfma_f32_32x32x16_bf16 v[144:159], v[104:107], v[224:227], v[144:159]
  s_bitset0_b32 s36, s33
  v_exp_f32 v60, v60
  v_exp_f32 v61, v61
  v_exp_f32 v62, v62
  v_exp_f32 v63, v63
  v_cvt_pk_bf16_f32 v228, v56, v57
  v_cvt_pk_bf16_f32 v229, v58, v59
  v_cvt_pk_bf16_f32 v230, v60, v61
  v_cvt_pk_bf16_f32 v231, v62, v63
  v_mfma_f32_32x32x16_bf16 v[48:63], v[96:99], v[32:35], 0
  s_lshl_b32 s33, s33, 14
  v_exp_f32 v64, v64
  v_exp_f32 v65, v65
  v_exp_f32 v66, v66
  v_exp_f32 v67, v67
  v_mfma_f32_32x32x16_bf16 v[144:159], v[108:111], v[228:231], v[144:159]
  s_add_u32 s30, s33, s35
  v_exp_f32 v68, v68
  v_exp_f32 v69, v69
  v_exp_f32 v70, v70
  v_smfmac_f32_16x16x64_bf16 v[208:211], v[12:15], v[224:231], v11
  buffer_load_dwordx4 v[80:83], v3, s[4:7], s30 offen offset:0
  v_exp_f32 v71, v71
  v_mfma_f32_32x32x16_bf16 v[48:63], v[100:103], v[36:39], v[48:63]
  buffer_load_dwordx4 v[84:87], v3, s[4:7], s30 offen offset:1024
  v_cvt_pk_bf16_f32 v224, v64, v65
  v_cvt_pk_bf16_f32 v225, v66, v67
  v_cvt_pk_bf16_f32 v226, v68, v69
  v_cvt_pk_bf16_f32 v227, v70, v71
  v_exp_f32 v72, v72
  v_exp_f32 v73, v73
  v_exp_f32 v74, v74
  v_exp_f32 v75, v75
  v_mfma_f32_32x32x16_bf16 v[160:175], v[104:107], v[224:227], v[160:175]
  buffer_load_dwordx4 v[88:91], v3, s[4:7], s30 offen offset:2048
  v_exp_f32 v76, v76
  v_exp_f32 v77, v77
  v_exp_f32 v78, v78
  v_exp_f32 v79, v79
  v_cvt_pk_bf16_f32 v228, v72, v73
  v_cvt_pk_bf16_f32 v229, v74, v75
  v_cvt_pk_bf16_f32 v230, v76, v77
  v_cvt_pk_bf16_f32 v231, v78, v79
  v_mfma_f32_32x32x16_bf16 v[64:79], v[96:99], v[40:43], 0
  buffer_load_dwordx4 v[92:95], v3, s[4:7], s30 offen offset:3072
  v_exp_f32 v48, v48
  v_exp_f32 v49, v49
  v_exp_f32 v50, v50
  v_exp_f32 v51, v51
  v_mfma_f32_32x32x16_bf16 v[160:175], v[108:111], v[228:231], v[160:175]
  v_exp_f32 v52, v52
  v_exp_f32 v53, v53
  v_exp_f32 v54, v54
  v_smfmac_f32_16x16x64_bf16 v[212:215], v[12:15], v[224:231], v11
  v_exp_f32 v55, v55
  v_mfma_f32_32x32x16_bf16 v[64:79], v[100:103], v[44:47], v[64:79]
  v_cvt_pk_bf16_f32 v224, v48, v49
  v_cvt_pk_bf16_f32 v225, v50, v51
  v_cvt_pk_bf16_f32 v226, v52, v53
  v_cvt_pk_bf16_f32 v227, v54, v55
  v_exp_f32 v56, v56
  v_exp_f32 v57, v57
  v_exp_f32 v58, v58
  v_exp_f32 v59, v59
  v_mfma_f32_32x32x16_bf16 v[176:191], v[104:107], v[224:227], v[176:191]
  s_waitcnt vmcnt(10)
  v_exp_f32 v60, v60
  v_exp_f32 v61, v61
  v_exp_f32 v62, v62
  v_exp_f32 v63, v63
  v_cvt_pk_bf16_f32 v228, v56, v57
  v_cvt_pk_bf16_f32 v229, v58, v59
  v_cvt_pk_bf16_f32 v230, v60, v61
  v_cvt_pk_bf16_f32 v231, v62, v63
  v_mfma_f32_32x32x16_bf16 v[48:63], v[112:115], v[16:19], 0
  v_exp_f32 v64, v64
  v_exp_f32 v65, v65
  v_exp_f32 v66, v66
  v_exp_f32 v67, v67
  v_mfma_f32_32x32x16_bf16 v[176:191], v[108:111], v[228:231], v[176:191]
  buffer_load_dwordx4 v[96:99], v10, s[4:7], s30 offen offset:0
  v_exp_f32 v68, v68
  v_exp_f32 v69, v69
  v_exp_f32 v70, v70
  v_smfmac_f32_16x16x64_bf16 v[216:219], v[12:15], v[224:231], v11
  v_exp_f32 v71, v71
  v_mfma_f32_32x32x16_bf16 v[48:63], v[116:119], v[20:23], v[48:63]
  v_cvt_pk_bf16_f32 v224, v64, v65
  v_cvt_pk_bf16_f32 v225, v66, v67
  v_cvt_pk_bf16_f32 v226, v68, v69
  v_cvt_pk_bf16_f32 v227, v70, v71
  v_exp_f32 v72, v72
  v_exp_f32 v73, v73
  v_exp_f32 v74, v74
  v_exp_f32 v75, v75
  v_mfma_f32_32x32x16_bf16 v[192:207], v[104:107], v[224:227], v[192:207]
  v_exp_f32 v76, v76
  v_exp_f32 v77, v77
  v_exp_f32 v78, v78
  v_exp_f32 v79, v79
  v_cvt_pk_bf16_f32 v228, v72, v73
  v_cvt_pk_bf16_f32 v229, v74, v75
  v_cvt_pk_bf16_f32 v230, v76, v77
  v_cvt_pk_bf16_f32 v231, v78, v79
  s_branch .fz_kernel_a_b2
  .p2align 6
.fz_kernel_a_loop:
  v_mfma_f32_32x32x16_bf16 v[64:79], v[80:83], v[24:27], 0
  v_exp_f32 v48, v48
  v_exp_f32 v49, v49
  v_exp_f32 v50, v50
  v_exp_f32 v51, v51
  v_mfma_f32_32x32x16_bf16 v[192:207], v[140:143], v[228:231], v[192:207]
  v_exp_f32 v52, v52
  v_exp_f32 v53, v53
  v_exp_f32 v54, v54
  v_smfmac_f32_16x16x64_bf16 v[220:223], v[12:15], v[224:231], v11
  buffer_load_dwordx4 v[132:135], v10, s[4:7], s30 offen offset:1024
  v_exp_f32 v55, v55
  v_mfma_f32_32x32x16_bf16 v[64:79], v[84:87], v[28:31], v[64:79]
  s_waitcnt vmcnt(10)
  v_cvt_pk_bf16_f32 v224, v48, v49
  v_cvt_pk_bf16_f32 v225, v50, v51
  v_cvt_pk_bf16_f32 v226, v52, v53
  v_cvt_pk_bf16_f32 v227, v54, v55
  v_exp_f32 v56, v56
  v_exp_f32 v57, v57
  v_exp_f32 v58, v58
  v_exp_f32 v59, v59
  v_mfma_f32_32x32x16_bf16 v[144:159], v[88:91], v[224:227], v[144:159]
  v_exp_f32 v60, v60
  v_exp_f32 v61, v61
  v_exp_f32 v62, v62
  v_exp_f32 v63, v63
  v_cvt_pk_bf16_f32 v228, v56, v57
  v_cvt_pk_bf16_f32 v229, v58, v59
  v_cvt_pk_bf16_f32 v230, v60, v61
  v_cvt_pk_bf16_f32 v231, v62, v63
  v_mfma_f32_32x32x16_bf16 v[48:63], v[80:83], v[32:35], 0
  v_exp_f32 v64, v64
  v_exp_f32 v65, v65
  v_exp_f32 v66, v66
  v_exp_f32 v67, v67
  v_mfma_f32_32x32x16_bf16 v[144:159], v[92:95], v[228:231], v[144:159]
  v_exp_f32 v68, v68
  v_exp_f32 v69, v69
  v_exp_f32 v70, v70
  v_smfmac_f32_16x16x64_bf16 v[208:211], v[12:15], v[224:231], v11
  buffer_load_dwordx4 v[136:139], v10, s[4:7], s30 offen offset:2048
  v_exp_f32 v71, v71
  v_mfma_f32_32x32x16_bf16 v[48:63], v[84:87], v[36:39], v[48:63]
  s_ff1_i32_b32 s33, s36
  v_cvt_pk_bf16_f32 v224, v64, v65
  v_cvt_pk_bf16_f32 v225, v66, v67
  v_cvt_pk_bf16_f32 v226, v68, v69
  v_cvt_pk_bf16_f32 v227, v70, v71
  v_exp_f32 v72, v72
  v_exp_f32 v73, v73
  v_exp_f32 v74, v74
  v_exp_f32 v75, v75
  v_mfma_f32_32x32x16_bf16 v[160:175], v[88:91], v[224:227], v[160:175]
  s_bitset0_b32 s36, s33
  v_exp_f32 v76, v76
  v_exp_f32 v77, v77
  v_exp_f32 v78, v78
  v_exp_f32 v79, v79
  v_cvt_pk_bf16_f32 v228, v72, v73
  v_cvt_pk_bf16_f32 v229, v74, v75
  v_cvt_pk_bf16_f32 v230, v76, v77
  v_cvt_pk_bf16_f32 v231, v78, v79
  v_mfma_f32_32x32x16_bf16 v[64:79], v[80:83], v[40:43], 0
  s_lshl_b32 s33, s33, 14
  v_exp_f32 v48, v48
  v_exp_f32 v49, v49
  v_exp_f32 v50, v50
  v_exp_f32 v51, v51
  v_mfma_f32_32x32x16_bf16 v[160:175], v[92:95], v[228:231], v[160:175]
  v_exp_f32 v52, v52
  v_exp_f32 v53, v53
  v_exp_f32 v54, v54
  v_smfmac_f32_16x16x64_bf16 v[212:215], v[12:15], v[224:231], v11
  buffer_load_dwordx4 v[140:143], v10, s[4:7], s30 offen offset:3072
  v_exp_f32 v55, v55
  v_mfma_f32_32x32x16_bf16 v[64:79], v[84:87], v[44:47], v[64:79]
  s_add_u32 s30, s33, s35
  v_cvt_pk_bf16_f32 v224, v48, v49
  v_cvt_pk_bf16_f32 v225, v50, v51
  v_cvt_pk_bf16_f32 v226, v52, v53
  v_cvt_pk_bf16_f32 v227, v54, v55
  v_exp_f32 v56, v56
  v_exp_f32 v57, v57
  v_exp_f32 v58, v58
  v_exp_f32 v59, v59
  v_mfma_f32_32x32x16_bf16 v[176:191], v[88:91], v[224:227], v[176:191]
  s_waitcnt vmcnt(10)
  v_exp_f32 v60, v60
  v_exp_f32 v61, v61
  v_exp_f32 v62, v62
  v_exp_f32 v63, v63
  v_cvt_pk_bf16_f32 v228, v56, v57
  v_cvt_pk_bf16_f32 v229, v58, v59
  v_cvt_pk_bf16_f32 v230, v60, v61
  v_cvt_pk_bf16_f32 v231, v62, v63
  v_mfma_f32_32x32x16_bf16 v[48:63], v[96:99], v[16:19], 0
  s_cbranch_scc1 .fz_kernel_pk38c
.fz_kernel_pk38:
  v_exp_f32 v64, v64
  v_exp_f32 v65, v65
  v_exp_f32 v66, v66
  v_exp_f32 v67, v67
  v_mfma_f32_32x32x16_bf16 v[176:191], v[92:95], v[228:231], v[176:191]
  v_exp_f32 v68, v68
  v_exp_f32 v69, v69
  v_exp_f32 v70, v70
  v_smfmac_f32_16x16x64_bf16 v[216:219], v[12:15], v[224:231], v11
  buffer_load_dwordx4 v[80:83], v3, s[4:7], s30 offen offset:0
  v_exp_f32 v71, v71
  v_mfma_f32_32x32x16_bf16 v[48:63], v[100:103], v[20:23], v[48:63]
  v_cvt_pk_bf16_f32 v224, v64, v65
  v_cvt_pk_bf16_f32 v225, v66, v67
  v_cvt_pk_bf16_f32 v226, v68, v69
  v_cvt_pk_bf16_f32 v227, v70, v71
  v_exp_f32 v72, v72
  v_exp_f32 v73, v73
  v_exp_f32 v74, v74
  v_exp_f32 v75, v75
  v_mfma_f32_32x32x16_bf16 v[192:207], v[88:91], v[224:227], v[192:207]
  v_exp_f32 v76, v76
  v_exp_f32 v77, v77
  v_exp_f32 v78, v78
  v_exp_f32 v79, v79
  v_cvt_pk_bf16_f32 v228, v72, v73
  v_cvt_pk_bf16_f32 v229, v74, v75
  v_cvt_pk_bf16_f32 v230, v76, v77
  v_cvt_pk_bf16_f32 v231, v78, v79
  v_mfma_f32_32x32x16_bf16 v[64:79], v[96:99], v[24:27], 0
  v_exp_f32 v48, v48
  v_exp_f32 v49, v49
  v_exp_f32 v50, v50
  v_exp_f32 v51, v51
  v_mfma_f32_32x32x16_bf16 v[192:207], v[92:95], v[228:231], v[192:207]
  v_exp_f32 v52, v52
  v_exp_f32 v53, v53
  v_exp_f32 v54, v54
  v_smfmac_f32_16x16x64_bf16 v[220:223], v[12:15], v[224:231], v11
  buffer_load_dwordx4 v[84:87], v3, s[4:7], s30 offen offset:1024
  v_exp_f32 v55, v55
  v_mfma_f32_32x32x16_bf16 v[64:79], v[100:103], v[28:31], v[64:79]
  s_waitcnt vmcnt(10)
  v_cvt_pk_bf16_f32 v224, v48, v49
  v_cvt_pk_bf16_f32 v225, v50, v51
  v_cvt_pk_bf16_f32 v226, v52, v53
  v_cvt_pk_bf16_f32 v227, v54, v55
  v_exp_f32 v56, v56
  v_exp_f32 v57, v57
  v_exp_f32 v58, v58
  v_exp_f32 v59, v59
  v_mfma_f32_32x32x16_bf16 v[144:159], v[104:107], v[224:227], v[144:159]
  v_exp_f32 v60, v60
  v_exp_f32 v61, v61
  v_exp_f32 v62, v62
  v_exp_f32 v63, v63
  v_cvt_pk_bf16_f32 v228, v56, v57
  v_cvt_pk_bf16_f32 v229, v58, v59
  v_cvt_pk_bf16_f32 v230, v60, v61
  v_cvt_pk_bf16_f32 v231, v62, v63
  v_mfma_f32_32x32x16_bf16 v[48:63], v[96:99], v[32:35], 0
  v_exp_f32 v64, v64
  v_exp_f32 v65, v65
  v_exp_f32 v66, v66
  v_exp_f32 v67, v67
  v_mfma_f32_32x32x16_bf16 v[144:159], v[108:111], v[228:231], v[144:159]
  v_exp_f32 v68, v68
  v_exp_f32 v69, v69
  v_exp_f32 v70, v70
  v_smfmac_f32_16x16x64_bf16 v[208:211], v[12:15], v[224:231], v11
  buffer_load_dwordx4 v[88:91], v3, s[4:7], s30 offen offset:2048
  v_exp_f32 v71, v71
  v_mfma_f32_32x32x16_bf16 v[48:63], v[100:103], v[36:39], v[48:63]
  v_cvt_pk_bf16_f32 v224, v64, v65
  v_cvt_pk_bf16_f32 v225, v66, v67
  v_cvt_pk_bf16_f32 v226, v68, v69
  v_cvt_pk_bf16_f32 v227, v70, v71
  v_exp_f32 v72, v72
  v_exp_f32 v73, v73
  v_exp_f32 v74, v74
  v_exp_f32 v75, v75
  v_mfma_f32_32x32x16_bf16 v[160:175], v[104:107], v[224:227], v[160:175]
  v_exp_f32 v76, v76
  v_exp_f32 v77, v77
  v_exp_f32 v78, v78
  v_exp_f32 v79, v79
  v_cvt_pk_bf16_f32 v228, v72, v73
  v_cvt_pk_bf16_f32 v229, v74, v75
  v_cvt_pk_bf16_f32 v230, v76, v77
  v_cvt_pk_bf16_f32 v231, v78, v79
  v_mfma_f32_32x32x16_bf16 v[64:79], v[96:99], v[40:43], 0
  v_exp_f32 v48, v48
  v_exp_f32 v49, v49
  v_exp_f32 v50, v50
  v_exp_f32 v51, v51
  v_mfma_f32_32x32x16_bf16 v[160:175], v[108:111], v[228:231], v[160:175]
  v_exp_f32 v52, v52
  v_exp_f32 v53, v53
  v_exp_f32 v54, v54
  v_smfmac_f32_16x16x64_bf16 v[212:215], v[12:15], v[224:231], v11
  buffer_load_dwordx4 v[92:95], v3, s[4:7], s30 offen offset:3072
  v_exp_f32 v55, v55
  v_mfma_f32_32x32x16_bf16 v[64:79], v[100:103], v[44:47], v[64:79]
  v_cvt_pk_bf16_f32 v224, v48, v49
  v_cvt_pk_bf16_f32 v225, v50, v51
  v_cvt_pk_bf16_f32 v226, v52, v53
  v_cvt_pk_bf16_f32 v227, v54, v55
  v_exp_f32 v56, v56
  v_exp_f32 v57, v57
  v_exp_f32 v58, v58
  v_exp_f32 v59, v59
  v_mfma_f32_32x32x16_bf16 v[176:191], v[104:107], v[224:227], v[176:191]
  s_waitcnt vmcnt(10)
  v_exp_f32 v60, v60
  v_exp_f32 v61, v61
  v_exp_f32 v62, v62
  v_exp_f32 v63, v63
  v_cvt_pk_bf16_f32 v228, v56, v57
  v_cvt_pk_bf16_f32 v229, v58, v59
  v_cvt_pk_bf16_f32 v230, v60, v61
  v_cvt_pk_bf16_f32 v231, v62, v63
  v_mfma_f32_32x32x16_bf16 v[48:63], v[112:115], v[16:19], 0
  v_exp_f32 v64, v64
  v_exp_f32 v65, v65
  v_exp_f32 v66, v66
  v_exp_f32 v67, v67
  v_mfma_f32_32x32x16_bf16 v[176:191], v[108:111], v[228:231], v[176:191]
  v_exp_f32 v68, v68
  v_exp_f32 v69, v69
  v_exp_f32 v70, v70
  v_smfmac_f32_16x16x64_bf16 v[216:219], v[12:15], v[224:231], v11
  buffer_load_dwordx4 v[96:99], v10, s[4:7], s30 offen offset:0
  v_exp_f32 v71, v71
  v_mfma_f32_32x32x16_bf16 v[48:63], v[116:119], v[20:23], v[48:63]
  s_sub_u32 s32, s32, 1
  v_cvt_pk_bf16_f32 v224, v64, v65
  v_cvt_pk_bf16_f32 v225, v66, v67
  v_cvt_pk_bf16_f32 v226, v68, v69
  v_cvt_pk_bf16_f32 v227, v70, v71
  v_exp_f32 v72, v72
  v_exp_f32 v73, v73
  v_exp_f32 v74, v74
  v_exp_f32 v75, v75
  v_mfma_f32_32x32x16_bf16 v[192:207], v[104:107], v[224:227], v[192:207]
  s_cmp_eq_u32 s32, 0
  v_exp_f32 v76, v76
  v_exp_f32 v77, v77
  v_exp_f32 v78, v78
  v_exp_f32 v79, v79
  v_cvt_pk_bf16_f32 v228, v72, v73
  v_cvt_pk_bf16_f32 v229, v74, v75
  v_cvt_pk_bf16_f32 v230, v76, v77
  v_cvt_pk_bf16_f32 v231, v78, v79
  s_cbranch_scc1 .fz_kernel_a_x
.fz_kernel_a_b2:
  v_mfma_f32_32x32x16_bf16 v[64:79], v[112:115], v[24:27], 0
  v_exp_f32 v48, v48
  v_exp_f32 v49, v49
  v_exp_f32 v50, v50
  v_exp_f32 v51, v51
  v_mfma_f32_32x32x16_bf16 v[192:207], v[108:111], v[228:231], v[192:207]
  v_exp_f32 v52, v52
  v_exp_f32 v53, v53
  v_exp_f32 v54, v54
  v_smfmac_f32_16x16x64_bf16 v[220:223], v[12:15], v[224:231], v11
  buffer_load_dwordx4 v[100:103], v10, s[4:7], s30 offen offset:1024
  v_exp_f32 v55, v55
  v_mfma_f32_32x32x16_bf16 v[64:79], v[116:119], v[28:31], v[64:79]
  s_waitcnt vmcnt(10)
  v_cvt_pk_bf16_f32 v224, v48, v49
  v_cvt_pk_bf16_f32 v225, v50, v51
  v_cvt_pk_bf16_f32 v226, v52, v53
  v_cvt_pk_bf16_f32 v227, v54, v55
  v_exp_f32 v56, v56
  v_exp_f32 v57, v57
  v_exp_f32 v58, v58
  v_exp_f32 v59, v59
  v_mfma_f32_32x32x16_bf16 v[144:159], v[120:123], v[224:227], v[144:159]
  v_exp_f32 v60, v60
  v_exp_f32 v61, v61
  v_exp_f32 v62, v62
  v_exp_f32 v63, v63
  v_cvt_pk_bf16_f32 v228, v56, v57
  v_cvt_pk_bf16_f32 v229, v58, v59
  v_cvt_pk_bf16_f32 v230, v60, v61
  v_cvt_pk_bf16_f32 v231, v62, v63
  v_mfma_f32_32x32x16_bf16 v[48:63], v[112:115], v[32:35], 0
  v_exp_f32 v64, v64
  v_exp_f32 v65, v65
  v_exp_f32 v66, v66
  v_exp_f32 v67, v67
  v_mfma_f32_32x32x16_bf16 v[144:159], v[124:127], v[228:231], v[144:159]
  v_exp_f32 v68, v68
  v_exp_f32 v69, v69
  v_exp_f32 v70, v70
  v_smfmac_f32_16x16x64_bf16 v[208:211], v[12:15], v[224:231], v11
  buffer_load_dwordx4 v[104:107], v10, s[4:7], s30 offen offset:2048
  v_exp_f32 v71, v71
  v_mfma_f32_32x32x16_bf16 v[48:63], v[116:119], v[36:39], v[48:63]
  s_ff1_i32_b32 s33, s36
  v_cvt_pk_bf16_f32 v224, v64, v65
  v_cvt_pk_bf16_f32 v225, v66, v67
  v_cvt_pk_bf16_f32 v226, v68, v69
  v_cvt_pk_bf16_f32 v227, v70, v71
  v_exp_f32 v72, v72
  v_exp_f32 v73, v73
  v_exp_f32 v74, v74
  v_exp_f32 v75, v75
  v_mfma_f32_32x32x16_bf16 v[160:175], v[120:123], v[224:227], v[160:175]
  s_bitset0_b32 s36, s33
  v_exp_f32 v76, v76
  v_exp_f32 v77, v77
  v_exp_f32 v78, v78
  v_exp_f32 v79, v79
  v_cvt_pk_bf16_f32 v228, v72, v73
  v_cvt_pk_bf16_f32 v229, v74, v75
  v_cvt_pk_bf16_f32 v230, v76, v77
  v_cvt_pk_bf16_f32 v231, v78, v79
  v_mfma_f32_32x32x16_bf16 v[64:79], v[112:115], v[40:43], 0
  s_lshl_b32 s33, s33, 14
  v_exp_f32 v48, v48
  v_exp_f32 v49, v49
  v_exp_f32 v50, v50
  v_exp_f32 v51, v51
  v_mfma_f32_32x32x16_bf16 v[160:175], v[124:127], v[228:231], v[160:175]
  v_exp_f32 v52, v52
  v_exp_f32 v53, v53
  v_exp_f32 v54, v54
  v_smfmac_f32_16x16x64_bf16 v[212:215], v[12:15], v[224:231], v11
  buffer_load_dwordx4 v[108:111], v10, s[4:7], s30 offen offset:3072
  v_exp_f32 v55, v55
  v_mfma_f32_32x32x16_bf16 v[64:79], v[116:119], v[44:47], v[64:79]
  s_add_u32 s30, s33, s35
  v_cvt_pk_bf16_f32 v224, v48, v49
  v_cvt_pk_bf16_f32 v225, v50, v51
  v_cvt_pk_bf16_f32 v226, v52, v53
  v_cvt_pk_bf16_f32 v227, v54, v55
  v_exp_f32 v56, v56
  v_exp_f32 v57, v57
  v_exp_f32 v58, v58
  v_exp_f32 v59, v59
  v_mfma_f32_32x32x16_bf16 v[176:191], v[120:123], v[224:227], v[176:191]
  s_waitcnt vmcnt(10)
  v_exp_f32 v60, v60
  v_exp_f32 v61, v61
  v_exp_f32 v62, v62
  v_exp_f32 v63, v63
  v_cvt_pk_bf16_f32 v228, v56, v57
  v_cvt_pk_bf16_f32 v229, v58, v59
  v_cvt_pk_bf16_f32 v230, v60, v61
  v_cvt_pk_bf16_f32 v231, v62, v63
  v_mfma_f32_32x32x16_bf16 v[48:63], v[128:131], v[16:19], 0
  s_cbranch_scc1 .fz_kernel_pk39c
.fz_kernel_pk39:
  v_exp_f32 v64, v64
  v_exp_f32 v65, v65
  v_exp_f32 v66, v66
  v_exp_f32 v67, v67
  v_mfma_f32_32x32x16_bf16 v[176:191], v[124:127], v[228:231], v[176:191]
  v_exp_f32 v68, v68
  v_exp_f32 v69, v69
  v_exp_f32 v70, v70
  v_smfmac_f32_16x16x64_bf16 v[216:219], v[12:15], v[224:231], v11
  buffer_load_dwordx4 v[112:115], v3, s[4:7], s30 offen offset:0
  v_exp_f32 v71, v71
  v_mfma_f32_32x32x16_bf16 v[48:63], v[132:135], v[20:23], v[48:63]
  v_cvt_pk_bf16_f32 v224, v64, v65
  v_cvt_pk_bf16_f32 v225, v66, v67
  v_cvt_pk_bf16_f32 v226, v68, v69
  v_cvt_pk_bf16_f32 v227, v70, v71
  v_exp_f32 v72, v72
  v_exp_f32 v73, v73
  v_exp_f32 v74, v74
  v_exp_f32 v75, v75
  v_mfma_f32_32x32x16_bf16 v[192:207], v[120:123], v[224:227], v[192:207]
  v_exp_f32 v76, v76
  v_exp_f32 v77, v77
  v_exp_f32 v78, v78
  v_exp_f32 v79, v79
  v_cvt_pk_bf16_f32 v228, v72, v73
  v_cvt_pk_bf16_f32 v229, v74, v75
  v_cvt_pk_bf16_f32 v230, v76, v77
  v_cvt_pk_bf16_f32 v231, v78, v79
  v_mfma_f32_32x32x16_bf16 v[64:79], v[128:131], v[24:27], 0
  v_exp_f32 v48, v48
  v_exp_f32 v49, v49
  v_exp_f32 v50, v50
  v_exp_f32 v51, v51
  v_mfma_f32_32x32x16_bf16 v[192:207], v[124:127], v[228:231], v[192:207]
  v_exp_f32 v52, v52
  v_exp_f32 v53, v53
  v_exp_f32 v54, v54
  v_smfmac_f32_16x16x64_bf16 v[220:223], v[12:15], v[224:231], v11
  buffer_load_dwordx4 v[116:119], v3, s[4:7], s30 offen offset:1024
  v_exp_f32 v55, v55
  v_mfma_f32_32x32x16_bf16 v[64:79], v[132:135], v[28:31], v[64:79]
  s_waitcnt vmcnt(10)
  v_cvt_pk_bf16_f32 v224, v48, v49
  v_cvt_pk_bf16_f32 v225, v50, v51
  v_cvt_pk_bf16_f32 v226, v52, v53
  v_cvt_pk_bf16_f32 v227, v54, v55
  v_exp_f32 v56, v56
  v_exp_f32 v57, v57
  v_exp_f32 v58, v58
  v_exp_f32 v59, v59
  v_mfma_f32_32x32x16_bf16 v[144:159], v[136:139], v[224:227], v[144:159]
  v_exp_f32 v60, v60
  v_exp_f32 v61, v61
  v_exp_f32 v62, v62
  v_exp_f32 v63, v63
  v_cvt_pk_bf16_f32 v228, v56, v57
  v_cvt_pk_bf16_f32 v229, v58, v59
  v_cvt_pk_bf16_f32 v230, v60, v61
  v_cvt_pk_bf16_f32 v231, v62, v63
  v_mfma_f32_32x32x16_bf16 v[48:63], v[128:131], v[32:35], 0
  v_exp_f32 v64, v64
  v_exp_f32 v65, v65
  v_exp_f32 v66, v66
  v_exp_f32 v67, v67
  v_mfma_f32_32x32x16_bf16 v[144:159], v[140:143], v[228:231], v[144:159]
  v_exp_f32 v68, v68
  v_exp_f32 v69, v69
  v_exp_f32 v70, v70
  v_smfmac_f32_16x16x64_bf16 v[208:211], v[12:15], v[224:231], v11
  buffer_load_dwordx4 v[120:123], v3, s[4:7], s30 offen offset:2048
  v_exp_f32 v71, v71
  v_mfma_f32_32x32x16_bf16 v[48:63], v[132:135], v[36:39], v[48:63]
  v_cvt_pk_bf16_f32 v224, v64, v65
  v_cvt_pk_bf16_f32 v225, v66, v67
  v_cvt_pk_bf16_f32 v226, v68, v69
  v_cvt_pk_bf16_f32 v227, v70, v71
  v_exp_f32 v72, v72
  v_exp_f32 v73, v73
  v_exp_f32 v74, v74
  v_exp_f32 v75, v75
  v_mfma_f32_32x32x16_bf16 v[160:175], v[136:139], v[224:227], v[160:175]
  v_exp_f32 v76, v76
  v_exp_f32 v77, v77
  v_exp_f32 v78, v78
  v_exp_f32 v79, v79
  v_cvt_pk_bf16_f32 v228, v72, v73
  v_cvt_pk_bf16_f32 v229, v74, v75
  v_cvt_pk_bf16_f32 v230, v76, v77
  v_cvt_pk_bf16_f32 v231, v78, v79
  v_mfma_f32_32x32x16_bf16 v[64:79], v[128:131], v[40:43], 0
  v_exp_f32 v48, v48
  v_exp_f32 v49, v49
  v_exp_f32 v50, v50
  v_exp_f32 v51, v51
  v_mfma_f32_32x32x16_bf16 v[160:175], v[140:143], v[228:231], v[160:175]
  v_exp_f32 v52, v52
  v_exp_f32 v53, v53
  v_exp_f32 v54, v54
  v_smfmac_f32_16x16x64_bf16 v[212:215], v[12:15], v[224:231], v11
  buffer_load_dwordx4 v[124:127], v3, s[4:7], s30 offen offset:3072
  v_exp_f32 v55, v55
  v_mfma_f32_32x32x16_bf16 v[64:79], v[132:135], v[44:47], v[64:79]
  v_cvt_pk_bf16_f32 v224, v48, v49
  v_cvt_pk_bf16_f32 v225, v50, v51
  v_cvt_pk_bf16_f32 v226, v52, v53
  v_cvt_pk_bf16_f32 v227, v54, v55
  v_exp_f32 v56, v56
  v_exp_f32 v57, v57
  v_exp_f32 v58, v58
  v_exp_f32 v59, v59
  v_mfma_f32_32x32x16_bf16 v[176:191], v[136:139], v[224:227], v[176:191]
  s_waitcnt vmcnt(10)
  v_exp_f32 v60, v60
  v_exp_f32 v61, v61
  v_exp_f32 v62, v62
  v_exp_f32 v63, v63
  v_cvt_pk_bf16_f32 v228, v56, v57
  v_cvt_pk_bf16_f32 v229, v58, v59
  v_cvt_pk_bf16_f32 v230, v60, v61
  v_cvt_pk_bf16_f32 v231, v62, v63
  v_mfma_f32_32x32x16_bf16 v[48:63], v[80:83], v[16:19], 0
  v_exp_f32 v64, v64
  v_exp_f32 v65, v65
  v_exp_f32 v66, v66
  v_exp_f32 v67, v67
  v_mfma_f32_32x32x16_bf16 v[176:191], v[140:143], v[228:231], v[176:191]
  v_exp_f32 v68, v68
  v_exp_f32 v69, v69
  v_exp_f32 v70, v70
  v_smfmac_f32_16x16x64_bf16 v[216:219], v[12:15], v[224:231], v11
  buffer_load_dwordx4 v[128:131], v10, s[4:7], s30 offen offset:0
  v_exp_f32 v71, v71
  v_mfma_f32_32x32x16_bf16 v[48:63], v[84:87], v[20:23], v[48:63]
  v_cvt_pk_bf16_f32 v224, v64, v65
  v_cvt_pk_bf16_f32 v225, v66, v67
  v_cvt_pk_bf16_f32 v226, v68, v69
  v_cvt_pk_bf16_f32 v227, v70, v71
  v_exp_f32 v72, v72
  v_exp_f32 v73, v73
  v_exp_f32 v74, v74
  v_exp_f32 v75, v75
  v_mfma_f32_32x32x16_bf16 v[192:207], v[136:139], v[224:227], v[192:207]
  v_exp_f32 v76, v76
  v_exp_f32 v77, v77
  v_exp_f32 v78, v78
  v_exp_f32 v79, v79
  v_cvt_pk_bf16_f32 v228, v72, v73
  v_cvt_pk_bf16_f32 v229, v74, v75
  v_cvt_pk_bf16_f32 v230, v76, v77
  v_cvt_pk_bf16_f32 v231, v78, v79
  s_branch .fz_kernel_a_loop
.fz_kernel_a_x:
  s_waitcnt vmcnt(7)
  v_mfma_f32_32x32x16_bf16 v[64:79], v[128:131], v[16:19], 0
  v_exp_f32 v48, v48
  v_exp_f32 v49, v49
  v_exp_f32 v50, v50
  v_exp_f32 v51, v51
  v_mfma_f32_32x32x16_bf16 v[192:207], v[108:111], v[228:231], v[192:207]
  v_exp_f32 v52, v52
  v_exp_f32 v53, v53
  v_exp_f32 v54, v54
  v_smfmac_f32_16x16x64_bf16 v[220:223], v[12:15], v[224:231], v11
  v_exp_f32 v55, v55
  v_mfma_f32_32x32x16_bf16 v[64:79], v[132:135], v[20:23], v[64:79]
  s_waitcnt vmcnt(5)
  v_cvt_pk_bf16_f32 v224, v48, v49
  v_cvt_pk_bf16_f32 v225, v50, v51
  v_cvt_pk_bf16_f32 v226, v52, v53
  v_cvt_pk_bf16_f32 v227, v54, v55
  v_exp_f32 v56, v56
  v_exp_f32 v57, v57
  v_exp_f32 v58, v58
  v_exp_f32 v59, v59
  v_mfma_f32_32x32x16_bf16 v[144:159], v[120:123], v[224:227], v[144:159]
  v_exp_f32 v60, v60
  v_exp_f32 v61, v61
  v_exp_f32 v62, v62
  v_exp_f32 v63, v63
  v_cvt_pk_bf16_f32 v228, v56, v57
  v_cvt_pk_bf16_f32 v229, v58, v59
  v_cvt_pk_bf16_f32 v230, v60, v61
  v_cvt_pk_bf16_f32 v231, v62, v63
  v_mfma_f32_32x32x16_bf16 v[48:63], v[112:115], v[24:27], 0
  v_exp_f32 v64, v64
  v_exp_f32 v65, v65
  v_exp_f32 v66, v66
  v_exp_f32 v67, v67
  v_mfma_f32_32x32x16_bf16 v[144:159], v[124:127], v[228:231], v[144:159]
  v_exp_f32 v68, v68
  v_exp_f32 v69, v69
  v_exp_f32 v70, v70
  v_smfmac_f32_16x16x64_bf16 v[208:211], v[12:15], v[224:231], v11
  v_exp_f32 v71, v71
  v_mfma_f32_32x32x16_bf16 v[48:63], v[116:119], v[28:31], v[48:63]
  v_cvt_pk_bf16_f32 v224, v64, v65
  v_cvt_pk_bf16_f32 v225, v66, v67
  v_cvt_pk_bf16_f32 v226, v68, v69
  v_cvt_pk_bf16_f32 v227, v70, v71
  v_exp_f32 v72, v72
  v_exp_f32 v73, v73
  v_exp_f32 v74, v74
  v_exp_f32 v75, v75
  v_mfma_f32_32x32x16_bf16 v[144:159], v[136:139], v[224:227], v[144:159]
  v_exp_f32 v76, v76
  v_exp_f32 v77, v77
  v_exp_f32 v78, v78
  v_exp_f32 v79, v79
  v_cvt_pk_bf16_f32 v228, v72, v73
  v_cvt_pk_bf16_f32 v229, v74, v75
  v_cvt_pk_bf16_f32 v230, v76, v77
  v_cvt_pk_bf16_f32 v231, v78, v79
  v_mfma_f32_32x32x16_bf16 v[64:79], v[128:131], v[24:27], 0
  v_exp_f32 v48, v48
  v_exp_f32 v49, v49
  v_exp_f32 v50, v50
  v_exp_f32 v51, v51
  v_mfma_f32_32x32x16_bf16 v[144:159], v[140:143], v[228:231], v[144:159]
  v_exp_f32 v52, v52
  v_exp_f32 v53, v53
  v_exp_f32 v54, v54
  v_smfmac_f32_16x16x64_bf16 v[208:211], v[12:15], v[224:231], v11
  v_exp_f32 v55, v55
  v_mfma_f32_32x32x16_bf16 v[64:79], v[132:135], v[28:31], v[64:79]
  v_cvt_pk_bf16_f32 v224, v48, v49
  v_cvt_pk_bf16_f32 v225, v50, v51
  v_cvt_pk_bf16_f32 v226, v52, v53
  v_cvt_pk_bf16_f32 v227, v54, v55
  v_exp_f32 v56, v56
  v_exp_f32 v57, v57
  v_exp_f32 v58, v58
  v_exp_f32 v59, v59
  v_mfma_f32_32x32x16_bf16 v[160:175], v[120:123], v[224:227], v[160:175]
  v_exp_f32 v60, v60
  v_exp_f32 v61, v61
  v_exp_f32 v62, v62
  v_exp_f32 v63, v63
  v_cvt_pk_bf16_f32 v228, v56, v57
  v_cvt_pk_bf16_f32 v229, v58, v59
  v_cvt_pk_bf16_f32 v230, v60, v61
  v_cvt_pk_bf16_f32 v231, v62, v63
  v_cvt_pk_bf16_f32 v144, v144, v145
  v_cvt_pk_bf16_f32 v145, v146, v147
  v_cvt_pk_bf16_f32 v146, v148, v149
  v_cvt_pk_bf16_f32 v147, v150, v151
  ds_write_b128 v9, v[144:147] offset:0
  v_cvt_pk_bf16_f32 v148, v152, v153
  v_cvt_pk_bf16_f32 v149, v154, v155
  v_cvt_pk_bf16_f32 v150, v156, v157
  v_cvt_pk_bf16_f32 v151, v158, v159
  ds_write_b128 v9, v[148:151] offset:1024
  v_add_f32 v208, v208, v210
  v_add_f32 v209, v209, v211
  v_cndmask_b32 v30, v208, v209, s[20:21]
  v_mfma_f32_32x32x16_bf16 v[48:63], v[112:115], v[32:35], 0
  v_exp_f32 v64, v64
  v_exp_f32 v65, v65
  v_exp_f32 v66, v66
  v_exp_f32 v67, v67
  v_mfma_f32_32x32x16_bf16 v[160:175], v[124:127], v[228:231], v[160:175]
  v_exp_f32 v68, v68
  v_exp_f32 v69, v69
  v_exp_f32 v70, v70
  v_smfmac_f32_16x16x64_bf16 v[212:215], v[12:15], v[224:231], v11
  v_exp_f32 v71, v71
  v_mfma_f32_32x32x16_bf16 v[48:63], v[116:119], v[36:39], v[48:63]
  v_cvt_pk_bf16_f32 v224, v64, v65
  v_cvt_pk_bf16_f32 v225, v66, v67
  v_cvt_pk_bf16_f32 v226, v68, v69
  v_cvt_pk_bf16_f32 v227, v70, v71
  v_exp_f32 v72, v72
  v_exp_f32 v73, v73
  v_exp_f32 v74, v74
  v_exp_f32 v75, v75
  v_mfma_f32_32x32x16_bf16 v[160:175], v[136:139], v[224:227], v[160:175]
  v_exp_f32 v76, v76
  v_exp_f32 v77, v77
  v_exp_f32 v78, v78
  v_exp_f32 v79, v79
  v_cvt_pk_bf16_f32 v228, v72, v73
  v_cvt_pk_bf16_f32 v229, v74, v75
  v_cvt_pk_bf16_f32 v230, v76, v77
  v_cvt_pk_bf16_f32 v231, v78, v79
  v_mfma_f32_32x32x16_bf16 v[64:79], v[128:131], v[32:35], 0
  v_exp_f32 v48, v48
  v_exp_f32 v49, v49
  v_exp_f32 v50, v50
  v_exp_f32 v51, v51
  v_mfma_f32_32x32x16_bf16 v[160:175], v[140:143], v[228:231], v[160:175]
  v_exp_f32 v52, v52
  v_exp_f32 v53, v53
  v_exp_f32 v54, v54
  v_smfmac_f32_16x16x64_bf16 v[212:215], v[12:15], v[224:231], v11
  v_exp_f32 v55, v55
  v_mfma_f32_32x32x16_bf16 v[64:79], v[132:135], v[36:39], v[64:79]
  v_cvt_pk_bf16_f32 v224, v48, v49
  v_cvt_pk_bf16_f32 v225, v50, v51
  v_cvt_pk_bf16_f32 v226, v52, v53
  v_cvt_pk_bf16_f32 v227, v54, v55
  v_exp_f32 v56, v56
  v_exp_f32 v57, v57
  v_exp_f32 v58, v58
  v_exp_f32 v59, v59
  v_mfma_f32_32x32x16_bf16 v[176:191], v[120:123], v[224:227], v[176:191]
  v_exp_f32 v60, v60
  v_exp_f32 v61, v61
  v_exp_f32 v62, v62
  v_exp_f32 v63, v63
  v_cvt_pk_bf16_f32 v228, v56, v57
  v_cvt_pk_bf16_f32 v229, v58, v59
  v_cvt_pk_bf16_f32 v230, v60, v61
  v_cvt_pk_bf16_f32 v231, v62, v63
  v_cvt_pk_bf16_f32 v160, v160, v161
  v_cvt_pk_bf16_f32 v161, v162, v163
  v_cvt_pk_bf16_f32 v162, v164, v165
  v_cvt_pk_bf16_f32 v163, v166, v167
  ds_write_b128 v9, v[160:163] offset:2048
  v_cvt_pk_bf16_f32 v164, v168, v169
  v_cvt_pk_bf16_f32 v165, v170, v171
  v_cvt_pk_bf16_f32 v166, v172, v173
  v_cvt_pk_bf16_f32 v167, v174, v175
  ds_write_b128 v9, v[164:167] offset:3072
  v_add_f32 v212, v212, v214
  v_add_f32 v213, v213, v215
  v_cndmask_b32 v31, v212, v213, s[20:21]
  ds_write_b64 v1, v[30:31]
  v_xor_b32 v1, 512, v1
  v_mfma_f32_32x32x16_bf16 v[48:63], v[112:115], v[40:43], 0
  v_exp_f32 v64, v64
  v_exp_f32 v65, v65
  v_exp_f32 v66, v66
  v_exp_f32 v67, v67
  v_mfma_f32_32x32x16_bf16 v[176:191], v[124:127], v[228:231], v[176:191]
  v_exp_f32 v68, v68
  v_exp_f32 v69, v69
  v_exp_f32 v70, v70
  v_smfmac_f32_16x16x64_bf16 v[216:219], v[12:15], v[224:231], v11
  s_waitcnt vmcnt(0) lgkmcnt(0)
  s_barrier
  ds_read_b128 v[80:83], v8 offset:0
  ds_read_b128 v[84:87], v8 offset:1024
  ds_read_b128 v[88:91], v8 offset:2048
  ds_read_b128 v[92:95], v8 offset:3072
  ds_read_b64 v[30:31], v1
  v_exp_f32 v71, v71
  v_mfma_f32_32x32x16_bf16 v[48:63], v[116:119], v[44:47], v[48:63]
  v_cvt_pk_bf16_f32 v224, v64, v65
  v_cvt_pk_bf16_f32 v225, v66, v67
  v_cvt_pk_bf16_f32 v226, v68, v69
  v_cvt_pk_bf16_f32 v227, v70, v71
  v_exp_f32 v72, v72
  v_exp_f32 v73, v73
  v_exp_f32 v74, v74
  v_exp_f32 v75, v75
  v_mfma_f32_32x32x16_bf16 v[176:191], v[136:139], v[224:227], v[176:191]
  v_exp_f32 v76, v76
  v_exp_f32 v77, v77
  s_waitcnt lgkmcnt(0)
  v_mfma_f32_32x32x16_bf16 v[176:191], v[248:251], v[80:83], v[176:191]
  v_exp_f32 v78, v78
  v_exp_f32 v79, v79
  v_mfma_f32_32x32x16_bf16 v[176:191], v[252:255], v[84:87], v[176:191]
  v_cvt_pk_bf16_f32 v228, v72, v73
  v_cvt_pk_bf16_f32 v229, v74, v75
  v_cvt_pk_bf16_f32 v230, v76, v77
  v_cvt_pk_bf16_f32 v231, v78, v79
  v_mfma_f32_32x32x16_bf16 v[64:79], v[128:131], v[40:43], 0
  v_exp_f32 v48, v48
  v_exp_f32 v49, v49
  v_exp_f32 v50, v50
  v_exp_f32 v51, v51
  v_mfma_f32_32x32x16_bf16 v[176:191], v[140:143], v[228:231], v[176:191]
  v_exp_f32 v52, v52
  v_exp_f32 v53, v53
  v_exp_f32 v54, v54
  v_smfmac_f32_16x16x64_bf16 v[216:219], v[12:15], v[224:231], v11
  v_exp_f32 v55, v55
  v_mfma_f32_32x32x16_bf16 v[64:79], v[132:135], v[44:47], v[64:79]
  v_cvt_pk_bf16_f32 v224, v48, v49
  v_cvt_pk_bf16_f32 v225, v50, v51
  v_cvt_pk_bf16_f32 v226, v52, v53
  v_cvt_pk_bf16_f32 v227, v54, v55
  v_exp_f32 v56, v56
  v_exp_f32 v57, v57
  v_exp_f32 v58, v58
  v_exp_f32 v59, v59
  s_nop 1
  v_add_f32 v216, v216, v218
  v_add_f32 v217, v217, v219
  v_cndmask_b32 v24, v216, v217, s[20:21]
  v_add_f32 v24, v24, v30
  s_mov_b64 s[36:37], -1
  v_rcp_f32 v26, v24
  v_cmp_le_f32 vcc, s24, v24
  s_and_b64 s[36:37], s[36:37], vcc
  v_cmp_ge_f32 vcc, s25, v24
  s_and_b64 s[36:37], s[36:37], vcc
  v_pk_mul_f32 v[176:177], v[176:177], v[26:27] op_sel_hi:[1,0]
  v_pk_mul_f32 v[178:179], v[178:179], v[26:27] op_sel_hi:[1,0]
  v_pk_mul_f32 v[180:181], v[180:181], v[26:27] op_sel_hi:[1,0]
  v_pk_mul_f32 v[182:183], v[182:183], v[26:27] op_sel_hi:[1,0]
  v_cvt_pk_bf16_f32 v80, v176, v177
  v_cvt_pk_bf16_f32 v81, v178, v179
  v_cvt_pk_bf16_f32 v82, v180, v181
  v_cvt_pk_bf16_f32 v83, v182, v183
  buffer_store_dwordx4 v[80:83], v3, s[4:7], s8 offen offset:0 sc1
  v_pk_mul_f32 v[184:185], v[184:185], v[26:27] op_sel_hi:[1,0]
  v_pk_mul_f32 v[186:187], v[186:187], v[26:27] op_sel_hi:[1,0]
  v_pk_mul_f32 v[188:189], v[188:189], v[26:27] op_sel_hi:[1,0]
  v_pk_mul_f32 v[190:191], v[190:191], v[26:27] op_sel_hi:[1,0]
  v_cvt_pk_bf16_f32 v84, v184, v185
  v_cvt_pk_bf16_f32 v85, v186, v187
  v_cvt_pk_bf16_f32 v86, v188, v189
  v_cvt_pk_bf16_f32 v87, v190, v191
  buffer_store_dwordx4 v[84:87], v3, s[4:7], s8 offen offset:1024 sc1
  v_mfma_f32_32x32x16_bf16 v[192:207], v[120:123], v[224:227], v[192:207]
  v_exp_f32 v60, v60
  v_exp_f32 v61, v61
  v_exp_f32 v62, v62
  v_exp_f32 v63, v63
  v_cvt_pk_bf16_f32 v228, v56, v57
  v_cvt_pk_bf16_f32 v229, v58, v59
  v_cvt_pk_bf16_f32 v230, v60, v61
  v_cvt_pk_bf16_f32 v231, v62, v63
  v_mfma_f32_32x32x16_bf16 v[192:207], v[248:251], v[88:91], v[192:207]
  v_exp_f32 v64, v64
  v_exp_f32 v65, v65
  v_exp_f32 v66, v66
  v_exp_f32 v67, v67
  v_mfma_f32_32x32x16_bf16 v[192:207], v[124:127], v[228:231], v[192:207]
  v_exp_f32 v68, v68
  v_exp_f32 v69, v69
  v_exp_f32 v70, v70
  v_smfmac_f32_16x16x64_bf16 v[220:223], v[12:15], v[224:231], v11
  v_exp_f32 v71, v71
  v_mfma_f32_32x32x16_bf16 v[192:207], v[252:255], v[92:95], v[192:207]
  v_cvt_pk_bf16_f32 v224, v64, v65
  v_cvt_pk_bf16_f32 v225, v66, v67
  v_cvt_pk_bf16_f32 v226, v68, v69
  v_cvt_pk_bf16_f32 v227, v70, v71
  v_exp_f32 v72, v72
  v_exp_f32 v73, v73
  v_exp_f32 v74, v74
  v_exp_f32 v75, v75
  v_mfma_f32_32x32x16_bf16 v[192:207], v[136:139], v[224:227], v[192:207]
  v_exp_f32 v76, v76
  v_exp_f32 v77, v77
  v_exp_f32 v78, v78
  v_exp_f32 v79, v79
  v_cvt_pk_bf16_f32 v228, v72, v73
  v_cvt_pk_bf16_f32 v229, v74, v75
  v_cvt_pk_bf16_f32 v230, v76, v77
  v_cvt_pk_bf16_f32 v231, v78, v79
  s_nop 1
  v_smfmac_f32_16x16x64_bf16 v[220:223], v[12:15], v[224:231], v11
  v_mfma_f32_32x32x16_bf16 v[192:207], v[140:143], v[228:231], v[192:207]
  s_nop 10
  v_add_f32 v220, v220, v222
  v_add_f32 v221, v221, v223
  v_cndmask_b32 v25, v220, v221, s[20:21]
  v_add_f32 v25, v25, v31
.fz_kernel_a_fin:
  v_rcp_f32 v28, v25
  v_cmp_le_f32 vcc, s24, v25
  s_and_b64 s[36:37], s[36:37], vcc
  v_cmp_ge_f32 vcc, s25, v25
  s_and_b64 s[36:37], s[36:37], vcc
  v_pk_mul_f32 v[192:193], v[192:193], v[28:29] op_sel_hi:[1,0]
  v_pk_mul_f32 v[194:195], v[194:195], v[28:29] op_sel_hi:[1,0]
  v_pk_mul_f32 v[196:197], v[196:197], v[28:29] op_sel_hi:[1,0]
  v_pk_mul_f32 v[198:199], v[198:199], v[28:29] op_sel_hi:[1,0]
  v_cvt_pk_bf16_f32 v88, v192, v193
  v_cvt_pk_bf16_f32 v89, v194, v195
  v_cvt_pk_bf16_f32 v90, v196, v197
  v_cvt_pk_bf16_f32 v91, v198, v199
  buffer_store_dwordx4 v[88:91], v3, s[4:7], s9 offen offset:0 sc1
  v_pk_mul_f32 v[200:201], v[200:201], v[28:29] op_sel_hi:[1,0]
  v_pk_mul_f32 v[202:203], v[202:203], v[28:29] op_sel_hi:[1,0]
  v_pk_mul_f32 v[204:205], v[204:205], v[28:29] op_sel_hi:[1,0]
  v_pk_mul_f32 v[206:207], v[206:207], v[28:29] op_sel_hi:[1,0]
  v_cvt_pk_bf16_f32 v92, v200, v201
  v_cvt_pk_bf16_f32 v93, v202, v203
  v_cvt_pk_bf16_f32 v94, v204, v205
  v_cvt_pk_bf16_f32 v95, v206, v207
  buffer_store_dwordx4 v[92:95], v3, s[4:7], s9 offen offset:1024 sc1
  ds_read_b32 v7, v6 offset:8
  v_pk_fma_f32 v[64:65], v[176:177], 0, 0 op_sel_hi:[1,0,0]
  v_pk_fma_f32 v[66:67], v[178:179], 0, 0 op_sel_hi:[1,0,0]
  v_pk_fma_f32 v[64:65], v[180:181], 0, v[64:65] op_sel_hi:[1,0,1]
  v_pk_fma_f32 v[66:67], v[182:183], 0, v[66:67] op_sel_hi:[1,0,1]
  v_pk_fma_f32 v[64:65], v[184:185], 0, v[64:65] op_sel_hi:[1,0,1]
  v_pk_fma_f32 v[66:67], v[186:187], 0, v[66:67] op_sel_hi:[1,0,1]
  v_pk_fma_f32 v[64:65], v[188:189], 0, v[64:65] op_sel_hi:[1,0,1]
  v_pk_fma_f32 v[66:67], v[190:191], 0, v[66:67] op_sel_hi:[1,0,1]
  v_pk_fma_f32 v[64:65], v[192:193], 0, v[64:65] op_sel_hi:[1,0,1]
  v_pk_fma_f32 v[66:67], v[194:195], 0, v[66:67] op_sel_hi:[1,0,1]
  v_pk_fma_f32 v[64:65], v[196:197], 0, v[64:65] op_sel_hi:[1,0,1]
  v_pk_fma_f32 v[66:67], v[198:199], 0, v[66:67] op_sel_hi:[1,0,1]
  v_pk_fma_f32 v[64:65], v[200:201], 0, v[64:65] op_sel_hi:[1,0,1]
  v_pk_fma_f32 v[66:67], v[202:203], 0, v[66:67] op_sel_hi:[1,0,1]
  v_pk_fma_f32 v[64:65], v[204:205], 0, v[64:65] op_sel_hi:[1,0,1]
  v_pk_fma_f32 v[66:67], v[206:207], 0, v[66:67] op_sel_hi:[1,0,1]
  v_pk_add_f32 v[64:65], v[64:65], v[66:67]
  v_cmp_o_f32 vcc, v64, v65
  s_and_b64 s[36:37], s[36:37], vcc
  s_cmp_eq_u64 s[36:37], -1
  s_cbranch_scc0 .fz_kernel_a_slow
.fz_kernel_a_ok:
  s_mov_b32 s8, s48
  s_mov_b32 s9, s49
  s_mov_b32 s10, 0x800
  s_mov_b32 s11, 0x00020000
  v_lshrrev_b32 v17, 5, v2
  v_lshlrev_b32 v19, 4, v17
  s_lshl_b32 s22, s18, 7
  s_lshl2_add_u32 s32, s17, s16
  s_lshl_b32 s35, s32, 16
  s_add_u32 s35, s35, s64
  v_add_u32 v8, s35, v3
  v_add_u32 v6, 8, v6
  buffer_load_dwordx4 v[48:51], v19, s[8:11], s22 offen offset:0
  buffer_load_dwordx4 v[52:55], v19, s[8:11], s22 offen offset:32
  buffer_load_dwordx4 v[56:59], v19, s[8:11], s22 offen offset:64
  buffer_load_dwordx4 v[60:63], v19, s[8:11], s22 offen offset:96
  s_waitcnt lgkmcnt(0)
  v_readfirstlane_b32 s36, v7
  s_mov_b32 s34, s36
  s_bcnt1_i32_b32 s29, s36
  s_cmp_lt_u32 s29, 2
  s_cbranch_scc1 .fz_kernel_w_e0
  s_cmp_eq_u32 s36, 0
  s_cbranch_scc1 .fz_kernel_pk48c
.fz_kernel_pk48:
  s_ff1_i32_b32 s33, s36
  s_bitset0_b32 s36, s33
  s_lshl_b32 s20, s33, 12
  buffer_load_dwordx4 v[96:99], v8, s[4:7], s20 offen offset:0
  buffer_load_dwordx4 v[100:103], v8, s[4:7], s20 offen offset:1024
  buffer_load_dwordx4 v[104:107], v8, s[4:7], s20 offen offset:2048
  buffer_load_dwordx4 v[108:111], v8, s[4:7], s20 offen offset:3072
  s_cmp_eq_u32 s36, 0
  s_cbranch_scc1 .fz_kernel_pk49c
.fz_kernel_pk49:
  s_ff1_i32_b32 s33, s36
  s_bitset0_b32 s36, s33
  s_lshl_b32 s21, s33, 12
  buffer_load_dwordx4 v[112:115], v8, s[4:7], s21 offen offset:0
  buffer_load_dwordx4 v[116:119], v8, s[4:7], s21 offen offset:1024
  buffer_load_dwordx4 v[120:123], v8, s[4:7], s21 offen offset:2048
  buffer_load_dwordx4 v[124:127], v8, s[4:7], s21 offen offset:3072
.fz_kernel_w_e0:
  v_and_b32 v18, 31, v2
  s_lshl_b32 s39, s17, 4
  s_add_u32 s39, s39, s18
  s_lshl_b32 s39, s39, 2
  s_add_u32 s39, s39, s16
  s_lshl_b32 s39, s39, 12
  v_and_b32 v16, 16, v2
  v_lshlrev_b32 v16, 7, v16
  v_lshl_add_u32 v16, v17, 8, v16
  v_and_b32 v1, 0xf0, v3
  v_add_u32 v16, v16, v1
  s_add_u32 s39, s39, s65
  s_lshl_b32 s31, s16, 5
  v_add_u32 v45, s31, v18
  v_lshlrev_b32 v11, 2, v45
  v_add_u32 v11, 155648, v11
  v_mov_b32 v44, 159952
  ds_read_b32 v40, v11 offset:6400
  ds_read_b32 v42, v11 offset:6912
  ds_read_b32 v46, v44 offset:8
  ds_read_b32 v44, v44
  v_mov_b32 v47, 0.32768
  v_add_u32 v45, 1, v45
  v_bfe_u32 v11, v2, 2, 2
  v_lshl_add_u32 v12, v17, 2, v11
  v_lshlrev_b32 v12, 7, v12
  v_lshrrev_b32 v13, 1, v11
  v_lshl_add_u32 v12, v13, 6, v12
  v_bfe_u32 v13, v2, 4, 1
  v_lshl_add_u32 v12, v13, 5, v12
  v_and_b32 v13, 1, v2
  v_lshl_add_u32 v12, v13, 4, v12
  v_bfe_u32 v13, v2, 1, 1
  v_lshl_add_u32 v14, v13, 3, v12
  v_xor_b32 v15, 64, v14
  s_mov_b64 exec, 1
  s_cmp_lt_u32 s29, 2
  s_cbranch_scc1 .fz_kernel_w_e1
  s_waitcnt vmcnt(12)
  s_branch .fz_kernel_w_e3
.fz_kernel_w_e1:
  s_waitcnt vmcnt(4)
.fz_kernel_w_e3:
  ds_add_u32 v6, v5 offset:0x100
  s_mov_b64 exec, -1
  v_lshlrev_b32 v64, 16, v232
  v_and_b32 v65, 0xffff0000, v232
  v_lshlrev_b32 v66, 16, v233
  v_and_b32 v67, 0xffff0000, v233
  v_lshlrev_b32 v68, 16, v234
  v_and_b32 v69, 0xffff0000, v234
  v_lshlrev_b32 v70, 16, v235
  v_and_b32 v71, 0xffff0000, v235
  v_lshlrev_b32 v72, 16, v236
  v_and_b32 v73, 0xffff0000, v236
  v_lshlrev_b32 v74, 16, v237
  v_and_b32 v75, 0xffff0000, v237
  v_lshlrev_b32 v76, 16, v238
  v_and_b32 v77, 0xffff0000, v238
  v_lshlrev_b32 v78, 16, v239
  v_and_b32 v79, 0xffff0000, v239
  v_lshlrev_b32 v80, 16, v240
  v_and_b32 v81, 0xffff0000, v240
  v_lshlrev_b32 v82, 16, v241
  v_and_b32 v83, 0xffff0000, v241
  v_lshlrev_b32 v84, 16, v242
  v_and_b32 v85, 0xffff0000, v242
  v_lshlrev_b32 v86, 16, v243
  v_and_b32 v87, 0xffff0000, v243
  v_lshlrev_b32 v88, 16, v244
  v_and_b32 v89, 0xffff0000, v244
  v_lshlrev_b32 v90, 16, v245
  v_and_b32 v91, 0xffff0000, v245
  v_lshlrev_b32 v92, 16, v246
  v_and_b32 v93, 0xffff0000, v246
  v_lshlrev_b32 v94, 16, v247
  v_and_b32 v95, 0xffff0000, v247
  s_waitcnt lgkmcnt(0)
  v_pk_fma_f32 v[64:65], v[64:65], v[40:41], v[42:43] op_sel_hi:[1,0,0]
  v_pk_fma_f32 v[66:67], v[66:67], v[40:41], v[42:43] op_sel_hi:[1,0,0]
  v_pk_fma_f32 v[68:69], v[68:69], v[40:41], v[42:43] op_sel_hi:[1,0,0]
  v_pk_fma_f32 v[70:71], v[70:71], v[40:41], v[42:43] op_sel_hi:[1,0,0]
  v_pk_fma_f32 v[72:73], v[72:73], v[40:41], v[42:43] op_sel_hi:[1,0,0]
  v_pk_fma_f32 v[74:75], v[74:75], v[40:41], v[42:43] op_sel_hi:[1,0,0]
  v_pk_fma_f32 v[76:77], v[76:77], v[40:41], v[42:43] op_sel_hi:[1,0,0]
  v_pk_fma_f32 v[78:79], v[78:79], v[40:41], v[42:43] op_sel_hi:[1,0,0]
  v_pk_fma_f32 v[80:81], v[80:81], v[40:41], v[42:43] op_sel_hi:[1,0,0]
  v_pk_fma_f32 v[82:83], v[82:83], v[40:41], v[42:43] op_sel_hi:[1,0,0]
  v_pk_fma_f32 v[84:85], v[84:85], v[40:41], v[42:43] op_sel_hi:[1,0,0]
  v_pk_fma_f32 v[86:87], v[86:87], v[40:41], v[42:43] op_sel_hi:[1,0,0]
  v_pk_fma_f32 v[88:89], v[88:89], v[40:41], v[42:43] op_sel_hi:[1,0,0]
  v_pk_fma_f32 v[90:91], v[90:91], v[40:41], v[42:43] op_sel_hi:[1,0,0]
  v_pk_fma_f32 v[92:93], v[92:93], v[40:41], v[42:43] op_sel_hi:[1,0,0]
  v_pk_fma_f32 v[94:95], v[94:95], v[40:41], v[42:43] op_sel_hi:[1,0,0]
  v_cmp_eq_u32 vcc, v44, v45
  s_cbranch_vccnz .fz_kernel_w_pt
.fz_kernel_w_pb:
  s_cmp_ge_u32 s29, 2
  s_cbranch_scc1 .fz_kernel_w_e2
  s_cmp_eq_u32 s36, 0
  s_cbranch_scc1 .fz_kernel_pk50c
.fz_kernel_pk50:
  s_ff1_i32_b32 s33, s36
  s_bitset0_b32 s36, s33
  s_lshl_b32 s20, s33, 12
  buffer_load_dwordx4 v[96:99], v8, s[4:7], s20 offen offset:0
  buffer_load_dwordx4 v[100:103], v8, s[4:7], s20 offen offset:1024
  buffer_load_dwordx4 v[104:107], v8, s[4:7], s20 offen offset:2048
  buffer_load_dwordx4 v[108:111], v8, s[4:7], s20 offen offset:3072
  s_cmp_eq_u32 s36, 0
  s_cbranch_scc1 .fz_kernel_pk51c
.fz_kernel_pk51:
  s_ff1_i32_b32 s33, s36
  s_bitset0_b32 s36, s33
  s_lshl_b32 s21, s33, 12
  buffer_load_dwordx4 v[112:115], v8, s[4:7], s21 offen offset:0
  buffer_load_dwordx4 v[116:119], v8, s[4:7], s21 offen offset:1024
  buffer_load_dwordx4 v[120:123], v8, s[4:7], s21 offen offset:2048
  buffer_load_dwordx4 v[124:127], v8, s[4:7], s21 offen offset:3072
.fz_kernel_w_e2:
  s_cmp_eq_u32 s36, 0
  s_cbranch_scc1 .fz_kernel_pk52c
.fz_kernel_pk52:
  s_ff1_i32_b32 s33, s36
  s_bitset0_b32 s36, s33
  s_lshl_b32 s22, s33, 12
  buffer_load_dwordx4 v[128:131], v8, s[4:7], s22 offen offset:0
  buffer_load_dwordx4 v[132:135], v8, s[4:7], s22 offen offset:1024
  buffer_load_dwordx4 v[136:139], v8, s[4:7], s22 offen offset:2048
  buffer_load_dwordx4 v[140:143], v8, s[4:7], s22 offen offset:3072
  v_lshl_add_u32 v10, s20, 1, v14
  v_lshl_add_u32 v11, s20, 1, v15
  ds_read_b64_tr_b16 v[224:225], v10 offset:0
  ds_read_b64_tr_b16 v[226:227], v10 offset:1024
  ds_read_b64_tr_b16 v[228:229], v11 offset:0
  ds_read_b64_tr_b16 v[230:231], v11 offset:1024
  ds_read_b64_tr_b16 v[232:233], v10 offset:2048
  ds_read_b64_tr_b16 v[234:235], v10 offset:3072
  ds_read_b64_tr_b16 v[236:237], v11 offset:2048
  ds_read_b64_tr_b16 v[238:239], v11 offset:3072
  ds_read_b64_tr_b16 v[240:241], v10 offset:4096
  ds_read_b64_tr_b16 v[242:243], v10 offset:5120
  ds_read_b64_tr_b16 v[244:245], v11 offset:4096
  ds_read_b64_tr_b16 v[246:247], v11 offset:5120
  s_cmp_eq_u32 s36, 0
  s_cbranch_scc1 .fz_kernel_pk53c
.fz_kernel_pk53:
  s_ff1_i32_b32 s33, s36
  s_bitset0_b32 s36, s33
  s_lshl_b32 s23, s33, 12
  s_waitcnt vmcnt(11) lgkmcnt(8)
  v_mfma_f32_32x32x16_bf16 v[64:79], v[224:227], v[96:99], v[64:79]
  buffer_load_dwordx4 v[144:147], v8, s[4:7], s23 offen offset:0
  ds_read_b64_tr_b16 v[248:249], v10 offset:6144
  ds_read_b64_tr_b16 v[250:251], v10 offset:7168
  v_mfma_f32_32x32x16_bf16 v[80:95], v[228:231], v[96:99], v[80:95]
  ds_read_b64_tr_b16 v[252:253], v11 offset:6144
  ds_read_b64_tr_b16 v[254:255], v11 offset:7168
  v_lshl_add_u32 v12, s21, 1, v14
  v_lshl_add_u32 v13, s21, 1, v15
  s_waitcnt vmcnt(11) lgkmcnt(8)
  v_mfma_f32_32x32x16_bf16 v[64:79], v[232:235], v[100:103], v[64:79]
  buffer_load_dwordx4 v[148:151], v8, s[4:7], s23 offen offset:1024
  ds_read_b64_tr_b16 v[224:225], v12 offset:0
  ds_read_b64_tr_b16 v[226:227], v12 offset:1024
  v_mfma_f32_32x32x16_bf16 v[80:95], v[236:239], v[100:103], v[80:95]
  ds_read_b64_tr_b16 v[228:229], v13 offset:0
  ds_read_b64_tr_b16 v[230:231], v13 offset:1024
  s_waitcnt vmcnt(11) lgkmcnt(8)
  v_mfma_f32_32x32x16_bf16 v[64:79], v[240:243], v[104:107], v[64:79]
  buffer_load_dwordx4 v[152:155], v8, s[4:7], s23 offen offset:2048
  ds_read_b64_tr_b16 v[232:233], v12 offset:2048
  ds_read_b64_tr_b16 v[234:235], v12 offset:3072
  v_mfma_f32_32x32x16_bf16 v[80:95], v[244:247], v[104:107], v[80:95]
  ds_read_b64_tr_b16 v[236:237], v13 offset:2048
  ds_read_b64_tr_b16 v[238:239], v13 offset:3072
  s_cmp_eq_u32 s36, 0
  s_cbranch_scc1 .fz_kernel_pk54c
.fz_kernel_pk54:
  s_ff1_i32_b32 s33, s36
  s_waitcnt vmcnt(11) lgkmcnt(8)
  v_mfma_f32_32x32x16_bf16 v[64:79], v[248:251], v[108:111], v[64:79]
  buffer_load_dwordx4 v[156:159], v8, s[4:7], s23 offen offset:3072
  ds_read_b64_tr_b16 v[240:241], v12 offset:4096
  ds_read_b64_tr_b16 v[242:243], v12 offset:5120
  v_mfma_f32_32x32x16_bf16 v[80:95], v[252:255], v[108:111], v[80:95]
  ds_read_b64_tr_b16 v[244:245], v13 offset:4096
  ds_read_b64_tr_b16 v[246:247], v13 offset:5120
  s_bitset0_b32 s36, s33
  s_lshl_b32 s24, s33, 12
  s_waitcnt vmcnt(11) lgkmcnt(8)
  v_mfma_f32_32x32x16_bf16 v[64:79], v[224:227], v[112:115], v[64:79]
  buffer_load_dwordx4 v[160:163], v8, s[4:7], s24 offen offset:0
  ds_read_b64_tr_b16 v[248:249], v12 offset:6144
  ds_read_b64_tr_b16 v[250:251], v12 offset:7168
  v_mfma_f32_32x32x16_bf16 v[80:95], v[228:231], v[112:115], v[80:95]
  ds_read_b64_tr_b16 v[252:253], v13 offset:6144
  ds_read_b64_tr_b16 v[254:255], v13 offset:7168
  v_lshl_add_u32 v10, s22, 1, v14
  v_lshl_add_u32 v11, s22, 1, v15
  s_waitcnt vmcnt(11) lgkmcnt(8)
  v_mfma_f32_32x32x16_bf16 v[64:79], v[232:235], v[116:119], v[64:79]
  buffer_load_dwordx4 v[164:167], v8, s[4:7], s24 offen offset:1024
  ds_read_b64_tr_b16 v[224:225], v10 offset:0
  ds_read_b64_tr_b16 v[226:227], v10 offset:1024
  v_mfma_f32_32x32x16_bf16 v[80:95], v[236:239], v[116:119], v[80:95]
  ds_read_b64_tr_b16 v[228:229], v11 offset:0
  ds_read_b64_tr_b16 v[230:231], v11 offset:1024
  s_waitcnt vmcnt(11) lgkmcnt(8)
  v_mfma_f32_32x32x16_bf16 v[64:79], v[240:243], v[120:123], v[64:79]
  buffer_load_dwordx4 v[168:171], v8, s[4:7], s24 offen offset:2048
  ds_read_b64_tr_b16 v[232:233], v10 offset:2048
  ds_read_b64_tr_b16 v[234:235], v10 offset:3072
  v_mfma_f32_32x32x16_bf16 v[80:95], v[244:247], v[120:123], v[80:95]
  ds_read_b64_tr_b16 v[236:237], v11 offset:2048
  ds_read_b64_tr_b16 v[238:239], v11 offset:3072
  s_cmp_eq_u32 s36, 0
  s_cbranch_scc1 .fz_kernel_pk55c
.fz_kernel_pk55:
  s_ff1_i32_b32 s33, s36
  s_waitcnt vmcnt(11) lgkmcnt(8)
  v_mfma_f32_32x32x16_bf16 v[64:79], v[248:251], v[124:127], v[64:79]
  buffer_load_dwordx4 v[172:175], v8, s[4:7], s24 offen offset:3072
  ds_read_b64_tr_b16 v[240:241], v10 offset:4096
  ds_read_b64_tr_b16 v[242:243], v10 offset:5120
  v_mfma_f32_32x32x16_bf16 v[80:95], v[252:255], v[124:127], v[80:95]
  ds_read_b64_tr_b16 v[244:245], v11 offset:4096
  ds_read_b64_tr_b16 v[246:247], v11 offset:5120
  s_bitset0_b32 s36, s33
  s_lshl_b32 s25, s33, 12
  s_waitcnt vmcnt(11) lgkmcnt(8)
  v_mfma_f32_32x32x16_bf16 v[64:79], v[224:227], v[128:131], v[64:79]
  buffer_load_dwordx4 v[176:179], v8, s[4:7], s25 offen offset:0
  ds_read_b64_tr_b16 v[248:249], v10 offset:6144
  ds_read_b64_tr_b16 v[250:251], v10 offset:7168
  v_mfma_f32_32x32x16_bf16 v[80:95], v[228:231], v[128:131], v[80:95]
  ds_read_b64_tr_b16 v[252:253], v11 offset:6144
  ds_read_b64_tr_b16 v[254:255], v11 offset:7168
  v_lshl_add_u32 v12, s23, 1, v14
  v_lshl_add_u32 v13, s23, 1, v15
  s_waitcnt vmcnt(11) lgkmcnt(8)
  v_mfma_f32_32x32x16_bf16 v[64:79], v[232:235], v[132:135], v[64:79]
  buffer_load_dwordx4 v[180:183], v8, s[4:7], s25 offen offset:1024
  ds_read_b64_tr_b16 v[224:225], v12 offset:0
  ds_read_b64_tr_b16 v[226:227], v12 offset:1024
  v_mfma_f32_32x32x16_bf16 v[80:95], v[236:239], v[132:135], v[80:95]
  ds_read_b64_tr_b16 v[228:229], v13 offset:0
  ds_read_b64_tr_b16 v[230:231], v13 offset:1024
  s_waitcnt vmcnt(11) lgkmcnt(8)
  v_mfma_f32_32x32x16_bf16 v[64:79], v[240:243], v[136:139], v[64:79]
  buffer_load_dwordx4 v[184:187], v8, s[4:7], s25 offen offset:2048
  ds_read_b64_tr_b16 v[232:233], v12 offset:2048
  ds_read_b64_tr_b16 v[234:235], v12 offset:3072
  v_mfma_f32_32x32x16_bf16 v[80:95], v[244:247], v[136:139], v[80:95]
  ds_read_b64_tr_b16 v[236:237], v13 offset:2048
  ds_read_b64_tr_b16 v[238:239], v13 offset:3072
  s_cmp_eq_u32 s36, 0
  s_cbranch_scc1 .fz_kernel_pk56c
.fz_kernel_pk56:
  s_ff1_i32_b32 s33, s36
  s_waitcnt vmcnt(11) lgkmcnt(8)
  v_mfma_f32_32x32x16_bf16 v[64:79], v[248:251], v[140:143], v[64:79]
  buffer_load_dwordx4 v[188:191], v8, s[4:7], s25 offen offset:3072
  ds_read_b64_tr_b16 v[240:241], v12 offset:4096
  ds_read_b64_tr_b16 v[242:243], v12 offset:5120
  v_mfma_f32_32x32x16_bf16 v[80:95], v[252:255], v[140:143], v[80:95]
  ds_read_b64_tr_b16 v[244:245], v13 offset:4096
  ds_read_b64_tr_b16 v[246:247], v13 offset:5120
  s_bitset0_b32 s36, s33
  s_lshl_b32 s26, s33, 12
  s_waitcnt vmcnt(11) lgkmcnt(8)
  v_mfma_f32_32x32x16_bf16 v[64:79], v[224:227], v[144:147], v[64:79]
  buffer_load_dwordx4 v[192:195], v8, s[4:7], s26 offen offset:0
  ds_read_b64_tr_b16 v[248:249], v12 offset:6144
  ds_read_b64_tr_b16 v[250:251], v12 offset:7168
  v_mfma_f32_32x32x16_bf16 v[80:95], v[228:231], v[144:147], v[80:95]
  ds_read_b64_tr_b16 v[252:253], v13 offset:6144
  ds_read_b64_tr_b16 v[254:255], v13 offset:7168
  v_lshl_add_u32 v10, s24, 1, v14
  v_lshl_add_u32 v11, s24, 1, v15
  s_waitcnt vmcnt(11) lgkmcnt(8)
  v_mfma_f32_32x32x16_bf16 v[64:79], v[232:235], v[148:151], v[64:79]
  buffer_load_dwordx4 v[196:199], v8, s[4:7], s26 offen offset:1024
  ds_read_b64_tr_b16 v[224:225], v10 offset:0
  ds_read_b64_tr_b16 v[226:227], v10 offset:1024
  v_mfma_f32_32x32x16_bf16 v[80:95], v[236:239], v[148:151], v[80:95]
  ds_read_b64_tr_b16 v[228:229], v11 offset:0
  ds_read_b64_tr_b16 v[230:231], v11 offset:1024
  s_waitcnt vmcnt(11) lgkmcnt(8)
  v_mfma_f32_32x32x16_bf16 v[64:79], v[240:243], v[152:155], v[64:79]
  buffer_load_dwordx4 v[200:203], v8, s[4:7], s26 offen offset:2048
  ds_read_b64_tr_b16 v[232:233], v10 offset:2048
  ds_read_b64_tr_b16 v[234:235], v10 offset:3072
  v_mfma_f32_32x32x16_bf16 v[80:95], v[244:247], v[152:155], v[80:95]
  ds_read_b64_tr_b16 v[236:237], v11 offset:2048
  ds_read_b64_tr_b16 v[238:239], v11 offset:3072
  s_cmp_eq_u32 s36, 0
  s_cbranch_scc1 .fz_kernel_pk57c
.fz_kernel_pk57:
  s_ff1_i32_b32 s33, s36
  s_waitcnt vmcnt(11) lgkmcnt(8)
  v_mfma_f32_32x32x16_bf16 v[64:79], v[248:251], v[156:159], v[64:79]
  buffer_load_dwordx4 v[204:207], v8, s[4:7], s26 offen offset:3072
  ds_read_b64_tr_b16 v[240:241], v10 offset:4096
  ds_read_b64_tr_b16 v[242:243], v10 offset:5120
  v_mfma_f32_32x32x16_bf16 v[80:95], v[252:255], v[156:159], v[80:95]
  ds_read_b64_tr_b16 v[244:245], v11 offset:4096
  ds_read_b64_tr_b16 v[246:247], v11 offset:5120
  s_bitset0_b32 s36, s33
  s_lshl_b32 s27, s33, 12
  s_waitcnt vmcnt(11) lgkmcnt(8)
  v_mfma_f32_32x32x16_bf16 v[64:79], v[224:227], v[160:163], v[64:79]
  buffer_load_dwordx4 v[208:211], v8, s[4:7], s27 offen offset:0
  ds_read_b64_tr_b16 v[248:249], v10 offset:6144
  ds_read_b64_tr_b16 v[250:251], v10 offset:7168
  v_mfma_f32_32x32x16_bf16 v[80:95], v[228:231], v[160:163], v[80:95]
  ds_read_b64_tr_b16 v[252:253], v11 offset:6144
  ds_read_b64_tr_b16 v[254:255], v11 offset:7168
  v_lshl_add_u32 v12, s25, 1, v14
  v_lshl_add_u32 v13, s25, 1, v15
  s_waitcnt vmcnt(11) lgkmcnt(8)
  v_mfma_f32_32x32x16_bf16 v[64:79], v[232:235], v[164:167], v[64:79]
  buffer_load_dwordx4 v[212:215], v8, s[4:7], s27 offen offset:1024
  ds_read_b64_tr_b16 v[224:225], v12 offset:0
  ds_read_b64_tr_b16 v[226:227], v12 offset:1024
  v_mfma_f32_32x32x16_bf16 v[80:95], v[236:239], v[164:167], v[80:95]
  ds_read_b64_tr_b16 v[228:229], v13 offset:0
  ds_read_b64_tr_b16 v[230:231], v13 offset:1024
  s_waitcnt vmcnt(11) lgkmcnt(8)
  v_mfma_f32_32x32x16_bf16 v[64:79], v[240:243], v[168:171], v[64:79]
  buffer_load_dwordx4 v[216:219], v8, s[4:7], s27 offen offset:2048
  ds_read_b64_tr_b16 v[232:233], v12 offset:2048
  ds_read_b64_tr_b16 v[234:235], v12 offset:3072
  v_mfma_f32_32x32x16_bf16 v[80:95], v[244:247], v[168:171], v[80:95]
  ds_read_b64_tr_b16 v[236:237], v13 offset:2048
  ds_read_b64_tr_b16 v[238:239], v13 offset:3072
  s_cmp_eq_u32 s36, 0
  s_cbranch_scc1 .fz_kernel_pk58c
.fz_kernel_pk58:
  s_ff1_i32_b32 s33, s36
  s_waitcnt vmcnt(11) lgkmcnt(8)
  v_mfma_f32_32x32x16_bf16 v[64:79], v[248:251], v[172:175], v[64:79]
  buffer_load_dwordx4 v[220:223], v8, s[4:7], s27 offen offset:3072
  ds_read_b64_tr_b16 v[240:241], v12 offset:4096
  ds_read_b64_tr_b16 v[242:243], v12 offset:5120
  v_mfma_f32_32x32x16_bf16 v[80:95], v[252:255], v[172:175], v[80:95]
  ds_read_b64_tr_b16 v[244:245], v13 offset:4096
  ds_read_b64_tr_b16 v[246:247], v13 offset:5120
  s_bitset0_b32 s36, s33
  s_lshl_b32 s20, s33, 12
  s_waitcnt vmcnt(11) lgkmcnt(8)
  v_mfma_f32_32x32x16_bf16 v[64:79], v[224:227], v[176:179], v[64:79]
  buffer_load_dwordx4 v[96:99], v8, s[4:7], s20 offen offset:0
  ds_read_b64_tr_b16 v[248:249], v12 offset:6144
  ds_read_b64_tr_b16 v[250:251], v12 offset:7168
  v_mfma_f32_32x32x16_bf16 v[80:95], v[228:231], v[176:179], v[80:95]
  ds_read_b64_tr_b16 v[252:253], v13 offset:6144
  ds_read_b64_tr_b16 v[254:255], v13 offset:7168
  v_lshl_add_u32 v10, s26, 1, v14
  v_lshl_add_u32 v11, s26, 1, v15
  s_waitcnt vmcnt(11) lgkmcnt(8)
  v_mfma_f32_32x32x16_bf16 v[64:79], v[232:235], v[180:183], v[64:79]
  buffer_load_dwordx4 v[100:103], v8, s[4:7], s20 offen offset:1024
  ds_read_b64_tr_b16 v[224:225], v10 offset:0
  ds_read_b64_tr_b16 v[226:227], v10 offset:1024
  v_mfma_f32_32x32x16_bf16 v[80:95], v[236:239], v[180:183], v[80:95]
  ds_read_b64_tr_b16 v[228:229], v11 offset:0
  ds_read_b64_tr_b16 v[230:231], v11 offset:1024
  s_waitcnt vmcnt(11) lgkmcnt(8)
  v_mfma_f32_32x32x16_bf16 v[64:79], v[240:243], v[184:187], v[64:79]
  buffer_load_dwordx4 v[104:107], v8, s[4:7], s20 offen offset:2048
  ds_read_b64_tr_b16 v[232:233], v10 offset:2048
  ds_read_b64_tr_b16 v[234:235], v10 offset:3072
  v_mfma_f32_32x32x16_bf16 v[80:95], v[244:247], v[184:187], v[80:95]
  ds_read_b64_tr_b16 v[236:237], v11 offset:2048
  ds_read_b64_tr_b16 v[238:239], v11 offset:3072
  s_cmp_eq_u32 s36, 0
  s_cbranch_scc1 .fz_kernel_pk59c
.fz_kernel_pk59:
  s_ff1_i32_b32 s33, s36
  s_waitcnt vmcnt(11) lgkmcnt(8)
  v_mfma_f32_32x32x16_bf16 v[64:79], v[248:251], v[188:191], v[64:79]
  buffer_load_dwordx4 v[108:111], v8, s[4:7], s20 offen offset:3072
  ds_read_b64_tr_b16 v[240:241], v10 offset:4096
  ds_read_b64_tr_b16 v[242:243], v10 offset:5120
  v_mfma_f32_32x32x16_bf16 v[80:95], v[252:255], v[188:191], v[80:95]
  ds_read_b64_tr_b16 v[244:245], v11 offset:4096
  ds_read_b64_tr_b16 v[246:247], v11 offset:5120
  s_bitset0_b32 s36, s33
  s_lshl_b32 s21, s33, 12
  s_waitcnt vmcnt(11) lgkmcnt(8)
  v_mfma_f32_32x32x16_bf16 v[64:79], v[224:227], v[192:195], v[64:79]
  buffer_load_dwordx4 v[112:115], v8, s[4:7], s21 offen offset:0
  ds_read_b64_tr_b16 v[248:249], v10 offset:6144
  ds_read_b64_tr_b16 v[250:251], v10 offset:7168
  v_mfma_f32_32x32x16_bf16 v[80:95], v[228:231], v[192:195], v[80:95]
  ds_read_b64_tr_b16 v[252:253], v11 offset:6144
  ds_read_b64_tr_b16 v[254:255], v11 offset:7168
  v_lshl_add_u32 v12, s27, 1, v14
  v_lshl_add_u32 v13, s27, 1, v15
  s_waitcnt vmcnt(11) lgkmcnt(8)
  v_mfma_f32_32x32x16_bf16 v[64:79], v[232:235], v[196:199], v[64:79]
  buffer_load_dwordx4 v[116:119], v8, s[4:7], s21 offen offset:1024
  ds_read_b64_tr_b16 v[224:225], v12 offset:0
  ds_read_b64_tr_b16 v[226:227], v12 offset:1024
  v_mfma_f32_32x32x16_bf16 v[80:95], v[236:239], v[196:199], v[80:95]
  ds_read_b64_tr_b16 v[228:229], v13 offset:0
  ds_read_b64_tr_b16 v[230:231], v13 offset:1024
  s_waitcnt vmcnt(11) lgkmcnt(8)
  v_mfma_f32_32x32x16_bf16 v[64:79], v[240:243], v[200:203], v[64:79]
  buffer_load_dwordx4 v[120:123], v8, s[4:7], s21 offen offset:2048
  ds_read_b64_tr_b16 v[232:233], v12 offset:2048
  ds_read_b64_tr_b16 v[234:235], v12 offset:3072
  v_mfma_f32_32x32x16_bf16 v[80:95], v[244:247], v[200:203], v[80:95]
  ds_read_b64_tr_b16 v[236:237], v13 offset:2048
  ds_read_b64_tr_b16 v[238:239], v13 offset:3072
  s_cmp_eq_u32 s36, 0
  s_cbranch_scc1 .fz_kernel_pk60c
.fz_kernel_pk60:
  s_ff1_i32_b32 s33, s36
  s_waitcnt vmcnt(11) lgkmcnt(8)
  v_mfma_f32_32x32x16_bf16 v[64:79], v[248:251], v[204:207], v[64:79]
  buffer_load_dwordx4 v[124:127], v8, s[4:7], s21 offen offset:3072
  ds_read_b64_tr_b16 v[240:241], v12 offset:4096
  ds_read_b64_tr_b16 v[242:243], v12 offset:5120
  v_mfma_f32_32x32x16_bf16 v[80:95], v[252:255], v[204:207], v[80:95]
  ds_read_b64_tr_b16 v[244:245], v13 offset:4096
  ds_read_b64_tr_b16 v[246:247], v13 offset:5120
  s_bitset0_b32 s36, s33
  s_lshl_b32 s22, s33, 12
  s_waitcnt vmcnt(11) lgkmcnt(8)
  v_mfma_f32_32x32x16_bf16 v[64:79], v[224:227], v[208:211], v[64:79]
  buffer_load_dwordx4 v[128:131], v8, s[4:7], s22 offen offset:0
  ds_read_b64_tr_b16 v[248:249], v12 offset:6144
  ds_read_b64_tr_b16 v[250:251], v12 offset:7168
  v_mfma_f32_32x32x16_bf16 v[80:95], v[228:231], v[208:211], v[80:95]
  ds_read_b64_tr_b16 v[252:253], v13 offset:6144
  ds_read_b64_tr_b16 v[254:255], v13 offset:7168
  v_lshl_add_u32 v10, s20, 1, v14
  v_lshl_add_u32 v11, s20, 1, v15
  s_waitcnt vmcnt(11) lgkmcnt(8)
  v_mfma_f32_32x32x16_bf16 v[64:79], v[232:235], v[212:215], v[64:79]
  buffer_load_dwordx4 v[132:135], v8, s[4:7], s22 offen offset:1024
  ds_read_b64_tr_b16 v[224:225], v10 offset:0
  ds_read_b64_tr_b16 v[226:227], v10 offset:1024
  v_mfma_f32_32x32x16_bf16 v[80:95], v[236:239], v[212:215], v[80:95]
  ds_read_b64_tr_b16 v[228:229], v11 offset:0
  ds_read_b64_tr_b16 v[230:231], v11 offset:1024
  s_waitcnt vmcnt(11) lgkmcnt(8)
  v_mfma_f32_32x32x16_bf16 v[64:79], v[240:243], v[216:219], v[64:79]
  buffer_load_dwordx4 v[136:139], v8, s[4:7], s22 offen offset:2048
  ds_read_b64_tr_b16 v[232:233], v10 offset:2048
  ds_read_b64_tr_b16 v[234:235], v10 offset:3072
  v_mfma_f32_32x32x16_bf16 v[80:95], v[244:247], v[216:219], v[80:95]
  ds_read_b64_tr_b16 v[236:237], v11 offset:2048
  ds_read_b64_tr_b16 v[238:239], v11 offset:3072
  s_cmp_eq_u32 s36, 0
  s_cbranch_scc1 .fz_kernel_pk61c
.fz_kernel_pk61:
  s_ff1_i32_b32 s33, s36
  s_waitcnt vmcnt(11) lgkmcnt(8)
  v_mfma_f32_32x32x16_bf16 v[64:79], v[248:251], v[220:223], v[64:79]
  buffer_load_dwordx4 v[140:143], v8, s[4:7], s22 offen offset:3072
  ds_read_b64_tr_b16 v[240:241], v10 offset:4096
  ds_read_b64_tr_b16 v[242:243], v10 offset:5120
  v_mfma_f32_32x32x16_bf16 v[80:95], v[252:255], v[220:223], v[80:95]
  ds_read_b64_tr_b16 v[244:245], v11 offset:4096
  ds_read_b64_tr_b16 v[246:247], v11 offset:5120
  s_bitset0_b32 s36, s33
  s_lshl_b32 s23, s33, 12
  s_waitcnt vmcnt(11) lgkmcnt(8)
  v_mfma_f32_32x32x16_bf16 v[64:79], v[224:227], v[96:99], v[64:79]
  buffer_load_dwordx4 v[144:147], v8, s[4:7], s23 offen offset:0
  ds_read_b64_tr_b16 v[248:249], v10 offset:6144
  ds_read_b64_tr_b16 v[250:251], v10 offset:7168
  v_mfma_f32_32x32x16_bf16 v[80:95], v[228:231], v[96:99], v[80:95]
  ds_read_b64_tr_b16 v[252:253], v11 offset:6144
  ds_read_b64_tr_b16 v[254:255], v11 offset:7168
  v_lshl_add_u32 v12, s21, 1, v14
  v_lshl_add_u32 v13, s21, 1, v15
  s_waitcnt vmcnt(11) lgkmcnt(8)
  v_mfma_f32_32x32x16_bf16 v[64:79], v[232:235], v[100:103], v[64:79]
  buffer_load_dwordx4 v[148:151], v8, s[4:7], s23 offen offset:1024
  ds_read_b64_tr_b16 v[224:225], v12 offset:0
  ds_read_b64_tr_b16 v[226:227], v12 offset:1024
  v_mfma_f32_32x32x16_bf16 v[80:95], v[236:239], v[100:103], v[80:95]
  ds_read_b64_tr_b16 v[228:229], v13 offset:0
  ds_read_b64_tr_b16 v[230:231], v13 offset:1024
  s_waitcnt vmcnt(11) lgkmcnt(8)
  v_mfma_f32_32x32x16_bf16 v[64:79], v[240:243], v[104:107], v[64:79]
  buffer_load_dwordx4 v[152:155], v8, s[4:7], s23 offen offset:2048
  ds_read_b64_tr_b16 v[232:233], v12 offset:2048
  ds_read_b64_tr_b16 v[234:235], v12 offset:3072
  v_mfma_f32_32x32x16_bf16 v[80:95], v[244:247], v[104:107], v[80:95]
  ds_read_b64_tr_b16 v[236:237], v13 offset:2048
  ds_read_b64_tr_b16 v[238:239], v13 offset:3072
  s_cmp_eq_u32 s36, 0
  s_cbranch_scc1 .fz_kernel_pk62c
.fz_kernel_pk62:
  s_ff1_i32_b32 s33, s36
  s_waitcnt vmcnt(11) lgkmcnt(8)
  v_mfma_f32_32x32x16_bf16 v[64:79], v[248:251], v[108:111], v[64:79]
  buffer_load_dwordx4 v[156:159], v8, s[4:7], s23 offen offset:3072
  ds_read_b64_tr_b16 v[240:241], v12 offset:4096
  ds_read_b64_tr_b16 v[242:243], v12 offset:5120
  v_mfma_f32_32x32x16_bf16 v[80:95], v[252:255], v[108:111], v[80:95]
  ds_read_b64_tr_b16 v[244:245], v13 offset:4096
  ds_read_b64_tr_b16 v[246:247], v13 offset:5120
  s_bitset0_b32 s36, s33
  s_lshl_b32 s24, s33, 12
  s_waitcnt vmcnt(11) lgkmcnt(8)
  v_mfma_f32_32x32x16_bf16 v[64:79], v[224:227], v[112:115], v[64:79]
  buffer_load_dwordx4 v[160:163], v8, s[4:7], s24 offen offset:0
  ds_read_b64_tr_b16 v[248:249], v12 offset:6144
  ds_read_b64_tr_b16 v[250:251], v12 offset:7168
  v_mfma_f32_32x32x16_bf16 v[80:95], v[228:231], v[112:115], v[80:95]
  ds_read_b64_tr_b16 v[252:253], v13 offset:6144
  ds_read_b64_tr_b16 v[254:255], v13 offset:7168
  v_lshl_add_u32 v10, s22, 1, v14
  v_lshl_add_u32 v11, s22, 1, v15
  s_waitcnt vmcnt(11) lgkmcnt(8)
  v_mfma_f32_32x32x16_bf16 v[64:79], v[232:235], v[116:119], v[64:79]
  buffer_load_dwordx4 v[164:167], v8, s[4:7], s24 offen offset:1024
  ds_read_b64_tr_b16 v[224:225], v10 offset:0
  ds_read_b64_tr_b16 v[226:227], v10 offset:1024
  v_mfma_f32_32x32x16_bf16 v[80:95], v[236:239], v[116:119], v[80:95]
  ds_read_b64_tr_b16 v[228:229], v11 offset:0
  ds_read_b64_tr_b16 v[230:231], v11 offset:1024
  s_waitcnt vmcnt(11) lgkmcnt(8)
  v_mfma_f32_32x32x16_bf16 v[64:79], v[240:243], v[120:123], v[64:79]
  buffer_load_dwordx4 v[168:171], v8, s[4:7], s24 offen offset:2048
  ds_read_b64_tr_b16 v[232:233], v10 offset:2048
  ds_read_b64_tr_b16 v[234:235], v10 offset:3072
  v_mfma_f32_32x32x16_bf16 v[80:95], v[244:247], v[120:123], v[80:95]
  ds_read_b64_tr_b16 v[236:237], v11 offset:2048
  ds_read_b64_tr_b16 v[238:239], v11 offset:3072
  s_cmp_eq_u32 s36, 0
  s_cbranch_scc1 .fz_kernel_pk63c
.fz_kernel_pk63:
  s_ff1_i32_b32 s33, s36
  s_waitcnt vmcnt(11) lgkmcnt(8)
  v_mfma_f32_32x32x16_bf16 v[64:79], v[248:251], v[124:127], v[64:79]
  buffer_load_dwordx4 v[172:175], v8, s[4:7], s24 offen offset:3072
  ds_read_b64_tr_b16 v[240:241], v10 offset:4096
  ds_read_b64_tr_b16 v[242:243], v10 offset:5120
  v_mfma_f32_32x32x16_bf16 v[80:95], v[252:255], v[124:127], v[80:95]
  ds_read_b64_tr_b16 v[244:245], v11 offset:4096
  ds_read_b64_tr_b16 v[246:247], v11 offset:5120
  s_bitset0_b32 s36, s33
  s_lshl_b32 s25, s33, 12
  s_waitcnt vmcnt(11) lgkmcnt(8)
  v_mfma_f32_32x32x16_bf16 v[64:79], v[224:227], v[128:131], v[64:79]
  buffer_load_dwordx4 v[176:179], v8, s[4:7], s25 offen offset:0
  ds_read_b64_tr_b16 v[248:249], v10 offset:6144
  ds_read_b64_tr_b16 v[250:251], v10 offset:7168
  v_mfma_f32_32x32x16_bf16 v[80:95], v[228:231], v[128:131], v[80:95]
  ds_read_b64_tr_b16 v[252:253], v11 offset:6144
  ds_read_b64_tr_b16 v[254:255], v11 offset:7168
  v_lshl_add_u32 v12, s23, 1, v14
  v_lshl_add_u32 v13, s23, 1, v15
  s_waitcnt vmcnt(11) lgkmcnt(8)
  v_mfma_f32_32x32x16_bf16 v[64:79], v[232:235], v[132:135], v[64:79]
  buffer_load_dwordx4 v[180:183], v8, s[4:7], s25 offen offset:1024
  ds_read_b64_tr_b16 v[224:225], v12 offset:0
  ds_read_b64_tr_b16 v[226:227], v12 offset:1024
  v_mfma_f32_32x32x16_bf16 v[80:95], v[236:239], v[132:135], v[80:95]
  ds_read_b64_tr_b16 v[228:229], v13 offset:0
  ds_read_b64_tr_b16 v[230:231], v13 offset:1024
  s_waitcnt vmcnt(11) lgkmcnt(8)
  v_mfma_f32_32x32x16_bf16 v[64:79], v[240:243], v[136:139], v[64:79]
  buffer_load_dwordx4 v[184:187], v8, s[4:7], s25 offen offset:2048
  ds_read_b64_tr_b16 v[232:233], v12 offset:2048
  ds_read_b64_tr_b16 v[234:235], v12 offset:3072
  v_mfma_f32_32x32x16_bf16 v[80:95], v[244:247], v[136:139], v[80:95]
  ds_read_b64_tr_b16 v[236:237], v13 offset:2048
  ds_read_b64_tr_b16 v[238:239], v13 offset:3072
  s_cmp_eq_u32 s36, 0
  s_cbranch_scc1 .fz_kernel_pk64c
.fz_kernel_pk64:
  s_ff1_i32_b32 s33, s36
  s_waitcnt vmcnt(11) lgkmcnt(8)
  v_mfma_f32_32x32x16_bf16 v[64:79], v[248:251], v[140:143], v[64:79]
  buffer_load_dwordx4 v[188:191], v8, s[4:7], s25 offen offset:3072
  ds_read_b64_tr_b16 v[240:241], v12 offset:4096
  ds_read_b64_tr_b16 v[242:243], v12 offset:5120
  v_mfma_f32_32x32x16_bf16 v[80:95], v[252:255], v[140:143], v[80:95]
  ds_read_b64_tr_b16 v[244:245], v13 offset:4096
  ds_read_b64_tr_b16 v[246:247], v13 offset:5120
  s_bitset0_b32 s36, s33
  s_lshl_b32 s26, s33, 12
  s_waitcnt vmcnt(11) lgkmcnt(8)
  v_mfma_f32_32x32x16_bf16 v[64:79], v[224:227], v[144:147], v[64:79]
  buffer_load_dwordx4 v[192:195], v8, s[4:7], s26 offen offset:0
  ds_read_b64_tr_b16 v[248:249], v12 offset:6144
  ds_read_b64_tr_b16 v[250:251], v12 offset:7168
  v_mfma_f32_32x32x16_bf16 v[80:95], v[228:231], v[144:147], v[80:95]
  ds_read_b64_tr_b16 v[252:253], v13 offset:6144
  ds_read_b64_tr_b16 v[254:255], v13 offset:7168
  v_lshl_add_u32 v10, s24, 1, v14
  v_lshl_add_u32 v11, s24, 1, v15
  s_waitcnt vmcnt(11) lgkmcnt(8)
  v_mfma_f32_32x32x16_bf16 v[64:79], v[232:235], v[148:151], v[64:79]
  buffer_load_dwordx4 v[196:199], v8, s[4:7], s26 offen offset:1024
  ds_read_b64_tr_b16 v[224:225], v10 offset:0
  ds_read_b64_tr_b16 v[226:227], v10 offset:1024
  v_mfma_f32_32x32x16_bf16 v[80:95], v[236:239], v[148:151], v[80:95]
  ds_read_b64_tr_b16 v[228:229], v11 offset:0
  ds_read_b64_tr_b16 v[230:231], v11 offset:1024
  s_waitcnt vmcnt(11) lgkmcnt(8)
  v_mfma_f32_32x32x16_bf16 v[64:79], v[240:243], v[152:155], v[64:79]
  buffer_load_dwordx4 v[200:203], v8, s[4:7], s26 offen offset:2048
  ds_read_b64_tr_b16 v[232:233], v10 offset:2048
  ds_read_b64_tr_b16 v[234:235], v10 offset:3072
  v_mfma_f32_32x32x16_bf16 v[80:95], v[244:247], v[152:155], v[80:95]
  ds_read_b64_tr_b16 v[236:237], v11 offset:2048
  ds_read_b64_tr_b16 v[238:239], v11 offset:3072
  s_cmp_eq_u32 s36, 0
  s_cbranch_scc1 .fz_kernel_pk65c
.fz_kernel_pk65:
  s_ff1_i32_b32 s33, s36
  s_waitcnt vmcnt(11) lgkmcnt(8)
  v_mfma_f32_32x32x16_bf16 v[64:79], v[248:251], v[156:159], v[64:79]
  buffer_load_dwordx4 v[204:207], v8, s[4:7], s26 offen offset:3072
  ds_read_b64_tr_b16 v[240:241], v10 offset:4096
  ds_read_b64_tr_b16 v[242:243], v10 offset:5120
  v_mfma_f32_32x32x16_bf16 v[80:95], v[252:255], v[156:159], v[80:95]
  ds_read_b64_tr_b16 v[244:245], v11 offset:4096
  ds_read_b64_tr_b16 v[246:247], v11 offset:5120
  s_bitset0_b32 s36, s33
  s_lshl_b32 s27, s33, 12
  s_waitcnt vmcnt(11) lgkmcnt(8)
  v_mfma_f32_32x32x16_bf16 v[64:79], v[224:227], v[160:163], v[64:79]
  buffer_load_dwordx4 v[208:211], v8, s[4:7], s27 offen offset:0
  ds_read_b64_tr_b16 v[248:249], v10 offset:6144
  ds_read_b64_tr_b16 v[250:251], v10 offset:7168
  v_mfma_f32_32x32x16_bf16 v[80:95], v[228:231], v[160:163], v[80:95]
  ds_read_b64_tr_b16 v[252:253], v11 offset:6144
  ds_read_b64_tr_b16 v[254:255], v11 offset:7168
  v_lshl_add_u32 v12, s25, 1, v14
  v_lshl_add_u32 v13, s25, 1, v15
  s_waitcnt vmcnt(11) lgkmcnt(8)
  v_mfma_f32_32x32x16_bf16 v[64:79], v[232:235], v[164:167], v[64:79]
  buffer_load_dwordx4 v[212:215], v8, s[4:7], s27 offen offset:1024
  ds_read_b64_tr_b16 v[224:225], v12 offset:0
  ds_read_b64_tr_b16 v[226:227], v12 offset:1024
  v_mfma_f32_32x32x16_bf16 v[80:95], v[236:239], v[164:167], v[80:95]
  ds_read_b64_tr_b16 v[228:229], v13 offset:0
  ds_read_b64_tr_b16 v[230:231], v13 offset:1024
  s_waitcnt vmcnt(11) lgkmcnt(8)
  v_mfma_f32_32x32x16_bf16 v[64:79], v[240:243], v[168:171], v[64:79]
  buffer_load_dwordx4 v[216:219], v8, s[4:7], s27 offen offset:2048
  ds_read_b64_tr_b16 v[232:233], v12 offset:2048
  ds_read_b64_tr_b16 v[234:235], v12 offset:3072
  v_mfma_f32_32x32x16_bf16 v[80:95], v[244:247], v[168:171], v[80:95]
  ds_read_b64_tr_b16 v[236:237], v13 offset:2048
  ds_read_b64_tr_b16 v[238:239], v13 offset:3072
  s_waitcnt vmcnt(11) lgkmcnt(8)
  v_mfma_f32_32x32x16_bf16 v[64:79], v[248:251], v[172:175], v[64:79]
  buffer_load_dwordx4 v[220:223], v8, s[4:7], s27 offen offset:3072
  ds_read_b64_tr_b16 v[240:241], v12 offset:4096
  ds_read_b64_tr_b16 v[242:243], v12 offset:5120
  v_mfma_f32_32x32x16_bf16 v[80:95], v[252:255], v[172:175], v[80:95]
  ds_read_b64_tr_b16 v[244:245], v13 offset:4096
  ds_read_b64_tr_b16 v[246:247], v13 offset:5120
  s_waitcnt vmcnt(11) lgkmcnt(8)
  v_mfma_f32_32x32x16_bf16 v[64:79], v[224:227], v[176:179], v[64:79]
  ds_read_b64_tr_b16 v[248:249], v12 offset:6144
  ds_read_b64_tr_b16 v[250:251], v12 offset:7168
  s_mov_b32 s36, 0x3f803f80
  v_mov_b32 v36, 0
  v_mov_b32 v37, 0
  v_mfma_f32_32x32x16_bf16 v[80:95], v[228:231], v[176:179], v[80:95]
  ds_read_b64_tr_b16 v[252:253], v13 offset:6144
  ds_read_b64_tr_b16 v[254:255], v13 offset:7168
  v_lshl_add_u32 v10, s26, 1, v14
  v_lshl_add_u32 v11, s26, 1, v15
  v_mov_b32 v38, 0
  v_mov_b32 v39, 0
  v_mov_b32 v41, 0
  s_waitcnt vmcnt(10) lgkmcnt(8)
  v_mfma_f32_32x32x16_bf16 v[64:79], v[232:235], v[180:183], v[64:79]
  ds_read_b64_tr_b16 v[224:225], v10 offset:0
  ds_read_b64_tr_b16 v[226:227], v10 offset:1024
  v_mov_b32 v43, 0
  v_lshlrev_b32 v19, 2, v18
  v_mfma_f32_32x32x16_bf16 v[80:95], v[236:239], v[180:183], v[80:95]
  ds_read_b64_tr_b16 v[228:229], v11 offset:0
  ds_read_b64_tr_b16 v[230:231], v11 offset:1024
  v_lshl_add_u32 v19, v17, 13, v19
  s_lshl_b32 s34, s32, 7
  s_add_u32 s34, s34, s66
  s_waitcnt vmcnt(9) lgkmcnt(8)
  v_mfma_f32_32x32x16_bf16 v[64:79], v[240:243], v[184:187], v[64:79]
  ds_read_b64_tr_b16 v[232:233], v10 offset:2048
  ds_read_b64_tr_b16 v[234:235], v10 offset:3072
  s_add_u32 s34, s34, 16384
  s_add_u32 s37, s34, 16384
  v_mfma_f32_32x32x16_bf16 v[80:95], v[244:247], v[184:187], v[80:95]
  ds_read_b64_tr_b16 v[236:237], v11 offset:2048
  ds_read_b64_tr_b16 v[238:239], v11 offset:3072
  s_waitcnt vmcnt(8) lgkmcnt(8)
  v_mfma_f32_32x32x16_bf16 v[64:79], v[248:251], v[188:191], v[64:79]
  ds_read_b64_tr_b16 v[240:241], v10 offset:4096
  ds_read_b64_tr_b16 v[242:243], v10 offset:5120
  v_mfma_f32_32x32x16_bf16 v[80:95], v[252:255], v[188:191], v[80:95]
  ds_read_b64_tr_b16 v[244:245], v11 offset:4096
  ds_read_b64_tr_b16 v[246:247], v11 offset:5120
  s_waitcnt vmcnt(7) lgkmcnt(8)
  v_mfma_f32_32x32x16_bf16 v[64:79], v[224:227], v[192:195], v[64:79]
  ds_read_b64_tr_b16 v[248:249], v10 offset:6144
  ds_read_b64_tr_b16 v[250:251], v10 offset:7168
  v_mfma_f32_32x32x16_bf16 v[80:95], v[228:231], v[192:195], v[80:95]
  ds_read_b64_tr_b16 v[252:253], v11 offset:6144
  ds_read_b64_tr_b16 v[254:255], v11 offset:7168
  v_lshl_add_u32 v12, s27, 1, v14
  v_lshl_add_u32 v13, s27, 1, v15
  s_waitcnt vmcnt(6) lgkmcnt(8)
  v_mfma_f32_32x32x16_bf16 v[64:79], v[232:235], v[196:199], v[64:79]
  ds_read_b64_tr_b16 v[224:225], v12 offset:0
  ds_read_b64_tr_b16 v[226:227], v12 offset:1024
  v_mfma_f32_32x32x16_bf16 v[80:95], v[236:239], v[196:199], v[80:95]
  ds_read_b64_tr_b16 v[228:229], v13 offset:0
  ds_read_b64_tr_b16 v[230:231], v13 offset:1024
  s_waitcnt vmcnt(5) lgkmcnt(8)
  v_mfma_f32_32x32x16_bf16 v[64:79], v[240:243], v[200:203], v[64:79]
  ds_read_b64_tr_b16 v[232:233], v12 offset:2048
  ds_read_b64_tr_b16 v[234:235], v12 offset:3072
  v_mfma_f32_32x32x16_bf16 v[80:95], v[244:247], v[200:203], v[80:95]
  ds_read_b64_tr_b16 v[236:237], v13 offset:2048
  ds_read_b64_tr_b16 v[238:239], v13 offset:3072
  s_waitcnt vmcnt(4) lgkmcnt(8)
  v_mfma_f32_32x32x16_bf16 v[64:79], v[248:251], v[204:207], v[64:79]
  ds_read_b64_tr_b16 v[240:241], v12 offset:4096
  ds_read_b64_tr_b16 v[242:243], v12 offset:5120
  v_mfma_f32_32x32x16_bf16 v[80:95], v[252:255], v[204:207], v[80:95]
  ds_read_b64_tr_b16 v[244:245], v13 offset:4096
  ds_read_b64_tr_b16 v[246:247], v13 offset:5120
  s_waitcnt vmcnt(3) lgkmcnt(8)
  v_mfma_f32_32x32x16_bf16 v[64:79], v[224:227], v[208:211], v[64:79]
  ds_read_b64_tr_b16 v[248:249], v12 offset:6144
  ds_read_b64_tr_b16 v[250:251], v12 offset:7168
  v_mfma_f32_32x32x16_bf16 v[80:95], v[228:231], v[208:211], v[80:95]
  ds_read_b64_tr_b16 v[252:253], v13 offset:6144
  ds_read_b64_tr_b16 v[254:255], v13 offset:7168
  s_waitcnt vmcnt(2) lgkmcnt(8)
  v_mfma_f32_32x32x16_bf16 v[64:79], v[232:235], v[212:215], v[64:79]
  v_mfma_f32_32x32x16_bf16 v[80:95], v[236:239], v[212:215], v[80:95]
  s_waitcnt vmcnt(1) lgkmcnt(4)
  v_mfma_f32_32x32x16_bf16 v[64:79], v[240:243], v[216:219], v[64:79]
  v_mfma_f32_32x32x16_bf16 v[80:95], v[244:247], v[216:219], v[80:95]
  s_waitcnt vmcnt(0) lgkmcnt(0)
  v_mfma_f32_32x32x16_bf16 v[64:79], v[248:251], v[220:223], v[64:79]
  v_mfma_f32_32x32x16_bf16 v[80:95], v[252:255], v[220:223], v[80:95]
  s_nop 10
  v_cvt_pk_bf16_f32 v20, v64, v65
  v_cvt_pk_bf16_f32 v21, v66, v67
  v_cvt_pk_bf16_f32 v22, v68, v69
  v_cvt_pk_bf16_f32 v23, v70, v71
  buffer_store_dwordx4 v[20:23], v16, s[4:7], s39 offen offset:0 sc1
  v_cvt_pk_bf16_f32 v24, v72, v73
  v_cvt_pk_bf16_f32 v25, v74, v75
  v_cvt_pk_bf16_f32 v26, v76, v77
  v_cvt_pk_bf16_f32 v27, v78, v79
  buffer_store_dwordx4 v[24:27], v16, s[4:7], s39 offen offset:512 sc1
  v_cvt_pk_bf16_f32 v28, v80, v81
  v_cvt_pk_bf16_f32 v29, v82, v83
  v_cvt_pk_bf16_f32 v30, v84, v85
  v_cvt_pk_bf16_f32 v31, v86, v87
  buffer_store_dwordx4 v[28:31], v16, s[4:7], s39 offen offset:1024 sc1
  v_cvt_pk_bf16_f32 v32, v88, v89
  v_cvt_pk_bf16_f32 v33, v90, v91
  v_cvt_pk_bf16_f32 v34, v92, v93
  v_cvt_pk_bf16_f32 v35, v94, v95
  buffer_store_dwordx4 v[32:35], v16, s[4:7], s39 offen offset:1536 sc1
  v_dot2c_f32_bf16 v36, s36, v20
  v_dot2c_f32_bf16 v37, v20, v20
  v_dot2c_f32_bf16 v38, v20, v48
  v_dot2c_f32_bf16 v39, s36, v21
  v_dot2c_f32_bf16 v41, v21, v21
  v_dot2c_f32_bf16 v43, v21, v49
  v_dot2c_f32_bf16 v36, s36, v22
  v_dot2c_f32_bf16 v37, v22, v22
  v_dot2c_f32_bf16 v38, v22, v50
  v_dot2c_f32_bf16 v39, s36, v23
  v_dot2c_f32_bf16 v41, v23, v23
  v_dot2c_f32_bf16 v43, v23, v51
  v_dot2c_f32_bf16 v36, s36, v24
  v_dot2c_f32_bf16 v37, v24, v24
  v_dot2c_f32_bf16 v38, v24, v52
  v_dot2c_f32_bf16 v39, s36, v25
  v_dot2c_f32_bf16 v41, v25, v25
  v_dot2c_f32_bf16 v43, v25, v53
  v_dot2c_f32_bf16 v36, s36, v26
  v_dot2c_f32_bf16 v37, v26, v26
  v_dot2c_f32_bf16 v38, v26, v54
  v_dot2c_f32_bf16 v39, s36, v27
  v_dot2c_f32_bf16 v41, v27, v27
  v_dot2c_f32_bf16 v43, v27, v55
  v_dot2c_f32_bf16 v36, s36, v28
  v_dot2c_f32_bf16 v37, v28, v28
  v_dot2c_f32_bf16 v38, v28, v56
  v_dot2c_f32_bf16 v39, s36, v29
  v_dot2c_f32_bf16 v41, v29, v29
  v_dot2c_f32_bf16 v43, v29, v57
  v_dot2c_f32_bf16 v36, s36, v30
  v_dot2c_f32_bf16 v37, v30, v30
  v_dot2c_f32_bf16 v38, v30, v58
  v_dot2c_f32_bf16 v39, s36, v31
  v_dot2c_f32_bf16 v41, v31, v31
  v_dot2c_f32_bf16 v43, v31, v59
  v_dot2c_f32_bf16 v36, s36, v32
  v_dot2c_f32_bf16 v37, v32, v32
  v_dot2c_f32_bf16 v38, v32, v60
  v_dot2c_f32_bf16 v39, s36, v33
  v_dot2c_f32_bf16 v41, v33, v33
  v_dot2c_f32_bf16 v43, v33, v61
  v_dot2c_f32_bf16 v36, s36, v34
  v_dot2c_f32_bf16 v37, v34, v34
  v_dot2c_f32_bf16 v38, v34, v62
  v_dot2c_f32_bf16 v39, s36, v35
  v_dot2c_f32_bf16 v41, v35, v35
  v_dot2c_f32_bf16 v43, v35, v63
  s_nop 0
  v_add_f32 v36, v36, v39
  v_add_f32 v37, v37, v41
  v_add_f32 v38, v38, v43
  v_fma_f32 v38, -v36, v46, v38
  v_fmac_f32 v47, 0x44800000, v37
  v_mov_b32 v39, v38
  s_nop 0
  v_permlane32_swap_b32 v36, v47
  v_permlane32_swap_b32 v38, v39
  v_add_f32 v36, v36, v47
  v_add_f32 v38, v38, v39
  buffer_atomic_add_f32 v36, v19, s[4:7], s34 offen sc1
  s_mov_b32 exec_hi, 0
  buffer_atomic_add_f32 v38, v19, s[4:7], s37 offen sc1
  s_mov_b64 exec, -1
  s_barrier
  v_add_u32 v1, 4, v6
  s_mov_b32 s72, s66
  s_mov_b32 s73, s65
  s_mov_b32 s74, s67
  s_mov_b32 s75, s62
  s_cmp_lg_u32 s62, 0
  s_cbranch_scc1 .fz_kernel_tail
  s_mov_b32 s62, 1
  s_mov_b32 s63, 0x2000000
  s_mov_b32 s64, 0x2800000
  s_mov_b32 s65, 0x1400000
  s_mov_b32 s66, 0x1c42000
  s_mov_b32 s67, 12
  s_mov_b32 s71, 159776
  v_mov_b32 v6, 159832
  s_branch .fz_kernel_q_cons2
.fz_kernel_tail:
  s_mov_b32 s28, s56
  s_mov_b32 s29, s57
  s_mov_b32 s30, 0x400000
  s_mov_b32 s31, 0x00020000
  v_lshlrev_b32 v37, 2, v45
  v_add_u32 v37, 155644, v37
  v_mov_b32 v36, 159952
  v_lshlrev_b32 v38, 11, v18
  v_lshl_add_u32 v38, v17, 4, v38
  s_lshl_b32 s32, s32, 16
  s_lshl_b32 s33, s18, 7
  s_add_u32 s32, s32, s33
  v_lshlrev_b32 v64, 16, v20
  v_and_b32 v65, 0xffff0000, v20
  v_lshlrev_b32 v66, 16, v21
  v_and_b32 v67, 0xffff0000, v21
  v_lshlrev_b32 v68, 16, v22
  v_and_b32 v69, 0xffff0000, v22
  v_lshlrev_b32 v70, 16, v23
  v_and_b32 v71, 0xffff0000, v23
  v_lshlrev_b32 v72, 16, v24
  v_and_b32 v73, 0xffff0000, v24
  v_lshlrev_b32 v74, 16, v25
  v_and_b32 v75, 0xffff0000, v25
  v_lshlrev_b32 v76, 16, v26
  v_and_b32 v77, 0xffff0000, v26
  v_lshlrev_b32 v78, 16, v27
  v_and_b32 v79, 0xffff0000, v27
  v_lshlrev_b32 v80, 16, v28
  v_and_b32 v81, 0xffff0000, v28
  v_lshlrev_b32 v82, 16, v29
  v_and_b32 v83, 0xffff0000, v29
  v_lshlrev_b32 v84, 16, v30
  v_and_b32 v85, 0xffff0000, v30
  v_lshlrev_b32 v86, 16, v31
  v_and_b32 v87, 0xffff0000, v31
  v_lshlrev_b32 v88, 16, v32
  v_and_b32 v89, 0xffff0000, v32
  v_lshlrev_b32 v90, 16, v33
  v_and_b32 v91, 0xffff0000, v33
  v_lshlrev_b32 v92, 16, v34
  v_and_b32 v93, 0xffff0000, v34
  v_lshlrev_b32 v94, 16, v35
  v_and_b32 v95, 0xffff0000, v35
  s_mov_b64 exec, 1
  s_waitcnt vmcnt(0)
  ds_add_u32 v1, v5 offset:0x100
  s_mov_b64 exec, -1
  s_barrier
  ds_read_b32 v40, v37 offset:6400
  ds_read_b32 v42, v37 offset:6912
  ds_read_b32 v36, v36
  s_waitcnt lgkmcnt(0)
  v_cmp_ne_u32 vcc, v36, v45
  s_mov_b64 exec, vcc
  v_pk_fma_f32 v[64:65], v[64:65], v[40:41], v[42:43] op_sel_hi:[1,0,0]
  v_pk_fma_f32 v[66:67], v[66:67], v[40:41], v[42:43] op_sel_hi:[1,0,0]
  v_pk_fma_f32 v[68:69], v[68:69], v[40:41], v[42:43] op_sel_hi:[1,0,0]
  v_pk_fma_f32 v[70:71], v[70:71], v[40:41], v[42:43] op_sel_hi:[1,0,0]
  v_cvt_pk_bf16_f32 v20, v64, v65
  v_cvt_pk_bf16_f32 v21, v66, v67
  v_cvt_pk_bf16_f32 v22, v68, v69
  v_cvt_pk_bf16_f32 v23, v70, v71
  buffer_store_dwordx4 v[20:23], v38, s[28:31], s32 offen offset:0
  v_pk_fma_f32 v[72:73], v[72:73], v[40:41], v[42:43] op_sel_hi:[1,0,0]
  v_pk_fma_f32 v[74:75], v[74:75], v[40:41], v[42:43] op_sel_hi:[1,0,0]
  v_pk_fma_f32 v[76:77], v[76:77], v[40:41], v[42:43] op_sel_hi:[1,0,0]
  v_pk_fma_f32 v[78:79], v[78:79], v[40:41], v[42:43] op_sel_hi:[1,0,0]
  v_cvt_pk_bf16_f32 v24, v72, v73
  v_cvt_pk_bf16_f32 v25, v74, v75
  v_cvt_pk_bf16_f32 v26, v76, v77
  v_cvt_pk_bf16_f32 v27, v78, v79
  buffer_store_dwordx4 v[24:27], v38, s[28:31], s32 offen offset:32
  v_pk_fma_f32 v[80:81], v[80:81], v[40:41], v[42:43] op_sel_hi:[1,0,0]
  v_pk_fma_f32 v[82:83], v[82:83], v[40:41], v[42:43] op_sel_hi:[1,0,0]
  v_pk_fma_f32 v[84:85], v[84:85], v[40:41], v[42:43] op_sel_hi:[1,0,0]
  v_pk_fma_f32 v[86:87], v[86:87], v[40:41], v[42:43] op_sel_hi:[1,0,0]
  v_cvt_pk_bf16_f32 v28, v80, v81
  v_cvt_pk_bf16_f32 v29, v82, v83
  v_cvt_pk_bf16_f32 v30, v84, v85
  v_cvt_pk_bf16_f32 v31, v86, v87
  buffer_store_dwordx4 v[28:31], v38, s[28:31], s32 offen offset:64
  v_pk_fma_f32 v[88:89], v[88:89], v[40:41], v[42:43] op_sel_hi:[1,0,0]
  v_pk_fma_f32 v[90:91], v[90:91], v[40:41], v[42:43] op_sel_hi:[1,0,0]
  v_pk_fma_f32 v[92:93], v[92:93], v[40:41], v[42:43] op_sel_hi:[1,0,0]
  v_pk_fma_f32 v[94:95], v[94:95], v[40:41], v[42:43] op_sel_hi:[1,0,0]
  v_cvt_pk_bf16_f32 v32, v88, v89
  v_cvt_pk_bf16_f32 v33, v90, v91
  v_cvt_pk_bf16_f32 v34, v92, v93
  v_cvt_pk_bf16_f32 v35, v94, v95
  buffer_store_dwordx4 v[32:35], v38, s[28:31], s32 offen offset:96
  s_mov_b64 exec, -1
  s_branch .fz_kernel_fin
.fz_kernel_chain:
  s_setprio 0
  s_bitcmp1_b32 s18, 0
  s_cselect_b32 s8, s52, s50
  s_cselect_b32 s9, s53, s51
  s_mov_b32 s10, 0x700000
  s_mov_b32 s11, 0x00020000
  s_lshl_b32 s12, s16, 8
  s_and_b32 s12, s12, 511
  s_and_b32 s31, s18, 2
  s_lshl_b32 s31, s31, 8
  s_add_u32 s12, s12, s31
  s_mul_i32 s12, s12, 7168
  s_lshl_b32 s31, s17, 2
  s_lshr_b32 s33, s18, 2
  s_add_u32 s31, s31, s33
  s_lshl_b32 s31, s31, 7
  s_add_u32 s12, s12, s31
  v_lshrrev_b32 v13, 3, v2
  v_mul_u32_u24 v13, 229376, v13
  v_and_b32 v11, 7, v2
  v_lshl_add_u32 v13, v11, 4, v13
  s_mov_b32 s36, 0x05040100
  s_mov_b32 s37, 0x07060302
  v_lshrrev_b32 v13, 4, v2
  v_bfe_u32 v14, v2, 3, 1
  v_lshl_add_u32 v13, v14, 2, v13
  v_mul_u32_u24 v13, 28672, v13
  v_lshl_add_u32 v13, v11, 4, v13
  s_cmp_ge_u32 s17, 14
  s_cbranch_scc1 .fz_kernel_c_nl
  s_mov_b32 s38, 0
.fz_kernel_kw66:
  s_sleep 2
  ds_read_b32 v7, v6 offset:0
  s_add_u32 s38, s38, 1
  s_waitcnt lgkmcnt(0)
  v_readfirstlane_b32 s31, v7
  s_bcnt1_i32_b32 s31, s31
  s_cmp_ge_u32 s31, 16
  s_cbranch_scc1 .fz_kernel_kw66d
  s_cmp_lt_u32 s38, 1048576
  s_cbranch_scc1 .fz_kernel_kw66
.fz_kernel_kw66d:
  buffer_load_dwordx4 v[144:147], v13, s[8:11], s12 offen nt
  s_add_u32 s12, s12, 7168
  s_waitcnt vmcnt(1)
  buffer_load_dwordx4 v[148:151], v13, s[8:11], s12 offen nt
  s_add_u32 s12, s12, 7168
  s_waitcnt vmcnt(1)
  buffer_load_dwordx4 v[152:155], v13, s[8:11], s12 offen nt
  s_add_u32 s12, s12, 7168
  s_waitcnt vmcnt(1)
  buffer_load_dwordx4 v[156:159], v13, s[8:11], s12 offen nt
  s_add_u32 s12, s12, 207872
  s_waitcnt vmcnt(1)
  buffer_load_dwordx4 v[160:163], v13, s[8:11], s12 offen nt
  s_add_u32 s12, s12, 7168
  s_waitcnt vmcnt(1)
  buffer_load_dwordx4 v[164:167], v13, s[8:11], s12 offen nt
  s_add_u32 s12, s12, 7168
  s_waitcnt vmcnt(1)
  buffer_load_dwordx4 v[168:171], v13, s[8:11], s12 offen nt
  s_add_u32 s12, s12, 7168
  s_waitcnt vmcnt(1)
  buffer_load_dwordx4 v[172:175], v13, s[8:11], s12 offen nt
  s_add_u32 s12, s12, 207872
  s_waitcnt vmcnt(1)
  buffer_load_dwordx4 v[176:179], v13, s[8:11], s12 offen nt
  s_add_u32 s12, s12, 7168
  s_waitcnt vmcnt(1)
  buffer_load_dwordx4 v[180:183], v13, s[8:11], s12 offen nt
  s_add_u32 s12, s12, 7168
  s_waitcnt vmcnt(1)
  buffer_load_dwordx4 v[184:187], v13, s[8:11], s12 offen nt
  s_add_u32 s12, s12, 7168
  s_waitcnt vmcnt(1)
  buffer_load_dwordx4 v[188:191], v13, s[8:11], s12 offen nt
  s_add_u32 s12, s12, 207872
  s_waitcnt vmcnt(1)
  buffer_load_dwordx4 v[192:195], v13, s[8:11], s12 offen nt
  s_add_u32 s12, s12, 7168
  s_waitcnt vmcnt(1)
  buffer_load_dwordx4 v[196:199], v13, s[8:11], s12 offen nt
  s_add_u32 s12, s12, 7168
  s_waitcnt vmcnt(1)
  buffer_load_dwordx4 v[200:203], v13, s[8:11], s12 offen nt
  s_add_u32 s12, s12, 7168
  s_waitcnt vmcnt(1)
  buffer_load_dwordx4 v[204:207], v13, s[8:11], s12 offen nt
  s_add_u32 s12, s12, 207872
  s_waitcnt vmcnt(1)
  buffer_load_dwordx4 v[208:211], v13, s[8:11], s12 offen nt
  s_add_u32 s12, s12, 7168
  s_waitcnt vmcnt(1)
  buffer_load_dwordx4 v[212:215], v13, s[8:11], s12 offen nt
  s_add_u32 s12, s12, 7168
  s_waitcnt vmcnt(1)
  buffer_load_dwordx4 v[216:219], v13, s[8:11], s12 offen nt
  s_add_u32 s12, s12, 7168
  s_waitcnt vmcnt(1)
  buffer_load_dwordx4 v[220:223], v13, s[8:11], s12 offen nt
  s_add_u32 s12, s12, 207872
  s_waitcnt vmcnt(1)
  buffer_load_dwordx4 v[224:227], v13, s[8:11], s12 offen nt
  s_add_u32 s12, s12, 7168
  s_waitcnt vmcnt(1)
  buffer_load_dwordx4 v[228:231], v13, s[8:11], s12 offen nt
  s_add_u32 s12, s12, 7168
  s_waitcnt vmcnt(1)
  buffer_load_dwordx4 v[232:235], v13, s[8:11], s12 offen nt
  s_add_u32 s12, s12, 7168
  s_waitcnt vmcnt(1)
  buffer_load_dwordx4 v[236:239], v13, s[8:11], s12 offen nt
  s_add_u32 s12, s12, 207872
  s_waitcnt vmcnt(1)
  buffer_load_dwordx4 v[240:243], v13, s[8:11], s12 offen nt
  s_add_u32 s12, s12, 7168
  s_waitcnt vmcnt(1)
  buffer_load_dwordx4 v[244:247], v13, s[8:11], s12 offen nt
  s_add_u32 s12, s12, 7168
  s_waitcnt vmcnt(1)
  buffer_load_dwordx4 v[248:251], v13, s[8:11], s12 offen nt
  s_add_u32 s12, s12, 7168
  s_waitcnt vmcnt(1)
  buffer_load_dwordx4 v[252:255], v13, s[8:11], s12 offen nt
  s_add_u32 s12, s12, 207872
  s_waitcnt vmcnt(1)
  buffer_load_dwordx4 v[32:35], v13, s[8:11], s12 offen nt
  s_add_u32 s12, s12, 7168
  s_waitcnt vmcnt(1)
  buffer_load_dwordx4 v[36:39], v13, s[8:11], s12 offen nt
  s_add_u32 s12, s12, 7168
  s_waitcnt vmcnt(1)
  buffer_load_dwordx4 v[40:43], v13, s[8:11], s12 offen nt
  s_add_u32 s12, s12, 7168
  s_waitcnt vmcnt(1)
  buffer_load_dwordx4 v[44:47], v13, s[8:11], s12 offen nt
  s_add_u32 s12, s12, 207872
  s_waitcnt vmcnt(1)
  v_mov_b32 v16, 0x3f803f80
  v_mov_b32 v17, 0x3f803f80
  v_mov_b32 v18, 0x3f803f80
  v_mov_b32 v19, 0x3f803f80
  v_and_b32 v20, 2, v2
  v_mul_u32_u24 v20, 0x5555, v20
  v_add_u32 v20, 0x4444, v20
  s_waitcnt vmcnt(0)
  s_barrier
  v_perm_b32 v80, v148, v144, s36
  v_perm_b32 v88, v148, v144, s37
  v_perm_b32 v96, v149, v145, s36
  v_perm_b32 v104, v149, v145, s37
  v_perm_b32 v112, v150, v146, s36
  v_perm_b32 v120, v150, v146, s37
  v_perm_b32 v128, v151, v147, s36
  v_perm_b32 v136, v151, v147, s37
  v_perm_b32 v81, v164, v160, s36
  v_perm_b32 v89, v164, v160, s37
  v_perm_b32 v97, v165, v161, s36
  v_perm_b32 v105, v165, v161, s37
  v_perm_b32 v113, v166, v162, s36
  v_perm_b32 v121, v166, v162, s37
  v_perm_b32 v129, v167, v163, s36
  v_perm_b32 v137, v167, v163, s37
  v_perm_b32 v82, v156, v152, s36
  v_perm_b32 v90, v156, v152, s37
  v_perm_b32 v98, v157, v153, s36
  v_perm_b32 v106, v157, v153, s37
  v_perm_b32 v114, v158, v154, s36
  v_perm_b32 v122, v158, v154, s37
  v_perm_b32 v130, v159, v155, s36
  v_perm_b32 v138, v159, v155, s37
  v_perm_b32 v83, v172, v168, s36
  v_perm_b32 v91, v172, v168, s37
  v_perm_b32 v99, v173, v169, s36
  v_perm_b32 v107, v173, v169, s37
  v_perm_b32 v115, v174, v170, s36
  v_perm_b32 v123, v174, v170, s37
  v_perm_b32 v131, v175, v171, s36
  v_perm_b32 v139, v175, v171, s37
  v_perm_b32 v84, v180, v176, s36
  v_perm_b32 v92, v180, v176, s37
  v_perm_b32 v100, v181, v177, s36
  v_perm_b32 v108, v181, v177, s37
  v_perm_b32 v116, v182, v178, s36
  v_perm_b32 v124, v182, v178, s37
  v_perm_b32 v132, v183, v179, s36
  v_perm_b32 v140, v183, v179, s37
  v_perm_b32 v85, v196, v192, s36
  v_perm_b32 v93, v196, v192, s37
  v_perm_b32 v101, v197, v193, s36
  v_perm_b32 v109, v197, v193, s37
  v_perm_b32 v117, v198, v194, s36
  v_perm_b32 v125, v198, v194, s37
  v_perm_b32 v133, v199, v195, s36
  v_perm_b32 v141, v199, v195, s37
  v_perm_b32 v86, v188, v184, s36
  v_perm_b32 v94, v188, v184, s37
  v_perm_b32 v102, v189, v185, s36
  v_perm_b32 v110, v189, v185, s37
  v_perm_b32 v118, v190, v186, s36
  v_perm_b32 v126, v190, v186, s37
  v_perm_b32 v134, v191, v187, s36
  v_perm_b32 v142, v191, v187, s37
  v_perm_b32 v87, v204, v200, s36
  v_perm_b32 v95, v204, v200, s37
  v_perm_b32 v103, v205, v201, s36
  v_perm_b32 v111, v205, v201, s37
  v_perm_b32 v119, v206, v202, s36
  v_perm_b32 v127, v206, v202, s37
  v_perm_b32 v135, v207, v203, s36
  v_perm_b32 v143, v207, v203, s37
  v_perm_b32 v144, v212, v208, s36
  v_perm_b32 v152, v212, v208, s37
  v_perm_b32 v160, v213, v209, s36
  v_perm_b32 v168, v213, v209, s37
  v_perm_b32 v176, v214, v210, s36
  v_perm_b32 v184, v214, v210, s37
  v_perm_b32 v192, v215, v211, s36
  v_perm_b32 v200, v215, v211, s37
  v_perm_b32 v145, v228, v224, s36
  v_perm_b32 v153, v228, v224, s37
  v_perm_b32 v161, v229, v225, s36
  v_perm_b32 v169, v229, v225, s37
  v_perm_b32 v177, v230, v226, s36
  v_perm_b32 v185, v230, v226, s37
  v_perm_b32 v193, v231, v227, s36
  v_perm_b32 v201, v231, v227, s37
  v_perm_b32 v146, v220, v216, s36
  v_perm_b32 v154, v220, v216, s37
  v_perm_b32 v162, v221, v217, s36
  v_perm_b32 v170, v221, v217, s37
  v_perm_b32 v178, v222, v218, s36
  v_perm_b32 v186, v222, v218, s37
  v_perm_b32 v194, v223, v219, s36
  v_perm_b32 v202, v223, v219, s37
  v_perm_b32 v147, v236, v232, s36
  v_perm_b32 v155, v236, v232, s37
  v_perm_b32 v163, v237, v233, s36
  v_perm_b32 v171, v237, v233, s37
  v_perm_b32 v179, v238, v234, s36
  v_perm_b32 v187, v238, v234, s37
  v_perm_b32 v195, v239, v235, s36
  v_perm_b32 v203, v239, v235, s37
  v_perm_b32 v148, v244, v240, s36
  v_perm_b32 v156, v244, v240, s37
  v_perm_b32 v164, v245, v241, s36
  v_perm_b32 v172, v245, v241, s37
  v_perm_b32 v180, v246, v242, s36
  v_perm_b32 v188, v246, v242, s37
  v_perm_b32 v196, v247, v243, s36
  v_perm_b32 v204, v247, v243, s37
  v_perm_b32 v149, v36, v32, s36
  v_perm_b32 v157, v36, v32, s37
  v_perm_b32 v165, v37, v33, s36
  v_perm_b32 v173, v37, v33, s37
  v_perm_b32 v181, v38, v34, s36
  v_perm_b32 v189, v38, v34, s37
  v_perm_b32 v197, v39, v35, s36
  v_perm_b32 v205, v39, v35, s37
  v_perm_b32 v150, v252, v248, s36
  v_perm_b32 v158, v252, v248, s37
  v_perm_b32 v166, v253, v249, s36
  v_perm_b32 v174, v253, v249, s37
  v_perm_b32 v182, v254, v250, s36
  v_perm_b32 v190, v254, v250, s37
  v_perm_b32 v198, v255, v251, s36
  v_perm_b32 v206, v255, v251, s37
  v_perm_b32 v151, v44, v40, s36
  v_perm_b32 v159, v44, v40, s37
  v_perm_b32 v167, v45, v41, s36
  v_perm_b32 v175, v45, v41, s37
  v_perm_b32 v183, v46, v42, s36
  v_perm_b32 v191, v46, v42, s37
  v_perm_b32 v199, v47, v43, s36
  v_perm_b32 v207, v47, v43, s37
  v_mov_b32 v208, 0
  v_mov_b32 v209, 0
  v_mov_b32 v210, 0
  v_mov_b32 v211, 0
  v_mov_b32 v212, 0
  v_mov_b32 v213, 0
  v_mov_b32 v214, 0
  v_mov_b32 v215, 0
  v_mov_b32 v216, 0
  v_mov_b32 v217, 0
  v_mov_b32 v218, 0
  v_mov_b32 v219, 0
  v_mov_b32 v220, 0
  v_mov_b32 v221, 0
  v_mov_b32 v222, 0
  v_mov_b32 v223, 0
  v_mov_b32 v224, 0
  v_mov_b32 v225, 0
  v_mov_b32 v226, 0
  v_mov_b32 v227, 0
  v_mov_b32 v228, 0
  v_mov_b32 v229, 0
  v_mov_b32 v230, 0
  v_mov_b32 v231, 0
  v_mov_b32 v232, 0
  v_mov_b32 v233, 0
  v_mov_b32 v234, 0
  v_mov_b32 v235, 0
  v_mov_b32 v236, 0
  v_mov_b32 v237, 0
  v_mov_b32 v238, 0
  v_mov_b32 v239, 0
  v_smfmac_f32_16x16x64_bf16 v[208:211], v[16:19], v[80:87], v20
  v_smfmac_f32_16x16x64_bf16 v[212:215], v[16:19], v[88:95], v20
  v_smfmac_f32_16x16x64_bf16 v[216:219], v[16:19], v[96:103], v20
  v_smfmac_f32_16x16x64_bf16 v[220:223], v[16:19], v[104:111], v20
  v_smfmac_f32_16x16x64_bf16 v[224:227], v[16:19], v[112:119], v20
  v_smfmac_f32_16x16x64_bf16 v[228:231], v[16:19], v[120:127], v20
  v_smfmac_f32_16x16x64_bf16 v[232:235], v[16:19], v[128:135], v20
  v_smfmac_f32_16x16x64_bf16 v[236:239], v[16:19], v[136:143], v20
  v_smfmac_f32_16x16x64_bf16 v[208:211], v[16:19], v[144:151], v20
  v_smfmac_f32_16x16x64_bf16 v[212:215], v[16:19], v[152:159], v20
  v_smfmac_f32_16x16x64_bf16 v[216:219], v[16:19], v[160:167], v20
  v_smfmac_f32_16x16x64_bf16 v[220:223], v[16:19], v[168:175], v20
  v_smfmac_f32_16x16x64_bf16 v[224:227], v[16:19], v[176:183], v20
  v_smfmac_f32_16x16x64_bf16 v[228:231], v[16:19], v[184:191], v20
  v_smfmac_f32_16x16x64_bf16 v[232:235], v[16:19], v[192:199], v20
  v_smfmac_f32_16x16x64_bf16 v[236:239], v[16:19], v[200:207], v20
  s_nop 4
  v_add_f32 v208, v208, v210
  v_add_f32 v209, v209, v211
  v_add_f32 v212, v212, v214
  v_add_f32 v213, v213, v215
  v_add_f32 v216, v216, v218
  v_add_f32 v217, v217, v219
  v_add_f32 v220, v220, v222
  v_add_f32 v221, v221, v223
  v_add_f32 v224, v224, v226
  v_add_f32 v225, v225, v227
  v_add_f32 v228, v228, v230
  v_add_f32 v229, v229, v231
  v_add_f32 v232, v232, v234
  v_add_f32 v233, v233, v235
  v_add_f32 v236, v236, v238
  v_add_f32 v237, v237, v239
  v_add_f32 v28, v209, v208 row_ror:8 row_mask:0xf bank_mask:0x3
  v_add_f32 v29, v213, v212 row_ror:8 row_mask:0xf bank_mask:0x3
  v_add_f32 v30, v217, v216 row_ror:8 row_mask:0xf bank_mask:0x3
  v_add_f32 v31, v221, v220 row_ror:8 row_mask:0xf bank_mask:0x3
  v_add_f32 v28, v224, v225 row_ror:8 row_mask:0xf bank_mask:0xc
  v_add_f32 v29, v228, v229 row_ror:8 row_mask:0xf bank_mask:0xc
  v_add_f32 v30, v232, v233 row_ror:8 row_mask:0xf bank_mask:0xc
  v_add_f32 v31, v236, v237 row_ror:8 row_mask:0xf bank_mask:0xc
  v_mul_f32 v28, 0.0009765625, v28
  v_mul_f32 v29, 0.0009765625, v29
  v_mul_f32 v30, 0.0009765625, v30
  v_mul_f32 v31, 0.0009765625, v31
.fz_kernel_c_np:
  v_mov_b32 v27, v6
  s_mov_b32 s72, s66
  s_mov_b32 s73, s65
  s_mov_b32 s74, s67
  s_mov_b32 s75, s62
  s_cmp_lg_u32 s62, 0
  s_cbranch_scc1 .fz_kernel_c_n2
  s_mov_b32 s62, 1
  s_mov_b32 s63, 0x2000000
  s_mov_b32 s64, 0x2800000
  s_mov_b32 s65, 0x1400000
  s_mov_b32 s66, 0x1c42000
  s_mov_b32 s67, 12
  s_mov_b32 s71, 159776
  v_mov_b32 v6, 159832
.fz_kernel_c_n2:
  s_lshr_b32 s21, s17, 3
  s_add_u32 s70, s18, s21
  s_lshl1_add_u32 s70, s17, s70
  s_and_b32 s70, s70, 15
  s_cmp_eq_u32 s75, 0
  s_cselect_b32 s3, 32, 0
  s_cselect_b32 s70, s70, s18
  s_and_b32 s20, s16, 1
  s_mov_b32 s34, 0x000f000f
  s_mov_b32 s35, 0x000f000f
  s_mov_b32 s71, 0
  s_lshl1_add_u32 s26, s17, s20
  v_lshrrev_b32 v8, 4, v2
  v_lshrrev_b32 v12, 5, v2
  v_lshlrev_b32 v12, 10, v12
  v_bfe_u32 v14, v2, 3, 2
  v_lshl_add_u32 v12, v14, 8, v12
  v_and_b32 v14, 7, v2
  v_lshl_add_u32 v12, v14, 1, v12
  v_lshlrev_b32 v19, 7, v2
  s_lshl_b32 s25, s20, 1
  v_lshrrev_b32 v14, 4, v2
  v_bfe_u32 v15, v2, 2, 2
  v_lshl_add_u32 v16, v14, 3, v15
  v_lshlrev_b32 v16, 7, v16
  v_and_b32 v14, 1, v14
  v_lshrrev_b32 v15, 1, v15
  v_lshl_add_u32 v14, v14, 1, v15
  v_xor_b32 v14, s25, v14
  v_lshl_add_u32 v16, v14, 5, v16
  v_and_b32 v14, 3, v2
  v_lshl_add_u32 v16, v14, 3, v16
  v_add_u32 v7, 65536, v16
  v_xor_b32 v9, 32, v7
  s_and_b32 s61, s18, 2
  s_add_u32 s61, s61, s20
  s_and_b32 s32, s18, 1
  s_lshl2_add_u32 s32, s32, s61
  s_lshl_b32 s32, s32, 9
  s_lshl_b32 s22, s17, 13
  s_add_u32 s32, s32, s22
  s_and_b32 s22, s18, 8
  s_lshl_b32 s22, s22, 9
  s_add_u32 s32, s32, s22
  s_and_b32 s22, s18, 4
  s_lshl_b32 s22, s22, 6
  s_add_u32 s32, s32, s22
  s_add_u32 s32, s32, s72
  s_add_u32 s32, s32, 40960
  s_lshl_b32 s61, s61, 16
  s_lshl_b32 s33, s26, 12
  s_add_u32 s33, s33, s72
  s_add_u32 s33, s33, 40960
  s_mul_i32 s39, s18, 28
  s_add_u32 s39, s39, s26
  s_lshl_b32 s39, s39, 8
  s_add_u32 s39, s39, s72
  s_add_u32 s39, s39, 155648
  s_lshl4_add_u32 s60, s18, s17
  s_lshl_b32 s60, s60, 10
  s_add_u32 s60, s60, 0x1c84000
  s_add_u32 s21, s74, 0x1800008
  s_sub_u32 s22, s72, 32768
  v_mov_b32 v14, s21
  v_mov_b32 v15, s22
  v_cmp_gt_u32 vcc, 16, v2
  s_nop 1
  v_cndmask_b32 v14, v15, v14, vcc
  v_lshl_add_u32 v14, v2, 11, v14
  s_lshl_b32 s25, s17, 7
  s_lshl_b32 s22, 1, s18
  v_mov_b32 v15, s22
  v_lshlrev_b32 v16, 3, v2
  s_and_b32 s21, s2, 7
  s_lshl_b32 s21, s21, 11
  s_lshl_b32 s22, s20, 10
  s_add_u32 s21, s21, s22
  s_add_u32 s21, s21, s72
  s_lshl_b32 s22, s20, 12
  s_add_u32 s22, s22, s72
  s_add_u32 s22, s22, 16384
  s_add_u32 s23, s22, 8192
  s_add_u32 s24, s22, 16384
  v_lshrrev_b32 v17, 1, v8
  v_lshlrev_b32 v17, 13, v17
  v_and_b32 v18, 1, v8
  v_lshl_add_u32 v17, v18, 11, v17
  v_bfe_u32 v18, v2, 3, 1
  v_lshl_add_u32 v17, v18, 10, v17
  v_bfe_u32 v18, v2, 2, 1
  v_lshl_add_u32 v17, v18, 7, v17
  v_and_b32 v18, 3, v2
  v_lshl_add_u32 v17, v18, 3, v17
  s_lshl_b32 s27, s20, 14
  s_add_u32 s27, s27, 114688
  v_add_u32 v17, s27, v17
  v_xor_b32 v18, 64, v17
  v_and_b32 v20, 7, v2
  v_lshlrev_b32 v20, 5, v20
  v_and_b32 v21, 8, v2
  v_lshl_add_u32 v20, v21, 1, v20
  v_and_b32 v21, 31, v2
  v_lshlrev_b32 v21, 4, v21
  v_lshrrev_b32 v22, 5, v2
  v_lshl_add_u32 v21, v22, 11, v21
  v_mov_b32 v23, 0.0009765625
  v_mov_b32 v24, 9.5367431640625e-07
  v_mov_b32 v25, 1e-05
  v_add_u32 v26, 155648, v16
  s_lshl_b32 s14, s17, 9
  s_add_u32 s14, s14, s72
  s_add_u32 s14, s14, 16384
  s_add_u32 s15, s14, 8192
  s_barrier
.fz_kernel_c_n3:
  s_mov_b32 s13, 0xff0000
  s_cmp_eq_u32 s20, 0
  s_cbranch_scc1 .fz_kernel_c_nf
  s_cmp_eq_u32 s75, 0
  s_cselect_b32 exec_lo, 0xffff, s13
  s_mov_b32 exec_hi, 0
  s_mov_b32 s38, 0
.fz_kernel_cw67:
  s_sleep 1
  ds_read_u8 v22, v27 offset:268
  s_add_u32 s38, s38, 1
  s_waitcnt lgkmcnt(0)
  v_cmp_gt_u32 vcc, 4, v22
  s_cbranch_vccz .fz_kernel_cw67d
  s_cmp_lt_u32 s38, 8388608
  s_cbranch_scc1 .fz_kernel_cw67
.fz_kernel_cw67d:
  buffer_atomic_or v15, v14, s[4:7], s25 offen sc1
  s_mov_b64 exec, -1
.fz_kernel_c_nf:
  s_add_u32 s13, s19, s74
  s_mov_b64 exec, 1
  buffer_load_dword v11, v4, s[4:7], s13 offen offset:8 sc1
  s_mov_b64 exec, -1
  v_and_b32 v14, 3, v2
  v_lshlrev_b32 v14, 9, v14
  v_and_b32 v13, 1, v8
  v_lshl_add_u32 v14, v13, 8, v14
  v_lshrrev_b32 v13, 1, v8
  v_lshl_add_u32 v14, v13, 14, v14
  v_add_u32 v14, s61, v14
  v_add_u32 v10, 0x8000, v14
  v_and_b32 v8, 2, v2
  v_mul_u32_u24 v8, 0x5555, v8
  v_add_u32 v8, 0x4444, v8
  s_waitcnt lgkmcnt(0)
  s_cmp_lg_u32 s75, 0
  s_cbranch_scc1 .fz_kernel_c_nw
  v_mov_b32 v13, v9
  s_lshl_b32 s21, s18, 10
  s_add_u32 s21, s21, s72
  s_cmp_lg_u32 s20, 0
  s_cbranch_scc1 .fz_kernel_c_c7
  s_add_u32 s22, s19, s74
  s_add_u32 s23, s14, 16384
  s_mov_b64 exec, 1
  s_mov_b32 s38, 0
  s_branch .fz_kernel_c_c00
.fz_kernel_c_c0:
  s_sleep 6
  buffer_load_dword v11, v4, s[4:7], s22 offen offset:8 sc1
.fz_kernel_c_c00:
  s_add_u32 s38, s38, 1
  s_waitcnt vmcnt(0)
  ds_or_b32 v6, v11 offset:0x114
  v_or_b32 v11, v11, v15
  v_cmp_ne_u32 vcc, 0xffff, v11
  s_cbranch_vccz .fz_kernel_c_c1
  s_cmp_lt_u32 s38, 131072
  s_cbranch_scc1 .fz_kernel_c_c0
.fz_kernel_c_c1:
  s_mov_b32 s38, 0
.fz_kernel_cw68:
  s_sleep 1
  ds_read_u8 v22, v27 offset:268
  s_add_u32 s38, s38, 1
  s_waitcnt lgkmcnt(0)
  v_cmp_gt_u32 vcc, 4, v22
  s_cbranch_vccz .fz_kernel_cw68d
  s_cmp_lt_u32 s38, 8388608
  s_cbranch_scc1 .fz_kernel_cw68
.fz_kernel_cw68d:
  ds_or_b32 v6, v11 offset:0x114
  s_mov_b64 exec, -1
  buffer_load_dwordx2 v[240:241], v16, s[4:7], s14 offen
  buffer_load_dwordx2 v[242:243], v16, s[4:7], s15 offen
  buffer_load_dwordx2 v[244:245], v16, s[4:7], s23 offen
  s_lshl_b32 s23, s17, 6
  s_add_u32 s23, s23, s21
  s_lshl_b32 s24, s17, 18
  s_add_u32 s24, s24, 1
  v_and_b32 v19, 0x38, v2
  v_lshl_add_u32 v19, v19, 8, s24
  v_and_b32 v208, 7, v2
  v_lshl_add_u32 v19, v208, 5, v19
  s_mov_b32 s38, 0
.fz_kernel_cw69:
  s_sleep 1
  ds_read_u8 v22, v6 offset:272
  s_add_u32 s38, s38, 1
  s_waitcnt lgkmcnt(0)
  v_cmp_gt_u32 vcc, 2, v22
  s_cbranch_vccz .fz_kernel_cw69d
  s_cmp_lt_u32 s38, 8388608
  s_cbranch_scc1 .fz_kernel_cw69
.fz_kernel_cw69d:
  ds_read_b64_tr_b16 v[32:33], v7 offset:0
  ds_read_b64_tr_b16 v[34:35], v7 offset:512
  ds_read_b64_tr_b16 v[40:41], v13 offset:0
  ds_read_b64_tr_b16 v[42:43], v13 offset:512
  ds_read_b64_tr_b16 v[48:49], v7 offset:4096
  ds_read_b64_tr_b16 v[50:51], v7 offset:4608
  ds_read_b64_tr_b16 v[56:57], v13 offset:4096
  ds_read_b64_tr_b16 v[58:59], v13 offset:4608
  ds_read_b64_tr_b16 v[64:65], v7 offset:8192
  ds_read_b64_tr_b16 v[66:67], v7 offset:8704
  ds_read_b64_tr_b16 v[72:73], v13 offset:8192
  ds_read_b64_tr_b16 v[74:75], v13 offset:8704
  s_waitcnt lgkmcnt(0)
  ds_read_b64_tr_b16 v[36:37], v7 offset:12288
  ds_read_b64_tr_b16 v[38:39], v7 offset:12800
  ds_read_b64_tr_b16 v[44:45], v13 offset:12288
  ds_read_b64_tr_b16 v[46:47], v13 offset:12800
  ds_read_b64_tr_b16 v[52:53], v7 offset:16384
  ds_read_b64_tr_b16 v[54:55], v7 offset:16896
  ds_read_b64_tr_b16 v[60:61], v13 offset:16384
  ds_read_b64_tr_b16 v[62:63], v13 offset:16896
  ds_read_b64_tr_b16 v[68:69], v7 offset:20480
  ds_read_b64_tr_b16 v[70:71], v7 offset:20992
  ds_read_b64_tr_b16 v[76:77], v13 offset:20480
  ds_read_b64_tr_b16 v[78:79], v13 offset:20992
  s_waitcnt lgkmcnt(0)
  s_waitcnt vmcnt(0)
  v_fma_f32 v208, -v240, v240, v242
  v_fma_f32 v209, -v241, v241, v243
  v_rsq_f32 v208, abs(v208)
  v_rsq_f32 v209, abs(v209)
  v_mul_f32 v208, v208, v244
  v_mul_f32 v209, v209, v245
  v_and_b32 v208, -2, v208
  v_or_b32 v209, 1, v209
  v_cmp_gt_f32 vcc, v209, v208
  v_max_f32 v9, v208, v209
  s_nop 0
  v_cndmask_b32 v210, v240, v241, vcc
  v_max_f32 v7, v9, v9 row_ror:8 row_mask:0xf bank_mask:0xf
  v_cndmask_b32 v211, v242, v243, vcc
  s_nop 0
  v_max_f32 v7, v7, v7 row_ror:4 row_mask:0xf bank_mask:0xf
  s_nop 1
  v_max_f32 v7, v7, v7 row_ror:2 row_mask:0xf bank_mask:0xf
  s_nop 1
  v_max_f32 v7, v7, v7 row_ror:1 row_mask:0xf bank_mask:0xf
  s_nop 1
  v_max_f32 v7, v7, v7 row_bcast:15 row_mask:0xa bank_mask:0xf
  s_nop 1
  v_max_f32 v7, v7, v7 row_bcast:31 row_mask:0xc bank_mask:0xf
  v_and_b32 v209, 1, v9
  v_lshl_add_u32 v209, v209, 4, v19
  v_readlane_b32 s22, v7, 63
  v_mov_b32 v208, v9
  s_nop 0
  v_cmp_eq_u32 vcc, s22, v9
  s_ff1_i32_b64 s22, vcc
  s_lshl_b64 exec, 1, s22
  buffer_store_dwordx4 v[208:211], v4, s[4:7], s23 offen sc1
  s_mov_b64 exec, -1
.fz_kernel_c_c2:
  s_cmp_lg_u32 s20, 0
  s_cbranch_scc1 .fz_kernel_c_c21
  s_call_b64 s[68:69], .fz_kernel_c_coef
  ds_write_b64 v26, v[248:249] offset:4608
  ds_write_b64 v26, v[250:251] offset:5120
  ds_write_b64 v26, v[252:253] offset:6400
  ds_write_b64 v26, v[254:255] offset:6912
.fz_kernel_c_c21:
.fz_kernel_c_c22:
  s_cmp_le_u32 s3, 28
  s_cbranch_scc1 .fz_kernel_c_c3
  s_barrier
  s_sub_u32 s3, s3, 1
  s_branch .fz_kernel_c_c22
.fz_kernel_c_c3:
  v_lshlrev_b32 v22, 6, v2
  s_mov_b64 exec, 0xffff
  s_mov_b32 s38, 0
.fz_kernel_c_c4:
  buffer_load_dwordx4 v[224:227], v22, s[4:7], s21 offen sc1
  s_add_u32 s38, s38, 1
  s_mov_b32 s46, 0
  s_call_b64 s[0:1], .fz_kernel_hw
  s_waitcnt vmcnt(0)
  v_min_u32 v9, v225, v227
  v_max_f32 v7, v224, v224 row_ror:8 row_mask:0xf bank_mask:0xf
  v_cmp_eq_u32 vcc, 0, v9
  s_cbranch_vccz .fz_kernel_c_c5
  s_cmp_lt_u32 s38, 131072
  s_cbranch_scc1 .fz_kernel_c_c4
.fz_kernel_c_c5:
  s_waitcnt lgkmcnt(0)
  v_max_f32 v7, v7, v7 row_ror:4 row_mask:0xf bank_mask:0xf
  s_nop 1
  v_max_f32 v7, v7, v7 row_ror:2 row_mask:0xf bank_mask:0xf
  s_nop 1
  v_max_f32 v7, v7, v7 row_ror:1 row_mask:0xf bank_mask:0xf
  v_cmp_eq_u32 vcc, v7, v224
  s_or_b32 s22, vcc_lo, 0x8000
  s_ff1_i32_b32 s22, s22
  v_readlane_b32 s77, v225, s22
  s_mov_b64 exec, s[34:35]
  s_and_b32 s77, s77, 0x3c38f0
  s_add_u32 s78, s77, s73
  buffer_load_dwordx4 v[208:211], v14, s[4:7], s78 offen
  buffer_load_dwordx4 v[212:215], v10, s[4:7], s78 offen
  s_mov_b64 exec, -1
  s_cmp_eq_u32 s3, 0
  s_cbranch_scc1 .fz_kernel_hb71
  s_barrier
  s_sub_u32 s3, s3, 1
.fz_kernel_hb71:
  v_readlane_b32 s27, v224, s22
  v_readlane_b32 s23, v226, s22
  v_readlane_b32 s24, v227, s22
  s_lshr_b32 s21, s77, 11
  s_and_b32 s22, s21, 7
  s_and_b32 s21, s21, 0x780
  s_lshl4_add_u32 s21, s22, s21
  s_bfe_u32 s77, s77, 0x40004
  s_add_u32 s77, s77, s21
  v_mov_b32 v11, s23
  v_mov_b32 v15, s24
  s_branch .fz_kernel_c_idx
.fz_kernel_c_nw:
  s_mov_b64 exec, 0xff
  s_mov_b32 s38, 0
.fz_kernel_c_gm:
  buffer_load_dword v9, v19, s[4:7], s21 offen sc1
  s_add_u32 s38, s38, 1
  s_waitcnt vmcnt(0)
  v_cmp_ne_u32 vcc, 0xffff, v9
  s_cbranch_vccz .fz_kernel_c_gmd
  s_sleep 10
  s_cmp_lt_u32 s38, 131072
  s_cbranch_scc1 .fz_kernel_c_gm
.fz_kernel_c_gmd:
  s_mov_b64 exec, -1
  buffer_load_dwordx4 v[208:211], v3, s[4:7], s22 offen offset:0
  buffer_load_dwordx4 v[212:215], v3, s[4:7], s23 offen offset:0
  buffer_load_dwordx4 v[216:219], v3, s[4:7], s24 offen offset:0
  buffer_load_dwordx4 v[220:223], v3, s[4:7], s22 offen offset:1024
  buffer_load_dwordx4 v[224:227], v3, s[4:7], s23 offen offset:1024
  buffer_load_dwordx4 v[228:231], v3, s[4:7], s24 offen offset:1024
  buffer_load_dwordx4 v[232:235], v3, s[4:7], s22 offen offset:2048
  buffer_load_dwordx4 v[236:239], v3, s[4:7], s23 offen offset:2048
  buffer_load_dwordx4 v[240:243], v3, s[4:7], s24 offen offset:2048
  buffer_load_dwordx4 v[244:247], v3, s[4:7], s22 offen offset:3072
  buffer_load_dwordx4 v[248:251], v3, s[4:7], s23 offen offset:3072
  buffer_load_dwordx4 v[252:255], v3, s[4:7], s24 offen offset:3072
  s_lshl_b32 s21, s75, 4
  s_add_u32 s21, s21, 159968
  v_mov_b32 v19, s21
  s_lshl_b32 s22, s20, 3
  v_add_u32 v13, s22, v19
  s_waitcnt vmcnt(10)
  v_fma_f32 v212, -v208, v208, v212
  v_fma_f32 v213, -v209, v209, v213
  v_fma_f32 v214, -v210, v210, v214
  v_fma_f32 v215, -v211, v211, v215
  v_rsq_f32 v212, abs(v212)
  v_rsq_f32 v213, abs(v213)
  v_rsq_f32 v214, abs(v214)
  v_rsq_f32 v215, abs(v215)
  s_waitcnt vmcnt(9)
  v_mul_f32 v216, v216, v212
  v_mul_f32 v217, v217, v213
  v_mul_f32 v218, v218, v214
  v_mul_f32 v219, v219, v215
  v_and_or_b32 v216, v216, -16, 0
  v_and_or_b32 v217, v217, -16, 1
  v_and_or_b32 v218, v218, -16, 2
  v_and_or_b32 v219, v219, -16, 3
  v_max3_f32 v9, v216, v217, v218
  v_max_f32 v9, v9, v219
  s_waitcnt vmcnt(7)
  v_fma_f32 v224, -v220, v220, v224
  v_fma_f32 v225, -v221, v221, v225
  v_fma_f32 v226, -v222, v222, v226
  v_fma_f32 v227, -v223, v223, v227
  v_rsq_f32 v224, abs(v224)
  v_rsq_f32 v225, abs(v225)
  v_rsq_f32 v226, abs(v226)
  v_rsq_f32 v227, abs(v227)
  s_waitcnt vmcnt(6)
  v_mul_f32 v228, v228, v224
  v_mul_f32 v229, v229, v225
  v_mul_f32 v230, v230, v226
  v_mul_f32 v231, v231, v227
  v_and_or_b32 v228, v228, -16, 4
  v_and_or_b32 v229, v229, -16, 5
  v_and_or_b32 v230, v230, -16, 6
  v_and_or_b32 v231, v231, -16, 7
  v_max3_f32 v9, v9, v228, v229
  v_max3_f32 v9, v9, v230, v231
  s_waitcnt vmcnt(4)
  v_fma_f32 v236, -v232, v232, v236
  v_fma_f32 v237, -v233, v233, v237
  v_fma_f32 v238, -v234, v234, v238
  v_fma_f32 v239, -v235, v235, v239
  v_rsq_f32 v236, abs(v236)
  v_rsq_f32 v237, abs(v237)
  v_rsq_f32 v238, abs(v238)
  v_rsq_f32 v239, abs(v239)
  s_waitcnt vmcnt(3)
  v_mul_f32 v240, v240, v236
  v_mul_f32 v241, v241, v237
  v_mul_f32 v242, v242, v238
  v_mul_f32 v243, v243, v239
  v_and_or_b32 v240, v240, -16, 8
  v_and_or_b32 v241, v241, -16, 9
  v_and_or_b32 v242, v242, -16, 10
  v_and_or_b32 v243, v243, -16, 11
  v_max3_f32 v9, v9, v240, v241
  v_max3_f32 v9, v9, v242, v243
  s_waitcnt vmcnt(1)
  v_fma_f32 v248, -v244, v244, v248
  v_fma_f32 v249, -v245, v245, v249
  v_fma_f32 v250, -v246, v246, v250
  v_fma_f32 v251, -v247, v247, v251
  v_rsq_f32 v248, abs(v248)
  v_rsq_f32 v249, abs(v249)
  v_rsq_f32 v250, abs(v250)
  v_rsq_f32 v251, abs(v251)
  s_waitcnt vmcnt(0)
  v_mul_f32 v252, v252, v248
  v_mul_f32 v253, v253, v249
  v_mul_f32 v254, v254, v250
  v_mul_f32 v255, v255, v251
  v_and_or_b32 v252, v252, -16, 12
  v_and_or_b32 v253, v253, -16, 13
  v_and_or_b32 v254, v254, -16, 14
  v_and_or_b32 v255, v255, -16, 15
  v_max3_f32 v9, v9, v252, v253
  v_max3_f32 v9, v9, v254, v255
  s_nop 1
  v_max_f32 v7, v9, v9 row_ror:8 row_mask:0xf bank_mask:0xf
  s_nop 1
  v_max_f32 v7, v7, v7 row_ror:4 row_mask:0xf bank_mask:0xf
  s_nop 1
  v_max_f32 v7, v7, v7 row_ror:2 row_mask:0xf bank_mask:0xf
  s_nop 1
  v_max_f32 v7, v7, v7 row_ror:1 row_mask:0xf bank_mask:0xf
  s_nop 1
  v_max_f32 v7, v7, v7 row_bcast:15 row_mask:0xa bank_mask:0xf
  s_nop 1
  v_max_f32 v7, v7, v7 row_bcast:31 row_mask:0xc bank_mask:0xf
  s_nop 0
  v_readlane_b32 s21, v7, 63
  s_nop 1
  v_cmp_eq_u32 vcc, s21, v9
  s_ff1_i32_b64 s22, vcc
  s_lshl_b32 s22, s22, 2
  s_and_b32 s23, s21, 3
  s_add_u32 s22, s22, s23
  s_and_b32 s23, s21, 12
  s_lshl_b32 s23, s23, 6
  s_add_u32 s22, s22, s23
  s_and_b32 s22, s22, 1023
  s_lshl_b32 s23, s20, 10
  s_add_u32 s22, s22, s23
  s_add_u32 s22, s22, 1
  v_mov_b32 v224, s21
  v_mov_b32 v225, s22
  s_mov_b64 exec, 1
  ds_write_b64 v13, v[224:225]
  s_mov_b32 s38, 0
.fz_kernel_cw72:
  s_sleep 1
  ds_read_u8 v22, v6 offset:280
  s_add_u32 s38, s38, 1
  s_waitcnt lgkmcnt(0)
  v_cmp_gt_u32 vcc, 2, v22
  s_cbranch_vccz .fz_kernel_cw72d
  s_cmp_lt_u32 s38, 8388608
  s_cbranch_scc1 .fz_kernel_cw72
.fz_kernel_cw72d:
  s_mov_b32 s38, 0
.fz_kernel_c_am:
  ds_read_b128 v[224:227], v19
  s_add_u32 s38, s38, 1
  s_waitcnt lgkmcnt(0)
  v_min_u32 v9, v225, v227
  v_cmp_eq_u32 vcc, 0, v9
  s_cbranch_vccz .fz_kernel_c_amd
  s_cmp_lt_u32 s38, 524288
  s_cbranch_scc1 .fz_kernel_c_am
.fz_kernel_c_amd:
  v_cmp_gt_f32 vcc, v226, v224
  s_nop 1
  v_cndmask_b32 v225, v225, v227, vcc
  v_cndmask_b32 v224, v224, v226, vcc
  v_readfirstlane_b32 s77, v225
  v_readfirstlane_b32 s27, v224
  s_mov_b64 exec, -1
  s_sub_u32 s21, s77, 1
  s_and_b32 s21, s21, 2047
  s_lshl_b32 s21, s21, 2
  s_add_u32 s21, s21, s72
  s_add_u32 s21, s21, 16384
  s_add_u32 s22, s21, 8192
  buffer_load_dword v11, v4, s[4:7], s21 offen
  buffer_load_dword v15, v4, s[4:7], s22 offen
  s_mov_b64 exec, s[34:35]
  s_sub_u32 s77, s77, 1
  s_and_b32 s77, s77, 2047
  s_lshr_b32 s78, s77, 7
  s_lshl_b32 s78, s78, 18
  s_and_b32 s21, s77, 0x70
  s_lshl_b32 s21, s21, 7
  s_add_u32 s78, s78, s21
  s_and_b32 s21, s77, 15
  s_lshl_b32 s21, s21, 4
  s_add_u32 s78, s78, s21
  s_add_u32 s78, s78, s73
  buffer_load_dwordx4 v[208:211], v14, s[4:7], s78 offen
  buffer_load_dwordx4 v[212:215], v10, s[4:7], s78 offen
  s_mov_b64 exec, -1
.fz_kernel_c_idx:
  s_lshr_b32 s21, s77, 7
  s_and_b32 s79, s77, 127
  s_add_u32 s79, s79, 1
  s_cmp_eq_u32 s21, s17
  s_cselect_b32 s79, s79, 0
  v_mov_b32 v1, -1477.3197218702985
  v_mul_f32 v1, s27, v1
  v_exp_f32 v1, v1
  s_nop 0
  v_add_f32 v1, 1.0, v1
  v_rcp_f32 v1, v1
  s_lshl_b32 s23, s70, 14
  s_add_u32 s23, s23, s78
  v_mov_b32 v224, 0
  v_mov_b32 v225, 0
  v_mov_b32 v226, 0
  v_mov_b32 v227, 0
  v_mov_b32 v228, 0
  v_mov_b32 v229, 0
  v_mov_b32 v230, 0
  v_mov_b32 v231, 0
  v_mov_b32 v232, 0
  v_mov_b32 v233, 0
  v_mov_b32 v234, 0
  v_mov_b32 v235, 0
  v_mov_b32 v236, 0
  v_mov_b32 v237, 0
  v_mov_b32 v238, 0
  s_cmp_eq_u32 s3, 0
  s_cbranch_scc1 .fz_kernel_hb81
  s_barrier
  s_sub_u32 s3, s3, 1
.fz_kernel_hb81:
  v_mov_b32 v239, 0
  v_mov_b32 v240, 0
  v_mov_b32 v241, 0
  v_mov_b32 v242, 0
  v_mov_b32 v243, 0
  v_mov_b32 v244, 0
  v_mov_b32 v245, 0
  v_mov_b32 v246, 0
  v_mov_b32 v247, 0
  v_mov_b32 v248, 0
  v_mov_b32 v249, 0
  v_mov_b32 v250, 0
  v_mov_b32 v251, 0
  v_mov_b32 v252, 0
  v_mov_b32 v253, 0
  v_mov_b32 v254, 0
  v_mov_b32 v255, 0
  s_mov_b32 s46, 0
  s_call_b64 s[0:1], .fz_kernel_hw
  s_waitcnt vmcnt(0)
  s_cmp_ge_u32 s17, 14
  s_cbranch_scc1 .fz_kernel_c_ng
  s_setprio 2
  v_smfmac_f32_16x16x64_bf16 v[224:227], v[208:211], v[80:87], v8
  v_smfmac_f32_16x16x64_bf16 v[228:231], v[208:211], v[88:95], v8
  v_smfmac_f32_16x16x64_bf16 v[232:235], v[208:211], v[96:103], v8
  v_smfmac_f32_16x16x64_bf16 v[236:239], v[208:211], v[104:111], v8
  v_smfmac_f32_16x16x64_bf16 v[240:243], v[208:211], v[112:119], v8
  v_smfmac_f32_16x16x64_bf16 v[244:247], v[208:211], v[120:127], v8
  v_smfmac_f32_16x16x64_bf16 v[248:251], v[208:211], v[128:135], v8
  v_smfmac_f32_16x16x64_bf16 v[252:255], v[208:211], v[136:143], v8
  v_smfmac_f32_16x16x64_bf16 v[224:227], v[212:215], v[144:151], v8
  v_smfmac_f32_16x16x64_bf16 v[228:231], v[212:215], v[152:159], v8
  v_smfmac_f32_16x16x64_bf16 v[232:235], v[212:215], v[160:167], v8
  v_smfmac_f32_16x16x64_bf16 v[236:239], v[212:215], v[168:175], v8
  v_smfmac_f32_16x16x64_bf16 v[240:243], v[212:215], v[176:183], v8
  v_smfmac_f32_16x16x64_bf16 v[244:247], v[212:215], v[184:191], v8
  v_smfmac_f32_16x16x64_bf16 v[248:251], v[212:215], v[192:199], v8
  v_smfmac_f32_16x16x64_bf16 v[252:255], v[212:215], v[200:207], v8
  s_nop 4
  v_add_f32 v224, v224, v226
  v_add_f32 v225, v225, v227
  v_add_f32 v228, v228, v230
  v_add_f32 v229, v229, v231
  v_add_f32 v232, v232, v234
  v_add_f32 v233, v233, v235
  v_add_f32 v236, v236, v238
  v_add_f32 v237, v237, v239
  v_add_f32 v240, v240, v242
  v_add_f32 v241, v241, v243
  v_add_f32 v244, v244, v246
  v_add_f32 v245, v245, v247
  v_add_f32 v248, v248, v250
  v_add_f32 v249, v249, v251
  v_add_f32 v252, v252, v254
  v_add_f32 v253, v253, v255
  v_add_f32 v208, v225, v224 row_ror:8 row_mask:0xf bank_mask:0x3
  v_add_f32 v209, v229, v228 row_ror:8 row_mask:0xf bank_mask:0x3
  v_add_f32 v210, v233, v232 row_ror:8 row_mask:0xf bank_mask:0x3
  v_add_f32 v211, v237, v236 row_ror:8 row_mask:0xf bank_mask:0x3
  v_add_f32 v208, v240, v241 row_ror:8 row_mask:0xf bank_mask:0xc
  v_add_f32 v209, v244, v245 row_ror:8 row_mask:0xf bank_mask:0xc
  v_add_f32 v210, v248, v249 row_ror:8 row_mask:0xf bank_mask:0xc
  v_add_f32 v211, v252, v253 row_ror:8 row_mask:0xf bank_mask:0xc
  v_fma_f32 v208, -v11, v28, v208
  v_fma_f32 v209, -v11, v29, v209
  v_or_b32 v208, 1, v208
  v_fma_f32 v210, -v11, v30, v210
  v_fma_f32 v211, -v11, v31, v211
  v_or_b32 v210, 1, v210
  s_mov_b64 exec, 0xffff
  buffer_store_dwordx4 v[208:211], v20, s[4:7], s32 offen offset:0 sc1
  s_mov_b64 exec, -1
  s_setprio 0
  s_cmp_eq_u32 s3, 0
  s_cbranch_scc1 .fz_kernel_hb73
  s_barrier
  s_sub_u32 s3, s3, 1
.fz_kernel_hb73:
.fz_kernel_c_ng:
  s_cmp_eq_u32 s20, 0
  s_cbranch_scc1 .fz_kernel_c_ng1
  buffer_load_ushort v184, v12, s[4:7], s23 offen
  s_branch .fz_kernel_c_ng2
.fz_kernel_c_ng1:
  s_cmp_eq_u32 s75, 0
  s_cbranch_scc1 .fz_kernel_c_ng2
  buffer_load_dwordx2 v[240:241], v16, s[4:7], s14 offen
  buffer_load_dwordx2 v[242:243], v16, s[4:7], s15 offen
.fz_kernel_c_ng2:
  s_cmp_ge_u32 s17, 14
  s_cbranch_scc1 .fz_kernel_c_g1
  ds_read_b64_tr_b16 v[80:81], v17 offset:0
  ds_read_b64_tr_b16 v[82:83], v17 offset:512
  ds_read_b64_tr_b16 v[88:89], v17 offset:32
  ds_read_b64_tr_b16 v[90:91], v17 offset:544
  ds_read_b64_tr_b16 v[96:97], v18 offset:0
  ds_read_b64_tr_b16 v[98:99], v18 offset:512
  ds_read_b64_tr_b16 v[104:105], v18 offset:32
  ds_read_b64_tr_b16 v[106:107], v18 offset:544
  ds_read_b64_tr_b16 v[84:85], v18 offset:256
  ds_read_b64_tr_b16 v[86:87], v18 offset:768
  ds_read_b64_tr_b16 v[92:93], v18 offset:288
  ds_read_b64_tr_b16 v[94:95], v18 offset:800
  ds_read_b64_tr_b16 v[100:101], v17 offset:256
  s_cmp_eq_u32 s3, 0
  s_cbranch_scc1 .fz_kernel_hb82
  s_barrier
  s_sub_u32 s3, s3, 1
.fz_kernel_hb82:
  ds_read_b64_tr_b16 v[102:103], v17 offset:768
  ds_read_b64_tr_b16 v[108:109], v17 offset:288
  ds_read_b64_tr_b16 v[110:111], v17 offset:800
  s_waitcnt lgkmcnt(4)
  ds_read_b64_tr_b16 v[112:113], v17 offset:4096
  ds_read_b64_tr_b16 v[114:115], v17 offset:4608
  ds_read_b64_tr_b16 v[120:121], v17 offset:4128
  ds_read_b64_tr_b16 v[122:123], v17 offset:4640
  ds_read_b64_tr_b16 v[128:129], v18 offset:4096
  ds_read_b64_tr_b16 v[130:131], v18 offset:4608
  ds_read_b64_tr_b16 v[136:137], v18 offset:4128
  ds_read_b64_tr_b16 v[138:139], v18 offset:4640
  ds_read_b64_tr_b16 v[116:117], v18 offset:4352
  ds_read_b64_tr_b16 v[118:119], v18 offset:4864
  ds_read_b64_tr_b16 v[124:125], v18 offset:4384
  ds_read_b64_tr_b16 v[126:127], v18 offset:4896
  ds_read_b64_tr_b16 v[132:133], v17 offset:4352
  ds_read_b64_tr_b16 v[134:135], v17 offset:4864
  s_cmp_eq_u32 s3, 0
  s_cbranch_scc1 .fz_kernel_hb83
  s_barrier
  s_sub_u32 s3, s3, 1
.fz_kernel_hb83:
  ds_read_b64_tr_b16 v[140:141], v17 offset:4384
  ds_read_b64_tr_b16 v[142:143], v17 offset:4896
.fz_kernel_c_g1:
  v_fma_f32 v15, -v11, v11, v15
  v_rsq_f32 v15, abs(v15)
  s_nop 0
  v_mul_f32 v179, v11, v15
  v_mul_f32 v15, 0x44800000, v15
  v_sub_f32 v179, 0, v179
  v_add_f32 v178, 1.0, v15
  v_mul_f32 v177, -1.4426950408889634, v15
  v_mul_f32 v15, v15, v15
  v_mul_f32 v1, v1, v15
  v_mov_b32 v188, 0
  v_mov_b32 v190, 0
  v_mov_b32 v192, 0
  v_mov_b32 v194, 0
  v_mov_b32 v196, 0
  v_mov_b32 v198, 0
  v_mov_b32 v200, 0
  v_mov_b32 v202, 0
  v_mov_b32 v212, 0
  v_mov_b32 v214, 0
  v_mov_b32 v216, 0
  v_mov_b32 v218, 0
  v_mov_b32 v220, 0
  v_mov_b32 v222, 0
  v_mov_b32 v224, 0
  v_mov_b32 v226, 0
  v_mov_b32 v228, 0
  v_mov_b32 v230, 0
  v_mov_b32 v232, 0
  v_mov_b32 v234, 0
  s_cmp_eq_u32 s75, 0
  s_cbranch_scc1 .fz_kernel_c_d0
  s_cmp_lg_u32 s20, 0
  s_cbranch_scc1 .fz_kernel_c_t2
  s_waitcnt vmcnt(0)
  s_call_b64 s[68:69], .fz_kernel_c_coef
  s_cmp_eq_u32 s3, 0
  s_cbranch_scc1 .fz_kernel_hb84
  s_barrier
  s_sub_u32 s3, s3, 1
.fz_kernel_hb84:
  v_mov_b32 v9, 159952
  v_mov_b32 v7, s79
  ds_write_b64 v26, v[252:253] offset:6400
  ds_write_b64 v26, v[254:255] offset:6912
  ds_write_b32 v9, v7
  s_waitcnt lgkmcnt(0)
.fz_kernel_c_t2:
  s_barrier
.fz_kernel_c_d0:
  s_cmp_ge_u32 s17, 14
  s_cbranch_scc1 .fz_kernel_c_nd
  s_cmp_eq_u32 s3, 0
  s_cbranch_scc1 .fz_kernel_hb75
  s_barrier
  s_sub_u32 s3, s3, 1
.fz_kernel_hb75:
  buffer_load_dwordx4 v[144:147], v21, s[4:7], s33 offen offset:0 sc1
  buffer_load_dwordx4 v[148:151], v21, s[4:7], s33 offen offset:512 sc1
  buffer_load_dwordx4 v[152:155], v21, s[4:7], s33 offen offset:1024 sc1
  buffer_load_dwordx4 v[156:159], v21, s[4:7], s33 offen offset:1536 sc1
  s_mov_b32 s38, 0
.fz_kernel_c_gu:
  s_mov_b32 s46, 0
  s_call_b64 s[0:1], .fz_kernel_hw
  s_waitcnt vmcnt(0)
  v_min3_u32 v9, v144, v146, v148
  v_min3_u32 v9, v9, v150, v152
  v_min3_u32 v9, v9, v154, v156
  v_min_u32 v9, v9, v158
  v_cmp_eq_u32 vcc, 0, v9
  v_add_f32 v160, v144, v148
  v_add_f32 v161, v145, v149
  v_add_f32 v162, v146, v150
  v_add_f32 v163, v147, v151
  s_cbranch_vccnz .fz_kernel_c_gur
.fz_kernel_c_gud:
  v_add_f32 v152, v152, v156
  v_add_f32 v153, v153, v157
  v_add_f32 v154, v154, v158
  v_add_f32 v155, v155, v159
  v_add_f32 v144, v152, v160
  v_add_f32 v145, v153, v161
  v_add_f32 v146, v154, v162
  v_add_f32 v147, v155, v163
  s_nop 0
  v_permlane32_swap_b32 v144, v146
  v_permlane32_swap_b32 v145, v147
  v_mul_f32 v148, v144, v177
  v_mul_f32 v149, v145, v177
  v_exp_f32 v148, v148
  s_cmp_eq_u32 s3, 0
  s_cbranch_scc1 .fz_kernel_hb85
  s_barrier
  s_sub_u32 s3, s3, 1
.fz_kernel_hb85:
  v_exp_f32 v149, v149
  v_mul_f32 v144, v144, v146
  v_add_f32 v148, 1.0, v148
  v_add_f32 v149, 1.0, v149
  v_rcp_f32 v148, v148
  v_rcp_f32 v149, v149
  v_mul_f32 v145, v145, v147
  v_mul_f32 v144, v144, v148
  v_mul_f32 v145, v145, v149
  v_cvt_pk_bf16_f32 v144, v144, v145
  s_waitcnt lgkmcnt(0)
  s_setprio 2
  v_mov_b32 v160, v144
  v_mov_b32 v161, v144 row_ror:15 row_mask:0xf bank_mask:0xf
  v_mov_b32 v162, v144 row_ror:12 row_mask:0xf bank_mask:0xf
  v_mov_b32 v163, v144 row_ror:11 row_mask:0xf bank_mask:0xf
  v_mov_b32 v164, v144 row_ror:8 row_mask:0xf bank_mask:0xf
  v_mov_b32 v165, v144 row_ror:7 row_mask:0xf bank_mask:0xf
  v_mov_b32 v166, v144 row_ror:4 row_mask:0xf bank_mask:0xf
  v_mov_b32 v167, v144 row_ror:3 row_mask:0xf bank_mask:0xf
  v_smfmac_f32_16x16x64_bf16 v[188:191], v[160:163], v[80:87], v8
  v_smfmac_f32_16x16x64_bf16 v[192:195], v[160:163], v[88:95], v8
  v_smfmac_f32_16x16x64_bf16 v[196:199], v[160:163], v[96:103], v8
  v_smfmac_f32_16x16x64_bf16 v[200:203], v[160:163], v[104:111], v8
  v_smfmac_f32_16x16x64_bf16 v[188:191], v[164:167], v[112:119], v8
  v_smfmac_f32_16x16x64_bf16 v[192:195], v[164:167], v[120:127], v8
  v_smfmac_f32_16x16x64_bf16 v[196:199], v[164:167], v[128:135], v8
  v_smfmac_f32_16x16x64_bf16 v[200:203], v[164:167], v[136:143], v8
  s_nop 8
  v_add_f32 v188, v188, v190
  v_add_f32 v189, v192, v194
  v_or_b32 v188, 1, v188
  v_add_f32 v190, v196, v198
  v_add_f32 v191, v200, v202
  v_or_b32 v190, 1, v190
  s_mov_b64 exec, 0xffff
  buffer_store_dwordx4 v[188:191], v3, s[4:7], s39 offen offset:0 sc1
  s_mov_b64 exec, -1
  s_setprio 0
.fz_kernel_c_nd:
  s_cmp_eq_u32 s75, 0
  s_cbranch_scc1 .fz_kernel_c_m0
  s_lshl_b32 s21, s17, 1
  s_add_u32 s21, s21, s20
  s_cmp_lg_u32 s21, 31
  s_cbranch_scc1 .fz_kernel_fin
  s_branch .fz_kernel_c_pp
.fz_kernel_c_m0:
  s_cmp_eq_u32 s79, 0
  s_cselect_b32 s21, 2, 0
  s_add_u32 s3, s3, s21
.fz_kernel_c_pp:
  s_mul_i32 s21, s70, 7168
  s_add_u32 s21, s21, s72
  s_add_u32 s21, s21, 155648
  s_add_u32 s22, s21, 4096
  s_cmp_eq_u32 s3, 0
  s_cbranch_scc1 .fz_kernel_hb76
  s_barrier
  s_sub_u32 s3, s3, 1
.fz_kernel_hb76:
  s_cmp_eq_u32 s3, 0
  s_cbranch_scc1 .fz_kernel_hb77
  s_barrier
  s_sub_u32 s3, s3, 1
.fz_kernel_hb77:
  s_cmp_eq_u32 s3, 0
  s_cbranch_scc1 .fz_kernel_hb78
  s_barrier
  s_sub_u32 s3, s3, 1
.fz_kernel_hb78:
  buffer_load_dwordx4 v[144:147], v3, s[4:7], s21 offen offset:0 sc1
  buffer_load_dwordx4 v[148:151], v3, s[4:7], s21 offen offset:1024 sc1
  buffer_load_dwordx4 v[152:155], v3, s[4:7], s21 offen offset:2048 sc1
  buffer_load_dwordx4 v[156:159], v3, s[4:7], s21 offen offset:3072 sc1
  buffer_load_dwordx4 v[160:163], v3, s[4:7], s22 offen offset:0 sc1
  buffer_load_dwordx4 v[164:167], v3, s[4:7], s22 offen offset:1024 sc1
  buffer_load_dwordx4 v[168:171], v3, s[4:7], s22 offen offset:2048 sc1
  s_mov_b32 s38, 0
.fz_kernel_c_pu:
  s_mov_b32 s46, 0
  s_call_b64 s[0:1], .fz_kernel_hw
  s_waitcnt vmcnt(0)
  v_min3_u32 v9, v144, v146, v148
  v_min3_u32 v9, v9, v150, v152
  v_min3_u32 v9, v9, v154, v156
  v_min3_u32 v9, v9, v158, v160
  v_min3_u32 v9, v9, v162, v164
  v_min3_u32 v9, v9, v166, v168
  v_min_u32 v9, v9, v170
  v_cmp_eq_u32 vcc, 0, v9
  v_add_f32 v236, v144, v148
  v_add_f32 v237, v145, v149
  v_add_f32 v238, v146, v150
  v_add_f32 v239, v147, v151
  s_cbranch_vccnz .fz_kernel_c_pur
.fz_kernel_c_pud:
  v_add_f32 v152, v152, v156
  v_add_f32 v153, v153, v157
  v_add_f32 v154, v154, v158
  v_add_f32 v155, v155, v159
  v_add_f32 v160, v160, v164
  v_add_f32 v161, v161, v165
  v_add_f32 v162, v162, v166
  s_cmp_eq_u32 s3, 0
  s_cbranch_scc1 .fz_kernel_hb86
  s_barrier
  s_sub_u32 s3, s3, 1
.fz_kernel_hb86:
  v_add_f32 v163, v163, v167
  v_add_f32 v236, v236, v168
  v_add_f32 v237, v237, v169
  v_add_f32 v238, v238, v170
  v_add_f32 v239, v239, v171
  v_add_f32 v152, v152, v160
  v_add_f32 v153, v153, v161
  v_add_f32 v154, v154, v162
  v_add_f32 v155, v155, v163
  v_add_f32 v144, v236, v152
  v_add_f32 v146, v238, v154
  v_add_f32 v145, v237, v153
  v_add_f32 v147, v239, v155
  v_permlane32_swap_b32 v144, v146
  s_nop 0
  v_permlane32_swap_b32 v145, v147
  v_add_f32 v144, v144, v146
  v_add_f32 v145, v145, v147
  v_lshlrev_b32 v184, 16, v184
  s_nop 0
  v_permlane16_swap_b32 v144, v145
  v_add_f32 v144, v144, v145
  v_mul_f32 v144, v144, v1
  v_fma_f32 v184, v184, v178, v179
  s_nop 0
  v_mov_b32 v145, v144 quad_perm:[1,0,3,2] row_mask:0xf bank_mask:0xf
  v_cvt_pk_bf16_f32 v144, v144, v145
  s_or_b32 s21, s75, s71
  s_cbranch_scc1 .fz_kernel_c_w7
  s_mul_i32 s21, s20, 384
  s_add_u32 s21, s21, s60
  v_mov_b32 v180, v144
  v_mov_b32 v181, v144 row_ror:12 row_mask:0xf bank_mask:0xf
  v_mov_b32 v182, v144 row_ror:8 row_mask:0xf bank_mask:0xf
  v_mov_b32 v183, v144 row_ror:4 row_mask:0xf bank_mask:0xf
  s_cmp_eq_u32 s3, 0
  s_cbranch_scc1 .fz_kernel_hb80
  s_barrier
  s_sub_u32 s3, s3, 1
.fz_kernel_hb80:
  s_setprio 2
  v_smfmac_f32_16x16x64_bf16 v[212:215], v[180:183], v[32:39], v8
  v_smfmac_f32_16x16x64_bf16 v[216:219], v[180:183], v[40:47], v8
  v_smfmac_f32_16x16x64_bf16 v[220:223], v[180:183], v[48:55], v8
  v_smfmac_f32_16x16x64_bf16 v[224:227], v[180:183], v[56:63], v8
  v_smfmac_f32_16x16x64_bf16 v[228:231], v[180:183], v[64:71], v8
  v_smfmac_f32_16x16x64_bf16 v[232:235], v[180:183], v[72:79], v8
  s_nop 6
  v_add_f32 v212, v212, v214
  v_add_f32 v213, v216, v218
  v_or_b32 v212, 1, v212
  v_add_f32 v214, v220, v222
  v_add_f32 v215, v224, v226
  v_or_b32 v214, 1, v214
  v_add_f32 v216, v228, v230
  v_add_f32 v217, v232, v234
  v_or_b32 v216, 1, v216
  s_mov_b64 exec, 0xffff
  buffer_store_dwordx4 v[212:215], v3, s[4:7], s21 offen offset:0 sc1
  buffer_store_dwordx2 v[216:217], v16, s[4:7], s21 offen offset:256 sc1
  s_mov_b64 exec, -1
  s_setprio 0
  s_cmp_lg_u32 s20, 0
  s_cbranch_scc1 .fz_kernel_c_w7
  s_cmp_eq_u32 s79, 0
  s_cbranch_scc1 .fz_kernel_c_no2
  v_add_u32 v13, 155648, v3
  s_lshl_b32 s21, s18, 14
  s_add_u32 s21, s21, 0x1c84000
  s_add_u32 s22, s21, 4096
  s_add_u32 s23, s21, 8192
  s_add_u32 s24, s21, 12288
  v_rcp_f32 v144, v178
  v_lshlrev_b32 v146, 1, v2
  v_sub_u32 v146, s79, v146
  v_cmp_eq_u32 s[28:29], 1, v146
  v_cmp_eq_u32 s[30:31], 2, v146
  s_nop 0
  v_cndmask_b32 v148, 0, v144, s[28:29]
  v_cndmask_b32 v149, 0, v144, s[30:31]
  v_mov_b32 v9, 159952
  v_mov_b32 v7, s79
  ds_write_b32 v9, v7
  ds_write_b64 v26, v[148:149] offset:512
  s_lshl_b32 s25, s79, 2
  s_add_u32 s25, s25, 155644
  s_cmp_eq_u32 s3, 0
  s_cbranch_scc1 .fz_kernel_hb87
  s_barrier
  s_sub_u32 s3, s3, 1
.fz_kernel_hb87:
  v_mov_b32 v7, s25
  v_mov_b32 v152, 0
  v_mov_b32 v153, 0
  v_mov_b32 v154, 0
  v_mov_b32 v155, 0
  s_bfm_b64 exec, 49, 0
  s_mov_b32 s38, 0
  s_mov_b32 s25, 15
.fz_kernel_c_pw:
  s_cmp_le_u32 s3, 3
  s_cbranch_scc1 .fz_kernel_c_pw1
  s_barrier
  s_sub_u32 s3, s3, 1
  s_branch .fz_kernel_c_pw
.fz_kernel_c_pw1:
  s_setprio 2
.fz_kernel_c_pd:
  s_bitcmp1_b32 s25, 0
  s_cbranch_scc0 .fz_kernel_c_pl0
  buffer_load_dwordx4 v[80:83], v3, s[4:7], s21 offen offset:0 sc1
  buffer_load_dwordx4 v[84:87], v3, s[4:7], s21 offen offset:1024 sc1
  buffer_load_dwordx4 v[88:91], v3, s[4:7], s21 offen offset:2048 sc1
  buffer_load_dwordx4 v[92:95], v3, s[4:7], s21 offen offset:3072 sc1
.fz_kernel_c_pl0:
  s_bitcmp1_b32 s25, 1
  s_cbranch_scc0 .fz_kernel_c_pl1
  buffer_load_dwordx4 v[96:99], v3, s[4:7], s22 offen offset:0 sc1
  buffer_load_dwordx4 v[100:103], v3, s[4:7], s22 offen offset:1024 sc1
  buffer_load_dwordx4 v[104:107], v3, s[4:7], s22 offen offset:2048 sc1
  buffer_load_dwordx4 v[108:111], v3, s[4:7], s22 offen offset:3072 sc1
.fz_kernel_c_pl1:
  s_bitcmp1_b32 s25, 2
  s_cbranch_scc0 .fz_kernel_c_pl2
  buffer_load_dwordx4 v[112:115], v3, s[4:7], s23 offen offset:0 sc1
  buffer_load_dwordx4 v[116:119], v3, s[4:7], s23 offen offset:1024 sc1
  buffer_load_dwordx4 v[120:123], v3, s[4:7], s23 offen offset:2048 sc1
  buffer_load_dwordx4 v[124:127], v3, s[4:7], s23 offen offset:3072 sc1
.fz_kernel_c_pl2:
  s_bitcmp1_b32 s25, 3
  s_cbranch_scc0 .fz_kernel_c_pl3
  buffer_load_dwordx4 v[128:131], v3, s[4:7], s24 offen offset:0 sc1
  buffer_load_dwordx4 v[132:135], v3, s[4:7], s24 offen offset:1024 sc1
  buffer_load_dwordx4 v[136:139], v3, s[4:7], s24 offen offset:2048 sc1
  buffer_load_dwordx4 v[140:143], v3, s[4:7], s24 offen offset:3072 sc1
.fz_kernel_c_pl3:
  s_add_u32 s38, s38, 1
  s_mov_b32 s46, 0
  s_call_b64 s[0:1], .fz_kernel_hw
  s_waitcnt vmcnt(0)
  s_bitcmp1_b32 s25, 0
  s_cbranch_scc0 .fz_kernel_c_pa0
  v_min3_u32 v9, v80, v82, v84
  v_min3_u32 v9, v9, v86, v88
  v_min3_u32 v9, v9, v90, v92
  v_min_u32 v9, v9, v94
  v_cmp_eq_u32 vcc, 0, v9
  v_add_f32 v80, v80, v84
  v_add_f32 v81, v81, v85
  v_add_f32 v82, v82, v86
  v_add_f32 v83, v83, v87
  s_cbranch_vccnz .fz_kernel_c_pa0
  v_add_f32 v88, v88, v92
  v_add_f32 v89, v89, v93
  v_add_f32 v90, v90, v94
  v_add_f32 v91, v91, v95
  v_add_f32 v152, v152, v80
  v_add_f32 v153, v153, v81
  v_add_f32 v154, v154, v82
  v_add_f32 v155, v155, v83
  v_add_f32 v152, v152, v88
  v_add_f32 v153, v153, v89
  v_add_f32 v154, v154, v90
  v_add_f32 v155, v155, v91
  s_bitset0_b32 s25, 0
.fz_kernel_c_pa0:
  s_bitcmp1_b32 s25, 1
  s_cbranch_scc0 .fz_kernel_c_pa1
  v_min3_u32 v9, v96, v98, v100
  v_min3_u32 v9, v9, v102, v104
  v_min3_u32 v9, v9, v106, v108
  v_min_u32 v9, v9, v110
  v_cmp_eq_u32 vcc, 0, v9
  v_add_f32 v96, v96, v100
  v_add_f32 v97, v97, v101
  v_add_f32 v98, v98, v102
  v_add_f32 v99, v99, v103
  s_cbranch_vccnz .fz_kernel_c_pa1
  v_add_f32 v104, v104, v108
  v_add_f32 v105, v105, v109
  v_add_f32 v106, v106, v110
  v_add_f32 v107, v107, v111
  v_add_f32 v152, v152, v96
  v_add_f32 v153, v153, v97
  v_add_f32 v154, v154, v98
  v_add_f32 v155, v155, v99
  v_add_f32 v152, v152, v104
  v_add_f32 v153, v153, v105
  v_add_f32 v154, v154, v106
  v_add_f32 v155, v155, v107
  s_bitset0_b32 s25, 1
.fz_kernel_c_pa1:
  s_bitcmp1_b32 s25, 2
  s_cbranch_scc0 .fz_kernel_c_pa2
  v_min3_u32 v9, v112, v114, v116
  v_min3_u32 v9, v9, v118, v120
  v_min3_u32 v9, v9, v122, v124
  v_min_u32 v9, v9, v126
  v_cmp_eq_u32 vcc, 0, v9
  v_add_f32 v112, v112, v116
  v_add_f32 v113, v113, v117
  v_add_f32 v114, v114, v118
  v_add_f32 v115, v115, v119
  s_cbranch_vccnz .fz_kernel_c_pa2
  v_add_f32 v120, v120, v124
  v_add_f32 v121, v121, v125
  v_add_f32 v122, v122, v126
  v_add_f32 v123, v123, v127
  v_add_f32 v152, v152, v112
  v_add_f32 v153, v153, v113
  v_add_f32 v154, v154, v114
  v_add_f32 v155, v155, v115
  v_add_f32 v152, v152, v120
  v_add_f32 v153, v153, v121
  v_add_f32 v154, v154, v122
  v_add_f32 v155, v155, v123
  s_bitset0_b32 s25, 2
.fz_kernel_c_pa2:
  s_bitcmp1_b32 s25, 3
  s_cbranch_scc0 .fz_kernel_c_pa3
  v_min3_u32 v9, v128, v130, v132
  v_min3_u32 v9, v9, v134, v136
  v_min3_u32 v9, v9, v138, v140
  v_min_u32 v9, v9, v142
  v_cmp_eq_u32 vcc, 0, v9
  v_add_f32 v128, v128, v132
  v_add_f32 v129, v129, v133
  v_add_f32 v130, v130, v134
  v_add_f32 v131, v131, v135
  s_cbranch_vccnz .fz_kernel_c_pa3
  v_add_f32 v136, v136, v140
  v_add_f32 v137, v137, v141
  v_add_f32 v138, v138, v142
  v_add_f32 v139, v139, v143
  v_add_f32 v152, v152, v128
  v_add_f32 v153, v153, v129
  v_add_f32 v154, v154, v130
  v_add_f32 v155, v155, v131
  v_add_f32 v152, v152, v136
  v_add_f32 v153, v153, v137
  v_add_f32 v154, v154, v138
  v_add_f32 v155, v155, v139
  s_bitset0_b32 s25, 3
.fz_kernel_c_pa3:
  s_cmp_eq_u32 s25, 0
  s_cbranch_scc1 .fz_kernel_c_pdd
  s_cmp_lt_u32 s38, 131072
  s_cbranch_scc1 .fz_kernel_c_pd
.fz_kernel_c_pdd:
  s_mov_b32 exec_hi, 0xffff
  ds_write_b128 v13, v[152:155] offset:1536
  s_mov_b64 exec, -1
  v_readlane_b32 s21, v152, 48
  v_readlane_b32 s22, v154, 48
  s_nop 0
  v_mul_f32 v144, s21, v23
  v_fma_f32 v145, s22, v23, v25
  v_fma_f32 v145, -v144, v144, v145
  v_rsq_f32 v145, abs(v145)
  v_sub_f32 v144, v179, v144
  v_mul_f32 v146, v145, v178
  v_mul_f32 v147, v145, v144
  ds_write_b32 v7, v146 offset:4608
  ds_write_b32 v7, v147 offset:5120
  s_waitcnt lgkmcnt(0)
  s_add_u32 s3, s3, 2
  s_setprio 0
.fz_kernel_c_no2:
  s_branch .fz_kernel_q_he
.fz_kernel_c_w7:
  s_setprio 2
  v_lshlrev_b32 v144, 16, v144
  s_cmp_lg_u32 s71, 0
  s_cbranch_scc1 .fz_kernel_c_eu
  v_add_f32 v184, v184, v144
  s_cmp_lg_u32 s75, 0
  s_cbranch_scc1 .fz_kernel_c_t3
  v_mul_f32 v146, v184, v184
  v_lshrrev_b32 v9, 5, v2
  v_lshlrev_b32 v9, 3, v9
  v_permlane32_swap_b32 v184, v146
  v_add_f32 v184, v184, v146
  s_nop 1
  v_add_f32 v184, v184, v184 row_ror:8 row_mask:0xf bank_mask:0xf
  s_nop 1
  v_add_f32 v184, v184, v184 row_ror:4 row_mask:0xf bank_mask:0xf
  s_nop 1
  v_add_f32 v184, v184, v184 row_ror:2 row_mask:0xf bank_mask:0xf
  s_nop 1
  v_add_f32 v184, v184, v184 row_ror:1 row_mask:0xf bank_mask:0xf
  s_nop 1
  v_add_f32 v184, v184, v184 row_bcast:15 row_mask:0xa bank_mask:0xf
  v_or_b32 v184, 1, v184
  s_mov_b32 exec_lo, 0x10000
  s_mov_b32 exec_hi, 0x10000
  buffer_store_dword v184, v9, s[4:7], s60 offen offset:768 sc1
  s_mov_b64 exec, -1
  s_setprio 0
  s_cmp_eq_u32 s79, 0
  s_cbranch_scc1 .fz_kernel_q_he
  s_add_u32 s3, s3, 2
  s_mov_b32 s71, 1
  s_mov_b32 s70, s18
.fz_kernel_c_e0:
  s_cmp_eq_u32 s3, 0
  s_cbranch_scc1 .fz_kernel_c_pp
  s_barrier
  s_sub_u32 s3, s3, 1
  s_branch .fz_kernel_c_e0
.fz_kernel_c_eu:
  v_lshlrev_b32 v9, 2, v2
  v_add_u32 v9, 155648, v9
  ds_write_b32 v9, v144 offset:7424
  s_waitcnt lgkmcnt(0)
  s_branch .fz_kernel_q_he
.fz_kernel_c_t3:
  s_mov_b32 s28, s56
  s_mov_b32 s29, s57
  s_mov_b32 s30, 0x400000
  s_mov_b32 s31, 0x00020000
  v_cvt_pk_bf16_f32 v144, v184, v184
  v_lshlrev_b32 v9, 1, v2
  s_lshl_b32 s21, s77, 11
  s_lshl_b32 s22, s18, 7
  s_add_u32 s21, s21, s22
  buffer_store_short v144, v9, s[28:31], s21 offen
.fz_kernel_fin:
.fz_kernel_end:
  s_endpgm
.fz_kernel_pick:
  s_mov_b32 s38, 0
.fz_kernel_pick_l:
  ds_read_b32 v7, v6
  s_add_u32 s38, s38, 1
  s_waitcnt lgkmcnt(0)
  v_readfirstlane_b32 s33, v7
  s_cmp_lt_u32 s38, 1048576
  s_cselect_b32 s33, s33, 0xffff
  s_andn2_b32 s36, s33, s34
  s_cbranch_scc0 .fz_kernel_pick_l
  s_or_b32 s34, s34, s33
  s_setpc_b64 s[68:69]
.fz_kernel_hw:
  s_mov_b32 s47, 0
.fz_kernel_hwl:
  s_getreg_b32 s100, hwreg(HW_REG_IB_STS)
  s_bfe_u32 s101, s100, 0x20016
  s_and_b32 s100, s100, 15
  s_lshl4_add_u32 s100, s101, s100
  s_cmp_le_u32 s100, s46
  s_cbranch_scc1 .fz_kernel_hwr
  s_sub_u32 s47, s47, 1
  s_cbranch_scc0 .fz_kernel_hwl
  s_cmp_eq_u32 s3, 0
  s_cbranch_scc1 .fz_kernel_hwr
  s_cmp_eq_u32 s3, 32
  s_cbranch_scc1 .fz_kernel_hwp
.fz_kernel_hwb:
  s_barrier
  s_sub_u32 s3, s3, 1
  s_mov_b32 s47, 2
  s_branch .fz_kernel_hwl
.fz_kernel_hwr:
  s_setpc_b64 s[0:1]
  .fz_kernel_hwp:
  ds_read_b32 v27, v6 offset:0x110
  s_mov_b32 s47, 0
  s_waitcnt lgkmcnt(0)
  v_readfirstlane_b32 s100, v27
  s_cmp_ge_u32 s100, 0x200
  s_cbranch_scc1 .fz_kernel_hwb
  s_branch .fz_kernel_hwl
.fz_kernel_q_cons2:
  s_setprio 0
  s_lshr_b32 s26, s16, 1
  s_lshl_b32 s28, s26, 13
  v_add_u32 v8, s28, v3
  v_add_u32 v9, 1024, v8
  v_mov_b32 v232, v20
  v_mov_b32 v233, v21
  v_mov_b32 v234, v22
  v_mov_b32 v235, v23
  v_mov_b32 v236, v24
  v_mov_b32 v237, v25
  v_mov_b32 v238, v26
  v_mov_b32 v239, v27
  v_mov_b32 v240, v28
  v_mov_b32 v241, v29
  v_mov_b32 v242, v30
  v_mov_b32 v243, v31
  v_mov_b32 v244, v32
  v_mov_b32 v245, v33
  v_mov_b32 v246, v34
  v_mov_b32 v247, v35
  s_branch .fz_kernel_q_cs
.fz_kernel_q_patch:
  s_mul_i32 s31, s27, 384
  s_add_u32 s31, s31, 155648
  v_and_b32 v73, 48, v2
  v_lshlrev_b32 v73, 2, v73
  v_add_u32 v73, s31, v73
  v_and_b32 v75, 15, v2
  v_lshlrev_b32 v75, 3, v75
  v_add_u32 v75, s31, v75
  ds_read_b32 v72, v22 offset:512
  ds_read_b32 v74, v22 offset:576
  ds_read_b32 v76, v22 offset:640
  ds_read_b32 v78, v22 offset:704
  ds_read_b128 v[80:83], v73 offset:1536
  ds_read_b128 v[84:87], v73 offset:1552
  ds_read_b128 v[88:91], v73 offset:1568
  ds_read_b128 v[92:95], v73 offset:1584
  s_waitcnt lgkmcnt(0)
  v_fmac_f32 v160, v82, v72
  v_fmac_f32 v161, v86, v72
  v_fmac_f32 v162, v90, v72
  v_fmac_f32 v163, v94, v72
  v_fmac_f32 v164, v82, v74
  v_fmac_f32 v165, v86, v74
  v_fmac_f32 v166, v90, v74
  v_fmac_f32 v167, v94, v74
  v_fmac_f32 v168, v82, v76
  v_fmac_f32 v169, v86, v76
  v_fmac_f32 v170, v90, v76
  v_fmac_f32 v171, v94, v76
  v_fmac_f32 v172, v82, v78
  v_fmac_f32 v173, v86, v78
  v_fmac_f32 v174, v90, v78
  v_fmac_f32 v175, v94, v78
  v_fmac_f32 v176, v83, v72
  v_fmac_f32 v177, v87, v72
  v_fmac_f32 v178, v91, v72
  v_fmac_f32 v179, v95, v72
  v_fmac_f32 v180, v83, v74
  v_fmac_f32 v181, v87, v74
  v_fmac_f32 v182, v91, v74
  v_fmac_f32 v183, v95, v74
  v_fmac_f32 v184, v83, v76
  v_fmac_f32 v185, v87, v76
  v_fmac_f32 v186, v91, v76
  v_fmac_f32 v187, v95, v76
  v_fmac_f32 v188, v83, v78
  v_fmac_f32 v189, v87, v78
  v_fmac_f32 v190, v91, v78
  v_fmac_f32 v191, v95, v78
  v_fmac_f32 v128, v80, v72
  v_fmac_f32 v129, v84, v72
  v_fmac_f32 v130, v88, v72
  v_fmac_f32 v131, v92, v72
  v_fmac_f32 v132, v80, v74
  v_fmac_f32 v133, v84, v74
  v_fmac_f32 v134, v88, v74
  v_fmac_f32 v135, v92, v74
  v_fmac_f32 v136, v80, v76
  v_fmac_f32 v137, v84, v76
  v_fmac_f32 v138, v88, v76
  v_fmac_f32 v139, v92, v76
  v_fmac_f32 v140, v80, v78
  v_fmac_f32 v141, v84, v78
  v_fmac_f32 v142, v88, v78
  v_fmac_f32 v143, v92, v78
  v_fmac_f32 v144, v81, v72
  v_fmac_f32 v145, v85, v72
  v_fmac_f32 v146, v89, v72
  v_fmac_f32 v147, v93, v72
  v_fmac_f32 v148, v81, v74
  v_fmac_f32 v149, v85, v74
  v_fmac_f32 v150, v89, v74
  v_fmac_f32 v151, v93, v74
  v_fmac_f32 v152, v81, v76
  v_fmac_f32 v153, v85, v76
  v_fmac_f32 v154, v89, v76
  v_fmac_f32 v155, v93, v76
  v_fmac_f32 v156, v81, v78
  v_fmac_f32 v157, v85, v78
  v_fmac_f32 v158, v89, v78
  v_fmac_f32 v159, v93, v78
  ds_read_b128 v[80:83], v23 offset:512
  ds_read_b128 v[84:87], v23 offset:576
  ds_read_b128 v[88:91], v23 offset:640
  ds_read_b128 v[92:95], v23 offset:704
  ds_read_b64 v[72:73], v75 offset:1792
  s_waitcnt lgkmcnt(0)
  v_fmac_f32 v192, v80, v72
  v_fmac_f32 v193, v81, v72
  v_fmac_f32 v194, v82, v72
  v_fmac_f32 v195, v83, v72
  v_fmac_f32 v196, v84, v72
  v_fmac_f32 v197, v85, v72
  v_fmac_f32 v198, v86, v72
  v_fmac_f32 v199, v87, v72
  v_fmac_f32 v200, v88, v72
  v_fmac_f32 v201, v89, v72
  v_fmac_f32 v202, v90, v72
  v_fmac_f32 v203, v91, v72
  v_fmac_f32 v204, v92, v72
  v_fmac_f32 v205, v93, v72
  v_fmac_f32 v206, v94, v72
  v_fmac_f32 v207, v95, v72
  v_fmac_f32 v208, v80, v73
  v_fmac_f32 v209, v81, v73
  v_fmac_f32 v210, v82, v73
  v_fmac_f32 v211, v83, v73
  v_fmac_f32 v212, v84, v73
  v_fmac_f32 v213, v85, v73
  v_fmac_f32 v214, v86, v73
  v_fmac_f32 v215, v87, v73
  v_fmac_f32 v216, v88, v73
  v_fmac_f32 v217, v89, v73
  v_fmac_f32 v218, v90, v73
  v_fmac_f32 v219, v91, v73
  v_fmac_f32 v220, v92, v73
  v_fmac_f32 v221, v93, v73
  v_fmac_f32 v222, v94, v73
  v_fmac_f32 v223, v95, v73
  s_branch .fz_kernel_q_pback
.fz_kernel_q_prod2:
  s_setprio 0
  s_mov_b64 s[8:9], s[4:5]
  s_mov_b64 s[10:11], s[6:7]
  s_mov_b64 s[12:13], s[42:43]
  s_lshl_b32 s35, s17, 6
  s_and_b32 s31, s16, 1
  s_add_u32 s35, s35, s31
  s_lshl_b32 s35, s35, 12
  s_add_u32 s35, s35, s73
  s_lshr_b32 s33, s17, 3
  s_add_u32 s29, s18, s33
  s_lshl1_add_u32 s29, s17, s29
  s_and_b32 s29, s29, 15
  s_mov_b32 s22, 16384
  s_mov_b32 s23, 8192
  s_mov_b32 s36, 0
  s_add_u32 s37, s19, s74
  s_add_u32 s37, s37, 8
  v_mov_b32 v40, v3
  v_mov_b32 v41, v3
  v_mov_b32 v42, v3
  v_mov_b32 v43, v3
  s_branch .fz_kernel_q_pc
.fz_kernel_xok1w:
  s_call_b64 s[68:69], .fz_kernel_q_xw
  s_branch .fz_kernel_xok1
.fz_kernel_xok2w:
  s_call_b64 s[68:69], .fz_kernel_q_xw
  s_branch .fz_kernel_xok2
.fz_kernel_q_xw:
  s_mov_b64 exec, 1
  s_mov_b32 s38, 0
.fz_kernel_q_xwl:
  ds_read_b32 v11, v6 offset:0x114
  s_add_u32 s38, s38, 1
  s_waitcnt lgkmcnt(0)
  v_readfirstlane_b32 s36, v11
  s_bitcmp1_b32 s36, s24
  s_cbranch_scc1 .fz_kernel_q_xwd
  s_cmp_lt_u32 s38, 1048576
  s_cbranch_scc1 .fz_kernel_q_xwl
  s_mov_b32 s36, -1
.fz_kernel_q_xwd:
  s_mov_b64 exec, -1
  s_nop 4
  s_setpc_b64 s[68:69]
.fz_kernel_xok3w:
  s_call_b64 s[68:69], .fz_kernel_q_xw
  s_branch .fz_kernel_xok3
.fz_kernel_lz26a:
  v_lshlrev_b32 v16, 3, v2
  buffer_atomic_and_x2 v[12:13], v16, s[4:7], s36 offen offset:0 sc1
  buffer_atomic_and_x2 v[12:13], v16, s[4:7], s36 offen offset:512 sc1
  buffer_atomic_and_x2 v[12:13], v16, s[4:7], s36 offen offset:1024 sc1
  buffer_atomic_and_x2 v[12:13], v16, s[4:7], s36 offen offset:1536 sc1
  buffer_atomic_and_x2 v[12:13], v16, s[4:7], s36 offen offset:2048 sc1
  buffer_atomic_and_x2 v[12:13], v16, s[4:7], s36 offen offset:2560 sc1
  buffer_atomic_and_x2 v[12:13], v16, s[4:7], s36 offen offset:3072 sc1
  buffer_atomic_and_x2 v[12:13], v16, s[4:7], s36 offen offset:3584 sc1
  s_branch .fz_kernel_lz26
.fz_kernel_a_pick:
  s_mov_b32 s38, 0
.fz_kernel_a_pickl:
  ds_read_b32 v7, v6
  s_add_u32 s38, s38, 1
  s_waitcnt lgkmcnt(0)
  v_readfirstlane_b32 s33, v7
  s_cmp_lt_u32 s38, 1048576
  s_cselect_b32 s33, s33, 0xffff
  s_andn2_b32 s36, s33, s34
  s_cbranch_scc0 .fz_kernel_a_pickl
  s_or_b32 s34, s34, s33
  s_ff1_i32_b32 s33, s36
  s_bitset0_b32 s36, s33
  s_lshl_b32 s33, s33, 14
  s_add_u32 s30, s33, s35
  s_setpc_b64 s[68:69]
.fz_kernel_pk33c:
  v_mov_b32 v7, s34
  s_brev_b32 s30, 2
  s_cmp_eq_u32 s34, 0xffff
  ds_write_b32 v6, v7 offset:0x104
  s_cbranch_scc1 .fz_kernel_pk33
  s_call_b64 s[68:69], .fz_kernel_a_pick
  s_branch .fz_kernel_pk33
.fz_kernel_pk34c:
  v_mov_b32 v7, s34
  s_brev_b32 s30, 2
  s_cmp_eq_u32 s34, 0xffff
  ds_write_b32 v6, v7 offset:0x104
  s_cbranch_scc1 .fz_kernel_pk34
  s_call_b64 s[68:69], .fz_kernel_a_pick
  s_branch .fz_kernel_pk34
.fz_kernel_pk35c:
  v_mov_b32 v7, s34
  s_brev_b32 s30, 2
  s_cmp_eq_u32 s34, 0xffff
  ds_write_b32 v6, v7 offset:0x104
  s_cbranch_scc1 .fz_kernel_pk35
  s_call_b64 s[68:69], .fz_kernel_a_pick
  s_branch .fz_kernel_pk35
.fz_kernel_pk38c:
  v_mov_b32 v7, s34
  s_brev_b32 s30, 2
  s_cmp_eq_u32 s34, 0xffff
  ds_write_b32 v6, v7 offset:0x104
  s_cbranch_scc1 .fz_kernel_pk38
  s_call_b64 s[68:69], .fz_kernel_a_pick
  s_branch .fz_kernel_pk38
.fz_kernel_pk39c:
  v_mov_b32 v7, s34
  s_brev_b32 s30, 2
  s_cmp_eq_u32 s34, 0xffff
  ds_write_b32 v6, v7 offset:0x104
  s_cbranch_scc1 .fz_kernel_pk39
  s_call_b64 s[68:69], .fz_kernel_a_pick
  s_branch .fz_kernel_pk39
.fz_kernel_a_slow:
  s_cmp_lg_u32 s73, 0
  s_cbranch_scc1 .fz_kernel_a_ok
  s_mov_b32 s73, 1
  s_and_b32 s39, s16, 1
  v_mov_b32 v16, v32
  v_mov_b32 v17, v33
  v_mov_b32 v18, v34
  v_mov_b32 v19, v35
  v_mov_b32 v20, v36
  v_mov_b32 v21, v37
  v_mov_b32 v22, v38
  v_mov_b32 v23, v39
  s_call_b64 s[68:69], .fz_kernel_a_sl
  v_mov_b32 v176, v144
  v_mov_b32 v177, v145
  v_mov_b32 v178, v146
  v_mov_b32 v179, v147
  v_mov_b32 v180, v148
  v_mov_b32 v181, v149
  v_mov_b32 v182, v150
  v_mov_b32 v183, v151
  v_mov_b32 v184, v152
  v_mov_b32 v185, v153
  v_mov_b32 v186, v154
  v_mov_b32 v187, v155
  v_mov_b32 v188, v156
  v_mov_b32 v189, v157
  v_mov_b32 v190, v158
  v_mov_b32 v191, v159
  v_mov_b32 v24, v25
  v_mov_b32 v16, v40
  v_mov_b32 v17, v41
  v_mov_b32 v18, v42
  v_mov_b32 v19, v43
  v_mov_b32 v20, v44
  v_mov_b32 v21, v45
  v_mov_b32 v22, v46
  v_mov_b32 v23, v47
  s_call_b64 s[68:69], .fz_kernel_a_sl
  v_mov_b32 v192, v144
  v_mov_b32 v193, v145
  v_mov_b32 v194, v146
  v_mov_b32 v195, v147
  v_mov_b32 v196, v148
  v_mov_b32 v197, v149
  v_mov_b32 v198, v150
  v_mov_b32 v199, v151
  v_mov_b32 v200, v152
  v_mov_b32 v201, v153
  v_mov_b32 v202, v154
  v_mov_b32 v203, v155
  v_mov_b32 v204, v156
  v_mov_b32 v205, v157
  v_mov_b32 v206, v158
  v_mov_b32 v207, v159
  v_rcp_f32 v26, v24
  v_cmp_le_f32 vcc, s24, v24
  s_and_b64 s[36:37], s[36:37], vcc
  v_cmp_ge_f32 vcc, s25, v24
  s_and_b64 s[36:37], s[36:37], vcc
  v_pk_mul_f32 v[176:177], v[176:177], v[26:27] op_sel_hi:[1,0]
  v_pk_mul_f32 v[178:179], v[178:179], v[26:27] op_sel_hi:[1,0]
  v_pk_mul_f32 v[180:181], v[180:181], v[26:27] op_sel_hi:[1,0]
  v_pk_mul_f32 v[182:183], v[182:183], v[26:27] op_sel_hi:[1,0]
  v_cvt_pk_bf16_f32 v80, v176, v177
  v_cvt_pk_bf16_f32 v81, v178, v179
  v_cvt_pk_bf16_f32 v82, v180, v181
  v_cvt_pk_bf16_f32 v83, v182, v183
  buffer_store_dwordx4 v[80:83], v3, s[4:7], s8 offen offset:0 sc1
  v_pk_mul_f32 v[184:185], v[184:185], v[26:27] op_sel_hi:[1,0]
  v_pk_mul_f32 v[186:187], v[186:187], v[26:27] op_sel_hi:[1,0]
  v_pk_mul_f32 v[188:189], v[188:189], v[26:27] op_sel_hi:[1,0]
  v_pk_mul_f32 v[190:191], v[190:191], v[26:27] op_sel_hi:[1,0]
  v_cvt_pk_bf16_f32 v84, v184, v185
  v_cvt_pk_bf16_f32 v85, v186, v187
  v_cvt_pk_bf16_f32 v86, v188, v189
  v_cvt_pk_bf16_f32 v87, v190, v191
  buffer_store_dwordx4 v[84:87], v3, s[4:7], s8 offen offset:1024 sc1
  s_branch .fz_kernel_a_fin
.fz_kernel_a_sl:
  s_waitcnt vmcnt(0)
  s_lshl_b32 s23, s18, 1
  s_add_u32 s23, s23, s39
  s_lshl_b32 s23, s23, 18
  s_add_u32 s23, s23, s63
  s_mov_b32 s30, s23
  s_mov_b32 s33, 64
  v_mov_b32 v27, 0xff800000
.fz_kernel_a_s1:
  buffer_load_dwordx4 v[80:83], v3, s[4:7], s30 offen offset:0
  buffer_load_dwordx4 v[84:87], v3, s[4:7], s30 offen offset:1024
  s_waitcnt vmcnt(0)
  v_mfma_f32_32x32x16_bf16 v[48:63], v[80:83], v[16:19], 0
  v_mfma_f32_32x32x16_bf16 v[48:63], v[84:87], v[20:23], v[48:63]
  s_nop 11
  v_max3_f32 v27, v27, v48, v49
  v_max3_f32 v27, v27, v50, v51
  v_max3_f32 v27, v27, v52, v53
  v_max3_f32 v27, v27, v54, v55
  v_max3_f32 v27, v27, v56, v57
  v_max3_f32 v27, v27, v58, v59
  v_max3_f32 v27, v27, v60, v61
  v_max3_f32 v27, v27, v62, v63
  s_add_u32 s30, s30, 4096
  s_sub_u32 s33, s33, 1
  s_cmp_lg_u32 s33, 0
  s_cbranch_scc1 .fz_kernel_a_s1
  v_mov_b32 v29, v27
  s_nop 1
  v_permlane32_swap_b32 v29, v27
  v_max_f32 v27, v27, v29
  v_sub_f32 v27, 0, v27
  v_mov_b32 v64, v27
  v_mov_b32 v144, 0
  v_mov_b32 v65, v27
  v_mov_b32 v145, 0
  v_mov_b32 v66, v27
  v_mov_b32 v146, 0
  v_mov_b32 v67, v27
  v_mov_b32 v147, 0
  v_mov_b32 v68, v27
  v_mov_b32 v148, 0
  v_mov_b32 v69, v27
  v_mov_b32 v149, 0
  v_mov_b32 v70, v27
  v_mov_b32 v150, 0
  v_mov_b32 v71, v27
  v_mov_b32 v151, 0
  v_mov_b32 v72, v27
  v_mov_b32 v152, 0
  v_mov_b32 v73, v27
  v_mov_b32 v153, 0
  v_mov_b32 v74, v27
  v_mov_b32 v154, 0
  v_mov_b32 v75, v27
  v_mov_b32 v155, 0
  v_mov_b32 v76, v27
  v_mov_b32 v156, 0
  v_mov_b32 v77, v27
  v_mov_b32 v157, 0
  v_mov_b32 v78, v27
  v_mov_b32 v158, 0
  v_mov_b32 v79, v27
  v_mov_b32 v159, 0
  v_mov_b32 v208, 0
  v_mov_b32 v209, 0
  v_mov_b32 v210, 0
  v_mov_b32 v211, 0
  s_mov_b32 s30, s23
  s_mov_b32 s33, 64
.fz_kernel_a_s2:
  buffer_load_dwordx4 v[80:83], v3, s[4:7], s30 offen offset:0
  buffer_load_dwordx4 v[84:87], v3, s[4:7], s30 offen offset:1024
  buffer_load_dwordx4 v[88:91], v3, s[4:7], s30 offen offset:2048
  buffer_load_dwordx4 v[92:95], v3, s[4:7], s30 offen offset:3072
  s_waitcnt vmcnt(0)
  v_mfma_f32_32x32x16_bf16 v[48:63], v[80:83], v[16:19], v[64:79]
  v_mfma_f32_32x32x16_bf16 v[48:63], v[84:87], v[20:23], v[48:63]
  s_nop 11
  v_exp_f32 v48, v48
  v_exp_f32 v49, v49
  v_exp_f32 v50, v50
  v_exp_f32 v51, v51
  v_exp_f32 v52, v52
  v_exp_f32 v53, v53
  v_exp_f32 v54, v54
  v_exp_f32 v55, v55
  v_exp_f32 v56, v56
  v_exp_f32 v57, v57
  v_exp_f32 v58, v58
  v_exp_f32 v59, v59
  v_exp_f32 v60, v60
  v_exp_f32 v61, v61
  v_exp_f32 v62, v62
  v_exp_f32 v63, v63
  v_cvt_pk_bf16_f32 v224, v48, v49
  v_cvt_pk_bf16_f32 v225, v50, v51
  v_cvt_pk_bf16_f32 v226, v52, v53
  v_cvt_pk_bf16_f32 v227, v54, v55
  v_cvt_pk_bf16_f32 v228, v56, v57
  v_cvt_pk_bf16_f32 v229, v58, v59
  v_cvt_pk_bf16_f32 v230, v60, v61
  v_cvt_pk_bf16_f32 v231, v62, v63
  v_mfma_f32_32x32x16_bf16 v[144:159], v[88:91], v[224:227], v[144:159]
  s_nop 0
  v_mfma_f32_32x32x16_bf16 v[144:159], v[92:95], v[228:231], v[144:159]
  v_smfmac_f32_16x16x64_bf16 v[208:211], v[12:15], v[224:231], v11
  s_add_u32 s30, s30, 4096
  s_sub_u32 s33, s33, 1
  s_cmp_lg_u32 s33, 0
  s_cbranch_scc1 .fz_kernel_a_s2
  s_nop 7
  v_add_f32 v208, v208, v210
  v_add_f32 v209, v209, v211
  v_cndmask_b32 v25, v208, v209, s[20:21]
  s_nop 7
  s_setpc_b64 s[68:69]
.fz_kernel_serv:
  s_setprio 3
  s_mov_b32 s24, s44
  s_mov_b32 s25, s45
  s_mov_b32 s26, 0x200000
  s_mov_b32 s27, 0x00020000
  v_lshrrev_b32 v8, 3, v2
  v_and_b32 v9, 7, v2
  v_bfe_u32 v10, v2, 4, 1
  v_lshlrev_b32 v10, 2, v10
  v_xor_b32 v9, v9, v10
  v_lshlrev_b32 v9, 4, v9
  v_lshl_add_u32 v10, v8, 11, v9
  s_cmp_eq_u32 s16, 5
  s_cbranch_scc1 .fz_kernel_sv1
  s_barrier
  v_lshlrev_b32 v7, 7, v2
  s_lshl_b32 s31, s18, 11
  s_lshl_b32 s33, 1, s17
  s_add_u32 s31, s31, s67
  s_add_u32 s31, s31, 0x1800000
  v_mov_b32 v8, s33
  s_mov_b64 exec, 0xffff
  s_mov_b32 s38, 0
.fz_kernel_cw40:
  s_sleep 1
  ds_read_u8 v9, v6 offset:256
  s_add_u32 s38, s38, 1
  s_waitcnt lgkmcnt(0)
  v_cmp_gt_u32 vcc, 4, v9
  s_cbranch_vccz .fz_kernel_cw40d
  s_cmp_lt_u32 s38, 8388608
  s_cbranch_scc1 .fz_kernel_cw40
.fz_kernel_cw40d:
  buffer_atomic_or v8, v7, s[4:7], s31 offen sc1
  s_mov_b64 exec, -1
  s_setprio 0
  s_mov_b32 s38, 0
.fz_kernel_kw41:
  s_sleep 2
  ds_read_b32 v7, v6 offset:0
  s_add_u32 s38, s38, 1
  s_waitcnt lgkmcnt(0)
  v_readfirstlane_b32 s31, v7
  s_bcnt1_i32_b32 s31, s31
  s_cmp_ge_u32 s31, 16
  s_cbranch_scc1 .fz_kernel_kw41d
  s_cmp_lt_u32 s38, 1048576
  s_cbranch_scc1 .fz_kernel_kw41
.fz_kernel_kw41d:
  s_branch .fz_kernel_sv2
.fz_kernel_sv1:
  s_add_u32 s37, s19, s67
  s_mov_b64 exec, 1
  buffer_load_dword v7, v4, s[4:7], s37 offen sc1
  s_waitcnt vmcnt(0)
  ds_or_b32 v6, v7
  buffer_load_dword v9, v4, s[4:7], s37 offen sc1
  s_barrier
  s_waitcnt vmcnt(0)
  ds_or_b32 v6, v9
  s_add_u32 s37, s19, s67
  s_mov_b64 exec, 1
  s_mov_b32 s38, 0
.fz_kernel_po42:
  buffer_load_dword v7, v4, s[4:7], s37 offen offset:0 sc1
  s_add_u32 s38, s38, 1
  s_waitcnt vmcnt(0)
  ds_or_b32 v6, v7 offset:0
  v_cmp_ne_u32 vcc, 0xffff, v7
  s_cbranch_vccz .fz_kernel_po42d
  s_sleep 12
  s_cmp_lt_u32 s38, 131072
  s_cbranch_scc1 .fz_kernel_po42
.fz_kernel_po42d:
  s_mov_b64 exec, -1
  s_setprio 0
  s_mov_b32 s38, 0
.fz_kernel_kw43:
  s_sleep 2
  ds_read_b32 v7, v6 offset:0
  s_add_u32 s38, s38, 1
  s_waitcnt lgkmcnt(0)
  v_readfirstlane_b32 s31, v7
  s_bcnt1_i32_b32 s31, s31
  s_cmp_ge_u32 s31, 16
  s_cbranch_scc1 .fz_kernel_kw43d
  s_cmp_lt_u32 s38, 1048576
  s_cbranch_scc1 .fz_kernel_kw43
.fz_kernel_kw43d:
.fz_kernel_sv2:
  s_and_b32 s30, s16, 1
  s_lshl_b32 s30, s30, 16
  s_add_u32 s32, s30, 65536
  s_lshl_b32 s31, s18, 7
  v_add_u32 v10, s31, v10
  s_lshr_b32 s33, s30, 2
  s_add_u32 s33, s33, 114688
  v_add_u32 v44, s33, v3
.fz_kernel_sv3:
  s_mov_b32 m0, s30
  s_lshl_b32 s31, s30, 4
  s_add_u32 s30, s30, 1024
  buffer_load_dwordx4 v10, s[24:27], s31 offen  lds
  s_cmp_lg_u32 s30, s32
  s_waitcnt vmcnt(4)
  s_cbranch_scc1 .fz_kernel_sv3
  s_mov_b32 s12, s54
  s_mov_b32 s13, s55
  s_mov_b32 s14, 0x700000
  s_mov_b32 s15, 0x00020000
  s_and_b32 s30, s16, 1
  s_lshl1_add_u32 s30, s17, s30
  s_lshl_b32 s30, s30, 18
  buffer_load_dwordx4 v[64:67], v10, s[12:15], s30 offen nt
  s_add_u32 s30, s30, 16384
  s_waitcnt vmcnt(2)
  buffer_load_dwordx4 v[68:71], v10, s[12:15], s30 offen nt
  s_add_u32 s30, s30, 16384
  s_waitcnt vmcnt(2)
  buffer_load_dwordx4 v[72:75], v10, s[12:15], s30 offen nt
  s_add_u32 s30, s30, 16384
  s_waitcnt vmcnt(2)
  buffer_load_dwordx4 v[76:79], v10, s[12:15], s30 offen nt
  s_add_u32 s30, s30, 16384
  s_waitcnt vmcnt(2)
  buffer_load_dwordx4 v[80:83], v10, s[12:15], s30 offen nt
  s_add_u32 s30, s30, 16384
  s_waitcnt vmcnt(2)
  buffer_load_dwordx4 v[84:87], v10, s[12:15], s30 offen nt
  s_add_u32 s30, s30, 16384
  s_waitcnt vmcnt(2)
  buffer_load_dwordx4 v[88:91], v10, s[12:15], s30 offen nt
  s_add_u32 s30, s30, 16384
  s_waitcnt vmcnt(2)
  buffer_load_dwordx4 v[92:95], v10, s[12:15], s30 offen nt
  s_add_u32 s30, s30, 16384
  s_waitcnt vmcnt(2)
  buffer_load_dwordx4 v[96:99], v10, s[12:15], s30 offen nt
  s_add_u32 s30, s30, 16384
  s_waitcnt vmcnt(2)
  buffer_load_dwordx4 v[100:103], v10, s[12:15], s30 offen nt
  s_add_u32 s30, s30, 16384
  s_waitcnt vmcnt(2)
  buffer_load_dwordx4 v[104:107], v10, s[12:15], s30 offen nt
  s_add_u32 s30, s30, 16384
  s_waitcnt vmcnt(2)
  buffer_load_dwordx4 v[108:111], v10, s[12:15], s30 offen nt
  s_add_u32 s30, s30, 16384
  s_waitcnt vmcnt(2)
  buffer_load_dwordx4 v[112:115], v10, s[12:15], s30 offen nt
  s_add_u32 s30, s30, 16384
  s_waitcnt vmcnt(2)
  buffer_load_dwordx4 v[116:119], v10, s[12:15], s30 offen nt
  s_add_u32 s30, s30, 16384
  s_waitcnt vmcnt(2)
  buffer_load_dwordx4 v[120:123], v10, s[12:15], s30 offen nt
  s_add_u32 s30, s30, 16384
  s_waitcnt vmcnt(2)
  buffer_load_dwordx4 v[124:127], v10, s[12:15], s30 offen nt
  s_add_u32 s30, s30, 16384
  s_waitcnt vmcnt(2)
  s_cmp_lg_u32 s62, 0
  s_cbranch_scc1 .fz_kernel_wt44
  s_mov_b32 s12, s42
  s_mov_b32 s13, s43
  s_mov_b32 s14, 0x600000
  s_mov_b32 s15, 0x00020000
  s_and_b32 s30, s16, 1
  s_lshl1_add_u32 s30, s17, s30
  s_and_b32 s30, s30, 15
  s_mul_i32 s30, s30, 393216
  s_lshl_b32 s31, s18, 7
  s_add_u32 s30, s30, s31
  v_mul_u32_u24 v11, 6144, v2
  buffer_load_dword v1, v11, s[12:15], s30 offen
  s_add_u32 s30, s30, 2048
  s_waitcnt vmcnt(0)
  buffer_load_dword v1, v11, s[12:15], s30 offen
  s_add_u32 s30, s30, 2048
  s_waitcnt vmcnt(0)
  buffer_load_dword v1, v11, s[12:15], s30 offen
  s_add_u32 s30, s30, 2048
  s_waitcnt vmcnt(0)
.fz_kernel_wt44:
  s_cmp_lg_u32 s16, 4
  s_cbranch_scc1 .fz_kernel_ct45e
  s_getpc_b64 s[0:1]
.fz_kernel_ct45:
  s_sub_u32 s0, s0, .fz_kernel_ct45-fz_kernel
  s_subb_u32 s1, s1, 0
  s_lshr_b32 s31, s2, 3
  s_mulk_i32 s31, 0x500
  v_lshl_add_u32 v1, v2, 7, s31
  v_min_u32 v1, .fz_kernel_last-fz_kernel, v1
  s_mov_b64 exec, 0x3ff
  global_load_dword v1, v1, s[0:1]
  s_mov_b64 exec, -1
.fz_kernel_ct45e:
  s_waitcnt vmcnt(0)
  s_cmp_lg_u32 s16, 5
  s_cbranch_scc1 .fz_kernel_sv35
  s_mov_b64 exec, 1
  s_mov_b32 s38, 0
.fz_kernel_sv34:
  s_sleep 4
  buffer_load_dword v7, v4, s[4:7], s37 offen offset:4 sc1
  ds_read_b32 v8, v6 offset:0x104
  s_add_u32 s38, s38, 1
  s_waitcnt vmcnt(0) lgkmcnt(0)
  ds_or_b32 v6, v7 offset:8
  v_cmp_eq_u32 vcc, 0xffff, v8
  s_cbranch_vccnz .fz_kernel_sv35
  s_cmp_lt_u32 s38, 131072
  s_cbranch_scc1 .fz_kernel_sv34
.fz_kernel_sv35:
  s_mov_b64 exec, -1
  s_setprio 3
  s_barrier
  s_cmp_eq_u32 s16, 5
  s_cbranch_scc1 .fz_kernel_sv4
  v_lshlrev_b32 v7, 11, v2
  s_lshl_b32 s31, s17, 7
  s_lshl_b32 s33, 1, s18
  s_add_u32 s31, s31, s67
  s_add_u32 s31, s31, 0x1800004
  v_mov_b32 v8, s33
  s_mov_b64 exec, 0xffff
  s_mov_b32 s38, 0
.fz_kernel_cw46:
  s_sleep 1
  ds_read_u8 v9, v6 offset:264
  s_add_u32 s38, s38, 1
  s_waitcnt lgkmcnt(0)
  v_cmp_gt_u32 vcc, 4, v9
  s_cbranch_vccz .fz_kernel_cw46d
  s_cmp_lt_u32 s38, 8388608
  s_cbranch_scc1 .fz_kernel_cw46
.fz_kernel_cw46d:
  buffer_atomic_or v8, v7, s[4:7], s31 offen sc1
  s_mov_b64 exec, -1
  s_mov_b64 exec, 1
  ds_or_b32 v6, v8 offset:8
  s_mov_b64 exec, -1
  s_branch .fz_kernel_sv5
.fz_kernel_sv4:
  s_add_u32 s37, s19, s67
  s_mov_b64 exec, 1
  s_mov_b32 s38, 0
.fz_kernel_po47:
  buffer_load_dword v7, v4, s[4:7], s37 offen offset:4 sc1
  s_add_u32 s38, s38, 1
  s_waitcnt vmcnt(0)
  ds_or_b32 v6, v7 offset:8
  v_cmp_ne_u32 vcc, 0xffff, v7
  s_cbranch_vccz .fz_kernel_po47d
  s_sleep 12
  s_cmp_lt_u32 s38, 131072
  s_cbranch_scc1 .fz_kernel_po47
.fz_kernel_po47d:
  s_mov_b64 exec, -1
.fz_kernel_sv5:
  s_mov_b32 s72, s66
  s_mov_b32 s73, s65
  s_mov_b32 s74, s67
  s_mov_b32 s75, s62
  s_cmp_lg_u32 s62, 0
  s_cbranch_scc1 .fz_kernel_w_lt
  s_mov_b32 s62, 1
  s_mov_b32 s63, 0x2000000
  s_mov_b32 s64, 0x2800000
  s_mov_b32 s65, 0x1400000
  s_mov_b32 s66, 0x1c42000
  s_mov_b32 s67, 12
  s_mov_b32 s71, 159776
  v_mov_b32 v6, 159832
  s_branch .fz_kernel_q_prod2
.fz_kernel_w_lt:
  s_barrier
  ds_write_b128 v44, v[64:67] offset:0
  ds_write_b128 v44, v[68:71] offset:1024
  ds_write_b128 v44, v[72:75] offset:2048
  ds_write_b128 v44, v[76:79] offset:3072
  ds_write_b128 v44, v[80:83] offset:4096
  ds_write_b128 v44, v[84:87] offset:5120
  ds_write_b128 v44, v[88:91] offset:6144
  ds_write_b128 v44, v[92:95] offset:7168
  ds_write_b128 v44, v[96:99] offset:8192
  ds_write_b128 v44, v[100:103] offset:9216
  ds_write_b128 v44, v[104:107] offset:10240
  ds_write_b128 v44, v[108:111] offset:11264
  ds_write_b128 v44, v[112:115] offset:12288
  ds_write_b128 v44, v[116:119] offset:13312
  ds_write_b128 v44, v[120:123] offset:14336
  ds_write_b128 v44, v[124:127] offset:15360
  s_waitcnt lgkmcnt(0)
  s_mov_b64 exec, 1
  ds_add_u32 v6, v5 offset:0x118
  s_mov_b64 exec, -1
  s_barrier
  s_branch .fz_kernel_fin
.fz_kernel_pk48c:
  s_call_b64 s[68:69], .fz_kernel_pick
  s_branch .fz_kernel_pk48
.fz_kernel_pk49c:
  s_call_b64 s[68:69], .fz_kernel_pick
  s_branch .fz_kernel_pk49
.fz_kernel_w_pt:
  v_lshlrev_b32 v44, 5, v17
  v_add_u32 v44, 155648, v44
  s_mov_b64 exec, vcc
  ds_read_b128 v[232:235], v44 offset:7424
  ds_read_b128 v[236:239], v44 offset:7440
  ds_read_b128 v[240:243], v44 offset:7488
  ds_read_b128 v[244:247], v44 offset:7504
  s_waitcnt lgkmcnt(0)
  v_pk_add_f32 v[64:65], v[64:65], v[232:233]
  v_pk_add_f32 v[66:67], v[66:67], v[234:235]
  v_pk_add_f32 v[68:69], v[68:69], v[236:237]
  v_pk_add_f32 v[70:71], v[70:71], v[238:239]
  v_pk_add_f32 v[72:73], v[72:73], v[240:241]
  v_pk_add_f32 v[74:75], v[74:75], v[242:243]
  v_pk_add_f32 v[76:77], v[76:77], v[244:245]
  v_pk_add_f32 v[78:79], v[78:79], v[246:247]
  ds_read_b128 v[232:235], v44 offset:7552
  ds_read_b128 v[236:239], v44 offset:7568
  ds_read_b128 v[240:243], v44 offset:7616
  ds_read_b128 v[244:247], v44 offset:7632
  s_waitcnt lgkmcnt(0)
  v_pk_add_f32 v[80:81], v[80:81], v[232:233]
  v_pk_add_f32 v[82:83], v[82:83], v[234:235]
  v_pk_add_f32 v[84:85], v[84:85], v[236:237]
  v_pk_add_f32 v[86:87], v[86:87], v[238:239]
  v_pk_add_f32 v[88:89], v[88:89], v[240:241]
  v_pk_add_f32 v[90:91], v[90:91], v[242:243]
  v_pk_add_f32 v[92:93], v[92:93], v[244:245]
  v_pk_add_f32 v[94:95], v[94:95], v[246:247]
  s_mov_b64 exec, -1
  s_branch .fz_kernel_w_pb
.fz_kernel_pk50c:
  s_call_b64 s[68:69], .fz_kernel_pick
  s_branch .fz_kernel_pk50
.fz_kernel_pk51c:
  s_call_b64 s[68:69], .fz_kernel_pick
  s_branch .fz_kernel_pk51
.fz_kernel_pk52c:
  s_call_b64 s[68:69], .fz_kernel_pick
  s_branch .fz_kernel_pk52
.fz_kernel_pk53c:
  s_call_b64 s[68:69], .fz_kernel_pick
  s_branch .fz_kernel_pk53
.fz_kernel_pk54c:
  s_call_b64 s[68:69], .fz_kernel_pick
  s_branch .fz_kernel_pk54
.fz_kernel_pk55c:
  s_call_b64 s[68:69], .fz_kernel_pick
  s_branch .fz_kernel_pk55
.fz_kernel_pk56c:
  s_call_b64 s[68:69], .fz_kernel_pick
  s_branch .fz_kernel_pk56
.fz_kernel_pk57c:
  s_call_b64 s[68:69], .fz_kernel_pick
  s_branch .fz_kernel_pk57
.fz_kernel_pk58c:
  s_call_b64 s[68:69], .fz_kernel_pick
  s_branch .fz_kernel_pk58
.fz_kernel_pk59c:
  s_call_b64 s[68:69], .fz_kernel_pick
  s_branch .fz_kernel_pk59
.fz_kernel_pk60c:
  s_call_b64 s[68:69], .fz_kernel_pick
  s_branch .fz_kernel_pk60
.fz_kernel_pk61c:
  s_call_b64 s[68:69], .fz_kernel_pick
  s_branch .fz_kernel_pk61
.fz_kernel_pk62c:
  s_call_b64 s[68:69], .fz_kernel_pick
  s_branch .fz_kernel_pk62
.fz_kernel_pk63c:
  s_call_b64 s[68:69], .fz_kernel_pick
  s_branch .fz_kernel_pk63
.fz_kernel_pk64c:
  s_call_b64 s[68:69], .fz_kernel_pick
  s_branch .fz_kernel_pk64
.fz_kernel_pk65c:
  s_call_b64 s[68:69], .fz_kernel_pick
  s_branch .fz_kernel_pk65
.fz_kernel_c_nl:
  s_barrier
  s_branch .fz_kernel_c_np
.fz_kernel_c_c7:
  s_mov_b32 s38, 0
.fz_kernel_cw70:
  s_sleep 1
  ds_read_u8 v22, v6 offset:272
  s_add_u32 s38, s38, 1
  s_waitcnt lgkmcnt(0)
  v_cmp_gt_u32 vcc, 2, v22
  s_cbranch_vccz .fz_kernel_cw70d
  s_cmp_lt_u32 s38, 8388608
  s_cbranch_scc1 .fz_kernel_cw70
.fz_kernel_cw70d:
  ds_read_b64_tr_b16 v[32:33], v7 offset:0
  ds_read_b64_tr_b16 v[34:35], v7 offset:512
  ds_read_b64_tr_b16 v[40:41], v13 offset:0
  ds_read_b64_tr_b16 v[42:43], v13 offset:512
  ds_read_b64_tr_b16 v[48:49], v7 offset:4096
  ds_read_b64_tr_b16 v[50:51], v7 offset:4608
  ds_read_b64_tr_b16 v[56:57], v13 offset:4096
  ds_read_b64_tr_b16 v[58:59], v13 offset:4608
  ds_read_b64_tr_b16 v[64:65], v7 offset:8192
  ds_read_b64_tr_b16 v[66:67], v7 offset:8704
  ds_read_b64_tr_b16 v[72:73], v13 offset:8192
  ds_read_b64_tr_b16 v[74:75], v13 offset:8704
  s_waitcnt lgkmcnt(0)
  ds_read_b64_tr_b16 v[36:37], v7 offset:12288
  ds_read_b64_tr_b16 v[38:39], v7 offset:12800
  ds_read_b64_tr_b16 v[44:45], v13 offset:12288
  ds_read_b64_tr_b16 v[46:47], v13 offset:12800
  ds_read_b64_tr_b16 v[52:53], v7 offset:16384
  ds_read_b64_tr_b16 v[54:55], v7 offset:16896
  ds_read_b64_tr_b16 v[60:61], v13 offset:16384
  ds_read_b64_tr_b16 v[62:63], v13 offset:16896
  ds_read_b64_tr_b16 v[68:69], v7 offset:20480
  ds_read_b64_tr_b16 v[70:71], v7 offset:20992
  ds_read_b64_tr_b16 v[76:77], v13 offset:20480
  ds_read_b64_tr_b16 v[78:79], v13 offset:20992
  s_waitcnt lgkmcnt(0)
  s_branch .fz_kernel_c_c2
.fz_kernel_c_coef:
  v_fma_f32 v242, -v240, v240, v242
  v_fma_f32 v243, -v241, v241, v243
  v_rsq_f32 v248, abs(v242)
  v_rsq_f32 v249, abs(v243)
  v_mul_f32 v254, v240, v248
  v_sub_f32 v254, 0, v254
  v_mov_b32 v252, 1.0
  v_fmac_f32 v252, 0x44800000, v248
  v_fma_f32 v242, v242, v24, -v25
  v_max_f32 v242, 0, v242
  v_mul_f32 v248, v252, v252
  v_fma_f32 v248, v248, v242, v25
  v_rsq_f32 v248, v248
  v_mul_f32 v240, v23, v240
  v_mul_f32 v248, v248, v252
  v_mul_f32 v250, v248, v240
  v_sub_f32 v250, 0, v250
  v_mul_f32 v255, v241, v249
  v_sub_f32 v255, 0, v255
  v_mov_b32 v253, 1.0
  v_fmac_f32 v253, 0x44800000, v249
  s_cmp_eq_u32 s3, 0
  s_cbranch_scc1 .fz_kernel_hb74
  s_barrier
  s_sub_u32 s3, s3, 1
.fz_kernel_hb74:
  v_fma_f32 v243, v243, v24, -v25
  v_max_f32 v243, 0, v243
  v_mul_f32 v249, v253, v253
  v_fma_f32 v249, v249, v243, v25
  v_rsq_f32 v249, v249
  v_mul_f32 v241, v23, v241
  v_mul_f32 v249, v249, v253
  v_mul_f32 v251, v249, v241
  v_sub_f32 v251, 0, v251
  s_setpc_b64 s[68:69]
.fz_kernel_c_gur:
  v_min_u32 v9, v144, v146
  v_cmp_eq_u32 s[8:9], 0, v9
  v_min_u32 v9, v148, v150
  v_cmp_eq_u32 s[10:11], 0, v9
  v_min_u32 v9, v152, v154
  v_cmp_eq_u32 s[12:13], 0, v9
  v_min_u32 v9, v156, v158
  v_cmp_eq_u32 s[14:15], 0, v9
  s_add_u32 s38, s38, 1
  s_cmp_ge_u32 s38, 131072
  s_cbranch_scc1 .fz_kernel_c_gud
  s_or_b64 exec, s[8:9], 1
  buffer_load_dwordx4 v[144:147], v21, s[4:7], s33 offen offset:0 sc1
  s_or_b64 exec, s[10:11], 1
  buffer_load_dwordx4 v[148:151], v21, s[4:7], s33 offen offset:512 sc1
  s_or_b64 exec, s[12:13], 1
  buffer_load_dwordx4 v[152:155], v21, s[4:7], s33 offen offset:1024 sc1
  s_or_b64 exec, s[14:15], 1
  buffer_load_dwordx4 v[156:159], v21, s[4:7], s33 offen offset:1536 sc1
  s_mov_b64 exec, -1
  s_branch .fz_kernel_c_gu
.fz_kernel_c_pur:
  s_cmp_eq_u32 s3, 0
  s_cbranch_scc1 .fz_kernel_hb79
  s_barrier
  s_sub_u32 s3, s3, 1
.fz_kernel_hb79:
  s_add_u32 s38, s38, 1
  s_cmp_ge_u32 s38, 131072
  s_cbranch_scc1 .fz_kernel_c_pud
  v_min_u32 v9, v144, v146
  v_cmp_eq_u32 vcc, 0, v9
  s_cbranch_vccz .fz_kernel_c_ps0
  buffer_load_dwordx4 v[144:147], v3, s[4:7], s21 offen offset:0 sc1
.fz_kernel_c_ps0:
  v_min_u32 v9, v148, v150
  v_cmp_eq_u32 vcc, 0, v9
  s_cbranch_vccz .fz_kernel_c_ps1
  buffer_load_dwordx4 v[148:151], v3, s[4:7], s21 offen offset:1024 sc1
.fz_kernel_c_ps1:
  v_min_u32 v9, v152, v154
  v_cmp_eq_u32 vcc, 0, v9
  s_cbranch_vccz .fz_kernel_c_ps2
  buffer_load_dwordx4 v[152:155], v3, s[4:7], s21 offen offset:2048 sc1
.fz_kernel_c_ps2:
  v_min_u32 v9, v156, v158
  v_cmp_eq_u32 vcc, 0, v9
  s_cbranch_vccz .fz_kernel_c_ps3
  buffer_load_dwordx4 v[156:159], v3, s[4:7], s21 offen offset:3072 sc1
.fz_kernel_c_ps3:
  v_min_u32 v9, v160, v162
  v_cmp_eq_u32 vcc, 0, v9
  s_cbranch_vccz .fz_kernel_c_ps4
  buffer_load_dwordx4 v[160:163], v3, s[4:7], s22 offen offset:0 sc1
.fz_kernel_c_ps4:
  v_min_u32 v9, v164, v166
  v_cmp_eq_u32 vcc, 0, v9
  s_cbranch_vccz .fz_kernel_c_ps5
  buffer_load_dwordx4 v[164:167], v3, s[4:7], s22 offen offset:1024 sc1
.fz_kernel_c_ps5:
  v_min_u32 v9, v168, v170
  v_cmp_eq_u32 vcc, 0, v9
  s_cbranch_vccz .fz_kernel_c_ps6
  buffer_load_dwordx4 v[168:171], v3, s[4:7], s22 offen offset:2048 sc1
.fz_kernel_c_ps6:
  s_branch .fz_kernel_c_pu
.fz_kernel_last:
  s_endpgm

.section .rodata,"a"
.p2align 6
.amdhsa_kernel fz_kernel
  .amdhsa_next_free_vgpr 256
  .amdhsa_next_free_sgpr 102
  .amdhsa_accum_offset 256
  .amdhsa_group_segment_fixed_size 0
  .amdhsa_kernarg_size 88
  .amdhsa_user_sgpr_count 2
  .amdhsa_user_sgpr_kernarg_segment_ptr 1
  .amdhsa_system_sgpr_workgroup_id_x 1
.end_amdhsa_kernel
```

```asm
; @launch kernel=fz_kernel grid=(256,1,1) block=(512,1,1) lds=163840
.amdgcn_target "amdgcn-amd-amdhsa--gfx950"
.text
.globl fz_kernel
.p2align 8
.type fz_kernel,@function
fz_kernel:
  s_cmp_ge_u32 s2, 256
  s_cbranch_scc1 .fz_kernel_end
  s_load_dwordx2 s[8:9], s[0:1], 0
  s_load_dwordx2 s[12:13], s[0:1], 8
  s_load_dwordx2 s[4:5], s[0:1], 80
  s_load_dwordx16 s[40:55], s[0:1], 0
  s_load_dwordx4 s[56:59], s[0:1], 64
  v_lshrrev_b32 v1, 6, v0
  v_and_b32 v2, 63, v0
  v_readfirstlane_b32 s16, v1
  s_and_b32 s21, s2, 7
  s_lshr_b32 s22, s2, 3
  s_and_b32 s23, s21, 3
  s_lshl_b32 s23, s23, 2
  s_and_b32 s24, s22, 3
  s_add_u32 s18, s23, s24
  s_lshr_b32 s24, s21, 2
  s_lshl_b32 s24, s24, 3
  s_lshr_b32 s25, s22, 2
  s_add_u32 s17, s24, s25
  s_lshl_b32 s19, s18, 4
  s_add_u32 s19, s19, s17
  s_lshl_b32 s19, s19, 7
  s_add_u32 s19, s19, 0x1800000
  v_lshlrev_b32 v3, 4, v2
  v_mov_b32 v4, 0
  v_mov_b32 v5, 1
  s_mov_b32 s6, 0x2c00000
  s_mov_b32 s7, 0x00020000
  s_mov_b32 s62, 0
  s_mov_b32 s63, 0x400000
  s_mov_b32 s64, 0xc00000
  s_mov_b32 s65, 0x1000000
  s_mov_b32 s66, 0x1c00000
  s_mov_b32 s67, 0
  s_mov_b32 s71, 159744
  v_mov_b32 v6, 159808
  s_cmp_lt_u32 s16, 4
  s_cbranch_scc1 .fz_kernel_q_cons1
  s_cmp_ge_u32 s16, 6
  s_cbranch_scc1 .fz_kernel_q_help1
  s_mov_b32 s10, 0x400000
  s_mov_b32 s11, 0x00020000
  v_lshrrev_b32 v20, 3, v2
  v_and_b32 v21, 7, v2
  v_lshrrev_b32 v22, 4, v2
  v_xor_b32 v23, v21, v22
  v_lshlrev_b32 v23, 4, v23
  v_lshl_add_u32 v24, v20, 11, v23
  v_xor_b32 v25, 64, v24
  s_lshl_b32 s35, s17, 2
  s_and_b32 s31, s16, 1
  s_add_u32 s35, s35, s31
  s_lshl_b32 s35, s35, 16
  s_and_b32 s29, s18, 12
  s_lshr_b32 s33, s17, 3
  s_lshl1_add_u32 s29, s33, s29
  s_lshl2_add_u32 s29, s17, s29
  s_and_b32 s29, s29, 15
  s_mov_b32 s22, 128
  s_mov_b32 s23, 131072
  s_mov_b32 s36, -1
  v_add_u32 v40, 0, v24
  v_add_u32 v41, 15360, v25
  v_add_u32 v42, 30720, v24
  v_add_u32 v43, 46080, v25
.fz_kernel_q_pc:
  s_mov_b32 s14, 0x600000
  s_mov_b32 s15, 0x00020000
  v_lshrrev_b32 v28, 3, v2
  v_and_b32 v29, 7, v2
  v_bfe_u32 v30, v2, 4, 1
  v_lshlrev_b32 v30, 1, v30
  v_xor_b32 v31, v29, v30
  v_lshlrev_b32 v31, 4, v31
  v_mul_u32_u24 v28, 6144, v28
  v_add_u32 v28, v28, v31
  v_xor_b32 v29, 64, v28
  s_lshl_b32 s32, s18, 7
  s_add_u32 s39, s32, 6291456
  s_mul_i32 s33, s29, 393216
  s_add_u32 s33, s33, s32
  s_lshl_b32 s29, s29, 1
  s_mul_i32 s25, s31, 6144
  s_add_u32 s25, s25, 65536
  s_mov_b32 s30, s25
  s_add_u32 s26, s25, 49152
  s_lshl_b32 s21, s31, 12
  s_cmp_eq_u32 s31, 0
  s_mov_b32 s24, 100352
  s_cselect_b32 s24, 0, s24
  v_add_u32 v32, s24, v28
  s_mov_b32 s24, 148480
  s_cselect_b32 s24, 48128, s24
  v_add_u32 v33, s24, v29
  s_mov_b32 s24, 2048
  s_cselect_b32 s24, 96256, s24
  v_add_u32 v34, s24, v28
  s_mov_b32 s24, 50176
  s_cselect_b32 s24, 144384, s24
  v_add_u32 v35, s24, v29
  s_mov_b32 s24, 102400
  s_cselect_b32 s24, 2048, s24
  v_add_u32 v36, s24, v28
  s_mov_b32 s24, 150528
  s_cselect_b32 s24, 50176, s24
  v_add_u32 v37, s24, v29
  s_cmp_lg_u32 s62, 0
  s_cbranch_scc1 .fz_kernel_q_st2
  s_waitcnt lgkmcnt(0)
  s_mov_b32 s34, 32
  s_call_b64 s[0:1], .fz_kernel_q_ix
  s_call_b64 s[0:1], .fz_kernel_q_iu
  s_call_b64 s[0:1], .fz_kernel_q_iu
  s_call_b64 s[0:1], .fz_kernel_q_iu
  s_waitcnt vmcnt(20)
  s_barrier
  s_call_b64 s[0:1], .fz_kernel_q_iu
  s_waitcnt vmcnt(24)
  s_barrier
  s_call_b64 s[0:1], .fz_kernel_q_iu
  s_branch .fz_kernel_q_pl
.fz_kernel_q_ix:
  s_bfe_u32 s24, s29, 0x40001
  s_mul_i32 s20, s24, s22
  s_bitcmp1_b32 s29, 0
  s_cselect_b32 s31, s23, 0
  s_add_u32 s20, s20, s35
  s_add_u32 s20, s20, s31
  s_bitcmp1_b32 s36, s24
  s_cbranch_scc0 .fz_kernel_xok1w
.fz_kernel_xok1:
  s_mov_b32 m0, s21
  s_add_u32 s21, s21, 8192
  s_and_b32 s21, s21, 0xffff
  s_add_u32 s29, s29, 1
  buffer_load_dwordx4 v40, s[8:11], s20 offen offset:0 lds
  buffer_load_dwordx4 v41, s[8:11], s20 offen offset:1024 lds
  buffer_load_dwordx4 v42, s[8:11], s20 offen offset:2048 lds
  buffer_load_dwordx4 v43, s[8:11], s20 offen offset:3072 lds
  s_setpc_b64 s[0:1]
.fz_kernel_q_iu:
  s_mov_b32 m0, s30
  s_add_u32 s30, s30, 12288
  buffer_load_dwordx4 v32, s[12:15], s33 offen offset:0 lds
  s_bfe_u32 s24, s29, 0x40001
  buffer_load_dwordx4 v33, s[12:15], s33 offen offset:1024 lds
  s_mul_i32 s20, s24, s22
  buffer_load_dwordx4 v34, s[12:15], s33 offen offset:2048 lds
  s_bitcmp1_b32 s29, 0
  s_cselect_b32 s31, s23, 0
  buffer_load_dwordx4 v35, s[12:15], s33 offen offset:3072 lds
  s_add_u32 m0, m0, 4096
  s_add_u32 s20, s20, s35
  buffer_load_dwordx4 v36, s[12:15], s33 offen offset:0 lds
  s_add_u32 s20, s20, s31
  buffer_load_dwordx4 v37, s[12:15], s33 offen offset:1024 lds
  s_bitcmp1_b32 s36, s24
  s_cbranch_scc0 .fz_kernel_xok2w
.fz_kernel_xok2:
  s_mov_b32 m0, s21
  s_add_u32 s21, s21, 8192
  s_and_b32 s21, s21, 0xffff
  s_add_u32 s29, s29, 1
  buffer_load_dwordx4 v40, s[8:11], s20 offen offset:0 lds
  s_add_u32 s33, s33, 196608
  s_cmp_eq_u32 s33, s39
  s_cselect_b32 s33, s32, s33
  buffer_load_dwordx4 v41, s[8:11], s20 offen offset:1024 lds
  s_cmp_eq_u32 s30, s26
  s_cselect_b32 s30, s25, s30
  buffer_load_dwordx4 v42, s[8:11], s20 offen offset:2048 lds
  s_sub_u32 s34, s34, 1
  s_cmp_lg_u32 s34, 0
  buffer_load_dwordx4 v43, s[8:11], s20 offen offset:3072 lds
  s_setpc_b64 s[0:1]
.fz_kernel_q_iw:
  s_mov_b32 m0, s30
  s_add_u32 s30, s30, 12288
  buffer_load_dwordx4 v32, s[12:15], s33 offen offset:0 lds
  s_nop 0
  buffer_load_dwordx4 v33, s[12:15], s33 offen offset:1024 lds
  s_nop 0
  buffer_load_dwordx4 v34, s[12:15], s33 offen offset:2048 lds
  s_nop 0
  buffer_load_dwordx4 v35, s[12:15], s33 offen offset:3072 lds
  s_add_u32 m0, m0, 4096
  s_nop 0
  buffer_load_dwordx4 v36, s[12:15], s33 offen offset:0 lds
  buffer_load_dwordx4 v37, s[12:15], s33 offen offset:1024 lds
  s_add_u32 s33, s33, 196608
  s_cmp_eq_u32 s33, s39
  s_cselect_b32 s33, s32, s33
  s_cmp_eq_u32 s30, s26
  s_cselect_b32 s30, s25, s30
  s_sub_u32 s34, s34, 1
  s_cmp_lg_u32 s34, 0
  s_setpc_b64 s[0:1]
.fz_kernel_q_st2:
  s_mov_b32 s34, 32
  s_waitcnt vmcnt(0)
  s_barrier
  ds_write_b128 v44, v[64:67] offset:0
  ds_write_b128 v44, v[68:71] offset:1024
  ds_write_b128 v44, v[72:75] offset:2048
  ds_write_b128 v44, v[76:79] offset:3072
  ds_write_b128 v44, v[80:83] offset:4096
  ds_write_b128 v44, v[84:87] offset:5120
  ds_write_b128 v44, v[88:91] offset:6144
  ds_write_b128 v44, v[92:95] offset:7168
  ds_write_b128 v44, v[96:99] offset:8192
  ds_write_b128 v44, v[100:103] offset:9216
  ds_write_b128 v44, v[104:107] offset:10240
  ds_write_b128 v44, v[108:111] offset:11264
  ds_write_b128 v44, v[112:115] offset:12288
  ds_write_b128 v44, v[116:119] offset:13312
  ds_write_b128 v44, v[120:123] offset:14336
  ds_write_b128 v44, v[124:127] offset:15360
  s_waitcnt lgkmcnt(0)
  s_call_b64 s[0:1], .fz_kernel_q_iw
  s_call_b64 s[0:1], .fz_kernel_q_iw
  s_call_b64 s[0:1], .fz_kernel_q_iw
  s_call_b64 s[0:1], .fz_kernel_q_iw
  s_call_b64 s[0:1], .fz_kernel_q_ix
  s_call_b64 s[0:1], .fz_kernel_q_ix
  s_mov_b64 exec, 1
  s_waitcnt vmcnt(20)
  ds_add_u32 v6, v5 offset:0x110
  s_mov_b64 exec, -1
  v_mov_b32 v12, 0x100
  s_call_b64 s[0:1], .fz_kernel_q_ix
  s_call_b64 s[0:1], .fz_kernel_q_ix
  s_waitcnt vmcnt(8)
  s_mov_b64 exec, 1
  ds_add_u32 v6, v12 offset:0x110
  s_mov_b64 exec, -1
  s_barrier
  s_waitcnt vmcnt(8)
  s_barrier
  s_call_b64 s[0:1], .fz_kernel_q_ix
  s_call_b64 s[0:1], .fz_kernel_q_iu
  s_waitcnt vmcnt(14)
  s_barrier
  s_call_b64 s[0:1], .fz_kernel_q_iu
  s_waitcnt vmcnt(20)
  s_barrier
  s_call_b64 s[0:1], .fz_kernel_q_iu
.fz_kernel_q_pl:
  s_waitcnt vmcnt(20)
  s_barrier
  s_mov_b32 m0, s30
  s_add_u32 s30, s30, 12288
  buffer_load_dwordx4 v32, s[12:15], s33 offen offset:0 lds
  s_bfe_u32 s24, s29, 0x40001
  buffer_load_dwordx4 v33, s[12:15], s33 offen offset:1024 lds
  s_mul_i32 s20, s24, s22
  buffer_load_dwordx4 v34, s[12:15], s33 offen offset:2048 lds
  s_bitcmp1_b32 s29, 0
  s_cselect_b32 s31, s23, 0
  buffer_load_dwordx4 v35, s[12:15], s33 offen offset:3072 lds
  s_add_u32 m0, m0, 4096
  s_add_u32 s20, s20, s35
  buffer_load_dwordx4 v36, s[12:15], s33 offen offset:0 lds
  s_add_u32 s20, s20, s31
  buffer_load_dwordx4 v37, s[12:15], s33 offen offset:1024 lds
  s_bitcmp1_b32 s36, s24
  s_cbranch_scc0 .fz_kernel_xok3w
.fz_kernel_xok3:
  s_mov_b32 m0, s21
  s_add_u32 s21, s21, 8192
  s_and_b32 s21, s21, 0xffff
  s_add_u32 s29, s29, 1
  buffer_load_dwordx4 v40, s[8:11], s20 offen offset:0 lds
  s_add_u32 s33, s33, 196608
  s_cmp_eq_u32 s33, s39
  s_cselect_b32 s33, s32, s33
  buffer_load_dwordx4 v41, s[8:11], s20 offen offset:1024 lds
  s_cmp_eq_u32 s30, s26
  s_cselect_b32 s30, s25, s30
  buffer_load_dwordx4 v42, s[8:11], s20 offen offset:2048 lds
  s_sub_u32 s34, s34, 1
  s_cmp_lg_u32 s34, 0
  buffer_load_dwordx4 v43, s[8:11], s20 offen offset:3072 lds
  s_cbranch_scc1 .fz_kernel_q_pl
  s_waitcnt vmcnt(20)
  s_barrier
  s_waitcnt vmcnt(10)
  s_barrier
  s_waitcnt vmcnt(0)
  s_barrier
  s_barrier
  s_branch .fz_kernel_serv
.fz_kernel_q_cons1:
  s_waitcnt lgkmcnt(0)
  s_mov_b32 s12, s42
  s_mov_b32 s13, s43
  s_mov_b32 s14, 0x600000
  s_mov_b32 s15, 0x00020000
  s_and_b32 s20, s18, 4
  s_add_u32 s20, s20, s16
  s_cmp_ge_u32 s20, 3
  s_cbranch_scc1 .fz_kernel_q_nsp
  s_and_b32 s20, s17, 7
  s_and_b32 s21, s18, 3
  s_lshl2_add_u32 s20, s20, s21
  s_mul_i32 s20, s20, 196608
  s_or_b32 s21, s18, 3
  s_lshl4_add_u32 s21, s16, s21
  s_lshl_b32 s21, s21, 7
  s_add_u32 s20, s20, s21
  v_mul_u32_u24 v20, 6144, v2
  s_mov_b32 exec_hi, 0
  buffer_load_dword v231, v20, s[12:15], s20 offen
  s_mov_b32 exec_hi, -1
.fz_kernel_q_nsp:
  v_lshlrev_b32 v20, 2, v0
  v_add_u32 v20, 159744, v20
  s_cmp_ge_u32 s16, 2
  s_cbranch_scc1 .fz_kernel_q_nz
  ds_write_b32 v20, v4
.fz_kernel_q_nz:
  s_lshr_b32 s26, s16, 1
  s_lshl_b32 s28, s26, 13
  v_and_b32 v20, 15, v2
  v_lshrrev_b32 v21, 4, v2
  v_bfe_u32 v22, v2, 1, 3
  v_xor_b32 v22, v22, v21
  v_lshlrev_b32 v20, 7, v20
  v_lshl_add_u32 v20, v22, 4, v20
  v_add_u32 v8, s28, v20
  v_xor_b32 v9, 64, v8
.fz_kernel_q_cs:
  s_and_b32 s27, s16, 1
  s_lshl_b32 s28, s27, 1
  v_lshrrev_b32 v14, 4, v2
  v_bfe_u32 v15, v2, 2, 2
  v_lshl_add_u32 v16, v14, 3, v15
  v_lshlrev_b32 v16, 7, v16
  v_and_b32 v14, 1, v14
  v_lshrrev_b32 v15, 1, v15
  v_lshl_add_u32 v14, v14, 1, v15
  v_xor_b32 v14, s28, v14
  v_lshl_add_u32 v16, v14, 5, v16
  v_and_b32 v14, 3, v2
  v_lshl_add_u32 v16, v14, 3, v16
  v_add_u32 v12, 65536, v16
  v_xor_b32 v13, 32, v12
  v_mov_b32 v10, v12
  v_mov_b32 v11, v13
  s_mov_b32 s29, 16
  s_mov_b32 s30, 0
  v_mov_b32 v128, 0
  v_mov_b32 v129, 0
  v_mov_b32 v130, 0
  v_mov_b32 v131, 0
  v_mov_b32 v132, 0
  v_mov_b32 v133, 0
  v_mov_b32 v134, 0
  v_mov_b32 v135, 0
  v_mov_b32 v136, 0
  v_mov_b32 v137, 0
  v_mov_b32 v138, 0
  v_mov_b32 v139, 0
  v_mov_b32 v140, 0
  v_mov_b32 v141, 0
  v_mov_b32 v142, 0
  v_mov_b32 v143, 0
  v_mov_b32 v144, 0
  v_mov_b32 v145, 0
  v_mov_b32 v146, 0
  v_mov_b32 v147, 0
  v_mov_b32 v148, 0
  v_mov_b32 v149, 0
  v_mov_b32 v150, 0
  v_mov_b32 v151, 0
  v_mov_b32 v152, 0
  v_mov_b32 v153, 0
  v_mov_b32 v154, 0
  v_mov_b32 v155, 0
  v_mov_b32 v156, 0
  v_mov_b32 v157, 0
  v_mov_b32 v158, 0
  v_mov_b32 v159, 0
  v_mov_b32 v160, 0
  v_mov_b32 v161, 0
  v_mov_b32 v162, 0
  v_mov_b32 v163, 0
  v_mov_b32 v164, 0
  v_mov_b32 v165, 0
  v_mov_b32 v166, 0
  v_mov_b32 v167, 0
  v_mov_b32 v168, 0
  v_mov_b32 v169, 0
  v_mov_b32 v170, 0
  v_mov_b32 v171, 0
  v_mov_b32 v172, 0
  v_mov_b32 v173, 0
  v_mov_b32 v174, 0
  v_mov_b32 v175, 0
  s_cmp_eq_u32 s62, 0
  s_cbranch_scc1 .fz_kernel_q_i1
  s_mov_b64 exec, 1
  s_waitcnt vmcnt(0)
  ds_add_u32 v1, v5 offset:0x100
  s_mov_b64 exec, -1
.fz_kernel_q_i1:
  v_mov_b32 v176, 0
  v_mov_b32 v177, 0
  v_mov_b32 v178, 0
  v_mov_b32 v179, 0
  v_mov_b32 v180, 0
  v_mov_b32 v181, 0
  v_mov_b32 v182, 0
  v_mov_b32 v183, 0
  v_mov_b32 v184, 0
  v_mov_b32 v185, 0
  v_mov_b32 v186, 0
  v_mov_b32 v187, 0
  v_mov_b32 v188, 0
  v_mov_b32 v189, 0
  v_mov_b32 v190, 0
  v_mov_b32 v191, 0
  v_mov_b32 v192, 0
  v_mov_b32 v193, 0
  v_mov_b32 v194, 0
  v_mov_b32 v195, 0
  v_mov_b32 v196, 0
  v_mov_b32 v197, 0
  v_mov_b32 v198, 0
  v_mov_b32 v199, 0
  v_mov_b32 v200, 0
  v_mov_b32 v201, 0
  v_mov_b32 v202, 0
  v_mov_b32 v203, 0
  v_mov_b32 v204, 0
  v_mov_b32 v205, 0
  v_mov_b32 v206, 0
  v_mov_b32 v207, 0
  v_mov_b32 v208, 0
  v_mov_b32 v209, 0
  v_mov_b32 v210, 0
  v_mov_b32 v211, 0
  v_mov_b32 v212, 0
  v_mov_b32 v213, 0
  v_mov_b32 v214, 0
  v_mov_b32 v215, 0
  v_mov_b32 v216, 0
  v_mov_b32 v217, 0
  v_mov_b32 v218, 0
  v_mov_b32 v219, 0
  v_mov_b32 v220, 0
  v_mov_b32 v221, 0
  v_mov_b32 v222, 0
  v_mov_b32 v223, 0
  v_and_b32 v14, 1, v2
  v_lshlrev_b32 v14, 4, v14
  v_mov_b32 v15, 0x3f80
  v_lshlrev_b32 v14, v14, v15
  v_mov_b32 v248, 0
  v_mov_b32 v249, 0
  v_mov_b32 v250, 0
  v_mov_b32 v251, 0
  v_mov_b32 v252, 0
  v_mov_b32 v253, 0
  v_mov_b32 v254, 0
  v_mov_b32 v255, 0
  s_mov_b32 exec_lo, 0x3
  s_mov_b32 exec_hi, 0x30
  v_mov_b32 v248, v14
  s_mov_b32 exec_lo, 0xc
  s_mov_b32 exec_hi, 0xc0
  v_mov_b32 v249, v14
  s_mov_b32 exec_lo, 0x300
  s_mov_b32 exec_hi, 0x3000
  v_mov_b32 v250, v14
  s_mov_b32 exec_lo, 0xc00
  s_mov_b32 exec_hi, 0xc000
  v_mov_b32 v251, v14
  s_mov_b32 exec_lo, 0x30000
  s_mov_b32 exec_hi, 0x300000
  v_mov_b32 v252, v14
  s_mov_b32 exec_lo, 0xc0000
  s_mov_b32 exec_hi, 0xc00000
  v_mov_b32 v253, v14
  s_mov_b32 exec_lo, 0x3000000
  s_mov_b32 exec_hi, 0x30000000
  v_mov_b32 v254, v14
  s_mov_b32 exec_lo, 0xc000000
  s_mov_b32 exec_hi, 0xc0000000
  v_mov_b32 v255, v14
  s_mov_b64 exec, -1
  s_lshl1_add_u32 s35, s18, s27
  s_lshl_b32 s35, s35, 5
  s_add_u32 s35, s35, s26
  s_lshl_b32 s35, s35, 13
  s_add_u32 s35, s35, s63
  s_lshl_b32 s11, s16, 8
  s_add_u32 s11, s11, 147456
  s_mov_b32 s20, 0xffff0000
  s_mov_b32 s21, 0xffff0000
  s_mov_b32 s24, 0x21800000
  s_mov_b32 s25, 0x5d800000
  s_andn2_b32 s8, 2, s16
  s_lshl2_add_u32 s8, s17, s8
  s_lshl4_add_u32 s8, s8, s18
  s_lshl1_add_u32 s8, s8, s27
  s_lshl_b32 s8, s8, 11
  s_add_u32 s8, s8, s64
  s_add_u32 s9, s8, 65536
  s_mov_b32 s73, 0
  s_mov_b32 s32, 7
  s_mov_b32 s12, s40
  s_mov_b32 s13, s41
  s_mov_b32 s14, 0x400000
  s_mov_b32 s15, 0x00020000
  v_lshrrev_b32 v14, 5, v2
  v_and_b32 v15, 31, v2
  v_lshlrev_b32 v14, 4, v14
  v_lshl_add_u32 v15, v15, 11, v14
  s_lshl2_add_u32 s23, s17, s16
  s_lshl_b32 s23, s23, 16
  s_lshl_b32 s22, s18, 7
  s_add_u32 s23, s22, s23
  s_waitcnt lgkmcnt(0)
  s_barrier
  ds_read_b64_tr_b16 v[56:57], v10 offset:4096
  ds_read_b64_tr_b16 v[58:59], v10 offset:4608
  ds_read_b128 v[32:35], v8 offset:0
  ds_read_b128 v[36:39], v8 offset:2048
  ds_read_b128 v[40:43], v8 offset:4096
  ds_read_b128 v[44:47], v8 offset:6144
  ds_read_b64_tr_b16 v[60:61], v11 offset:4096
  ds_read_b64_tr_b16 v[62:63], v11 offset:4608
  ds_read_b64_tr_b16 v[64:65], v10 offset:8192
  ds_read_b64_tr_b16 v[66:67], v10 offset:8704
  ds_read_b64_tr_b16 v[68:69], v11 offset:8192
  ds_read_b64_tr_b16 v[70:71], v11 offset:8704
  ds_read_b64_tr_b16 v[48:49], v10 offset:0
  ds_read_b64_tr_b16 v[50:51], v10 offset:512
  ds_read_b64_tr_b16 v[52:53], v11 offset:0
  ds_read_b64_tr_b16 v[54:55], v11 offset:512
  s_add_u32 s30, s30, 12288
  s_cmp_eq_u32 s30, 49152
  s_cselect_b32 s30, 0, s30
  v_add_u32 v8, 0x4000, v8
  v_add_u32 v10, s30, v12
  v_add_u32 v11, s30, v13
  v_and_b32 v8, 0xffff, v8
  s_waitcnt lgkmcnt(0)
  s_branch .fz_kernel_q_l0
  .p2align 6
.fz_kernel_q_loop:
  v_mfma_f32_16x16x32_bf16 v[148:151], v[52:55], v[36:39], v[148:151]
  v_mfma_f32_16x16x32_bf16 v[152:155], v[52:55], v[40:43], v[152:155]
  s_waitcnt lgkmcnt(0)
  v_mfma_f32_16x16x32_bf16 v[156:159], v[52:55], v[44:47], v[156:159]
  s_barrier
  v_mfma_f32_16x16x32_bf16 v[160:163], v[96:99], v[72:75], v[160:163]
  ds_read_b64_tr_b16 v[56:57], v10 offset:4096
  v_mfma_f32_16x16x32_bf16 v[164:167], v[96:99], v[76:79], v[164:167]
  ds_read_b64_tr_b16 v[58:59], v10 offset:4608
  v_mfma_f32_16x16x32_bf16 v[168:171], v[96:99], v[80:83], v[168:171]
  ds_read_b128 v[32:35], v8 offset:0
  v_mfma_f32_16x16x32_bf16 v[172:175], v[96:99], v[84:87], v[172:175]
  ds_read_b128 v[36:39], v8 offset:2048
  v_mfma_f32_16x16x32_bf16 v[176:179], v[100:103], v[72:75], v[176:179]
  ds_read_b128 v[40:43], v8 offset:4096
  v_mfma_f32_16x16x32_bf16 v[180:183], v[100:103], v[76:79], v[180:183]
  ds_read_b128 v[44:47], v8 offset:6144
  v_mfma_f32_16x16x32_bf16 v[184:187], v[100:103], v[80:83], v[184:187]
  ds_read_b64_tr_b16 v[60:61], v11 offset:4096
  v_mfma_f32_16x16x32_bf16 v[188:191], v[100:103], v[84:87], v[188:191]
  ds_read_b64_tr_b16 v[62:63], v11 offset:4608
  v_mfma_f32_16x16x32_bf16 v[192:195], v[72:75], v[104:107], v[192:195]
  ds_read_b64_tr_b16 v[64:65], v10 offset:8192
  s_add_u32 s30, s30, 12288
  v_mfma_f32_16x16x32_bf16 v[196:199], v[76:79], v[104:107], v[196:199]
  ds_read_b64_tr_b16 v[66:67], v10 offset:8704
  s_cmp_eq_u32 s30, 49152
  v_mfma_f32_16x16x32_bf16 v[200:203], v[80:83], v[104:107], v[200:203]
  ds_read_b64_tr_b16 v[68:69], v11 offset:8192
  s_cselect_b32 s30, 0, s30
  v_mfma_f32_16x16x32_bf16 v[204:207], v[84:87], v[104:107], v[204:207]
  ds_read_b64_tr_b16 v[70:71], v11 offset:8704
  v_mfma_f32_16x16x32_bf16 v[208:211], v[72:75], v[108:111], v[208:211]
  ds_read_b64_tr_b16 v[48:49], v10 offset:0
  v_mfma_f32_16x16x32_bf16 v[212:215], v[76:79], v[108:111], v[212:215]
  ds_read_b64_tr_b16 v[50:51], v10 offset:512
  v_mfma_f32_16x16x32_bf16 v[216:219], v[80:83], v[108:111], v[216:219]
  ds_read_b64_tr_b16 v[52:53], v11 offset:0
  v_mfma_f32_16x16x32_bf16 v[220:223], v[84:87], v[108:111], v[220:223]
  ds_read_b64_tr_b16 v[54:55], v11 offset:512
  v_mfma_f32_16x16x32_bf16 v[128:131], v[88:91], v[72:75], v[128:131]
  v_add_u32 v8, 0x4000, v8
  v_mfma_f32_16x16x32_bf16 v[132:135], v[88:91], v[76:79], v[132:135]
  v_add_u32 v10, s30, v12
  v_mfma_f32_16x16x32_bf16 v[136:139], v[88:91], v[80:83], v[136:139]
  v_add_u32 v11, s30, v13
  v_mfma_f32_16x16x32_bf16 v[140:143], v[88:91], v[84:87], v[140:143]
  v_and_b32 v8, 0xffff, v8
  v_mfma_f32_16x16x32_bf16 v[144:147], v[92:95], v[72:75], v[144:147]
  v_mfma_f32_16x16x32_bf16 v[148:151], v[92:95], v[76:79], v[148:151]
  v_mfma_f32_16x16x32_bf16 v[152:155], v[92:95], v[80:83], v[152:155]
  s_waitcnt lgkmcnt(0)
  v_mfma_f32_16x16x32_bf16 v[156:159], v[92:95], v[84:87], v[156:159]
.fz_kernel_q_l0:
  s_barrier
  v_mfma_f32_16x16x32_bf16 v[160:163], v[56:59], v[32:35], v[160:163]
  ds_read_b64_tr_b16 v[96:97], v10 offset:4096
  v_mfma_f32_16x16x32_bf16 v[164:167], v[56:59], v[36:39], v[164:167]
  ds_read_b64_tr_b16 v[98:99], v10 offset:4608
  v_mfma_f32_16x16x32_bf16 v[168:171], v[56:59], v[40:43], v[168:171]
  ds_read_b128 v[72:75], v9 offset:0
  v_mfma_f32_16x16x32_bf16 v[172:175], v[56:59], v[44:47], v[172:175]
  ds_read_b128 v[76:79], v9 offset:2048
  v_mfma_f32_16x16x32_bf16 v[176:179], v[60:63], v[32:35], v[176:179]
  ds_read_b128 v[80:83], v9 offset:4096
  v_mfma_f32_16x16x32_bf16 v[180:183], v[60:63], v[36:39], v[180:183]
  ds_read_b128 v[84:87], v9 offset:6144
  v_mfma_f32_16x16x32_bf16 v[184:187], v[60:63], v[40:43], v[184:187]
  ds_read_b64_tr_b16 v[100:101], v11 offset:4096
  v_mfma_f32_16x16x32_bf16 v[188:191], v[60:63], v[44:47], v[188:191]
  ds_read_b64_tr_b16 v[102:103], v11 offset:4608
  v_mfma_f32_16x16x32_bf16 v[192:195], v[32:35], v[64:67], v[192:195]
  ds_read_b64_tr_b16 v[104:105], v10 offset:8192
  s_add_u32 s30, s30, 12288
  v_mfma_f32_16x16x32_bf16 v[196:199], v[36:39], v[64:67], v[196:199]
  ds_read_b64_tr_b16 v[106:107], v10 offset:8704
  s_cmp_eq_u32 s30, 49152
  v_mfma_f32_16x16x32_bf16 v[200:203], v[40:43], v[64:67], v[200:203]
  ds_read_b64_tr_b16 v[108:109], v11 offset:8192
  s_cselect_b32 s30, 0, s30
  v_mfma_f32_16x16x32_bf16 v[204:207], v[44:47], v[64:67], v[204:207]
  ds_read_b64_tr_b16 v[110:111], v11 offset:8704
  s_sub_u32 s29, s29, 1
  v_mfma_f32_16x16x32_bf16 v[208:211], v[32:35], v[68:71], v[208:211]
  ds_read_b64_tr_b16 v[88:89], v10 offset:0
  s_cmp_lg_u32 s29, 0
  v_mfma_f32_16x16x32_bf16 v[212:215], v[36:39], v[68:71], v[212:215]
  ds_read_b64_tr_b16 v[90:91], v10 offset:512
  v_mfma_f32_16x16x32_bf16 v[216:219], v[40:43], v[68:71], v[216:219]
  ds_read_b64_tr_b16 v[92:93], v11 offset:0
  v_mfma_f32_16x16x32_bf16 v[220:223], v[44:47], v[68:71], v[220:223]
  ds_read_b64_tr_b16 v[94:95], v11 offset:512
  v_mfma_f32_16x16x32_bf16 v[128:131], v[48:51], v[32:35], v[128:131]
  v_add_u32 v9, 0x4000, v9
  v_mfma_f32_16x16x32_bf16 v[132:135], v[48:51], v[36:39], v[132:135]
  v_add_u32 v10, s30, v12
  v_mfma_f32_16x16x32_bf16 v[136:139], v[48:51], v[40:43], v[136:139]
  v_add_u32 v11, s30, v13
  v_mfma_f32_16x16x32_bf16 v[140:143], v[48:51], v[44:47], v[140:143]
  v_and_b32 v9, 0xffff, v9
  v_mfma_f32_16x16x32_bf16 v[144:147], v[52:55], v[32:35], v[144:147]
  s_cbranch_scc1 .fz_kernel_q_loop
  v_mfma_f32_16x16x32_bf16 v[148:151], v[52:55], v[36:39], v[148:151]
  v_mfma_f32_16x16x32_bf16 v[152:155], v[52:55], v[40:43], v[152:155]
  s_waitcnt lgkmcnt(0)
  v_mfma_f32_16x16x32_bf16 v[156:159], v[52:55], v[44:47], v[156:159]
  s_cmp_lg_u32 s62, 0
  s_cbranch_scc1 .fz_kernel_q_nr
  buffer_load_dwordx4 v[232:235], v15, s[12:15], s23 offen offset:0
  buffer_load_dwordx4 v[236:239], v15, s[12:15], s23 offen offset:32
  buffer_load_dwordx4 v[240:243], v15, s[12:15], s23 offen offset:64
  buffer_load_dwordx4 v[244:247], v15, s[12:15], s23 offen offset:96
.fz_kernel_q_nr:
  s_barrier
  v_mfma_f32_16x16x32_bf16 v[160:163], v[96:99], v[72:75], v[160:163]
  s_lshl_b32 s31, s26, 8
  s_add_u32 s31, s31, 155648
  v_and_b32 v22, 15, v2
  v_and_b32 v23, 48, v2
  v_mfma_f32_16x16x32_bf16 v[164:167], v[96:99], v[76:79], v[164:167]
  s_lshl_b32 s33, s27, 7
  s_add_u32 s33, s33, 155648
  v_lshlrev_b32 v22, 2, v22
  v_mov_b32 v1, 159952
  v_mfma_f32_16x16x32_bf16 v[168:171], v[96:99], v[80:83], v[168:171]
  v_add_u32 v29, s33, v22
  v_add_u32 v22, s31, v22
  v_mfma_f32_16x16x32_bf16 v[172:175], v[96:99], v[84:87], v[172:175]
  v_add_u32 v28, s33, v23
  v_add_u32 v23, s31, v23
  v_mfma_f32_16x16x32_bf16 v[176:179], v[100:103], v[72:75], v[176:179]
  ds_read_b32 v1, v1
  v_add_u32 v64, 4608, v22
  v_mfma_f32_16x16x32_bf16 v[180:183], v[100:103], v[76:79], v[180:183]
  ds_read_b128 v[120:123], v28 offset:5888
  v_and_b32 v12, 1, v2
  v_mfma_f32_16x16x32_bf16 v[184:187], v[100:103], v[80:83], v[184:187]
  ds_read_b128 v[124:127], v28 offset:5952
  v_add_u32 v12, -1, v12
  v_mfma_f32_16x16x32_bf16 v[188:191], v[100:103], v[84:87], v[188:191]
  ds_read2_b32 v[224:225], v64 offset0:0 offset1:128
  v_and_b32 v12, 0x3f803f80, v12
  v_mfma_f32_16x16x32_bf16 v[192:195], v[72:75], v[104:107], v[192:195]
  ds_read2_b32 v[226:227], v64 offset0:16 offset1:144
  v_and_b32 v11, 2, v2
  v_mfma_f32_16x16x32_bf16 v[196:199], v[76:79], v[104:107], v[196:199]
  ds_read2_b32 v[228:229], v64 offset0:32 offset1:160
  v_xor_b32 v14, 0x3f803f80, v12
  v_mfma_f32_16x16x32_bf16 v[200:203], v[80:83], v[104:107], v[200:203]
  ds_read2_b32 v[230:231], v64 offset0:48 offset1:176
  v_mul_u32_u24 v11, 0x5555, v11
  v_mfma_f32_16x16x32_bf16 v[204:207], v[84:87], v[104:107], v[204:207]
  ds_read_b32 v24, v29 offset:6144
  v_mov_b32 v13, v12
  v_mfma_f32_16x16x32_bf16 v[208:211], v[72:75], v[108:111], v[208:211]
  ds_read_b32 v26, v29 offset:6208
  v_mov_b32 v15, v14
  v_mfma_f32_16x16x32_bf16 v[212:215], v[76:79], v[108:111], v[212:215]
  ds_read_b128 v[32:35], v23 offset:4608
  ds_read_b128 v[48:51], v23 offset:5120
  v_mfma_f32_16x16x32_bf16 v[216:219], v[80:83], v[108:111], v[216:219]
  ds_read_b128 v[36:39], v23 offset:4672
  ds_read_b128 v[52:55], v23 offset:5184
  v_mfma_f32_16x16x32_bf16 v[220:223], v[84:87], v[108:111], v[220:223]
  ds_read_b128 v[40:43], v23 offset:4736
  ds_read_b128 v[56:59], v23 offset:5248
  v_mfma_f32_16x16x32_bf16 v[128:131], v[88:91], v[72:75], v[128:131]
  ds_read_b128 v[44:47], v23 offset:4800
  ds_read_b128 v[60:63], v23 offset:5312
  v_mfma_f32_16x16x32_bf16 v[132:135], v[88:91], v[76:79], v[132:135]
  ds_read_b128 v[112:115], v28 offset:5632
  ds_read_b128 v[116:119], v28 offset:5696
  v_mfma_f32_16x16x32_bf16 v[136:139], v[88:91], v[80:83], v[136:139]
  s_lshl1_add_u32 s34, s18, s27
  s_lshl4_add_u32 s34, s34, s17
  s_lshl1_add_u32 s34, s34, s26
  v_mfma_f32_16x16x32_bf16 v[140:143], v[88:91], v[84:87], v[140:143]
  s_lshl_b32 s36, s34, 13
  s_add_u32 s36, s36, s63
  s_add_u32 s37, s36, 4096
  v_mfma_f32_16x16x32_bf16 v[144:147], v[92:95], v[72:75], v[144:147]
  s_lshl_b32 s34, s16, 12
  s_add_u32 s34, s34, 131072
  v_add_u32 v9, s34, v3
  v_mfma_f32_16x16x32_bf16 v[148:151], v[92:95], v[76:79], v[148:151]
  v_xor_b32 v8, 8192, v9
  v_mfma_f32_16x16x32_bf16 v[152:155], v[92:95], v[80:83], v[152:155]
  v_add_u32 v11, 0x4444, v11
  v_mfma_f32_16x16x32_bf16 v[156:159], v[92:95], v[84:87], v[156:159]
  v_add_u32 v10, 4096, v3
  s_waitcnt lgkmcnt(12)
  v_add_u32 v1, -1, v1
  v_lshrrev_b32 v1, 6, v1
  v_cmp_eq_u32 vcc, s26, v1
  s_cbranch_vccnz .fz_kernel_q_patch
.fz_kernel_q_pback:
  v_pk_mul_f32 v[64:65], v[120:121], v[224:225] op_sel:[0,1] op_sel_hi:[1,1]
  v_pk_fma_f32 v[160:161], v[160:161], v[224:225], v[64:65] op_sel_hi:[1,0,1]
  v_pk_mul_f32 v[66:67], v[122:123], v[224:225] op_sel:[0,1] op_sel_hi:[1,1]
  v_pk_fma_f32 v[162:163], v[162:163], v[224:225], v[66:67] op_sel_hi:[1,0,1]
  v_pk_mul_f32 v[68:69], v[124:125], v[224:225] op_sel:[0,1] op_sel_hi:[1,1]
  v_pk_fma_f32 v[176:177], v[176:177], v[224:225], v[68:69] op_sel_hi:[1,0,1]
  v_pk_mul_f32 v[70:71], v[126:127], v[224:225] op_sel:[0,1] op_sel_hi:[1,1]
  v_pk_fma_f32 v[178:179], v[178:179], v[224:225], v[70:71] op_sel_hi:[1,0,1]
  v_cvt_pk_bf16_f32 v80, v160, v161
  v_cvt_pk_bf16_f32 v81, v162, v163
  v_cvt_pk_bf16_f32 v82, v176, v177
  v_cvt_pk_bf16_f32 v83, v178, v179
  v_pk_mul_f32 v[64:65], v[120:121], v[226:227] op_sel:[0,1] op_sel_hi:[1,1]
  v_pk_fma_f32 v[164:165], v[164:165], v[226:227], v[64:65] op_sel_hi:[1,0,1]
  v_pk_mul_f32 v[66:67], v[122:123], v[226:227] op_sel:[0,1] op_sel_hi:[1,1]
  v_pk_fma_f32 v[166:167], v[166:167], v[226:227], v[66:67] op_sel_hi:[1,0,1]
  v_pk_mul_f32 v[68:69], v[124:125], v[226:227] op_sel:[0,1] op_sel_hi:[1,1]
  v_pk_fma_f32 v[180:181], v[180:181], v[226:227], v[68:69] op_sel_hi:[1,0,1]
  v_pk_mul_f32 v[70:71], v[126:127], v[226:227] op_sel:[0,1] op_sel_hi:[1,1]
  v_pk_fma_f32 v[182:183], v[182:183], v[226:227], v[70:71] op_sel_hi:[1,0,1]
  v_cvt_pk_bf16_f32 v84, v164, v165
  v_cvt_pk_bf16_f32 v85, v166, v167
  v_cvt_pk_bf16_f32 v86, v180, v181
  v_cvt_pk_bf16_f32 v87, v182, v183
  v_permlane16_swap_b32 v80, v84
  v_permlane16_swap_b32 v81, v85
  v_permlane16_swap_b32 v82, v86
  v_permlane16_swap_b32 v83, v87
  buffer_store_dwordx4 v[80:83], v3, s[4:7], s36 offen offset:0 sc1
  buffer_store_dwordx4 v[84:87], v3, s[4:7], s36 offen offset:1024 sc1
  v_pk_mul_f32 v[64:65], v[120:121], v[228:229] op_sel:[0,1] op_sel_hi:[1,1]
  v_pk_fma_f32 v[168:169], v[168:169], v[228:229], v[64:65] op_sel_hi:[1,0,1]
  v_pk_mul_f32 v[66:67], v[122:123], v[228:229] op_sel:[0,1] op_sel_hi:[1,1]
  v_pk_fma_f32 v[170:171], v[170:171], v[228:229], v[66:67] op_sel_hi:[1,0,1]
  v_pk_mul_f32 v[68:69], v[124:125], v[228:229] op_sel:[0,1] op_sel_hi:[1,1]
  v_pk_fma_f32 v[184:185], v[184:185], v[228:229], v[68:69] op_sel_hi:[1,0,1]
  v_pk_mul_f32 v[70:71], v[126:127], v[228:229] op_sel:[0,1] op_sel_hi:[1,1]
  v_pk_fma_f32 v[186:187], v[186:187], v[228:229], v[70:71] op_sel_hi:[1,0,1]
  v_cvt_pk_bf16_f32 v96, v168, v169
  v_cvt_pk_bf16_f32 v97, v170, v171
  v_cvt_pk_bf16_f32 v98, v184, v185
  v_cvt_pk_bf16_f32 v99, v186, v187
  v_pk_mul_f32 v[64:65], v[120:121], v[230:231] op_sel:[0,1] op_sel_hi:[1,1]
  v_pk_fma_f32 v[172:173], v[172:173], v[230:231], v[64:65] op_sel_hi:[1,0,1]
  v_pk_mul_f32 v[66:67], v[122:123], v[230:231] op_sel:[0,1] op_sel_hi:[1,1]
  v_pk_fma_f32 v[174:175], v[174:175], v[230:231], v[66:67] op_sel_hi:[1,0,1]
  v_pk_mul_f32 v[68:69], v[124:125], v[230:231] op_sel:[0,1] op_sel_hi:[1,1]
  v_pk_fma_f32 v[188:189], v[188:189], v[230:231], v[68:69] op_sel_hi:[1,0,1]
  v_pk_mul_f32 v[70:71], v[126:127], v[230:231] op_sel:[0,1] op_sel_hi:[1,1]
  v_pk_fma_f32 v[190:191], v[190:191], v[230:231], v[70:71] op_sel_hi:[1,0,1]
  v_cvt_pk_bf16_f32 v100, v172, v173
  v_cvt_pk_bf16_f32 v101, v174, v175
  v_cvt_pk_bf16_f32 v102, v188, v189
  v_cvt_pk_bf16_f32 v103, v190, v191
  v_permlane16_swap_b32 v96, v100
  v_permlane16_swap_b32 v97, v101
  v_permlane16_swap_b32 v98, v102
  v_permlane16_swap_b32 v99, v103
  buffer_store_dwordx4 v[96:99], v3, s[4:7], s37 offen offset:0 sc1
  buffer_store_dwordx4 v[100:103], v3, s[4:7], s37 offen offset:1024 sc1
  s_waitcnt lgkmcnt(0)
  v_pk_mul_f32 v[64:65], v[48:49], v[24:25] op_sel_hi:[1,0]
  v_pk_fma_f32 v[192:193], v[192:193], v[32:33], v[64:65]
  v_pk_mul_f32 v[66:67], v[50:51], v[24:25] op_sel_hi:[1,0]
  v_pk_fma_f32 v[194:195], v[194:195], v[34:35], v[66:67]
  v_pk_mul_f32 v[68:69], v[48:49], v[26:27] op_sel_hi:[1,0]
  v_pk_fma_f32 v[208:209], v[208:209], v[32:33], v[68:69]
  v_pk_mul_f32 v[70:71], v[50:51], v[26:27] op_sel_hi:[1,0]
  v_pk_fma_f32 v[210:211], v[210:211], v[34:35], v[70:71]
  v_cvt_pk_bf16_f32 v88, v192, v193
  v_cvt_pk_bf16_f32 v90, v208, v209
  v_cvt_pk_bf16_f32 v89, v194, v195
  v_cvt_pk_bf16_f32 v91, v210, v211
  v_pk_mul_f32 v[64:65], v[52:53], v[24:25] op_sel_hi:[1,0]
  v_pk_fma_f32 v[196:197], v[196:197], v[36:37], v[64:65]
  v_pk_mul_f32 v[66:67], v[54:55], v[24:25] op_sel_hi:[1,0]
  v_pk_fma_f32 v[198:199], v[198:199], v[38:39], v[66:67]
  v_pk_mul_f32 v[68:69], v[52:53], v[26:27] op_sel_hi:[1,0]
  v_pk_fma_f32 v[212:213], v[212:213], v[36:37], v[68:69]
  v_pk_mul_f32 v[70:71], v[54:55], v[26:27] op_sel_hi:[1,0]
  v_pk_fma_f32 v[214:215], v[214:215], v[38:39], v[70:71]
  v_cvt_pk_bf16_f32 v92, v196, v197
  v_cvt_pk_bf16_f32 v94, v212, v213
  v_cvt_pk_bf16_f32 v93, v198, v199
  v_cvt_pk_bf16_f32 v95, v214, v215
  v_permlane16_swap_b32 v88, v90
  v_permlane16_swap_b32 v89, v91
  v_permlane16_swap_b32 v92, v94
  v_permlane16_swap_b32 v93, v95
  v_permlane32_swap_b32 v88, v90
  v_permlane32_swap_b32 v89, v91
  v_permlane32_swap_b32 v92, v94
  v_permlane32_swap_b32 v93, v95
  buffer_store_dwordx4 v[88:91], v3, s[4:7], s36 offen offset:2048 sc1
  buffer_store_dwordx4 v[92:95], v3, s[4:7], s36 offen offset:3072 sc1
  v_pk_mul_f32 v[64:65], v[56:57], v[24:25] op_sel_hi:[1,0]
  v_pk_fma_f32 v[200:201], v[200:201], v[40:41], v[64:65]
  v_pk_mul_f32 v[66:67], v[58:59], v[24:25] op_sel_hi:[1,0]
  v_pk_fma_f32 v[202:203], v[202:203], v[42:43], v[66:67]
  v_pk_mul_f32 v[68:69], v[56:57], v[26:27] op_sel_hi:[1,0]
  v_pk_fma_f32 v[216:217], v[216:217], v[40:41], v[68:69]
  v_pk_mul_f32 v[70:71], v[58:59], v[26:27] op_sel_hi:[1,0]
  v_pk_fma_f32 v[218:219], v[218:219], v[42:43], v[70:71]
  v_cvt_pk_bf16_f32 v104, v200, v201
  v_cvt_pk_bf16_f32 v106, v216, v217
  v_cvt_pk_bf16_f32 v105, v202, v203
  v_cvt_pk_bf16_f32 v107, v218, v219
  v_pk_mul_f32 v[64:65], v[60:61], v[24:25] op_sel_hi:[1,0]
  v_pk_fma_f32 v[204:205], v[204:205], v[44:45], v[64:65]
  v_pk_mul_f32 v[66:67], v[62:63], v[24:25] op_sel_hi:[1,0]
  v_pk_fma_f32 v[206:207], v[206:207], v[46:47], v[66:67]
  v_pk_mul_f32 v[68:69], v[60:61], v[26:27] op_sel_hi:[1,0]
  v_pk_fma_f32 v[220:221], v[220:221], v[44:45], v[68:69]
  v_pk_mul_f32 v[70:71], v[62:63], v[26:27] op_sel_hi:[1,0]
  v_pk_fma_f32 v[222:223], v[222:223], v[46:47], v[70:71]
  v_cvt_pk_bf16_f32 v108, v204, v205
  v_cvt_pk_bf16_f32 v110, v220, v221
  v_cvt_pk_bf16_f32 v109, v206, v207
  v_cvt_pk_bf16_f32 v111, v222, v223
  v_permlane16_swap_b32 v104, v106
  v_permlane16_swap_b32 v105, v107
  v_permlane16_swap_b32 v108, v110
  v_permlane16_swap_b32 v109, v111
  v_permlane32_swap_b32 v104, v106
  v_permlane32_swap_b32 v105, v107
  v_permlane32_swap_b32 v108, v110
  v_permlane32_swap_b32 v109, v111
  buffer_store_dwordx4 v[104:107], v3, s[4:7], s37 offen offset:2048 sc1
  buffer_store_dwordx4 v[108:111], v3, s[4:7], s37 offen offset:3072 sc1
  v_mul_f32 v224, 0.25503486164919736, v224
  v_mul_f32 v225, 0.25503486164919736, v225
  v_mul_f32 v226, 0.25503486164919736, v226
  v_mul_f32 v227, 0.25503486164919736, v227
  v_mul_f32 v228, 0.25503486164919736, v228
  v_mul_f32 v229, 0.25503486164919736, v229
  v_mul_f32 v230, 0.25503486164919736, v230
  v_mul_f32 v231, 0.25503486164919736, v231
  v_pk_mul_f32 v[64:65], v[112:113], v[224:225] op_sel:[0,1] op_sel_hi:[1,1]
  v_pk_fma_f32 v[128:129], v[128:129], v[224:225], v[64:65] op_sel_hi:[1,0,1]
  v_pk_mul_f32 v[66:67], v[114:115], v[224:225] op_sel:[0,1] op_sel_hi:[1,1]
  v_pk_fma_f32 v[130:131], v[130:131], v[224:225], v[66:67] op_sel_hi:[1,0,1]
  v_pk_mul_f32 v[68:69], v[116:117], v[224:225] op_sel:[0,1] op_sel_hi:[1,1]
  v_pk_fma_f32 v[144:145], v[144:145], v[224:225], v[68:69] op_sel_hi:[1,0,1]
  v_pk_mul_f32 v[70:71], v[118:119], v[224:225] op_sel:[0,1] op_sel_hi:[1,1]
  v_pk_fma_f32 v[146:147], v[146:147], v[224:225], v[70:71] op_sel_hi:[1,0,1]
  v_cvt_pk_bf16_f32 v16, v128, v129
  v_cvt_pk_bf16_f32 v17, v130, v131
  v_cvt_pk_bf16_f32 v18, v144, v145
  v_cvt_pk_bf16_f32 v19, v146, v147
  v_pk_mul_f32 v[64:65], v[112:113], v[226:227] op_sel:[0,1] op_sel_hi:[1,1]
  v_pk_fma_f32 v[132:133], v[132:133], v[226:227], v[64:65] op_sel_hi:[1,0,1]
  v_pk_mul_f32 v[66:67], v[114:115], v[226:227] op_sel:[0,1] op_sel_hi:[1,1]
  v_pk_fma_f32 v[134:135], v[134:135], v[226:227], v[66:67] op_sel_hi:[1,0,1]
  v_pk_mul_f32 v[68:69], v[116:117], v[226:227] op_sel:[0,1] op_sel_hi:[1,1]
  v_pk_fma_f32 v[148:149], v[148:149], v[226:227], v[68:69] op_sel_hi:[1,0,1]
  v_pk_mul_f32 v[70:71], v[118:119], v[226:227] op_sel:[0,1] op_sel_hi:[1,1]
  v_pk_fma_f32 v[150:151], v[150:151], v[226:227], v[70:71] op_sel_hi:[1,0,1]
  v_cvt_pk_bf16_f32 v20, v132, v133
  v_cvt_pk_bf16_f32 v21, v134, v135
  v_cvt_pk_bf16_f32 v22, v148, v149
  v_cvt_pk_bf16_f32 v23, v150, v151
  v_permlane16_swap_b32 v16, v20
  v_permlane16_swap_b32 v17, v21
  v_permlane16_swap_b32 v18, v22
  v_permlane16_swap_b32 v19, v23
  ds_write_b128 v8, v[16:19] offset:0
  ds_write_b128 v8, v[20:23] offset:1024
  v_pk_mul_f32 v[64:65], v[112:113], v[228:229] op_sel:[0,1] op_sel_hi:[1,1]
  v_pk_fma_f32 v[136:137], v[136:137], v[228:229], v[64:65] op_sel_hi:[1,0,1]
  v_pk_mul_f32 v[66:67], v[114:115], v[228:229] op_sel:[0,1] op_sel_hi:[1,1]
  v_pk_fma_f32 v[138:139], v[138:139], v[228:229], v[66:67] op_sel_hi:[1,0,1]
  v_pk_mul_f32 v[68:69], v[116:117], v[228:229] op_sel:[0,1] op_sel_hi:[1,1]
  v_pk_fma_f32 v[152:153], v[152:153], v[228:229], v[68:69] op_sel_hi:[1,0,1]
  v_pk_mul_f32 v[70:71], v[118:119], v[228:229] op_sel:[0,1] op_sel_hi:[1,1]
  v_pk_fma_f32 v[154:155], v[154:155], v[228:229], v[70:71] op_sel_hi:[1,0,1]
  v_cvt_pk_bf16_f32 v24, v136, v137
  v_cvt_pk_bf16_f32 v25, v138, v139
  v_cvt_pk_bf16_f32 v26, v152, v153
  v_cvt_pk_bf16_f32 v27, v154, v155
  v_pk_mul_f32 v[64:65], v[112:113], v[230:231] op_sel:[0,1] op_sel_hi:[1,1]
  v_pk_fma_f32 v[140:141], v[140:141], v[230:231], v[64:65] op_sel_hi:[1,0,1]
  v_pk_mul_f32 v[66:67], v[114:115], v[230:231] op_sel:[0,1] op_sel_hi:[1,1]
  v_pk_fma_f32 v[142:143], v[142:143], v[230:231], v[66:67] op_sel_hi:[1,0,1]
  v_pk_mul_f32 v[68:69], v[116:117], v[230:231] op_sel:[0,1] op_sel_hi:[1,1]
  v_pk_fma_f32 v[156:157], v[156:157], v[230:231], v[68:69] op_sel_hi:[1,0,1]
  v_pk_mul_f32 v[70:71], v[118:119], v[230:231] op_sel:[0,1] op_sel_hi:[1,1]
  v_pk_fma_f32 v[158:159], v[158:159], v[230:231], v[70:71] op_sel_hi:[1,0,1]
  v_cvt_pk_bf16_f32 v28, v140, v141
  v_cvt_pk_bf16_f32 v29, v142, v143
  v_cvt_pk_bf16_f32 v30, v156, v157
  v_cvt_pk_bf16_f32 v31, v158, v159
  v_permlane16_swap_b32 v24, v28
  v_permlane16_swap_b32 v25, v29
  v_permlane16_swap_b32 v26, v30
  v_permlane16_swap_b32 v27, v31
  ds_write_b128 v8, v[24:27] offset:2048
  ds_write_b128 v8, v[28:31] offset:3072
  s_branch .fz_kernel_att
.fz_kernel_q_help1:
  s_waitcnt lgkmcnt(0)
  s_mov_b32 s3, 32
  s_cmp_eq_u32 s16, 7
  s_cbranch_scc1 .fz_kernel_q_h7
  s_getpc_b64 s[0:1]
.fz_kernel_ct4:
  s_sub_u32 s0, s0, .fz_kernel_ct4-fz_kernel
  s_subb_u32 s1, s1, 0
  s_lshr_b32 s31, s2, 3
  s_mulk_i32 s31, 0x500
  v_lshl_add_u32 v1, v2, 7, s31
  v_min_u32 v1, .fz_kernel_last-fz_kernel, v1
  s_mov_b64 exec, 0x3ff
  global_load_dword v1, v1, s[0:1]
  s_mov_b64 exec, -1
.fz_kernel_ct4e:
  s_mov_b32 s12, s58
  s_mov_b32 s13, s59
  s_mov_b32 s14, 0x100
  s_mov_b32 s15, 0x00020000
  s_mov_b32 s30, 0
  s_and_b32 s31, s18, 3
  s_sub_u32 s31, s31, s30
  s_and_b32 s30, s31, 3
  s_lshl_b32 s30, s30, 14
  v_and_b32 v20, 15, v2
  v_lshrrev_b32 v21, 4, v2
  v_bfe_u32 v22, v2, 1, 3
  v_xor_b32 v22, v22, v21
  v_lshlrev_b32 v21, 7, v20
  v_lshl_add_u32 v21, v22, 4, v21
  v_add_u32 v21, s30, v21
  v_xor_b32 v22, 64, v21
  v_lshlrev_b32 v20, 3, v20
  s_lshl_b32 s30, s17, 10
  s_add_u32 s30, s30, 0x1808000
  s_mov_b32 exec_lo, 0x00f0000f
  s_mov_b32 exec_hi, 0xf0000f00
  v_add_u32 v20, 4, v20
  s_mov_b64 exec, -1
  v_mov_b32 v24, 0x3f803f80
  v_mov_b32 v25, v24
  v_mov_b32 v26, v24
  v_mov_b32 v27, v24
  s_lshl_b32 s31, s31, 1
  s_sub_u32 s31, 31, s31
  v_lshlrev_b32 v52, 3, v2
  v_add_u32 v52, 155648, v52
  v_mov_b32 v54, 1.0
  v_mov_b32 v55, 1.0
  v_mov_b32 v56, 0
  v_mov_b32 v57, 0
  ds_write_b64 v52, v[54:55] offset:6400
  ds_write_b64 v52, v[56:57] offset:6912
  s_mov_b32 s20, s48
  s_mov_b32 s21, s49
  s_mov_b32 s22, 0x800
  s_mov_b32 s23, 0x00020000
  v_lshlrev_b32 v40, 5, v2
  buffer_load_dwordx4 v[44:47], v40, s[20:23], 0 offen
  buffer_load_dwordx4 v[48:51], v40, s[20:23], 0 offen offset:16
  v_mov_b32 v40, 0
  s_waitcnt vmcnt(0)
  v_lshlrev_b32 v41, 16, v44
  v_and_b32 v42, 0xffff0000, v44
  v_add_f32 v40, v40, v41
  v_add_f32 v40, v40, v42
  v_lshlrev_b32 v41, 16, v45
  v_and_b32 v42, 0xffff0000, v45
  v_add_f32 v40, v40, v41
  v_add_f32 v40, v40, v42
  v_lshlrev_b32 v41, 16, v46
  v_and_b32 v42, 0xffff0000, v46
  v_add_f32 v40, v40, v41
  v_add_f32 v40, v40, v42
  v_lshlrev_b32 v41, 16, v47
  v_and_b32 v42, 0xffff0000, v47
  v_add_f32 v40, v40, v41
  v_add_f32 v40, v40, v42
  v_lshlrev_b32 v41, 16, v48
  v_and_b32 v42, 0xffff0000, v48
  v_add_f32 v40, v40, v41
  v_add_f32 v40, v40, v42
  v_lshlrev_b32 v41, 16, v49
  v_and_b32 v42, 0xffff0000, v49
  v_add_f32 v40, v40, v41
  v_add_f32 v40, v40, v42
  v_lshlrev_b32 v41, 16, v50
  v_and_b32 v42, 0xffff0000, v50
  v_add_f32 v40, v40, v41
  v_add_f32 v40, v40, v42
  v_lshlrev_b32 v41, 16, v51
  v_and_b32 v42, 0xffff0000, v51
  v_add_f32 v40, v40, v41
  v_add_f32 v40, v40, v42
  s_nop 1
  v_add_f32 v40, v40, v40 quad_perm:[1,0,3,2] row_mask:0xf bank_mask:0xf
  s_nop 1
  v_add_f32 v40, v40, v40 quad_perm:[2,3,0,1] row_mask:0xf bank_mask:0xf
  s_nop 1
  v_add_f32 v40, v40, v40 row_half_mirror row_mask:0xf bank_mask:0xf
  s_nop 1
  v_add_f32 v40, v40, v40 row_mirror row_mask:0xf bank_mask:0xf
  s_nop 0
  v_readlane_b32 s20, v40, 16
  v_readlane_b32 s21, v40, 32
  v_readlane_b32 s22, v40, 48
  v_add_f32 v40, s20, v40
  v_add_f32 v40, s21, v40
  v_add_f32 v40, s22, v40
  v_mul_f32 v40, 0x3a800000, v40
  s_nop 0
  v_readfirstlane_b32 s76, v40
.fz_kernel_xs5:
  s_barrier
  s_sub_u32 s3, s3, 1
  s_cmp_lg_u32 s3, s31
  s_cbranch_scc1 .fz_kernel_xs5
  ds_read_b128 v[64:67], v21 offset:0
  ds_read_b128 v[72:75], v21 offset:2048
  ds_read_b128 v[80:83], v21 offset:4096
  ds_read_b128 v[88:91], v21 offset:6144
  ds_read_b128 v[96:99], v21 offset:8192
  ds_read_b128 v[104:107], v21 offset:10240
  ds_read_b128 v[112:115], v21 offset:12288
  ds_read_b128 v[120:123], v21 offset:14336
  ds_read_b128 v[68:71], v22 offset:0
  ds_read_b128 v[76:79], v22 offset:2048
  ds_read_b128 v[84:87], v22 offset:4096
  ds_read_b128 v[92:95], v22 offset:6144
  ds_read_b128 v[100:103], v22 offset:8192
  ds_read_b128 v[108:111], v22 offset:10240
  ds_read_b128 v[116:119], v22 offset:12288
  ds_read_b128 v[124:127], v22 offset:14336
  s_waitcnt lgkmcnt(0)
  s_cmp_eq_u32 s3, 0
  s_cbranch_scc1 .fz_kernel_hb6
  s_barrier
  s_sub_u32 s3, s3, 1
.fz_kernel_hb6:
  s_setprio 2
  v_mfma_f32_16x16x32_bf16 v[128:131], v[24:27], v[64:67], 0
  v_mfma_f32_16x16x32_bf16 v[160:163], v[64:67], v[64:67], 0
  v_mfma_f32_16x16x32_bf16 v[132:135], v[24:27], v[72:75], 0
  v_mfma_f32_16x16x32_bf16 v[164:167], v[72:75], v[72:75], 0
  v_mfma_f32_16x16x32_bf16 v[136:139], v[24:27], v[80:83], 0
  v_mfma_f32_16x16x32_bf16 v[168:171], v[80:83], v[80:83], 0
  v_mfma_f32_16x16x32_bf16 v[140:143], v[24:27], v[88:91], 0
  v_mfma_f32_16x16x32_bf16 v[172:175], v[88:91], v[88:91], 0
  v_mfma_f32_16x16x32_bf16 v[144:147], v[24:27], v[96:99], 0
  v_mfma_f32_16x16x32_bf16 v[176:179], v[96:99], v[96:99], 0
  v_mfma_f32_16x16x32_bf16 v[148:151], v[24:27], v[104:107], 0
  v_mfma_f32_16x16x32_bf16 v[180:183], v[104:107], v[104:107], 0
  v_mfma_f32_16x16x32_bf16 v[152:155], v[24:27], v[112:115], 0
  v_mfma_f32_16x16x32_bf16 v[184:187], v[112:115], v[112:115], 0
  v_mfma_f32_16x16x32_bf16 v[156:159], v[24:27], v[120:123], 0
  v_mfma_f32_16x16x32_bf16 v[188:191], v[120:123], v[120:123], 0
  v_mfma_f32_16x16x32_bf16 v[128:131], v[24:27], v[68:71], v[128:131]
  v_mfma_f32_16x16x32_bf16 v[160:163], v[68:71], v[68:71], v[160:163]
  v_mfma_f32_16x16x32_bf16 v[132:135], v[24:27], v[76:79], v[132:135]
  v_mfma_f32_16x16x32_bf16 v[164:167], v[76:79], v[76:79], v[164:167]
  v_mfma_f32_16x16x32_bf16 v[136:139], v[24:27], v[84:87], v[136:139]
  v_mfma_f32_16x16x32_bf16 v[168:171], v[84:87], v[84:87], v[168:171]
  v_mfma_f32_16x16x32_bf16 v[140:143], v[24:27], v[92:95], v[140:143]
  v_mfma_f32_16x16x32_bf16 v[172:175], v[92:95], v[92:95], v[172:175]
  v_mfma_f32_16x16x32_bf16 v[144:147], v[24:27], v[100:103], v[144:147]
  v_mfma_f32_16x16x32_bf16 v[176:179], v[100:103], v[100:103], v[176:179]
  v_mfma_f32_16x16x32_bf16 v[148:151], v[24:27], v[108:111], v[148:151]
  v_mfma_f32_16x16x32_bf16 v[180:183], v[108:111], v[108:111], v[180:183]
  v_mfma_f32_16x16x32_bf16 v[152:155], v[24:27], v[116:119], v[152:155]
  v_mfma_f32_16x16x32_bf16 v[184:187], v[116:119], v[116:119], v[184:187]
  v_mfma_f32_16x16x32_bf16 v[156:159], v[24:27], v[124:127], v[156:159]
  v_mfma_f32_16x16x32_bf16 v[188:191], v[124:127], v[124:127], v[188:191]
  s_setprio 0
  s_cmp_eq_u32 s3, 0
  s_cbranch_scc1 .fz_kernel_hb7
  s_barrier
  s_sub_u32 s3, s3, 1
.fz_kernel_hb7:
  s_mov_b32 exec_lo, 0x100001
  s_mov_b32 exec_hi, 0x10000100
  buffer_load_dword v9, v4, s[12:15], 0 offen sc1
  v_mov_b32 v128, v160
  v_mov_b32 v132, v164
  v_mov_b32 v136, v168
  v_mov_b32 v140, v172
  v_mov_b32 v144, v176
  v_mov_b32 v148, v180
  v_mov_b32 v152, v184
  v_mov_b32 v156, v188
  s_mov_b32 exec_lo, 0x200002
  s_mov_b32 exec_hi, 0x20000200
  v_mov_b32 v128, v161
  v_mov_b32 v132, v165
  v_mov_b32 v136, v169
  v_mov_b32 v140, v173
  v_mov_b32 v144, v177
  v_mov_b32 v148, v181
  v_mov_b32 v152, v185
  v_mov_b32 v156, v189
  s_mov_b32 exec_lo, 0x400004
  s_mov_b32 exec_hi, 0x40000400
  v_mov_b32 v128, v162
  v_mov_b32 v132, v166
  v_mov_b32 v136, v170
  v_mov_b32 v140, v174
  v_mov_b32 v144, v178
  v_mov_b32 v148, v182
  v_mov_b32 v152, v186
  v_mov_b32 v156, v190
  s_cmp_eq_u32 s3, 0
  s_cbranch_scc1 .fz_kernel_hb8
  s_barrier
  s_sub_u32 s3, s3, 1
.fz_kernel_hb8:
  s_mov_b32 exec_lo, 0x800008
  s_mov_b32 exec_hi, 0x80000800
  v_mov_b32 v128, v163
  v_mov_b32 v132, v167
  v_mov_b32 v136, v171
  v_mov_b32 v140, v175
  v_mov_b32 v144, v179
  v_mov_b32 v148, v183
  v_mov_b32 v152, v187
  v_mov_b32 v156, v191
  s_mov_b64 exec, 1
  s_mov_b32 s38, 0
.fz_kernel_pw9:
  s_mov_b32 s46, 0
  s_call_b64 s[0:1], .fz_kernel_hw
  s_waitcnt vmcnt(0)
  v_readfirstlane_b32 s31, v9
  s_cmp_eq_u32 s31, 64
  s_cbranch_scc1 .fz_kernel_pw9d
  s_cmp_eq_u32 s3, 0
  s_cbranch_scc1 .fz_kernel_hb10
  s_barrier
  s_sub_u32 s3, s3, 1
.fz_kernel_hb10:
  s_cmp_eq_u32 s3, 0
  s_cbranch_scc1 .fz_kernel_hb11
  s_barrier
  s_sub_u32 s3, s3, 1
.fz_kernel_hb11:
  buffer_load_dword v9, v4, s[12:15], 0 offen sc1
  s_add_u32 s38, s38, 1
  s_cmp_lt_u32 s38, 131072
  s_cbranch_scc1 .fz_kernel_pw9
  s_waitcnt vmcnt(0)
.fz_kernel_pw9d:
  s_mov_b64 exec, -1
  s_cmp_eq_u32 s3, 0
  s_cbranch_scc1 .fz_kernel_hb12
  s_barrier
  s_sub_u32 s3, s3, 1
.fz_kernel_hb12:
  s_mov_b32 exec_lo, 0x00fff00f
  s_mov_b32 exec_hi, 0xff000ff0
  buffer_atomic_add_f32 v128, v20, s[4:7], s30 offen offset:0 sc1
  buffer_atomic_add_f32 v132, v20, s[4:7], s30 offen offset:128 sc1
  buffer_atomic_add_f32 v136, v20, s[4:7], s30 offen offset:256 sc1
  buffer_atomic_add_f32 v140, v20, s[4:7], s30 offen offset:384 sc1
  buffer_atomic_add_f32 v144, v20, s[4:7], s30 offen offset:512 sc1
  buffer_atomic_add_f32 v148, v20, s[4:7], s30 offen offset:640 sc1
  buffer_atomic_add_f32 v152, v20, s[4:7], s30 offen offset:768 sc1
  buffer_atomic_add_f32 v156, v20, s[4:7], s30 offen offset:896 sc1
  s_mov_b64 exec, -1
  s_mov_b32 s46, 0
  s_call_b64 s[0:1], .fz_kernel_hw
  s_waitcnt vmcnt(0)
  v_lshlrev_b32 v7, 11, v2
  s_lshl_b32 s31, s17, 7
  s_lshl_b32 s33, 1, s18
  s_add_u32 s31, s31, s67
  s_add_u32 s31, s31, 0x1800018
  v_mov_b32 v8, s33
  s_mov_b64 exec, 0xffff
  buffer_atomic_or v8, v7, s[4:7], s31 offen sc1
  s_mov_b64 exec, -1
  s_add_u32 s37, s19, 24
.fz_kernel_f113:
  s_cmp_le_u32 s3, 9
  s_cbranch_scc1 .fz_kernel_f113d
  s_barrier
  s_sub_u32 s3, s3, 1
  s_branch .fz_kernel_f113
.fz_kernel_f113d:
  s_mov_b64 exec, 1
  buffer_load_dword v9, v4, s[4:7], s37 offen sc1
  s_mov_b64 exec, 1
  s_mov_b32 s38, 0
.fz_kernel_pw14:
  s_mov_b32 s46, 0
  s_call_b64 s[0:1], .fz_kernel_hw
  s_waitcnt vmcnt(0)
  v_readfirstlane_b32 s31, v9
  s_cmp_eq_u32 s31, 65535
  s_cbranch_scc1 .fz_kernel_pw14d
  s_cmp_eq_u32 s3, 0
  s_cbranch_scc1 .fz_kernel_hb15
  s_barrier
  s_sub_u32 s3, s3, 1
.fz_kernel_hb15:
  s_cmp_eq_u32 s3, 0
  s_cbranch_scc1 .fz_kernel_hb16
  s_barrier
  s_sub_u32 s3, s3, 1
.fz_kernel_hb16:
  buffer_load_dword v9, v4, s[4:7], s37 offen sc1
  s_add_u32 s38, s38, 1
  s_cmp_lt_u32 s38, 131072
  s_cbranch_scc1 .fz_kernel_pw14
  s_waitcnt vmcnt(0)
.fz_kernel_pw14d:
  s_mov_b64 exec, -1
  buffer_load_dwordx4 v[64:67], v3, s[4:7], s30 offen sc1
  s_mov_b32 s46, 0
  s_call_b64 s[0:1], .fz_kernel_hw
  s_waitcnt vmcnt(0)
  s_cmp_eq_u32 s3, 0
  s_cbranch_scc1 .fz_kernel_hb17
  s_barrier
  s_sub_u32 s3, s3, 1
.fz_kernel_hb17:
  v_mov_b32 v26, 0.0009765625
  v_mul_f32 v20, v26, v64
  v_mul_f32 v27, v20, v20
  v_fma_f32 v22, v65, v26, -v27
  v_max_f32 v22, 0, v22
  v_add_f32 v22, 1e-05, v22
  v_rsq_f32 v22, v22
  s_nop 0
  v_mul_f32 v20, v20, v22
  v_sub_f32 v20, 0, v20
  v_mul_f32 v21, v26, v66
  v_mul_f32 v27, v21, v21
  v_fma_f32 v23, v67, v26, -v27
  v_max_f32 v23, 0, v23
  v_add_f32 v23, 1e-05, v23
  v_rsq_f32 v23, v23
  s_nop 0
  v_mul_f32 v21, v21, v23
  v_sub_f32 v21, 0, v21
  ds_write_b64 v52, v[22:23] offset:4608
  ds_write_b64 v52, v[20:21] offset:5120
  v_mov_b32 v24, 159952
  v_mov_b32 v25, s76
  ds_write_b32 v24, v25 offset:8
  s_waitcnt lgkmcnt(0)
.fz_kernel_q_hw2:
  s_add_u32 s3, s3, 2
.fz_kernel_q_he:
  s_cmp_eq_u32 s3, 0
  s_cbranch_scc1 .fz_kernel_chain
  s_barrier
  s_sub_u32 s3, s3, 1
  s_branch .fz_kernel_q_he
.fz_kernel_q_h7:
  s_mov_b32 s8, s58
  s_mov_b32 s9, s59
  s_mov_b32 s10, 0x100
  s_mov_b32 s11, 0x00020000
  v_mov_b32 v12, 0
  v_mov_b32 v13, 0
  v_mov_b32 v14, 0
  v_mov_b32 v15, 0
  s_cmp_ge_u32 s2, 64
  s_cbranch_scc1 .fz_kernel_q_nzero
  s_lshl_b32 s36, s2, 10
  s_add_u32 s36, s36, 0x1800000
  buffer_store_dwordx4 v[12:15], v3, s[4:7], s36 offen sc1
.fz_kernel_q_nzero:
  v_and_b32 v21, 7, v2
  v_and_b32 v20, 16, v2
  v_lshlrev_b32 v20, 1, v20
  v_xor_b32 v20, v20, v3
  s_bfe_u32 s33, s17, 0x10002
  s_lshl_b32 s33, s33, 1
  s_and_b32 s31, s33, 3
  s_mul_i32 s31, s31, 12288
  s_add_u32 s31, s31, 65536
  v_add_u32 v16, s31, v20
  v_xor_b32 v17, 64, v16
  s_add_u32 s31, s31, 12288
  v_add_u32 v18, s31, v20
  v_xor_b32 v19, 64, v18
  s_sub_u32 s33, 31, s33
  v_lshlrev_b32 v21, 5, v21
  v_and_b32 v22, 24, v2
  v_add_u32 v21, v22, v21
  v_lshrrev_b32 v22, 5, v2
  v_lshl_add_u32 v21, v22, 2, v21
  s_lshl_b32 s30, s18, 10
  s_add_u32 s30, s30, 0x180c000
  v_and_b32 v22, 1, v2
  v_lshlrev_b32 v22, 4, v22
  v_mov_b32 v23, 0x3f80
  v_lshlrev_b32 v22, v22, v23
  v_mov_b32 v24, 0
  v_mov_b32 v25, 0
  v_mov_b32 v26, 0
  v_mov_b32 v27, 0
  s_mov_b32 exec_lo, 0x3030303
  s_mov_b32 exec_hi, 0x3030303
  v_mov_b32 v24, v22
  s_mov_b32 exec_lo, 0xc0c0c0c
  s_mov_b32 exec_hi, 0xc0c0c0c
  v_mov_b32 v25, v22
  s_mov_b32 exec_lo, 0x30303030
  s_mov_b32 exec_hi, 0x30303030
  v_mov_b32 v26, v22
  s_mov_b32 exec_lo, 0xc0c0c0c0
  s_mov_b32 exec_hi, 0xc0c0c0c0
  v_mov_b32 v27, v22
  s_mov_b64 exec, -1
  s_cmp_ge_u32 s2, 64
  s_cbranch_scc1 .fz_kernel_nz2
  s_mov_b64 exec, 1
  s_waitcnt vmcnt(0)
  buffer_atomic_add v5, v4, s[8:11], 0 offen sc1
  s_mov_b64 exec, -1
.fz_kernel_nz2:
  s_barrier
  s_sub_u32 s3, s3, 1
  s_cmp_lg_u32 s3, s33
  s_cbranch_scc1 .fz_kernel_nz2
  ds_read_b128 v[64:67], v16 offset:0
  ds_read_b128 v[68:71], v16 offset:4096
  ds_read_b128 v[72:75], v16 offset:8192
  ds_read_b128 v[76:79], v17 offset:1024
  ds_read_b128 v[80:83], v17 offset:5120
  ds_read_b128 v[84:87], v17 offset:9216
  ds_read_b128 v[88:91], v16 offset:2048
  ds_read_b128 v[92:95], v16 offset:6144
  ds_read_b128 v[96:99], v16 offset:10240
  ds_read_b128 v[100:103], v17 offset:3072
  ds_read_b128 v[104:107], v17 offset:7168
  ds_read_b128 v[108:111], v17 offset:11264
  s_waitcnt lgkmcnt(0)
  s_cmp_eq_u32 s3, 0
  s_cbranch_scc1 .fz_kernel_hb18
  s_barrier
  s_sub_u32 s3, s3, 1
.fz_kernel_hb18:
  ds_read_b128 v[112:115], v18 offset:0
  ds_read_b128 v[116:119], v18 offset:4096
  ds_read_b128 v[120:123], v18 offset:8192
  ds_read_b128 v[124:127], v19 offset:1024
  ds_read_b128 v[128:131], v19 offset:5120
  ds_read_b128 v[132:135], v19 offset:9216
  ds_read_b128 v[136:139], v18 offset:2048
  ds_read_b128 v[140:143], v18 offset:6144
  ds_read_b128 v[144:147], v18 offset:10240
  ds_read_b128 v[148:151], v19 offset:3072
  ds_read_b128 v[152:155], v19 offset:7168
  ds_read_b128 v[156:159], v19 offset:11264
  s_waitcnt lgkmcnt(0)
  s_cmp_eq_u32 s3, 0
  s_cbranch_scc1 .fz_kernel_hb19
  s_barrier
  s_sub_u32 s3, s3, 1
.fz_kernel_hb19:
  s_setprio 2
  v_mfma_f32_16x16x32_bf16 v[160:163], v[24:27], v[64:67], 0
  v_mfma_f32_16x16x32_bf16 v[164:167], v[24:27], v[68:71], 0
  v_mfma_f32_16x16x32_bf16 v[168:171], v[24:27], v[72:75], 0
  v_mfma_f32_16x16x32_bf16 v[160:163], v[24:27], v[76:79], v[160:163]
  v_mfma_f32_16x16x32_bf16 v[164:167], v[24:27], v[80:83], v[164:167]
  v_mfma_f32_16x16x32_bf16 v[168:171], v[24:27], v[84:87], v[168:171]
  v_mfma_f32_16x16x32_bf16 v[160:163], v[24:27], v[88:91], v[160:163]
  v_mfma_f32_16x16x32_bf16 v[164:167], v[24:27], v[92:95], v[164:167]
  v_mfma_f32_16x16x32_bf16 v[168:171], v[24:27], v[96:99], v[168:171]
  v_mfma_f32_16x16x32_bf16 v[160:163], v[24:27], v[100:103], v[160:163]
  v_mfma_f32_16x16x32_bf16 v[164:167], v[24:27], v[104:107], v[164:167]
  v_mfma_f32_16x16x32_bf16 v[168:171], v[24:27], v[108:111], v[168:171]
  v_mfma_f32_16x16x32_bf16 v[160:163], v[24:27], v[112:115], v[160:163]
  v_mfma_f32_16x16x32_bf16 v[164:167], v[24:27], v[116:119], v[164:167]
  v_mfma_f32_16x16x32_bf16 v[168:171], v[24:27], v[120:123], v[168:171]
  v_mfma_f32_16x16x32_bf16 v[160:163], v[24:27], v[124:127], v[160:163]
  v_mfma_f32_16x16x32_bf16 v[164:167], v[24:27], v[128:131], v[164:167]
  v_mfma_f32_16x16x32_bf16 v[168:171], v[24:27], v[132:135], v[168:171]
  v_mfma_f32_16x16x32_bf16 v[160:163], v[24:27], v[136:139], v[160:163]
  v_mfma_f32_16x16x32_bf16 v[164:167], v[24:27], v[140:143], v[164:167]
  v_mfma_f32_16x16x32_bf16 v[168:171], v[24:27], v[144:147], v[168:171]
  v_mfma_f32_16x16x32_bf16 v[160:163], v[24:27], v[148:151], v[160:163]
  v_mfma_f32_16x16x32_bf16 v[164:167], v[24:27], v[152:155], v[164:167]
  v_mfma_f32_16x16x32_bf16 v[168:171], v[24:27], v[156:159], v[168:171]
  s_setprio 0
  s_mov_b64 exec, 1
  buffer_load_dword v9, v4, s[8:11], 0 offen sc1
  s_mov_b64 exec, -1
  s_cmp_eq_u32 s3, 0
  s_cbranch_scc1 .fz_kernel_hb20
  s_barrier
  s_sub_u32 s3, s3, 1
.fz_kernel_hb20:
  v_add_f32 v160, v160, v160 row_ror:8 row_mask:0xf bank_mask:0xf
  v_add_f32 v161, v161, v161 row_ror:8 row_mask:0xf bank_mask:0xf
  v_add_f32 v162, v162, v162 row_ror:8 row_mask:0xf bank_mask:0xf
  v_add_f32 v163, v163, v163 row_ror:8 row_mask:0xf bank_mask:0xf
  v_add_f32 v164, v164, v164 row_ror:8 row_mask:0xf bank_mask:0xf
  v_add_f32 v165, v165, v165 row_ror:8 row_mask:0xf bank_mask:0xf
  v_add_f32 v166, v166, v166 row_ror:8 row_mask:0xf bank_mask:0xf
  v_add_f32 v167, v167, v167 row_ror:8 row_mask:0xf bank_mask:0xf
  v_add_f32 v168, v168, v168 row_ror:8 row_mask:0xf bank_mask:0xf
  v_add_f32 v169, v169, v169 row_ror:8 row_mask:0xf bank_mask:0xf
  v_add_f32 v170, v170, v170 row_ror:8 row_mask:0xf bank_mask:0xf
  v_add_f32 v171, v171, v171 row_ror:8 row_mask:0xf bank_mask:0xf
  s_mov_b32 exec_lo, 0x0
  s_mov_b32 exec_hi, 0xff00ff
  v_mov_b32 v160, v161
  v_mov_b32 v164, v165
  v_mov_b32 v168, v169
  s_mov_b32 exec_lo, 0xff00ff00
  s_mov_b32 exec_hi, 0x0
  v_mov_b32 v160, v162
  v_mov_b32 v164, v166
  v_mov_b32 v168, v170
  s_mov_b32 exec_lo, 0x0
  s_mov_b32 exec_hi, 0xff00ff00
  v_mov_b32 v160, v163
  v_mov_b32 v164, v167
  v_mov_b32 v168, v171
  s_cmp_eq_u32 s3, 0
  s_cbranch_scc1 .fz_kernel_hb21
  s_barrier
  s_sub_u32 s3, s3, 1
.fz_kernel_hb21:
  s_mov_b64 exec, 1
  s_mov_b32 s38, 0
.fz_kernel_pw22:
  s_mov_b32 s46, 0
  s_call_b64 s[0:1], .fz_kernel_hw
  s_waitcnt vmcnt(0)
  v_readfirstlane_b32 s31, v9
  s_cmp_eq_u32 s31, 64
  s_cbranch_scc1 .fz_kernel_pw22d
  s_cmp_eq_u32 s3, 0
  s_cbranch_scc1 .fz_kernel_hb23
  s_barrier
  s_sub_u32 s3, s3, 1
.fz_kernel_hb23:
  s_cmp_eq_u32 s3, 0
  s_cbranch_scc1 .fz_kernel_hb24
  s_barrier
  s_sub_u32 s3, s3, 1
.fz_kernel_hb24:
  buffer_load_dword v9, v4, s[8:11], 0 offen sc1
  s_add_u32 s38, s38, 1
  s_cmp_lt_u32 s38, 131072
  s_cbranch_scc1 .fz_kernel_pw22
  s_waitcnt vmcnt(0)
.fz_kernel_pw22d:
  s_mov_b64 exec, -1
  buffer_atomic_add_f32 v160, v21, s[4:7], s30 offen offset:0 sc1
  buffer_atomic_add_f32 v164, v21, s[4:7], s30 offen offset:256 sc1
  buffer_atomic_add_f32 v168, v21, s[4:7], s30 offen offset:512 sc1
  s_mov_b32 s46, 0
  s_call_b64 s[0:1], .fz_kernel_hw
  s_waitcnt vmcnt(0)
  v_lshlrev_b32 v7, 7, v2
  s_lshl_b32 s31, s18, 11
  s_lshl_b32 s33, 1, s17
  s_add_u32 s31, s31, s67
  s_add_u32 s31, s31, 0x180001c
  v_mov_b32 v8, s33
  s_mov_b64 exec, 0xffff
  buffer_atomic_or v8, v7, s[4:7], s31 offen sc1
  s_mov_b64 exec, -1
  s_cmp_eq_u32 s3, 0
  s_cbranch_scc1 .fz_kernel_hb25
  s_barrier
  s_sub_u32 s3, s3, 1
.fz_kernel_hb25:
  s_cmp_ge_u32 s2, 196
  s_cbranch_scc1 .fz_kernel_lz26
  s_lshl_b32 s36, s2, 12
  s_add_u32 s36, s36, 0x1c00000
  s_sub_u32 s31, s2, 66
  s_min_u32 s31, s31, s2
  s_sub_u32 s31, s31, 4
  s_cmp_lt_u32 s31, 6
  s_cbranch_scc1 .fz_kernel_lz26a
  buffer_store_dwordx4 v[12:15], v3, s[4:7], s36 offen sc1
  buffer_store_dwordx4 v[12:15], v3, s[4:7], s36 offen offset:1024 sc1
  buffer_store_dwordx4 v[12:15], v3, s[4:7], s36 offen offset:2048 sc1
  buffer_store_dwordx4 v[12:15], v3, s[4:7], s36 offen offset:3072 sc1
.fz_kernel_lz26:
  s_add_u32 s37, s19, 28
.fz_kernel_f127:
  s_cmp_le_u32 s3, 9
  s_cbranch_scc1 .fz_kernel_f127d
  s_barrier
  s_sub_u32 s3, s3, 1
  s_branch .fz_kernel_f127
.fz_kernel_f127d:
  s_mov_b64 exec, 1
  buffer_load_dword v9, v4, s[4:7], s37 offen sc1
  s_mov_b64 exec, 1
  s_mov_b32 s38, 0
.fz_kernel_pw28:
  s_mov_b32 s46, 0
  s_call_b64 s[0:1], .fz_kernel_hw
  s_waitcnt vmcnt(0)
  v_readfirstlane_b32 s31, v9
  s_cmp_eq_u32 s31, 65535
  s_cbranch_scc1 .fz_kernel_pw28d
  s_cmp_eq_u32 s3, 0
  s_cbranch_scc1 .fz_kernel_hb29
  s_barrier
  s_sub_u32 s3, s3, 1
.fz_kernel_hb29:
  s_cmp_eq_u32 s3, 0
  s_cbranch_scc1 .fz_kernel_hb30
  s_barrier
  s_sub_u32 s3, s3, 1
.fz_kernel_hb30:
  buffer_load_dword v9, v4, s[4:7], s37 offen sc1
  s_add_u32 s38, s38, 1
  s_cmp_lt_u32 s38, 131072
  s_cbranch_scc1 .fz_kernel_pw28
  s_waitcnt vmcnt(0)
.fz_kernel_pw28d:
  s_mov_b64 exec, -1
  buffer_load_dwordx4 v[64:67], v3, s[4:7], s30 offen sc1
  s_mov_b32 s46, 0
  s_call_b64 s[0:1], .fz_kernel_hw
  s_waitcnt vmcnt(0)
  v_add_u32 v24, 155648, v3
  s_mov_b32 exec_hi, 0xffff
  ds_write_b128 v24, v[64:67] offset:5632
  s_mov_b64 exec, -1
  s_waitcnt lgkmcnt(0)
  s_cmp_eq_u32 s3, 0
  s_cbranch_scc1 .fz_kernel_hb31
  s_barrier
  s_sub_u32 s3, s3, 1
.fz_kernel_hb31:
  s_getpc_b64 s[0:1]
.fz_kernel_ct32:
  s_sub_u32 s0, s0, .fz_kernel_ct32-fz_kernel
  s_subb_u32 s1, s1, 0
  s_lshr_b32 s31, s2, 3
  s_mulk_i32 s31, 0x500
  v_lshl_add_u32 v1, v2, 7, s31
  v_min_u32 v1, .fz_kernel_last-fz_kernel, v1
  s_mov_b64 exec, 0x3ff
  global_load_dword v1, v1, s[0:1]
  s_mov_b64 exec, -1
.fz_kernel_ct32e:
  s_branch .fz_kernel_q_hw2
.fz_kernel_att:
  s_setprio 1
  s_lshl_b32 s34, 1, s17
  s_mov_b32 s36, 0
  v_mfma_f32_32x32x16_bf16 v[48:63], v[80:83], v[16:19], 0
  v_mfma_f32_32x32x16_bf16 v[48:63], v[84:87], v[20:23], v[48:63]
  v_and_b32 v1, 31, v2
  v_lshl_add_u32 v1, v1, 3, s11
  v_mov_b32 v208, 0
  v_mov_b32 v209, 0
  v_mov_b32 v210, 0
  v_mov_b32 v211, 0
  v_mov_b32 v212, 0
  v_mov_b32 v213, 0
  v_mov_b32 v214, 0
  v_mov_b32 v215, 0
  v_mov_b32 v216, 0
  v_mov_b32 v217, 0
  v_mov_b32 v218, 0
  v_mov_b32 v219, 0
  v_mov_b32 v220, 0
  v_mov_b32 v221, 0
  v_mov_b32 v222, 0
  v_mov_b32 v223, 0
  s_waitcnt lgkmcnt(0)
  s_barrier
  ds_read_b128 v[32:35], v9 offset:0
  ds_read_b128 v[36:39], v9 offset:1024
  ds_read_b128 v[40:43], v9 offset:2048
  ds_read_b128 v[44:47], v9 offset:3072
  v_mfma_f32_32x32x16_bf16 v[64:79], v[80:83], v[24:27], 0
  v_exp_f32 v48, v48
  v_exp_f32 v49, v49
  v_exp_f32 v50, v50
  v_exp_f32 v51, v51
  v_exp_f32 v52, v52
  v_exp_f32 v53, v53
  v_exp_f32 v54, v54
  v_exp_f32 v55, v55
  v_mfma_f32_32x32x16_bf16 v[64:79], v[84:87], v[28:31], v[64:79]
  v_cvt_pk_bf16_f32 v224, v48, v49
  v_cvt_pk_bf16_f32 v225, v50, v51
  v_cvt_pk_bf16_f32 v226, v52, v53
  v_cvt_pk_bf16_f32 v227, v54, v55
  v_exp_f32 v56, v56
  v_exp_f32 v57, v57
  v_exp_f32 v58, v58
  v_exp_f32 v59, v59
  v_mfma_f32_32x32x16_bf16 v[144:159], v[88:91], v[224:227], 0
  v_exp_f32 v60, v60
  v_exp_f32 v61, v61
  v_exp_f32 v62, v62
  v_exp_f32 v63, v63
  v_cvt_pk_bf16_f32 v228, v56, v57
  v_cvt_pk_bf16_f32 v229, v58, v59
  v_cvt_pk_bf16_f32 v230, v60, v61
  v_cvt_pk_bf16_f32 v231, v62, v63
  s_waitcnt lgkmcnt(0)
  v_mfma_f32_32x32x16_bf16 v[48:63], v[80:83], v[32:35], 0
  v_exp_f32 v64, v64
  v_exp_f32 v65, v65
  v_exp_f32 v66, v66
  v_exp_f32 v67, v67
  v_mfma_f32_32x32x16_bf16 v[144:159], v[92:95], v[228:231], v[144:159]
  v_exp_f32 v68, v68
  v_exp_f32 v69, v69
  v_exp_f32 v70, v70
  v_smfmac_f32_16x16x64_bf16 v[208:211], v[12:15], v[224:231], v11
  v_exp_f32 v71, v71
  v_mfma_f32_32x32x16_bf16 v[48:63], v[84:87], v[36:39], v[48:63]
  v_cvt_pk_bf16_f32 v224, v64, v65
  v_cvt_pk_bf16_f32 v225, v66, v67
  v_cvt_pk_bf16_f32 v226, v68, v69
  v_cvt_pk_bf16_f32 v227, v70, v71
  v_exp_f32 v72, v72
  v_exp_f32 v73, v73
  v_exp_f32 v74, v74
  v_exp_f32 v75, v75
  v_mfma_f32_32x32x16_bf16 v[160:175], v[88:91], v[224:227], 0
  v_exp_f32 v76, v76
  v_exp_f32 v77, v77
  v_exp_f32 v78, v78
  v_exp_f32 v79, v79
  v_cvt_pk_bf16_f32 v228, v72, v73
  v_cvt_pk_bf16_f32 v229, v74, v75
  v_cvt_pk_bf16_f32 v230, v76, v77
  v_cvt_pk_bf16_f32 v231, v78, v79
  s_mov_b64 exec, 1
  s_waitcnt vmcnt(0)
  ds_add_u32 v6, v5 offset:0x100
  s_mov_b64 exec, -1
  v_mfma_f32_32x32x16_bf16 v[64:79], v[80:83], v[40:43], 0
  v_exp_f32 v48, v48
  v_exp_f32 v49, v49
  v_exp_f32 v50, v50
  v_exp_f32 v51, v51
  v_mfma_f32_32x32x16_bf16 v[160:175], v[92:95], v[228:231], v[160:175]
  v_exp_f32 v52, v52
  v_exp_f32 v53, v53
  v_exp_f32 v54, v54
  v_smfmac_f32_16x16x64_bf16 v[212:215], v[12:15], v[224:231], v11
  v_exp_f32 v55, v55
  v_mfma_f32_32x32x16_bf16 v[64:79], v[84:87], v[44:47], v[64:79]
  v_cvt_pk_bf16_f32 v224, v48, v49
  v_cvt_pk_bf16_f32 v225, v50, v51
  v_cvt_pk_bf16_f32 v226, v52, v53
  v_cvt_pk_bf16_f32 v227, v54, v55
  v_exp_f32 v56, v56
  v_exp_f32 v57, v57
  v_exp_f32 v58, v58
  v_exp_f32 v59, v59
  v_mfma_f32_32x32x16_bf16 v[176:191], v[88:91], v[224:227], 0
  ds_read_b32 v7, v6
  v_exp_f32 v60, v60
  v_exp_f32 v61, v61
  v_exp_f32 v62, v62
  v_exp_f32 v63, v63
  v_cvt_pk_bf16_f32 v228, v56, v57
  v_cvt_pk_bf16_f32 v229, v58, v59
  v_cvt_pk_bf16_f32 v230, v60, v61
  v_cvt_pk_bf16_f32 v231, v62, v63
  s_waitcnt lgkmcnt(0)
  v_readfirstlane_b32 s39, v7
  s_andn2_b32 s33, s39, s34
  s_bcnt1_i32_b32 s31, s33
  s_cmp_ge_u32 s31, 2
  s_cbranch_scc1 .fz_kernel_a_e
  v_mfma_f32_32x32x16_bf16 v[48:63], v[96:99], v[16:19], 0
  v_exp_f32 v64, v64
  v_exp_f32 v65, v65
  v_exp_f32 v66, v66
  v_exp_f32 v67, v67
  v_mfma_f32_32x32x16_bf16 v[176:191], v[92:95], v[228:231], v[176:191]
  v_exp_f32 v68, v68
  v_exp_f32 v69, v69
  v_exp_f32 v70, v70
  v_smfmac_f32_16x16x64_bf16 v[216:219], v[12:15], v[224:231], v11
  v_exp_f32 v71, v71
  v_mfma_f32_32x32x16_bf16 v[48:63], v[100:103], v[20:23], v[48:63]
  v_cvt_pk_bf16_f32 v224, v64, v65
  v_cvt_pk_bf16_f32 v225, v66, v67
  v_cvt_pk_bf16_f32 v226, v68, v69
  v_cvt_pk_bf16_f32 v227, v70, v71
  v_exp_f32 v72, v72
  v_exp_f32 v73, v73
  v_exp_f32 v74, v74
  v_exp_f32 v75, v75
  v_mfma_f32_32x32x16_bf16 v[192:207], v[88:91], v[224:227], 0
  v_exp_f32 v76, v76
  v_exp_f32 v77, v77
  v_exp_f32 v78, v78
  v_exp_f32 v79, v79
  v_cvt_pk_bf16_f32 v228, v72, v73
  v_cvt_pk_bf16_f32 v229, v74, v75
  v_cvt_pk_bf16_f32 v230, v76, v77
  v_cvt_pk_bf16_f32 v231, v78, v79
  v_mfma_f32_32x32x16_bf16 v[64:79], v[96:99], v[24:27], 0
  v_exp_f32 v48, v48
  v_exp_f32 v49, v49
  v_exp_f32 v50, v50
  v_exp_f32 v51, v51
  v_mfma_f32_32x32x16_bf16 v[192:207], v[92:95], v[228:231], v[192:207]
  v_exp_f32 v52, v52
  v_exp_f32 v53, v53
  v_exp_f32 v54, v54
  v_smfmac_f32_16x16x64_bf16 v[220:223], v[12:15], v[224:231], v11
  v_exp_f32 v55, v55
  v_mfma_f32_32x32x16_bf16 v[64:79], v[100:103], v[28:31], v[64:79]
  v_cvt_pk_bf16_f32 v224, v48, v49
  v_cvt_pk_bf16_f32 v225, v50, v51
  v_cvt_pk_bf16_f32 v226, v52, v53
  v_cvt_pk_bf16_f32 v227, v54, v55
  v_exp_f32 v56, v56
  v_exp_f32 v57, v57
  v_exp_f32 v58, v58
  v_exp_f32 v59, v59
  v_mfma_f32_32x32x16_bf16 v[144:159], v[104:107], v[224:227], v[144:159]
  v_exp_f32 v60, v60
  v_exp_f32 v61, v61
  v_exp_f32 v62, v62
  v_exp_f32 v63, v63
  v_cvt_pk_bf16_f32 v228, v56, v57
  v_cvt_pk_bf16_f32 v229, v58, v59
  v_cvt_pk_bf16_f32 v230, v60, v61
  v_cvt_pk_bf16_f32 v231, v62, v63
  v_mfma_f32_32x32x16_bf16 v[48:63], v[96:99], v[32:35], 0
  v_exp_f32 v64, v64
  v_exp_f32 v65, v65
  v_exp_f32 v66, v66
  v_exp_f32 v67, v67
  v_mfma_f32_32x32x16_bf16 v[144:159], v[108:111], v[228:231], v[144:159]
  v_exp_f32 v68, v68
  v_exp_f32 v69, v69
  v_exp_f32 v70, v70
  v_smfmac_f32_16x16x64_bf16 v[208:211], v[12:15], v[224:231], v11
  v_exp_f32 v71, v71
  v_mfma_f32_32x32x16_bf16 v[48:63], v[100:103], v[36:39], v[48:63]
  v_cvt_pk_bf16_f32 v224, v64, v65
  v_cvt_pk_bf16_f32 v225, v66, v67
  v_cvt_pk_bf16_f32 v226, v68, v69
  v_cvt_pk_bf16_f32 v227, v70, v71
  v_exp_f32 v72, v72
  v_exp_f32 v73, v73
  v_exp_f32 v74, v74
  v_exp_f32 v75, v75
  v_mfma_f32_32x32x16_bf16 v[160:175], v[104:107], v[224:227], v[160:175]
  ds_read_b32 v7, v6
  v_exp_f32 v76, v76
  v_exp_f32 v77, v77
  v_exp_f32 v78, v78
  v_exp_f32 v79, v79
  v_cvt_pk_bf16_f32 v228, v72, v73
  v_cvt_pk_bf16_f32 v229, v74, v75
  v_cvt_pk_bf16_f32 v230, v76, v77
  v_cvt_pk_bf16_f32 v231, v78, v79
  s_waitcnt lgkmcnt(0)
  v_readfirstlane_b32 s39, v7
  s_andn2_b32 s39, s39, s34
  s_cbranch_scc0 .fz_kernel_a_p0
  s_ff1_i32_b32 s33, s36
  s_bitset0_b32 s36, s33
  s_lshl_b32 s33, s33, 14
  s_add_u32 s30, s33, s35
  s_cbranch_scc1 .fz_kernel_pk33c
.fz_kernel_pk33:
  buffer_load_dwordx4 v[112:115], v3, s[4:7], s30 offen offset:0
  buffer_load_dwordx4 v[116:119], v3, s[4:7], s30 offen offset:1024
  buffer_load_dwordx4 v[120:123], v3, s[4:7], s30 offen offset:2048
  buffer_load_dwordx4 v[124:127], v3, s[4:7], s30 offen offset:3072
  buffer_load_dwordx4 v[128:131], v10, s[4:7], s30 offen offset:0
  buffer_load_dwordx4 v[132:135], v10, s[4:7], s30 offen offset:1024
  buffer_load_dwordx4 v[136:139], v10, s[4:7], s30 offen offset:2048
  buffer_load_dwordx4 v[140:143], v10, s[4:7], s30 offen offset:3072
.fz_kernel_a_p0:
  v_mfma_f32_32x32x16_bf16 v[64:79], v[96:99], v[40:43], 0
  v_exp_f32 v48, v48
  v_exp_f32 v49, v49
  v_exp_f32 v50, v50
  v_exp_f32 v51, v51
  v_mfma_f32_32x32x16_bf16 v[160:175], v[108:111], v[228:231], v[160:175]
  v_exp_f32 v52, v52
  v_exp_f32 v53, v53
  v_exp_f32 v54, v54
  v_smfmac_f32_16x16x64_bf16 v[212:215], v[12:15], v[224:231], v11
  v_exp_f32 v55, v55
  v_mfma_f32_32x32x16_bf16 v[64:79], v[100:103], v[44:47], v[64:79]
  v_cvt_pk_bf16_f32 v224, v48, v49
  v_cvt_pk_bf16_f32 v225, v50, v51
  v_cvt_pk_bf16_f32 v226, v52, v53
  v_cvt_pk_bf16_f32 v227, v54, v55
  v_exp_f32 v56, v56
  v_exp_f32 v57, v57
  v_exp_f32 v58, v58
  v_exp_f32 v59, v59
  v_mfma_f32_32x32x16_bf16 v[176:191], v[104:107], v[224:227], v[176:191]
  v_exp_f32 v60, v60
  v_exp_f32 v61, v61
  v_exp_f32 v62, v62
  v_exp_f32 v63, v63
  v_cvt_pk_bf16_f32 v228, v56, v57
  v_cvt_pk_bf16_f32 v229, v58, v59
  v_cvt_pk_bf16_f32 v230, v60, v61
  v_cvt_pk_bf16_f32 v231, v62, v63
  v_exp_f32 v64, v64
  v_exp_f32 v65, v65
  v_exp_f32 v66, v66
  v_exp_f32 v67, v67
  v_mfma_f32_32x32x16_bf16 v[176:191], v[108:111], v[228:231], v[176:191]
  v_exp_f32 v68, v68
  v_exp_f32 v69, v69
  v_exp_f32 v70, v70
  v_smfmac_f32_16x16x64_bf16 v[216:219], v[12:15], v[224:231], v11
  v_exp_f32 v71, v71
  v_cvt_pk_bf16_f32 v224, v64, v65
  v_cvt_pk_bf16_f32 v225, v66, v67
  v_cvt_pk_bf16_f32 v226, v68, v69
  v_cvt_pk_bf16_f32 v227, v70, v71
  v_exp_f32 v72, v72
  v_exp_f32 v73, v73
  v_exp_f32 v74, v74
  v_exp_f32 v75, v75
  v_mfma_f32_32x32x16_bf16 v[192:207], v[104:107], v[224:227], v[192:207]
  v_exp_f32 v76, v76
  v_exp_f32 v77, v77
  v_exp_f32 v78, v78
  v_exp_f32 v79, v79
  v_cvt_pk_bf16_f32 v228, v72, v73
  v_cvt_pk_bf16_f32 v229, v74, v75
  v_cvt_pk_bf16_f32 v230, v76, v77
  v_cvt_pk_bf16_f32 v231, v78, v79
  s_cmp_lg_u32 s39, 0
  s_cbranch_scc1 .fz_kernel_a_p1
  s_ff1_i32_b32 s33, s36
  s_bitset0_b32 s36, s33
  s_lshl_b32 s33, s33, 14
  s_add_u32 s30, s33, s35
  s_cbranch_scc1 .fz_kernel_pk34c
.fz_kernel_pk34:
  buffer_load_dwordx4 v[112:115], v3, s[4:7], s30 offen offset:0
  buffer_load_dwordx4 v[116:119], v3, s[4:7], s30 offen offset:1024
  buffer_load_dwordx4 v[120:123], v3, s[4:7], s30 offen offset:2048
  buffer_load_dwordx4 v[124:127], v3, s[4:7], s30 offen offset:3072
  buffer_load_dwordx4 v[128:131], v10, s[4:7], s30 offen offset:0
  buffer_load_dwordx4 v[132:135], v10, s[4:7], s30 offen offset:1024
  buffer_load_dwordx4 v[136:139], v10, s[4:7], s30 offen offset:2048
  buffer_load_dwordx4 v[140:143], v10, s[4:7], s30 offen offset:3072
.fz_kernel_a_p1:
  s_ff1_i32_b32 s33, s36
  s_bitset0_b32 s36, s33
  s_lshl_b32 s33, s33, 14
  s_add_u32 s30, s33, s35
  s_cbranch_scc1 .fz_kernel_pk35c
.fz_kernel_pk35:
  buffer_load_dwordx4 v[80:83], v3, s[4:7], s30 offen offset:0
  buffer_load_dwordx4 v[84:87], v3, s[4:7], s30 offen offset:1024
  buffer_load_dwordx4 v[88:91], v3, s[4:7], s30 offen offset:2048
  buffer_load_dwordx4 v[92:95], v3, s[4:7], s30 offen offset:3072
  buffer_load_dwordx4 v[96:99], v10, s[4:7], s30 offen offset:0
  s_waitcnt vmcnt(11)
  v_mfma_f32_32x32x16_bf16 v[48:63], v[112:115], v[16:19], 0
  v_mfma_f32_32x32x16_bf16 v[48:63], v[116:119], v[20:23], v[48:63]
  s_nop 9
  s_branch .fz_kernel_a_b2
.fz_kernel_a_e:
  s_mov_b32 s36, s33
  s_or_b32 s34, s34, s39
  s_ff1_i32_b32 s33, s36
  s_bitset0_b32 s36, s33
  s_lshl_b32 s33, s33, 14
  s_add_u32 s30, s33, s35
  v_mfma_f32_32x32x16_bf16 v[48:63], v[96:99], v[16:19], 0
  buffer_load_dwordx4 v[112:115], v3, s[4:7], s30 offen offset:0
  v_exp_f32 v64, v64
  v_exp_f32 v65, v65
  v_exp_f32 v66, v66
  v_exp_f32 v67, v67
  v_mfma_f32_32x32x16_bf16 v[176:191], v[92:95], v[228:231], v[176:191]
  buffer_load_dwordx4 v[116:119], v3, s[4:7], s30 offen offset:1024
  v_exp_f32 v68, v68
  v_exp_f32 v69, v69
  v_exp_f32 v70, v70
  v_smfmac_f32_16x16x64_bf16 v[216:219], v[12:15], v[224:231], v11
  buffer_load_dwordx4 v[120:123], v3, s[4:7], s30 offen offset:2048
  v_exp_f32 v71, v71
  v_mfma_f32_32x32x16_bf16 v[48:63], v[100:103], v[20:23], v[48:63]
  buffer_load_dwordx4 v[124:127], v3, s[4:7], s30 offen offset:3072
  v_cvt_pk_bf16_f32 v224, v64, v65
  v_cvt_pk_bf16_f32 v225, v66, v67
  v_cvt_pk_bf16_f32 v226, v68, v69
  v_cvt_pk_bf16_f32 v227, v70, v71
  v_exp_f32 v72, v72
  v_exp_f32 v73, v73
  v_exp_f32 v74, v74
  v_exp_f32 v75, v75
  v_mfma_f32_32x32x16_bf16 v[192:207], v[88:91], v[224:227], 0
  buffer_load_dwordx4 v[128:131], v10, s[4:7], s30 offen offset:0
  v_exp_f32 v76, v76
  v_exp_f32 v77, v77
  v_exp_f32 v78, v78
  v_exp_f32 v79, v79
  v_cvt_pk_bf16_f32 v228, v72, v73
  v_cvt_pk_bf16_f32 v229, v74, v75
  v_cvt_pk_bf16_f32 v230, v76, v77
  v_cvt_pk_bf16_f32 v231, v78, v79
  v_mfma_f32_32x32x16_bf16 v[64:79], v[96:99], v[24:27], 0
  buffer_load_dwordx4 v[132:135], v10, s[4:7], s30 offen offset:1024
  v_exp_f32 v48, v48
  v_exp_f32 v49, v49
  v_exp_f32 v50, v50
  v_exp_f32 v51, v51
  v_mfma_f32_32x32x16_bf16 v[192:207], v[92:95], v[228:231], v[192:207]
  buffer_load_dwordx4 v[136:139], v10, s[4:7], s30 offen offset:2048
  v_exp_f32 v52, v52
  v_exp_f32 v53, v53
  v_exp_f32 v54, v54
  v_smfmac_f32_16x16x64_bf16 v[220:223], v[12:15], v[224:231], v11
  buffer_load_dwordx4 v[140:143], v10, s[4:7], s30 offen offset:3072
  v_exp_f32 v55, v55
  v_mfma_f32_32x32x16_bf16 v[64:79], v[100:103], v[28:31], v[64:79]
  s_ff1_i32_b32 s33, s36
  v_cvt_pk_bf16_f32 v224, v48, v49
  v_cvt_pk_bf16_f32 v225, v50, v51
  v_cvt_pk_bf16_f32 v226, v52, v53
  v_cvt_pk_bf16_f32 v227, v54, v55
  v_exp_f32 v56, v56
  v_exp_f32 v57, v57
  v_exp_f32 v58, v58
  v_exp_f32 v59, v59
  v_mfma_f32_32x32x16_bf16 v[144:159], v[104:107], v[224:227], v[144:159]
  s_bitset0_b32 s36, s33
  v_exp_f32 v60, v60
  v_exp_f32 v61, v61
  v_exp_f32 v62, v62
  v_exp_f32 v63, v63
  v_cvt_pk_bf16_f32 v228, v56, v57
  v_cvt_pk_bf16_f32 v229, v58, v59
  v_cvt_pk_bf16_f32 v230, v60, v61
  v_cvt_pk_bf16_f32 v231, v62, v63
  v_mfma_f32_32x32x16_bf16 v[48:63], v[96:99], v[32:35], 0
  s_lshl_b32 s33, s33, 14
  v_exp_f32 v64, v64
  v_exp_f32 v65, v65
  v_exp_f32 v66, v66
  v_exp_f32 v67, v67
  v_mfma_f32_32x32x16_bf16 v[144:159], v[108:111], v[228:231], v[144:159]
  s_add_u32 s30, s33, s35
  v_exp_f32 v68, v68
  v_exp_f32 v69, v69
  v_exp_f32 v70, v70
  v_smfmac_f32_16x16x64_bf16 v[208:211], v[12:15], v[224:231], v11
  buffer_load_dwordx4 v[80:83], v3, s[4:7], s30 offen offset:0
  v_exp_f32 v71, v71
  v_mfma_f32_32x32x16_bf16 v[48:63], v[100:103], v[36:39], v[48:63]
  buffer_load_dwordx4 v[84:87], v3, s[4:7], s30 offen offset:1024
  v_cvt_pk_bf16_f32 v224, v64, v65
  v_cvt_pk_bf16_f32 v225, v66, v67
  v_cvt_pk_bf16_f32 v226, v68, v69
  v_cvt_pk_bf16_f32 v227, v70, v71
  v_exp_f32 v72, v72
  v_exp_f32 v73, v73
  v_exp_f32 v74, v74
  v_exp_f32 v75, v75
  v_mfma_f32_32x32x16_bf16 v[160:175], v[104:107], v[224:227], v[160:175]
  buffer_load_dwordx4 v[88:91], v3, s[4:7], s30 offen offset:2048
  v_exp_f32 v76, v76
  v_exp_f32 v77, v77
  v_exp_f32 v78, v78
  v_exp_f32 v79, v79
  v_cvt_pk_bf16_f32 v228, v72, v73
  v_cvt_pk_bf16_f32 v229, v74, v75
  v_cvt_pk_bf16_f32 v230, v76, v77
  v_cvt_pk_bf16_f32 v231, v78, v79
  v_mfma_f32_32x32x16_bf16 v[64:79], v[96:99], v[40:43], 0
  buffer_load_dwordx4 v[92:95], v3, s[4:7], s30 offen offset:3072
  v_exp_f32 v48, v48
  v_exp_f32 v49, v49
  v_exp_f32 v50, v50
  v_exp_f32 v51, v51
  v_mfma_f32_32x32x16_bf16 v[160:175], v[108:111], v[228:231], v[160:175]
  v_exp_f32 v52, v52
  v_exp_f32 v53, v53
  v_exp_f32 v54, v54
  v_smfmac_f32_16x16x64_bf16 v[212:215], v[12:15], v[224:231], v11
  v_exp_f32 v55, v55
  v_mfma_f32_32x32x16_bf16 v[64:79], v[100:103], v[44:47], v[64:79]
  v_cvt_pk_bf16_f32 v224, v48, v49
  v_cvt_pk_bf16_f32 v225, v50, v51
  v_cvt_pk_bf16_f32 v226, v52, v53
  v_cvt_pk_bf16_f32 v227, v54, v55
  v_exp_f32 v56, v56
  v_exp_f32 v57, v57
  v_exp_f32 v58, v58
  v_exp_f32 v59, v59
  v_mfma_f32_32x32x16_bf16 v[176:191], v[104:107], v[224:227], v[176:191]
  s_waitcnt vmcnt(10)
  v_exp_f32 v60, v60
  v_exp_f32 v61, v61
  v_exp_f32 v62, v62
  v_exp_f32 v63, v63
  v_cvt_pk_bf16_f32 v228, v56, v57
  v_cvt_pk_bf16_f32 v229, v58, v59
  v_cvt_pk_bf16_f32 v230, v60, v61
  v_cvt_pk_bf16_f32 v231, v62, v63
  v_mfma_f32_32x32x16_bf16 v[48:63], v[112:115], v[16:19], 0
  v_exp_f32 v64, v64
  v_exp_f32 v65, v65
  v_exp_f32 v66, v66
  v_exp_f32 v67, v67
  v_mfma_f32_32x32x16_bf16 v[176:191], v[108:111], v[228:231], v[176:191]
  buffer_load_dwordx4 v[96:99], v10, s[4:7], s30 offen offset:0
  v_exp_f32 v68, v68
  v_exp_f32 v69, v69
  v_exp_f32 v70, v70
  v_smfmac_f32_16x16x64_bf16 v[216:219], v[12:15], v[224:231], v11
  v_exp_f32 v71, v71
  v_mfma_f32_32x32x16_bf16 v[48:63], v[116:119], v[20:23], v[48:63]
  v_cvt_pk_bf16_f32 v224, v64, v65
  v_cvt_pk_bf16_f32 v225, v66, v67
  v_cvt_pk_bf16_f32 v226, v68, v69
  v_cvt_pk_bf16_f32 v227, v70, v71
  v_exp_f32 v72, v72
  v_exp_f32 v73, v73
  v_exp_f32 v74, v74
  v_exp_f32 v75, v75
  v_mfma_f32_32x32x16_bf16 v[192:207], v[104:107], v[224:227], v[192:207]
  v_exp_f32 v76, v76
  v_exp_f32 v77, v77
  v_exp_f32 v78, v78
  v_exp_f32 v79, v79
  v_cvt_pk_bf16_f32 v228, v72, v73
  v_cvt_pk_bf16_f32 v229, v74, v75
  v_cvt_pk_bf16_f32 v230, v76, v77
  v_cvt_pk_bf16_f32 v231, v78, v79
  s_branch .fz_kernel_a_b2
  .p2align 6
.fz_kernel_a_loop:
  v_mfma_f32_32x32x16_bf16 v[64:79], v[80:83], v[24:27], 0
  v_exp_f32 v48, v48
  v_exp_f32 v49, v49
  v_exp_f32 v50, v50
  v_exp_f32 v51, v51
  v_mfma_f32_32x32x16_bf16 v[192:207], v[140:143], v[228:231], v[192:207]
  v_exp_f32 v52, v52
  v_exp_f32 v53, v53
  v_exp_f32 v54, v54
  v_smfmac_f32_16x16x64_bf16 v[220:223], v[12:15], v[224:231], v11
  buffer_load_dwordx4 v[132:135], v10, s[4:7], s30 offen offset:1024
  v_exp_f32 v55, v55
  v_mfma_f32_32x32x16_bf16 v[64:79], v[84:87], v[28:31], v[64:79]
  s_waitcnt vmcnt(10)
  v_cvt_pk_bf16_f32 v224, v48, v49
  v_cvt_pk_bf16_f32 v225, v50, v51
  v_cvt_pk_bf16_f32 v226, v52, v53
  v_cvt_pk_bf16_f32 v227, v54, v55
  v_exp_f32 v56, v56
  v_exp_f32 v57, v57
  v_exp_f32 v58, v58
  v_exp_f32 v59, v59
  v_mfma_f32_32x32x16_bf16 v[144:159], v[88:91], v[224:227], v[144:159]
  v_exp_f32 v60, v60
  v_exp_f32 v61, v61
  v_exp_f32 v62, v62
  v_exp_f32 v63, v63
  v_cvt_pk_bf16_f32 v228, v56, v57
  v_cvt_pk_bf16_f32 v229, v58, v59
  v_cvt_pk_bf16_f32 v230, v60, v61
  v_cvt_pk_bf16_f32 v231, v62, v63
  v_mfma_f32_32x32x16_bf16 v[48:63], v[80:83], v[32:35], 0
  v_exp_f32 v64, v64
  v_exp_f32 v65, v65
  v_exp_f32 v66, v66
  v_exp_f32 v67, v67
  v_mfma_f32_32x32x16_bf16 v[144:159], v[92:95], v[228:231], v[144:159]
  v_exp_f32 v68, v68
  v_exp_f32 v69, v69
  v_exp_f32 v70, v70
  v_smfmac_f32_16x16x64_bf16 v[208:211], v[12:15], v[224:231], v11
  buffer_load_dwordx4 v[136:139], v10, s[4:7], s30 offen offset:2048
  v_exp_f32 v71, v71
  v_mfma_f32_32x32x16_bf16 v[48:63], v[84:87], v[36:39], v[48:63]
  s_ff1_i32_b32 s33, s36
  v_cvt_pk_bf16_f32 v224, v64, v65
  v_cvt_pk_bf16_f32 v225, v66, v67
  v_cvt_pk_bf16_f32 v226, v68, v69
  v_cvt_pk_bf16_f32 v227, v70, v71
  v_exp_f32 v72, v72
  v_exp_f32 v73, v73
  v_exp_f32 v74, v74
  v_exp_f32 v75, v75
  v_mfma_f32_32x32x16_bf16 v[160:175], v[88:91], v[224:227], v[160:175]
  s_bitset0_b32 s36, s33
  v_exp_f32 v76, v76
  v_exp_f32 v77, v77
  v_exp_f32 v78, v78
  v_exp_f32 v79, v79
  v_cvt_pk_bf16_f32 v228, v72, v73
  v_cvt_pk_bf16_f32 v229, v74, v75
  v_cvt_pk_bf16_f32 v230, v76, v77
  v_cvt_pk_bf16_f32 v231, v78, v79
  v_mfma_f32_32x32x16_bf16 v[64:79], v[80:83], v[40:43], 0
  s_lshl_b32 s33, s33, 14
  v_exp_f32 v48, v48
  v_exp_f32 v49, v49
  v_exp_f32 v50, v50
  v_exp_f32 v51, v51
  v_mfma_f32_32x32x16_bf16 v[160:175], v[92:95], v[228:231], v[160:175]
  v_exp_f32 v52, v52
  v_exp_f32 v53, v53
  v_exp_f32 v54, v54
  v_smfmac_f32_16x16x64_bf16 v[212:215], v[12:15], v[224:231], v11
  buffer_load_dwordx4 v[140:143], v10, s[4:7], s30 offen offset:3072
  v_exp_f32 v55, v55
  v_mfma_f32_32x32x16_bf16 v[64:79], v[84:87], v[44:47], v[64:79]
  s_add_u32 s30, s33, s35
  v_cvt_pk_bf16_f32 v224, v48, v49
  v_cvt_pk_bf16_f32 v225, v50, v51
  v_cvt_pk_bf16_f32 v226, v52, v53
  v_cvt_pk_bf16_f32 v227, v54, v55
  v_exp_f32 v56, v56
  v_exp_f32 v57, v57
  v_exp_f32 v58, v58
  v_exp_f32 v59, v59
  v_mfma_f32_32x32x16_bf16 v[176:191], v[88:91], v[224:227], v[176:191]
  s_waitcnt vmcnt(10)
  v_exp_f32 v60, v60
  v_exp_f32 v61, v61
  v_exp_f32 v62, v62
  v_exp_f32 v63, v63
  v_cvt_pk_bf16_f32 v228, v56, v57
  v_cvt_pk_bf16_f32 v229, v58, v59
  v_cvt_pk_bf16_f32 v230, v60, v61
  v_cvt_pk_bf16_f32 v231, v62, v63
  v_mfma_f32_32x32x16_bf16 v[48:63], v[96:99], v[16:19], 0
  s_cbranch_scc1 .fz_kernel_pk38c
.fz_kernel_pk38:
  v_exp_f32 v64, v64
  v_exp_f32 v65, v65
  v_exp_f32 v66, v66
  v_exp_f32 v67, v67
  v_mfma_f32_32x32x16_bf16 v[176:191], v[92:95], v[228:231], v[176:191]
  v_exp_f32 v68, v68
  v_exp_f32 v69, v69
  v_exp_f32 v70, v70
  v_smfmac_f32_16x16x64_bf16 v[216:219], v[12:15], v[224:231], v11
  buffer_load_dwordx4 v[80:83], v3, s[4:7], s30 offen offset:0
  v_exp_f32 v71, v71
  v_mfma_f32_32x32x16_bf16 v[48:63], v[100:103], v[20:23], v[48:63]
  v_cvt_pk_bf16_f32 v224, v64, v65
  v_cvt_pk_bf16_f32 v225, v66, v67
  v_cvt_pk_bf16_f32 v226, v68, v69
  v_cvt_pk_bf16_f32 v227, v70, v71
  v_exp_f32 v72, v72
  v_exp_f32 v73, v73
  v_exp_f32 v74, v74
  v_exp_f32 v75, v75
  v_mfma_f32_32x32x16_bf16 v[192:207], v[88:91], v[224:227], v[192:207]
  v_exp_f32 v76, v76
  v_exp_f32 v77, v77
  v_exp_f32 v78, v78
  v_exp_f32 v79, v79
  v_cvt_pk_bf16_f32 v228, v72, v73
  v_cvt_pk_bf16_f32 v229, v74, v75
  v_cvt_pk_bf16_f32 v230, v76, v77
  v_cvt_pk_bf16_f32 v231, v78, v79
  v_mfma_f32_32x32x16_bf16 v[64:79], v[96:99], v[24:27], 0
  v_exp_f32 v48, v48
  v_exp_f32 v49, v49
  v_exp_f32 v50, v50
  v_exp_f32 v51, v51
  v_mfma_f32_32x32x16_bf16 v[192:207], v[92:95], v[228:231], v[192:207]
  v_exp_f32 v52, v52
  v_exp_f32 v53, v53
  v_exp_f32 v54, v54
  v_smfmac_f32_16x16x64_bf16 v[220:223], v[12:15], v[224:231], v11
  buffer_load_dwordx4 v[84:87], v3, s[4:7], s30 offen offset:1024
  v_exp_f32 v55, v55
  v_mfma_f32_32x32x16_bf16 v[64:79], v[100:103], v[28:31], v[64:79]
  s_waitcnt vmcnt(10)
  v_cvt_pk_bf16_f32 v224, v48, v49
  v_cvt_pk_bf16_f32 v225, v50, v51
  v_cvt_pk_bf16_f32 v226, v52, v53
  v_cvt_pk_bf16_f32 v227, v54, v55
  v_exp_f32 v56, v56
  v_exp_f32 v57, v57
  v_exp_f32 v58, v58
  v_exp_f32 v59, v59
  v_mfma_f32_32x32x16_bf16 v[144:159], v[104:107], v[224:227], v[144:159]
  v_exp_f32 v60, v60
  v_exp_f32 v61, v61
  v_exp_f32 v62, v62
  v_exp_f32 v63, v63
  v_cvt_pk_bf16_f32 v228, v56, v57
  v_cvt_pk_bf16_f32 v229, v58, v59
  v_cvt_pk_bf16_f32 v230, v60, v61
  v_cvt_pk_bf16_f32 v231, v62, v63
  v_mfma_f32_32x32x16_bf16 v[48:63], v[96:99], v[32:35], 0
  v_exp_f32 v64, v64
  v_exp_f32 v65, v65
  v_exp_f32 v66, v66
  v_exp_f32 v67, v67
  v_mfma_f32_32x32x16_bf16 v[144:159], v[108:111], v[228:231], v[144:159]
  v_exp_f32 v68, v68
  v_exp_f32 v69, v69
  v_exp_f32 v70, v70
  v_smfmac_f32_16x16x64_bf16 v[208:211], v[12:15], v[224:231], v11
  buffer_load_dwordx4 v[88:91], v3, s[4:7], s30 offen offset:2048
  v_exp_f32 v71, v71
  v_mfma_f32_32x32x16_bf16 v[48:63], v[100:103], v[36:39], v[48:63]
  v_cvt_pk_bf16_f32 v224, v64, v65
  v_cvt_pk_bf16_f32 v225, v66, v67
  v_cvt_pk_bf16_f32 v226, v68, v69
  v_cvt_pk_bf16_f32 v227, v70, v71
  v_exp_f32 v72, v72
  v_exp_f32 v73, v73
  v_exp_f32 v74, v74
  v_exp_f32 v75, v75
  v_mfma_f32_32x32x16_bf16 v[160:175], v[104:107], v[224:227], v[160:175]
  v_exp_f32 v76, v76
  v_exp_f32 v77, v77
  v_exp_f32 v78, v78
  v_exp_f32 v79, v79
  v_cvt_pk_bf16_f32 v228, v72, v73
  v_cvt_pk_bf16_f32 v229, v74, v75
  v_cvt_pk_bf16_f32 v230, v76, v77
  v_cvt_pk_bf16_f32 v231, v78, v79
  v_mfma_f32_32x32x16_bf16 v[64:79], v[96:99], v[40:43], 0
  v_exp_f32 v48, v48
  v_exp_f32 v49, v49
  v_exp_f32 v50, v50
  v_exp_f32 v51, v51
  v_mfma_f32_32x32x16_bf16 v[160:175], v[108:111], v[228:231], v[160:175]
  v_exp_f32 v52, v52
  v_exp_f32 v53, v53
  v_exp_f32 v54, v54
  v_smfmac_f32_16x16x64_bf16 v[212:215], v[12:15], v[224:231], v11
  buffer_load_dwordx4 v[92:95], v3, s[4:7], s30 offen offset:3072
  v_exp_f32 v55, v55
  v_mfma_f32_32x32x16_bf16 v[64:79], v[100:103], v[44:47], v[64:79]
  v_cvt_pk_bf16_f32 v224, v48, v49
  v_cvt_pk_bf16_f32 v225, v50, v51
  v_cvt_pk_bf16_f32 v226, v52, v53
  v_cvt_pk_bf16_f32 v227, v54, v55
  v_exp_f32 v56, v56
  v_exp_f32 v57, v57
  v_exp_f32 v58, v58
  v_exp_f32 v59, v59
  v_mfma_f32_32x32x16_bf16 v[176:191], v[104:107], v[224:227], v[176:191]
  s_waitcnt vmcnt(10)
  v_exp_f32 v60, v60
  v_exp_f32 v61, v61
  v_exp_f32 v62, v62
  v_exp_f32 v63, v63
  v_cvt_pk_bf16_f32 v228, v56, v57
  v_cvt_pk_bf16_f32 v229, v58, v59
  v_cvt_pk_bf16_f32 v230, v60, v61
  v_cvt_pk_bf16_f32 v231, v62, v63
  v_mfma_f32_32x32x16_bf16 v[48:63], v[112:115], v[16:19], 0
  v_exp_f32 v64, v64
  v_exp_f32 v65, v65
  v_exp_f32 v66, v66
  v_exp_f32 v67, v67
  v_mfma_f32_32x32x16_bf16 v[176:191], v[108:111], v[228:231], v[176:191]
  v_exp_f32 v68, v68
  v_exp_f32 v69, v69
  v_exp_f32 v70, v70
  v_smfmac_f32_16x16x64_bf16 v[216:219], v[12:15], v[224:231], v11
  buffer_load_dwordx4 v[96:99], v10, s[4:7], s30 offen offset:0
  v_exp_f32 v71, v71
  v_mfma_f32_32x32x16_bf16 v[48:63], v[116:119], v[20:23], v[48:63]
  s_sub_u32 s32, s32, 1
  v_cvt_pk_bf16_f32 v224, v64, v65
  v_cvt_pk_bf16_f32 v225, v66, v67
  v_cvt_pk_bf16_f32 v226, v68, v69
  v_cvt_pk_bf16_f32 v227, v70, v71
  v_exp_f32 v72, v72
  v_exp_f32 v73, v73
  v_exp_f32 v74, v74
  v_exp_f32 v75, v75
  v_mfma_f32_32x32x16_bf16 v[192:207], v[104:107], v[224:227], v[192:207]
  s_cmp_eq_u32 s32, 0
  v_exp_f32 v76, v76
  v_exp_f32 v77, v77
  v_exp_f32 v78, v78
  v_exp_f32 v79, v79
  v_cvt_pk_bf16_f32 v228, v72, v73
  v_cvt_pk_bf16_f32 v229, v74, v75
  v_cvt_pk_bf16_f32 v230, v76, v77
  v_cvt_pk_bf16_f32 v231, v78, v79
  s_cbranch_scc1 .fz_kernel_a_x
.fz_kernel_a_b2:
  v_mfma_f32_32x32x16_bf16 v[64:79], v[112:115], v[24:27], 0
  v_exp_f32 v48, v48
  v_exp_f32 v49, v49
  v_exp_f32 v50, v50
  v_exp_f32 v51, v51
  v_mfma_f32_32x32x16_bf16 v[192:207], v[108:111], v[228:231], v[192:207]
  v_exp_f32 v52, v52
  v_exp_f32 v53, v53
  v_exp_f32 v54, v54
  v_smfmac_f32_16x16x64_bf16 v[220:223], v[12:15], v[224:231], v11
  buffer_load_dwordx4 v[100:103], v10, s[4:7], s30 offen offset:1024
  v_exp_f32 v55, v55
  v_mfma_f32_32x32x16_bf16 v[64:79], v[116:119], v[28:31], v[64:79]
  s_waitcnt vmcnt(10)
  v_cvt_pk_bf16_f32 v224, v48, v49
  v_cvt_pk_bf16_f32 v225, v50, v51
  v_cvt_pk_bf16_f32 v226, v52, v53
  v_cvt_pk_bf16_f32 v227, v54, v55
  v_exp_f32 v56, v56
  v_exp_f32 v57, v57
  v_exp_f32 v58, v58
  v_exp_f32 v59, v59
  v_mfma_f32_32x32x16_bf16 v[144:159], v[120:123], v[224:227], v[144:159]
  v_exp_f32 v60, v60
  v_exp_f32 v61, v61
  v_exp_f32 v62, v62
  v_exp_f32 v63, v63
  v_cvt_pk_bf16_f32 v228, v56, v57
  v_cvt_pk_bf16_f32 v229, v58, v59
  v_cvt_pk_bf16_f32 v230, v60, v61
  v_cvt_pk_bf16_f32 v231, v62, v63
  v_mfma_f32_32x32x16_bf16 v[48:63], v[112:115], v[32:35], 0
  v_exp_f32 v64, v64
  v_exp_f32 v65, v65
  v_exp_f32 v66, v66
  v_exp_f32 v67, v67
  v_mfma_f32_32x32x16_bf16 v[144:159], v[124:127], v[228:231], v[144:159]
  v_exp_f32 v68, v68
  v_exp_f32 v69, v69
  v_exp_f32 v70, v70
  v_smfmac_f32_16x16x64_bf16 v[208:211], v[12:15], v[224:231], v11
  buffer_load_dwordx4 v[104:107], v10, s[4:7], s30 offen offset:2048
  v_exp_f32 v71, v71
  v_mfma_f32_32x32x16_bf16 v[48:63], v[116:119], v[36:39], v[48:63]
  s_ff1_i32_b32 s33, s36
  v_cvt_pk_bf16_f32 v224, v64, v65
  v_cvt_pk_bf16_f32 v225, v66, v67
  v_cvt_pk_bf16_f32 v226, v68, v69
  v_cvt_pk_bf16_f32 v227, v70, v71
  v_exp_f32 v72, v72
  v_exp_f32 v73, v73
  v_exp_f32 v74, v74
  v_exp_f32 v75, v75
  v_mfma_f32_32x32x16_bf16 v[160:175], v[120:123], v[224:227], v[160:175]
  s_bitset0_b32 s36, s33
  v_exp_f32 v76, v76
  v_exp_f32 v77, v77
  v_exp_f32 v78, v78
  v_exp_f32 v79, v79
  v_cvt_pk_bf16_f32 v228, v72, v73
  v_cvt_pk_bf16_f32 v229, v74, v75
  v_cvt_pk_bf16_f32 v230, v76, v77
  v_cvt_pk_bf16_f32 v231, v78, v79
  v_mfma_f32_32x32x16_bf16 v[64:79], v[112:115], v[40:43], 0
  s_lshl_b32 s33, s33, 14
  v_exp_f32 v48, v48
  v_exp_f32 v49, v49
  v_exp_f32 v50, v50
  v_exp_f32 v51, v51
  v_mfma_f32_32x32x16_bf16 v[160:175], v[124:127], v[228:231], v[160:175]
  v_exp_f32 v52, v52
  v_exp_f32 v53, v53
  v_exp_f32 v54, v54
  v_smfmac_f32_16x16x64_bf16 v[212:215], v[12:15], v[224:231], v11
  buffer_load_dwordx4 v[108:111], v10, s[4:7], s30 offen offset:3072
  v_exp_f32 v55, v55
  v_mfma_f32_32x32x16_bf16 v[64:79], v[116:119], v[44:47], v[64:79]
  s_add_u32 s30, s33, s35
  v_cvt_pk_bf16_f32 v224, v48, v49
  v_cvt_pk_bf16_f32 v225, v50, v51
  v_cvt_pk_bf16_f32 v226, v52, v53
  v_cvt_pk_bf16_f32 v227, v54, v55
  v_exp_f32 v56, v56
  v_exp_f32 v57, v57
  v_exp_f32 v58, v58
  v_exp_f32 v59, v59
  v_mfma_f32_32x32x16_bf16 v[176:191], v[120:123], v[224:227], v[176:191]
  s_waitcnt vmcnt(10)
  v_exp_f32 v60, v60
  v_exp_f32 v61, v61
  v_exp_f32 v62, v62
  v_exp_f32 v63, v63
  v_cvt_pk_bf16_f32 v228, v56, v57
  v_cvt_pk_bf16_f32 v229, v58, v59
  v_cvt_pk_bf16_f32 v230, v60, v61
  v_cvt_pk_bf16_f32 v231, v62, v63
  v_mfma_f32_32x32x16_bf16 v[48:63], v[128:131], v[16:19], 0
  s_cbranch_scc1 .fz_kernel_pk39c
.fz_kernel_pk39:
  v_exp_f32 v64, v64
  v_exp_f32 v65, v65
  v_exp_f32 v66, v66
  v_exp_f32 v67, v67
  v_mfma_f32_32x32x16_bf16 v[176:191], v[124:127], v[228:231], v[176:191]
  v_exp_f32 v68, v68
  v_exp_f32 v69, v69
  v_exp_f32 v70, v70
  v_smfmac_f32_16x16x64_bf16 v[216:219], v[12:15], v[224:231], v11
  buffer_load_dwordx4 v[112:115], v3, s[4:7], s30 offen offset:0
  v_exp_f32 v71, v71
  v_mfma_f32_32x32x16_bf16 v[48:63], v[132:135], v[20:23], v[48:63]
  v_cvt_pk_bf16_f32 v224, v64, v65
  v_cvt_pk_bf16_f32 v225, v66, v67
  v_cvt_pk_bf16_f32 v226, v68, v69
  v_cvt_pk_bf16_f32 v227, v70, v71
  v_exp_f32 v72, v72
  v_exp_f32 v73, v73
  v_exp_f32 v74, v74
  v_exp_f32 v75, v75
  v_mfma_f32_32x32x16_bf16 v[192:207], v[120:123], v[224:227], v[192:207]
  v_exp_f32 v76, v76
  v_exp_f32 v77, v77
  v_exp_f32 v78, v78
  v_exp_f32 v79, v79
  v_cvt_pk_bf16_f32 v228, v72, v73
  v_cvt_pk_bf16_f32 v229, v74, v75
  v_cvt_pk_bf16_f32 v230, v76, v77
  v_cvt_pk_bf16_f32 v231, v78, v79
  v_mfma_f32_32x32x16_bf16 v[64:79], v[128:131], v[24:27], 0
  v_exp_f32 v48, v48
  v_exp_f32 v49, v49
  v_exp_f32 v50, v50
  v_exp_f32 v51, v51
  v_mfma_f32_32x32x16_bf16 v[192:207], v[124:127], v[228:231], v[192:207]
  v_exp_f32 v52, v52
  v_exp_f32 v53, v53
  v_exp_f32 v54, v54
  v_smfmac_f32_16x16x64_bf16 v[220:223], v[12:15], v[224:231], v11
  buffer_load_dwordx4 v[116:119], v3, s[4:7], s30 offen offset:1024
  v_exp_f32 v55, v55
  v_mfma_f32_32x32x16_bf16 v[64:79], v[132:135], v[28:31], v[64:79]
  s_waitcnt vmcnt(10)
  v_cvt_pk_bf16_f32 v224, v48, v49
  v_cvt_pk_bf16_f32 v225, v50, v51
  v_cvt_pk_bf16_f32 v226, v52, v53
  v_cvt_pk_bf16_f32 v227, v54, v55
  v_exp_f32 v56, v56
  v_exp_f32 v57, v57
  v_exp_f32 v58, v58
  v_exp_f32 v59, v59
  v_mfma_f32_32x32x16_bf16 v[144:159], v[136:139], v[224:227], v[144:159]
  v_exp_f32 v60, v60
  v_exp_f32 v61, v61
  v_exp_f32 v62, v62
  v_exp_f32 v63, v63
  v_cvt_pk_bf16_f32 v228, v56, v57
  v_cvt_pk_bf16_f32 v229, v58, v59
  v_cvt_pk_bf16_f32 v230, v60, v61
  v_cvt_pk_bf16_f32 v231, v62, v63
  v_mfma_f32_32x32x16_bf16 v[48:63], v[128:131], v[32:35], 0
  v_exp_f32 v64, v64
  v_exp_f32 v65, v65
  v_exp_f32 v66, v66
  v_exp_f32 v67, v67
  v_mfma_f32_32x32x16_bf16 v[144:159], v[140:143], v[228:231], v[144:159]
  v_exp_f32 v68, v68
  v_exp_f32 v69, v69
  v_exp_f32 v70, v70
  v_smfmac_f32_16x16x64_bf16 v[208:211], v[12:15], v[224:231], v11
  buffer_load_dwordx4 v[120:123], v3, s[4:7], s30 offen offset:2048
  v_exp_f32 v71, v71
  v_mfma_f32_32x32x16_bf16 v[48:63], v[132:135], v[36:39], v[48:63]
  v_cvt_pk_bf16_f32 v224, v64, v65
  v_cvt_pk_bf16_f32 v225, v66, v67
  v_cvt_pk_bf16_f32 v226, v68, v69
  v_cvt_pk_bf16_f32 v227, v70, v71
  v_exp_f32 v72, v72
  v_exp_f32 v73, v73
  v_exp_f32 v74, v74
  v_exp_f32 v75, v75
  v_mfma_f32_32x32x16_bf16 v[160:175], v[136:139], v[224:227], v[160:175]
  v_exp_f32 v76, v76
  v_exp_f32 v77, v77
  v_exp_f32 v78, v78
  v_exp_f32 v79, v79
  v_cvt_pk_bf16_f32 v228, v72, v73
  v_cvt_pk_bf16_f32 v229, v74, v75
  v_cvt_pk_bf16_f32 v230, v76, v77
  v_cvt_pk_bf16_f32 v231, v78, v79
  v_mfma_f32_32x32x16_bf16 v[64:79], v[128:131], v[40:43], 0
  v_exp_f32 v48, v48
  v_exp_f32 v49, v49
  v_exp_f32 v50, v50
  v_exp_f32 v51, v51
  v_mfma_f32_32x32x16_bf16 v[160:175], v[140:143], v[228:231], v[160:175]
  v_exp_f32 v52, v52
  v_exp_f32 v53, v53
  v_exp_f32 v54, v54
  v_smfmac_f32_16x16x64_bf16 v[212:215], v[12:15], v[224:231], v11
  buffer_load_dwordx4 v[124:127], v3, s[4:7], s30 offen offset:3072
  v_exp_f32 v55, v55
  v_mfma_f32_32x32x16_bf16 v[64:79], v[132:135], v[44:47], v[64:79]
  v_cvt_pk_bf16_f32 v224, v48, v49
  v_cvt_pk_bf16_f32 v225, v50, v51
  v_cvt_pk_bf16_f32 v226, v52, v53
  v_cvt_pk_bf16_f32 v227, v54, v55
  v_exp_f32 v56, v56
  v_exp_f32 v57, v57
  v_exp_f32 v58, v58
  v_exp_f32 v59, v59
  v_mfma_f32_32x32x16_bf16 v[176:191], v[136:139], v[224:227], v[176:191]
  s_waitcnt vmcnt(10)
  v_exp_f32 v60, v60
  v_exp_f32 v61, v61
  v_exp_f32 v62, v62
  v_exp_f32 v63, v63
  v_cvt_pk_bf16_f32 v228, v56, v57
  v_cvt_pk_bf16_f32 v229, v58, v59
  v_cvt_pk_bf16_f32 v230, v60, v61
  v_cvt_pk_bf16_f32 v231, v62, v63
  v_mfma_f32_32x32x16_bf16 v[48:63], v[80:83], v[16:19], 0
  v_exp_f32 v64, v64
  v_exp_f32 v65, v65
  v_exp_f32 v66, v66
  v_exp_f32 v67, v67
  v_mfma_f32_32x32x16_bf16 v[176:191], v[140:143], v[228:231], v[176:191]
  v_exp_f32 v68, v68
  v_exp_f32 v69, v69
  v_exp_f32 v70, v70
  v_smfmac_f32_16x16x64_bf16 v[216:219], v[12:15], v[224:231], v11
  buffer_load_dwordx4 v[128:131], v10, s[4:7], s30 offen offset:0
  v_exp_f32 v71, v71
  v_mfma_f32_32x32x16_bf16 v[48:63], v[84:87], v[20:23], v[48:63]
  v_cvt_pk_bf16_f32 v224, v64, v65
  v_cvt_pk_bf16_f32 v225, v66, v67
  v_cvt_pk_bf16_f32 v226, v68, v69
  v_cvt_pk_bf16_f32 v227, v70, v71
  v_exp_f32 v72, v72
  v_exp_f32 v73, v73
  v_exp_f32 v74, v74
  v_exp_f32 v75, v75
  v_mfma_f32_32x32x16_bf16 v[192:207], v[136:139], v[224:227], v[192:207]
  v_exp_f32 v76, v76
  v_exp_f32 v77, v77
  v_exp_f32 v78, v78
  v_exp_f32 v79, v79
  v_cvt_pk_bf16_f32 v228, v72, v73
  v_cvt_pk_bf16_f32 v229, v74, v75
  v_cvt_pk_bf16_f32 v230, v76, v77
  v_cvt_pk_bf16_f32 v231, v78, v79
  s_branch .fz_kernel_a_loop
.fz_kernel_a_x:
  s_waitcnt vmcnt(7)
  v_mfma_f32_32x32x16_bf16 v[64:79], v[128:131], v[16:19], 0
  v_exp_f32 v48, v48
  v_exp_f32 v49, v49
  v_exp_f32 v50, v50
  v_exp_f32 v51, v51
  v_mfma_f32_32x32x16_bf16 v[192:207], v[108:111], v[228:231], v[192:207]
  v_exp_f32 v52, v52
  v_exp_f32 v53, v53
  v_exp_f32 v54, v54
  v_smfmac_f32_16x16x64_bf16 v[220:223], v[12:15], v[224:231], v11
  v_exp_f32 v55, v55
  v_mfma_f32_32x32x16_bf16 v[64:79], v[132:135], v[20:23], v[64:79]
  s_waitcnt vmcnt(5)
  v_cvt_pk_bf16_f32 v224, v48, v49
  v_cvt_pk_bf16_f32 v225, v50, v51
  v_cvt_pk_bf16_f32 v226, v52, v53
  v_cvt_pk_bf16_f32 v227, v54, v55
  v_exp_f32 v56, v56
  v_exp_f32 v57, v57
  v_exp_f32 v58, v58
  v_exp_f32 v59, v59
  v_mfma_f32_32x32x16_bf16 v[144:159], v[120:123], v[224:227], v[144:159]
  v_exp_f32 v60, v60
  v_exp_f32 v61, v61
  v_exp_f32 v62, v62
  v_exp_f32 v63, v63
  v_cvt_pk_bf16_f32 v228, v56, v57
  v_cvt_pk_bf16_f32 v229, v58, v59
  v_cvt_pk_bf16_f32 v230, v60, v61
  v_cvt_pk_bf16_f32 v231, v62, v63
  v_mfma_f32_32x32x16_bf16 v[48:63], v[112:115], v[24:27], 0
  v_exp_f32 v64, v64
  v_exp_f32 v65, v65
  v_exp_f32 v66, v66
  v_exp_f32 v67, v67
  v_mfma_f32_32x32x16_bf16 v[144:159], v[124:127], v[228:231], v[144:159]
  v_exp_f32 v68, v68
  v_exp_f32 v69, v69
  v_exp_f32 v70, v70
  v_smfmac_f32_16x16x64_bf16 v[208:211], v[12:15], v[224:231], v11
  v_exp_f32 v71, v71
  v_mfma_f32_32x32x16_bf16 v[48:63], v[116:119], v[28:31], v[48:63]
  v_cvt_pk_bf16_f32 v224, v64, v65
  v_cvt_pk_bf16_f32 v225, v66, v67
  v_cvt_pk_bf16_f32 v226, v68, v69
  v_cvt_pk_bf16_f32 v227, v70, v71
  v_exp_f32 v72, v72
  v_exp_f32 v73, v73
  v_exp_f32 v74, v74
  v_exp_f32 v75, v75
  v_mfma_f32_32x32x16_bf16 v[144:159], v[136:139], v[224:227], v[144:159]
  v_exp_f32 v76, v76
  v_exp_f32 v77, v77
  v_exp_f32 v78, v78
  v_exp_f32 v79, v79
  v_cvt_pk_bf16_f32 v228, v72, v73
  v_cvt_pk_bf16_f32 v229, v74, v75
  v_cvt_pk_bf16_f32 v230, v76, v77
  v_cvt_pk_bf16_f32 v231, v78, v79
  v_mfma_f32_32x32x16_bf16 v[64:79], v[128:131], v[24:27], 0
  v_exp_f32 v48, v48
  v_exp_f32 v49, v49
  v_exp_f32 v50, v50
  v_exp_f32 v51, v51
  v_mfma_f32_32x32x16_bf16 v[144:159], v[140:143], v[228:231], v[144:159]
  v_exp_f32 v52, v52
  v_exp_f32 v53, v53
  v_exp_f32 v54, v54
  v_smfmac_f32_16x16x64_bf16 v[208:211], v[12:15], v[224:231], v11
  v_exp_f32 v55, v55
  v_mfma_f32_32x32x16_bf16 v[64:79], v[132:135], v[28:31], v[64:79]
  v_cvt_pk_bf16_f32 v224, v48, v49
  v_cvt_pk_bf16_f32 v225, v50, v51
  v_cvt_pk_bf16_f32 v226, v52, v53
  v_cvt_pk_bf16_f32 v227, v54, v55
  v_exp_f32 v56, v56
  v_exp_f32 v57, v57
  v_exp_f32 v58, v58
  v_exp_f32 v59, v59
  v_mfma_f32_32x32x16_bf16 v[160:175], v[120:123], v[224:227], v[160:175]
  v_exp_f32 v60, v60
  v_exp_f32 v61, v61
  v_exp_f32 v62, v62
  v_exp_f32 v63, v63
  v_cvt_pk_bf16_f32 v228, v56, v57
  v_cvt_pk_bf16_f32 v229, v58, v59
  v_cvt_pk_bf16_f32 v230, v60, v61
  v_cvt_pk_bf16_f32 v231, v62, v63
  v_cvt_pk_bf16_f32 v144, v144, v145
  v_cvt_pk_bf16_f32 v145, v146, v147
  v_cvt_pk_bf16_f32 v146, v148, v149
  v_cvt_pk_bf16_f32 v147, v150, v151
  ds_write_b128 v9, v[144:147] offset:0
  v_cvt_pk_bf16_f32 v148, v152, v153
  v_cvt_pk_bf16_f32 v149, v154, v155
  v_cvt_pk_bf16_f32 v150, v156, v157
  v_cvt_pk_bf16_f32 v151, v158, v159
  ds_write_b128 v9, v[148:151] offset:1024
  v_add_f32 v208, v208, v210
  v_add_f32 v209, v209, v211
  v_cndmask_b32 v30, v208, v209, s[20:21]
  v_mfma_f32_32x32x16_bf16 v[48:63], v[112:115], v[32:35], 0
  v_exp_f32 v64, v64
  v_exp_f32 v65, v65
  v_exp_f32 v66, v66
  v_exp_f32 v67, v67
  v_mfma_f32_32x32x16_bf16 v[160:175], v[124:127], v[228:231], v[160:175]
  v_exp_f32 v68, v68
  v_exp_f32 v69, v69
  v_exp_f32 v70, v70
  v_smfmac_f32_16x16x64_bf16 v[212:215], v[12:15], v[224:231], v11
  v_exp_f32 v71, v71
  v_mfma_f32_32x32x16_bf16 v[48:63], v[116:119], v[36:39], v[48:63]
  v_cvt_pk_bf16_f32 v224, v64, v65
  v_cvt_pk_bf16_f32 v225, v66, v67
  v_cvt_pk_bf16_f32 v226, v68, v69
  v_cvt_pk_bf16_f32 v227, v70, v71
  v_exp_f32 v72, v72
  v_exp_f32 v73, v73
  v_exp_f32 v74, v74
  v_exp_f32 v75, v75
  v_mfma_f32_32x32x16_bf16 v[160:175], v[136:139], v[224:227], v[160:175]
  v_exp_f32 v76, v76
  v_exp_f32 v77, v77
  v_exp_f32 v78, v78
  v_exp_f32 v79, v79
  v_cvt_pk_bf16_f32 v228, v72, v73
  v_cvt_pk_bf16_f32 v229, v74, v75
  v_cvt_pk_bf16_f32 v230, v76, v77
  v_cvt_pk_bf16_f32 v231, v78, v79
  v_mfma_f32_32x32x16_bf16 v[64:79], v[128:131], v[32:35], 0
  v_exp_f32 v48, v48
  v_exp_f32 v49, v49
  v_exp_f32 v50, v50
  v_exp_f32 v51, v51
  v_mfma_f32_32x32x16_bf16 v[160:175], v[140:143], v[228:231], v[160:175]
  v_exp_f32 v52, v52
  v_exp_f32 v53, v53
  v_exp_f32 v54, v54
  v_smfmac_f32_16x16x64_bf16 v[212:215], v[12:15], v[224:231], v11
  v_exp_f32 v55, v55
  v_mfma_f32_32x32x16_bf16 v[64:79], v[132:135], v[36:39], v[64:79]
  v_cvt_pk_bf16_f32 v224, v48, v49
  v_cvt_pk_bf16_f32 v225, v50, v51
  v_cvt_pk_bf16_f32 v226, v52, v53
  v_cvt_pk_bf16_f32 v227, v54, v55
  v_exp_f32 v56, v56
  v_exp_f32 v57, v57
  v_exp_f32 v58, v58
  v_exp_f32 v59, v59
  v_mfma_f32_32x32x16_bf16 v[176:191], v[120:123], v[224:227], v[176:191]
  v_exp_f32 v60, v60
  v_exp_f32 v61, v61
  v_exp_f32 v62, v62
  v_exp_f32 v63, v63
  v_cvt_pk_bf16_f32 v228, v56, v57
  v_cvt_pk_bf16_f32 v229, v58, v59
  v_cvt_pk_bf16_f32 v230, v60, v61
  v_cvt_pk_bf16_f32 v231, v62, v63
  v_cvt_pk_bf16_f32 v160, v160, v161
  v_cvt_pk_bf16_f32 v161, v162, v163
  v_cvt_pk_bf16_f32 v162, v164, v165
  v_cvt_pk_bf16_f32 v163, v166, v167
  ds_write_b128 v9, v[160:163] offset:2048
  v_cvt_pk_bf16_f32 v164, v168, v169
  v_cvt_pk_bf16_f32 v165, v170, v171
  v_cvt_pk_bf16_f32 v166, v172, v173
  v_cvt_pk_bf16_f32 v167, v174, v175
  ds_write_b128 v9, v[164:167] offset:3072
  v_add_f32 v212, v212, v214
  v_add_f32 v213, v213, v215
  v_cndmask_b32 v31, v212, v213, s[20:21]
  ds_write_b64 v1, v[30:31]
  v_xor_b32 v1, 512, v1
  v_mfma_f32_32x32x16_bf16 v[48:63], v[112:115], v[40:43], 0
  v_exp_f32 v64, v64
  v_exp_f32 v65, v65
  v_exp_f32 v66, v66
  v_exp_f32 v67, v67
  v_mfma_f32_32x32x16_bf16 v[176:191], v[124:127], v[228:231], v[176:191]
  v_exp_f32 v68, v68
  v_exp_f32 v69, v69
  v_exp_f32 v70, v70
  v_smfmac_f32_16x16x64_bf16 v[216:219], v[12:15], v[224:231], v11
  s_waitcnt vmcnt(0) lgkmcnt(0)
  s_barrier
  ds_read_b128 v[80:83], v8 offset:0
  ds_read_b128 v[84:87], v8 offset:1024
  ds_read_b128 v[88:91], v8 offset:2048
  ds_read_b128 v[92:95], v8 offset:3072
  ds_read_b64 v[30:31], v1
  v_exp_f32 v71, v71
  v_mfma_f32_32x32x16_bf16 v[48:63], v[116:119], v[44:47], v[48:63]
  v_cvt_pk_bf16_f32 v224, v64, v65
  v_cvt_pk_bf16_f32 v225, v66, v67
  v_cvt_pk_bf16_f32 v226, v68, v69
  v_cvt_pk_bf16_f32 v227, v70, v71
  v_exp_f32 v72, v72
  v_exp_f32 v73, v73
  v_exp_f32 v74, v74
  v_exp_f32 v75, v75
  v_mfma_f32_32x32x16_bf16 v[176:191], v[136:139], v[224:227], v[176:191]
  v_exp_f32 v76, v76
  v_exp_f32 v77, v77
  s_waitcnt lgkmcnt(0)
  v_mfma_f32_32x32x16_bf16 v[176:191], v[248:251], v[80:83], v[176:191]
  v_exp_f32 v78, v78
  v_exp_f32 v79, v79
  v_mfma_f32_32x32x16_bf16 v[176:191], v[252:255], v[84:87], v[176:191]
  v_cvt_pk_bf16_f32 v228, v72, v73
  v_cvt_pk_bf16_f32 v229, v74, v75
  v_cvt_pk_bf16_f32 v230, v76, v77
  v_cvt_pk_bf16_f32 v231, v78, v79
  v_mfma_f32_32x32x16_bf16 v[64:79], v[128:131], v[40:43], 0
  v_exp_f32 v48, v48
  v_exp_f32 v49, v49
  v_exp_f32 v50, v50
  v_exp_f32 v51, v51
  v_mfma_f32_32x32x16_bf16 v[176:191], v[140:143], v[228:231], v[176:191]
  v_exp_f32 v52, v52
  v_exp_f32 v53, v53
  v_exp_f32 v54, v54
  v_smfmac_f32_16x16x64_bf16 v[216:219], v[12:15], v[224:231], v11
  v_exp_f32 v55, v55
  v_mfma_f32_32x32x16_bf16 v[64:79], v[132:135], v[44:47], v[64:79]
  v_cvt_pk_bf16_f32 v224, v48, v49
  v_cvt_pk_bf16_f32 v225, v50, v51
  v_cvt_pk_bf16_f32 v226, v52, v53
  v_cvt_pk_bf16_f32 v227, v54, v55
  v_exp_f32 v56, v56
  v_exp_f32 v57, v57
  v_exp_f32 v58, v58
  v_exp_f32 v59, v59
  s_nop 1
  v_add_f32 v216, v216, v218
  v_add_f32 v217, v217, v219
  v_cndmask_b32 v24, v216, v217, s[20:21]
  v_add_f32 v24, v24, v30
  s_mov_b64 s[36:37], -1
  v_rcp_f32 v26, v24
  v_cmp_le_f32 vcc, s24, v24
  s_and_b64 s[36:37], s[36:37], vcc
  v_cmp_ge_f32 vcc, s25, v24
  s_and_b64 s[36:37], s[36:37], vcc
  v_pk_mul_f32 v[176:177], v[176:177], v[26:27] op_sel_hi:[1,0]
  v_pk_mul_f32 v[178:179], v[178:179], v[26:27] op_sel_hi:[1,0]
  v_pk_mul_f32 v[180:181], v[180:181], v[26:27] op_sel_hi:[1,0]
  v_pk_mul_f32 v[182:183], v[182:183], v[26:27] op_sel_hi:[1,0]
  v_cvt_pk_bf16_f32 v80, v176, v177
  v_cvt_pk_bf16_f32 v81, v178, v179
  v_cvt_pk_bf16_f32 v82, v180, v181
  v_cvt_pk_bf16_f32 v83, v182, v183
  buffer_store_dwordx4 v[80:83], v3, s[4:7], s8 offen offset:0 sc1
  v_pk_mul_f32 v[184:185], v[184:185], v[26:27] op_sel_hi:[1,0]
  v_pk_mul_f32 v[186:187], v[186:187], v[26:27] op_sel_hi:[1,0]
  v_pk_mul_f32 v[188:189], v[188:189], v[26:27] op_sel_hi:[1,0]
  v_pk_mul_f32 v[190:191], v[190:191], v[26:27] op_sel_hi:[1,0]
  v_cvt_pk_bf16_f32 v84, v184, v185
  v_cvt_pk_bf16_f32 v85, v186, v187
  v_cvt_pk_bf16_f32 v86, v188, v189
  v_cvt_pk_bf16_f32 v87, v190, v191
  buffer_store_dwordx4 v[84:87], v3, s[4:7], s8 offen offset:1024 sc1
  v_mfma_f32_32x32x16_bf16 v[192:207], v[120:123], v[224:227], v[192:207]
  v_exp_f32 v60, v60
  v_exp_f32 v61, v61
  v_exp_f32 v62, v62
  v_exp_f32 v63, v63
  v_cvt_pk_bf16_f32 v228, v56, v57
  v_cvt_pk_bf16_f32 v229, v58, v59
  v_cvt_pk_bf16_f32 v230, v60, v61
  v_cvt_pk_bf16_f32 v231, v62, v63
  v_mfma_f32_32x32x16_bf16 v[192:207], v[248:251], v[88:91], v[192:207]
  v_exp_f32 v64, v64
  v_exp_f32 v65, v65
  v_exp_f32 v66, v66
  v_exp_f32 v67, v67
  v_mfma_f32_32x32x16_bf16 v[192:207], v[124:127], v[228:231], v[192:207]
  v_exp_f32 v68, v68
  v_exp_f32 v69, v69
  v_exp_f32 v70, v70
  v_smfmac_f32_16x16x64_bf16 v[220:223], v[12:15], v[224:231], v11
  v_exp_f32 v71, v71
  v_mfma_f32_32x32x16_bf16 v[192:207], v[252:255], v[92:95], v[192:207]
  v_cvt_pk_bf16_f32 v224, v64, v65
  v_cvt_pk_bf16_f32 v225, v66, v67
  v_cvt_pk_bf16_f32 v226, v68, v69
  v_cvt_pk_bf16_f32 v227, v70, v71
  v_exp_f32 v72, v72
  v_exp_f32 v73, v73
  v_exp_f32 v74, v74
  v_exp_f32 v75, v75
  v_mfma_f32_32x32x16_bf16 v[192:207], v[136:139], v[224:227], v[192:207]
  v_exp_f32 v76, v76
  v_exp_f32 v77, v77
  v_exp_f32 v78, v78
  v_exp_f32 v79, v79
  v_cvt_pk_bf16_f32 v228, v72, v73
  v_cvt_pk_bf16_f32 v229, v74, v75
  v_cvt_pk_bf16_f32 v230, v76, v77
  v_cvt_pk_bf16_f32 v231, v78, v79
  s_nop 1
  v_smfmac_f32_16x16x64_bf16 v[220:223], v[12:15], v[224:231], v11
  v_mfma_f32_32x32x16_bf16 v[192:207], v[140:143], v[228:231], v[192:207]
  s_nop 10
  v_add_f32 v220, v220, v222
  v_add_f32 v221, v221, v223
  v_cndmask_b32 v25, v220, v221, s[20:21]
  v_add_f32 v25, v25, v31
.fz_kernel_a_fin:
  v_rcp_f32 v28, v25
  v_cmp_le_f32 vcc, s24, v25
  s_and_b64 s[36:37], s[36:37], vcc
  v_cmp_ge_f32 vcc, s25, v25
  s_and_b64 s[36:37], s[36:37], vcc
  v_pk_mul_f32 v[192:193], v[192:193], v[28:29] op_sel_hi:[1,0]
  v_pk_mul_f32 v[194:195], v[194:195], v[28:29] op_sel_hi:[1,0]
  v_pk_mul_f32 v[196:197], v[196:197], v[28:29] op_sel_hi:[1,0]
  v_pk_mul_f32 v[198:199], v[198:199], v[28:29] op_sel_hi:[1,0]
  v_cvt_pk_bf16_f32 v88, v192, v193
  v_cvt_pk_bf16_f32 v89, v194, v195
  v_cvt_pk_bf16_f32 v90, v196, v197
  v_cvt_pk_bf16_f32 v91, v198, v199
  buffer_store_dwordx4 v[88:91], v3, s[4:7], s9 offen offset:0 sc1
  v_pk_mul_f32 v[200:201], v[200:201], v[28:29] op_sel_hi:[1,0]
  v_pk_mul_f32 v[202:203], v[202:203], v[28:29] op_sel_hi:[1,0]
  v_pk_mul_f32 v[204:205], v[204:205], v[28:29] op_sel_hi:[1,0]
  v_pk_mul_f32 v[206:207], v[206:207], v[28:29] op_sel_hi:[1,0]
  v_cvt_pk_bf16_f32 v92, v200, v201
  v_cvt_pk_bf16_f32 v93, v202, v203
  v_cvt_pk_bf16_f32 v94, v204, v205
  v_cvt_pk_bf16_f32 v95, v206, v207
  buffer_store_dwordx4 v[92:95], v3, s[4:7], s9 offen offset:1024 sc1
  ds_read_b32 v7, v6 offset:8
  v_pk_fma_f32 v[64:65], v[176:177], 0, 0 op_sel_hi:[1,0,0]
  v_pk_fma_f32 v[66:67], v[178:179], 0, 0 op_sel_hi:[1,0,0]
  v_pk_fma_f32 v[64:65], v[180:181], 0, v[64:65] op_sel_hi:[1,0,1]
  v_pk_fma_f32 v[66:67], v[182:183], 0, v[66:67] op_sel_hi:[1,0,1]
  v_pk_fma_f32 v[64:65], v[184:185], 0, v[64:65] op_sel_hi:[1,0,1]
  v_pk_fma_f32 v[66:67], v[186:187], 0, v[66:67] op_sel_hi:[1,0,1]
  v_pk_fma_f32 v[64:65], v[188:189], 0, v[64:65] op_sel_hi:[1,0,1]
  v_pk_fma_f32 v[66:67], v[190:191], 0, v[66:67] op_sel_hi:[1,0,1]
  v_pk_fma_f32 v[64:65], v[192:193], 0, v[64:65] op_sel_hi:[1,0,1]
  v_pk_fma_f32 v[66:67], v[194:195], 0, v[66:67] op_sel_hi:[1,0,1]
  v_pk_fma_f32 v[64:65], v[196:197], 0, v[64:65] op_sel_hi:[1,0,1]
  v_pk_fma_f32 v[66:67], v[198:199], 0, v[66:67] op_sel_hi:[1,0,1]
  v_pk_fma_f32 v[64:65], v[200:201], 0, v[64:65] op_sel_hi:[1,0,1]
  v_pk_fma_f32 v[66:67], v[202:203], 0, v[66:67] op_sel_hi:[1,0,1]
  v_pk_fma_f32 v[64:65], v[204:205], 0, v[64:65] op_sel_hi:[1,0,1]
  v_pk_fma_f32 v[66:67], v[206:207], 0, v[66:67] op_sel_hi:[1,0,1]
  v_pk_add_f32 v[64:65], v[64:65], v[66:67]
  v_cmp_o_f32 vcc, v64, v65
  s_and_b64 s[36:37], s[36:37], vcc
  s_cmp_eq_u64 s[36:37], -1
  s_cbranch_scc0 .fz_kernel_a_slow
.fz_kernel_a_ok:
  s_mov_b32 s8, s48
  s_mov_b32 s9, s49
  s_mov_b32 s10, 0x800
  s_mov_b32 s11, 0x00020000
  v_lshrrev_b32 v17, 5, v2
  v_lshlrev_b32 v19, 4, v17
  s_lshl_b32 s22, s18, 7
  s_lshl2_add_u32 s32, s17, s16
  s_lshl_b32 s35, s32, 16
  s_add_u32 s35, s35, s64
  v_add_u32 v8, s35, v3
  v_add_u32 v6, 8, v6
  buffer_load_dwordx4 v[48:51], v19, s[8:11], s22 offen offset:0
  buffer_load_dwordx4 v[52:55], v19, s[8:11], s22 offen offset:32
  buffer_load_dwordx4 v[56:59], v19, s[8:11], s22 offen offset:64
  buffer_load_dwordx4 v[60:63], v19, s[8:11], s22 offen offset:96
  s_waitcnt lgkmcnt(0)
  v_readfirstlane_b32 s36, v7
  s_mov_b32 s34, s36
  s_bcnt1_i32_b32 s29, s36
  s_cmp_lt_u32 s29, 2
  s_cbranch_scc1 .fz_kernel_w_e0
  s_cmp_eq_u32 s36, 0
  s_cbranch_scc1 .fz_kernel_pk48c
.fz_kernel_pk48:
  s_ff1_i32_b32 s33, s36
  s_bitset0_b32 s36, s33
  s_lshl_b32 s20, s33, 12
  buffer_load_dwordx4 v[96:99], v8, s[4:7], s20 offen offset:0
  buffer_load_dwordx4 v[100:103], v8, s[4:7], s20 offen offset:1024
  buffer_load_dwordx4 v[104:107], v8, s[4:7], s20 offen offset:2048
  buffer_load_dwordx4 v[108:111], v8, s[4:7], s20 offen offset:3072
  s_cmp_eq_u32 s36, 0
  s_cbranch_scc1 .fz_kernel_pk49c
.fz_kernel_pk49:
  s_ff1_i32_b32 s33, s36
  s_bitset0_b32 s36, s33
  s_lshl_b32 s21, s33, 12
  buffer_load_dwordx4 v[112:115], v8, s[4:7], s21 offen offset:0
  buffer_load_dwordx4 v[116:119], v8, s[4:7], s21 offen offset:1024
  buffer_load_dwordx4 v[120:123], v8, s[4:7], s21 offen offset:2048
  buffer_load_dwordx4 v[124:127], v8, s[4:7], s21 offen offset:3072
.fz_kernel_w_e0:
  v_and_b32 v18, 31, v2
  s_lshl_b32 s39, s17, 4
  s_add_u32 s39, s39, s18
  s_lshl_b32 s39, s39, 2
  s_add_u32 s39, s39, s16
  s_lshl_b32 s39, s39, 12
  v_and_b32 v16, 16, v2
  v_lshlrev_b32 v16, 7, v16
  v_lshl_add_u32 v16, v17, 8, v16
  v_and_b32 v1, 0xf0, v3
  v_add_u32 v16, v16, v1
  s_add_u32 s39, s39, s65
  s_lshl_b32 s31, s16, 5
  v_add_u32 v45, s31, v18
  v_lshlrev_b32 v11, 2, v45
  v_add_u32 v11, 155648, v11
  v_mov_b32 v44, 159952
  ds_read_b32 v40, v11 offset:6400
  ds_read_b32 v42, v11 offset:6912
  ds_read_b32 v46, v44 offset:8
  ds_read_b32 v44, v44
  v_mov_b32 v47, 0.32768
  v_add_u32 v45, 1, v45
  v_bfe_u32 v11, v2, 2, 2
  v_lshl_add_u32 v12, v17, 2, v11
  v_lshlrev_b32 v12, 7, v12
  v_lshrrev_b32 v13, 1, v11
  v_lshl_add_u32 v12, v13, 6, v12
  v_bfe_u32 v13, v2, 4, 1
  v_lshl_add_u32 v12, v13, 5, v12
  v_and_b32 v13, 1, v2
  v_lshl_add_u32 v12, v13, 4, v12
  v_bfe_u32 v13, v2, 1, 1
  v_lshl_add_u32 v14, v13, 3, v12
  v_xor_b32 v15, 64, v14
  s_mov_b64 exec, 1
  s_cmp_lt_u32 s29, 2
  s_cbranch_scc1 .fz_kernel_w_e1
  s_waitcnt vmcnt(12)
  s_branch .fz_kernel_w_e3
.fz_kernel_w_e1:
  s_waitcnt vmcnt(4)
.fz_kernel_w_e3:
  ds_add_u32 v6, v5 offset:0x100
  s_mov_b64 exec, -1
  v_lshlrev_b32 v64, 16, v232
  v_and_b32 v65, 0xffff0000, v232
  v_lshlrev_b32 v66, 16, v233
  v_and_b32 v67, 0xffff0000, v233
  v_lshlrev_b32 v68, 16, v234
  v_and_b32 v69, 0xffff0000, v234
  v_lshlrev_b32 v70, 16, v235
  v_and_b32 v71, 0xffff0000, v235
  v_lshlrev_b32 v72, 16, v236
  v_and_b32 v73, 0xffff0000, v236
  v_lshlrev_b32 v74, 16, v237
  v_and_b32 v75, 0xffff0000, v237
  v_lshlrev_b32 v76, 16, v238
  v_and_b32 v77, 0xffff0000, v238
  v_lshlrev_b32 v78, 16, v239
  v_and_b32 v79, 0xffff0000, v239
  v_lshlrev_b32 v80, 16, v240
  v_and_b32 v81, 0xffff0000, v240
  v_lshlrev_b32 v82, 16, v241
  v_and_b32 v83, 0xffff0000, v241
  v_lshlrev_b32 v84, 16, v242
  v_and_b32 v85, 0xffff0000, v242
  v_lshlrev_b32 v86, 16, v243
  v_and_b32 v87, 0xffff0000, v243
  v_lshlrev_b32 v88, 16, v244
  v_and_b32 v89, 0xffff0000, v244
  v_lshlrev_b32 v90, 16, v245
  v_and_b32 v91, 0xffff0000, v245
  v_lshlrev_b32 v92, 16, v246
  v_and_b32 v93, 0xffff0000, v246
  v_lshlrev_b32 v94, 16, v247
  v_and_b32 v95, 0xffff0000, v247
  s_waitcnt lgkmcnt(0)
  v_pk_fma_f32 v[64:65], v[64:65], v[40:41], v[42:43] op_sel_hi:[1,0,0]
  v_pk_fma_f32 v[66:67], v[66:67], v[40:41], v[42:43] op_sel_hi:[1,0,0]
  v_pk_fma_f32 v[68:69], v[68:69], v[40:41], v[42:43] op_sel_hi:[1,0,0]
  v_pk_fma_f32 v[70:71], v[70:71], v[40:41], v[42:43] op_sel_hi:[1,0,0]
  v_pk_fma_f32 v[72:73], v[72:73], v[40:41], v[42:43] op_sel_hi:[1,0,0]
  v_pk_fma_f32 v[74:75], v[74:75], v[40:41], v[42:43] op_sel_hi:[1,0,0]
  v_pk_fma_f32 v[76:77], v[76:77], v[40:41], v[42:43] op_sel_hi:[1,0,0]
  v_pk_fma_f32 v[78:79], v[78:79], v[40:41], v[42:43] op_sel_hi:[1,0,0]
  v_pk_fma_f32 v[80:81], v[80:81], v[40:41], v[42:43] op_sel_hi:[1,0,0]
  v_pk_fma_f32 v[82:83], v[82:83], v[40:41], v[42:43] op_sel_hi:[1,0,0]
  v_pk_fma_f32 v[84:85], v[84:85], v[40:41], v[42:43] op_sel_hi:[1,0,0]
  v_pk_fma_f32 v[86:87], v[86:87], v[40:41], v[42:43] op_sel_hi:[1,0,0]
  v_pk_fma_f32 v[88:89], v[88:89], v[40:41], v[42:43] op_sel_hi:[1,0,0]
  v_pk_fma_f32 v[90:91], v[90:91], v[40:41], v[42:43] op_sel_hi:[1,0,0]
  v_pk_fma_f32 v[92:93], v[92:93], v[40:41], v[42:43] op_sel_hi:[1,0,0]
  v_pk_fma_f32 v[94:95], v[94:95], v[40:41], v[42:43] op_sel_hi:[1,0,0]
  v_cmp_eq_u32 vcc, v44, v45
  s_cbranch_vccnz .fz_kernel_w_pt
.fz_kernel_w_pb:
  s_cmp_ge_u32 s29, 2
  s_cbranch_scc1 .fz_kernel_w_e2
  s_cmp_eq_u32 s36, 0
  s_cbranch_scc1 .fz_kernel_pk50c
.fz_kernel_pk50:
  s_ff1_i32_b32 s33, s36
  s_bitset0_b32 s36, s33
  s_lshl_b32 s20, s33, 12
  buffer_load_dwordx4 v[96:99], v8, s[4:7], s20 offen offset:0
  buffer_load_dwordx4 v[100:103], v8, s[4:7], s20 offen offset:1024
  buffer_load_dwordx4 v[104:107], v8, s[4:7], s20 offen offset:2048
  buffer_load_dwordx4 v[108:111], v8, s[4:7], s20 offen offset:3072
  s_cmp_eq_u32 s36, 0
  s_cbranch_scc1 .fz_kernel_pk51c
.fz_kernel_pk51:
  s_ff1_i32_b32 s33, s36
  s_bitset0_b32 s36, s33
  s_lshl_b32 s21, s33, 12
  buffer_load_dwordx4 v[112:115], v8, s[4:7], s21 offen offset:0
  buffer_load_dwordx4 v[116:119], v8, s[4:7], s21 offen offset:1024
  buffer_load_dwordx4 v[120:123], v8, s[4:7], s21 offen offset:2048
  buffer_load_dwordx4 v[124:127], v8, s[4:7], s21 offen offset:3072
.fz_kernel_w_e2:
  s_cmp_eq_u32 s36, 0
  s_cbranch_scc1 .fz_kernel_pk52c
.fz_kernel_pk52:
  s_ff1_i32_b32 s33, s36
  s_bitset0_b32 s36, s33
  s_lshl_b32 s22, s33, 12
  buffer_load_dwordx4 v[128:131], v8, s[4:7], s22 offen offset:0
  buffer_load_dwordx4 v[132:135], v8, s[4:7], s22 offen offset:1024
  buffer_load_dwordx4 v[136:139], v8, s[4:7], s22 offen offset:2048
  buffer_load_dwordx4 v[140:143], v8, s[4:7], s22 offen offset:3072
  v_lshl_add_u32 v10, s20, 1, v14
  v_lshl_add_u32 v11, s20, 1, v15
  ds_read_b64_tr_b16 v[224:225], v10 offset:0
  ds_read_b64_tr_b16 v[226:227], v10 offset:1024
  ds_read_b64_tr_b16 v[228:229], v11 offset:0
  ds_read_b64_tr_b16 v[230:231], v11 offset:1024
  ds_read_b64_tr_b16 v[232:233], v10 offset:2048
  ds_read_b64_tr_b16 v[234:235], v10 offset:3072
  ds_read_b64_tr_b16 v[236:237], v11 offset:2048
  ds_read_b64_tr_b16 v[238:239], v11 offset:3072
  ds_read_b64_tr_b16 v[240:241], v10 offset:4096
  ds_read_b64_tr_b16 v[242:243], v10 offset:5120
  ds_read_b64_tr_b16 v[244:245], v11 offset:4096
  ds_read_b64_tr_b16 v[246:247], v11 offset:5120
  s_cmp_eq_u32 s36, 0
  s_cbranch_scc1 .fz_kernel_pk53c
.fz_kernel_pk53:
  s_ff1_i32_b32 s33, s36
  s_bitset0_b32 s36, s33
  s_lshl_b32 s23, s33, 12
  s_waitcnt vmcnt(11) lgkmcnt(8)
  v_mfma_f32_32x32x16_bf16 v[64:79], v[224:227], v[96:99], v[64:79]
  buffer_load_dwordx4 v[144:147], v8, s[4:7], s23 offen offset:0
  ds_read_b64_tr_b16 v[248:249], v10 offset:6144
  ds_read_b64_tr_b16 v[250:251], v10 offset:7168
  v_mfma_f32_32x32x16_bf16 v[80:95], v[228:231], v[96:99], v[80:95]
  ds_read_b64_tr_b16 v[252:253], v11 offset:6144
  ds_read_b64_tr_b16 v[254:255], v11 offset:7168
  v_lshl_add_u32 v12, s21, 1, v14
  v_lshl_add_u32 v13, s21, 1, v15
  s_waitcnt vmcnt(11) lgkmcnt(8)
  v_mfma_f32_32x32x16_bf16 v[64:79], v[232:235], v[100:103], v[64:79]
  buffer_load_dwordx4 v[148:151], v8, s[4:7], s23 offen offset:1024
  ds_read_b64_tr_b16 v[224:225], v12 offset:0
  ds_read_b64_tr_b16 v[226:227], v12 offset:1024
  v_mfma_f32_32x32x16_bf16 v[80:95], v[236:239], v[100:103], v[80:95]
  ds_read_b64_tr_b16 v[228:229], v13 offset:0
  ds_read_b64_tr_b16 v[230:231], v13 offset:1024
  s_waitcnt vmcnt(11) lgkmcnt(8)
  v_mfma_f32_32x32x16_bf16 v[64:79], v[240:243], v[104:107], v[64:79]
  buffer_load_dwordx4 v[152:155], v8, s[4:7], s23 offen offset:2048
  ds_read_b64_tr_b16 v[232:233], v12 offset:2048
  ds_read_b64_tr_b16 v[234:235], v12 offset:3072
  v_mfma_f32_32x32x16_bf16 v[80:95], v[244:247], v[104:107], v[80:95]
  ds_read_b64_tr_b16 v[236:237], v13 offset:2048
  ds_read_b64_tr_b16 v[238:239], v13 offset:3072
  s_cmp_eq_u32 s36, 0
  s_cbranch_scc1 .fz_kernel_pk54c
.fz_kernel_pk54:
  s_ff1_i32_b32 s33, s36
  s_waitcnt vmcnt(11) lgkmcnt(8)
  v_mfma_f32_32x32x16_bf16 v[64:79], v[248:251], v[108:111], v[64:79]
  buffer_load_dwordx4 v[156:159], v8, s[4:7], s23 offen offset:3072
  ds_read_b64_tr_b16 v[240:241], v12 offset:4096
  ds_read_b64_tr_b16 v[242:243], v12 offset:5120
  v_mfma_f32_32x32x16_bf16 v[80:95], v[252:255], v[108:111], v[80:95]
  ds_read_b64_tr_b16 v[244:245], v13 offset:4096
  ds_read_b64_tr_b16 v[246:247], v13 offset:5120
  s_bitset0_b32 s36, s33
  s_lshl_b32 s24, s33, 12
  s_waitcnt vmcnt(11) lgkmcnt(8)
  v_mfma_f32_32x32x16_bf16 v[64:79], v[224:227], v[112:115], v[64:79]
  buffer_load_dwordx4 v[160:163], v8, s[4:7], s24 offen offset:0
  ds_read_b64_tr_b16 v[248:249], v12 offset:6144
  ds_read_b64_tr_b16 v[250:251], v12 offset:7168
  v_mfma_f32_32x32x16_bf16 v[80:95], v[228:231], v[112:115], v[80:95]
  ds_read_b64_tr_b16 v[252:253], v13 offset:6144
  ds_read_b64_tr_b16 v[254:255], v13 offset:7168
  v_lshl_add_u32 v10, s22, 1, v14
  v_lshl_add_u32 v11, s22, 1, v15
  s_waitcnt vmcnt(11) lgkmcnt(8)
  v_mfma_f32_32x32x16_bf16 v[64:79], v[232:235], v[116:119], v[64:79]
  buffer_load_dwordx4 v[164:167], v8, s[4:7], s24 offen offset:1024
  ds_read_b64_tr_b16 v[224:225], v10 offset:0
  ds_read_b64_tr_b16 v[226:227], v10 offset:1024
  v_mfma_f32_32x32x16_bf16 v[80:95], v[236:239], v[116:119], v[80:95]
  ds_read_b64_tr_b16 v[228:229], v11 offset:0
  ds_read_b64_tr_b16 v[230:231], v11 offset:1024
  s_waitcnt vmcnt(11) lgkmcnt(8)
  v_mfma_f32_32x32x16_bf16 v[64:79], v[240:243], v[120:123], v[64:79]
  buffer_load_dwordx4 v[168:171], v8, s[4:7], s24 offen offset:2048
  ds_read_b64_tr_b16 v[232:233], v10 offset:2048
  ds_read_b64_tr_b16 v[234:235], v10 offset:3072
  v_mfma_f32_32x32x16_bf16 v[80:95], v[244:247], v[120:123], v[80:95]
  ds_read_b64_tr_b16 v[236:237], v11 offset:2048
  ds_read_b64_tr_b16 v[238:239], v11 offset:3072
  s_cmp_eq_u32 s36, 0
  s_cbranch_scc1 .fz_kernel_pk55c
.fz_kernel_pk55:
  s_ff1_i32_b32 s33, s36
  s_waitcnt vmcnt(11) lgkmcnt(8)
  v_mfma_f32_32x32x16_bf16 v[64:79], v[248:251], v[124:127], v[64:79]
  buffer_load_dwordx4 v[172:175], v8, s[4:7], s24 offen offset:3072
  ds_read_b64_tr_b16 v[240:241], v10 offset:4096
  ds_read_b64_tr_b16 v[242:243], v10 offset:5120
  v_mfma_f32_32x32x16_bf16 v[80:95], v[252:255], v[124:127], v[80:95]
  ds_read_b64_tr_b16 v[244:245], v11 offset:4096
  ds_read_b64_tr_b16 v[246:247], v11 offset:5120
  s_bitset0_b32 s36, s33
  s_lshl_b32 s25, s33, 12
  s_waitcnt vmcnt(11) lgkmcnt(8)
  v_mfma_f32_32x32x16_bf16 v[64:79], v[224:227], v[128:131], v[64:79]
  buffer_load_dwordx4 v[176:179], v8, s[4:7], s25 offen offset:0
  ds_read_b64_tr_b16 v[248:249], v10 offset:6144
  ds_read_b64_tr_b16 v[250:251], v10 offset:7168
  v_mfma_f32_32x32x16_bf16 v[80:95], v[228:231], v[128:131], v[80:95]
  ds_read_b64_tr_b16 v[252:253], v11 offset:6144
  ds_read_b64_tr_b16 v[254:255], v11 offset:7168
  v_lshl_add_u32 v12, s23, 1, v14
  v_lshl_add_u32 v13, s23, 1, v15
  s_waitcnt vmcnt(11) lgkmcnt(8)
  v_mfma_f32_32x32x16_bf16 v[64:79], v[232:235], v[132:135], v[64:79]
  buffer_load_dwordx4 v[180:183], v8, s[4:7], s25 offen offset:1024
  ds_read_b64_tr_b16 v[224:225], v12 offset:0
  ds_read_b64_tr_b16 v[226:227], v12 offset:1024
  v_mfma_f32_32x32x16_bf16 v[80:95], v[236:239], v[132:135], v[80:95]
  ds_read_b64_tr_b16 v[228:229], v13 offset:0
  ds_read_b64_tr_b16 v[230:231], v13 offset:1024
  s_waitcnt vmcnt(11) lgkmcnt(8)
  v_mfma_f32_32x32x16_bf16 v[64:79], v[240:243], v[136:139], v[64:79]
  buffer_load_dwordx4 v[184:187], v8, s[4:7], s25 offen offset:2048
  ds_read_b64_tr_b16 v[232:233], v12 offset:2048
  ds_read_b64_tr_b16 v[234:235], v12 offset:3072
  v_mfma_f32_32x32x16_bf16 v[80:95], v[244:247], v[136:139], v[80:95]
  ds_read_b64_tr_b16 v[236:237], v13 offset:2048
  ds_read_b64_tr_b16 v[238:239], v13 offset:3072
  s_cmp_eq_u32 s36, 0
  s_cbranch_scc1 .fz_kernel_pk56c
.fz_kernel_pk56:
  s_ff1_i32_b32 s33, s36
  s_waitcnt vmcnt(11) lgkmcnt(8)
  v_mfma_f32_32x32x16_bf16 v[64:79], v[248:251], v[140:143], v[64:79]
  buffer_load_dwordx4 v[188:191], v8, s[4:7], s25 offen offset:3072
  ds_read_b64_tr_b16 v[240:241], v12 offset:4096
  ds_read_b64_tr_b16 v[242:243], v12 offset:5120
  v_mfma_f32_32x32x16_bf16 v[80:95], v[252:255], v[140:143], v[80:95]
  ds_read_b64_tr_b16 v[244:245], v13 offset:4096
  ds_read_b64_tr_b16 v[246:247], v13 offset:5120
  s_bitset0_b32 s36, s33
  s_lshl_b32 s26, s33, 12
  s_waitcnt vmcnt(11) lgkmcnt(8)
  v_mfma_f32_32x32x16_bf16 v[64:79], v[224:227], v[144:147], v[64:79]
  buffer_load_dwordx4 v[192:195], v8, s[4:7], s26 offen offset:0
  ds_read_b64_tr_b16 v[248:249], v12 offset:6144
  ds_read_b64_tr_b16 v[250:251], v12 offset:7168
  v_mfma_f32_32x32x16_bf16 v[80:95], v[228:231], v[144:147], v[80:95]
  ds_read_b64_tr_b16 v[252:253], v13 offset:6144
  ds_read_b64_tr_b16 v[254:255], v13 offset:7168
  v_lshl_add_u32 v10, s24, 1, v14
  v_lshl_add_u32 v11, s24, 1, v15
  s_waitcnt vmcnt(11) lgkmcnt(8)
  v_mfma_f32_32x32x16_bf16 v[64:79], v[232:235], v[148:151], v[64:79]
  buffer_load_dwordx4 v[196:199], v8, s[4:7], s26 offen offset:1024
  ds_read_b64_tr_b16 v[224:225], v10 offset:0
  ds_read_b64_tr_b16 v[226:227], v10 offset:1024
  v_mfma_f32_32x32x16_bf16 v[80:95], v[236:239], v[148:151], v[80:95]
  ds_read_b64_tr_b16 v[228:229], v11 offset:0
  ds_read_b64_tr_b16 v[230:231], v11 offset:1024
  s_waitcnt vmcnt(11) lgkmcnt(8)
  v_mfma_f32_32x32x16_bf16 v[64:79], v[240:243], v[152:155], v[64:79]
  buffer_load_dwordx4 v[200:203], v8, s[4:7], s26 offen offset:2048
  ds_read_b64_tr_b16 v[232:233], v10 offset:2048
  ds_read_b64_tr_b16 v[234:235], v10 offset:3072
  v_mfma_f32_32x32x16_bf16 v[80:95], v[244:247], v[152:155], v[80:95]
  ds_read_b64_tr_b16 v[236:237], v11 offset:2048
  ds_read_b64_tr_b16 v[238:239], v11 offset:3072
  s_cmp_eq_u32 s36, 0
  s_cbranch_scc1 .fz_kernel_pk57c
.fz_kernel_pk57:
  s_ff1_i32_b32 s33, s36
  s_waitcnt vmcnt(11) lgkmcnt(8)
  v_mfma_f32_32x32x16_bf16 v[64:79], v[248:251], v[156:159], v[64:79]
  buffer_load_dwordx4 v[204:207], v8, s[4:7], s26 offen offset:3072
  ds_read_b64_tr_b16 v[240:241], v10 offset:4096
  ds_read_b64_tr_b16 v[242:243], v10 offset:5120
  v_mfma_f32_32x32x16_bf16 v[80:95], v[252:255], v[156:159], v[80:95]
  ds_read_b64_tr_b16 v[244:245], v11 offset:4096
  ds_read_b64_tr_b16 v[246:247], v11 offset:5120
  s_bitset0_b32 s36, s33
  s_lshl_b32 s27, s33, 12
  s_waitcnt vmcnt(11) lgkmcnt(8)
  v_mfma_f32_32x32x16_bf16 v[64:79], v[224:227], v[160:163], v[64:79]
  buffer_load_dwordx4 v[208:211], v8, s[4:7], s27 offen offset:0
  ds_read_b64_tr_b16 v[248:249], v10 offset:6144
  ds_read_b64_tr_b16 v[250:251], v10 offset:7168
  v_mfma_f32_32x32x16_bf16 v[80:95], v[228:231], v[160:163], v[80:95]
  ds_read_b64_tr_b16 v[252:253], v11 offset:6144
  ds_read_b64_tr_b16 v[254:255], v11 offset:7168
  v_lshl_add_u32 v12, s25, 1, v14
  v_lshl_add_u32 v13, s25, 1, v15
  s_waitcnt vmcnt(11) lgkmcnt(8)
  v_mfma_f32_32x32x16_bf16 v[64:79], v[232:235], v[164:167], v[64:79]
  buffer_load_dwordx4 v[212:215], v8, s[4:7], s27 offen offset:1024
  ds_read_b64_tr_b16 v[224:225], v12 offset:0
  ds_read_b64_tr_b16 v[226:227], v12 offset:1024
  v_mfma_f32_32x32x16_bf16 v[80:95], v[236:239], v[164:167], v[80:95]
  ds_read_b64_tr_b16 v[228:229], v13 offset:0
  ds_read_b64_tr_b16 v[230:231], v13 offset:1024
  s_waitcnt vmcnt(11) lgkmcnt(8)
  v_mfma_f32_32x32x16_bf16 v[64:79], v[240:243], v[168:171], v[64:79]
  buffer_load_dwordx4 v[216:219], v8, s[4:7], s27 offen offset:2048
  ds_read_b64_tr_b16 v[232:233], v12 offset:2048
  ds_read_b64_tr_b16 v[234:235], v12 offset:3072
  v_mfma_f32_32x32x16_bf16 v[80:95], v[244:247], v[168:171], v[80:95]
  ds_read_b64_tr_b16 v[236:237], v13 offset:2048
  ds_read_b64_tr_b16 v[238:239], v13 offset:3072
  s_cmp_eq_u32 s36, 0
  s_cbranch_scc1 .fz_kernel_pk58c
.fz_kernel_pk58:
  s_ff1_i32_b32 s33, s36
  s_waitcnt vmcnt(11) lgkmcnt(8)
  v_mfma_f32_32x32x16_bf16 v[64:79], v[248:251], v[172:175], v[64:79]
  buffer_load_dwordx4 v[220:223], v8, s[4:7], s27 offen offset:3072
  ds_read_b64_tr_b16 v[240:241], v12 offset:4096
  ds_read_b64_tr_b16 v[242:243], v12 offset:5120
  v_mfma_f32_32x32x16_bf16 v[80:95], v[252:255], v[172:175], v[80:95]
  ds_read_b64_tr_b16 v[244:245], v13 offset:4096
  ds_read_b64_tr_b16 v[246:247], v13 offset:5120
  s_bitset0_b32 s36, s33
  s_lshl_b32 s20, s33, 12
  s_waitcnt vmcnt(11) lgkmcnt(8)
  v_mfma_f32_32x32x16_bf16 v[64:79], v[224:227], v[176:179], v[64:79]
  buffer_load_dwordx4 v[96:99], v8, s[4:7], s20 offen offset:0
  ds_read_b64_tr_b16 v[248:249], v12 offset:6144
  ds_read_b64_tr_b16 v[250:251], v12 offset:7168
  v_mfma_f32_32x32x16_bf16 v[80:95], v[228:231], v[176:179], v[80:95]
  ds_read_b64_tr_b16 v[252:253], v13 offset:6144
  ds_read_b64_tr_b16 v[254:255], v13 offset:7168
  v_lshl_add_u32 v10, s26, 1, v14
  v_lshl_add_u32 v11, s26, 1, v15
  s_waitcnt vmcnt(11) lgkmcnt(8)
  v_mfma_f32_32x32x16_bf16 v[64:79], v[232:235], v[180:183], v[64:79]
  buffer_load_dwordx4 v[100:103], v8, s[4:7], s20 offen offset:1024
  ds_read_b64_tr_b16 v[224:225], v10 offset:0
  ds_read_b64_tr_b16 v[226:227], v10 offset:1024
  v_mfma_f32_32x32x16_bf16 v[80:95], v[236:239], v[180:183], v[80:95]
  ds_read_b64_tr_b16 v[228:229], v11 offset:0
  ds_read_b64_tr_b16 v[230:231], v11 offset:1024
  s_waitcnt vmcnt(11) lgkmcnt(8)
  v_mfma_f32_32x32x16_bf16 v[64:79], v[240:243], v[184:187], v[64:79]
  buffer_load_dwordx4 v[104:107], v8, s[4:7], s20 offen offset:2048
  ds_read_b64_tr_b16 v[232:233], v10 offset:2048
  ds_read_b64_tr_b16 v[234:235], v10 offset:3072
  v_mfma_f32_32x32x16_bf16 v[80:95], v[244:247], v[184:187], v[80:95]
  ds_read_b64_tr_b16 v[236:237], v11 offset:2048
  ds_read_b64_tr_b16 v[238:239], v11 offset:3072
  s_cmp_eq_u32 s36, 0
  s_cbranch_scc1 .fz_kernel_pk59c
.fz_kernel_pk59:
  s_ff1_i32_b32 s33, s36
  s_waitcnt vmcnt(11) lgkmcnt(8)
  v_mfma_f32_32x32x16_bf16 v[64:79], v[248:251], v[188:191], v[64:79]
  buffer_load_dwordx4 v[108:111], v8, s[4:7], s20 offen offset:3072
  ds_read_b64_tr_b16 v[240:241], v10 offset:4096
  ds_read_b64_tr_b16 v[242:243], v10 offset:5120
  v_mfma_f32_32x32x16_bf16 v[80:95], v[252:255], v[188:191], v[80:95]
  ds_read_b64_tr_b16 v[244:245], v11 offset:4096
  ds_read_b64_tr_b16 v[246:247], v11 offset:5120
  s_bitset0_b32 s36, s33
  s_lshl_b32 s21, s33, 12
  s_waitcnt vmcnt(11) lgkmcnt(8)
  v_mfma_f32_32x32x16_bf16 v[64:79], v[224:227], v[192:195], v[64:79]
  buffer_load_dwordx4 v[112:115], v8, s[4:7], s21 offen offset:0
  ds_read_b64_tr_b16 v[248:249], v10 offset:6144
  ds_read_b64_tr_b16 v[250:251], v10 offset:7168
  v_mfma_f32_32x32x16_bf16 v[80:95], v[228:231], v[192:195], v[80:95]
  ds_read_b64_tr_b16 v[252:253], v11 offset:6144
  ds_read_b64_tr_b16 v[254:255], v11 offset:7168
  v_lshl_add_u32 v12, s27, 1, v14
  v_lshl_add_u32 v13, s27, 1, v15
  s_waitcnt vmcnt(11) lgkmcnt(8)
  v_mfma_f32_32x32x16_bf16 v[64:79], v[232:235], v[196:199], v[64:79]
  buffer_load_dwordx4 v[116:119], v8, s[4:7], s21 offen offset:1024
  ds_read_b64_tr_b16 v[224:225], v12 offset:0
  ds_read_b64_tr_b16 v[226:227], v12 offset:1024
  v_mfma_f32_32x32x16_bf16 v[80:95], v[236:239], v[196:199], v[80:95]
  ds_read_b64_tr_b16 v[228:229], v13 offset:0
  ds_read_b64_tr_b16 v[230:231], v13 offset:1024
  s_waitcnt vmcnt(11) lgkmcnt(8)
  v_mfma_f32_32x32x16_bf16 v[64:79], v[240:243], v[200:203], v[64:79]
  buffer_load_dwordx4 v[120:123], v8, s[4:7], s21 offen offset:2048
  ds_read_b64_tr_b16 v[232:233], v12 offset:2048
  ds_read_b64_tr_b16 v[234:235], v12 offset:3072
  v_mfma_f32_32x32x16_bf16 v[80:95], v[244:247], v[200:203], v[80:95]
  ds_read_b64_tr_b16 v[236:237], v13 offset:2048
  ds_read_b64_tr_b16 v[238:239], v13 offset:3072
  s_cmp_eq_u32 s36, 0
  s_cbranch_scc1 .fz_kernel_pk60c
.fz_kernel_pk60:
  s_ff1_i32_b32 s33, s36
  s_waitcnt vmcnt(11) lgkmcnt(8)
  v_mfma_f32_32x32x16_bf16 v[64:79], v[248:251], v[204:207], v[64:79]
  buffer_load_dwordx4 v[124:127], v8, s[4:7], s21 offen offset:3072
  ds_read_b64_tr_b16 v[240:241], v12 offset:4096
  ds_read_b64_tr_b16 v[242:243], v12 offset:5120
  v_mfma_f32_32x32x16_bf16 v[80:95], v[252:255], v[204:207], v[80:95]
  ds_read_b64_tr_b16 v[244:245], v13 offset:4096
  ds_read_b64_tr_b16 v[246:247], v13 offset:5120
  s_bitset0_b32 s36, s33
  s_lshl_b32 s22, s33, 12
  s_waitcnt vmcnt(11) lgkmcnt(8)
  v_mfma_f32_32x32x16_bf16 v[64:79], v[224:227], v[208:211], v[64:79]
  buffer_load_dwordx4 v[128:131], v8, s[4:7], s22 offen offset:0
  ds_read_b64_tr_b16 v[248:249], v12 offset:6144
  ds_read_b64_tr_b16 v[250:251], v12 offset:7168
  v_mfma_f32_32x32x16_bf16 v[80:95], v[228:231], v[208:211], v[80:95]
  ds_read_b64_tr_b16 v[252:253], v13 offset:6144
  ds_read_b64_tr_b16 v[254:255], v13 offset:7168
  v_lshl_add_u32 v10, s20, 1, v14
  v_lshl_add_u32 v11, s20, 1, v15
  s_waitcnt vmcnt(11) lgkmcnt(8)
  v_mfma_f32_32x32x16_bf16 v[64:79], v[232:235], v[212:215], v[64:79]
  buffer_load_dwordx4 v[132:135], v8, s[4:7], s22 offen offset:1024
  ds_read_b64_tr_b16 v[224:225], v10 offset:0
  ds_read_b64_tr_b16 v[226:227], v10 offset:1024
  v_mfma_f32_32x32x16_bf16 v[80:95], v[236:239], v[212:215], v[80:95]
  ds_read_b64_tr_b16 v[228:229], v11 offset:0
  ds_read_b64_tr_b16 v[230:231], v11 offset:1024
  s_waitcnt vmcnt(11) lgkmcnt(8)
  v_mfma_f32_32x32x16_bf16 v[64:79], v[240:243], v[216:219], v[64:79]
  buffer_load_dwordx4 v[136:139], v8, s[4:7], s22 offen offset:2048
  ds_read_b64_tr_b16 v[232:233], v10 offset:2048
  ds_read_b64_tr_b16 v[234:235], v10 offset:3072
  v_mfma_f32_32x32x16_bf16 v[80:95], v[244:247], v[216:219], v[80:95]
  ds_read_b64_tr_b16 v[236:237], v11 offset:2048
  ds_read_b64_tr_b16 v[238:239], v11 offset:3072
  s_cmp_eq_u32 s36, 0
  s_cbranch_scc1 .fz_kernel_pk61c
.fz_kernel_pk61:
  s_ff1_i32_b32 s33, s36
  s_waitcnt vmcnt(11) lgkmcnt(8)
  v_mfma_f32_32x32x16_bf16 v[64:79], v[248:251], v[220:223], v[64:79]
  buffer_load_dwordx4 v[140:143], v8, s[4:7], s22 offen offset:3072
  ds_read_b64_tr_b16 v[240:241], v10 offset:4096
  ds_read_b64_tr_b16 v[242:243], v10 offset:5120
  v_mfma_f32_32x32x16_bf16 v[80:95], v[252:255], v[220:223], v[80:95]
  ds_read_b64_tr_b16 v[244:245], v11 offset:4096
  ds_read_b64_tr_b16 v[246:247], v11 offset:5120
  s_bitset0_b32 s36, s33
  s_lshl_b32 s23, s33, 12
  s_waitcnt vmcnt(11) lgkmcnt(8)
  v_mfma_f32_32x32x16_bf16 v[64:79], v[224:227], v[96:99], v[64:79]
  buffer_load_dwordx4 v[144:147], v8, s[4:7], s23 offen offset:0
  ds_read_b64_tr_b16 v[248:249], v10 offset:6144
  ds_read_b64_tr_b16 v[250:251], v10 offset:7168
  v_mfma_f32_32x32x16_bf16 v[80:95], v[228:231], v[96:99], v[80:95]
  ds_read_b64_tr_b16 v[252:253], v11 offset:6144
  ds_read_b64_tr_b16 v[254:255], v11 offset:7168
  v_lshl_add_u32 v12, s21, 1, v14
  v_lshl_add_u32 v13, s21, 1, v15
  s_waitcnt vmcnt(11) lgkmcnt(8)
  v_mfma_f32_32x32x16_bf16 v[64:79], v[232:235], v[100:103], v[64:79]
  buffer_load_dwordx4 v[148:151], v8, s[4:7], s23 offen offset:1024
  ds_read_b64_tr_b16 v[224:225], v12 offset:0
  ds_read_b64_tr_b16 v[226:227], v12 offset:1024
  v_mfma_f32_32x32x16_bf16 v[80:95], v[236:239], v[100:103], v[80:95]
  ds_read_b64_tr_b16 v[228:229], v13 offset:0
  ds_read_b64_tr_b16 v[230:231], v13 offset:1024
  s_waitcnt vmcnt(11) lgkmcnt(8)
  v_mfma_f32_32x32x16_bf16 v[64:79], v[240:243], v[104:107], v[64:79]
  buffer_load_dwordx4 v[152:155], v8, s[4:7], s23 offen offset:2048
  ds_read_b64_tr_b16 v[232:233], v12 offset:2048
  ds_read_b64_tr_b16 v[234:235], v12 offset:3072
  v_mfma_f32_32x32x16_bf16 v[80:95], v[244:247], v[104:107], v[80:95]
  ds_read_b64_tr_b16 v[236:237], v13 offset:2048
  ds_read_b64_tr_b16 v[238:239], v13 offset:3072
  s_cmp_eq_u32 s36, 0
  s_cbranch_scc1 .fz_kernel_pk62c
.fz_kernel_pk62:
  s_ff1_i32_b32 s33, s36
  s_waitcnt vmcnt(11) lgkmcnt(8)
  v_mfma_f32_32x32x16_bf16 v[64:79], v[248:251], v[108:111], v[64:79]
  buffer_load_dwordx4 v[156:159], v8, s[4:7], s23 offen offset:3072
  ds_read_b64_tr_b16 v[240:241], v12 offset:4096
  ds_read_b64_tr_b16 v[242:243], v12 offset:5120
  v_mfma_f32_32x32x16_bf16 v[80:95], v[252:255], v[108:111], v[80:95]
  ds_read_b64_tr_b16 v[244:245], v13 offset:4096
  ds_read_b64_tr_b16 v[246:247], v13 offset:5120
  s_bitset0_b32 s36, s33
  s_lshl_b32 s24, s33, 12
  s_waitcnt vmcnt(11) lgkmcnt(8)
  v_mfma_f32_32x32x16_bf16 v[64:79], v[224:227], v[112:115], v[64:79]
  buffer_load_dwordx4 v[160:163], v8, s[4:7], s24 offen offset:0
  ds_read_b64_tr_b16 v[248:249], v12 offset:6144
  ds_read_b64_tr_b16 v[250:251], v12 offset:7168
  v_mfma_f32_32x32x16_bf16 v[80:95], v[228:231], v[112:115], v[80:95]
  ds_read_b64_tr_b16 v[252:253], v13 offset:6144
  ds_read_b64_tr_b16 v[254:255], v13 offset:7168
  v_lshl_add_u32 v10, s22, 1, v14
  v_lshl_add_u32 v11, s22, 1, v15
  s_waitcnt vmcnt(11) lgkmcnt(8)
  v_mfma_f32_32x32x16_bf16 v[64:79], v[232:235], v[116:119], v[64:79]
  buffer_load_dwordx4 v[164:167], v8, s[4:7], s24 offen offset:1024
  ds_read_b64_tr_b16 v[224:225], v10 offset:0
  ds_read_b64_tr_b16 v[226:227], v10 offset:1024
  v_mfma_f32_32x32x16_bf16 v[80:95], v[236:239], v[116:119], v[80:95]
  ds_read_b64_tr_b16 v[228:229], v11 offset:0
  ds_read_b64_tr_b16 v[230:231], v11 offset:1024
  s_waitcnt vmcnt(11) lgkmcnt(8)
  v_mfma_f32_32x32x16_bf16 v[64:79], v[240:243], v[120:123], v[64:79]
  buffer_load_dwordx4 v[168:171], v8, s[4:7], s24 offen offset:2048
  ds_read_b64_tr_b16 v[232:233], v10 offset:2048
  ds_read_b64_tr_b16 v[234:235], v10 offset:3072
  v_mfma_f32_32x32x16_bf16 v[80:95], v[244:247], v[120:123], v[80:95]
  ds_read_b64_tr_b16 v[236:237], v11 offset:2048
  ds_read_b64_tr_b16 v[238:239], v11 offset:3072
  s_cmp_eq_u32 s36, 0
  s_cbranch_scc1 .fz_kernel_pk63c
.fz_kernel_pk63:
  s_ff1_i32_b32 s33, s36
  s_waitcnt vmcnt(11) lgkmcnt(8)
  v_mfma_f32_32x32x16_bf16 v[64:79], v[248:251], v[124:127], v[64:79]
  buffer_load_dwordx4 v[172:175], v8, s[4:7], s24 offen offset:3072
  ds_read_b64_tr_b16 v[240:241], v10 offset:4096
  ds_read_b64_tr_b16 v[242:243], v10 offset:5120
  v_mfma_f32_32x32x16_bf16 v[80:95], v[252:255], v[124:127], v[80:95]
  ds_read_b64_tr_b16 v[244:245], v11 offset:4096
  ds_read_b64_tr_b16 v[246:247], v11 offset:5120
  s_bitset0_b32 s36, s33
  s_lshl_b32 s25, s33, 12
  s_waitcnt vmcnt(11) lgkmcnt(8)
  v_mfma_f32_32x32x16_bf16 v[64:79], v[224:227], v[128:131], v[64:79]
  buffer_load_dwordx4 v[176:179], v8, s[4:7], s25 offen offset:0
  ds_read_b64_tr_b16 v[248:249], v10 offset:6144
  ds_read_b64_tr_b16 v[250:251], v10 offset:7168
  v_mfma_f32_32x32x16_bf16 v[80:95], v[228:231], v[128:131], v[80:95]
  ds_read_b64_tr_b16 v[252:253], v11 offset:6144
  ds_read_b64_tr_b16 v[254:255], v11 offset:7168
  v_lshl_add_u32 v12, s23, 1, v14
  v_lshl_add_u32 v13, s23, 1, v15
  s_waitcnt vmcnt(11) lgkmcnt(8)
  v_mfma_f32_32x32x16_bf16 v[64:79], v[232:235], v[132:135], v[64:79]
  buffer_load_dwordx4 v[180:183], v8, s[4:7], s25 offen offset:1024
  ds_read_b64_tr_b16 v[224:225], v12 offset:0
  ds_read_b64_tr_b16 v[226:227], v12 offset:1024
  v_mfma_f32_32x32x16_bf16 v[80:95], v[236:239], v[132:135], v[80:95]
  ds_read_b64_tr_b16 v[228:229], v13 offset:0
  ds_read_b64_tr_b16 v[230:231], v13 offset:1024
  s_waitcnt vmcnt(11) lgkmcnt(8)
  v_mfma_f32_32x32x16_bf16 v[64:79], v[240:243], v[136:139], v[64:79]
  buffer_load_dwordx4 v[184:187], v8, s[4:7], s25 offen offset:2048
  ds_read_b64_tr_b16 v[232:233], v12 offset:2048
  ds_read_b64_tr_b16 v[234:235], v12 offset:3072
  v_mfma_f32_32x32x16_bf16 v[80:95], v[244:247], v[136:139], v[80:95]
  ds_read_b64_tr_b16 v[236:237], v13 offset:2048
  ds_read_b64_tr_b16 v[238:239], v13 offset:3072
  s_cmp_eq_u32 s36, 0
  s_cbranch_scc1 .fz_kernel_pk64c
.fz_kernel_pk64:
  s_ff1_i32_b32 s33, s36
  s_waitcnt vmcnt(11) lgkmcnt(8)
  v_mfma_f32_32x32x16_bf16 v[64:79], v[248:251], v[140:143], v[64:79]
  buffer_load_dwordx4 v[188:191], v8, s[4:7], s25 offen offset:3072
  ds_read_b64_tr_b16 v[240:241], v12 offset:4096
  ds_read_b64_tr_b16 v[242:243], v12 offset:5120
  v_mfma_f32_32x32x16_bf16 v[80:95], v[252:255], v[140:143], v[80:95]
  ds_read_b64_tr_b16 v[244:245], v13 offset:4096
  ds_read_b64_tr_b16 v[246:247], v13 offset:5120
  s_bitset0_b32 s36, s33
  s_lshl_b32 s26, s33, 12
  s_waitcnt vmcnt(11) lgkmcnt(8)
  v_mfma_f32_32x32x16_bf16 v[64:79], v[224:227], v[144:147], v[64:79]
  buffer_load_dwordx4 v[192:195], v8, s[4:7], s26 offen offset:0
  ds_read_b64_tr_b16 v[248:249], v12 offset:6144
  ds_read_b64_tr_b16 v[250:251], v12 offset:7168
  v_mfma_f32_32x32x16_bf16 v[80:95], v[228:231], v[144:147], v[80:95]
  ds_read_b64_tr_b16 v[252:253], v13 offset:6144
  ds_read_b64_tr_b16 v[254:255], v13 offset:7168
  v_lshl_add_u32 v10, s24, 1, v14
  v_lshl_add_u32 v11, s24, 1, v15
  s_waitcnt vmcnt(11) lgkmcnt(8)
  v_mfma_f32_32x32x16_bf16 v[64:79], v[232:235], v[148:151], v[64:79]
  buffer_load_dwordx4 v[196:199], v8, s[4:7], s26 offen offset:1024
  ds_read_b64_tr_b16 v[224:225], v10 offset:0
  ds_read_b64_tr_b16 v[226:227], v10 offset:1024
  v_mfma_f32_32x32x16_bf16 v[80:95], v[236:239], v[148:151], v[80:95]
  ds_read_b64_tr_b16 v[228:229], v11 offset:0
  ds_read_b64_tr_b16 v[230:231], v11 offset:1024
  s_waitcnt vmcnt(11) lgkmcnt(8)
  v_mfma_f32_32x32x16_bf16 v[64:79], v[240:243], v[152:155], v[64:79]
  buffer_load_dwordx4 v[200:203], v8, s[4:7], s26 offen offset:2048
  ds_read_b64_tr_b16 v[232:233], v10 offset:2048
  ds_read_b64_tr_b16 v[234:235], v10 offset:3072
  v_mfma_f32_32x32x16_bf16 v[80:95], v[244:247], v[152:155], v[80:95]
  ds_read_b64_tr_b16 v[236:237], v11 offset:2048
  ds_read_b64_tr_b16 v[238:239], v11 offset:3072
  s_cmp_eq_u32 s36, 0
  s_cbranch_scc1 .fz_kernel_pk65c
.fz_kernel_pk65:
  s_ff1_i32_b32 s33, s36
  s_waitcnt vmcnt(11) lgkmcnt(8)
  v_mfma_f32_32x32x16_bf16 v[64:79], v[248:251], v[156:159], v[64:79]
  buffer_load_dwordx4 v[204:207], v8, s[4:7], s26 offen offset:3072
  ds_read_b64_tr_b16 v[240:241], v10 offset:4096
  ds_read_b64_tr_b16 v[242:243], v10 offset:5120
  v_mfma_f32_32x32x16_bf16 v[80:95], v[252:255], v[156:159], v[80:95]
  ds_read_b64_tr_b16 v[244:245], v11 offset:4096
  ds_read_b64_tr_b16 v[246:247], v11 offset:5120
  s_bitset0_b32 s36, s33
  s_lshl_b32 s27, s33, 12
  s_waitcnt vmcnt(11) lgkmcnt(8)
  v_mfma_f32_32x32x16_bf16 v[64:79], v[224:227], v[160:163], v[64:79]
  buffer_load_dwordx4 v[208:211], v8, s[4:7], s27 offen offset:0
  ds_read_b64_tr_b16 v[248:249], v10 offset:6144
  ds_read_b64_tr_b16 v[250:251], v10 offset:7168
  v_mfma_f32_32x32x16_bf16 v[80:95], v[228:231], v[160:163], v[80:95]
  ds_read_b64_tr_b16 v[252:253], v11 offset:6144
  ds_read_b64_tr_b16 v[254:255], v11 offset:7168
  v_lshl_add_u32 v12, s25, 1, v14
  v_lshl_add_u32 v13, s25, 1, v15
  s_waitcnt vmcnt(11) lgkmcnt(8)
  v_mfma_f32_32x32x16_bf16 v[64:79], v[232:235], v[164:167], v[64:79]
  buffer_load_dwordx4 v[212:215], v8, s[4:7], s27 offen offset:1024
  ds_read_b64_tr_b16 v[224:225], v12 offset:0
  ds_read_b64_tr_b16 v[226:227], v12 offset:1024
  v_mfma_f32_32x32x16_bf16 v[80:95], v[236:239], v[164:167], v[80:95]
  ds_read_b64_tr_b16 v[228:229], v13 offset:0
  ds_read_b64_tr_b16 v[230:231], v13 offset:1024
  s_waitcnt vmcnt(11) lgkmcnt(8)
  v_mfma_f32_32x32x16_bf16 v[64:79], v[240:243], v[168:171], v[64:79]
  buffer_load_dwordx4 v[216:219], v8, s[4:7], s27 offen offset:2048
  ds_read_b64_tr_b16 v[232:233], v12 offset:2048
  ds_read_b64_tr_b16 v[234:235], v12 offset:3072
  v_mfma_f32_32x32x16_bf16 v[80:95], v[244:247], v[168:171], v[80:95]
  ds_read_b64_tr_b16 v[236:237], v13 offset:2048
  ds_read_b64_tr_b16 v[238:239], v13 offset:3072
  s_waitcnt vmcnt(11) lgkmcnt(8)
  v_mfma_f32_32x32x16_bf16 v[64:79], v[248:251], v[172:175], v[64:79]
  buffer_load_dwordx4 v[220:223], v8, s[4:7], s27 offen offset:3072
  ds_read_b64_tr_b16 v[240:241], v12 offset:4096
  ds_read_b64_tr_b16 v[242:243], v12 offset:5120
  v_mfma_f32_32x32x16_bf16 v[80:95], v[252:255], v[172:175], v[80:95]
  ds_read_b64_tr_b16 v[244:245], v13 offset:4096
  ds_read_b64_tr_b16 v[246:247], v13 offset:5120
  s_waitcnt vmcnt(11) lgkmcnt(8)
  v_mfma_f32_32x32x16_bf16 v[64:79], v[224:227], v[176:179], v[64:79]
  ds_read_b64_tr_b16 v[248:249], v12 offset:6144
  ds_read_b64_tr_b16 v[250:251], v12 offset:7168
  s_mov_b32 s36, 0x3f803f80
  v_mov_b32 v36, 0
  v_mov_b32 v37, 0
  v_mfma_f32_32x32x16_bf16 v[80:95], v[228:231], v[176:179], v[80:95]
  ds_read_b64_tr_b16 v[252:253], v13 offset:6144
  ds_read_b64_tr_b16 v[254:255], v13 offset:7168
  v_lshl_add_u32 v10, s26, 1, v14
  v_lshl_add_u32 v11, s26, 1, v15
  v_mov_b32 v38, 0
  v_mov_b32 v39, 0
  v_mov_b32 v41, 0
  s_waitcnt vmcnt(10) lgkmcnt(8)
  v_mfma_f32_32x32x16_bf16 v[64:79], v[232:235], v[180:183], v[64:79]
  ds_read_b64_tr_b16 v[224:225], v10 offset:0
  ds_read_b64_tr_b16 v[226:227], v10 offset:1024
  v_mov_b32 v43, 0
  v_lshlrev_b32 v19, 2, v18
  v_mfma_f32_32x32x16_bf16 v[80:95], v[236:239], v[180:183], v[80:95]
  ds_read_b64_tr_b16 v[228:229], v11 offset:0
  ds_read_b64_tr_b16 v[230:231], v11 offset:1024
  v_lshl_add_u32 v19, v17, 13, v19
  s_lshl_b32 s34, s32, 7
  s_add_u32 s34, s34, s66
  s_waitcnt vmcnt(9) lgkmcnt(8)
  v_mfma_f32_32x32x16_bf16 v[64:79], v[240:243], v[184:187], v[64:79]
  ds_read_b64_tr_b16 v[232:233], v10 offset:2048
  ds_read_b64_tr_b16 v[234:235], v10 offset:3072
  s_add_u32 s34, s34, 16384
  s_add_u32 s37, s34, 16384
  v_mfma_f32_32x32x16_bf16 v[80:95], v[244:247], v[184:187], v[80:95]
  ds_read_b64_tr_b16 v[236:237], v11 offset:2048
  ds_read_b64_tr_b16 v[238:239], v11 offset:3072
  s_waitcnt vmcnt(8) lgkmcnt(8)
  v_mfma_f32_32x32x16_bf16 v[64:79], v[248:251], v[188:191], v[64:79]
  ds_read_b64_tr_b16 v[240:241], v10 offset:4096
  ds_read_b64_tr_b16 v[242:243], v10 offset:5120
  v_mfma_f32_32x32x16_bf16 v[80:95], v[252:255], v[188:191], v[80:95]
  ds_read_b64_tr_b16 v[244:245], v11 offset:4096
  ds_read_b64_tr_b16 v[246:247], v11 offset:5120
  s_waitcnt vmcnt(7) lgkmcnt(8)
  v_mfma_f32_32x32x16_bf16 v[64:79], v[224:227], v[192:195], v[64:79]
  ds_read_b64_tr_b16 v[248:249], v10 offset:6144
  ds_read_b64_tr_b16 v[250:251], v10 offset:7168
  v_mfma_f32_32x32x16_bf16 v[80:95], v[228:231], v[192:195], v[80:95]
  ds_read_b64_tr_b16 v[252:253], v11 offset:6144
  ds_read_b64_tr_b16 v[254:255], v11 offset:7168
  v_lshl_add_u32 v12, s27, 1, v14
  v_lshl_add_u32 v13, s27, 1, v15
  s_waitcnt vmcnt(6) lgkmcnt(8)
  v_mfma_f32_32x32x16_bf16 v[64:79], v[232:235], v[196:199], v[64:79]
  ds_read_b64_tr_b16 v[224:225], v12 offset:0
  ds_read_b64_tr_b16 v[226:227], v12 offset:1024
  v_mfma_f32_32x32x16_bf16 v[80:95], v[236:239], v[196:199], v[80:95]
  ds_read_b64_tr_b16 v[228:229], v13 offset:0
  ds_read_b64_tr_b16 v[230:231], v13 offset:1024
  s_waitcnt vmcnt(5) lgkmcnt(8)
  v_mfma_f32_32x32x16_bf16 v[64:79], v[240:243], v[200:203], v[64:79]
  ds_read_b64_tr_b16 v[232:233], v12 offset:2048
  ds_read_b64_tr_b16 v[234:235], v12 offset:3072
  v_mfma_f32_32x32x16_bf16 v[80:95], v[244:247], v[200:203], v[80:95]
  ds_read_b64_tr_b16 v[236:237], v13 offset:2048
  ds_read_b64_tr_b16 v[238:239], v13 offset:3072
  s_waitcnt vmcnt(4) lgkmcnt(8)
  v_mfma_f32_32x32x16_bf16 v[64:79], v[248:251], v[204:207], v[64:79]
  ds_read_b64_tr_b16 v[240:241], v12 offset:4096
  ds_read_b64_tr_b16 v[242:243], v12 offset:5120
  v_mfma_f32_32x32x16_bf16 v[80:95], v[252:255], v[204:207], v[80:95]
  ds_read_b64_tr_b16 v[244:245], v13 offset:4096
  ds_read_b64_tr_b16 v[246:247], v13 offset:5120
  s_waitcnt vmcnt(3) lgkmcnt(8)
  v_mfma_f32_32x32x16_bf16 v[64:79], v[224:227], v[208:211], v[64:79]
  ds_read_b64_tr_b16 v[248:249], v12 offset:6144
  ds_read_b64_tr_b16 v[250:251], v12 offset:7168
  v_mfma_f32_32x32x16_bf16 v[80:95], v[228:231], v[208:211], v[80:95]
  ds_read_b64_tr_b16 v[252:253], v13 offset:6144
  ds_read_b64_tr_b16 v[254:255], v13 offset:7168
  s_waitcnt vmcnt(2) lgkmcnt(8)
  v_mfma_f32_32x32x16_bf16 v[64:79], v[232:235], v[212:215], v[64:79]
  v_mfma_f32_32x32x16_bf16 v[80:95], v[236:239], v[212:215], v[80:95]
  s_waitcnt vmcnt(1) lgkmcnt(4)
  v_mfma_f32_32x32x16_bf16 v[64:79], v[240:243], v[216:219], v[64:79]
  v_mfma_f32_32x32x16_bf16 v[80:95], v[244:247], v[216:219], v[80:95]
  s_waitcnt vmcnt(0) lgkmcnt(0)
  v_mfma_f32_32x32x16_bf16 v[64:79], v[248:251], v[220:223], v[64:79]
  v_mfma_f32_32x32x16_bf16 v[80:95], v[252:255], v[220:223], v[80:95]
  s_nop 10
  v_cvt_pk_bf16_f32 v20, v64, v65
  v_cvt_pk_bf16_f32 v21, v66, v67
  v_cvt_pk_bf16_f32 v22, v68, v69
  v_cvt_pk_bf16_f32 v23, v70, v71
  buffer_store_dwordx4 v[20:23], v16, s[4:7], s39 offen offset:0 sc1
  v_cvt_pk_bf16_f32 v24, v72, v73
  v_cvt_pk_bf16_f32 v25, v74, v75
  v_cvt_pk_bf16_f32 v26, v76, v77
  v_cvt_pk_bf16_f32 v27, v78, v79
  buffer_store_dwordx4 v[24:27], v16, s[4:7], s39 offen offset:512 sc1
  v_cvt_pk_bf16_f32 v28, v80, v81
  v_cvt_pk_bf16_f32 v29, v82, v83
  v_cvt_pk_bf16_f32 v30, v84, v85
  v_cvt_pk_bf16_f32 v31, v86, v87
  buffer_store_dwordx4 v[28:31], v16, s[4:7], s39 offen offset:1024 sc1
  v_cvt_pk_bf16_f32 v32, v88, v89
  v_cvt_pk_bf16_f32 v33, v90, v91
  v_cvt_pk_bf16_f32 v34, v92, v93
  v_cvt_pk_bf16_f32 v35, v94, v95
  buffer_store_dwordx4 v[32:35], v16, s[4:7], s39 offen offset:1536 sc1
  v_dot2c_f32_bf16 v36, s36, v20
  v_dot2c_f32_bf16 v37, v20, v20
  v_dot2c_f32_bf16 v38, v20, v48
  v_dot2c_f32_bf16 v39, s36, v21
  v_dot2c_f32_bf16 v41, v21, v21
  v_dot2c_f32_bf16 v43, v21, v49
  v_dot2c_f32_bf16 v36, s36, v22
  v_dot2c_f32_bf16 v37, v22, v22
  v_dot2c_f32_bf16 v38, v22, v50
  v_dot2c_f32_bf16 v39, s36, v23
  v_dot2c_f32_bf16 v41, v23, v23
  v_dot2c_f32_bf16 v43, v23, v51
  v_dot2c_f32_bf16 v36, s36, v24
  v_dot2c_f32_bf16 v37, v24, v24
  v_dot2c_f32_bf16 v38, v24, v52
  v_dot2c_f32_bf16 v39, s36, v25
  v_dot2c_f32_bf16 v41, v25, v25
  v_dot2c_f32_bf16 v43, v25, v53
  v_dot2c_f32_bf16 v36, s36, v26
  v_dot2c_f32_bf16 v37, v26, v26
  v_dot2c_f32_bf16 v38, v26, v54
  v_dot2c_f32_bf16 v39, s36, v27
  v_dot2c_f32_bf16 v41, v27, v27
  v_dot2c_f32_bf16 v43, v27, v55
  v_dot2c_f32_bf16 v36, s36, v28
  v_dot2c_f32_bf16 v37, v28, v28
  v_dot2c_f32_bf16 v38, v28, v56
  v_dot2c_f32_bf16 v39, s36, v29
  v_dot2c_f32_bf16 v41, v29, v29
  v_dot2c_f32_bf16 v43, v29, v57
  v_dot2c_f32_bf16 v36, s36, v30
  v_dot2c_f32_bf16 v37, v30, v30
  v_dot2c_f32_bf16 v38, v30, v58
  v_dot2c_f32_bf16 v39, s36, v31
  v_dot2c_f32_bf16 v41, v31, v31
  v_dot2c_f32_bf16 v43, v31, v59
  v_dot2c_f32_bf16 v36, s36, v32
  v_dot2c_f32_bf16 v37, v32, v32
  v_dot2c_f32_bf16 v38, v32, v60
  v_dot2c_f32_bf16 v39, s36, v33
  v_dot2c_f32_bf16 v41, v33, v33
  v_dot2c_f32_bf16 v43, v33, v61
  v_dot2c_f32_bf16 v36, s36, v34
  v_dot2c_f32_bf16 v37, v34, v34
  v_dot2c_f32_bf16 v38, v34, v62
  v_dot2c_f32_bf16 v39, s36, v35
  v_dot2c_f32_bf16 v41, v35, v35
  v_dot2c_f32_bf16 v43, v35, v63
  s_nop 0
  v_add_f32 v36, v36, v39
  v_add_f32 v37, v37, v41
  v_add_f32 v38, v38, v43
  v_fma_f32 v38, -v36, v46, v38
  v_fmac_f32 v47, 0x44800000, v37
  v_mov_b32 v39, v38
  s_nop 0
  v_permlane32_swap_b32 v36, v47
  v_permlane32_swap_b32 v38, v39
  v_add_f32 v36, v36, v47
  v_add_f32 v38, v38, v39
  buffer_atomic_add_f32 v36, v19, s[4:7], s34 offen sc1
  s_mov_b32 exec_hi, 0
  buffer_atomic_add_f32 v38, v19, s[4:7], s37 offen sc1
  s_mov_b64 exec, -1
  s_barrier
  v_add_u32 v1, 4, v6
  s_mov_b32 s72, s66
  s_mov_b32 s73, s65
  s_mov_b32 s74, s67
  s_mov_b32 s75, s62
  s_cmp_lg_u32 s62, 0
  s_cbranch_scc1 .fz_kernel_tail
  s_mov_b32 s62, 1
  s_mov_b32 s63, 0x2000000
  s_mov_b32 s64, 0x2800000
  s_mov_b32 s65, 0x1400000
  s_mov_b32 s66, 0x1c42000
  s_mov_b32 s67, 12
  s_mov_b32 s71, 159776
  v_mov_b32 v6, 159832
  s_branch .fz_kernel_q_cons2
.fz_kernel_tail:
  s_mov_b32 s28, s56
  s_mov_b32 s29, s57
  s_mov_b32 s30, 0x400000
  s_mov_b32 s31, 0x00020000
  v_lshlrev_b32 v37, 2, v45
  v_add_u32 v37, 155644, v37
  v_mov_b32 v36, 159952
  v_lshlrev_b32 v38, 11, v18
  v_lshl_add_u32 v38, v17, 4, v38
  s_lshl_b32 s32, s32, 16
  s_lshl_b32 s33, s18, 7
  s_add_u32 s32, s32, s33
  v_lshlrev_b32 v64, 16, v20
  v_and_b32 v65, 0xffff0000, v20
  v_lshlrev_b32 v66, 16, v21
  v_and_b32 v67, 0xffff0000, v21
  v_lshlrev_b32 v68, 16, v22
  v_and_b32 v69, 0xffff0000, v22
  v_lshlrev_b32 v70, 16, v23
  v_and_b32 v71, 0xffff0000, v23
  v_lshlrev_b32 v72, 16, v24
  v_and_b32 v73, 0xffff0000, v24
  v_lshlrev_b32 v74, 16, v25
  v_and_b32 v75, 0xffff0000, v25
  v_lshlrev_b32 v76, 16, v26
  v_and_b32 v77, 0xffff0000, v26
  v_lshlrev_b32 v78, 16, v27
  v_and_b32 v79, 0xffff0000, v27
  v_lshlrev_b32 v80, 16, v28
  v_and_b32 v81, 0xffff0000, v28
  v_lshlrev_b32 v82, 16, v29
  v_and_b32 v83, 0xffff0000, v29
  v_lshlrev_b32 v84, 16, v30
  v_and_b32 v85, 0xffff0000, v30
  v_lshlrev_b32 v86, 16, v31
  v_and_b32 v87, 0xffff0000, v31
  v_lshlrev_b32 v88, 16, v32
  v_and_b32 v89, 0xffff0000, v32
  v_lshlrev_b32 v90, 16, v33
  v_and_b32 v91, 0xffff0000, v33
  v_lshlrev_b32 v92, 16, v34
  v_and_b32 v93, 0xffff0000, v34
  v_lshlrev_b32 v94, 16, v35
  v_and_b32 v95, 0xffff0000, v35
  s_mov_b64 exec, 1
  s_waitcnt vmcnt(0)
  ds_add_u32 v1, v5 offset:0x100
  s_mov_b64 exec, -1
  s_barrier
  ds_read_b32 v40, v37 offset:6400
  ds_read_b32 v42, v37 offset:6912
  ds_read_b32 v36, v36
  s_waitcnt lgkmcnt(0)
  v_cmp_ne_u32 vcc, v36, v45
  s_mov_b64 exec, vcc
  v_pk_fma_f32 v[64:65], v[64:65], v[40:41], v[42:43] op_sel_hi:[1,0,0]
  v_pk_fma_f32 v[66:67], v[66:67], v[40:41], v[42:43] op_sel_hi:[1,0,0]
  v_pk_fma_f32 v[68:69], v[68:69], v[40:41], v[42:43] op_sel_hi:[1,0,0]
  v_pk_fma_f32 v[70:71], v[70:71], v[40:41], v[42:43] op_sel_hi:[1,0,0]
  v_cvt_pk_bf16_f32 v20, v64, v65
  v_cvt_pk_bf16_f32 v21, v66, v67
  v_cvt_pk_bf16_f32 v22, v68, v69
  v_cvt_pk_bf16_f32 v23, v70, v71
  buffer_store_dwordx4 v[20:23], v38, s[28:31], s32 offen offset:0
  v_pk_fma_f32 v[72:73], v[72:73], v[40:41], v[42:43] op_sel_hi:[1,0,0]
  v_pk_fma_f32 v[74:75], v[74:75], v[40:41], v[42:43] op_sel_hi:[1,0,0]
  v_pk_fma_f32 v[76:77], v[76:77], v[40:41], v[42:43] op_sel_hi:[1,0,0]
  v_pk_fma_f32 v[78:79], v[78:79], v[40:41], v[42:43] op_sel_hi:[1,0,0]
  v_cvt_pk_bf16_f32 v24, v72, v73
  v_cvt_pk_bf16_f32 v25, v74, v75
  v_cvt_pk_bf16_f32 v26, v76, v77
  v_cvt_pk_bf16_f32 v27, v78, v79
  buffer_store_dwordx4 v[24:27], v38, s[28:31], s32 offen offset:32
  v_pk_fma_f32 v[80:81], v[80:81], v[40:41], v[42:43] op_sel_hi:[1,0,0]
  v_pk_fma_f32 v[82:83], v[82:83], v[40:41], v[42:43] op_sel_hi:[1,0,0]
  v_pk_fma_f32 v[84:85], v[84:85], v[40:41], v[42:43] op_sel_hi:[1,0,0]
  v_pk_fma_f32 v[86:87], v[86:87], v[40:41], v[42:43] op_sel_hi:[1,0,0]
  v_cvt_pk_bf16_f32 v28, v80, v81
  v_cvt_pk_bf16_f32 v29, v82, v83
  v_cvt_pk_bf16_f32 v30, v84, v85
  v_cvt_pk_bf16_f32 v31, v86, v87
  buffer_store_dwordx4 v[28:31], v38, s[28:31], s32 offen offset:64
  v_pk_fma_f32 v[88:89], v[88:89], v[40:41], v[42:43] op_sel_hi:[1,0,0]
  v_pk_fma_f32 v[90:91], v[90:91], v[40:41], v[42:43] op_sel_hi:[1,0,0]
  v_pk_fma_f32 v[92:93], v[92:93], v[40:41], v[42:43] op_sel_hi:[1,0,0]
  v_pk_fma_f32 v[94:95], v[94:95], v[40:41], v[42:43] op_sel_hi:[1,0,0]
  v_cvt_pk_bf16_f32 v32, v88, v89
  v_cvt_pk_bf16_f32 v33, v90, v91
  v_cvt_pk_bf16_f32 v34, v92, v93
  v_cvt_pk_bf16_f32 v35, v94, v95
  buffer_store_dwordx4 v[32:35], v38, s[28:31], s32 offen offset:96
  s_mov_b64 exec, -1
  s_branch .fz_kernel_fin
.fz_kernel_chain:
  s_setprio 0
  s_bitcmp1_b32 s18, 0
  s_cselect_b32 s8, s52, s50
  s_cselect_b32 s9, s53, s51
  s_mov_b32 s10, 0x700000
  s_mov_b32 s11, 0x00020000
  s_lshl_b32 s12, s16, 8
  s_and_b32 s12, s12, 511
  s_and_b32 s31, s18, 2
  s_lshl_b32 s31, s31, 8
  s_add_u32 s12, s12, s31
  s_mul_i32 s12, s12, 7168
  s_lshl_b32 s31, s17, 2
  s_lshr_b32 s33, s18, 2
  s_add_u32 s31, s31, s33
  s_lshl_b32 s31, s31, 7
  s_add_u32 s12, s12, s31
  v_lshrrev_b32 v13, 3, v2
  v_mul_u32_u24 v13, 229376, v13
  v_and_b32 v11, 7, v2
  v_lshl_add_u32 v13, v11, 4, v13
  s_mov_b32 s36, 0x05040100
  s_mov_b32 s37, 0x07060302
  v_lshrrev_b32 v13, 4, v2
  v_bfe_u32 v14, v2, 3, 1
  v_lshl_add_u32 v13, v14, 2, v13
  v_mul_u32_u24 v13, 28672, v13
  v_lshl_add_u32 v13, v11, 4, v13
  s_cmp_ge_u32 s17, 14
  s_cbranch_scc1 .fz_kernel_c_nl
  s_mov_b32 s38, 0
.fz_kernel_kw66:
  s_sleep 2
  ds_read_b32 v7, v6 offset:0
  s_add_u32 s38, s38, 1
  s_waitcnt lgkmcnt(0)
  v_readfirstlane_b32 s31, v7
  s_bcnt1_i32_b32 s31, s31
  s_cmp_ge_u32 s31, 16
  s_cbranch_scc1 .fz_kernel_kw66d
  s_cmp_lt_u32 s38, 1048576
  s_cbranch_scc1 .fz_kernel_kw66
.fz_kernel_kw66d:
  buffer_load_dwordx4 v[144:147], v13, s[8:11], s12 offen nt
  s_add_u32 s12, s12, 7168
  s_waitcnt vmcnt(1)
  buffer_load_dwordx4 v[148:151], v13, s[8:11], s12 offen nt
  s_add_u32 s12, s12, 7168
  s_waitcnt vmcnt(1)
  buffer_load_dwordx4 v[152:155], v13, s[8:11], s12 offen nt
  s_add_u32 s12, s12, 7168
  s_waitcnt vmcnt(1)
  buffer_load_dwordx4 v[156:159], v13, s[8:11], s12 offen nt
  s_add_u32 s12, s12, 207872
  s_waitcnt vmcnt(1)
  buffer_load_dwordx4 v[160:163], v13, s[8:11], s12 offen nt
  s_add_u32 s12, s12, 7168
  s_waitcnt vmcnt(1)
  buffer_load_dwordx4 v[164:167], v13, s[8:11], s12 offen nt
  s_add_u32 s12, s12, 7168
  s_waitcnt vmcnt(1)
  buffer_load_dwordx4 v[168:171], v13, s[8:11], s12 offen nt
  s_add_u32 s12, s12, 7168
  s_waitcnt vmcnt(1)
  buffer_load_dwordx4 v[172:175], v13, s[8:11], s12 offen nt
  s_add_u32 s12, s12, 207872
  s_waitcnt vmcnt(1)
  buffer_load_dwordx4 v[176:179], v13, s[8:11], s12 offen nt
  s_add_u32 s12, s12, 7168
  s_waitcnt vmcnt(1)
  buffer_load_dwordx4 v[180:183], v13, s[8:11], s12 offen nt
  s_add_u32 s12, s12, 7168
  s_waitcnt vmcnt(1)
  buffer_load_dwordx4 v[184:187], v13, s[8:11], s12 offen nt
  s_add_u32 s12, s12, 7168
  s_waitcnt vmcnt(1)
  buffer_load_dwordx4 v[188:191], v13, s[8:11], s12 offen nt
  s_add_u32 s12, s12, 207872
  s_waitcnt vmcnt(1)
  buffer_load_dwordx4 v[192:195], v13, s[8:11], s12 offen nt
  s_add_u32 s12, s12, 7168
  s_waitcnt vmcnt(1)
  buffer_load_dwordx4 v[196:199], v13, s[8:11], s12 offen nt
  s_add_u32 s12, s12, 7168
  s_waitcnt vmcnt(1)
  buffer_load_dwordx4 v[200:203], v13, s[8:11], s12 offen nt
  s_add_u32 s12, s12, 7168
  s_waitcnt vmcnt(1)
  buffer_load_dwordx4 v[204:207], v13, s[8:11], s12 offen nt
  s_add_u32 s12, s12, 207872
  s_waitcnt vmcnt(1)
  buffer_load_dwordx4 v[208:211], v13, s[8:11], s12 offen nt
  s_add_u32 s12, s12, 7168
  s_waitcnt vmcnt(1)
  buffer_load_dwordx4 v[212:215], v13, s[8:11], s12 offen nt
  s_add_u32 s12, s12, 7168
  s_waitcnt vmcnt(1)
  buffer_load_dwordx4 v[216:219], v13, s[8:11], s12 offen nt
  s_add_u32 s12, s12, 7168
  s_waitcnt vmcnt(1)
  buffer_load_dwordx4 v[220:223], v13, s[8:11], s12 offen nt
  s_add_u32 s12, s12, 207872
  s_waitcnt vmcnt(1)
  buffer_load_dwordx4 v[224:227], v13, s[8:11], s12 offen nt
  s_add_u32 s12, s12, 7168
  s_waitcnt vmcnt(1)
  buffer_load_dwordx4 v[228:231], v13, s[8:11], s12 offen nt
  s_add_u32 s12, s12, 7168
  s_waitcnt vmcnt(1)
  buffer_load_dwordx4 v[232:235], v13, s[8:11], s12 offen nt
  s_add_u32 s12, s12, 7168
  s_waitcnt vmcnt(1)
  buffer_load_dwordx4 v[236:239], v13, s[8:11], s12 offen nt
  s_add_u32 s12, s12, 207872
  s_waitcnt vmcnt(1)
  buffer_load_dwordx4 v[240:243], v13, s[8:11], s12 offen nt
  s_add_u32 s12, s12, 7168
  s_waitcnt vmcnt(1)
  buffer_load_dwordx4 v[244:247], v13, s[8:11], s12 offen nt
  s_add_u32 s12, s12, 7168
  s_waitcnt vmcnt(1)
  buffer_load_dwordx4 v[248:251], v13, s[8:11], s12 offen nt
  s_add_u32 s12, s12, 7168
  s_waitcnt vmcnt(1)
  buffer_load_dwordx4 v[252:255], v13, s[8:11], s12 offen nt
  s_add_u32 s12, s12, 207872
  s_waitcnt vmcnt(1)
  buffer_load_dwordx4 v[32:35], v13, s[8:11], s12 offen nt
  s_add_u32 s12, s12, 7168
  s_waitcnt vmcnt(1)
  buffer_load_dwordx4 v[36:39], v13, s[8:11], s12 offen nt
  s_add_u32 s12, s12, 7168
  s_waitcnt vmcnt(1)
  buffer_load_dwordx4 v[40:43], v13, s[8:11], s12 offen nt
  s_add_u32 s12, s12, 7168
  s_waitcnt vmcnt(1)
  buffer_load_dwordx4 v[44:47], v13, s[8:11], s12 offen nt
  s_add_u32 s12, s12, 207872
  s_waitcnt vmcnt(1)
  v_mov_b32 v16, 0x3f803f80
  v_mov_b32 v17, 0x3f803f80
  v_mov_b32 v18, 0x3f803f80
  v_mov_b32 v19, 0x3f803f80
  v_and_b32 v20, 2, v2
  v_mul_u32_u24 v20, 0x5555, v20
  v_add_u32 v20, 0x4444, v20
  s_waitcnt vmcnt(0)
  s_barrier
  v_perm_b32 v80, v148, v144, s36
  v_perm_b32 v88, v148, v144, s37
  v_perm_b32 v96, v149, v145, s36
  v_perm_b32 v104, v149, v145, s37
  v_perm_b32 v112, v150, v146, s36
  v_perm_b32 v120, v150, v146, s37
  v_perm_b32 v128, v151, v147, s36
  v_perm_b32 v136, v151, v147, s37
  v_perm_b32 v81, v164, v160, s36
  v_perm_b32 v89, v164, v160, s37
  v_perm_b32 v97, v165, v161, s36
  v_perm_b32 v105, v165, v161, s37
  v_perm_b32 v113, v166, v162, s36
  v_perm_b32 v121, v166, v162, s37
  v_perm_b32 v129, v167, v163, s36
  v_perm_b32 v137, v167, v163, s37
  v_perm_b32 v82, v156, v152, s36
  v_perm_b32 v90, v156, v152, s37
  v_perm_b32 v98, v157, v153, s36
  v_perm_b32 v106, v157, v153, s37
  v_perm_b32 v114, v158, v154, s36
  v_perm_b32 v122, v158, v154, s37
  v_perm_b32 v130, v159, v155, s36
  v_perm_b32 v138, v159, v155, s37
  v_perm_b32 v83, v172, v168, s36
  v_perm_b32 v91, v172, v168, s37
  v_perm_b32 v99, v173, v169, s36
  v_perm_b32 v107, v173, v169, s37
  v_perm_b32 v115, v174, v170, s36
  v_perm_b32 v123, v174, v170, s37
  v_perm_b32 v131, v175, v171, s36
  v_perm_b32 v139, v175, v171, s37
  v_perm_b32 v84, v180, v176, s36
  v_perm_b32 v92, v180, v176, s37
  v_perm_b32 v100, v181, v177, s36
  v_perm_b32 v108, v181, v177, s37
  v_perm_b32 v116, v182, v178, s36
  v_perm_b32 v124, v182, v178, s37
  v_perm_b32 v132, v183, v179, s36
  v_perm_b32 v140, v183, v179, s37
  v_perm_b32 v85, v196, v192, s36
  v_perm_b32 v93, v196, v192, s37
  v_perm_b32 v101, v197, v193, s36
  v_perm_b32 v109, v197, v193, s37
  v_perm_b32 v117, v198, v194, s36
  v_perm_b32 v125, v198, v194, s37
  v_perm_b32 v133, v199, v195, s36
  v_perm_b32 v141, v199, v195, s37
  v_perm_b32 v86, v188, v184, s36
  v_perm_b32 v94, v188, v184, s37
  v_perm_b32 v102, v189, v185, s36
  v_perm_b32 v110, v189, v185, s37
  v_perm_b32 v118, v190, v186, s36
  v_perm_b32 v126, v190, v186, s37
  v_perm_b32 v134, v191, v187, s36
  v_perm_b32 v142, v191, v187, s37
  v_perm_b32 v87, v204, v200, s36
  v_perm_b32 v95, v204, v200, s37
  v_perm_b32 v103, v205, v201, s36
  v_perm_b32 v111, v205, v201, s37
  v_perm_b32 v119, v206, v202, s36
  v_perm_b32 v127, v206, v202, s37
  v_perm_b32 v135, v207, v203, s36
  v_perm_b32 v143, v207, v203, s37
  v_perm_b32 v144, v212, v208, s36
  v_perm_b32 v152, v212, v208, s37
  v_perm_b32 v160, v213, v209, s36
  v_perm_b32 v168, v213, v209, s37
  v_perm_b32 v176, v214, v210, s36
  v_perm_b32 v184, v214, v210, s37
  v_perm_b32 v192, v215, v211, s36
  v_perm_b32 v200, v215, v211, s37
  v_perm_b32 v145, v228, v224, s36
  v_perm_b32 v153, v228, v224, s37
  v_perm_b32 v161, v229, v225, s36
  v_perm_b32 v169, v229, v225, s37
  v_perm_b32 v177, v230, v226, s36
  v_perm_b32 v185, v230, v226, s37
  v_perm_b32 v193, v231, v227, s36
  v_perm_b32 v201, v231, v227, s37
  v_perm_b32 v146, v220, v216, s36
  v_perm_b32 v154, v220, v216, s37
  v_perm_b32 v162, v221, v217, s36
  v_perm_b32 v170, v221, v217, s37
  v_perm_b32 v178, v222, v218, s36
  v_perm_b32 v186, v222, v218, s37
  v_perm_b32 v194, v223, v219, s36
  v_perm_b32 v202, v223, v219, s37
  v_perm_b32 v147, v236, v232, s36
  v_perm_b32 v155, v236, v232, s37
  v_perm_b32 v163, v237, v233, s36
  v_perm_b32 v171, v237, v233, s37
  v_perm_b32 v179, v238, v234, s36
  v_perm_b32 v187, v238, v234, s37
  v_perm_b32 v195, v239, v235, s36
  v_perm_b32 v203, v239, v235, s37
  v_perm_b32 v148, v244, v240, s36
  v_perm_b32 v156, v244, v240, s37
  v_perm_b32 v164, v245, v241, s36
  v_perm_b32 v172, v245, v241, s37
  v_perm_b32 v180, v246, v242, s36
  v_perm_b32 v188, v246, v242, s37
  v_perm_b32 v196, v247, v243, s36
  v_perm_b32 v204, v247, v243, s37
  v_perm_b32 v149, v36, v32, s36
  v_perm_b32 v157, v36, v32, s37
  v_perm_b32 v165, v37, v33, s36
  v_perm_b32 v173, v37, v33, s37
  v_perm_b32 v181, v38, v34, s36
  v_perm_b32 v189, v38, v34, s37
  v_perm_b32 v197, v39, v35, s36
  v_perm_b32 v205, v39, v35, s37
  v_perm_b32 v150, v252, v248, s36
  v_perm_b32 v158, v252, v248, s37
  v_perm_b32 v166, v253, v249, s36
  v_perm_b32 v174, v253, v249, s37
  v_perm_b32 v182, v254, v250, s36
  v_perm_b32 v190, v254, v250, s37
  v_perm_b32 v198, v255, v251, s36
  v_perm_b32 v206, v255, v251, s37
  v_perm_b32 v151, v44, v40, s36
  v_perm_b32 v159, v44, v40, s37
  v_perm_b32 v167, v45, v41, s36
  v_perm_b32 v175, v45, v41, s37
  v_perm_b32 v183, v46, v42, s36
  v_perm_b32 v191, v46, v42, s37
  v_perm_b32 v199, v47, v43, s36
  v_perm_b32 v207, v47, v43, s37
  v_mov_b32 v208, 0
  v_mov_b32 v209, 0
  v_mov_b32 v210, 0
  v_mov_b32 v211, 0
  v_mov_b32 v212, 0
  v_mov_b32 v213, 0
  v_mov_b32 v214, 0
  v_mov_b32 v215, 0
  v_mov_b32 v216, 0
  v_mov_b32 v217, 0
  v_mov_b32 v218, 0
  v_mov_b32 v219, 0
  v_mov_b32 v220, 0
  v_mov_b32 v221, 0
  v_mov_b32 v222, 0
  v_mov_b32 v223, 0
  v_mov_b32 v224, 0
  v_mov_b32 v225, 0
  v_mov_b32 v226, 0
  v_mov_b32 v227, 0
  v_mov_b32 v228, 0
  v_mov_b32 v229, 0
  v_mov_b32 v230, 0
  v_mov_b32 v231, 0
  v_mov_b32 v232, 0
  v_mov_b32 v233, 0
  v_mov_b32 v234, 0
  v_mov_b32 v235, 0
  v_mov_b32 v236, 0
  v_mov_b32 v237, 0
  v_mov_b32 v238, 0
  v_mov_b32 v239, 0
  v_smfmac_f32_16x16x64_bf16 v[208:211], v[16:19], v[80:87], v20
  v_smfmac_f32_16x16x64_bf16 v[212:215], v[16:19], v[88:95], v20
  v_smfmac_f32_16x16x64_bf16 v[216:219], v[16:19], v[96:103], v20
  v_smfmac_f32_16x16x64_bf16 v[220:223], v[16:19], v[104:111], v20
  v_smfmac_f32_16x16x64_bf16 v[224:227], v[16:19], v[112:119], v20
  v_smfmac_f32_16x16x64_bf16 v[228:231], v[16:19], v[120:127], v20
  v_smfmac_f32_16x16x64_bf16 v[232:235], v[16:19], v[128:135], v20
  v_smfmac_f32_16x16x64_bf16 v[236:239], v[16:19], v[136:143], v20
  v_smfmac_f32_16x16x64_bf16 v[208:211], v[16:19], v[144:151], v20
  v_smfmac_f32_16x16x64_bf16 v[212:215], v[16:19], v[152:159], v20
  v_smfmac_f32_16x16x64_bf16 v[216:219], v[16:19], v[160:167], v20
  v_smfmac_f32_16x16x64_bf16 v[220:223], v[16:19], v[168:175], v20
  v_smfmac_f32_16x16x64_bf16 v[224:227], v[16:19], v[176:183], v20
  v_smfmac_f32_16x16x64_bf16 v[228:231], v[16:19], v[184:191], v20
  v_smfmac_f32_16x16x64_bf16 v[232:235], v[16:19], v[192:199], v20
  v_smfmac_f32_16x16x64_bf16 v[236:239], v[16:19], v[200:207], v20
  s_nop 4
  v_add_f32 v208, v208, v210
  v_add_f32 v209, v209, v211
  v_add_f32 v212, v212, v214
  v_add_f32 v213, v213, v215
  v_add_f32 v216, v216, v218
  v_add_f32 v217, v217, v219
  v_add_f32 v220, v220, v222
  v_add_f32 v221, v221, v223
  v_add_f32 v224, v224, v226
  v_add_f32 v225, v225, v227
  v_add_f32 v228, v228, v230
  v_add_f32 v229, v229, v231
  v_add_f32 v232, v232, v234
  v_add_f32 v233, v233, v235
  v_add_f32 v236, v236, v238
  v_add_f32 v237, v237, v239
  v_add_f32 v28, v209, v208 row_ror:8 row_mask:0xf bank_mask:0x3
  v_add_f32 v29, v213, v212 row_ror:8 row_mask:0xf bank_mask:0x3
  v_add_f32 v30, v217, v216 row_ror:8 row_mask:0xf bank_mask:0x3
  v_add_f32 v31, v221, v220 row_ror:8 row_mask:0xf bank_mask:0x3
  v_add_f32 v28, v224, v225 row_ror:8 row_mask:0xf bank_mask:0xc
  v_add_f32 v29, v228, v229 row_ror:8 row_mask:0xf bank_mask:0xc
  v_add_f32 v30, v232, v233 row_ror:8 row_mask:0xf bank_mask:0xc
  v_add_f32 v31, v236, v237 row_ror:8 row_mask:0xf bank_mask:0xc
  v_mul_f32 v28, 0.0009765625, v28
  v_mul_f32 v29, 0.0009765625, v29
  v_mul_f32 v30, 0.0009765625, v30
  v_mul_f32 v31, 0.0009765625, v31
.fz_kernel_c_np:
  v_mov_b32 v27, v6
  s_mov_b32 s72, s66
  s_mov_b32 s73, s65
  s_mov_b32 s74, s67
  s_mov_b32 s75, s62
  s_cmp_lg_u32 s62, 0
  s_cbranch_scc1 .fz_kernel_c_n2
  s_mov_b32 s62, 1
  s_mov_b32 s63, 0x2000000
  s_mov_b32 s64, 0x2800000
  s_mov_b32 s65, 0x1400000
  s_mov_b32 s66, 0x1c42000
  s_mov_b32 s67, 12
  s_mov_b32 s71, 159776
  v_mov_b32 v6, 159832
.fz_kernel_c_n2:
  s_lshr_b32 s21, s17, 3
  s_add_u32 s70, s18, s21
  s_lshl1_add_u32 s70, s17, s70
  s_and_b32 s70, s70, 15
  s_cmp_eq_u32 s75, 0
  s_cselect_b32 s3, 32, 0
  s_cselect_b32 s70, s70, s18
  s_and_b32 s20, s16, 1
  s_mov_b32 s34, 0x000f000f
  s_mov_b32 s35, 0x000f000f
  s_mov_b32 s71, 0
  s_lshl1_add_u32 s26, s17, s20
  v_lshrrev_b32 v8, 4, v2
  v_lshrrev_b32 v12, 5, v2
  v_lshlrev_b32 v12, 10, v12
  v_bfe_u32 v14, v2, 3, 2
  v_lshl_add_u32 v12, v14, 8, v12
  v_and_b32 v14, 7, v2
  v_lshl_add_u32 v12, v14, 1, v12
  v_lshlrev_b32 v19, 7, v2
  s_lshl_b32 s25, s20, 1
  v_lshrrev_b32 v14, 4, v2
  v_bfe_u32 v15, v2, 2, 2
  v_lshl_add_u32 v16, v14, 3, v15
  v_lshlrev_b32 v16, 7, v16
  v_and_b32 v14, 1, v14
  v_lshrrev_b32 v15, 1, v15
  v_lshl_add_u32 v14, v14, 1, v15
  v_xor_b32 v14, s25, v14
  v_lshl_add_u32 v16, v14, 5, v16
  v_and_b32 v14, 3, v2
  v_lshl_add_u32 v16, v14, 3, v16
  v_add_u32 v7, 65536, v16
  v_xor_b32 v9, 32, v7
  s_and_b32 s61, s18, 2
  s_add_u32 s61, s61, s20
  s_and_b32 s32, s18, 1
  s_lshl2_add_u32 s32, s32, s61
  s_lshl_b32 s32, s32, 9
  s_lshl_b32 s22, s17, 13
  s_add_u32 s32, s32, s22
  s_and_b32 s22, s18, 8
  s_lshl_b32 s22, s22, 9
  s_add_u32 s32, s32, s22
  s_and_b32 s22, s18, 4
  s_lshl_b32 s22, s22, 6
  s_add_u32 s32, s32, s22
  s_add_u32 s32, s32, s72
  s_add_u32 s32, s32, 40960
  s_lshl_b32 s61, s61, 16
  s_lshl_b32 s33, s26, 12
  s_add_u32 s33, s33, s72
  s_add_u32 s33, s33, 40960
  s_mul_i32 s39, s18, 28
  s_add_u32 s39, s39, s26
  s_lshl_b32 s39, s39, 8
  s_add_u32 s39, s39, s72
  s_add_u32 s39, s39, 155648
  s_lshl4_add_u32 s60, s18, s17
  s_lshl_b32 s60, s60, 10
  s_add_u32 s60, s60, 0x1c84000
  s_add_u32 s21, s74, 0x1800008
  s_sub_u32 s22, s72, 32768
  v_mov_b32 v14, s21
  v_mov_b32 v15, s22
  v_cmp_gt_u32 vcc, 16, v2
  s_nop 1
  v_cndmask_b32 v14, v15, v14, vcc
  v_lshl_add_u32 v14, v2, 11, v14
  s_lshl_b32 s25, s17, 7
  s_lshl_b32 s22, 1, s18
  v_mov_b32 v15, s22
  v_lshlrev_b32 v16, 3, v2
  s_and_b32 s21, s2, 7
  s_lshl_b32 s21, s21, 11
  s_lshl_b32 s22, s20, 10
  s_add_u32 s21, s21, s22
  s_add_u32 s21, s21, s72
  s_lshl_b32 s22, s20, 12
  s_add_u32 s22, s22, s72
  s_add_u32 s22, s22, 16384
  s_add_u32 s23, s22, 8192
  s_add_u32 s24, s22, 16384
  v_lshrrev_b32 v17, 1, v8
  v_lshlrev_b32 v17, 13, v17
  v_and_b32 v18, 1, v8
  v_lshl_add_u32 v17, v18, 11, v17
  v_bfe_u32 v18, v2, 3, 1
  v_lshl_add_u32 v17, v18, 10, v17
  v_bfe_u32 v18, v2, 2, 1
  v_lshl_add_u32 v17, v18, 7, v17
  v_and_b32 v18, 3, v2
  v_lshl_add_u32 v17, v18, 3, v17
  s_lshl_b32 s27, s20, 14
  s_add_u32 s27, s27, 114688
  v_add_u32 v17, s27, v17
  v_xor_b32 v18, 64, v17
  v_and_b32 v20, 7, v2
  v_lshlrev_b32 v20, 5, v20
  v_and_b32 v21, 8, v2
  v_lshl_add_u32 v20, v21, 1, v20
  v_and_b32 v21, 31, v2
  v_lshlrev_b32 v21, 4, v21
  v_lshrrev_b32 v22, 5, v2
  v_lshl_add_u32 v21, v22, 11, v21
  v_mov_b32 v23, 0.0009765625
  v_mov_b32 v24, 9.5367431640625e-07
  v_mov_b32 v25, 1e-05
  v_add_u32 v26, 155648, v16
  s_lshl_b32 s14, s17, 9
  s_add_u32 s14, s14, s72
  s_add_u32 s14, s14, 16384
  s_add_u32 s15, s14, 8192
  s_barrier
.fz_kernel_c_n3:
  s_mov_b32 s13, 0xff0000
  s_cmp_eq_u32 s20, 0
  s_cbranch_scc1 .fz_kernel_c_nf
  s_cmp_eq_u32 s75, 0
  s_cselect_b32 exec_lo, 0xffff, s13
  s_mov_b32 exec_hi, 0
  s_mov_b32 s38, 0
.fz_kernel_cw67:
  s_sleep 1
  ds_read_u8 v22, v27 offset:268
  s_add_u32 s38, s38, 1
  s_waitcnt lgkmcnt(0)
  v_cmp_gt_u32 vcc, 4, v22
  s_cbranch_vccz .fz_kernel_cw67d
  s_cmp_lt_u32 s38, 8388608
  s_cbranch_scc1 .fz_kernel_cw67
.fz_kernel_cw67d:
  buffer_atomic_or v15, v14, s[4:7], s25 offen sc1
  s_mov_b64 exec, -1
.fz_kernel_c_nf:
  s_add_u32 s13, s19, s74
  s_mov_b64 exec, 1
  buffer_load_dword v11, v4, s[4:7], s13 offen offset:8 sc1
  s_mov_b64 exec, -1
  v_and_b32 v14, 3, v2
  v_lshlrev_b32 v14, 9, v14
  v_and_b32 v13, 1, v8
  v_lshl_add_u32 v14, v13, 8, v14
  v_lshrrev_b32 v13, 1, v8
  v_lshl_add_u32 v14, v13, 14, v14
  v_add_u32 v14, s61, v14
  v_add_u32 v10, 0x8000, v14
  v_and_b32 v8, 2, v2
  v_mul_u32_u24 v8, 0x5555, v8
  v_add_u32 v8, 0x4444, v8
  s_waitcnt lgkmcnt(0)
  s_cmp_lg_u32 s75, 0
  s_cbranch_scc1 .fz_kernel_c_nw
  v_mov_b32 v13, v9
  s_lshl_b32 s21, s18, 10
  s_add_u32 s21, s21, s72
  s_cmp_lg_u32 s20, 0
  s_cbranch_scc1 .fz_kernel_c_c7
  s_add_u32 s22, s19, s74
  s_add_u32 s23, s14, 16384
  s_mov_b64 exec, 1
  s_mov_b32 s38, 0
  s_branch .fz_kernel_c_c00
.fz_kernel_c_c0:
  s_sleep 6
  buffer_load_dword v11, v4, s[4:7], s22 offen offset:8 sc1
.fz_kernel_c_c00:
  s_add_u32 s38, s38, 1
  s_waitcnt vmcnt(0)
  ds_or_b32 v6, v11 offset:0x114
  v_or_b32 v11, v11, v15
  v_cmp_ne_u32 vcc, 0xffff, v11
  s_cbranch_vccz .fz_kernel_c_c1
  s_cmp_lt_u32 s38, 131072
  s_cbranch_scc1 .fz_kernel_c_c0
.fz_kernel_c_c1:
  s_mov_b32 s38, 0
.fz_kernel_cw68:
  s_sleep 1
  ds_read_u8 v22, v27 offset:268
  s_add_u32 s38, s38, 1
  s_waitcnt lgkmcnt(0)
  v_cmp_gt_u32 vcc, 4, v22
  s_cbranch_vccz .fz_kernel_cw68d
  s_cmp_lt_u32 s38, 8388608
  s_cbranch_scc1 .fz_kernel_cw68
.fz_kernel_cw68d:
  ds_or_b32 v6, v11 offset:0x114
  s_mov_b64 exec, -1
  buffer_load_dwordx2 v[240:241], v16, s[4:7], s14 offen
  buffer_load_dwordx2 v[242:243], v16, s[4:7], s15 offen
  buffer_load_dwordx2 v[244:245], v16, s[4:7], s23 offen
  s_lshl_b32 s23, s17, 6
  s_add_u32 s23, s23, s21
  s_lshl_b32 s24, s17, 18
  s_add_u32 s24, s24, 1
  v_and_b32 v19, 0x38, v2
  v_lshl_add_u32 v19, v19, 8, s24
  v_and_b32 v208, 7, v2
  v_lshl_add_u32 v19, v208, 5, v19
  s_mov_b32 s38, 0
.fz_kernel_cw69:
  s_sleep 1
  ds_read_u8 v22, v6 offset:272
  s_add_u32 s38, s38, 1
  s_waitcnt lgkmcnt(0)
  v_cmp_gt_u32 vcc, 2, v22
  s_cbranch_vccz .fz_kernel_cw69d
  s_cmp_lt_u32 s38, 8388608
  s_cbranch_scc1 .fz_kernel_cw69
.fz_kernel_cw69d:
  ds_read_b64_tr_b16 v[32:33], v7 offset:0
  ds_read_b64_tr_b16 v[34:35], v7 offset:512
  ds_read_b64_tr_b16 v[40:41], v13 offset:0
  ds_read_b64_tr_b16 v[42:43], v13 offset:512
  ds_read_b64_tr_b16 v[48:49], v7 offset:4096
  ds_read_b64_tr_b16 v[50:51], v7 offset:4608
  ds_read_b64_tr_b16 v[56:57], v13 offset:4096
  ds_read_b64_tr_b16 v[58:59], v13 offset:4608
  ds_read_b64_tr_b16 v[64:65], v7 offset:8192
  ds_read_b64_tr_b16 v[66:67], v7 offset:8704
  ds_read_b64_tr_b16 v[72:73], v13 offset:8192
  ds_read_b64_tr_b16 v[74:75], v13 offset:8704
  s_waitcnt lgkmcnt(0)
  ds_read_b64_tr_b16 v[36:37], v7 offset:12288
  ds_read_b64_tr_b16 v[38:39], v7 offset:12800
  ds_read_b64_tr_b16 v[44:45], v13 offset:12288
  ds_read_b64_tr_b16 v[46:47], v13 offset:12800
  ds_read_b64_tr_b16 v[52:53], v7 offset:16384
  ds_read_b64_tr_b16 v[54:55], v7 offset:16896
  ds_read_b64_tr_b16 v[60:61], v13 offset:16384
  ds_read_b64_tr_b16 v[62:63], v13 offset:16896
  ds_read_b64_tr_b16 v[68:69], v7 offset:20480
  ds_read_b64_tr_b16 v[70:71], v7 offset:20992
  ds_read_b64_tr_b16 v[76:77], v13 offset:20480
  ds_read_b64_tr_b16 v[78:79], v13 offset:20992
  s_waitcnt lgkmcnt(0)
  s_waitcnt vmcnt(0)
  v_fma_f32 v208, -v240, v240, v242
  v_fma_f32 v209, -v241, v241, v243
  v_rsq_f32 v208, abs(v208)
  v_rsq_f32 v209, abs(v209)
  v_mul_f32 v208, v208, v244
  v_mul_f32 v209, v209, v245
  v_and_b32 v208, -2, v208
  v_or_b32 v209, 1, v209
  v_cmp_gt_f32 vcc, v209, v208
  v_max_f32 v9, v208, v209
  s_nop 0
  v_cndmask_b32 v210, v240, v241, vcc
  v_max_f32 v7, v9, v9 row_ror:8 row_mask:0xf bank_mask:0xf
  v_cndmask_b32 v211, v242, v243, vcc
  s_nop 0
  v_max_f32 v7, v7, v7 row_ror:4 row_mask:0xf bank_mask:0xf
  s_nop 1
  v_max_f32 v7, v7, v7 row_ror:2 row_mask:0xf bank_mask:0xf
  s_nop 1
  v_max_f32 v7, v7, v7 row_ror:1 row_mask:0xf bank_mask:0xf
  s_nop 1
  v_max_f32 v7, v7, v7 row_bcast:15 row_mask:0xa bank_mask:0xf
  s_nop 1
  v_max_f32 v7, v7, v7 row_bcast:31 row_mask:0xc bank_mask:0xf
  v_and_b32 v209, 1, v9
  v_lshl_add_u32 v209, v209, 4, v19
  v_readlane_b32 s22, v7, 63
  v_mov_b32 v208, v9
  s_nop 0
  v_cmp_eq_u32 vcc, s22, v9
  s_ff1_i32_b64 s22, vcc
  s_lshl_b64 exec, 1, s22
  buffer_store_dwordx4 v[208:211], v4, s[4:7], s23 offen sc1
  s_mov_b64 exec, -1
.fz_kernel_c_c2:
  s_cmp_lg_u32 s20, 0
  s_cbranch_scc1 .fz_kernel_c_c21
  s_call_b64 s[68:69], .fz_kernel_c_coef
  ds_write_b64 v26, v[248:249] offset:4608
  ds_write_b64 v26, v[250:251] offset:5120
  ds_write_b64 v26, v[252:253] offset:6400
  ds_write_b64 v26, v[254:255] offset:6912
.fz_kernel_c_c21:
.fz_kernel_c_c22:
  s_cmp_le_u32 s3, 28
  s_cbranch_scc1 .fz_kernel_c_c3
  s_barrier
  s_sub_u32 s3, s3, 1
  s_branch .fz_kernel_c_c22
.fz_kernel_c_c3:
  v_lshlrev_b32 v22, 6, v2
  s_mov_b64 exec, 0xffff
  s_mov_b32 s38, 0
.fz_kernel_c_c4:
  buffer_load_dwordx4 v[224:227], v22, s[4:7], s21 offen sc1
  s_add_u32 s38, s38, 1
  s_mov_b32 s46, 0
  s_call_b64 s[0:1], .fz_kernel_hw
  s_waitcnt vmcnt(0)
  v_min_u32 v9, v225, v227
  v_max_f32 v7, v224, v224 row_ror:8 row_mask:0xf bank_mask:0xf
  v_cmp_eq_u32 vcc, 0, v9
  s_cbranch_vccz .fz_kernel_c_c5
  s_cmp_lt_u32 s38, 131072
  s_cbranch_scc1 .fz_kernel_c_c4
.fz_kernel_c_c5:
  s_waitcnt lgkmcnt(0)
  v_max_f32 v7, v7, v7 row_ror:4 row_mask:0xf bank_mask:0xf
  s_nop 1
  v_max_f32 v7, v7, v7 row_ror:2 row_mask:0xf bank_mask:0xf
  s_nop 1
  v_max_f32 v7, v7, v7 row_ror:1 row_mask:0xf bank_mask:0xf
  v_cmp_eq_u32 vcc, v7, v224
  s_or_b32 s22, vcc_lo, 0x8000
  s_ff1_i32_b32 s22, s22
  v_readlane_b32 s77, v225, s22
  s_mov_b64 exec, s[34:35]
  s_and_b32 s77, s77, 0x3c38f0
  s_add_u32 s78, s77, s73
  buffer_load_dwordx4 v[208:211], v14, s[4:7], s78 offen
  buffer_load_dwordx4 v[212:215], v10, s[4:7], s78 offen
  s_mov_b64 exec, -1
  s_cmp_eq_u32 s3, 0
  s_cbranch_scc1 .fz_kernel_hb71
  s_barrier
  s_sub_u32 s3, s3, 1
.fz_kernel_hb71:
  v_readlane_b32 s27, v224, s22
  v_readlane_b32 s23, v226, s22
  v_readlane_b32 s24, v227, s22
  s_lshr_b32 s21, s77, 11
  s_and_b32 s22, s21, 7
  s_and_b32 s21, s21, 0x780
  s_lshl4_add_u32 s21, s22, s21
  s_bfe_u32 s77, s77, 0x40004
  s_add_u32 s77, s77, s21
  v_mov_b32 v11, s23
  v_mov_b32 v15, s24
  s_branch .fz_kernel_c_idx
.fz_kernel_c_nw:
  s_mov_b64 exec, 0xff
  s_mov_b32 s38, 0
.fz_kernel_c_gm:
  buffer_load_dword v9, v19, s[4:7], s21 offen sc1
  s_add_u32 s38, s38, 1
  s_waitcnt vmcnt(0)
  v_cmp_ne_u32 vcc, 0xffff, v9
  s_cbranch_vccz .fz_kernel_c_gmd
  s_sleep 10
  s_cmp_lt_u32 s38, 131072
  s_cbranch_scc1 .fz_kernel_c_gm
.fz_kernel_c_gmd:
  s_mov_b64 exec, -1
  buffer_load_dwordx4 v[208:211], v3, s[4:7], s22 offen offset:0
  buffer_load_dwordx4 v[212:215], v3, s[4:7], s23 offen offset:0
  buffer_load_dwordx4 v[216:219], v3, s[4:7], s24 offen offset:0
  buffer_load_dwordx4 v[220:223], v3, s[4:7], s22 offen offset:1024
  buffer_load_dwordx4 v[224:227], v3, s[4:7], s23 offen offset:1024
  buffer_load_dwordx4 v[228:231], v3, s[4:7], s24 offen offset:1024
  buffer_load_dwordx4 v[232:235], v3, s[4:7], s22 offen offset:2048
  buffer_load_dwordx4 v[236:239], v3, s[4:7], s23 offen offset:2048
  buffer_load_dwordx4 v[240:243], v3, s[4:7], s24 offen offset:2048
  buffer_load_dwordx4 v[244:247], v3, s[4:7], s22 offen offset:3072
  buffer_load_dwordx4 v[248:251], v3, s[4:7], s23 offen offset:3072
  buffer_load_dwordx4 v[252:255], v3, s[4:7], s24 offen offset:3072
  s_lshl_b32 s21, s75, 4
  s_add_u32 s21, s21, 159968
  v_mov_b32 v19, s21
  s_lshl_b32 s22, s20, 3
  v_add_u32 v13, s22, v19
  s_waitcnt vmcnt(10)
  v_fma_f32 v212, -v208, v208, v212
  v_fma_f32 v213, -v209, v209, v213
  v_fma_f32 v214, -v210, v210, v214
  v_fma_f32 v215, -v211, v211, v215
  v_rsq_f32 v212, abs(v212)
  v_rsq_f32 v213, abs(v213)
  v_rsq_f32 v214, abs(v214)
  v_rsq_f32 v215, abs(v215)
  s_waitcnt vmcnt(9)
  v_mul_f32 v216, v216, v212
  v_mul_f32 v217, v217, v213
  v_mul_f32 v218, v218, v214
  v_mul_f32 v219, v219, v215
  v_and_or_b32 v216, v216, -16, 0
  v_and_or_b32 v217, v217, -16, 1
  v_and_or_b32 v218, v218, -16, 2
  v_and_or_b32 v219, v219, -16, 3
  v_max3_f32 v9, v216, v217, v218
  v_max_f32 v9, v9, v219
  s_waitcnt vmcnt(7)
  v_fma_f32 v224, -v220, v220, v224
  v_fma_f32 v225, -v221, v221, v225
  v_fma_f32 v226, -v222, v222, v226
  v_fma_f32 v227, -v223, v223, v227
  v_rsq_f32 v224, abs(v224)
  v_rsq_f32 v225, abs(v225)
  v_rsq_f32 v226, abs(v226)
  v_rsq_f32 v227, abs(v227)
  s_waitcnt vmcnt(6)
  v_mul_f32 v228, v228, v224
  v_mul_f32 v229, v229, v225
  v_mul_f32 v230, v230, v226
  v_mul_f32 v231, v231, v227
  v_and_or_b32 v228, v228, -16, 4
  v_and_or_b32 v229, v229, -16, 5
  v_and_or_b32 v230, v230, -16, 6
  v_and_or_b32 v231, v231, -16, 7
  v_max3_f32 v9, v9, v228, v229
  v_max3_f32 v9, v9, v230, v231
  s_waitcnt vmcnt(4)
  v_fma_f32 v236, -v232, v232, v236
  v_fma_f32 v237, -v233, v233, v237
  v_fma_f32 v238, -v234, v234, v238
  v_fma_f32 v239, -v235, v235, v239
  v_rsq_f32 v236, abs(v236)
  v_rsq_f32 v237, abs(v237)
  v_rsq_f32 v238, abs(v238)
  v_rsq_f32 v239, abs(v239)
  s_waitcnt vmcnt(3)
  v_mul_f32 v240, v240, v236
  v_mul_f32 v241, v241, v237
  v_mul_f32 v242, v242, v238
  v_mul_f32 v243, v243, v239
  v_and_or_b32 v240, v240, -16, 8
  v_and_or_b32 v241, v241, -16, 9
  v_and_or_b32 v242, v242, -16, 10
  v_and_or_b32 v243, v243, -16, 11
  v_max3_f32 v9, v9, v240, v241
  v_max3_f32 v9, v9, v242, v243
  s_waitcnt vmcnt(1)
  v_fma_f32 v248, -v244, v244, v248
  v_fma_f32 v249, -v245, v245, v249
  v_fma_f32 v250, -v246, v246, v250
  v_fma_f32 v251, -v247, v247, v251
  v_rsq_f32 v248, abs(v248)
  v_rsq_f32 v249, abs(v249)
  v_rsq_f32 v250, abs(v250)
  v_rsq_f32 v251, abs(v251)
  s_waitcnt vmcnt(0)
  v_mul_f32 v252, v252, v248
  v_mul_f32 v253, v253, v249
  v_mul_f32 v254, v254, v250
  v_mul_f32 v255, v255, v251
  v_and_or_b32 v252, v252, -16, 12
  v_and_or_b32 v253, v253, -16, 13
  v_and_or_b32 v254, v254, -16, 14
  v_and_or_b32 v255, v255, -16, 15
  v_max3_f32 v9, v9, v252, v253
  v_max3_f32 v9, v9, v254, v255
  s_nop 1
  v_max_f32 v7, v9, v9 row_ror:8 row_mask:0xf bank_mask:0xf
  s_nop 1
  v_max_f32 v7, v7, v7 row_ror:4 row_mask:0xf bank_mask:0xf
  s_nop 1
  v_max_f32 v7, v7, v7 row_ror:2 row_mask:0xf bank_mask:0xf
  s_nop 1
  v_max_f32 v7, v7, v7 row_ror:1 row_mask:0xf bank_mask:0xf
  s_nop 1
  v_max_f32 v7, v7, v7 row_bcast:15 row_mask:0xa bank_mask:0xf
  s_nop 1
  v_max_f32 v7, v7, v7 row_bcast:31 row_mask:0xc bank_mask:0xf
  s_nop 0
  v_readlane_b32 s21, v7, 63
  s_nop 1
  v_cmp_eq_u32 vcc, s21, v9
  s_ff1_i32_b64 s22, vcc
  s_lshl_b32 s22, s22, 2
  s_and_b32 s23, s21, 3
  s_add_u32 s22, s22, s23
  s_and_b32 s23, s21, 12
  s_lshl_b32 s23, s23, 6
  s_add_u32 s22, s22, s23
  s_and_b32 s22, s22, 1023
  s_lshl_b32 s23, s20, 10
  s_add_u32 s22, s22, s23
  s_add_u32 s22, s22, 1
  v_mov_b32 v224, s21
  v_mov_b32 v225, s22
  s_mov_b64 exec, 1
  ds_write_b64 v13, v[224:225]
  s_mov_b32 s38, 0
.fz_kernel_cw72:
  s_sleep 1
  ds_read_u8 v22, v6 offset:280
  s_add_u32 s38, s38, 1
  s_waitcnt lgkmcnt(0)
  v_cmp_gt_u32 vcc, 2, v22
  s_cbranch_vccz .fz_kernel_cw72d
  s_cmp_lt_u32 s38, 8388608
  s_cbranch_scc1 .fz_kernel_cw72
.fz_kernel_cw72d:
  s_mov_b32 s38, 0
.fz_kernel_c_am:
  ds_read_b128 v[224:227], v19
  s_add_u32 s38, s38, 1
  s_waitcnt lgkmcnt(0)
  v_min_u32 v9, v225, v227
  v_cmp_eq_u32 vcc, 0, v9
  s_cbranch_vccz .fz_kernel_c_amd
  s_cmp_lt_u32 s38, 524288
  s_cbranch_scc1 .fz_kernel_c_am
.fz_kernel_c_amd:
  v_cmp_gt_f32 vcc, v226, v224
  s_nop 1
  v_cndmask_b32 v225, v225, v227, vcc
  v_cndmask_b32 v224, v224, v226, vcc
  v_readfirstlane_b32 s77, v225
  v_readfirstlane_b32 s27, v224
  s_mov_b64 exec, -1
  s_sub_u32 s21, s77, 1
  s_and_b32 s21, s21, 2047
  s_lshl_b32 s21, s21, 2
  s_add_u32 s21, s21, s72
  s_add_u32 s21, s21, 16384
  s_add_u32 s22, s21, 8192
  buffer_load_dword v11, v4, s[4:7], s21 offen
  buffer_load_dword v15, v4, s[4:7], s22 offen
  s_mov_b64 exec, s[34:35]
  s_sub_u32 s77, s77, 1
  s_and_b32 s77, s77, 2047
  s_lshr_b32 s78, s77, 7
  s_lshl_b32 s78, s78, 18
  s_and_b32 s21, s77, 0x70
  s_lshl_b32 s21, s21, 7
  s_add_u32 s78, s78, s21
  s_and_b32 s21, s77, 15
  s_lshl_b32 s21, s21, 4
  s_add_u32 s78, s78, s21
  s_add_u32 s78, s78, s73
  buffer_load_dwordx4 v[208:211], v14, s[4:7], s78 offen
  buffer_load_dwordx4 v[212:215], v10, s[4:7], s78 offen
  s_mov_b64 exec, -1
.fz_kernel_c_idx:
  s_lshr_b32 s21, s77, 7
  s_and_b32 s79, s77, 127
  s_add_u32 s79, s79, 1
  s_cmp_eq_u32 s21, s17
  s_cselect_b32 s79, s79, 0
  v_mov_b32 v1, -1477.3197218702985
  v_mul_f32 v1, s27, v1
  v_exp_f32 v1, v1
  s_nop 0
  v_add_f32 v1, 1.0, v1
  v_rcp_f32 v1, v1
  s_lshl_b32 s23, s70, 14
  s_add_u32 s23, s23, s78
  v_mov_b32 v224, 0
  v_mov_b32 v225, 0
  v_mov_b32 v226, 0
  v_mov_b32 v227, 0
  v_mov_b32 v228, 0
  v_mov_b32 v229, 0
  v_mov_b32 v230, 0
  v_mov_b32 v231, 0
  v_mov_b32 v232, 0
  v_mov_b32 v233, 0
  v_mov_b32 v234, 0
  v_mov_b32 v235, 0
  v_mov_b32 v236, 0
  v_mov_b32 v237, 0
  v_mov_b32 v238, 0
  s_cmp_eq_u32 s3, 0
  s_cbranch_scc1 .fz_kernel_hb81
  s_barrier
  s_sub_u32 s3, s3, 1
.fz_kernel_hb81:
  v_mov_b32 v239, 0
  v_mov_b32 v240, 0
  v_mov_b32 v241, 0
  v_mov_b32 v242, 0
  v_mov_b32 v243, 0
  v_mov_b32 v244, 0
  v_mov_b32 v245, 0
  v_mov_b32 v246, 0
  v_mov_b32 v247, 0
  v_mov_b32 v248, 0
  v_mov_b32 v249, 0
  v_mov_b32 v250, 0
  v_mov_b32 v251, 0
  v_mov_b32 v252, 0
  v_mov_b32 v253, 0
  v_mov_b32 v254, 0
  v_mov_b32 v255, 0
  s_mov_b32 s46, 0
  s_call_b64 s[0:1], .fz_kernel_hw
  s_waitcnt vmcnt(0)
  s_cmp_ge_u32 s17, 14
  s_cbranch_scc1 .fz_kernel_c_ng
  s_setprio 2
  v_smfmac_f32_16x16x64_bf16 v[224:227], v[208:211], v[80:87], v8
  v_smfmac_f32_16x16x64_bf16 v[228:231], v[208:211], v[88:95], v8
  v_smfmac_f32_16x16x64_bf16 v[232:235], v[208:211], v[96:103], v8
  v_smfmac_f32_16x16x64_bf16 v[236:239], v[208:211], v[104:111], v8
  v_smfmac_f32_16x16x64_bf16 v[240:243], v[208:211], v[112:119], v8
  v_smfmac_f32_16x16x64_bf16 v[244:247], v[208:211], v[120:127], v8
  v_smfmac_f32_16x16x64_bf16 v[248:251], v[208:211], v[128:135], v8
  v_smfmac_f32_16x16x64_bf16 v[252:255], v[208:211], v[136:143], v8
  v_smfmac_f32_16x16x64_bf16 v[224:227], v[212:215], v[144:151], v8
  v_smfmac_f32_16x16x64_bf16 v[228:231], v[212:215], v[152:159], v8
  v_smfmac_f32_16x16x64_bf16 v[232:235], v[212:215], v[160:167], v8
  v_smfmac_f32_16x16x64_bf16 v[236:239], v[212:215], v[168:175], v8
  v_smfmac_f32_16x16x64_bf16 v[240:243], v[212:215], v[176:183], v8
  v_smfmac_f32_16x16x64_bf16 v[244:247], v[212:215], v[184:191], v8
  v_smfmac_f32_16x16x64_bf16 v[248:251], v[212:215], v[192:199], v8
  v_smfmac_f32_16x16x64_bf16 v[252:255], v[212:215], v[200:207], v8
  s_nop 4
  v_add_f32 v224, v224, v226
  v_add_f32 v225, v225, v227
  v_add_f32 v228, v228, v230
  v_add_f32 v229, v229, v231
  v_add_f32 v232, v232, v234
  v_add_f32 v233, v233, v235
  v_add_f32 v236, v236, v238
  v_add_f32 v237, v237, v239
  v_add_f32 v240, v240, v242
  v_add_f32 v241, v241, v243
  v_add_f32 v244, v244, v246
  v_add_f32 v245, v245, v247
  v_add_f32 v248, v248, v250
  v_add_f32 v249, v249, v251
  v_add_f32 v252, v252, v254
  v_add_f32 v253, v253, v255
  v_add_f32 v208, v225, v224 row_ror:8 row_mask:0xf bank_mask:0x3
  v_add_f32 v209, v229, v228 row_ror:8 row_mask:0xf bank_mask:0x3
  v_add_f32 v210, v233, v232 row_ror:8 row_mask:0xf bank_mask:0x3
  v_add_f32 v211, v237, v236 row_ror:8 row_mask:0xf bank_mask:0x3
  v_add_f32 v208, v240, v241 row_ror:8 row_mask:0xf bank_mask:0xc
  v_add_f32 v209, v244, v245 row_ror:8 row_mask:0xf bank_mask:0xc
  v_add_f32 v210, v248, v249 row_ror:8 row_mask:0xf bank_mask:0xc
  v_add_f32 v211, v252, v253 row_ror:8 row_mask:0xf bank_mask:0xc
  v_fma_f32 v208, -v11, v28, v208
  v_fma_f32 v209, -v11, v29, v209
  v_or_b32 v208, 1, v208
  v_fma_f32 v210, -v11, v30, v210
  v_fma_f32 v211, -v11, v31, v211
  v_or_b32 v210, 1, v210
  s_mov_b64 exec, 0xffff
  buffer_store_dwordx4 v[208:211], v20, s[4:7], s32 offen offset:0 sc1
  s_mov_b64 exec, -1
  s_setprio 0
  s_cmp_eq_u32 s3, 0
  s_cbranch_scc1 .fz_kernel_hb73
  s_barrier
  s_sub_u32 s3, s3, 1
.fz_kernel_hb73:
.fz_kernel_c_ng:
  s_cmp_eq_u32 s20, 0
  s_cbranch_scc1 .fz_kernel_c_ng1
  buffer_load_ushort v184, v12, s[4:7], s23 offen
  s_branch .fz_kernel_c_ng2
.fz_kernel_c_ng1:
  s_cmp_eq_u32 s75, 0
  s_cbranch_scc1 .fz_kernel_c_ng2
  buffer_load_dwordx2 v[240:241], v16, s[4:7], s14 offen
  buffer_load_dwordx2 v[242:243], v16, s[4:7], s15 offen
.fz_kernel_c_ng2:
  s_cmp_ge_u32 s17, 14
  s_cbranch_scc1 .fz_kernel_c_g1
  ds_read_b64_tr_b16 v[80:81], v17 offset:0
  ds_read_b64_tr_b16 v[82:83], v17 offset:512
  ds_read_b64_tr_b16 v[88:89], v17 offset:32
  ds_read_b64_tr_b16 v[90:91], v17 offset:544
  ds_read_b64_tr_b16 v[96:97], v18 offset:0
  ds_read_b64_tr_b16 v[98:99], v18 offset:512
  ds_read_b64_tr_b16 v[104:105], v18 offset:32
  ds_read_b64_tr_b16 v[106:107], v18 offset:544
  ds_read_b64_tr_b16 v[84:85], v18 offset:256
  ds_read_b64_tr_b16 v[86:87], v18 offset:768
  ds_read_b64_tr_b16 v[92:93], v18 offset:288
  ds_read_b64_tr_b16 v[94:95], v18 offset:800
  ds_read_b64_tr_b16 v[100:101], v17 offset:256
  s_cmp_eq_u32 s3, 0
  s_cbranch_scc1 .fz_kernel_hb82
  s_barrier
  s_sub_u32 s3, s3, 1
.fz_kernel_hb82:
  ds_read_b64_tr_b16 v[102:103], v17 offset:768
  ds_read_b64_tr_b16 v[108:109], v17 offset:288
  ds_read_b64_tr_b16 v[110:111], v17 offset:800
  s_waitcnt lgkmcnt(4)
  ds_read_b64_tr_b16 v[112:113], v17 offset:4096
  ds_read_b64_tr_b16 v[114:115], v17 offset:4608
  ds_read_b64_tr_b16 v[120:121], v17 offset:4128
  ds_read_b64_tr_b16 v[122:123], v17 offset:4640
  ds_read_b64_tr_b16 v[128:129], v18 offset:4096
  ds_read_b64_tr_b16 v[130:131], v18 offset:4608
  ds_read_b64_tr_b16 v[136:137], v18 offset:4128
  ds_read_b64_tr_b16 v[138:139], v18 offset:4640
  ds_read_b64_tr_b16 v[116:117], v18 offset:4352
  ds_read_b64_tr_b16 v[118:119], v18 offset:4864
  ds_read_b64_tr_b16 v[124:125], v18 offset:4384
  ds_read_b64_tr_b16 v[126:127], v18 offset:4896
  ds_read_b64_tr_b16 v[132:133], v17 offset:4352
  ds_read_b64_tr_b16 v[134:135], v17 offset:4864
  s_cmp_eq_u32 s3, 0
  s_cbranch_scc1 .fz_kernel_hb83
  s_barrier
  s_sub_u32 s3, s3, 1
.fz_kernel_hb83:
  ds_read_b64_tr_b16 v[140:141], v17 offset:4384
  ds_read_b64_tr_b16 v[142:143], v17 offset:4896
.fz_kernel_c_g1:
  v_fma_f32 v15, -v11, v11, v15
  v_rsq_f32 v15, abs(v15)
  s_nop 0
  v_mul_f32 v179, v11, v15
  v_mul_f32 v15, 0x44800000, v15
  v_sub_f32 v179, 0, v179
  v_add_f32 v178, 1.0, v15
  v_mul_f32 v177, -1.4426950408889634, v15
  v_mul_f32 v15, v15, v15
  v_mul_f32 v1, v1, v15
  v_mov_b32 v188, 0
  v_mov_b32 v190, 0
  v_mov_b32 v192, 0
  v_mov_b32 v194, 0
  v_mov_b32 v196, 0
  v_mov_b32 v198, 0
  v_mov_b32 v200, 0
  v_mov_b32 v202, 0
  v_mov_b32 v212, 0
  v_mov_b32 v214, 0
  v_mov_b32 v216, 0
  v_mov_b32 v218, 0
  v_mov_b32 v220, 0
  v_mov_b32 v222, 0
  v_mov_b32 v224, 0
  v_mov_b32 v226, 0
  v_mov_b32 v228, 0
  v_mov_b32 v230, 0
  v_mov_b32 v232, 0
  v_mov_b32 v234, 0
  s_cmp_eq_u32 s75, 0
  s_cbranch_scc1 .fz_kernel_c_d0
  s_waitcnt vmcnt(0)
  s_cmp_lg_u32 s20, 0
  s_cbranch_scc1 .fz_kernel_c_t2
  s_call_b64 s[68:69], .fz_kernel_c_coef
  v_mov_b32 v9, 159952
  v_mov_b32 v7, s79
  ds_write_b64 v26, v[252:253] offset:6400
  ds_write_b64 v26, v[254:255] offset:6912
  ds_write_b32 v9, v7
  s_waitcnt lgkmcnt(0)
.fz_kernel_c_t2:
  s_barrier
.fz_kernel_c_d0:
  s_cmp_ge_u32 s17, 14
  s_cbranch_scc1 .fz_kernel_c_nd
  s_mov_b32 s38, 0
  s_cmp_eq_u32 s3, 0
  s_cbranch_scc1 .fz_kernel_hb75
  s_barrier
  s_sub_u32 s3, s3, 1
.fz_kernel_hb75:
  buffer_load_dwordx4 v[144:147], v21, s[4:7], s33 offen offset:0 sc1
  buffer_load_dwordx4 v[148:151], v21, s[4:7], s33 offen offset:512 sc1
  buffer_load_dwordx4 v[152:155], v21, s[4:7], s33 offen offset:1024 sc1
  buffer_load_dwordx4 v[156:159], v21, s[4:7], s33 offen offset:1536 sc1
.fz_kernel_c_gu:
  s_mov_b32 s46, 0
  s_call_b64 s[0:1], .fz_kernel_hw
  s_waitcnt vmcnt(0)
  v_min3_u32 v9, v144, v146, v148
  v_min3_u32 v9, v9, v150, v152
  v_min3_u32 v9, v9, v154, v156
  v_min_u32 v9, v9, v158
  v_cmp_eq_u32 vcc, 0, v9
  v_add_f32 v160, v144, v148
  v_add_f32 v161, v145, v149
  v_add_f32 v162, v146, v150
  v_add_f32 v163, v147, v151
  s_cbranch_vccnz .fz_kernel_c_gur
.fz_kernel_c_gud:
  v_add_f32 v152, v152, v156
  v_add_f32 v153, v153, v157
  v_add_f32 v154, v154, v158
  v_add_f32 v155, v155, v159
  v_add_f32 v144, v152, v160
  v_add_f32 v145, v153, v161
  v_add_f32 v146, v154, v162
  v_add_f32 v147, v155, v163
  s_nop 0
  v_permlane32_swap_b32 v144, v146
  v_permlane32_swap_b32 v145, v147
  v_mul_f32 v148, v144, v177
  v_mul_f32 v149, v145, v177
  v_exp_f32 v148, v148
  s_cmp_eq_u32 s3, 0
  s_cbranch_scc1 .fz_kernel_hb84
  s_barrier
  s_sub_u32 s3, s3, 1
.fz_kernel_hb84:
  v_exp_f32 v149, v149
  v_mul_f32 v144, v144, v146
  v_add_f32 v148, 1.0, v148
  v_add_f32 v149, 1.0, v149
  v_rcp_f32 v148, v148
  v_rcp_f32 v149, v149
  v_mul_f32 v145, v145, v147
  v_mul_f32 v144, v144, v148
  v_mul_f32 v145, v145, v149
  v_cvt_pk_bf16_f32 v144, v144, v145
  s_waitcnt lgkmcnt(0)
  s_setprio 2
  v_mov_b32 v160, v144
  v_mov_b32 v161, v144 row_ror:15 row_mask:0xf bank_mask:0xf
  v_mov_b32 v162, v144 row_ror:12 row_mask:0xf bank_mask:0xf
  v_mov_b32 v163, v144 row_ror:11 row_mask:0xf bank_mask:0xf
  v_mov_b32 v164, v144 row_ror:8 row_mask:0xf bank_mask:0xf
  v_mov_b32 v165, v144 row_ror:7 row_mask:0xf bank_mask:0xf
  v_mov_b32 v166, v144 row_ror:4 row_mask:0xf bank_mask:0xf
  v_mov_b32 v167, v144 row_ror:3 row_mask:0xf bank_mask:0xf
  v_smfmac_f32_16x16x64_bf16 v[188:191], v[160:163], v[80:87], v8
  v_smfmac_f32_16x16x64_bf16 v[192:195], v[160:163], v[88:95], v8
  v_smfmac_f32_16x16x64_bf16 v[196:199], v[160:163], v[96:103], v8
  v_smfmac_f32_16x16x64_bf16 v[200:203], v[160:163], v[104:111], v8
  v_smfmac_f32_16x16x64_bf16 v[188:191], v[164:167], v[112:119], v8
  v_smfmac_f32_16x16x64_bf16 v[192:195], v[164:167], v[120:127], v8
  v_smfmac_f32_16x16x64_bf16 v[196:199], v[164:167], v[128:135], v8
  v_smfmac_f32_16x16x64_bf16 v[200:203], v[164:167], v[136:143], v8
  s_nop 8
  v_add_f32 v188, v188, v190
  v_add_f32 v189, v192, v194
  v_or_b32 v188, 1, v188
  v_add_f32 v190, v196, v198
  v_add_f32 v191, v200, v202
  v_or_b32 v190, 1, v190
  s_mov_b64 exec, 0xffff
  buffer_store_dwordx4 v[188:191], v3, s[4:7], s39 offen offset:0 sc1
  s_mov_b64 exec, -1
  s_setprio 0
.fz_kernel_c_nd:
  s_cmp_eq_u32 s75, 0
  s_cbranch_scc1 .fz_kernel_c_m0
  s_lshl_b32 s21, s17, 1
  s_add_u32 s21, s21, s20
  s_cmp_lg_u32 s21, 31
  s_cbranch_scc1 .fz_kernel_fin
  s_branch .fz_kernel_c_pp
.fz_kernel_c_m0:
  s_cmp_eq_u32 s79, 0
  s_cselect_b32 s21, 2, 0
  s_add_u32 s3, s3, s21
.fz_kernel_c_pp:
  s_mul_i32 s21, s70, 7168
  s_add_u32 s21, s21, s72
  s_add_u32 s21, s21, 155648
  s_add_u32 s22, s21, 4096
  s_cmp_eq_u32 s3, 0
  s_cbranch_scc1 .fz_kernel_hb76
  s_barrier
  s_sub_u32 s3, s3, 1
.fz_kernel_hb76:
  s_cmp_eq_u32 s3, 0
  s_cbranch_scc1 .fz_kernel_hb77
  s_barrier
  s_sub_u32 s3, s3, 1
.fz_kernel_hb77:
  s_cmp_eq_u32 s3, 0
  s_cbranch_scc1 .fz_kernel_hb78
  s_barrier
  s_sub_u32 s3, s3, 1
.fz_kernel_hb78:
  buffer_load_dwordx4 v[144:147], v3, s[4:7], s21 offen offset:0 sc1
  buffer_load_dwordx4 v[148:151], v3, s[4:7], s21 offen offset:1024 sc1
  buffer_load_dwordx4 v[152:155], v3, s[4:7], s21 offen offset:2048 sc1
  buffer_load_dwordx4 v[156:159], v3, s[4:7], s21 offen offset:3072 sc1
  buffer_load_dwordx4 v[160:163], v3, s[4:7], s22 offen offset:0 sc1
  buffer_load_dwordx4 v[164:167], v3, s[4:7], s22 offen offset:1024 sc1
  buffer_load_dwordx4 v[168:171], v3, s[4:7], s22 offen offset:2048 sc1
  s_mov_b32 s38, 0
.fz_kernel_c_pu:
  s_mov_b32 s46, 0
  s_call_b64 s[0:1], .fz_kernel_hw
  s_waitcnt vmcnt(0)
  v_min3_u32 v9, v144, v146, v148
  v_min3_u32 v9, v9, v150, v152
  v_min3_u32 v9, v9, v154, v156
  v_min3_u32 v9, v9, v158, v160
  v_min3_u32 v9, v9, v162, v164
  v_min3_u32 v9, v9, v166, v168
  v_min_u32 v9, v9, v170
  v_cmp_eq_u32 vcc, 0, v9
  v_add_f32 v236, v144, v148
  v_add_f32 v237, v145, v149
  v_add_f32 v238, v146, v150
  v_add_f32 v239, v147, v151
  s_cbranch_vccnz .fz_kernel_c_pur
.fz_kernel_c_pud:
  v_add_f32 v152, v152, v156
  v_add_f32 v153, v153, v157
  v_add_f32 v154, v154, v158
  v_add_f32 v155, v155, v159
  v_add_f32 v160, v160, v164
  v_add_f32 v161, v161, v165
  v_add_f32 v162, v162, v166
  s_cmp_eq_u32 s3, 0
  s_cbranch_scc1 .fz_kernel_hb85
  s_barrier
  s_sub_u32 s3, s3, 1
.fz_kernel_hb85:
  v_add_f32 v163, v163, v167
  v_add_f32 v236, v236, v168
  v_add_f32 v237, v237, v169
  v_add_f32 v238, v238, v170
  v_add_f32 v239, v239, v171
  v_add_f32 v152, v152, v160
  v_add_f32 v153, v153, v161
  v_add_f32 v154, v154, v162
  v_add_f32 v155, v155, v163
  v_add_f32 v144, v236, v152
  v_add_f32 v146, v238, v154
  v_add_f32 v145, v237, v153
  v_add_f32 v147, v239, v155
  v_permlane32_swap_b32 v144, v146
  s_nop 0
  v_permlane32_swap_b32 v145, v147
  v_add_f32 v144, v144, v146
  v_add_f32 v145, v145, v147
  v_lshlrev_b32 v184, 16, v184
  s_nop 0
  v_permlane16_swap_b32 v144, v145
  v_add_f32 v144, v144, v145
  v_mul_f32 v144, v144, v1
  v_fma_f32 v184, v184, v178, v179
  s_nop 0
  v_mov_b32 v145, v144 quad_perm:[1,0,3,2] row_mask:0xf bank_mask:0xf
  v_cvt_pk_bf16_f32 v144, v144, v145
  s_or_b32 s21, s75, s71
  s_cbranch_scc1 .fz_kernel_c_w7
  s_mul_i32 s21, s20, 384
  s_add_u32 s21, s21, s60
  v_mov_b32 v180, v144
  v_mov_b32 v181, v144 row_ror:12 row_mask:0xf bank_mask:0xf
  v_mov_b32 v182, v144 row_ror:8 row_mask:0xf bank_mask:0xf
  v_mov_b32 v183, v144 row_ror:4 row_mask:0xf bank_mask:0xf
  s_cmp_eq_u32 s3, 0
  s_cbranch_scc1 .fz_kernel_hb80
  s_barrier
  s_sub_u32 s3, s3, 1
.fz_kernel_hb80:
  s_setprio 2
  v_smfmac_f32_16x16x64_bf16 v[212:215], v[180:183], v[32:39], v8
  v_smfmac_f32_16x16x64_bf16 v[216:219], v[180:183], v[40:47], v8
  v_smfmac_f32_16x16x64_bf16 v[220:223], v[180:183], v[48:55], v8
  v_smfmac_f32_16x16x64_bf16 v[224:227], v[180:183], v[56:63], v8
  v_smfmac_f32_16x16x64_bf16 v[228:231], v[180:183], v[64:71], v8
  v_smfmac_f32_16x16x64_bf16 v[232:235], v[180:183], v[72:79], v8
  s_nop 6
  v_add_f32 v212, v212, v214
  v_add_f32 v213, v216, v218
  v_or_b32 v212, 1, v212
  v_add_f32 v214, v220, v222
  v_add_f32 v215, v224, v226
  v_or_b32 v214, 1, v214
  v_add_f32 v216, v228, v230
  v_add_f32 v217, v232, v234
  v_or_b32 v216, 1, v216
  s_mov_b64 exec, 0xffff
  buffer_store_dwordx4 v[212:215], v3, s[4:7], s21 offen offset:0 sc1
  buffer_store_dwordx2 v[216:217], v16, s[4:7], s21 offen offset:256 sc1
  s_mov_b64 exec, -1
  s_setprio 0
  s_cmp_lg_u32 s20, 0
  s_cbranch_scc1 .fz_kernel_c_w7
  s_cmp_eq_u32 s79, 0
  s_cbranch_scc1 .fz_kernel_c_no2
  v_add_u32 v13, 155648, v3
  s_lshl_b32 s21, s18, 14
  s_add_u32 s21, s21, 0x1c84000
  s_add_u32 s22, s21, 4096
  s_add_u32 s23, s21, 8192
  s_add_u32 s24, s21, 12288
  v_rcp_f32 v144, v178
  v_lshlrev_b32 v146, 1, v2
  v_sub_u32 v146, s79, v146
  v_cmp_eq_u32 s[28:29], 1, v146
  v_cmp_eq_u32 s[30:31], 2, v146
  s_nop 0
  v_cndmask_b32 v148, 0, v144, s[28:29]
  v_cndmask_b32 v149, 0, v144, s[30:31]
  v_mov_b32 v9, 159952
  v_mov_b32 v7, s79
  ds_write_b32 v9, v7
  ds_write_b64 v26, v[148:149] offset:512
  s_lshl_b32 s25, s79, 2
  s_add_u32 s25, s25, 155644
  s_cmp_eq_u32 s3, 0
  s_cbranch_scc1 .fz_kernel_hb86
  s_barrier
  s_sub_u32 s3, s3, 1
.fz_kernel_hb86:
  v_mov_b32 v7, s25
  v_mov_b32 v152, 0
  v_mov_b32 v153, 0
  v_mov_b32 v154, 0
  v_mov_b32 v155, 0
  s_bfm_b64 exec, 49, 0
  s_mov_b32 s38, 0
  s_mov_b32 s25, 15
.fz_kernel_c_pw:
  s_cmp_le_u32 s3, 3
  s_cbranch_scc1 .fz_kernel_c_pw1
  s_barrier
  s_sub_u32 s3, s3, 1
  s_branch .fz_kernel_c_pw
.fz_kernel_c_pw1:
  s_setprio 2
.fz_kernel_c_pd:
  s_bitcmp1_b32 s25, 0
  s_cbranch_scc0 .fz_kernel_c_pl0
  buffer_load_dwordx4 v[80:83], v3, s[4:7], s21 offen offset:0 sc1
  buffer_load_dwordx4 v[84:87], v3, s[4:7], s21 offen offset:1024 sc1
  buffer_load_dwordx4 v[88:91], v3, s[4:7], s21 offen offset:2048 sc1
  buffer_load_dwordx4 v[92:95], v3, s[4:7], s21 offen offset:3072 sc1
.fz_kernel_c_pl0:
  s_bitcmp1_b32 s25, 1
  s_cbranch_scc0 .fz_kernel_c_pl1
  buffer_load_dwordx4 v[96:99], v3, s[4:7], s22 offen offset:0 sc1
  buffer_load_dwordx4 v[100:103], v3, s[4:7], s22 offen offset:1024 sc1
  buffer_load_dwordx4 v[104:107], v3, s[4:7], s22 offen offset:2048 sc1
  buffer_load_dwordx4 v[108:111], v3, s[4:7], s22 offen offset:3072 sc1
.fz_kernel_c_pl1:
  s_bitcmp1_b32 s25, 2
  s_cbranch_scc0 .fz_kernel_c_pl2
  buffer_load_dwordx4 v[112:115], v3, s[4:7], s23 offen offset:0 sc1
  buffer_load_dwordx4 v[116:119], v3, s[4:7], s23 offen offset:1024 sc1
  buffer_load_dwordx4 v[120:123], v3, s[4:7], s23 offen offset:2048 sc1
  buffer_load_dwordx4 v[124:127], v3, s[4:7], s23 offen offset:3072 sc1
.fz_kernel_c_pl2:
  s_bitcmp1_b32 s25, 3
  s_cbranch_scc0 .fz_kernel_c_pl3
  buffer_load_dwordx4 v[128:131], v3, s[4:7], s24 offen offset:0 sc1
  buffer_load_dwordx4 v[132:135], v3, s[4:7], s24 offen offset:1024 sc1
  buffer_load_dwordx4 v[136:139], v3, s[4:7], s24 offen offset:2048 sc1
  buffer_load_dwordx4 v[140:143], v3, s[4:7], s24 offen offset:3072 sc1
.fz_kernel_c_pl3:
  s_add_u32 s38, s38, 1
  s_mov_b32 s46, 0
  s_call_b64 s[0:1], .fz_kernel_hw
  s_waitcnt vmcnt(0)
  s_bitcmp1_b32 s25, 0
  s_cbranch_scc0 .fz_kernel_c_pa0
  v_min3_u32 v9, v80, v82, v84
  v_min3_u32 v9, v9, v86, v88
  v_min3_u32 v9, v9, v90, v92
  v_min_u32 v9, v9, v94
  v_cmp_eq_u32 vcc, 0, v9
  v_add_f32 v80, v80, v84
  v_add_f32 v81, v81, v85
  v_add_f32 v82, v82, v86
  v_add_f32 v83, v83, v87
  s_cbranch_vccnz .fz_kernel_c_pa0
  v_add_f32 v88, v88, v92
  v_add_f32 v89, v89, v93
  v_add_f32 v90, v90, v94
  v_add_f32 v91, v91, v95
  v_add_f32 v152, v152, v80
  v_add_f32 v153, v153, v81
  v_add_f32 v154, v154, v82
  v_add_f32 v155, v155, v83
  v_add_f32 v152, v152, v88
  v_add_f32 v153, v153, v89
  v_add_f32 v154, v154, v90
  v_add_f32 v155, v155, v91
  s_bitset0_b32 s25, 0
.fz_kernel_c_pa0:
  s_bitcmp1_b32 s25, 1
  s_cbranch_scc0 .fz_kernel_c_pa1
  v_min3_u32 v9, v96, v98, v100
  v_min3_u32 v9, v9, v102, v104
  v_min3_u32 v9, v9, v106, v108
  v_min_u32 v9, v9, v110
  v_cmp_eq_u32 vcc, 0, v9
  v_add_f32 v96, v96, v100
  v_add_f32 v97, v97, v101
  v_add_f32 v98, v98, v102
  v_add_f32 v99, v99, v103
  s_cbranch_vccnz .fz_kernel_c_pa1
  v_add_f32 v104, v104, v108
  v_add_f32 v105, v105, v109
  v_add_f32 v106, v106, v110
  v_add_f32 v107, v107, v111
  v_add_f32 v152, v152, v96
  v_add_f32 v153, v153, v97
  v_add_f32 v154, v154, v98
  v_add_f32 v155, v155, v99
  v_add_f32 v152, v152, v104
  v_add_f32 v153, v153, v105
  v_add_f32 v154, v154, v106
  v_add_f32 v155, v155, v107
  s_bitset0_b32 s25, 1
.fz_kernel_c_pa1:
  s_bitcmp1_b32 s25, 2
  s_cbranch_scc0 .fz_kernel_c_pa2
  v_min3_u32 v9, v112, v114, v116
  v_min3_u32 v9, v9, v118, v120
  v_min3_u32 v9, v9, v122, v124
  v_min_u32 v9, v9, v126
  v_cmp_eq_u32 vcc, 0, v9
  v_add_f32 v112, v112, v116
  v_add_f32 v113, v113, v117
  v_add_f32 v114, v114, v118
  v_add_f32 v115, v115, v119
  s_cbranch_vccnz .fz_kernel_c_pa2
  v_add_f32 v120, v120, v124
  v_add_f32 v121, v121, v125
  v_add_f32 v122, v122, v126
  v_add_f32 v123, v123, v127
  v_add_f32 v152, v152, v112
  v_add_f32 v153, v153, v113
  v_add_f32 v154, v154, v114
  v_add_f32 v155, v155, v115
  v_add_f32 v152, v152, v120
  v_add_f32 v153, v153, v121
  v_add_f32 v154, v154, v122
  v_add_f32 v155, v155, v123
  s_bitset0_b32 s25, 2
.fz_kernel_c_pa2:
  s_bitcmp1_b32 s25, 3
  s_cbranch_scc0 .fz_kernel_c_pa3
  v_min3_u32 v9, v128, v130, v132
  v_min3_u32 v9, v9, v134, v136
  v_min3_u32 v9, v9, v138, v140
  v_min_u32 v9, v9, v142
  v_cmp_eq_u32 vcc, 0, v9
  v_add_f32 v128, v128, v132
  v_add_f32 v129, v129, v133
  v_add_f32 v130, v130, v134
  v_add_f32 v131, v131, v135
  s_cbranch_vccnz .fz_kernel_c_pa3
  v_add_f32 v136, v136, v140
  v_add_f32 v137, v137, v141
  v_add_f32 v138, v138, v142
  v_add_f32 v139, v139, v143
  v_add_f32 v152, v152, v128
  v_add_f32 v153, v153, v129
  v_add_f32 v154, v154, v130
  v_add_f32 v155, v155, v131
  v_add_f32 v152, v152, v136
  v_add_f32 v153, v153, v137
  v_add_f32 v154, v154, v138
  v_add_f32 v155, v155, v139
  s_bitset0_b32 s25, 3
.fz_kernel_c_pa3:
  s_cmp_eq_u32 s25, 0
  s_cbranch_scc1 .fz_kernel_c_pdd
  s_cmp_lt_u32 s38, 131072
  s_cbranch_scc1 .fz_kernel_c_pd
.fz_kernel_c_pdd:
  s_mov_b32 exec_hi, 0xffff
  ds_write_b128 v13, v[152:155] offset:1536
  s_mov_b64 exec, -1
  v_readlane_b32 s21, v152, 48
  v_readlane_b32 s22, v154, 48
  s_nop 0
  v_mul_f32 v144, s21, v23
  v_fma_f32 v145, s22, v23, v25
  v_fma_f32 v145, -v144, v144, v145
  v_rsq_f32 v145, abs(v145)
  v_sub_f32 v144, v179, v144
  v_mul_f32 v146, v145, v178
  v_mul_f32 v147, v145, v144
  ds_write_b32 v7, v146 offset:4608
  ds_write_b32 v7, v147 offset:5120
  s_waitcnt lgkmcnt(0)
  s_add_u32 s3, s3, 2
  s_setprio 0
.fz_kernel_c_no2:
  s_branch .fz_kernel_q_he
.fz_kernel_c_w7:
  s_setprio 2
  v_lshlrev_b32 v144, 16, v144
  s_cmp_lg_u32 s71, 0
  s_cbranch_scc1 .fz_kernel_c_eu
  v_add_f32 v184, v184, v144
  s_cmp_lg_u32 s75, 0
  s_cbranch_scc1 .fz_kernel_c_t3
  v_mul_f32 v146, v184, v184
  v_lshrrev_b32 v9, 5, v2
  v_lshlrev_b32 v9, 3, v9
  v_permlane32_swap_b32 v184, v146
  v_add_f32 v184, v184, v146
  s_nop 1
  v_add_f32 v184, v184, v184 row_ror:8 row_mask:0xf bank_mask:0xf
  s_nop 1
  v_add_f32 v184, v184, v184 row_ror:4 row_mask:0xf bank_mask:0xf
  s_nop 1
  v_add_f32 v184, v184, v184 row_ror:2 row_mask:0xf bank_mask:0xf
  s_nop 1
  v_add_f32 v184, v184, v184 row_ror:1 row_mask:0xf bank_mask:0xf
  s_nop 1
  v_add_f32 v184, v184, v184 row_bcast:15 row_mask:0xa bank_mask:0xf
  v_or_b32 v184, 1, v184
  s_mov_b32 exec_lo, 0x10000
  s_mov_b32 exec_hi, 0x10000
  buffer_store_dword v184, v9, s[4:7], s60 offen offset:768 sc1
  s_mov_b64 exec, -1
  s_setprio 0
  s_cmp_eq_u32 s79, 0
  s_cbranch_scc1 .fz_kernel_q_he
  s_add_u32 s3, s3, 2
  s_mov_b32 s71, 1
  s_mov_b32 s70, s18
.fz_kernel_c_e0:
  s_cmp_eq_u32 s3, 0
  s_cbranch_scc1 .fz_kernel_c_pp
  s_barrier
  s_sub_u32 s3, s3, 1
  s_branch .fz_kernel_c_e0
.fz_kernel_c_eu:
  v_lshlrev_b32 v9, 2, v2
  v_add_u32 v9, 155648, v9
  ds_write_b32 v9, v144 offset:7424
  s_waitcnt lgkmcnt(0)
  s_branch .fz_kernel_q_he
.fz_kernel_c_t3:
  s_mov_b32 s28, s56
  s_mov_b32 s29, s57
  s_mov_b32 s30, 0x400000
  s_mov_b32 s31, 0x00020000
  v_cvt_pk_bf16_f32 v144, v184, v184
  v_lshlrev_b32 v9, 1, v2
  s_lshl_b32 s21, s77, 11
  s_lshl_b32 s22, s18, 7
  s_add_u32 s21, s21, s22
  buffer_store_short v144, v9, s[28:31], s21 offen
.fz_kernel_fin:
.fz_kernel_end:
  s_endpgm
.fz_kernel_pick:
  s_mov_b32 s38, 0
.fz_kernel_pick_l:
  ds_read_b32 v7, v6
  s_add_u32 s38, s38, 1
  s_waitcnt lgkmcnt(0)
  v_readfirstlane_b32 s33, v7
  s_cmp_lt_u32 s38, 1048576
  s_cselect_b32 s33, s33, 0xffff
  s_andn2_b32 s36, s33, s34
  s_cbranch_scc0 .fz_kernel_pick_l
  s_or_b32 s34, s34, s33
  s_setpc_b64 s[68:69]
.fz_kernel_hw:
  s_mov_b32 s47, 0
.fz_kernel_hwl:
  s_getreg_b32 s100, hwreg(HW_REG_IB_STS)
  s_bfe_u32 s101, s100, 0x20016
  s_and_b32 s100, s100, 15
  s_lshl4_add_u32 s100, s101, s100
  s_cmp_le_u32 s100, s46
  s_cbranch_scc1 .fz_kernel_hwr
  s_sub_u32 s47, s47, 1
  s_cbranch_scc0 .fz_kernel_hwl
  s_cmp_eq_u32 s3, 0
  s_cbranch_scc1 .fz_kernel_hwr
  s_cmp_eq_u32 s3, 32
  s_cbranch_scc1 .fz_kernel_hwp
.fz_kernel_hwb:
  s_barrier
  s_sub_u32 s3, s3, 1
  s_mov_b32 s47, 2
  s_branch .fz_kernel_hwl
.fz_kernel_hwr:
  s_setpc_b64 s[0:1]
  .fz_kernel_hwp:
  ds_read_b32 v27, v6 offset:0x110
  s_mov_b32 s47, 0
  s_waitcnt lgkmcnt(0)
  v_readfirstlane_b32 s100, v27
  s_cmp_ge_u32 s100, 0x200
  s_cbranch_scc1 .fz_kernel_hwb
  s_branch .fz_kernel_hwl
.fz_kernel_q_cons2:
  s_setprio 0
  s_lshr_b32 s26, s16, 1
  s_lshl_b32 s28, s26, 13
  v_add_u32 v8, s28, v3
  v_add_u32 v9, 1024, v8
  v_mov_b32 v232, v20
  v_mov_b32 v233, v21
  v_mov_b32 v234, v22
  v_mov_b32 v235, v23
  v_mov_b32 v236, v24
  v_mov_b32 v237, v25
  v_mov_b32 v238, v26
  v_mov_b32 v239, v27
  v_mov_b32 v240, v28
  v_mov_b32 v241, v29
  v_mov_b32 v242, v30
  v_mov_b32 v243, v31
  v_mov_b32 v244, v32
  v_mov_b32 v245, v33
  v_mov_b32 v246, v34
  v_mov_b32 v247, v35
  s_branch .fz_kernel_q_cs
.fz_kernel_q_patch:
  s_mul_i32 s31, s27, 384
  s_add_u32 s31, s31, 155648
  v_and_b32 v73, 48, v2
  v_lshlrev_b32 v73, 2, v73
  v_add_u32 v73, s31, v73
  v_and_b32 v75, 15, v2
  v_lshlrev_b32 v75, 3, v75
  v_add_u32 v75, s31, v75
  ds_read_b32 v72, v22 offset:512
  ds_read_b32 v74, v22 offset:576
  ds_read_b32 v76, v22 offset:640
  ds_read_b32 v78, v22 offset:704
  ds_read_b128 v[80:83], v73 offset:1536
  ds_read_b128 v[84:87], v73 offset:1552
  ds_read_b128 v[88:91], v73 offset:1568
  ds_read_b128 v[92:95], v73 offset:1584
  s_waitcnt lgkmcnt(0)
  v_fmac_f32 v160, v82, v72
  v_fmac_f32 v161, v86, v72
  v_fmac_f32 v162, v90, v72
  v_fmac_f32 v163, v94, v72
  v_fmac_f32 v164, v82, v74
  v_fmac_f32 v165, v86, v74
  v_fmac_f32 v166, v90, v74
  v_fmac_f32 v167, v94, v74
  v_fmac_f32 v168, v82, v76
  v_fmac_f32 v169, v86, v76
  v_fmac_f32 v170, v90, v76
  v_fmac_f32 v171, v94, v76
  v_fmac_f32 v172, v82, v78
  v_fmac_f32 v173, v86, v78
  v_fmac_f32 v174, v90, v78
  v_fmac_f32 v175, v94, v78
  v_fmac_f32 v176, v83, v72
  v_fmac_f32 v177, v87, v72
  v_fmac_f32 v178, v91, v72
  v_fmac_f32 v179, v95, v72
  v_fmac_f32 v180, v83, v74
  v_fmac_f32 v181, v87, v74
  v_fmac_f32 v182, v91, v74
  v_fmac_f32 v183, v95, v74
  v_fmac_f32 v184, v83, v76
  v_fmac_f32 v185, v87, v76
  v_fmac_f32 v186, v91, v76
  v_fmac_f32 v187, v95, v76
  v_fmac_f32 v188, v83, v78
  v_fmac_f32 v189, v87, v78
  v_fmac_f32 v190, v91, v78
  v_fmac_f32 v191, v95, v78
  v_fmac_f32 v128, v80, v72
  v_fmac_f32 v129, v84, v72
  v_fmac_f32 v130, v88, v72
  v_fmac_f32 v131, v92, v72
  v_fmac_f32 v132, v80, v74
  v_fmac_f32 v133, v84, v74
  v_fmac_f32 v134, v88, v74
  v_fmac_f32 v135, v92, v74
  v_fmac_f32 v136, v80, v76
  v_fmac_f32 v137, v84, v76
  v_fmac_f32 v138, v88, v76
  v_fmac_f32 v139, v92, v76
  v_fmac_f32 v140, v80, v78
  v_fmac_f32 v141, v84, v78
  v_fmac_f32 v142, v88, v78
  v_fmac_f32 v143, v92, v78
  v_fmac_f32 v144, v81, v72
  v_fmac_f32 v145, v85, v72
  v_fmac_f32 v146, v89, v72
  v_fmac_f32 v147, v93, v72
  v_fmac_f32 v148, v81, v74
  v_fmac_f32 v149, v85, v74
  v_fmac_f32 v150, v89, v74
  v_fmac_f32 v151, v93, v74
  v_fmac_f32 v152, v81, v76
  v_fmac_f32 v153, v85, v76
  v_fmac_f32 v154, v89, v76
  v_fmac_f32 v155, v93, v76
  v_fmac_f32 v156, v81, v78
  v_fmac_f32 v157, v85, v78
  v_fmac_f32 v158, v89, v78
  v_fmac_f32 v159, v93, v78
  ds_read_b128 v[80:83], v23 offset:512
  ds_read_b128 v[84:87], v23 offset:576
  ds_read_b128 v[88:91], v23 offset:640
  ds_read_b128 v[92:95], v23 offset:704
  ds_read_b64 v[72:73], v75 offset:1792
  s_waitcnt lgkmcnt(0)
  v_fmac_f32 v192, v80, v72
  v_fmac_f32 v193, v81, v72
  v_fmac_f32 v194, v82, v72
  v_fmac_f32 v195, v83, v72
  v_fmac_f32 v196, v84, v72
  v_fmac_f32 v197, v85, v72
  v_fmac_f32 v198, v86, v72
  v_fmac_f32 v199, v87, v72
  v_fmac_f32 v200, v88, v72
  v_fmac_f32 v201, v89, v72
  v_fmac_f32 v202, v90, v72
  v_fmac_f32 v203, v91, v72
  v_fmac_f32 v204, v92, v72
  v_fmac_f32 v205, v93, v72
  v_fmac_f32 v206, v94, v72
  v_fmac_f32 v207, v95, v72
  v_fmac_f32 v208, v80, v73
  v_fmac_f32 v209, v81, v73
  v_fmac_f32 v210, v82, v73
  v_fmac_f32 v211, v83, v73
  v_fmac_f32 v212, v84, v73
  v_fmac_f32 v213, v85, v73
  v_fmac_f32 v214, v86, v73
  v_fmac_f32 v215, v87, v73
  v_fmac_f32 v216, v88, v73
  v_fmac_f32 v217, v89, v73
  v_fmac_f32 v218, v90, v73
  v_fmac_f32 v219, v91, v73
  v_fmac_f32 v220, v92, v73
  v_fmac_f32 v221, v93, v73
  v_fmac_f32 v222, v94, v73
  v_fmac_f32 v223, v95, v73
  s_branch .fz_kernel_q_pback
.fz_kernel_q_prod2:
  s_setprio 0
  s_mov_b64 s[8:9], s[4:5]
  s_mov_b64 s[10:11], s[6:7]
  s_mov_b64 s[12:13], s[42:43]
  s_lshl_b32 s35, s17, 6
  s_and_b32 s31, s16, 1
  s_add_u32 s35, s35, s31
  s_lshl_b32 s35, s35, 12
  s_add_u32 s35, s35, s73
  s_lshr_b32 s33, s17, 3
  s_add_u32 s29, s18, s33
  s_lshl1_add_u32 s29, s17, s29
  s_and_b32 s29, s29, 15
  s_mov_b32 s22, 16384
  s_mov_b32 s23, 8192
  s_mov_b32 s36, 0
  s_add_u32 s37, s19, s74
  s_add_u32 s37, s37, 8
  v_mov_b32 v40, v3
  v_mov_b32 v41, v3
  v_mov_b32 v42, v3
  v_mov_b32 v43, v3
  s_branch .fz_kernel_q_pc
.fz_kernel_xok1w:
  s_call_b64 s[68:69], .fz_kernel_q_xw
  s_branch .fz_kernel_xok1
.fz_kernel_xok2w:
  s_call_b64 s[68:69], .fz_kernel_q_xw
  s_branch .fz_kernel_xok2
.fz_kernel_q_xw:
  s_mov_b64 exec, 1
  s_mov_b32 s38, 0
.fz_kernel_q_xwl:
  ds_read_b32 v11, v6 offset:0x114
  s_add_u32 s38, s38, 1
  s_waitcnt lgkmcnt(0)
  v_readfirstlane_b32 s36, v11
  s_bitcmp1_b32 s36, s24
  s_cbranch_scc1 .fz_kernel_q_xwd
  s_cmp_lt_u32 s38, 1048576
  s_cbranch_scc1 .fz_kernel_q_xwl
  s_mov_b32 s36, -1
.fz_kernel_q_xwd:
  s_mov_b64 exec, -1
  s_nop 4
  s_setpc_b64 s[68:69]
.fz_kernel_xok3w:
  s_call_b64 s[68:69], .fz_kernel_q_xw
  s_branch .fz_kernel_xok3
.fz_kernel_lz26a:
  v_lshlrev_b32 v16, 3, v2
  buffer_atomic_and_x2 v[12:13], v16, s[4:7], s36 offen offset:0 sc1
  buffer_atomic_and_x2 v[12:13], v16, s[4:7], s36 offen offset:512 sc1
  buffer_atomic_and_x2 v[12:13], v16, s[4:7], s36 offen offset:1024 sc1
  buffer_atomic_and_x2 v[12:13], v16, s[4:7], s36 offen offset:1536 sc1
  buffer_atomic_and_x2 v[12:13], v16, s[4:7], s36 offen offset:2048 sc1
  buffer_atomic_and_x2 v[12:13], v16, s[4:7], s36 offen offset:2560 sc1
  buffer_atomic_and_x2 v[12:13], v16, s[4:7], s36 offen offset:3072 sc1
  buffer_atomic_and_x2 v[12:13], v16, s[4:7], s36 offen offset:3584 sc1
  s_branch .fz_kernel_lz26
.fz_kernel_a_pick:
  s_mov_b32 s38, 0
.fz_kernel_a_pickl:
  ds_read_b32 v7, v6
  s_add_u32 s38, s38, 1
  s_waitcnt lgkmcnt(0)
  v_readfirstlane_b32 s33, v7
  s_cmp_lt_u32 s38, 1048576
  s_cselect_b32 s33, s33, 0xffff
  s_andn2_b32 s36, s33, s34
  s_cbranch_scc0 .fz_kernel_a_pickl
  s_or_b32 s34, s34, s33
  s_ff1_i32_b32 s33, s36
  s_bitset0_b32 s36, s33
  s_lshl_b32 s33, s33, 14
  s_add_u32 s30, s33, s35
  s_setpc_b64 s[68:69]
.fz_kernel_pk33c:
  v_mov_b32 v7, s34
  s_brev_b32 s30, 2
  s_cmp_eq_u32 s34, 0xffff
  ds_write_b32 v6, v7 offset:0x104
  s_cbranch_scc1 .fz_kernel_pk33
  s_call_b64 s[68:69], .fz_kernel_a_pick
  s_branch .fz_kernel_pk33
.fz_kernel_pk34c:
  v_mov_b32 v7, s34
  s_brev_b32 s30, 2
  s_cmp_eq_u32 s34, 0xffff
  ds_write_b32 v6, v7 offset:0x104
  s_cbranch_scc1 .fz_kernel_pk34
  s_call_b64 s[68:69], .fz_kernel_a_pick
  s_branch .fz_kernel_pk34
.fz_kernel_pk35c:
  v_mov_b32 v7, s34
  s_brev_b32 s30, 2
  s_cmp_eq_u32 s34, 0xffff
  ds_write_b32 v6, v7 offset:0x104
  s_cbranch_scc1 .fz_kernel_pk35
  s_call_b64 s[68:69], .fz_kernel_a_pick
  s_branch .fz_kernel_pk35
.fz_kernel_pk38c:
  v_mov_b32 v7, s34
  s_brev_b32 s30, 2
  s_cmp_eq_u32 s34, 0xffff
  ds_write_b32 v6, v7 offset:0x104
  s_cbranch_scc1 .fz_kernel_pk38
  s_call_b64 s[68:69], .fz_kernel_a_pick
  s_branch .fz_kernel_pk38
.fz_kernel_pk39c:
  v_mov_b32 v7, s34
  s_brev_b32 s30, 2
  s_cmp_eq_u32 s34, 0xffff
  ds_write_b32 v6, v7 offset:0x104
  s_cbranch_scc1 .fz_kernel_pk39
  s_call_b64 s[68:69], .fz_kernel_a_pick
  s_branch .fz_kernel_pk39
.fz_kernel_a_slow:
  s_cmp_lg_u32 s73, 0
  s_cbranch_scc1 .fz_kernel_a_ok
  s_mov_b32 s73, 1
  s_and_b32 s39, s16, 1
  v_mov_b32 v16, v32
  v_mov_b32 v17, v33
  v_mov_b32 v18, v34
  v_mov_b32 v19, v35
  v_mov_b32 v20, v36
  v_mov_b32 v21, v37
  v_mov_b32 v22, v38
  v_mov_b32 v23, v39
  s_call_b64 s[68:69], .fz_kernel_a_sl
  v_mov_b32 v176, v144
  v_mov_b32 v177, v145
  v_mov_b32 v178, v146
  v_mov_b32 v179, v147
  v_mov_b32 v180, v148
  v_mov_b32 v181, v149
  v_mov_b32 v182, v150
  v_mov_b32 v183, v151
  v_mov_b32 v184, v152
  v_mov_b32 v185, v153
  v_mov_b32 v186, v154
  v_mov_b32 v187, v155
  v_mov_b32 v188, v156
  v_mov_b32 v189, v157
  v_mov_b32 v190, v158
  v_mov_b32 v191, v159
  v_mov_b32 v24, v25
  v_mov_b32 v16, v40
  v_mov_b32 v17, v41
  v_mov_b32 v18, v42
  v_mov_b32 v19, v43
  v_mov_b32 v20, v44
  v_mov_b32 v21, v45
  v_mov_b32 v22, v46
  v_mov_b32 v23, v47
  s_call_b64 s[68:69], .fz_kernel_a_sl
  v_mov_b32 v192, v144
  v_mov_b32 v193, v145
  v_mov_b32 v194, v146
  v_mov_b32 v195, v147
  v_mov_b32 v196, v148
  v_mov_b32 v197, v149
  v_mov_b32 v198, v150
  v_mov_b32 v199, v151
  v_mov_b32 v200, v152
  v_mov_b32 v201, v153
  v_mov_b32 v202, v154
  v_mov_b32 v203, v155
  v_mov_b32 v204, v156
  v_mov_b32 v205, v157
  v_mov_b32 v206, v158
  v_mov_b32 v207, v159
  v_rcp_f32 v26, v24
  v_cmp_le_f32 vcc, s24, v24
  s_and_b64 s[36:37], s[36:37], vcc
  v_cmp_ge_f32 vcc, s25, v24
  s_and_b64 s[36:37], s[36:37], vcc
  v_pk_mul_f32 v[176:177], v[176:177], v[26:27] op_sel_hi:[1,0]
  v_pk_mul_f32 v[178:179], v[178:179], v[26:27] op_sel_hi:[1,0]
  v_pk_mul_f32 v[180:181], v[180:181], v[26:27] op_sel_hi:[1,0]
  v_pk_mul_f32 v[182:183], v[182:183], v[26:27] op_sel_hi:[1,0]
  v_cvt_pk_bf16_f32 v80, v176, v177
  v_cvt_pk_bf16_f32 v81, v178, v179
  v_cvt_pk_bf16_f32 v82, v180, v181
  v_cvt_pk_bf16_f32 v83, v182, v183
  buffer_store_dwordx4 v[80:83], v3, s[4:7], s8 offen offset:0 sc1
  v_pk_mul_f32 v[184:185], v[184:185], v[26:27] op_sel_hi:[1,0]
  v_pk_mul_f32 v[186:187], v[186:187], v[26:27] op_sel_hi:[1,0]
  v_pk_mul_f32 v[188:189], v[188:189], v[26:27] op_sel_hi:[1,0]
  v_pk_mul_f32 v[190:191], v[190:191], v[26:27] op_sel_hi:[1,0]
  v_cvt_pk_bf16_f32 v84, v184, v185
  v_cvt_pk_bf16_f32 v85, v186, v187
  v_cvt_pk_bf16_f32 v86, v188, v189
  v_cvt_pk_bf16_f32 v87, v190, v191
  buffer_store_dwordx4 v[84:87], v3, s[4:7], s8 offen offset:1024 sc1
  s_branch .fz_kernel_a_fin
.fz_kernel_a_sl:
  s_waitcnt vmcnt(0)
  s_lshl_b32 s23, s18, 1
  s_add_u32 s23, s23, s39
  s_lshl_b32 s23, s23, 18
  s_add_u32 s23, s23, s63
  s_mov_b32 s30, s23
  s_mov_b32 s33, 64
  v_mov_b32 v27, 0xff800000
.fz_kernel_a_s1:
  buffer_load_dwordx4 v[80:83], v3, s[4:7], s30 offen offset:0
  buffer_load_dwordx4 v[84:87], v3, s[4:7], s30 offen offset:1024
  s_waitcnt vmcnt(0)
  v_mfma_f32_32x32x16_bf16 v[48:63], v[80:83], v[16:19], 0
  v_mfma_f32_32x32x16_bf16 v[48:63], v[84:87], v[20:23], v[48:63]
  s_nop 11
  v_max3_f32 v27, v27, v48, v49
  v_max3_f32 v27, v27, v50, v51
  v_max3_f32 v27, v27, v52, v53
  v_max3_f32 v27, v27, v54, v55
  v_max3_f32 v27, v27, v56, v57
  v_max3_f32 v27, v27, v58, v59
  v_max3_f32 v27, v27, v60, v61
  v_max3_f32 v27, v27, v62, v63
  s_add_u32 s30, s30, 4096
  s_sub_u32 s33, s33, 1
  s_cmp_lg_u32 s33, 0
  s_cbranch_scc1 .fz_kernel_a_s1
  v_mov_b32 v29, v27
  s_nop 1
  v_permlane32_swap_b32 v29, v27
  v_max_f32 v27, v27, v29
  v_sub_f32 v27, 0, v27
  v_mov_b32 v64, v27
  v_mov_b32 v144, 0
  v_mov_b32 v65, v27
  v_mov_b32 v145, 0
  v_mov_b32 v66, v27
  v_mov_b32 v146, 0
  v_mov_b32 v67, v27
  v_mov_b32 v147, 0
  v_mov_b32 v68, v27
  v_mov_b32 v148, 0
  v_mov_b32 v69, v27
  v_mov_b32 v149, 0
  v_mov_b32 v70, v27
  v_mov_b32 v150, 0
  v_mov_b32 v71, v27
  v_mov_b32 v151, 0
  v_mov_b32 v72, v27
  v_mov_b32 v152, 0
  v_mov_b32 v73, v27
  v_mov_b32 v153, 0
  v_mov_b32 v74, v27
  v_mov_b32 v154, 0
  v_mov_b32 v75, v27
  v_mov_b32 v155, 0
  v_mov_b32 v76, v27
  v_mov_b32 v156, 0
  v_mov_b32 v77, v27
  v_mov_b32 v157, 0
  v_mov_b32 v78, v27
  v_mov_b32 v158, 0
  v_mov_b32 v79, v27
  v_mov_b32 v159, 0
  v_mov_b32 v208, 0
  v_mov_b32 v209, 0
  v_mov_b32 v210, 0
  v_mov_b32 v211, 0
  s_mov_b32 s30, s23
  s_mov_b32 s33, 64
.fz_kernel_a_s2:
  buffer_load_dwordx4 v[80:83], v3, s[4:7], s30 offen offset:0
  buffer_load_dwordx4 v[84:87], v3, s[4:7], s30 offen offset:1024
  buffer_load_dwordx4 v[88:91], v3, s[4:7], s30 offen offset:2048
  buffer_load_dwordx4 v[92:95], v3, s[4:7], s30 offen offset:3072
  s_waitcnt vmcnt(0)
  v_mfma_f32_32x32x16_bf16 v[48:63], v[80:83], v[16:19], v[64:79]
  v_mfma_f32_32x32x16_bf16 v[48:63], v[84:87], v[20:23], v[48:63]
  s_nop 11
  v_exp_f32 v48, v48
  v_exp_f32 v49, v49
  v_exp_f32 v50, v50
  v_exp_f32 v51, v51
  v_exp_f32 v52, v52
  v_exp_f32 v53, v53
  v_exp_f32 v54, v54
  v_exp_f32 v55, v55
  v_exp_f32 v56, v56
  v_exp_f32 v57, v57
  v_exp_f32 v58, v58
  v_exp_f32 v59, v59
  v_exp_f32 v60, v60
  v_exp_f32 v61, v61
  v_exp_f32 v62, v62
  v_exp_f32 v63, v63
  v_cvt_pk_bf16_f32 v224, v48, v49
  v_cvt_pk_bf16_f32 v225, v50, v51
  v_cvt_pk_bf16_f32 v226, v52, v53
  v_cvt_pk_bf16_f32 v227, v54, v55
  v_cvt_pk_bf16_f32 v228, v56, v57
  v_cvt_pk_bf16_f32 v229, v58, v59
  v_cvt_pk_bf16_f32 v230, v60, v61
  v_cvt_pk_bf16_f32 v231, v62, v63
  v_mfma_f32_32x32x16_bf16 v[144:159], v[88:91], v[224:227], v[144:159]
  s_nop 0
  v_mfma_f32_32x32x16_bf16 v[144:159], v[92:95], v[228:231], v[144:159]
  v_smfmac_f32_16x16x64_bf16 v[208:211], v[12:15], v[224:231], v11
  s_add_u32 s30, s30, 4096
  s_sub_u32 s33, s33, 1
  s_cmp_lg_u32 s33, 0
  s_cbranch_scc1 .fz_kernel_a_s2
  s_nop 7
  v_add_f32 v208, v208, v210
  v_add_f32 v209, v209, v211
  v_cndmask_b32 v25, v208, v209, s[20:21]
  s_nop 7
  s_setpc_b64 s[68:69]
.fz_kernel_serv:
  s_setprio 3
  s_mov_b32 s24, s44
  s_mov_b32 s25, s45
  s_mov_b32 s26, 0x200000
  s_mov_b32 s27, 0x00020000
  v_lshrrev_b32 v8, 3, v2
  v_and_b32 v9, 7, v2
  v_bfe_u32 v10, v2, 4, 1
  v_lshlrev_b32 v10, 2, v10
  v_xor_b32 v9, v9, v10
  v_lshlrev_b32 v9, 4, v9
  v_lshl_add_u32 v10, v8, 11, v9
  s_cmp_eq_u32 s16, 5
  s_cbranch_scc1 .fz_kernel_sv1
  s_barrier
  v_lshlrev_b32 v7, 7, v2
  s_lshl_b32 s31, s18, 11
  s_lshl_b32 s33, 1, s17
  s_add_u32 s31, s31, s67
  s_add_u32 s31, s31, 0x1800000
  v_mov_b32 v8, s33
  s_mov_b64 exec, 0xffff
  s_mov_b32 s38, 0
.fz_kernel_cw40:
  s_sleep 1
  ds_read_u8 v9, v6 offset:256
  s_add_u32 s38, s38, 1
  s_waitcnt lgkmcnt(0)
  v_cmp_gt_u32 vcc, 4, v9
  s_cbranch_vccz .fz_kernel_cw40d
  s_cmp_lt_u32 s38, 8388608
  s_cbranch_scc1 .fz_kernel_cw40
.fz_kernel_cw40d:
  buffer_atomic_or v8, v7, s[4:7], s31 offen sc1
  s_mov_b64 exec, -1
  s_setprio 0
  s_mov_b32 s38, 0
.fz_kernel_kw41:
  s_sleep 2
  ds_read_b32 v7, v6 offset:0
  s_add_u32 s38, s38, 1
  s_waitcnt lgkmcnt(0)
  v_readfirstlane_b32 s31, v7
  s_bcnt1_i32_b32 s31, s31
  s_cmp_ge_u32 s31, 16
  s_cbranch_scc1 .fz_kernel_kw41d
  s_cmp_lt_u32 s38, 1048576
  s_cbranch_scc1 .fz_kernel_kw41
.fz_kernel_kw41d:
  s_branch .fz_kernel_sv2
.fz_kernel_sv1:
  s_add_u32 s37, s19, s67
  s_mov_b64 exec, 1
  buffer_load_dword v7, v4, s[4:7], s37 offen sc1
  s_waitcnt vmcnt(0)
  ds_or_b32 v6, v7
  buffer_load_dword v9, v4, s[4:7], s37 offen sc1
  s_barrier
  s_waitcnt vmcnt(0)
  ds_or_b32 v6, v9
  s_add_u32 s37, s19, s67
  s_mov_b64 exec, 1
  s_mov_b32 s38, 0
.fz_kernel_po42:
  buffer_load_dword v7, v4, s[4:7], s37 offen offset:0 sc1
  s_add_u32 s38, s38, 1
  s_waitcnt vmcnt(0)
  ds_or_b32 v6, v7 offset:0
  v_cmp_ne_u32 vcc, 0xffff, v7
  s_cbranch_vccz .fz_kernel_po42d
  s_sleep 12
  s_cmp_lt_u32 s38, 131072
  s_cbranch_scc1 .fz_kernel_po42
.fz_kernel_po42d:
  s_mov_b64 exec, -1
  s_setprio 0
  s_mov_b32 s38, 0
.fz_kernel_kw43:
  s_sleep 2
  ds_read_b32 v7, v6 offset:0
  s_add_u32 s38, s38, 1
  s_waitcnt lgkmcnt(0)
  v_readfirstlane_b32 s31, v7
  s_bcnt1_i32_b32 s31, s31
  s_cmp_ge_u32 s31, 16
  s_cbranch_scc1 .fz_kernel_kw43d
  s_cmp_lt_u32 s38, 1048576
  s_cbranch_scc1 .fz_kernel_kw43
.fz_kernel_kw43d:
.fz_kernel_sv2:
  s_and_b32 s30, s16, 1
  s_lshl_b32 s30, s30, 16
  s_add_u32 s32, s30, 65536
  s_lshl_b32 s31, s18, 7
  v_add_u32 v10, s31, v10
  s_lshr_b32 s33, s30, 2
  s_add_u32 s33, s33, 114688
  v_add_u32 v44, s33, v3
.fz_kernel_sv3:
  s_mov_b32 m0, s30
  s_lshl_b32 s31, s30, 4
  s_add_u32 s30, s30, 1024
  buffer_load_dwordx4 v10, s[24:27], s31 offen  lds
  s_cmp_lg_u32 s30, s32
  s_waitcnt vmcnt(4)
  s_cbranch_scc1 .fz_kernel_sv3
  s_mov_b32 s12, s54
  s_mov_b32 s13, s55
  s_mov_b32 s14, 0x700000
  s_mov_b32 s15, 0x00020000
  s_and_b32 s30, s16, 1
  s_lshl1_add_u32 s30, s17, s30
  s_lshl_b32 s30, s30, 18
  buffer_load_dwordx4 v[64:67], v10, s[12:15], s30 offen nt
  s_add_u32 s30, s30, 16384
  s_waitcnt vmcnt(2)
  buffer_load_dwordx4 v[68:71], v10, s[12:15], s30 offen nt
  s_add_u32 s30, s30, 16384
  s_waitcnt vmcnt(2)
  buffer_load_dwordx4 v[72:75], v10, s[12:15], s30 offen nt
  s_add_u32 s30, s30, 16384
  s_waitcnt vmcnt(2)
  buffer_load_dwordx4 v[76:79], v10, s[12:15], s30 offen nt
  s_add_u32 s30, s30, 16384
  s_waitcnt vmcnt(2)
  buffer_load_dwordx4 v[80:83], v10, s[12:15], s30 offen nt
  s_add_u32 s30, s30, 16384
  s_waitcnt vmcnt(2)
  buffer_load_dwordx4 v[84:87], v10, s[12:15], s30 offen nt
  s_add_u32 s30, s30, 16384
  s_waitcnt vmcnt(2)
  buffer_load_dwordx4 v[88:91], v10, s[12:15], s30 offen nt
  s_add_u32 s30, s30, 16384
  s_waitcnt vmcnt(2)
  buffer_load_dwordx4 v[92:95], v10, s[12:15], s30 offen nt
  s_add_u32 s30, s30, 16384
  s_waitcnt vmcnt(2)
  buffer_load_dwordx4 v[96:99], v10, s[12:15], s30 offen nt
  s_add_u32 s30, s30, 16384
  s_waitcnt vmcnt(2)
  buffer_load_dwordx4 v[100:103], v10, s[12:15], s30 offen nt
  s_add_u32 s30, s30, 16384
  s_waitcnt vmcnt(2)
  buffer_load_dwordx4 v[104:107], v10, s[12:15], s30 offen nt
  s_add_u32 s30, s30, 16384
  s_waitcnt vmcnt(2)
  buffer_load_dwordx4 v[108:111], v10, s[12:15], s30 offen nt
  s_add_u32 s30, s30, 16384
  s_waitcnt vmcnt(2)
  buffer_load_dwordx4 v[112:115], v10, s[12:15], s30 offen nt
  s_add_u32 s30, s30, 16384
  s_waitcnt vmcnt(2)
  buffer_load_dwordx4 v[116:119], v10, s[12:15], s30 offen nt
  s_add_u32 s30, s30, 16384
  s_waitcnt vmcnt(2)
  buffer_load_dwordx4 v[120:123], v10, s[12:15], s30 offen nt
  s_add_u32 s30, s30, 16384
  s_waitcnt vmcnt(2)
  buffer_load_dwordx4 v[124:127], v10, s[12:15], s30 offen nt
  s_add_u32 s30, s30, 16384
  s_waitcnt vmcnt(2)
  s_cmp_lg_u32 s62, 0
  s_cbranch_scc1 .fz_kernel_wt44
  s_mov_b32 s12, s42
  s_mov_b32 s13, s43
  s_mov_b32 s14, 0x600000
  s_mov_b32 s15, 0x00020000
  s_and_b32 s30, s16, 1
  s_lshl1_add_u32 s30, s17, s30
  s_and_b32 s30, s30, 15
  s_mul_i32 s30, s30, 393216
  s_lshl_b32 s31, s18, 7
  s_add_u32 s30, s30, s31
  v_mul_u32_u24 v11, 6144, v2
  buffer_load_dword v1, v11, s[12:15], s30 offen
  s_add_u32 s30, s30, 2048
  s_waitcnt vmcnt(0)
  buffer_load_dword v1, v11, s[12:15], s30 offen
  s_add_u32 s30, s30, 2048
  s_waitcnt vmcnt(0)
  buffer_load_dword v1, v11, s[12:15], s30 offen
  s_add_u32 s30, s30, 2048
  s_waitcnt vmcnt(0)
.fz_kernel_wt44:
  s_cmp_lg_u32 s16, 4
  s_cbranch_scc1 .fz_kernel_ct45e
  s_getpc_b64 s[0:1]
.fz_kernel_ct45:
  s_sub_u32 s0, s0, .fz_kernel_ct45-fz_kernel
  s_subb_u32 s1, s1, 0
  s_lshr_b32 s31, s2, 3
  s_mulk_i32 s31, 0x500
  v_lshl_add_u32 v1, v2, 7, s31
  v_min_u32 v1, .fz_kernel_last-fz_kernel, v1
  s_mov_b64 exec, 0x3ff
  global_load_dword v1, v1, s[0:1]
  s_mov_b64 exec, -1
.fz_kernel_ct45e:
  s_waitcnt vmcnt(0)
  s_cmp_lg_u32 s16, 5
  s_cbranch_scc1 .fz_kernel_sv35
  s_mov_b64 exec, 1
  s_mov_b32 s38, 0
.fz_kernel_sv34:
  s_sleep 4
  buffer_load_dword v7, v4, s[4:7], s37 offen offset:4 sc1
  ds_read_b32 v8, v6 offset:0x104
  s_add_u32 s38, s38, 1
  s_waitcnt vmcnt(0) lgkmcnt(0)
  ds_or_b32 v6, v7 offset:8
  v_cmp_eq_u32 vcc, 0xffff, v8
  s_cbranch_vccnz .fz_kernel_sv35
  s_cmp_lt_u32 s38, 131072
  s_cbranch_scc1 .fz_kernel_sv34
.fz_kernel_sv35:
  s_mov_b64 exec, -1
  s_setprio 3
  s_barrier
  s_cmp_eq_u32 s16, 5
  s_cbranch_scc1 .fz_kernel_sv4
  v_lshlrev_b32 v7, 11, v2
  s_lshl_b32 s31, s17, 7
  s_lshl_b32 s33, 1, s18
  s_add_u32 s31, s31, s67
  s_add_u32 s31, s31, 0x1800004
  v_mov_b32 v8, s33
  s_mov_b64 exec, 0xffff
  s_mov_b32 s38, 0
.fz_kernel_cw46:
  s_sleep 1
  ds_read_u8 v9, v6 offset:264
  s_add_u32 s38, s38, 1
  s_waitcnt lgkmcnt(0)
  v_cmp_gt_u32 vcc, 4, v9
  s_cbranch_vccz .fz_kernel_cw46d
  s_cmp_lt_u32 s38, 8388608
  s_cbranch_scc1 .fz_kernel_cw46
.fz_kernel_cw46d:
  buffer_atomic_or v8, v7, s[4:7], s31 offen sc1
  s_mov_b64 exec, -1
  s_mov_b64 exec, 1
  ds_or_b32 v6, v8 offset:8
  s_mov_b64 exec, -1
  s_branch .fz_kernel_sv5
.fz_kernel_sv4:
  s_add_u32 s37, s19, s67
  s_mov_b64 exec, 1
  s_mov_b32 s38, 0
.fz_kernel_po47:
  buffer_load_dword v7, v4, s[4:7], s37 offen offset:4 sc1
  s_add_u32 s38, s38, 1
  s_waitcnt vmcnt(0)
  ds_or_b32 v6, v7 offset:8
  v_cmp_ne_u32 vcc, 0xffff, v7
  s_cbranch_vccz .fz_kernel_po47d
  s_sleep 12
  s_cmp_lt_u32 s38, 131072
  s_cbranch_scc1 .fz_kernel_po47
.fz_kernel_po47d:
  s_mov_b64 exec, -1
.fz_kernel_sv5:
  s_mov_b32 s72, s66
  s_mov_b32 s73, s65
  s_mov_b32 s74, s67
  s_mov_b32 s75, s62
  s_cmp_lg_u32 s62, 0
  s_cbranch_scc1 .fz_kernel_w_lt
  s_mov_b32 s62, 1
  s_mov_b32 s63, 0x2000000
  s_mov_b32 s64, 0x2800000
  s_mov_b32 s65, 0x1400000
  s_mov_b32 s66, 0x1c42000
  s_mov_b32 s67, 12
  s_mov_b32 s71, 159776
  v_mov_b32 v6, 159832
  s_branch .fz_kernel_q_prod2
.fz_kernel_w_lt:
  s_barrier
  ds_write_b128 v44, v[64:67] offset:0
  ds_write_b128 v44, v[68:71] offset:1024
  ds_write_b128 v44, v[72:75] offset:2048
  ds_write_b128 v44, v[76:79] offset:3072
  ds_write_b128 v44, v[80:83] offset:4096
  ds_write_b128 v44, v[84:87] offset:5120
  ds_write_b128 v44, v[88:91] offset:6144
  ds_write_b128 v44, v[92:95] offset:7168
  ds_write_b128 v44, v[96:99] offset:8192
  ds_write_b128 v44, v[100:103] offset:9216
  ds_write_b128 v44, v[104:107] offset:10240
  ds_write_b128 v44, v[108:111] offset:11264
  ds_write_b128 v44, v[112:115] offset:12288
  ds_write_b128 v44, v[116:119] offset:13312
  ds_write_b128 v44, v[120:123] offset:14336
  ds_write_b128 v44, v[124:127] offset:15360
  s_waitcnt lgkmcnt(0)
  s_mov_b64 exec, 1
  ds_add_u32 v6, v5 offset:0x118
  s_mov_b64 exec, -1
  s_barrier
  s_branch .fz_kernel_fin
.fz_kernel_pk48c:
  s_call_b64 s[68:69], .fz_kernel_pick
  s_branch .fz_kernel_pk48
.fz_kernel_pk49c:
  s_call_b64 s[68:69], .fz_kernel_pick
  s_branch .fz_kernel_pk49
.fz_kernel_w_pt:
  v_lshlrev_b32 v44, 5, v17
  v_add_u32 v44, 155648, v44
  s_mov_b64 exec, vcc
  ds_read_b128 v[232:235], v44 offset:7424
  ds_read_b128 v[236:239], v44 offset:7440
  ds_read_b128 v[240:243], v44 offset:7488
  ds_read_b128 v[244:247], v44 offset:7504
  s_waitcnt lgkmcnt(0)
  v_pk_add_f32 v[64:65], v[64:65], v[232:233]
  v_pk_add_f32 v[66:67], v[66:67], v[234:235]
  v_pk_add_f32 v[68:69], v[68:69], v[236:237]
  v_pk_add_f32 v[70:71], v[70:71], v[238:239]
  v_pk_add_f32 v[72:73], v[72:73], v[240:241]
  v_pk_add_f32 v[74:75], v[74:75], v[242:243]
  v_pk_add_f32 v[76:77], v[76:77], v[244:245]
  v_pk_add_f32 v[78:79], v[78:79], v[246:247]
  ds_read_b128 v[232:235], v44 offset:7552
  ds_read_b128 v[236:239], v44 offset:7568
  ds_read_b128 v[240:243], v44 offset:7616
  ds_read_b128 v[244:247], v44 offset:7632
  s_waitcnt lgkmcnt(0)
  v_pk_add_f32 v[80:81], v[80:81], v[232:233]
  v_pk_add_f32 v[82:83], v[82:83], v[234:235]
  v_pk_add_f32 v[84:85], v[84:85], v[236:237]
  v_pk_add_f32 v[86:87], v[86:87], v[238:239]
  v_pk_add_f32 v[88:89], v[88:89], v[240:241]
  v_pk_add_f32 v[90:91], v[90:91], v[242:243]
  v_pk_add_f32 v[92:93], v[92:93], v[244:245]
  v_pk_add_f32 v[94:95], v[94:95], v[246:247]
  s_mov_b64 exec, -1
  s_branch .fz_kernel_w_pb
.fz_kernel_pk50c:
  s_call_b64 s[68:69], .fz_kernel_pick
  s_branch .fz_kernel_pk50
.fz_kernel_pk51c:
  s_call_b64 s[68:69], .fz_kernel_pick
  s_branch .fz_kernel_pk51
.fz_kernel_pk52c:
  s_call_b64 s[68:69], .fz_kernel_pick
  s_branch .fz_kernel_pk52
.fz_kernel_pk53c:
  s_call_b64 s[68:69], .fz_kernel_pick
  s_branch .fz_kernel_pk53
.fz_kernel_pk54c:
  s_call_b64 s[68:69], .fz_kernel_pick
  s_branch .fz_kernel_pk54
.fz_kernel_pk55c:
  s_call_b64 s[68:69], .fz_kernel_pick
  s_branch .fz_kernel_pk55
.fz_kernel_pk56c:
  s_call_b64 s[68:69], .fz_kernel_pick
  s_branch .fz_kernel_pk56
.fz_kernel_pk57c:
  s_call_b64 s[68:69], .fz_kernel_pick
  s_branch .fz_kernel_pk57
.fz_kernel_pk58c:
  s_call_b64 s[68:69], .fz_kernel_pick
  s_branch .fz_kernel_pk58
.fz_kernel_pk59c:
  s_call_b64 s[68:69], .fz_kernel_pick
  s_branch .fz_kernel_pk59
.fz_kernel_pk60c:
  s_call_b64 s[68:69], .fz_kernel_pick
  s_branch .fz_kernel_pk60
.fz_kernel_pk61c:
  s_call_b64 s[68:69], .fz_kernel_pick
  s_branch .fz_kernel_pk61
.fz_kernel_pk62c:
  s_call_b64 s[68:69], .fz_kernel_pick
  s_branch .fz_kernel_pk62
.fz_kernel_pk63c:
  s_call_b64 s[68:69], .fz_kernel_pick
  s_branch .fz_kernel_pk63
.fz_kernel_pk64c:
  s_call_b64 s[68:69], .fz_kernel_pick
  s_branch .fz_kernel_pk64
.fz_kernel_pk65c:
  s_call_b64 s[68:69], .fz_kernel_pick
  s_branch .fz_kernel_pk65
.fz_kernel_c_nl:
  s_barrier
  s_branch .fz_kernel_c_np
.fz_kernel_c_c7:
  s_mov_b32 s38, 0
.fz_kernel_cw70:
  s_sleep 1
  ds_read_u8 v22, v6 offset:272
  s_add_u32 s38, s38, 1
  s_waitcnt lgkmcnt(0)
  v_cmp_gt_u32 vcc, 2, v22
  s_cbranch_vccz .fz_kernel_cw70d
  s_cmp_lt_u32 s38, 8388608
  s_cbranch_scc1 .fz_kernel_cw70
.fz_kernel_cw70d:
  ds_read_b64_tr_b16 v[32:33], v7 offset:0
  ds_read_b64_tr_b16 v[34:35], v7 offset:512
  ds_read_b64_tr_b16 v[40:41], v13 offset:0
  ds_read_b64_tr_b16 v[42:43], v13 offset:512
  ds_read_b64_tr_b16 v[48:49], v7 offset:4096
  ds_read_b64_tr_b16 v[50:51], v7 offset:4608
  ds_read_b64_tr_b16 v[56:57], v13 offset:4096
  ds_read_b64_tr_b16 v[58:59], v13 offset:4608
  ds_read_b64_tr_b16 v[64:65], v7 offset:8192
  ds_read_b64_tr_b16 v[66:67], v7 offset:8704
  ds_read_b64_tr_b16 v[72:73], v13 offset:8192
  ds_read_b64_tr_b16 v[74:75], v13 offset:8704
  s_waitcnt lgkmcnt(0)
  ds_read_b64_tr_b16 v[36:37], v7 offset:12288
  ds_read_b64_tr_b16 v[38:39], v7 offset:12800
  ds_read_b64_tr_b16 v[44:45], v13 offset:12288
  ds_read_b64_tr_b16 v[46:47], v13 offset:12800
  ds_read_b64_tr_b16 v[52:53], v7 offset:16384
  ds_read_b64_tr_b16 v[54:55], v7 offset:16896
  ds_read_b64_tr_b16 v[60:61], v13 offset:16384
  ds_read_b64_tr_b16 v[62:63], v13 offset:16896
  ds_read_b64_tr_b16 v[68:69], v7 offset:20480
  ds_read_b64_tr_b16 v[70:71], v7 offset:20992
  ds_read_b64_tr_b16 v[76:77], v13 offset:20480
  ds_read_b64_tr_b16 v[78:79], v13 offset:20992
  s_waitcnt lgkmcnt(0)
  s_branch .fz_kernel_c_c2
.fz_kernel_c_coef:
  v_fma_f32 v242, -v240, v240, v242
  v_fma_f32 v243, -v241, v241, v243
  v_rsq_f32 v248, abs(v242)
  v_rsq_f32 v249, abs(v243)
  v_mul_f32 v254, v240, v248
  v_sub_f32 v254, 0, v254
  v_mov_b32 v252, 1.0
  v_fmac_f32 v252, 0x44800000, v248
  v_fma_f32 v242, v242, v24, -v25
  v_max_f32 v242, 0, v242
  v_mul_f32 v248, v252, v252
  v_fma_f32 v248, v248, v242, v25
  v_rsq_f32 v248, v248
  v_mul_f32 v240, v23, v240
  v_mul_f32 v248, v248, v252
  v_mul_f32 v250, v248, v240
  v_sub_f32 v250, 0, v250
  v_mul_f32 v255, v241, v249
  v_sub_f32 v255, 0, v255
  v_mov_b32 v253, 1.0
  v_fmac_f32 v253, 0x44800000, v249
  s_cmp_eq_u32 s3, 0
  s_cbranch_scc1 .fz_kernel_hb74
  s_barrier
  s_sub_u32 s3, s3, 1
.fz_kernel_hb74:
  v_fma_f32 v243, v243, v24, -v25
  v_max_f32 v243, 0, v243
  v_mul_f32 v249, v253, v253
  v_fma_f32 v249, v249, v243, v25
  v_rsq_f32 v249, v249
  v_mul_f32 v241, v23, v241
  v_mul_f32 v249, v249, v253
  v_mul_f32 v251, v249, v241
  v_sub_f32 v251, 0, v251
  s_setpc_b64 s[68:69]
.fz_kernel_c_gur:
  v_min_u32 v9, v144, v146
  v_cmp_eq_u32 s[8:9], 0, v9
  v_min_u32 v9, v148, v150
  v_cmp_eq_u32 s[10:11], 0, v9
  v_min_u32 v9, v152, v154
  v_cmp_eq_u32 s[12:13], 0, v9
  v_min_u32 v9, v156, v158
  v_cmp_eq_u32 s[14:15], 0, v9
  s_add_u32 s38, s38, 1
  s_cmp_ge_u32 s38, 131072
  s_cbranch_scc1 .fz_kernel_c_gud
  s_or_b64 exec, s[8:9], 1
  buffer_load_dwordx4 v[144:147], v21, s[4:7], s33 offen offset:0 sc1
  s_or_b64 exec, s[10:11], 1
  buffer_load_dwordx4 v[148:151], v21, s[4:7], s33 offen offset:512 sc1
  s_or_b64 exec, s[12:13], 1
  buffer_load_dwordx4 v[152:155], v21, s[4:7], s33 offen offset:1024 sc1
  s_or_b64 exec, s[14:15], 1
  buffer_load_dwordx4 v[156:159], v21, s[4:7], s33 offen offset:1536 sc1
  s_mov_b64 exec, -1
  s_branch .fz_kernel_c_gu
.fz_kernel_c_pur:
  s_cmp_eq_u32 s3, 0
  s_cbranch_scc1 .fz_kernel_hb79
  s_barrier
  s_sub_u32 s3, s3, 1
.fz_kernel_hb79:
  s_add_u32 s38, s38, 1
  s_cmp_ge_u32 s38, 131072
  s_cbranch_scc1 .fz_kernel_c_pud
  v_min_u32 v9, v144, v146
  v_cmp_eq_u32 vcc, 0, v9
  s_cbranch_vccz .fz_kernel_c_ps0
  buffer_load_dwordx4 v[144:147], v3, s[4:7], s21 offen offset:0 sc1
.fz_kernel_c_ps0:
  v_min_u32 v9, v148, v150
  v_cmp_eq_u32 vcc, 0, v9
  s_cbranch_vccz .fz_kernel_c_ps1
  buffer_load_dwordx4 v[148:151], v3, s[4:7], s21 offen offset:1024 sc1
.fz_kernel_c_ps1:
  v_min_u32 v9, v152, v154
  v_cmp_eq_u32 vcc, 0, v9
  s_cbranch_vccz .fz_kernel_c_ps2
  buffer_load_dwordx4 v[152:155], v3, s[4:7], s21 offen offset:2048 sc1
.fz_kernel_c_ps2:
  v_min_u32 v9, v156, v158
  v_cmp_eq_u32 vcc, 0, v9
  s_cbranch_vccz .fz_kernel_c_ps3
  buffer_load_dwordx4 v[156:159], v3, s[4:7], s21 offen offset:3072 sc1
.fz_kernel_c_ps3:
  v_min_u32 v9, v160, v162
  v_cmp_eq_u32 vcc, 0, v9
  s_cbranch_vccz .fz_kernel_c_ps4
  buffer_load_dwordx4 v[160:163], v3, s[4:7], s22 offen offset:0 sc1
.fz_kernel_c_ps4:
  v_min_u32 v9, v164, v166
  v_cmp_eq_u32 vcc, 0, v9
  s_cbranch_vccz .fz_kernel_c_ps5
  buffer_load_dwordx4 v[164:167], v3, s[4:7], s22 offen offset:1024 sc1
.fz_kernel_c_ps5:
  v_min_u32 v9, v168, v170
  v_cmp_eq_u32 vcc, 0, v9
  s_cbranch_vccz .fz_kernel_c_ps6
  buffer_load_dwordx4 v[168:171], v3, s[4:7], s22 offen offset:2048 sc1
.fz_kernel_c_ps6:
  s_branch .fz_kernel_c_pu
.fz_kernel_last:
  s_endpgm

.section .rodata,"a"
.p2align 6
.amdhsa_kernel fz_kernel
  .amdhsa_next_free_vgpr 256
  .amdhsa_next_free_sgpr 102
  .amdhsa_accum_offset 256
  .amdhsa_group_segment_fixed_size 0
  .amdhsa_kernarg_size 88
  .amdhsa_user_sgpr_count 2
  .amdhsa_user_sgpr_kernarg_segment_ptr 1
  .amdhsa_system_sgpr_workgroup_id_x 1
.end_amdhsa_kernel
```
